```python
import torch

def _softmax(x, axis=-1):
    return torch.softmax(x, dim=axis)
def _gelu(x):
    return torch.nn.functional.gelu(x, approximate="tanh")
def _silu(x):
    return torch.nn.functional.silu(x)
def _sigmoid(x):
    return torch.sigmoid(x)
def _layernorm(x, axis=-1, eps=1e-5):
    m = x.mean(dim=axis, keepdim=True)
    v = x.var(dim=axis, keepdim=True, unbiased=False)
    return (x - m) / torch.sqrt(v + eps)
def _scatter_add(tgt, idx, src, axis=0):
    return tgt.clone().index_add_(axis, idx, src)
def _segment_sum(src, seg, n):
    out = torch.zeros((n,) + src.shape[1:], dtype=src.dtype)
    return out.index_add_(0, seg, src)
def _pad(x, pw):
    flat = tuple(v for pair in reversed(pw) for v in pair)
    return torch.nn.functional.pad(x, flat)

kernel_name = 'standalone__fft_conv__vision'

def setup_inputs():

    _w = (lambda a: (lambda t: t.to(torch.bfloat16) if t.is_floating_point() else t)(torch.as_tensor(a)))
    H = W = 224
    C = 96
    K = 7
    return {
        "x": _w((lambda *s: torch.randn(*s, dtype=torch.bfloat16) * 0.05)(1, H, W, C)),
        "w": _w((lambda *s: torch.randn(*s, dtype=torch.bfloat16) * 0.05)(K, K, C, C)),
    }

def reference(x, w):
    B, H, W, C = x.shape
    K = w.shape[0]
    wp = _pad(w, ((0, H - K), (0, W - K), (0, 0), (0, 0)))
    Xf = (lambda x, axes=(-2,-1): torch.fft.rfft2(x.float(), dim=axes))(x, axes=(1, 2))
    Wf = (lambda x, axes=(-2,-1): torch.fft.rfft2(x.float(), dim=axes))(wp, axes=(0, 1))
    Yf = torch.einsum('bhwi,hwio->bhwo', Xf, Wf)
    y = (lambda x, s, axes=(-2,-1): torch.fft.irfft2(x, s=s, dim=axes).to(torch.bfloat16))(Yf, (H, W), axes=(1, 2))
    return y
```

```asm
; @launch kernel=k1_kernel grid=(256,1,1) block=(384,1,1) lds=64000
; @launch kernel=k2_kernel grid=(256,1,1) block=(256,1,1) lds=122368
; @launch kernel=k3_kernel grid=(224,1,1) block=(256,1,1) lds=49152
.amdgcn_target "amdgcn-amd-amdhsa--gfx950"
.text
.globl k1_kernel
.p2align 8
.type k1_kernel,@function
k1_kernel:
    s_load_dwordx4 s[4:7], s[0:1], 0
    s_load_dwordx2 s[8:9], s[0:1], 32
    s_getpc_b64 s[10:11]
K1_pc:
    v_lshrrev_b32 v5, 6, v0
    v_and_b32 v0, 63, v0
    v_readfirstlane_b32 s28, v5
    v_lshlrev_b32 v6, 4, v0
    s_nop 2
    s_lshr_b32 s26, s28, 2
    s_and_b32 s30, s2, 7
    s_lshl_b32 s30, s30, 5
    s_lshr_b32 s31, s2, 3
    s_add_u32 s30, s30, s31
    s_cmp_eq_u32 s26, 1
    s_cselect_b32 s31, s30, s2
    s_mul_i32 s27, s26, 28
    s_add_u32 s27, s27, 224
    s_cmp_ge_u32 s31, s27
    s_cbranch_scc1 K1_end
    s_cmp_ge_u32 s2, 256
    s_cbranch_scc1 K1_end
    s_and_b32 s45, s28, 3
    s_lshr_b32 s31, s30, 2
    s_mul_i32 s32, s31, 57
    s_lshr_b32 s32, s32, 9
    s_mul_i32 s33, s32, 9
    s_sub_u32 s33, s31, s33
    s_mul_i32 s34, s33, 43
    s_lshr_b32 s34, s34, 7
    s_mul_i32 s35, s34, 3
    s_sub_u32 s35, s33, s35
    s_mul_i32 s36, s32, 129024
    s_mul_i32 s37, s34, 6144
    s_add_u32 s36, s36, s37
    s_lshl_b32 s35, s35, 1
    s_add_u32 s35, s35, s45
    s_lshl_b32 s37, s35, 5
    s_add_u32 s36, s36, s37
    s_mul_i32 s50, s45, 7424
    s_add_u32 s50, s50, 49152
    v_lshrrev_b32 v8, 1, v0
    v_mul_u32_u24 v8, 192, v8
    v_and_b32 v9, 1, v0
    v_lshl_add_u32 v10, v9, 4, v8
    s_mul_i32 s38, s2, 43008
    s_mul_i32 s39, s45, 10752
    s_add_u32 s38, s38, s39
    s_cmp_eq_u32 s28, 0
    s_cselect_b32 s39, 43008, 0
    v_mov_b32 v9, s39
    v_cmp_gt_u32 vcc, 8, v0
    s_nop 1
    v_cndmask_b32 v9, 0, v9, vcc
    s_mul_i32 s29, s45, 12288
    s_cmp_eq_u32 s26, 1
    s_cselect_b32 s40, s36, s38
    s_cselect_b32 m0, s50, s29
    s_cselect_b64 vcc, -1, 0
    s_mul_i32 s41, s26, 17408
    s_add_u32 s41, s41, 1024
    s_mul_i32 s42, s26, 32
    s_add_u32 s42, s42, 1024
    s_mul_i32 s49, s26, 8731776
    s_sub_u32 s14, 9634944, s49
    v_cndmask_b32 v11, v6, v10, vcc
    v_add_u32 v12, v9, v11
    s_add_u32 s48, s40, s39
    s_add_u32 s40, s40, s41
    s_mov_b32 s15, 0x00020000
    s_waitcnt lgkmcnt(0)
    s_sub_u32 s4, s4, 1152
    s_subb_u32 s5, s5, 0
    s_cmp_eq_u32 s26, 1
    s_cselect_b32 s12, s6, s4
    s_cselect_b32 s13, s7, s5
    s_and_b32 s13, s13, 0xffff
    buffer_load_dwordx4 v11, s[12:15], s48 offen lds
    s_add_u32 m0, m0, s42
    s_nop 0
    buffer_load_dwordx4 v12, s[12:15], s40 offen lds
    s_add_u32 m0, m0, s42
    s_add_u32 s40, s40, s41
    buffer_load_dwordx4 v11, s[12:15], s40 offen lds
    s_add_u32 m0, m0, s42
    s_add_u32 s40, s40, s41
    buffer_load_dwordx4 v11, s[12:15], s40 offen lds
    s_add_u32 m0, m0, s42
    s_add_u32 s40, s40, s41
    buffer_load_dwordx4 v11, s[12:15], s40 offen lds
    s_add_u32 m0, m0, s42
    s_add_u32 s40, s40, s41
    buffer_load_dwordx4 v11, s[12:15], s40 offen lds
    s_add_u32 m0, m0, s42
    s_add_u32 s40, s40, s41
    s_cmp_eq_u32 s26, 1
    buffer_load_dwordx4 v11, s[12:15], s40 offen lds
    s_cbranch_scc1 K1_w
    s_add_u32 m0, m0, s42
    s_add_u32 s40, s40, s41
    buffer_load_dwordx4 v11, s[12:15], s40 offen lds
    s_add_u32 m0, m0, s42
    s_add_u32 s40, s40, s41
    buffer_load_dwordx4 v11, s[12:15], s40 offen lds
    s_add_u32 m0, m0, s42
    s_add_u32 s40, s40, s41
    buffer_load_dwordx4 v11, s[12:15], s40 offen lds
    s_add_u32 m0, m0, s42
    s_add_u32 s40, s40, s41
    buffer_load_dwordx4 v11, s[12:15], s40 offen lds
    s_add_u32 m0, m0, s42
    s_add_u32 s40, s40, s41
    buffer_load_dwordx4 v11, s[12:15], s40 offen lds
    v_bfe_u32 v80, v0, 1, 3
    v_lshrrev_b32 v81, 5, v0
    v_lshlrev_b32 v81, 4, v81
    v_bfe_u32 v82, v0, 4, 1
    v_lshl_add_u32 v81, v82, 2, v81
    v_cvt_f32_u32 v81, v81
    v_and_b32 v82, 1, v0
    v_cvt_f32_u32 v82, v82
    v_mul_f32 v82, 0x3e800000, v82
    v_add_u32 v83, 0, v80
    v_cvt_f32_u32 v83, v83
    v_mul_f32 v40, 0x3c842108, v83
    v_fma_f32 v44, v40, v81, v82
    v_add_u32 v83, 8, v80
    v_cvt_f32_u32 v83, v83
    v_mul_f32 v41, 0x3c842108, v83
    v_fma_f32 v45, v41, v81, v82
    v_add_u32 v83, 16, v80
    v_cvt_f32_u32 v83, v83
    v_mul_f32 v42, 0x3c842108, v83
    v_fma_f32 v46, v42, v81, v82
    v_add_u32 v83, 24, v80
    v_cvt_f32_u32 v83, v83
    v_mul_f32 v43, 0x3c842108, v83
    v_fma_f32 v47, v43, v81, v82
    v_cos_f32 v32, v44
    v_fmamk_f32 v33, v40, 0x3f800000, v44
    v_fmamk_f32 v34, v40, 0x40000000, v44
    v_fmamk_f32 v35, v40, 0x40400000, v44
    v_fmamk_f32 v36, v40, 0x41000000, v44
    v_fmamk_f32 v37, v40, 0x41100000, v44
    v_fmamk_f32 v38, v40, 0x41200000, v44
    v_fmamk_f32 v39, v40, 0x41300000, v44
    v_cos_f32 v33, v33
    v_cos_f32 v34, v34
    v_cos_f32 v35, v35
    v_cos_f32 v36, v36
    v_cos_f32 v37, v37
    v_cos_f32 v38, v38
    v_cos_f32 v39, v39
    v_cvt_pk_bf16_f32 v48, v32, v33
    v_cvt_pk_bf16_f32 v49, v34, v35
    v_cvt_pk_bf16_f32 v50, v36, v37
    v_cvt_pk_bf16_f32 v51, v38, v39
    v_fmamk_f32 v32, v40, 0x42000000, v44
    v_fmamk_f32 v33, v40, 0x42040000, v44
    v_fmamk_f32 v34, v40, 0x42080000, v44
    v_fmamk_f32 v35, v40, 0x420c0000, v44
    v_fmamk_f32 v36, v40, 0x42200000, v44
    v_fmamk_f32 v37, v40, 0x42240000, v44
    v_fmamk_f32 v38, v40, 0x42280000, v44
    v_fmamk_f32 v39, v40, 0x422c0000, v44
    v_cos_f32 v32, v32
    v_cos_f32 v33, v33
    v_cos_f32 v34, v34
    v_cos_f32 v35, v35
    v_cos_f32 v36, v36
    v_cos_f32 v37, v37
    v_cos_f32 v38, v38
    v_cos_f32 v39, v39
    v_cvt_pk_bf16_f32 v52, v32, v33
    v_cvt_pk_bf16_f32 v53, v34, v35
    v_cvt_pk_bf16_f32 v54, v36, v37
    v_cvt_pk_bf16_f32 v55, v38, v39
    v_cos_f32 v32, v45
    v_fmamk_f32 v33, v41, 0x3f800000, v45
    v_fmamk_f32 v34, v41, 0x40000000, v45
    v_fmamk_f32 v35, v41, 0x40400000, v45
    v_fmamk_f32 v36, v41, 0x41000000, v45
    v_fmamk_f32 v37, v41, 0x41100000, v45
    v_fmamk_f32 v38, v41, 0x41200000, v45
    v_fmamk_f32 v39, v41, 0x41300000, v45
    v_cos_f32 v33, v33
    v_cos_f32 v34, v34
    v_cos_f32 v35, v35
    v_cos_f32 v36, v36
    v_cos_f32 v37, v37
    v_cos_f32 v38, v38
    v_cos_f32 v39, v39
    v_cvt_pk_bf16_f32 v56, v32, v33
    v_cvt_pk_bf16_f32 v57, v34, v35
    v_cvt_pk_bf16_f32 v58, v36, v37
    v_cvt_pk_bf16_f32 v59, v38, v39
    v_fmamk_f32 v32, v41, 0x42000000, v45
    v_fmamk_f32 v33, v41, 0x42040000, v45
    v_fmamk_f32 v34, v41, 0x42080000, v45
    v_fmamk_f32 v35, v41, 0x420c0000, v45
    v_fmamk_f32 v36, v41, 0x42200000, v45
    v_fmamk_f32 v37, v41, 0x42240000, v45
    v_fmamk_f32 v38, v41, 0x42280000, v45
    v_fmamk_f32 v39, v41, 0x422c0000, v45
    v_cos_f32 v32, v32
    v_cos_f32 v33, v33
    v_cos_f32 v34, v34
    v_cos_f32 v35, v35
    v_cos_f32 v36, v36
    v_cos_f32 v37, v37
    v_cos_f32 v38, v38
    v_cos_f32 v39, v39
    v_cvt_pk_bf16_f32 v60, v32, v33
    v_cvt_pk_bf16_f32 v61, v34, v35
    v_cvt_pk_bf16_f32 v62, v36, v37
    v_cvt_pk_bf16_f32 v63, v38, v39
    v_cos_f32 v32, v46
    v_fmamk_f32 v33, v42, 0x3f800000, v46
    v_fmamk_f32 v34, v42, 0x40000000, v46
    v_fmamk_f32 v35, v42, 0x40400000, v46
    v_fmamk_f32 v36, v42, 0x41000000, v46
    v_fmamk_f32 v37, v42, 0x41100000, v46
    v_fmamk_f32 v38, v42, 0x41200000, v46
    v_fmamk_f32 v39, v42, 0x41300000, v46
    v_cos_f32 v33, v33
    v_cos_f32 v34, v34
    v_cos_f32 v35, v35
    v_cos_f32 v36, v36
    v_cos_f32 v37, v37
    v_cos_f32 v38, v38
    v_cos_f32 v39, v39
    v_cvt_pk_bf16_f32 v64, v32, v33
    v_cvt_pk_bf16_f32 v65, v34, v35
    v_cvt_pk_bf16_f32 v66, v36, v37
    v_cvt_pk_bf16_f32 v67, v38, v39
    v_fmamk_f32 v32, v42, 0x42000000, v46
    v_fmamk_f32 v33, v42, 0x42040000, v46
    v_fmamk_f32 v34, v42, 0x42080000, v46
    v_fmamk_f32 v35, v42, 0x420c0000, v46
    v_fmamk_f32 v36, v42, 0x42200000, v46
    v_fmamk_f32 v37, v42, 0x42240000, v46
    v_fmamk_f32 v38, v42, 0x42280000, v46
    v_fmamk_f32 v39, v42, 0x422c0000, v46
    v_cos_f32 v32, v32
    v_cos_f32 v33, v33
    v_cos_f32 v34, v34
    v_cos_f32 v35, v35
    v_cos_f32 v36, v36
    v_cos_f32 v37, v37
    v_cos_f32 v38, v38
    v_cos_f32 v39, v39
    v_cvt_pk_bf16_f32 v68, v32, v33
    v_cvt_pk_bf16_f32 v69, v34, v35
    v_cvt_pk_bf16_f32 v70, v36, v37
    v_cvt_pk_bf16_f32 v71, v38, v39
    v_cos_f32 v32, v47
    v_fmamk_f32 v33, v43, 0x3f800000, v47
    v_fmamk_f32 v34, v43, 0x40000000, v47
    v_fmamk_f32 v35, v43, 0x40400000, v47
    v_fmamk_f32 v36, v43, 0x41000000, v47
    v_fmamk_f32 v37, v43, 0x41100000, v47
    v_fmamk_f32 v38, v43, 0x41200000, v47
    v_fmamk_f32 v39, v43, 0x41300000, v47
    v_cos_f32 v33, v33
    v_cos_f32 v34, v34
    v_cos_f32 v35, v35
    v_cos_f32 v36, v36
    v_cos_f32 v37, v37
    v_cos_f32 v38, v38
    v_cos_f32 v39, v39
    v_cvt_pk_bf16_f32 v72, v32, v33
    v_cvt_pk_bf16_f32 v73, v34, v35
    v_cvt_pk_bf16_f32 v74, v36, v37
    v_cvt_pk_bf16_f32 v75, v38, v39
    v_fmamk_f32 v32, v43, 0x42000000, v47
    v_fmamk_f32 v33, v43, 0x42040000, v47
    v_fmamk_f32 v34, v43, 0x42080000, v47
    v_fmamk_f32 v35, v43, 0x420c0000, v47
    v_fmamk_f32 v36, v43, 0x42200000, v47
    v_fmamk_f32 v37, v43, 0x42240000, v47
    v_fmamk_f32 v38, v43, 0x42280000, v47
    v_fmamk_f32 v39, v43, 0x422c0000, v47
    v_cos_f32 v32, v32
    v_cos_f32 v33, v33
    v_cos_f32 v34, v34
    v_cos_f32 v35, v35
    v_cos_f32 v36, v36
    v_cos_f32 v37, v37
    v_cos_f32 v38, v38
    v_cos_f32 v39, v39
    v_cvt_pk_bf16_f32 v76, v32, v33
    v_cvt_pk_bf16_f32 v77, v34, v35
    v_cvt_pk_bf16_f32 v78, v36, v37
    v_cvt_pk_bf16_f32 v79, v38, v39
    v_cmp_gt_u32 vcc, 48, v0
    s_nop 1
    v_cndmask_b32 v55, 0, v55, vcc
    v_cndmask_b32 v63, 0, v63, vcc
    v_cndmask_b32 v71, 0, v71, vcc
    v_cndmask_b32 v79, 0, v79, vcc
    s_mov_b32 s16, s8
    s_and_b32 s17, s9, 0xffff
    s_mov_b32 s18, 11010048
    s_mov_b32 s19, 0x00020000
    v_and_b32 v1, 15, v0
    v_lshrrev_b32 v2, 4, v0
    v_bfe_u32 v3, v0, 2, 2
    v_and_b32 v4, 3, v0
    v_lshrrev_b32 v23, 1, v2
    v_lshlrev_b32 v23, 4, v23
    v_add_u32 v23, v23, v3
    v_and_b32 v24, 1, v2
    v_lshl_add_u32 v23, v24, 2, v23
    v_mul_u32_u24 v23, 192, v23
    v_lshl_add_u32 v23, v4, 3, v23
    v_add_u32 v20, s29, v23
    v_lshlrev_b32 v23, 6, v1
    v_lshl_add_u32 v25, v2, 4, v23
    s_lshl_b32 s53, s2, 2
    s_add_u32 s53, s53, s28
    s_mul_i32 s53, s53, 12288
    s_waitcnt vmcnt(6)
    ds_read_b64_tr_b16 v[80:81], v20 offset:0
    ds_read_b64_tr_b16 v[82:83], v20 offset:1536
    ds_read_b64_tr_b16 v[84:85], v20 offset:32
    ds_read_b64_tr_b16 v[86:87], v20 offset:1568
    ds_read_b64_tr_b16 v[88:89], v20 offset:64
    ds_read_b64_tr_b16 v[90:91], v20 offset:1600
    ds_read_b64_tr_b16 v[92:93], v20 offset:96
    ds_read_b64_tr_b16 v[94:95], v20 offset:1632
    ds_read_b64_tr_b16 v[96:97], v20 offset:128
    ds_read_b64_tr_b16 v[98:99], v20 offset:1664
    ds_read_b64_tr_b16 v[100:101], v20 offset:160
    ds_read_b64_tr_b16 v[102:103], v20 offset:1696
    s_waitcnt lgkmcnt(10)
    v_mfma_f32_16x16x32_bf16 v[128:131], v[80:83], v[48:51], 0
    v_mfma_f32_16x16x32_bf16 v[132:135], v[80:83], v[56:59], 0
    v_mfma_f32_16x16x32_bf16 v[136:139], v[80:83], v[64:67], 0
    v_mfma_f32_16x16x32_bf16 v[140:143], v[80:83], v[72:75], 0
    s_waitcnt lgkmcnt(8)
    v_mfma_f32_16x16x32_bf16 v[144:147], v[84:87], v[48:51], 0
    v_mfma_f32_16x16x32_bf16 v[148:151], v[84:87], v[56:59], 0
    v_mfma_f32_16x16x32_bf16 v[152:155], v[84:87], v[64:67], 0
    v_mfma_f32_16x16x32_bf16 v[156:159], v[84:87], v[72:75], 0
    s_waitcnt lgkmcnt(6)
    v_mfma_f32_16x16x32_bf16 v[160:163], v[88:91], v[48:51], 0
    v_mfma_f32_16x16x32_bf16 v[164:167], v[88:91], v[56:59], 0
    v_mfma_f32_16x16x32_bf16 v[168:171], v[88:91], v[64:67], 0
    v_mfma_f32_16x16x32_bf16 v[172:175], v[88:91], v[72:75], 0
    s_waitcnt lgkmcnt(4)
    v_mfma_f32_16x16x32_bf16 v[176:179], v[92:95], v[48:51], 0
    v_mfma_f32_16x16x32_bf16 v[180:183], v[92:95], v[56:59], 0
    v_mfma_f32_16x16x32_bf16 v[184:187], v[92:95], v[64:67], 0
    v_mfma_f32_16x16x32_bf16 v[188:191], v[92:95], v[72:75], 0
    s_waitcnt lgkmcnt(2)
    v_mfma_f32_16x16x32_bf16 v[192:195], v[96:99], v[48:51], 0
    v_mfma_f32_16x16x32_bf16 v[196:199], v[96:99], v[56:59], 0
    v_mfma_f32_16x16x32_bf16 v[200:203], v[96:99], v[64:67], 0
    v_mfma_f32_16x16x32_bf16 v[204:207], v[96:99], v[72:75], 0
    s_waitcnt lgkmcnt(0)
    v_mfma_f32_16x16x32_bf16 v[208:211], v[100:103], v[48:51], 0
    v_mfma_f32_16x16x32_bf16 v[212:215], v[100:103], v[56:59], 0
    v_mfma_f32_16x16x32_bf16 v[216:219], v[100:103], v[64:67], 0
    v_mfma_f32_16x16x32_bf16 v[220:223], v[100:103], v[72:75], 0
    s_waitcnt vmcnt(0)
    ds_read_b64_tr_b16 v[104:105], v20 offset:6144
    ds_read_b64_tr_b16 v[106:107], v20 offset:7680
    ds_read_b64_tr_b16 v[108:109], v20 offset:6176
    ds_read_b64_tr_b16 v[110:111], v20 offset:7712
    ds_read_b64_tr_b16 v[112:113], v20 offset:6208
    ds_read_b64_tr_b16 v[114:115], v20 offset:7744
    ds_read_b64_tr_b16 v[116:117], v20 offset:6240
    ds_read_b64_tr_b16 v[118:119], v20 offset:7776
    ds_read_b64_tr_b16 v[120:121], v20 offset:6272
    ds_read_b64_tr_b16 v[122:123], v20 offset:7808
    ds_read_b64_tr_b16 v[124:125], v20 offset:6304
    ds_read_b64_tr_b16 v[126:127], v20 offset:7840
    s_waitcnt lgkmcnt(10)
    v_mfma_f32_16x16x32_bf16 v[128:131], v[104:107], v[52:55], v[128:131]
    s_waitcnt lgkmcnt(8)
    v_mfma_f32_16x16x32_bf16 v[144:147], v[108:111], v[52:55], v[144:147]
    v_mfma_f32_16x16x32_bf16 v[132:135], v[104:107], v[60:63], v[132:135]
    v_mfma_f32_16x16x32_bf16 v[148:151], v[108:111], v[60:63], v[148:151]
    v_mfma_f32_16x16x32_bf16 v[136:139], v[104:107], v[68:71], v[136:139]
    v_mfma_f32_16x16x32_bf16 v[152:155], v[108:111], v[68:71], v[152:155]
    v_mfma_f32_16x16x32_bf16 v[140:143], v[104:107], v[76:79], v[140:143]
    v_mfma_f32_16x16x32_bf16 v[156:159], v[108:111], v[76:79], v[156:159]
    v_cvt_pk_bf16_f32 v224, v128, v129
    v_cvt_pk_bf16_f32 v225, v130, v131
    v_cvt_pk_bf16_f32 v226, v144, v145
    v_cvt_pk_bf16_f32 v227, v146, v147
    s_add_u32 s54, s53, 0
    buffer_store_dwordx4 v[224:227], v25, s[16:19], s54 offen sc1
    s_waitcnt lgkmcnt(6)
    v_mfma_f32_16x16x32_bf16 v[160:163], v[112:115], v[52:55], v[160:163]
    s_waitcnt lgkmcnt(4)
    v_mfma_f32_16x16x32_bf16 v[176:179], v[116:119], v[52:55], v[176:179]
    v_cvt_pk_bf16_f32 v228, v132, v133
    v_cvt_pk_bf16_f32 v229, v134, v135
    v_cvt_pk_bf16_f32 v230, v148, v149
    v_cvt_pk_bf16_f32 v231, v150, v151
    s_add_u32 s54, s53, 1024
    buffer_store_dwordx4 v[228:231], v25, s[16:19], s54 offen sc1
    v_mfma_f32_16x16x32_bf16 v[164:167], v[112:115], v[60:63], v[164:167]
    v_mfma_f32_16x16x32_bf16 v[180:183], v[116:119], v[60:63], v[180:183]
    v_cvt_pk_bf16_f32 v232, v136, v137
    v_cvt_pk_bf16_f32 v233, v138, v139
    v_cvt_pk_bf16_f32 v234, v152, v153
    v_cvt_pk_bf16_f32 v235, v154, v155
    s_add_u32 s54, s53, 2048
    buffer_store_dwordx4 v[232:235], v25, s[16:19], s54 offen sc1
    v_mfma_f32_16x16x32_bf16 v[168:171], v[112:115], v[68:71], v[168:171]
    v_mfma_f32_16x16x32_bf16 v[184:187], v[116:119], v[68:71], v[184:187]
    v_cvt_pk_bf16_f32 v236, v140, v141
    v_cvt_pk_bf16_f32 v237, v142, v143
    v_cvt_pk_bf16_f32 v238, v156, v157
    v_cvt_pk_bf16_f32 v239, v158, v159
    s_add_u32 s54, s53, 3072
    buffer_store_dwordx4 v[236:239], v25, s[16:19], s54 offen sc1
    v_mfma_f32_16x16x32_bf16 v[172:175], v[112:115], v[76:79], v[172:175]
    v_mfma_f32_16x16x32_bf16 v[188:191], v[116:119], v[76:79], v[188:191]
    v_cvt_pk_bf16_f32 v224, v160, v161
    v_cvt_pk_bf16_f32 v225, v162, v163
    v_cvt_pk_bf16_f32 v226, v176, v177
    v_cvt_pk_bf16_f32 v227, v178, v179
    s_add_u32 s54, s53, 4096
    buffer_store_dwordx4 v[224:227], v25, s[16:19], s54 offen sc1
    s_waitcnt lgkmcnt(2)
    v_mfma_f32_16x16x32_bf16 v[192:195], v[120:123], v[52:55], v[192:195]
    s_waitcnt lgkmcnt(0)
    v_mfma_f32_16x16x32_bf16 v[208:211], v[124:127], v[52:55], v[208:211]
    v_cvt_pk_bf16_f32 v228, v164, v165
    v_cvt_pk_bf16_f32 v229, v166, v167
    v_cvt_pk_bf16_f32 v230, v180, v181
    v_cvt_pk_bf16_f32 v231, v182, v183
    s_add_u32 s54, s53, 5120
    buffer_store_dwordx4 v[228:231], v25, s[16:19], s54 offen sc1
    v_mfma_f32_16x16x32_bf16 v[196:199], v[120:123], v[60:63], v[196:199]
    v_mfma_f32_16x16x32_bf16 v[212:215], v[124:127], v[60:63], v[212:215]
    v_cvt_pk_bf16_f32 v232, v168, v169
    v_cvt_pk_bf16_f32 v233, v170, v171
    v_cvt_pk_bf16_f32 v234, v184, v185
    v_cvt_pk_bf16_f32 v235, v186, v187
    s_add_u32 s54, s53, 6144
    buffer_store_dwordx4 v[232:235], v25, s[16:19], s54 offen sc1
    v_mfma_f32_16x16x32_bf16 v[200:203], v[120:123], v[68:71], v[200:203]
    v_mfma_f32_16x16x32_bf16 v[216:219], v[124:127], v[68:71], v[216:219]
    v_cvt_pk_bf16_f32 v236, v172, v173
    v_cvt_pk_bf16_f32 v237, v174, v175
    v_cvt_pk_bf16_f32 v238, v188, v189
    v_cvt_pk_bf16_f32 v239, v190, v191
    s_add_u32 s54, s53, 7168
    buffer_store_dwordx4 v[236:239], v25, s[16:19], s54 offen sc1
    v_mfma_f32_16x16x32_bf16 v[204:207], v[120:123], v[76:79], v[204:207]
    v_mfma_f32_16x16x32_bf16 v[220:223], v[124:127], v[76:79], v[220:223]
    v_cvt_pk_bf16_f32 v224, v192, v193
    v_cvt_pk_bf16_f32 v225, v194, v195
    v_cvt_pk_bf16_f32 v226, v208, v209
    v_cvt_pk_bf16_f32 v227, v210, v211
    s_add_u32 s54, s53, 8192
    buffer_store_dwordx4 v[224:227], v25, s[16:19], s54 offen sc1
    v_cvt_pk_bf16_f32 v228, v196, v197
    v_cvt_pk_bf16_f32 v229, v198, v199
    v_cvt_pk_bf16_f32 v230, v212, v213
    v_cvt_pk_bf16_f32 v231, v214, v215
    s_add_u32 s54, s53, 9216
    buffer_store_dwordx4 v[228:231], v25, s[16:19], s54 offen sc1
    v_cvt_pk_bf16_f32 v232, v200, v201
    v_cvt_pk_bf16_f32 v233, v202, v203
    v_cvt_pk_bf16_f32 v234, v216, v217
    v_cvt_pk_bf16_f32 v235, v218, v219
    s_add_u32 s54, s53, 10240
    buffer_store_dwordx4 v[232:235], v25, s[16:19], s54 offen sc1
    v_cvt_pk_bf16_f32 v236, v204, v205
    v_cvt_pk_bf16_f32 v237, v206, v207
    v_cvt_pk_bf16_f32 v238, v220, v221
    v_cvt_pk_bf16_f32 v239, v222, v223
    s_add_u32 s54, s53, 11264
    buffer_store_dwordx4 v[236:239], v25, s[16:19], s54 offen sc1
    s_endpgm
K1_w:
    s_mov_b32 s51, s50
    s_and_b32 s43, s30, 3
    s_lshl_b32 s43, s43, 2
    v_bfe_u32 v40, v0, 1, 1
    v_and_b32 v41, 1, v0
    v_cvt_f32_u32 v41, v41
    v_mul_f32 v41, 0x3e800000, v41
    v_bfe_u32 v42, v0, 2, 2
    v_lshrrev_b32 v43, 4, v0
    v_cmp_eq_u32 s[46:47], v42, v43
    s_lshl_b32 s44, s43, 1
    v_add_u32 v40, s44, v40
    v_cvt_f32_u32 v40, v40
    v_mul_f32 v42, 0x3c842108, v40
    v_cos_f32 v32, v41
    v_fmamk_f32 v33, v42, 0x3f800000, v41
    v_fmamk_f32 v34, v42, 0x40000000, v41
    v_fmamk_f32 v35, v42, 0x40400000, v41
    v_fmamk_f32 v36, v42, 0x40800000, v41
    v_fmamk_f32 v37, v42, 0x40a00000, v41
    v_fmamk_f32 v38, v42, 0x40c00000, v41
    v_cos_f32 v33, v33
    v_cos_f32 v34, v34
    v_cos_f32 v35, v35
    v_cos_f32 v36, v36
    v_cos_f32 v37, v37
    v_cos_f32 v38, v38
    v_mov_b32 v39, 0
    v_cvt_pk_bf16_f32 v48, v32, v33
    v_cvt_pk_bf16_f32 v49, v34, v35
    v_cvt_pk_bf16_f32 v50, v36, v37
    v_cvt_pk_bf16_f32 v51, v38, v39
    v_cndmask_b32 v48, 0, v48, s[46:47]
    v_cndmask_b32 v49, 0, v49, s[46:47]
    v_cndmask_b32 v50, 0, v50, s[46:47]
    v_cndmask_b32 v51, 0, v51, s[46:47]
    v_add_f32 v42, 0x3d042108, v42
    v_cos_f32 v32, v41
    v_fmamk_f32 v33, v42, 0x3f800000, v41
    v_fmamk_f32 v34, v42, 0x40000000, v41
    v_fmamk_f32 v35, v42, 0x40400000, v41
    v_fmamk_f32 v36, v42, 0x40800000, v41
    v_fmamk_f32 v37, v42, 0x40a00000, v41
    v_fmamk_f32 v38, v42, 0x40c00000, v41
    v_cos_f32 v33, v33
    v_cos_f32 v34, v34
    v_cos_f32 v35, v35
    v_cos_f32 v36, v36
    v_cos_f32 v37, v37
    v_cos_f32 v38, v38
    v_mov_b32 v39, 0
    v_cvt_pk_bf16_f32 v52, v32, v33
    v_cvt_pk_bf16_f32 v53, v34, v35
    v_cvt_pk_bf16_f32 v54, v36, v37
    v_cvt_pk_bf16_f32 v55, v38, v39
    v_cndmask_b32 v52, 0, v52, s[46:47]
    v_cndmask_b32 v53, 0, v53, s[46:47]
    v_cndmask_b32 v54, 0, v54, s[46:47]
    v_cndmask_b32 v55, 0, v55, s[46:47]
    v_add_f32 v42, 0x3d042108, v42
    v_cos_f32 v32, v41
    v_fmamk_f32 v33, v42, 0x3f800000, v41
    v_fmamk_f32 v34, v42, 0x40000000, v41
    v_fmamk_f32 v35, v42, 0x40400000, v41
    v_fmamk_f32 v36, v42, 0x40800000, v41
    v_fmamk_f32 v37, v42, 0x40a00000, v41
    v_fmamk_f32 v38, v42, 0x40c00000, v41
    v_cos_f32 v33, v33
    v_cos_f32 v34, v34
    v_cos_f32 v35, v35
    v_cos_f32 v36, v36
    v_cos_f32 v37, v37
    v_cos_f32 v38, v38
    v_mov_b32 v39, 0
    v_cvt_pk_bf16_f32 v56, v32, v33
    v_cvt_pk_bf16_f32 v57, v34, v35
    v_cvt_pk_bf16_f32 v58, v36, v37
    v_cvt_pk_bf16_f32 v59, v38, v39
    v_cndmask_b32 v56, 0, v56, s[46:47]
    v_cndmask_b32 v57, 0, v57, s[46:47]
    v_cndmask_b32 v58, 0, v58, s[46:47]
    v_cndmask_b32 v59, 0, v59, s[46:47]
    v_add_f32 v42, 0x3d042108, v42
    v_cos_f32 v32, v41
    v_fmamk_f32 v33, v42, 0x3f800000, v41
    v_fmamk_f32 v34, v42, 0x40000000, v41
    v_fmamk_f32 v35, v42, 0x40400000, v41
    v_fmamk_f32 v36, v42, 0x40800000, v41
    v_fmamk_f32 v37, v42, 0x40a00000, v41
    v_fmamk_f32 v38, v42, 0x40c00000, v41
    v_cos_f32 v33, v33
    v_cos_f32 v34, v34
    v_cos_f32 v35, v35
    v_cos_f32 v36, v36
    v_cos_f32 v37, v37
    v_cos_f32 v38, v38
    v_mov_b32 v39, 0
    v_cvt_pk_bf16_f32 v60, v32, v33
    v_cvt_pk_bf16_f32 v61, v34, v35
    v_cvt_pk_bf16_f32 v62, v36, v37
    v_cvt_pk_bf16_f32 v63, v38, v39
    v_cndmask_b32 v60, 0, v60, s[46:47]
    v_cndmask_b32 v61, 0, v61, s[46:47]
    v_cndmask_b32 v62, 0, v62, s[46:47]
    v_cndmask_b32 v63, 0, v63, s[46:47]
    s_add_u32 s16, s8, 0xb00000
    s_addc_u32 s17, s9, 0
    s_and_b32 s17, s17, 0xffff
    s_mov_b32 s18, 8257536
    s_mov_b32 s19, 0x00020000
    v_lshrrev_b32 v2, 4, v0
    v_bfe_u32 v3, v0, 2, 2
    v_and_b32 v4, 3, v0
    v_mul_u32_u24 v22, 1056, v3
    v_lshl_add_u32 v23, v2, 7, v22
    v_lshl_add_u32 v23, v4, 3, v23
    v_add_u32 v20, s51, v23
    v_add_u32 v22, 4, v3
    v_min_u32 v22, 6, v22
    v_sub_u32 v22, v22, v3
    v_mul_u32_u24 v22, 1056, v22
    v_add_u32 v21, v20, v22
    s_cmp_ge_u32 s35, 3
    s_cselect_b32 s48, 1, 0
    s_mul_i32 s49, s48, 3
    s_sub_u32 s49, s35, s49
    s_lshl_b32 s50, s43, 2
    s_add_u32 s50, s50, s48
    s_mul_i32 s50, s50, 21
    s_mul_i32 s51, s34, 7
    s_add_u32 s50, s50, s51
    s_add_u32 s50, s50, s32
    s_mul_i32 s50, s50, 6144
    s_lshl_b32 s49, s49, 11
    s_add_u32 s50, s50, s49
    s_waitcnt vmcnt(0)
    ds_read_b64_tr_b16 v[80:81], v20 offset:0
    ds_read_b64_tr_b16 v[82:83], v21 offset:0
    ds_read_b64_tr_b16 v[84:85], v20 offset:32
    ds_read_b64_tr_b16 v[86:87], v21 offset:32
    ds_read_b64_tr_b16 v[88:89], v20 offset:64
    ds_read_b64_tr_b16 v[90:91], v21 offset:64
    ds_read_b64_tr_b16 v[92:93], v20 offset:96
    ds_read_b64_tr_b16 v[94:95], v21 offset:96
    ds_read_b64_tr_b16 v[96:97], v20 offset:512
    ds_read_b64_tr_b16 v[98:99], v21 offset:512
    ds_read_b64_tr_b16 v[100:101], v20 offset:544
    ds_read_b64_tr_b16 v[102:103], v21 offset:544
    ds_read_b64_tr_b16 v[104:105], v20 offset:576
    ds_read_b64_tr_b16 v[106:107], v21 offset:576
    ds_read_b64_tr_b16 v[108:109], v20 offset:608
    ds_read_b64_tr_b16 v[110:111], v21 offset:608
    s_waitcnt lgkmcnt(14)
    v_mfma_f32_16x16x32_bf16 v[112:115], v[48:51], v[80:83], 0
    s_waitcnt lgkmcnt(12)
    v_mfma_f32_16x16x32_bf16 v[116:119], v[48:51], v[84:87], 0
    s_waitcnt lgkmcnt(10)
    v_mfma_f32_16x16x32_bf16 v[120:123], v[48:51], v[88:91], 0
    s_waitcnt lgkmcnt(8)
    v_mfma_f32_16x16x32_bf16 v[124:127], v[48:51], v[92:95], 0
    s_waitcnt lgkmcnt(6)
    v_mfma_f32_16x16x32_bf16 v[128:131], v[48:51], v[96:99], 0
    s_waitcnt lgkmcnt(4)
    v_mfma_f32_16x16x32_bf16 v[132:135], v[48:51], v[100:103], 0
    s_waitcnt lgkmcnt(2)
    v_mfma_f32_16x16x32_bf16 v[136:139], v[48:51], v[104:107], 0
    s_waitcnt lgkmcnt(0)
    v_mfma_f32_16x16x32_bf16 v[140:143], v[48:51], v[108:111], 0
    v_mfma_f32_16x16x32_bf16 v[144:147], v[52:55], v[80:83], 0
    v_mfma_f32_16x16x32_bf16 v[148:151], v[52:55], v[84:87], 0
    v_mfma_f32_16x16x32_bf16 v[152:155], v[52:55], v[88:91], 0
    v_mfma_f32_16x16x32_bf16 v[156:159], v[52:55], v[92:95], 0
    v_mfma_f32_16x16x32_bf16 v[160:163], v[52:55], v[96:99], 0
    v_mfma_f32_16x16x32_bf16 v[164:167], v[52:55], v[100:103], 0
    v_mfma_f32_16x16x32_bf16 v[168:171], v[52:55], v[104:107], 0
    v_mfma_f32_16x16x32_bf16 v[172:175], v[52:55], v[108:111], 0
    v_cvt_pk_bf16_f32 v176, v112, v116
    v_cvt_pk_bf16_f32 v177, v120, v124
    v_cvt_pk_bf16_f32 v178, v128, v132
    v_cvt_pk_bf16_f32 v179, v136, v140
    buffer_store_dwordx4 v[176:179], v6, s[16:19], s50 offen offset:0
    v_cvt_pk_bf16_f32 v180, v113, v117
    v_cvt_pk_bf16_f32 v181, v121, v125
    v_cvt_pk_bf16_f32 v182, v129, v133
    v_cvt_pk_bf16_f32 v183, v137, v141
    buffer_store_dwordx4 v[180:183], v6, s[16:19], s50 offen offset:1024
    v_cvt_pk_bf16_f32 v184, v114, v118
    v_cvt_pk_bf16_f32 v185, v122, v126
    v_cvt_pk_bf16_f32 v186, v130, v134
    v_cvt_pk_bf16_f32 v187, v138, v142
    s_add_u32 s50, s50, 258048
    buffer_store_dwordx4 v[184:187], v6, s[16:19], s50 offen offset:0
    v_cvt_pk_bf16_f32 v188, v115, v119
    v_cvt_pk_bf16_f32 v189, v123, v127
    v_cvt_pk_bf16_f32 v190, v131, v135
    v_cvt_pk_bf16_f32 v191, v139, v143
    buffer_store_dwordx4 v[188:191], v6, s[16:19], s50 offen offset:1024
    v_mfma_f32_16x16x32_bf16 v[112:115], v[56:59], v[80:83], 0
    v_mfma_f32_16x16x32_bf16 v[116:119], v[56:59], v[84:87], 0
    v_mfma_f32_16x16x32_bf16 v[120:123], v[56:59], v[88:91], 0
    v_mfma_f32_16x16x32_bf16 v[124:127], v[56:59], v[92:95], 0
    v_mfma_f32_16x16x32_bf16 v[128:131], v[56:59], v[96:99], 0
    v_mfma_f32_16x16x32_bf16 v[132:135], v[56:59], v[100:103], 0
    v_mfma_f32_16x16x32_bf16 v[136:139], v[56:59], v[104:107], 0
    v_mfma_f32_16x16x32_bf16 v[140:143], v[56:59], v[108:111], 0
    v_cvt_pk_bf16_f32 v192, v144, v148
    v_cvt_pk_bf16_f32 v193, v152, v156
    v_cvt_pk_bf16_f32 v194, v160, v164
    v_cvt_pk_bf16_f32 v195, v168, v172
    s_add_u32 s50, s50, 258048
    buffer_store_dwordx4 v[192:195], v6, s[16:19], s50 offen offset:0
    v_cvt_pk_bf16_f32 v196, v145, v149
    v_cvt_pk_bf16_f32 v197, v153, v157
    v_cvt_pk_bf16_f32 v198, v161, v165
    v_cvt_pk_bf16_f32 v199, v169, v173
    buffer_store_dwordx4 v[196:199], v6, s[16:19], s50 offen offset:1024
    v_cvt_pk_bf16_f32 v200, v146, v150
    v_cvt_pk_bf16_f32 v201, v154, v158
    v_cvt_pk_bf16_f32 v202, v162, v166
    v_cvt_pk_bf16_f32 v203, v170, v174
    s_add_u32 s50, s50, 258048
    buffer_store_dwordx4 v[200:203], v6, s[16:19], s50 offen offset:0
    v_cvt_pk_bf16_f32 v204, v147, v151
    v_cvt_pk_bf16_f32 v205, v155, v159
    v_cvt_pk_bf16_f32 v206, v163, v167
    v_cvt_pk_bf16_f32 v207, v171, v175
    buffer_store_dwordx4 v[204:207], v6, s[16:19], s50 offen offset:1024
    v_mfma_f32_16x16x32_bf16 v[144:147], v[60:63], v[80:83], 0
    v_mfma_f32_16x16x32_bf16 v[148:151], v[60:63], v[84:87], 0
    v_mfma_f32_16x16x32_bf16 v[152:155], v[60:63], v[88:91], 0
    v_mfma_f32_16x16x32_bf16 v[156:159], v[60:63], v[92:95], 0
    v_mfma_f32_16x16x32_bf16 v[160:163], v[60:63], v[96:99], 0
    v_mfma_f32_16x16x32_bf16 v[164:167], v[60:63], v[100:103], 0
    v_mfma_f32_16x16x32_bf16 v[168:171], v[60:63], v[104:107], 0
    v_mfma_f32_16x16x32_bf16 v[172:175], v[60:63], v[108:111], 0
    v_cvt_pk_bf16_f32 v176, v112, v116
    v_cvt_pk_bf16_f32 v177, v120, v124
    v_cvt_pk_bf16_f32 v178, v128, v132
    v_cvt_pk_bf16_f32 v179, v136, v140
    s_add_u32 s50, s50, 258048
    buffer_store_dwordx4 v[176:179], v6, s[16:19], s50 offen offset:0
    v_cvt_pk_bf16_f32 v180, v113, v117
    v_cvt_pk_bf16_f32 v181, v121, v125
    v_cvt_pk_bf16_f32 v182, v129, v133
    v_cvt_pk_bf16_f32 v183, v137, v141
    buffer_store_dwordx4 v[180:183], v6, s[16:19], s50 offen offset:1024
    v_cvt_pk_bf16_f32 v184, v114, v118
    v_cvt_pk_bf16_f32 v185, v122, v126
    v_cvt_pk_bf16_f32 v186, v130, v134
    v_cvt_pk_bf16_f32 v187, v138, v142
    s_add_u32 s50, s50, 258048
    buffer_store_dwordx4 v[184:187], v6, s[16:19], s50 offen offset:0
    v_cvt_pk_bf16_f32 v188, v115, v119
    v_cvt_pk_bf16_f32 v189, v123, v127
    v_cvt_pk_bf16_f32 v190, v131, v135
    v_cvt_pk_bf16_f32 v191, v139, v143
    buffer_store_dwordx4 v[188:191], v6, s[16:19], s50 offen offset:1024
    v_cvt_pk_bf16_f32 v192, v144, v148
    v_cvt_pk_bf16_f32 v193, v152, v156
    v_cvt_pk_bf16_f32 v194, v160, v164
    v_cvt_pk_bf16_f32 v195, v168, v172
    s_add_u32 s50, s50, 258048
    buffer_store_dwordx4 v[192:195], v6, s[16:19], s50 offen offset:0
    v_cvt_pk_bf16_f32 v196, v145, v149
    v_cvt_pk_bf16_f32 v197, v153, v157
    v_cvt_pk_bf16_f32 v198, v161, v165
    v_cvt_pk_bf16_f32 v199, v169, v173
    buffer_store_dwordx4 v[196:199], v6, s[16:19], s50 offen offset:1024
    v_cvt_pk_bf16_f32 v200, v146, v150
    v_cvt_pk_bf16_f32 v201, v154, v158
    v_cvt_pk_bf16_f32 v202, v162, v166
    v_cvt_pk_bf16_f32 v203, v170, v174
    s_add_u32 s50, s50, 258048
    buffer_store_dwordx4 v[200:203], v6, s[16:19], s50 offen offset:0
    v_cvt_pk_bf16_f32 v204, v147, v151
    v_cvt_pk_bf16_f32 v205, v155, v159
    v_cvt_pk_bf16_f32 v206, v163, v167
    v_cvt_pk_bf16_f32 v207, v171, v175
    buffer_store_dwordx4 v[204:207], v6, s[16:19], s50 offen offset:1024
    s_cmp_lg_u32 s28, 5
    s_cbranch_scc1 K1_nopf
    s_bfe_u32 s52, s2, 0x30003
    s_lshl_b32 s52, s52, 13
    v_lshlrev_b32 v24, 7, v0
    v_add_u32 v24, s52, v24
    v_add_u32 v24, k2_kernel-K1_pc, v24
    v_min_u32 v24, fft_tables_end-K1_pc-4, v24
    global_load_dword v25, v24, s[10:11]
K1_nopf:
K1_end:
    s_endpgm
.globl k2_kernel
.p2align 8
.type k2_kernel,@function
k2_kernel:
    s_load_dwordx2 s[8:9], s[0:1], 32
    s_getpc_b64 s[10:11]
K2_pc:
    s_cmp_ge_u32 s2, 256
    s_cbranch_scc1 K2_end
    v_lshrrev_b32 v5, 6, v0
    v_lshlrev_b32 v11, 7, v0
    v_min_u32 v11, K2_end-K2_pc, v11
    global_load_dword v11, v11, s[10:11]
    v_and_b32 v0, 63, v0
    v_readfirstlane_b32 s28, v5
    v_and_b32 v1, 15, v0
    v_lshrrev_b32 v2, 4, v0
    s_and_b32 s30, s2, 7
    s_lshl_b32 s30, s30, 2
    s_lshr_b32 s31, s2, 6
    s_add_u32 s30, s30, s31
    s_bfe_u32 s31, s2, 0x20004
    s_bfe_u32 s32, s2, 0x10003
    s_mul_i32 s33, s31, 12288
    s_lshl_b32 s39, s30, 7
    s_add_u32 s33, s33, s39
    s_lshl_b32 s34, s30, 1
    s_add_u32 s34, s34, s32
    s_mul_i32 s34, s34, 129024
    s_add_u32 s34, s34, 0xb00000
    s_lshl_b32 s35, s31, 5
    s_add_u32 s35, s35, s30
    s_lshl_b32 s35, s35, 1
    s_add_u32 s35, s35, s32
    s_mul_i32 s35, s35, 192
    s_and_b32 s36, s28, 1
    s_lshr_b32 s37, s28, 1
    s_mov_b32 s40, 0xcff3fcff
    s_mov_b32 s41, 0x03fcff3f
    v_mul_u32_u24 v5, 205, v0
    v_lshrrev_b32 v5, 11, v5
    v_mul_u32_u24 v6, 10, v5
    v_sub_u32 v6, v0, v6
    v_lshlrev_b32 v6, 4, v6
    v_mul_u32_u24 v5, 49152, v5
    v_add_u32 v3, v5, v6
    v_lshlrev_b32 v4, 4, v0
    v_mul_u32_u24 v8, 1120, v1
    v_lshl_add_u32 v8, v2, 4, v8
    s_mul_i32 s38, s36, 17920
    v_add_u32 v5, s38, v8
    v_add_u32 v6, 38400, v5
    v_add_u32 v7, 76800, v5
    v_mul_u32_u24 v9, 344064, v1
    v_lshl_add_u32 v9, v2, 4, v9
    s_mul_i32 s38, s36, 5505024
    s_add_u32 s38, s38, s35
    v_add_u32 v9, s38, v9
    v_lshlrev_b32 v10, 3, v0
    s_mul_i32 s38, s36, 3584
    s_add_u32 s38, s38, 115200
    v_add_u32 v10, s38, v10
    s_mul_i32 s42, s28, 960
    s_mul_i32 s43, s28, 294912
    s_sub_u32 s43, s43, 294912
    s_cmp_eq_u32 s28, 0
    s_cselect_b32 s44, 10715136, s43
    s_add_u32 s43, s43, 1179648
    s_lshl_b32 s45, s37, 11
    s_waitcnt lgkmcnt(0)
    s_sub_u32 s39, 11010048, s33
    s_add_u32 s12, s8, s33
    s_addc_u32 s13, s9, 0
    s_and_b32 s13, s13, 0xffff
    s_mov_b32 s14, 0
    s_mov_b32 s15, 0x00020000
    s_mov_b32 s14, s39
    s_add_u32 s16, s8, s34
    s_addc_u32 s17, s9, 0
    s_and_b32 s17, s17, 0xffff
    s_mov_b32 s18, 129024
    s_mov_b32 s19, 0x00020000
    s_add_u32 m0, s42, 0
    s_add_u32 s46, s44, 0
    s_mov_b64 exec, s[40:41]
    buffer_load_dwordx4 v3, s[12:15], s46 offen lds
    s_mov_b64 exec, -1
    s_add_u32 m0, s42, 3840
    s_add_u32 s46, s43, 0
    s_mov_b64 exec, s[40:41]
    buffer_load_dwordx4 v3, s[12:15], s46 offen lds
    s_mov_b64 exec, -1
    s_add_u32 m0, s42, 7680
    s_add_u32 s46, s43, 1179648
    s_mov_b64 exec, s[40:41]
    buffer_load_dwordx4 v3, s[12:15], s46 offen lds
    s_mov_b64 exec, -1
    s_add_u32 m0, s42, 11520
    s_add_u32 s46, s43, 2359296
    s_mov_b64 exec, s[40:41]
    buffer_load_dwordx4 v3, s[12:15], s46 offen lds
    s_mov_b64 exec, -1
    s_add_u32 m0, s42, 15360
    s_add_u32 s46, s43, 3538944
    s_mov_b64 exec, s[40:41]
    buffer_load_dwordx4 v3, s[12:15], s46 offen lds
    s_mov_b64 exec, -1
    s_add_u32 m0, s42, 19200
    s_add_u32 s46, s43, 4718592
    s_mov_b64 exec, s[40:41]
    buffer_load_dwordx4 v3, s[12:15], s46 offen lds
    s_mov_b64 exec, -1
    s_add_u32 m0, s42, 23040
    s_add_u32 s46, s43, 5898240
    s_mov_b64 exec, s[40:41]
    buffer_load_dwordx4 v3, s[12:15], s46 offen lds
    s_mov_b64 exec, -1
    s_add_u32 m0, s42, 26880
    s_add_u32 s46, s43, 7077888
    s_mov_b64 exec, s[40:41]
    buffer_load_dwordx4 v3, s[12:15], s46 offen lds
    s_mov_b64 exec, -1
    s_add_u32 m0, s42, 30720
    s_add_u32 s46, s43, 8257536
    s_mov_b64 exec, s[40:41]
    buffer_load_dwordx4 v3, s[12:15], s46 offen lds
    s_mov_b64 exec, -1
    s_add_u32 m0, s42, 34560
    s_add_u32 s46, s43, 9437184
    s_mov_b64 exec, s[40:41]
    buffer_load_dwordx4 v3, s[12:15], s46 offen lds
    s_mov_b64 exec, -1
    s_add_u32 s47, s45, 0
    buffer_load_dwordx4 v[96:99], v4, s[16:19], s47 offen offset:0
    buffer_load_dwordx4 v[100:103], v4, s[16:19], s47 offen offset:1024
    buffer_load_dwordx4 v[104:107], v4, s[16:19], s47 offen offset:2048
    buffer_load_dwordx4 v[108:111], v4, s[16:19], s47 offen offset:3072
    s_add_u32 s47, s45, 6144
    buffer_load_dwordx4 v[112:115], v4, s[16:19], s47 offen offset:0
    buffer_load_dwordx4 v[116:119], v4, s[16:19], s47 offen offset:1024
    buffer_load_dwordx4 v[120:123], v4, s[16:19], s47 offen offset:2048
    buffer_load_dwordx4 v[124:127], v4, s[16:19], s47 offen offset:3072
    s_add_u32 s47, s45, 12288
    buffer_load_dwordx4 v[128:131], v4, s[16:19], s47 offen offset:0
    buffer_load_dwordx4 v[132:135], v4, s[16:19], s47 offen offset:1024
    buffer_load_dwordx4 v[136:139], v4, s[16:19], s47 offen offset:2048
    buffer_load_dwordx4 v[140:143], v4, s[16:19], s47 offen offset:3072
    s_add_u32 s47, s45, 18432
    buffer_load_dwordx4 v[144:147], v4, s[16:19], s47 offen offset:0
    buffer_load_dwordx4 v[148:151], v4, s[16:19], s47 offen offset:1024
    buffer_load_dwordx4 v[152:155], v4, s[16:19], s47 offen offset:2048
    buffer_load_dwordx4 v[156:159], v4, s[16:19], s47 offen offset:3072
    s_add_u32 s20, s8, 0x1400000
    s_addc_u32 s21, s9, 0
    s_and_b32 s21, s21, 0xffff
    s_mov_b32 s22, 11010048
    s_mov_b32 s23, 0x00020000
    s_cmp_eq_u32 s37, 1
    s_cbranch_scc1 K2_q1
    s_waitcnt vmcnt(16)
    s_barrier
    ds_read_b128 a[48:51], v5 offset:1920
    ds_read_b128 a[100:103], v5 offset:1984
    ds_read_b128 a[44:47], v5 offset:1760
    ds_read_b128 a[96:99], v5 offset:1824
    ds_read_b128 a[40:43], v5 offset:1600
    ds_read_b128 a[92:95], v5 offset:1664
    ds_read_b128 a[36:39], v5 offset:1440
    ds_read_b128 a[88:91], v5 offset:1504
    ds_read_b128 a[32:35], v5 offset:1280
    ds_read_b128 a[84:87], v5 offset:1344
    ds_read_b128 a[28:31], v5 offset:1120
    ds_read_b128 a[80:83], v5 offset:1184
    ds_read_b128 a[24:27], v5 offset:960
    ds_read_b128 a[76:79], v5 offset:1024
    s_waitcnt vmcnt(14)
    v_xor_b32 v176, 0x80008000, v100
    v_xor_b32 v177, 0x80008000, v101
    v_xor_b32 v178, 0x80008000, v102
    v_xor_b32 v179, 0x80008000, v103
    s_waitcnt vmcnt(12)
    v_xor_b32 v108, 0x80008000, v108
    v_xor_b32 v109, 0x80008000, v109
    v_xor_b32 v110, 0x80008000, v110
    v_xor_b32 v111, 0x80008000, v111
    s_waitcnt lgkmcnt(13)
    v_mfma_f32_16x16x32_bf16 v[36:39], v[96:99], a[48:51], 0
    s_add_u32 s47, s45, 24576
    v_mfma_f32_16x16x32_bf16 v[64:67], v[100:103], a[48:51], 0
    buffer_load_dwordx4 v[160:163], v4, s[16:19], s47 offen offset:0
    v_mfma_f32_16x16x32_bf16 v[92:95], v[104:107], a[48:51], 0
    s_waitcnt lgkmcnt(12)
    v_mfma_f32_16x16x32_bf16 v[92:95], v[108:111], a[100:103], v[92:95]
    v_mfma_f32_16x16x32_bf16 v[64:67], v[96:99], a[100:103], v[64:67]
    buffer_load_dwordx4 v[164:167], v4, s[16:19], s47 offen offset:1024
    v_mfma_f32_16x16x32_bf16 v[36:39], v[176:179], a[100:103], v[36:39]
    s_waitcnt lgkmcnt(10)
    v_mfma_f32_16x16x32_bf16 v[32:35], v[176:179], a[96:99], 0
    v_mfma_f32_16x16x32_bf16 v[60:63], v[96:99], a[96:99], 0
    buffer_load_dwordx4 v[168:171], v4, s[16:19], s47 offen offset:2048
    v_mfma_f32_16x16x32_bf16 v[88:91], v[108:111], a[96:99], 0
    v_mfma_f32_16x16x32_bf16 v[88:91], v[104:107], a[44:47], v[88:91]
    v_mfma_f32_16x16x32_bf16 v[60:63], v[100:103], a[44:47], v[60:63]
    buffer_load_dwordx4 v[172:175], v4, s[16:19], s47 offen offset:3072
    v_mfma_f32_16x16x32_bf16 v[32:35], v[96:99], a[44:47], v[32:35]
    s_waitcnt lgkmcnt(9)
    v_mfma_f32_16x16x32_bf16 v[28:31], v[96:99], a[40:43], 0
    v_mfma_f32_16x16x32_bf16 v[56:59], v[100:103], a[40:43], 0
    ds_read_b128 a[20:23], v5 offset:800
    v_mfma_f32_16x16x32_bf16 v[84:87], v[104:107], a[40:43], 0
    s_waitcnt lgkmcnt(9)
    v_mfma_f32_16x16x32_bf16 v[84:87], v[108:111], a[92:95], v[84:87]
    ds_read_b128 a[72:75], v5 offset:864
    v_mfma_f32_16x16x32_bf16 v[56:59], v[96:99], a[92:95], v[56:59]
    v_mfma_f32_16x16x32_bf16 v[28:31], v[176:179], a[92:95], v[28:31]
    s_add_u32 m0, s42, 38400
    s_add_u32 s46, s44, 4096
    s_mov_b64 exec, s[40:41]
    buffer_load_dwordx4 v3, s[12:15], s46 offen lds
    s_mov_b64 exec, -1
    s_waitcnt lgkmcnt(8)
    v_mfma_f32_16x16x32_bf16 v[24:27], v[176:179], a[88:91], 0
    v_mfma_f32_16x16x32_bf16 v[52:55], v[96:99], a[88:91], 0
    v_mfma_f32_16x16x32_bf16 v[80:83], v[108:111], a[88:91], 0
    s_add_u32 m0, s42, 42240
    s_add_u32 s46, s43, 4096
    s_mov_b64 exec, s[40:41]
    buffer_load_dwordx4 v3, s[12:15], s46 offen lds
    s_mov_b64 exec, -1
    v_mfma_f32_16x16x32_bf16 v[80:83], v[104:107], a[36:39], v[80:83]
    v_mfma_f32_16x16x32_bf16 v[52:55], v[100:103], a[36:39], v[52:55]
    v_mfma_f32_16x16x32_bf16 v[24:27], v[96:99], a[36:39], v[24:27]
    s_add_u32 m0, s42, 46080
    s_add_u32 s46, s43, 1183744
    s_mov_b64 exec, s[40:41]
    buffer_load_dwordx4 v3, s[12:15], s46 offen lds
    s_mov_b64 exec, -1
    s_waitcnt lgkmcnt(7)
    v_mfma_f32_16x16x32_bf16 v[20:23], v[96:99], a[32:35], 0
    v_mfma_f32_16x16x32_bf16 v[48:51], v[100:103], a[32:35], 0
    s_waitcnt vmcnt(17)
    v_xor_b32 v180, 0x80008000, v116
    v_mfma_f32_16x16x32_bf16 v[76:79], v[104:107], a[32:35], 0
    s_waitcnt lgkmcnt(6)
    v_mfma_f32_16x16x32_bf16 v[76:79], v[108:111], a[84:87], v[76:79]
    v_xor_b32 v181, 0x80008000, v117
    v_mfma_f32_16x16x32_bf16 v[48:51], v[96:99], a[84:87], v[48:51]
    v_mfma_f32_16x16x32_bf16 v[20:23], v[176:179], a[84:87], v[20:23]
    v_xor_b32 v182, 0x80008000, v118
    s_waitcnt lgkmcnt(4)
    v_mfma_f32_16x16x32_bf16 v[16:19], v[176:179], a[80:83], 0
    v_mfma_f32_16x16x32_bf16 v[44:47], v[96:99], a[80:83], 0
    v_xor_b32 v183, 0x80008000, v119
    v_mfma_f32_16x16x32_bf16 v[72:75], v[108:111], a[80:83], 0
    v_mfma_f32_16x16x32_bf16 v[72:75], v[104:107], a[28:31], v[72:75]
    s_waitcnt vmcnt(15)
    v_xor_b32 v124, 0x80008000, v124
    v_mfma_f32_16x16x32_bf16 v[44:47], v[100:103], a[28:31], v[44:47]
    v_mfma_f32_16x16x32_bf16 v[16:19], v[96:99], a[28:31], v[16:19]
    v_xor_b32 v125, 0x80008000, v125
    s_waitcnt lgkmcnt(3)
    v_mfma_f32_16x16x32_bf16 v[12:15], v[96:99], a[24:27], 0
    v_mfma_f32_16x16x32_bf16 v[40:43], v[100:103], a[24:27], 0
    v_xor_b32 v126, 0x80008000, v126
    v_mfma_f32_16x16x32_bf16 v[68:71], v[104:107], a[24:27], 0
    s_waitcnt lgkmcnt(2)
    v_mfma_f32_16x16x32_bf16 v[68:71], v[108:111], a[76:79], v[68:71]
    v_xor_b32 v127, 0x80008000, v127
    v_mfma_f32_16x16x32_bf16 v[40:43], v[96:99], a[76:79], v[40:43]
    v_mfma_f32_16x16x32_bf16 v[12:15], v[176:179], a[76:79], v[12:15]
    v_mfma_f32_16x16x32_bf16 v[36:39], v[112:115], a[44:47], v[36:39]
    s_add_u32 s47, s45, 30720
    v_mfma_f32_16x16x32_bf16 v[64:67], v[116:119], a[44:47], v[64:67]
    buffer_load_dwordx4 v[96:99], v4, s[16:19], s47 offen offset:0
    v_mfma_f32_16x16x32_bf16 v[92:95], v[120:123], a[44:47], v[92:95]
    v_mfma_f32_16x16x32_bf16 v[92:95], v[124:127], a[96:99], v[92:95]
    v_mfma_f32_16x16x32_bf16 v[64:67], v[112:115], a[96:99], v[64:67]
    buffer_load_dwordx4 v[100:103], v4, s[16:19], s47 offen offset:1024
    v_mfma_f32_16x16x32_bf16 v[36:39], v[180:183], a[96:99], v[36:39]
    v_mfma_f32_16x16x32_bf16 v[32:35], v[180:183], a[92:95], v[32:35]
    v_mfma_f32_16x16x32_bf16 v[60:63], v[112:115], a[92:95], v[60:63]
    buffer_load_dwordx4 v[104:107], v4, s[16:19], s47 offen offset:2048
    v_mfma_f32_16x16x32_bf16 v[88:91], v[124:127], a[92:95], v[88:91]
    v_mfma_f32_16x16x32_bf16 v[88:91], v[120:123], a[40:43], v[88:91]
    v_mfma_f32_16x16x32_bf16 v[60:63], v[116:119], a[40:43], v[60:63]
    buffer_load_dwordx4 v[108:111], v4, s[16:19], s47 offen offset:3072
    v_mfma_f32_16x16x32_bf16 v[32:35], v[112:115], a[40:43], v[32:35]
    v_mfma_f32_16x16x32_bf16 v[28:31], v[112:115], a[36:39], v[28:31]
    v_mfma_f32_16x16x32_bf16 v[56:59], v[116:119], a[36:39], v[56:59]
    ds_read_b128 a[16:19], v5 offset:640
    v_mfma_f32_16x16x32_bf16 v[84:87], v[120:123], a[36:39], v[84:87]
    v_mfma_f32_16x16x32_bf16 v[84:87], v[124:127], a[88:91], v[84:87]
    ds_read_b128 a[68:71], v5 offset:704
    v_mfma_f32_16x16x32_bf16 v[56:59], v[112:115], a[88:91], v[56:59]
    v_mfma_f32_16x16x32_bf16 v[28:31], v[180:183], a[88:91], v[28:31]
    s_add_u32 m0, s42, 49920
    s_add_u32 s46, s43, 2363392
    s_mov_b64 exec, s[40:41]
    buffer_load_dwordx4 v3, s[12:15], s46 offen lds
    s_mov_b64 exec, -1
    v_mfma_f32_16x16x32_bf16 v[24:27], v[180:183], a[84:87], v[24:27]
    v_mfma_f32_16x16x32_bf16 v[52:55], v[112:115], a[84:87], v[52:55]
    v_mfma_f32_16x16x32_bf16 v[80:83], v[124:127], a[84:87], v[80:83]
    s_add_u32 m0, s42, 53760
    s_add_u32 s46, s43, 3543040
    s_mov_b64 exec, s[40:41]
    buffer_load_dwordx4 v3, s[12:15], s46 offen lds
    s_mov_b64 exec, -1
    v_mfma_f32_16x16x32_bf16 v[80:83], v[120:123], a[32:35], v[80:83]
    v_mfma_f32_16x16x32_bf16 v[52:55], v[116:119], a[32:35], v[52:55]
    v_mfma_f32_16x16x32_bf16 v[24:27], v[112:115], a[32:35], v[24:27]
    s_add_u32 m0, s42, 57600
    s_add_u32 s46, s43, 4722688
    s_mov_b64 exec, s[40:41]
    buffer_load_dwordx4 v3, s[12:15], s46 offen lds
    s_mov_b64 exec, -1
    v_mfma_f32_16x16x32_bf16 v[20:23], v[112:115], a[28:31], v[20:23]
    v_mfma_f32_16x16x32_bf16 v[48:51], v[116:119], a[28:31], v[48:51]
    s_waitcnt vmcnt(20)
    v_xor_b32 v184, 0x80008000, v132
    v_mfma_f32_16x16x32_bf16 v[76:79], v[120:123], a[28:31], v[76:79]
    v_mfma_f32_16x16x32_bf16 v[76:79], v[124:127], a[80:83], v[76:79]
    v_xor_b32 v185, 0x80008000, v133
    v_mfma_f32_16x16x32_bf16 v[48:51], v[112:115], a[80:83], v[48:51]
    v_mfma_f32_16x16x32_bf16 v[20:23], v[180:183], a[80:83], v[20:23]
    v_xor_b32 v186, 0x80008000, v134
    v_mfma_f32_16x16x32_bf16 v[16:19], v[180:183], a[76:79], v[16:19]
    v_mfma_f32_16x16x32_bf16 v[44:47], v[112:115], a[76:79], v[44:47]
    v_xor_b32 v187, 0x80008000, v135
    v_mfma_f32_16x16x32_bf16 v[72:75], v[124:127], a[76:79], v[72:75]
    v_mfma_f32_16x16x32_bf16 v[72:75], v[120:123], a[24:27], v[72:75]
    s_waitcnt vmcnt(18)
    v_xor_b32 v140, 0x80008000, v140
    v_mfma_f32_16x16x32_bf16 v[44:47], v[116:119], a[24:27], v[44:47]
    v_mfma_f32_16x16x32_bf16 v[16:19], v[112:115], a[24:27], v[16:19]
    v_xor_b32 v141, 0x80008000, v141
    s_waitcnt lgkmcnt(3)
    v_mfma_f32_16x16x32_bf16 v[12:15], v[112:115], a[20:23], v[12:15]
    v_mfma_f32_16x16x32_bf16 v[40:43], v[116:119], a[20:23], v[40:43]
    v_xor_b32 v142, 0x80008000, v142
    v_mfma_f32_16x16x32_bf16 v[68:71], v[120:123], a[20:23], v[68:71]
    s_waitcnt lgkmcnt(2)
    v_mfma_f32_16x16x32_bf16 v[68:71], v[124:127], a[72:75], v[68:71]
    v_xor_b32 v143, 0x80008000, v143
    v_mfma_f32_16x16x32_bf16 v[40:43], v[112:115], a[72:75], v[40:43]
    v_mfma_f32_16x16x32_bf16 v[12:15], v[180:183], a[72:75], v[12:15]
    v_mfma_f32_16x16x32_bf16 v[36:39], v[128:131], a[40:43], v[36:39]
    s_add_u32 s47, s45, 36864
    v_mfma_f32_16x16x32_bf16 v[64:67], v[132:135], a[40:43], v[64:67]
    buffer_load_dwordx4 v[112:115], v4, s[16:19], s47 offen offset:0
    v_mfma_f32_16x16x32_bf16 v[92:95], v[136:139], a[40:43], v[92:95]
    v_mfma_f32_16x16x32_bf16 v[92:95], v[140:143], a[92:95], v[92:95]
    v_mfma_f32_16x16x32_bf16 v[64:67], v[128:131], a[92:95], v[64:67]
    buffer_load_dwordx4 v[116:119], v4, s[16:19], s47 offen offset:1024
    v_mfma_f32_16x16x32_bf16 v[36:39], v[184:187], a[92:95], v[36:39]
    v_mfma_f32_16x16x32_bf16 v[32:35], v[184:187], a[88:91], v[32:35]
    v_mfma_f32_16x16x32_bf16 v[60:63], v[128:131], a[88:91], v[60:63]
    buffer_load_dwordx4 v[120:123], v4, s[16:19], s47 offen offset:2048
    v_mfma_f32_16x16x32_bf16 v[88:91], v[140:143], a[88:91], v[88:91]
    v_mfma_f32_16x16x32_bf16 v[88:91], v[136:139], a[36:39], v[88:91]
    v_mfma_f32_16x16x32_bf16 v[60:63], v[132:135], a[36:39], v[60:63]
    buffer_load_dwordx4 v[124:127], v4, s[16:19], s47 offen offset:3072
    v_mfma_f32_16x16x32_bf16 v[32:35], v[128:131], a[36:39], v[32:35]
    v_mfma_f32_16x16x32_bf16 v[28:31], v[128:131], a[32:35], v[28:31]
    v_mfma_f32_16x16x32_bf16 v[56:59], v[132:135], a[32:35], v[56:59]
    ds_read_b128 a[12:15], v5 offset:480
    v_mfma_f32_16x16x32_bf16 v[84:87], v[136:139], a[32:35], v[84:87]
    v_mfma_f32_16x16x32_bf16 v[84:87], v[140:143], a[84:87], v[84:87]
    ds_read_b128 a[64:67], v5 offset:544
    v_mfma_f32_16x16x32_bf16 v[56:59], v[128:131], a[84:87], v[56:59]
    v_mfma_f32_16x16x32_bf16 v[28:31], v[184:187], a[84:87], v[28:31]
    s_add_u32 m0, s42, 61440
    s_add_u32 s46, s43, 5902336
    s_mov_b64 exec, s[40:41]
    buffer_load_dwordx4 v3, s[12:15], s46 offen lds
    s_mov_b64 exec, -1
    v_mfma_f32_16x16x32_bf16 v[24:27], v[184:187], a[80:83], v[24:27]
    v_mfma_f32_16x16x32_bf16 v[52:55], v[128:131], a[80:83], v[52:55]
    v_mfma_f32_16x16x32_bf16 v[80:83], v[140:143], a[80:83], v[80:83]
    s_add_u32 m0, s42, 65280
    s_add_u32 s46, s43, 7081984
    s_mov_b64 exec, s[40:41]
    buffer_load_dwordx4 v3, s[12:15], s46 offen lds
    s_mov_b64 exec, -1
    v_mfma_f32_16x16x32_bf16 v[80:83], v[136:139], a[28:31], v[80:83]
    v_mfma_f32_16x16x32_bf16 v[52:55], v[132:135], a[28:31], v[52:55]
    v_mfma_f32_16x16x32_bf16 v[24:27], v[128:131], a[28:31], v[24:27]
    v_mfma_f32_16x16x32_bf16 v[20:23], v[128:131], a[24:27], v[20:23]
    v_mfma_f32_16x16x32_bf16 v[48:51], v[132:135], a[24:27], v[48:51]
    s_waitcnt vmcnt(22)
    v_xor_b32 v188, 0x80008000, v148
    v_mfma_f32_16x16x32_bf16 v[76:79], v[136:139], a[24:27], v[76:79]
    v_mfma_f32_16x16x32_bf16 v[76:79], v[140:143], a[76:79], v[76:79]
    v_xor_b32 v189, 0x80008000, v149
    v_mfma_f32_16x16x32_bf16 v[48:51], v[128:131], a[76:79], v[48:51]
    v_mfma_f32_16x16x32_bf16 v[20:23], v[184:187], a[76:79], v[20:23]
    v_xor_b32 v190, 0x80008000, v150
    v_mfma_f32_16x16x32_bf16 v[16:19], v[184:187], a[72:75], v[16:19]
    v_mfma_f32_16x16x32_bf16 v[44:47], v[128:131], a[72:75], v[44:47]
    v_xor_b32 v191, 0x80008000, v151
    v_mfma_f32_16x16x32_bf16 v[72:75], v[140:143], a[72:75], v[72:75]
    v_mfma_f32_16x16x32_bf16 v[72:75], v[136:139], a[20:23], v[72:75]
    s_waitcnt vmcnt(20)
    v_xor_b32 v156, 0x80008000, v156
    v_mfma_f32_16x16x32_bf16 v[44:47], v[132:135], a[20:23], v[44:47]
    v_mfma_f32_16x16x32_bf16 v[16:19], v[128:131], a[20:23], v[16:19]
    v_xor_b32 v157, 0x80008000, v157
    s_waitcnt lgkmcnt(3)
    v_mfma_f32_16x16x32_bf16 v[12:15], v[128:131], a[16:19], v[12:15]
    v_mfma_f32_16x16x32_bf16 v[40:43], v[132:135], a[16:19], v[40:43]
    v_xor_b32 v158, 0x80008000, v158
    v_mfma_f32_16x16x32_bf16 v[68:71], v[136:139], a[16:19], v[68:71]
    s_waitcnt lgkmcnt(2)
    v_mfma_f32_16x16x32_bf16 v[68:71], v[140:143], a[68:71], v[68:71]
    v_xor_b32 v159, 0x80008000, v159
    v_mfma_f32_16x16x32_bf16 v[40:43], v[128:131], a[68:71], v[40:43]
    v_mfma_f32_16x16x32_bf16 v[12:15], v[184:187], a[68:71], v[12:15]
    v_mfma_f32_16x16x32_bf16 v[36:39], v[144:147], a[36:39], v[36:39]
    s_add_u32 s47, s45, 43008
    v_mfma_f32_16x16x32_bf16 v[64:67], v[148:151], a[36:39], v[64:67]
    buffer_load_dwordx4 v[128:131], v4, s[16:19], s47 offen offset:0
    v_mfma_f32_16x16x32_bf16 v[92:95], v[152:155], a[36:39], v[92:95]
    v_mfma_f32_16x16x32_bf16 v[92:95], v[156:159], a[88:91], v[92:95]
    v_mfma_f32_16x16x32_bf16 v[64:67], v[144:147], a[88:91], v[64:67]
    buffer_load_dwordx4 v[132:135], v4, s[16:19], s47 offen offset:1024
    v_mfma_f32_16x16x32_bf16 v[36:39], v[188:191], a[88:91], v[36:39]
    v_mfma_f32_16x16x32_bf16 v[32:35], v[188:191], a[84:87], v[32:35]
    v_mfma_f32_16x16x32_bf16 v[60:63], v[144:147], a[84:87], v[60:63]
    buffer_load_dwordx4 v[136:139], v4, s[16:19], s47 offen offset:2048
    v_mfma_f32_16x16x32_bf16 v[88:91], v[156:159], a[84:87], v[88:91]
    v_mfma_f32_16x16x32_bf16 v[88:91], v[152:155], a[32:35], v[88:91]
    v_mfma_f32_16x16x32_bf16 v[60:63], v[148:151], a[32:35], v[60:63]
    buffer_load_dwordx4 v[140:143], v4, s[16:19], s47 offen offset:3072
    v_mfma_f32_16x16x32_bf16 v[32:35], v[144:147], a[32:35], v[32:35]
    v_mfma_f32_16x16x32_bf16 v[28:31], v[144:147], a[28:31], v[28:31]
    v_mfma_f32_16x16x32_bf16 v[56:59], v[148:151], a[28:31], v[56:59]
    ds_read_b128 a[8:11], v5 offset:320
    v_mfma_f32_16x16x32_bf16 v[84:87], v[152:155], a[28:31], v[84:87]
    v_mfma_f32_16x16x32_bf16 v[84:87], v[156:159], a[80:83], v[84:87]
    ds_read_b128 a[60:63], v5 offset:384
    v_mfma_f32_16x16x32_bf16 v[56:59], v[144:147], a[80:83], v[56:59]
    v_mfma_f32_16x16x32_bf16 v[28:31], v[188:191], a[80:83], v[28:31]
    s_add_u32 m0, s42, 69120
    s_add_u32 s46, s43, 8261632
    s_mov_b64 exec, s[40:41]
    buffer_load_dwordx4 v3, s[12:15], s46 offen lds
    s_mov_b64 exec, -1
    v_mfma_f32_16x16x32_bf16 v[24:27], v[188:191], a[76:79], v[24:27]
    v_mfma_f32_16x16x32_bf16 v[52:55], v[144:147], a[76:79], v[52:55]
    v_mfma_f32_16x16x32_bf16 v[80:83], v[156:159], a[76:79], v[80:83]
    s_add_u32 m0, s42, 72960
    s_add_u32 s46, s43, 9441280
    s_mov_b64 exec, s[40:41]
    buffer_load_dwordx4 v3, s[12:15], s46 offen lds
    s_mov_b64 exec, -1
    v_mfma_f32_16x16x32_bf16 v[80:83], v[152:155], a[24:27], v[80:83]
    v_mfma_f32_16x16x32_bf16 v[52:55], v[148:151], a[24:27], v[52:55]
    v_mfma_f32_16x16x32_bf16 v[24:27], v[144:147], a[24:27], v[24:27]
    v_mfma_f32_16x16x32_bf16 v[20:23], v[144:147], a[20:23], v[20:23]
    v_mfma_f32_16x16x32_bf16 v[48:51], v[148:151], a[20:23], v[48:51]
    s_waitcnt vmcnt(24)
    v_xor_b32 v192, 0x80008000, v164
    v_mfma_f32_16x16x32_bf16 v[76:79], v[152:155], a[20:23], v[76:79]
    v_mfma_f32_16x16x32_bf16 v[76:79], v[156:159], a[72:75], v[76:79]
    v_xor_b32 v193, 0x80008000, v165
    v_mfma_f32_16x16x32_bf16 v[48:51], v[144:147], a[72:75], v[48:51]
    v_mfma_f32_16x16x32_bf16 v[20:23], v[188:191], a[72:75], v[20:23]
    v_xor_b32 v194, 0x80008000, v166
    v_mfma_f32_16x16x32_bf16 v[16:19], v[188:191], a[68:71], v[16:19]
    v_mfma_f32_16x16x32_bf16 v[44:47], v[144:147], a[68:71], v[44:47]
    v_xor_b32 v195, 0x80008000, v167
    v_mfma_f32_16x16x32_bf16 v[72:75], v[156:159], a[68:71], v[72:75]
    v_mfma_f32_16x16x32_bf16 v[72:75], v[152:155], a[16:19], v[72:75]
    s_waitcnt vmcnt(22)
    v_xor_b32 v172, 0x80008000, v172
    v_mfma_f32_16x16x32_bf16 v[44:47], v[148:151], a[16:19], v[44:47]
    v_mfma_f32_16x16x32_bf16 v[16:19], v[144:147], a[16:19], v[16:19]
    v_xor_b32 v173, 0x80008000, v173
    s_waitcnt lgkmcnt(3)
    v_mfma_f32_16x16x32_bf16 v[12:15], v[144:147], a[12:15], v[12:15]
    v_mfma_f32_16x16x32_bf16 v[40:43], v[148:151], a[12:15], v[40:43]
    v_xor_b32 v174, 0x80008000, v174
    v_mfma_f32_16x16x32_bf16 v[68:71], v[152:155], a[12:15], v[68:71]
    s_waitcnt lgkmcnt(2)
    v_mfma_f32_16x16x32_bf16 v[68:71], v[156:159], a[64:67], v[68:71]
    v_xor_b32 v175, 0x80008000, v175
    v_mfma_f32_16x16x32_bf16 v[40:43], v[144:147], a[64:67], v[40:43]
    v_mfma_f32_16x16x32_bf16 v[12:15], v[188:191], a[64:67], v[12:15]
    v_mfma_f32_16x16x32_bf16 v[36:39], v[160:163], a[32:35], v[36:39]
    s_add_u32 s47, s45, 49152
    v_mfma_f32_16x16x32_bf16 v[64:67], v[164:167], a[32:35], v[64:67]
    buffer_load_dwordx4 v[144:147], v4, s[16:19], s47 offen offset:0
    v_mfma_f32_16x16x32_bf16 v[92:95], v[168:171], a[32:35], v[92:95]
    v_mfma_f32_16x16x32_bf16 v[92:95], v[172:175], a[84:87], v[92:95]
    v_mfma_f32_16x16x32_bf16 v[64:67], v[160:163], a[84:87], v[64:67]
    buffer_load_dwordx4 v[148:151], v4, s[16:19], s47 offen offset:1024
    v_mfma_f32_16x16x32_bf16 v[36:39], v[192:195], a[84:87], v[36:39]
    v_mfma_f32_16x16x32_bf16 v[32:35], v[192:195], a[80:83], v[32:35]
    v_mfma_f32_16x16x32_bf16 v[60:63], v[160:163], a[80:83], v[60:63]
    buffer_load_dwordx4 v[152:155], v4, s[16:19], s47 offen offset:2048
    v_mfma_f32_16x16x32_bf16 v[88:91], v[172:175], a[80:83], v[88:91]
    v_mfma_f32_16x16x32_bf16 v[88:91], v[168:171], a[28:31], v[88:91]
    v_mfma_f32_16x16x32_bf16 v[60:63], v[164:167], a[28:31], v[60:63]
    buffer_load_dwordx4 v[156:159], v4, s[16:19], s47 offen offset:3072
    v_mfma_f32_16x16x32_bf16 v[32:35], v[160:163], a[28:31], v[32:35]
    v_mfma_f32_16x16x32_bf16 v[28:31], v[160:163], a[24:27], v[28:31]
    v_mfma_f32_16x16x32_bf16 v[56:59], v[164:167], a[24:27], v[56:59]
    ds_read_b128 a[4:7], v5 offset:160
    v_mfma_f32_16x16x32_bf16 v[84:87], v[168:171], a[24:27], v[84:87]
    v_mfma_f32_16x16x32_bf16 v[84:87], v[172:175], a[76:79], v[84:87]
    ds_read_b128 a[56:59], v5 offset:224
    v_mfma_f32_16x16x32_bf16 v[56:59], v[160:163], a[76:79], v[56:59]
    v_mfma_f32_16x16x32_bf16 v[28:31], v[192:195], a[76:79], v[28:31]
    v_mfma_f32_16x16x32_bf16 v[24:27], v[192:195], a[72:75], v[24:27]
    v_mfma_f32_16x16x32_bf16 v[52:55], v[160:163], a[72:75], v[52:55]
    v_mfma_f32_16x16x32_bf16 v[80:83], v[172:175], a[72:75], v[80:83]
    v_mfma_f32_16x16x32_bf16 v[80:83], v[168:171], a[20:23], v[80:83]
    v_mfma_f32_16x16x32_bf16 v[52:55], v[164:167], a[20:23], v[52:55]
    v_mfma_f32_16x16x32_bf16 v[24:27], v[160:163], a[20:23], v[24:27]
    v_mfma_f32_16x16x32_bf16 v[20:23], v[160:163], a[16:19], v[20:23]
    v_mfma_f32_16x16x32_bf16 v[48:51], v[164:167], a[16:19], v[48:51]
    s_waitcnt vmcnt(21)
    v_xor_b32 v176, 0x80008000, v100
    v_mfma_f32_16x16x32_bf16 v[76:79], v[168:171], a[16:19], v[76:79]
    v_mfma_f32_16x16x32_bf16 v[76:79], v[172:175], a[68:71], v[76:79]
    v_xor_b32 v177, 0x80008000, v101
    v_mfma_f32_16x16x32_bf16 v[48:51], v[160:163], a[68:71], v[48:51]
    v_mfma_f32_16x16x32_bf16 v[20:23], v[192:195], a[68:71], v[20:23]
    v_xor_b32 v178, 0x80008000, v102
    v_mfma_f32_16x16x32_bf16 v[16:19], v[192:195], a[64:67], v[16:19]
    v_mfma_f32_16x16x32_bf16 v[44:47], v[160:163], a[64:67], v[44:47]
    v_xor_b32 v179, 0x80008000, v103
    v_mfma_f32_16x16x32_bf16 v[72:75], v[172:175], a[64:67], v[72:75]
    v_mfma_f32_16x16x32_bf16 v[72:75], v[168:171], a[12:15], v[72:75]
    s_waitcnt vmcnt(19)
    v_xor_b32 v108, 0x80008000, v108
    v_mfma_f32_16x16x32_bf16 v[44:47], v[164:167], a[12:15], v[44:47]
    v_mfma_f32_16x16x32_bf16 v[16:19], v[160:163], a[12:15], v[16:19]
    v_xor_b32 v109, 0x80008000, v109
    s_waitcnt lgkmcnt(3)
    v_mfma_f32_16x16x32_bf16 v[12:15], v[160:163], a[8:11], v[12:15]
    v_mfma_f32_16x16x32_bf16 v[40:43], v[164:167], a[8:11], v[40:43]
    v_xor_b32 v110, 0x80008000, v110
    v_mfma_f32_16x16x32_bf16 v[68:71], v[168:171], a[8:11], v[68:71]
    s_waitcnt lgkmcnt(2)
    v_mfma_f32_16x16x32_bf16 v[68:71], v[172:175], a[60:63], v[68:71]
    v_xor_b32 v111, 0x80008000, v111
    v_mfma_f32_16x16x32_bf16 v[40:43], v[160:163], a[60:63], v[40:43]
    v_mfma_f32_16x16x32_bf16 v[12:15], v[192:195], a[60:63], v[12:15]
    v_mfma_f32_16x16x32_bf16 v[36:39], v[96:99], a[28:31], v[36:39]
    s_add_u32 s47, s45, 55296
    v_mfma_f32_16x16x32_bf16 v[64:67], v[100:103], a[28:31], v[64:67]
    buffer_load_dwordx4 v[160:163], v4, s[16:19], s47 offen offset:0
    v_mfma_f32_16x16x32_bf16 v[92:95], v[104:107], a[28:31], v[92:95]
    v_mfma_f32_16x16x32_bf16 v[92:95], v[108:111], a[80:83], v[92:95]
    v_mfma_f32_16x16x32_bf16 v[64:67], v[96:99], a[80:83], v[64:67]
    buffer_load_dwordx4 v[164:167], v4, s[16:19], s47 offen offset:1024
    v_mfma_f32_16x16x32_bf16 v[36:39], v[176:179], a[80:83], v[36:39]
    v_mfma_f32_16x16x32_bf16 v[32:35], v[176:179], a[76:79], v[32:35]
    v_mfma_f32_16x16x32_bf16 v[60:63], v[96:99], a[76:79], v[60:63]
    buffer_load_dwordx4 v[168:171], v4, s[16:19], s47 offen offset:2048
    v_mfma_f32_16x16x32_bf16 v[88:91], v[108:111], a[76:79], v[88:91]
    v_mfma_f32_16x16x32_bf16 v[88:91], v[104:107], a[24:27], v[88:91]
    v_mfma_f32_16x16x32_bf16 v[60:63], v[100:103], a[24:27], v[60:63]
    buffer_load_dwordx4 v[172:175], v4, s[16:19], s47 offen offset:3072
    v_mfma_f32_16x16x32_bf16 v[32:35], v[96:99], a[24:27], v[32:35]
    s_waitcnt vmcnt(8)
    s_barrier
    v_mfma_f32_16x16x32_bf16 v[28:31], v[96:99], a[20:23], v[28:31]
    v_mfma_f32_16x16x32_bf16 v[56:59], v[100:103], a[20:23], v[56:59]
    ds_read_b128 a[0:3], v5 offset:0
    v_mfma_f32_16x16x32_bf16 v[84:87], v[104:107], a[20:23], v[84:87]
    v_mfma_f32_16x16x32_bf16 v[84:87], v[108:111], a[72:75], v[84:87]
    ds_read_b128 a[52:55], v5 offset:64
    v_mfma_f32_16x16x32_bf16 v[56:59], v[96:99], a[72:75], v[56:59]
    v_mfma_f32_16x16x32_bf16 v[28:31], v[176:179], a[72:75], v[28:31]
    ds_read_b128 a[48:51], v6 offset:1920
    v_mfma_f32_16x16x32_bf16 v[24:27], v[176:179], a[68:71], v[24:27]
    v_mfma_f32_16x16x32_bf16 v[52:55], v[96:99], a[68:71], v[52:55]
    ds_read_b128 a[100:103], v6 offset:1984
    v_mfma_f32_16x16x32_bf16 v[80:83], v[108:111], a[68:71], v[80:83]
    v_mfma_f32_16x16x32_bf16 v[80:83], v[104:107], a[16:19], v[80:83]
    ds_read_b128 a[44:47], v6 offset:1760
    v_mfma_f32_16x16x32_bf16 v[52:55], v[100:103], a[16:19], v[52:55]
    v_mfma_f32_16x16x32_bf16 v[24:27], v[96:99], a[16:19], v[24:27]
    ds_read_b128 a[96:99], v6 offset:1824
    v_mfma_f32_16x16x32_bf16 v[20:23], v[96:99], a[12:15], v[20:23]
    v_mfma_f32_16x16x32_bf16 v[48:51], v[100:103], a[12:15], v[48:51]
    ds_read_b128 a[40:43], v6 offset:1600
    v_xor_b32 v180, 0x80008000, v116
    v_mfma_f32_16x16x32_bf16 v[76:79], v[104:107], a[12:15], v[76:79]
    v_mfma_f32_16x16x32_bf16 v[76:79], v[108:111], a[64:67], v[76:79]
    ds_read_b128 a[92:95], v6 offset:1664
    v_xor_b32 v181, 0x80008000, v117
    v_mfma_f32_16x16x32_bf16 v[48:51], v[96:99], a[64:67], v[48:51]
    v_mfma_f32_16x16x32_bf16 v[20:23], v[176:179], a[64:67], v[20:23]
    v_xor_b32 v182, 0x80008000, v118
    v_mfma_f32_16x16x32_bf16 v[16:19], v[176:179], a[60:63], v[16:19]
    v_mfma_f32_16x16x32_bf16 v[44:47], v[96:99], a[60:63], v[44:47]
    v_xor_b32 v183, 0x80008000, v119
    v_mfma_f32_16x16x32_bf16 v[72:75], v[108:111], a[60:63], v[72:75]
    v_mfma_f32_16x16x32_bf16 v[72:75], v[104:107], a[8:11], v[72:75]
    v_xor_b32 v124, 0x80008000, v124
    v_mfma_f32_16x16x32_bf16 v[44:47], v[100:103], a[8:11], v[44:47]
    v_mfma_f32_16x16x32_bf16 v[16:19], v[96:99], a[8:11], v[16:19]
    v_xor_b32 v125, 0x80008000, v125
    s_waitcnt lgkmcnt(9)
    v_mfma_f32_16x16x32_bf16 v[12:15], v[96:99], a[4:7], v[12:15]
    v_mfma_f32_16x16x32_bf16 v[40:43], v[100:103], a[4:7], v[40:43]
    v_xor_b32 v126, 0x80008000, v126
    v_mfma_f32_16x16x32_bf16 v[68:71], v[104:107], a[4:7], v[68:71]
    s_waitcnt lgkmcnt(8)
    v_mfma_f32_16x16x32_bf16 v[68:71], v[108:111], a[56:59], v[68:71]
    v_xor_b32 v127, 0x80008000, v127
    v_mfma_f32_16x16x32_bf16 v[40:43], v[96:99], a[56:59], v[40:43]
    v_mfma_f32_16x16x32_bf16 v[12:15], v[176:179], a[56:59], v[12:15]
    v_mfma_f32_16x16x32_bf16 v[36:39], v[112:115], a[24:27], v[36:39]
    s_add_u32 s47, s45, 61440
    v_mfma_f32_16x16x32_bf16 v[64:67], v[116:119], a[24:27], v[64:67]
    buffer_load_dwordx4 v[96:99], v4, s[16:19], s47 offen offset:0
    v_mfma_f32_16x16x32_bf16 v[92:95], v[120:123], a[24:27], v[92:95]
    v_mfma_f32_16x16x32_bf16 v[92:95], v[124:127], a[76:79], v[92:95]
    v_mfma_f32_16x16x32_bf16 v[64:67], v[112:115], a[76:79], v[64:67]
    buffer_load_dwordx4 v[100:103], v4, s[16:19], s47 offen offset:1024
    v_mfma_f32_16x16x32_bf16 v[36:39], v[180:183], a[76:79], v[36:39]
    v_mfma_f32_16x16x32_bf16 v[32:35], v[180:183], a[72:75], v[32:35]
    v_mfma_f32_16x16x32_bf16 v[60:63], v[112:115], a[72:75], v[60:63]
    buffer_load_dwordx4 v[104:107], v4, s[16:19], s47 offen offset:2048
    v_mfma_f32_16x16x32_bf16 v[88:91], v[124:127], a[72:75], v[88:91]
    v_mfma_f32_16x16x32_bf16 v[88:91], v[120:123], a[20:23], v[88:91]
    v_mfma_f32_16x16x32_bf16 v[60:63], v[116:119], a[20:23], v[60:63]
    buffer_load_dwordx4 v[108:111], v4, s[16:19], s47 offen offset:3072
    v_mfma_f32_16x16x32_bf16 v[32:35], v[112:115], a[20:23], v[32:35]
    v_mfma_f32_16x16x32_bf16 v[28:31], v[112:115], a[16:19], v[28:31]
    v_mfma_f32_16x16x32_bf16 v[56:59], v[116:119], a[16:19], v[56:59]
    ds_read_b128 a[36:39], v6 offset:1440
    v_mfma_f32_16x16x32_bf16 v[84:87], v[120:123], a[16:19], v[84:87]
    v_mfma_f32_16x16x32_bf16 v[84:87], v[124:127], a[68:71], v[84:87]
    ds_read_b128 a[88:91], v6 offset:1504
    v_mfma_f32_16x16x32_bf16 v[56:59], v[112:115], a[68:71], v[56:59]
    v_mfma_f32_16x16x32_bf16 v[28:31], v[180:183], a[68:71], v[28:31]
    ds_read_b128 a[32:35], v6 offset:1280
    v_mfma_f32_16x16x32_bf16 v[24:27], v[180:183], a[64:67], v[24:27]
    v_mfma_f32_16x16x32_bf16 v[52:55], v[112:115], a[64:67], v[52:55]
    ds_read_b128 a[84:87], v6 offset:1344
    v_mfma_f32_16x16x32_bf16 v[80:83], v[124:127], a[64:67], v[80:83]
    v_mfma_f32_16x16x32_bf16 v[80:83], v[120:123], a[12:15], v[80:83]
    ds_read_b128 a[28:31], v6 offset:1120
    v_mfma_f32_16x16x32_bf16 v[52:55], v[116:119], a[12:15], v[52:55]
    v_mfma_f32_16x16x32_bf16 v[24:27], v[112:115], a[12:15], v[24:27]
    ds_read_b128 a[80:83], v6 offset:1184
    v_mfma_f32_16x16x32_bf16 v[20:23], v[112:115], a[8:11], v[20:23]
    v_mfma_f32_16x16x32_bf16 v[48:51], v[116:119], a[8:11], v[48:51]
    ds_read_b128 a[24:27], v6 offset:960
    v_mfma_f32_16x16x32_bf16 v[76:79], v[120:123], a[8:11], v[76:79]
    v_mfma_f32_16x16x32_bf16 v[76:79], v[124:127], a[60:63], v[76:79]
    ds_read_b128 a[76:79], v6 offset:1024
    v_mfma_f32_16x16x32_bf16 v[48:51], v[112:115], a[60:63], v[48:51]
    v_mfma_f32_16x16x32_bf16 v[20:23], v[180:183], a[60:63], v[20:23]
    v_mfma_f32_16x16x32_bf16 v[16:19], v[180:183], a[56:59], v[16:19]
    v_mfma_f32_16x16x32_bf16 v[44:47], v[112:115], a[56:59], v[44:47]
    v_mfma_f32_16x16x32_bf16 v[72:75], v[124:127], a[56:59], v[72:75]
    v_xor_b32 v184, 0x80008000, v132
    v_mfma_f32_16x16x32_bf16 v[72:75], v[120:123], a[4:7], v[72:75]
    v_xor_b32 v185, 0x80008000, v133
    v_mfma_f32_16x16x32_bf16 v[44:47], v[116:119], a[4:7], v[44:47]
    v_xor_b32 v186, 0x80008000, v134
    v_mfma_f32_16x16x32_bf16 v[16:19], v[112:115], a[4:7], v[16:19]
    v_xor_b32 v187, 0x80008000, v135
    s_waitcnt lgkmcnt(15)
    v_mfma_f32_16x16x32_bf16 v[12:15], v[112:115], a[0:3], v[12:15]
    v_xor_b32 v140, 0x80008000, v140
    v_mfma_f32_16x16x32_bf16 v[40:43], v[116:119], a[0:3], v[40:43]
    v_xor_b32 v141, 0x80008000, v141
    v_mfma_f32_16x16x32_bf16 v[68:71], v[120:123], a[0:3], v[68:71]
    v_xor_b32 v142, 0x80008000, v142
    s_waitcnt lgkmcnt(14)
    v_mfma_f32_16x16x32_bf16 v[68:71], v[124:127], a[52:55], v[68:71]
    v_xor_b32 v143, 0x80008000, v143
    v_mfma_f32_16x16x32_bf16 v[40:43], v[112:115], a[52:55], v[40:43]
    v_mfma_f32_16x16x32_bf16 v[12:15], v[180:183], a[52:55], v[12:15]
    s_waitcnt lgkmcnt(13)
    v_mfma_f32_16x16x32_bf16 v[36:39], v[128:131], a[48:51], v[36:39]
    s_add_u32 s47, s45, 67584
    v_mfma_f32_16x16x32_bf16 v[64:67], v[132:135], a[48:51], v[64:67]
    buffer_load_dwordx4 v[112:115], v4, s[16:19], s47 offen offset:0
    v_mfma_f32_16x16x32_bf16 v[92:95], v[136:139], a[48:51], v[92:95]
    s_waitcnt lgkmcnt(12)
    v_mfma_f32_16x16x32_bf16 v[92:95], v[140:143], a[100:103], v[92:95]
    v_mfma_f32_16x16x32_bf16 v[64:67], v[128:131], a[100:103], v[64:67]
    buffer_load_dwordx4 v[116:119], v4, s[16:19], s47 offen offset:1024
    v_mfma_f32_16x16x32_bf16 v[36:39], v[184:187], a[100:103], v[36:39]
    s_waitcnt lgkmcnt(10)
    v_mfma_f32_16x16x32_bf16 v[32:35], v[184:187], a[96:99], v[32:35]
    v_mfma_f32_16x16x32_bf16 v[60:63], v[128:131], a[96:99], v[60:63]
    buffer_load_dwordx4 v[120:123], v4, s[16:19], s47 offen offset:2048
    v_mfma_f32_16x16x32_bf16 v[88:91], v[140:143], a[96:99], v[88:91]
    v_mfma_f32_16x16x32_bf16 v[88:91], v[136:139], a[44:47], v[88:91]
    v_mfma_f32_16x16x32_bf16 v[60:63], v[132:135], a[44:47], v[60:63]
    buffer_load_dwordx4 v[124:127], v4, s[16:19], s47 offen offset:3072
    v_mfma_f32_16x16x32_bf16 v[32:35], v[128:131], a[44:47], v[32:35]
    s_waitcnt lgkmcnt(9)
    v_mfma_f32_16x16x32_bf16 v[28:31], v[128:131], a[40:43], v[28:31]
    v_mfma_f32_16x16x32_bf16 v[56:59], v[132:135], a[40:43], v[56:59]
    ds_read_b128 a[20:23], v6 offset:800
    v_mfma_f32_16x16x32_bf16 v[84:87], v[136:139], a[40:43], v[84:87]
    s_waitcnt lgkmcnt(9)
    v_mfma_f32_16x16x32_bf16 v[84:87], v[140:143], a[92:95], v[84:87]
    ds_read_b128 a[72:75], v6 offset:864
    v_mfma_f32_16x16x32_bf16 v[56:59], v[128:131], a[92:95], v[56:59]
    v_mfma_f32_16x16x32_bf16 v[28:31], v[184:187], a[92:95], v[28:31]
    s_add_u32 m0, s42, 76800
    s_add_u32 s46, s44, 8192
    s_mov_b64 exec, s[40:41]
    buffer_load_dwordx4 v3, s[12:15], s46 offen lds
    s_mov_b64 exec, -1
    s_waitcnt lgkmcnt(8)
    v_mfma_f32_16x16x32_bf16 v[24:27], v[184:187], a[88:91], v[24:27]
    v_mfma_f32_16x16x32_bf16 v[52:55], v[128:131], a[88:91], v[52:55]
    v_mfma_f32_16x16x32_bf16 v[80:83], v[140:143], a[88:91], v[80:83]
    s_add_u32 m0, s42, 80640
    s_add_u32 s46, s43, 8192
    s_mov_b64 exec, s[40:41]
    buffer_load_dwordx4 v3, s[12:15], s46 offen lds
    s_mov_b64 exec, -1
    v_mfma_f32_16x16x32_bf16 v[80:83], v[136:139], a[36:39], v[80:83]
    v_mfma_f32_16x16x32_bf16 v[52:55], v[132:135], a[36:39], v[52:55]
    v_mfma_f32_16x16x32_bf16 v[24:27], v[128:131], a[36:39], v[24:27]
    s_add_u32 m0, s42, 84480
    s_add_u32 s46, s43, 1187840
    s_mov_b64 exec, s[40:41]
    buffer_load_dwordx4 v3, s[12:15], s46 offen lds
    s_mov_b64 exec, -1
    s_waitcnt lgkmcnt(7)
    v_mfma_f32_16x16x32_bf16 v[20:23], v[128:131], a[32:35], v[20:23]
    v_mfma_f32_16x16x32_bf16 v[48:51], v[132:135], a[32:35], v[48:51]
    s_waitcnt vmcnt(17)
    v_xor_b32 v188, 0x80008000, v148
    v_mfma_f32_16x16x32_bf16 v[76:79], v[136:139], a[32:35], v[76:79]
    s_waitcnt lgkmcnt(6)
    v_mfma_f32_16x16x32_bf16 v[76:79], v[140:143], a[84:87], v[76:79]
    v_xor_b32 v189, 0x80008000, v149
    v_mfma_f32_16x16x32_bf16 v[48:51], v[128:131], a[84:87], v[48:51]
    v_mfma_f32_16x16x32_bf16 v[20:23], v[184:187], a[84:87], v[20:23]
    v_xor_b32 v190, 0x80008000, v150
    s_waitcnt lgkmcnt(4)
    v_mfma_f32_16x16x32_bf16 v[16:19], v[184:187], a[80:83], v[16:19]
    v_mfma_f32_16x16x32_bf16 v[44:47], v[128:131], a[80:83], v[44:47]
    v_xor_b32 v191, 0x80008000, v151
    v_mfma_f32_16x16x32_bf16 v[72:75], v[140:143], a[80:83], v[72:75]
    v_mfma_f32_16x16x32_bf16 v[72:75], v[136:139], a[28:31], v[72:75]
    s_waitcnt vmcnt(15)
    v_xor_b32 v156, 0x80008000, v156
    v_mfma_f32_16x16x32_bf16 v[44:47], v[132:135], a[28:31], v[44:47]
    v_mfma_f32_16x16x32_bf16 v[16:19], v[128:131], a[28:31], v[16:19]
    v_xor_b32 v157, 0x80008000, v157
    s_waitcnt lgkmcnt(3)
    v_mfma_f32_16x16x32_bf16 v[12:15], v[128:131], a[24:27], v[12:15]
    v_mfma_f32_16x16x32_bf16 v[40:43], v[132:135], a[24:27], v[40:43]
    v_xor_b32 v158, 0x80008000, v158
    v_mfma_f32_16x16x32_bf16 v[68:71], v[136:139], a[24:27], v[68:71]
    s_waitcnt lgkmcnt(2)
    v_mfma_f32_16x16x32_bf16 v[68:71], v[140:143], a[76:79], v[68:71]
    v_xor_b32 v159, 0x80008000, v159
    v_mfma_f32_16x16x32_bf16 v[40:43], v[128:131], a[76:79], v[40:43]
    v_mfma_f32_16x16x32_bf16 v[12:15], v[184:187], a[76:79], v[12:15]
    v_mfma_f32_16x16x32_bf16 v[36:39], v[144:147], a[44:47], v[36:39]
    s_add_u32 s47, s45, 73728
    v_mfma_f32_16x16x32_bf16 v[64:67], v[148:151], a[44:47], v[64:67]
    buffer_load_dwordx4 v[128:131], v4, s[16:19], s47 offen offset:0
    v_mfma_f32_16x16x32_bf16 v[92:95], v[152:155], a[44:47], v[92:95]
    v_mfma_f32_16x16x32_bf16 v[92:95], v[156:159], a[96:99], v[92:95]
    v_mfma_f32_16x16x32_bf16 v[64:67], v[144:147], a[96:99], v[64:67]
    buffer_load_dwordx4 v[132:135], v4, s[16:19], s47 offen offset:1024
    v_mfma_f32_16x16x32_bf16 v[36:39], v[188:191], a[96:99], v[36:39]
    v_mfma_f32_16x16x32_bf16 v[32:35], v[188:191], a[92:95], v[32:35]
    v_mfma_f32_16x16x32_bf16 v[60:63], v[144:147], a[92:95], v[60:63]
    buffer_load_dwordx4 v[136:139], v4, s[16:19], s47 offen offset:2048
    v_mfma_f32_16x16x32_bf16 v[88:91], v[156:159], a[92:95], v[88:91]
    v_mfma_f32_16x16x32_bf16 v[88:91], v[152:155], a[40:43], v[88:91]
    v_mfma_f32_16x16x32_bf16 v[60:63], v[148:151], a[40:43], v[60:63]
    buffer_load_dwordx4 v[140:143], v4, s[16:19], s47 offen offset:3072
    v_mfma_f32_16x16x32_bf16 v[32:35], v[144:147], a[40:43], v[32:35]
    v_mfma_f32_16x16x32_bf16 v[28:31], v[144:147], a[36:39], v[28:31]
    v_mfma_f32_16x16x32_bf16 v[56:59], v[148:151], a[36:39], v[56:59]
    ds_read_b128 a[16:19], v6 offset:640
    v_mfma_f32_16x16x32_bf16 v[84:87], v[152:155], a[36:39], v[84:87]
    v_mfma_f32_16x16x32_bf16 v[84:87], v[156:159], a[88:91], v[84:87]
    ds_read_b128 a[68:71], v6 offset:704
    v_mfma_f32_16x16x32_bf16 v[56:59], v[144:147], a[88:91], v[56:59]
    v_mfma_f32_16x16x32_bf16 v[28:31], v[188:191], a[88:91], v[28:31]
    s_add_u32 m0, s42, 88320
    s_add_u32 s46, s43, 2367488
    s_mov_b64 exec, s[40:41]
    buffer_load_dwordx4 v3, s[12:15], s46 offen lds
    s_mov_b64 exec, -1
    v_mfma_f32_16x16x32_bf16 v[24:27], v[188:191], a[84:87], v[24:27]
    v_mfma_f32_16x16x32_bf16 v[52:55], v[144:147], a[84:87], v[52:55]
    v_mfma_f32_16x16x32_bf16 v[80:83], v[156:159], a[84:87], v[80:83]
    s_add_u32 m0, s42, 92160
    s_add_u32 s46, s43, 3547136
    s_mov_b64 exec, s[40:41]
    buffer_load_dwordx4 v3, s[12:15], s46 offen lds
    s_mov_b64 exec, -1
    v_mfma_f32_16x16x32_bf16 v[80:83], v[152:155], a[32:35], v[80:83]
    v_mfma_f32_16x16x32_bf16 v[52:55], v[148:151], a[32:35], v[52:55]
    v_mfma_f32_16x16x32_bf16 v[24:27], v[144:147], a[32:35], v[24:27]
    s_add_u32 m0, s42, 96000
    s_add_u32 s46, s43, 4726784
    s_mov_b64 exec, s[40:41]
    buffer_load_dwordx4 v3, s[12:15], s46 offen lds
    s_mov_b64 exec, -1
    v_mfma_f32_16x16x32_bf16 v[20:23], v[144:147], a[28:31], v[20:23]
    v_mfma_f32_16x16x32_bf16 v[48:51], v[148:151], a[28:31], v[48:51]
    s_waitcnt vmcnt(20)
    v_xor_b32 v192, 0x80008000, v164
    v_mfma_f32_16x16x32_bf16 v[76:79], v[152:155], a[28:31], v[76:79]
    v_mfma_f32_16x16x32_bf16 v[76:79], v[156:159], a[80:83], v[76:79]
    v_xor_b32 v193, 0x80008000, v165
    v_mfma_f32_16x16x32_bf16 v[48:51], v[144:147], a[80:83], v[48:51]
    v_mfma_f32_16x16x32_bf16 v[20:23], v[188:191], a[80:83], v[20:23]
    v_xor_b32 v194, 0x80008000, v166
    v_mfma_f32_16x16x32_bf16 v[16:19], v[188:191], a[76:79], v[16:19]
    v_mfma_f32_16x16x32_bf16 v[44:47], v[144:147], a[76:79], v[44:47]
    v_xor_b32 v195, 0x80008000, v167
    v_mfma_f32_16x16x32_bf16 v[72:75], v[156:159], a[76:79], v[72:75]
    v_mfma_f32_16x16x32_bf16 v[72:75], v[152:155], a[24:27], v[72:75]
    s_waitcnt vmcnt(18)
    v_xor_b32 v172, 0x80008000, v172
    v_mfma_f32_16x16x32_bf16 v[44:47], v[148:151], a[24:27], v[44:47]
    v_mfma_f32_16x16x32_bf16 v[16:19], v[144:147], a[24:27], v[16:19]
    v_xor_b32 v173, 0x80008000, v173
    s_waitcnt lgkmcnt(3)
    v_mfma_f32_16x16x32_bf16 v[12:15], v[144:147], a[20:23], v[12:15]
    v_mfma_f32_16x16x32_bf16 v[40:43], v[148:151], a[20:23], v[40:43]
    v_xor_b32 v174, 0x80008000, v174
    v_mfma_f32_16x16x32_bf16 v[68:71], v[152:155], a[20:23], v[68:71]
    s_waitcnt lgkmcnt(2)
    v_mfma_f32_16x16x32_bf16 v[68:71], v[156:159], a[72:75], v[68:71]
    v_xor_b32 v175, 0x80008000, v175
    v_mfma_f32_16x16x32_bf16 v[40:43], v[144:147], a[72:75], v[40:43]
    v_mfma_f32_16x16x32_bf16 v[12:15], v[188:191], a[72:75], v[12:15]
    v_mfma_f32_16x16x32_bf16 v[36:39], v[160:163], a[40:43], v[36:39]
    s_add_u32 s47, s45, 79872
    v_mfma_f32_16x16x32_bf16 v[64:67], v[164:167], a[40:43], v[64:67]
    buffer_load_dwordx4 v[144:147], v4, s[16:19], s47 offen offset:0
    v_mfma_f32_16x16x32_bf16 v[92:95], v[168:171], a[40:43], v[92:95]
    v_mfma_f32_16x16x32_bf16 v[92:95], v[172:175], a[92:95], v[92:95]
    v_mfma_f32_16x16x32_bf16 v[64:67], v[160:163], a[92:95], v[64:67]
    buffer_load_dwordx4 v[148:151], v4, s[16:19], s47 offen offset:1024
    v_mfma_f32_16x16x32_bf16 v[36:39], v[192:195], a[92:95], v[36:39]
    v_mfma_f32_16x16x32_bf16 v[32:35], v[192:195], a[88:91], v[32:35]
    v_mfma_f32_16x16x32_bf16 v[60:63], v[160:163], a[88:91], v[60:63]
    buffer_load_dwordx4 v[152:155], v4, s[16:19], s47 offen offset:2048
    v_mfma_f32_16x16x32_bf16 v[88:91], v[172:175], a[88:91], v[88:91]
    v_mfma_f32_16x16x32_bf16 v[88:91], v[168:171], a[36:39], v[88:91]
    v_mfma_f32_16x16x32_bf16 v[60:63], v[164:167], a[36:39], v[60:63]
    buffer_load_dwordx4 v[156:159], v4, s[16:19], s47 offen offset:3072
    v_mfma_f32_16x16x32_bf16 v[32:35], v[160:163], a[36:39], v[32:35]
    v_mfma_f32_16x16x32_bf16 v[28:31], v[160:163], a[32:35], v[28:31]
    v_mfma_f32_16x16x32_bf16 v[56:59], v[164:167], a[32:35], v[56:59]
    ds_read_b128 a[12:15], v6 offset:480
    v_mfma_f32_16x16x32_bf16 v[84:87], v[168:171], a[32:35], v[84:87]
    v_mfma_f32_16x16x32_bf16 v[84:87], v[172:175], a[84:87], v[84:87]
    ds_read_b128 a[64:67], v6 offset:544
    v_mfma_f32_16x16x32_bf16 v[56:59], v[160:163], a[84:87], v[56:59]
    v_mfma_f32_16x16x32_bf16 v[28:31], v[192:195], a[84:87], v[28:31]
    s_add_u32 m0, s42, 99840
    s_add_u32 s46, s43, 5906432
    s_mov_b64 exec, s[40:41]
    buffer_load_dwordx4 v3, s[12:15], s46 offen lds
    s_mov_b64 exec, -1
    v_mfma_f32_16x16x32_bf16 v[24:27], v[192:195], a[80:83], v[24:27]
    v_mfma_f32_16x16x32_bf16 v[52:55], v[160:163], a[80:83], v[52:55]
    v_mfma_f32_16x16x32_bf16 v[80:83], v[172:175], a[80:83], v[80:83]
    s_add_u32 m0, s42, 103680
    s_add_u32 s46, s43, 7086080
    s_mov_b64 exec, s[40:41]
    buffer_load_dwordx4 v3, s[12:15], s46 offen lds
    s_mov_b64 exec, -1
    v_mfma_f32_16x16x32_bf16 v[80:83], v[168:171], a[28:31], v[80:83]
    v_mfma_f32_16x16x32_bf16 v[52:55], v[164:167], a[28:31], v[52:55]
    v_mfma_f32_16x16x32_bf16 v[24:27], v[160:163], a[28:31], v[24:27]
    v_mfma_f32_16x16x32_bf16 v[20:23], v[160:163], a[24:27], v[20:23]
    v_mfma_f32_16x16x32_bf16 v[48:51], v[164:167], a[24:27], v[48:51]
    s_waitcnt vmcnt(22)
    v_xor_b32 v176, 0x80008000, v100
    v_mfma_f32_16x16x32_bf16 v[76:79], v[168:171], a[24:27], v[76:79]
    v_mfma_f32_16x16x32_bf16 v[76:79], v[172:175], a[76:79], v[76:79]
    v_xor_b32 v177, 0x80008000, v101
    v_mfma_f32_16x16x32_bf16 v[48:51], v[160:163], a[76:79], v[48:51]
    v_mfma_f32_16x16x32_bf16 v[20:23], v[192:195], a[76:79], v[20:23]
    v_xor_b32 v178, 0x80008000, v102
    v_mfma_f32_16x16x32_bf16 v[16:19], v[192:195], a[72:75], v[16:19]
    v_mfma_f32_16x16x32_bf16 v[44:47], v[160:163], a[72:75], v[44:47]
    v_xor_b32 v179, 0x80008000, v103
    v_mfma_f32_16x16x32_bf16 v[72:75], v[172:175], a[72:75], v[72:75]
    v_mfma_f32_16x16x32_bf16 v[72:75], v[168:171], a[20:23], v[72:75]
    s_waitcnt vmcnt(20)
    v_xor_b32 v108, 0x80008000, v108
    v_mfma_f32_16x16x32_bf16 v[44:47], v[164:167], a[20:23], v[44:47]
    v_mfma_f32_16x16x32_bf16 v[16:19], v[160:163], a[20:23], v[16:19]
    v_xor_b32 v109, 0x80008000, v109
    s_waitcnt lgkmcnt(3)
    v_mfma_f32_16x16x32_bf16 v[12:15], v[160:163], a[16:19], v[12:15]
    v_mfma_f32_16x16x32_bf16 v[40:43], v[164:167], a[16:19], v[40:43]
    v_xor_b32 v110, 0x80008000, v110
    v_mfma_f32_16x16x32_bf16 v[68:71], v[168:171], a[16:19], v[68:71]
    s_waitcnt lgkmcnt(2)
    v_mfma_f32_16x16x32_bf16 v[68:71], v[172:175], a[68:71], v[68:71]
    v_xor_b32 v111, 0x80008000, v111
    v_mfma_f32_16x16x32_bf16 v[40:43], v[160:163], a[68:71], v[40:43]
    v_mfma_f32_16x16x32_bf16 v[12:15], v[192:195], a[68:71], v[12:15]
    v_mfma_f32_16x16x32_bf16 v[36:39], v[96:99], a[36:39], v[36:39]
    s_add_u32 s47, s45, 86016
    v_mfma_f32_16x16x32_bf16 v[64:67], v[100:103], a[36:39], v[64:67]
    buffer_load_dwordx4 v[160:163], v4, s[16:19], s47 offen offset:0
    v_mfma_f32_16x16x32_bf16 v[92:95], v[104:107], a[36:39], v[92:95]
    v_mfma_f32_16x16x32_bf16 v[92:95], v[108:111], a[88:91], v[92:95]
    v_mfma_f32_16x16x32_bf16 v[64:67], v[96:99], a[88:91], v[64:67]
    buffer_load_dwordx4 v[164:167], v4, s[16:19], s47 offen offset:1024
    v_mfma_f32_16x16x32_bf16 v[36:39], v[176:179], a[88:91], v[36:39]
    v_mfma_f32_16x16x32_bf16 v[32:35], v[176:179], a[84:87], v[32:35]
    v_mfma_f32_16x16x32_bf16 v[60:63], v[96:99], a[84:87], v[60:63]
    buffer_load_dwordx4 v[168:171], v4, s[16:19], s47 offen offset:2048
    v_mfma_f32_16x16x32_bf16 v[88:91], v[108:111], a[84:87], v[88:91]
    v_mfma_f32_16x16x32_bf16 v[88:91], v[104:107], a[32:35], v[88:91]
    v_mfma_f32_16x16x32_bf16 v[60:63], v[100:103], a[32:35], v[60:63]
    buffer_load_dwordx4 v[172:175], v4, s[16:19], s47 offen offset:3072
    v_mfma_f32_16x16x32_bf16 v[32:35], v[96:99], a[32:35], v[32:35]
    v_mfma_f32_16x16x32_bf16 v[28:31], v[96:99], a[28:31], v[28:31]
    v_mfma_f32_16x16x32_bf16 v[56:59], v[100:103], a[28:31], v[56:59]
    ds_read_b128 a[8:11], v6 offset:320
    v_mfma_f32_16x16x32_bf16 v[84:87], v[104:107], a[28:31], v[84:87]
    v_mfma_f32_16x16x32_bf16 v[84:87], v[108:111], a[80:83], v[84:87]
    ds_read_b128 a[60:63], v6 offset:384
    v_mfma_f32_16x16x32_bf16 v[56:59], v[96:99], a[80:83], v[56:59]
    v_mfma_f32_16x16x32_bf16 v[28:31], v[176:179], a[80:83], v[28:31]
    s_add_u32 m0, s42, 107520
    s_add_u32 s46, s43, 8265728
    s_mov_b64 exec, s[40:41]
    buffer_load_dwordx4 v3, s[12:15], s46 offen lds
    s_mov_b64 exec, -1
    v_mfma_f32_16x16x32_bf16 v[24:27], v[176:179], a[76:79], v[24:27]
    v_mfma_f32_16x16x32_bf16 v[52:55], v[96:99], a[76:79], v[52:55]
    v_mfma_f32_16x16x32_bf16 v[80:83], v[108:111], a[76:79], v[80:83]
    s_add_u32 m0, s42, 111360
    s_add_u32 s46, s43, 9445376
    s_mov_b64 exec, s[40:41]
    buffer_load_dwordx4 v3, s[12:15], s46 offen lds
    s_mov_b64 exec, -1
    v_mfma_f32_16x16x32_bf16 v[80:83], v[104:107], a[24:27], v[80:83]
    v_mfma_f32_16x16x32_bf16 v[52:55], v[100:103], a[24:27], v[52:55]
    v_mfma_f32_16x16x32_bf16 v[24:27], v[96:99], a[24:27], v[24:27]
    v_mfma_f32_16x16x32_bf16 v[20:23], v[96:99], a[20:23], v[20:23]
    v_mfma_f32_16x16x32_bf16 v[48:51], v[100:103], a[20:23], v[48:51]
    s_waitcnt vmcnt(24)
    v_xor_b32 v180, 0x80008000, v116
    v_mfma_f32_16x16x32_bf16 v[76:79], v[104:107], a[20:23], v[76:79]
    v_mfma_f32_16x16x32_bf16 v[76:79], v[108:111], a[72:75], v[76:79]
    v_xor_b32 v181, 0x80008000, v117
    v_mfma_f32_16x16x32_bf16 v[48:51], v[96:99], a[72:75], v[48:51]
    v_mfma_f32_16x16x32_bf16 v[20:23], v[176:179], a[72:75], v[20:23]
    v_xor_b32 v182, 0x80008000, v118
    v_mfma_f32_16x16x32_bf16 v[16:19], v[176:179], a[68:71], v[16:19]
    v_mfma_f32_16x16x32_bf16 v[44:47], v[96:99], a[68:71], v[44:47]
    v_xor_b32 v183, 0x80008000, v119
    v_mfma_f32_16x16x32_bf16 v[72:75], v[108:111], a[68:71], v[72:75]
    v_mfma_f32_16x16x32_bf16 v[72:75], v[104:107], a[16:19], v[72:75]
    s_waitcnt vmcnt(22)
    v_xor_b32 v124, 0x80008000, v124
    v_mfma_f32_16x16x32_bf16 v[44:47], v[100:103], a[16:19], v[44:47]
    v_mfma_f32_16x16x32_bf16 v[16:19], v[96:99], a[16:19], v[16:19]
    v_xor_b32 v125, 0x80008000, v125
    s_waitcnt lgkmcnt(3)
    v_mfma_f32_16x16x32_bf16 v[12:15], v[96:99], a[12:15], v[12:15]
    v_mfma_f32_16x16x32_bf16 v[40:43], v[100:103], a[12:15], v[40:43]
    v_xor_b32 v126, 0x80008000, v126
    v_mfma_f32_16x16x32_bf16 v[68:71], v[104:107], a[12:15], v[68:71]
    s_waitcnt lgkmcnt(2)
    v_mfma_f32_16x16x32_bf16 v[68:71], v[108:111], a[64:67], v[68:71]
    v_xor_b32 v127, 0x80008000, v127
    v_mfma_f32_16x16x32_bf16 v[40:43], v[96:99], a[64:67], v[40:43]
    v_mfma_f32_16x16x32_bf16 v[12:15], v[176:179], a[64:67], v[12:15]
    v_mfma_f32_16x16x32_bf16 v[36:39], v[112:115], a[32:35], v[36:39]
    s_add_u32 s47, s45, 92160
    v_mfma_f32_16x16x32_bf16 v[64:67], v[116:119], a[32:35], v[64:67]
    buffer_load_dwordx4 v[96:99], v4, s[16:19], s47 offen offset:0
    v_mfma_f32_16x16x32_bf16 v[92:95], v[120:123], a[32:35], v[92:95]
    v_mfma_f32_16x16x32_bf16 v[92:95], v[124:127], a[84:87], v[92:95]
    v_mfma_f32_16x16x32_bf16 v[64:67], v[112:115], a[84:87], v[64:67]
    buffer_load_dwordx4 v[100:103], v4, s[16:19], s47 offen offset:1024
    v_mfma_f32_16x16x32_bf16 v[36:39], v[180:183], a[84:87], v[36:39]
    v_mfma_f32_16x16x32_bf16 v[32:35], v[180:183], a[80:83], v[32:35]
    v_mfma_f32_16x16x32_bf16 v[60:63], v[112:115], a[80:83], v[60:63]
    buffer_load_dwordx4 v[104:107], v4, s[16:19], s47 offen offset:2048
    v_mfma_f32_16x16x32_bf16 v[88:91], v[124:127], a[80:83], v[88:91]
    v_mfma_f32_16x16x32_bf16 v[88:91], v[120:123], a[28:31], v[88:91]
    v_mfma_f32_16x16x32_bf16 v[60:63], v[116:119], a[28:31], v[60:63]
    buffer_load_dwordx4 v[108:111], v4, s[16:19], s47 offen offset:3072
    v_mfma_f32_16x16x32_bf16 v[32:35], v[112:115], a[28:31], v[32:35]
    v_mfma_f32_16x16x32_bf16 v[28:31], v[112:115], a[24:27], v[28:31]
    v_mfma_f32_16x16x32_bf16 v[56:59], v[116:119], a[24:27], v[56:59]
    ds_read_b128 a[4:7], v6 offset:160
    v_mfma_f32_16x16x32_bf16 v[84:87], v[120:123], a[24:27], v[84:87]
    v_mfma_f32_16x16x32_bf16 v[84:87], v[124:127], a[76:79], v[84:87]
    ds_read_b128 a[56:59], v6 offset:224
    v_mfma_f32_16x16x32_bf16 v[56:59], v[112:115], a[76:79], v[56:59]
    v_mfma_f32_16x16x32_bf16 v[28:31], v[180:183], a[76:79], v[28:31]
    v_mfma_f32_16x16x32_bf16 v[24:27], v[180:183], a[72:75], v[24:27]
    v_mfma_f32_16x16x32_bf16 v[52:55], v[112:115], a[72:75], v[52:55]
    v_mfma_f32_16x16x32_bf16 v[80:83], v[124:127], a[72:75], v[80:83]
    v_mfma_f32_16x16x32_bf16 v[80:83], v[120:123], a[20:23], v[80:83]
    v_mfma_f32_16x16x32_bf16 v[52:55], v[116:119], a[20:23], v[52:55]
    v_mfma_f32_16x16x32_bf16 v[24:27], v[112:115], a[20:23], v[24:27]
    v_mfma_f32_16x16x32_bf16 v[20:23], v[112:115], a[16:19], v[20:23]
    v_mfma_f32_16x16x32_bf16 v[48:51], v[116:119], a[16:19], v[48:51]
    s_waitcnt vmcnt(21)
    v_xor_b32 v184, 0x80008000, v132
    v_mfma_f32_16x16x32_bf16 v[76:79], v[120:123], a[16:19], v[76:79]
    v_mfma_f32_16x16x32_bf16 v[76:79], v[124:127], a[68:71], v[76:79]
    v_xor_b32 v185, 0x80008000, v133
    v_mfma_f32_16x16x32_bf16 v[48:51], v[112:115], a[68:71], v[48:51]
    v_mfma_f32_16x16x32_bf16 v[20:23], v[180:183], a[68:71], v[20:23]
    v_xor_b32 v186, 0x80008000, v134
    v_mfma_f32_16x16x32_bf16 v[16:19], v[180:183], a[64:67], v[16:19]
    v_mfma_f32_16x16x32_bf16 v[44:47], v[112:115], a[64:67], v[44:47]
    v_xor_b32 v187, 0x80008000, v135
    v_mfma_f32_16x16x32_bf16 v[72:75], v[124:127], a[64:67], v[72:75]
    v_mfma_f32_16x16x32_bf16 v[72:75], v[120:123], a[12:15], v[72:75]
    s_waitcnt vmcnt(19)
    v_xor_b32 v140, 0x80008000, v140
    v_mfma_f32_16x16x32_bf16 v[44:47], v[116:119], a[12:15], v[44:47]
    v_mfma_f32_16x16x32_bf16 v[16:19], v[112:115], a[12:15], v[16:19]
    v_xor_b32 v141, 0x80008000, v141
    s_waitcnt lgkmcnt(3)
    v_mfma_f32_16x16x32_bf16 v[12:15], v[112:115], a[8:11], v[12:15]
    v_mfma_f32_16x16x32_bf16 v[40:43], v[116:119], a[8:11], v[40:43]
    v_xor_b32 v142, 0x80008000, v142
    v_mfma_f32_16x16x32_bf16 v[68:71], v[120:123], a[8:11], v[68:71]
    s_waitcnt lgkmcnt(2)
    v_mfma_f32_16x16x32_bf16 v[68:71], v[124:127], a[60:63], v[68:71]
    v_xor_b32 v143, 0x80008000, v143
    v_mfma_f32_16x16x32_bf16 v[40:43], v[112:115], a[60:63], v[40:43]
    v_mfma_f32_16x16x32_bf16 v[12:15], v[180:183], a[60:63], v[12:15]
    v_mfma_f32_16x16x32_bf16 v[36:39], v[128:131], a[28:31], v[36:39]
    s_add_u32 s47, s45, 98304
    v_mfma_f32_16x16x32_bf16 v[64:67], v[132:135], a[28:31], v[64:67]
    buffer_load_dwordx4 v[112:115], v4, s[16:19], s47 offen offset:0
    v_mfma_f32_16x16x32_bf16 v[92:95], v[136:139], a[28:31], v[92:95]
    v_mfma_f32_16x16x32_bf16 v[92:95], v[140:143], a[80:83], v[92:95]
    v_mfma_f32_16x16x32_bf16 v[64:67], v[128:131], a[80:83], v[64:67]
    buffer_load_dwordx4 v[116:119], v4, s[16:19], s47 offen offset:1024
    v_mfma_f32_16x16x32_bf16 v[36:39], v[184:187], a[80:83], v[36:39]
    v_mfma_f32_16x16x32_bf16 v[32:35], v[184:187], a[76:79], v[32:35]
    v_mfma_f32_16x16x32_bf16 v[60:63], v[128:131], a[76:79], v[60:63]
    buffer_load_dwordx4 v[120:123], v4, s[16:19], s47 offen offset:2048
    v_mfma_f32_16x16x32_bf16 v[88:91], v[140:143], a[76:79], v[88:91]
    v_mfma_f32_16x16x32_bf16 v[88:91], v[136:139], a[24:27], v[88:91]
    v_mfma_f32_16x16x32_bf16 v[60:63], v[132:135], a[24:27], v[60:63]
    buffer_load_dwordx4 v[124:127], v4, s[16:19], s47 offen offset:3072
    v_mfma_f32_16x16x32_bf16 v[32:35], v[128:131], a[24:27], v[32:35]
    s_waitcnt vmcnt(8)
    s_barrier
    v_mfma_f32_16x16x32_bf16 v[28:31], v[128:131], a[20:23], v[28:31]
    v_mfma_f32_16x16x32_bf16 v[56:59], v[132:135], a[20:23], v[56:59]
    ds_read_b128 a[0:3], v6 offset:0
    v_mfma_f32_16x16x32_bf16 v[84:87], v[136:139], a[20:23], v[84:87]
    v_mfma_f32_16x16x32_bf16 v[84:87], v[140:143], a[72:75], v[84:87]
    ds_read_b128 a[52:55], v6 offset:64
    v_mfma_f32_16x16x32_bf16 v[56:59], v[128:131], a[72:75], v[56:59]
    v_mfma_f32_16x16x32_bf16 v[28:31], v[184:187], a[72:75], v[28:31]
    ds_read_b128 a[48:51], v7 offset:1920
    v_mfma_f32_16x16x32_bf16 v[24:27], v[184:187], a[68:71], v[24:27]
    v_mfma_f32_16x16x32_bf16 v[52:55], v[128:131], a[68:71], v[52:55]
    ds_read_b128 a[100:103], v7 offset:1984
    v_mfma_f32_16x16x32_bf16 v[80:83], v[140:143], a[68:71], v[80:83]
    v_mfma_f32_16x16x32_bf16 v[80:83], v[136:139], a[16:19], v[80:83]
    ds_read_b128 a[44:47], v7 offset:1760
    v_mfma_f32_16x16x32_bf16 v[52:55], v[132:135], a[16:19], v[52:55]
    v_mfma_f32_16x16x32_bf16 v[24:27], v[128:131], a[16:19], v[24:27]
    ds_read_b128 a[96:99], v7 offset:1824
    v_mfma_f32_16x16x32_bf16 v[20:23], v[128:131], a[12:15], v[20:23]
    v_mfma_f32_16x16x32_bf16 v[48:51], v[132:135], a[12:15], v[48:51]
    ds_read_b128 a[40:43], v7 offset:1600
    v_xor_b32 v188, 0x80008000, v148
    v_mfma_f32_16x16x32_bf16 v[76:79], v[136:139], a[12:15], v[76:79]
    v_mfma_f32_16x16x32_bf16 v[76:79], v[140:143], a[64:67], v[76:79]
    ds_read_b128 a[92:95], v7 offset:1664
    v_xor_b32 v189, 0x80008000, v149
    v_mfma_f32_16x16x32_bf16 v[48:51], v[128:131], a[64:67], v[48:51]
    v_mfma_f32_16x16x32_bf16 v[20:23], v[184:187], a[64:67], v[20:23]
    v_xor_b32 v190, 0x80008000, v150
    v_mfma_f32_16x16x32_bf16 v[16:19], v[184:187], a[60:63], v[16:19]
    v_mfma_f32_16x16x32_bf16 v[44:47], v[128:131], a[60:63], v[44:47]
    v_xor_b32 v191, 0x80008000, v151
    v_mfma_f32_16x16x32_bf16 v[72:75], v[140:143], a[60:63], v[72:75]
    v_mfma_f32_16x16x32_bf16 v[72:75], v[136:139], a[8:11], v[72:75]
    v_xor_b32 v156, 0x80008000, v156
    v_mfma_f32_16x16x32_bf16 v[44:47], v[132:135], a[8:11], v[44:47]
    v_mfma_f32_16x16x32_bf16 v[16:19], v[128:131], a[8:11], v[16:19]
    v_xor_b32 v157, 0x80008000, v157
    s_waitcnt lgkmcnt(9)
    v_mfma_f32_16x16x32_bf16 v[12:15], v[128:131], a[4:7], v[12:15]
    v_mfma_f32_16x16x32_bf16 v[40:43], v[132:135], a[4:7], v[40:43]
    v_xor_b32 v158, 0x80008000, v158
    v_mfma_f32_16x16x32_bf16 v[68:71], v[136:139], a[4:7], v[68:71]
    s_waitcnt lgkmcnt(8)
    v_mfma_f32_16x16x32_bf16 v[68:71], v[140:143], a[56:59], v[68:71]
    v_xor_b32 v159, 0x80008000, v159
    v_mfma_f32_16x16x32_bf16 v[40:43], v[128:131], a[56:59], v[40:43]
    v_mfma_f32_16x16x32_bf16 v[12:15], v[184:187], a[56:59], v[12:15]
    v_mfma_f32_16x16x32_bf16 v[36:39], v[144:147], a[24:27], v[36:39]
    s_add_u32 s47, s45, 104448
    v_mfma_f32_16x16x32_bf16 v[64:67], v[148:151], a[24:27], v[64:67]
    buffer_load_dwordx4 v[128:131], v4, s[16:19], s47 offen offset:0
    v_mfma_f32_16x16x32_bf16 v[92:95], v[152:155], a[24:27], v[92:95]
    v_mfma_f32_16x16x32_bf16 v[92:95], v[156:159], a[76:79], v[92:95]
    v_mfma_f32_16x16x32_bf16 v[64:67], v[144:147], a[76:79], v[64:67]
    buffer_load_dwordx4 v[132:135], v4, s[16:19], s47 offen offset:1024
    v_mfma_f32_16x16x32_bf16 v[36:39], v[188:191], a[76:79], v[36:39]
    v_mfma_f32_16x16x32_bf16 v[32:35], v[188:191], a[72:75], v[32:35]
    v_mfma_f32_16x16x32_bf16 v[60:63], v[144:147], a[72:75], v[60:63]
    buffer_load_dwordx4 v[136:139], v4, s[16:19], s47 offen offset:2048
    v_mfma_f32_16x16x32_bf16 v[88:91], v[156:159], a[72:75], v[88:91]
    v_mfma_f32_16x16x32_bf16 v[88:91], v[152:155], a[20:23], v[88:91]
    v_mfma_f32_16x16x32_bf16 v[60:63], v[148:151], a[20:23], v[60:63]
    buffer_load_dwordx4 v[140:143], v4, s[16:19], s47 offen offset:3072
    v_mfma_f32_16x16x32_bf16 v[32:35], v[144:147], a[20:23], v[32:35]
    v_mfma_f32_16x16x32_bf16 v[28:31], v[144:147], a[16:19], v[28:31]
    v_mfma_f32_16x16x32_bf16 v[56:59], v[148:151], a[16:19], v[56:59]
    ds_read_b128 a[36:39], v7 offset:1440
    v_mfma_f32_16x16x32_bf16 v[84:87], v[152:155], a[16:19], v[84:87]
    v_mfma_f32_16x16x32_bf16 v[84:87], v[156:159], a[68:71], v[84:87]
    ds_read_b128 a[88:91], v7 offset:1504
    v_mfma_f32_16x16x32_bf16 v[56:59], v[144:147], a[68:71], v[56:59]
    v_mfma_f32_16x16x32_bf16 v[28:31], v[188:191], a[68:71], v[28:31]
    ds_read_b128 a[32:35], v7 offset:1280
    v_mfma_f32_16x16x32_bf16 v[24:27], v[188:191], a[64:67], v[24:27]
    v_mfma_f32_16x16x32_bf16 v[52:55], v[144:147], a[64:67], v[52:55]
    ds_read_b128 a[84:87], v7 offset:1344
    v_mfma_f32_16x16x32_bf16 v[80:83], v[156:159], a[64:67], v[80:83]
    v_mfma_f32_16x16x32_bf16 v[80:83], v[152:155], a[12:15], v[80:83]
    ds_read_b128 a[28:31], v7 offset:1120
    v_mfma_f32_16x16x32_bf16 v[52:55], v[148:151], a[12:15], v[52:55]
    v_mfma_f32_16x16x32_bf16 v[24:27], v[144:147], a[12:15], v[24:27]
    ds_read_b128 a[80:83], v7 offset:1184
    v_mfma_f32_16x16x32_bf16 v[20:23], v[144:147], a[8:11], v[20:23]
    v_mfma_f32_16x16x32_bf16 v[48:51], v[148:151], a[8:11], v[48:51]
    ds_read_b128 a[24:27], v7 offset:960
    v_mfma_f32_16x16x32_bf16 v[76:79], v[152:155], a[8:11], v[76:79]
    v_mfma_f32_16x16x32_bf16 v[76:79], v[156:159], a[60:63], v[76:79]
    ds_read_b128 a[76:79], v7 offset:1024
    v_mfma_f32_16x16x32_bf16 v[48:51], v[144:147], a[60:63], v[48:51]
    v_mfma_f32_16x16x32_bf16 v[20:23], v[188:191], a[60:63], v[20:23]
    v_mfma_f32_16x16x32_bf16 v[16:19], v[188:191], a[56:59], v[16:19]
    v_mfma_f32_16x16x32_bf16 v[44:47], v[144:147], a[56:59], v[44:47]
    v_mfma_f32_16x16x32_bf16 v[72:75], v[156:159], a[56:59], v[72:75]
    v_xor_b32 v192, 0x80008000, v164
    v_mfma_f32_16x16x32_bf16 v[72:75], v[152:155], a[4:7], v[72:75]
    v_xor_b32 v193, 0x80008000, v165
    v_mfma_f32_16x16x32_bf16 v[44:47], v[148:151], a[4:7], v[44:47]
    v_xor_b32 v194, 0x80008000, v166
    v_mfma_f32_16x16x32_bf16 v[16:19], v[144:147], a[4:7], v[16:19]
    v_xor_b32 v195, 0x80008000, v167
    s_waitcnt lgkmcnt(15)
    v_mfma_f32_16x16x32_bf16 v[12:15], v[144:147], a[0:3], v[12:15]
    v_xor_b32 v172, 0x80008000, v172
    v_mfma_f32_16x16x32_bf16 v[40:43], v[148:151], a[0:3], v[40:43]
    v_xor_b32 v173, 0x80008000, v173
    v_mfma_f32_16x16x32_bf16 v[68:71], v[152:155], a[0:3], v[68:71]
    v_xor_b32 v174, 0x80008000, v174
    s_waitcnt lgkmcnt(14)
    v_mfma_f32_16x16x32_bf16 v[68:71], v[156:159], a[52:55], v[68:71]
    v_xor_b32 v175, 0x80008000, v175
    v_mfma_f32_16x16x32_bf16 v[40:43], v[144:147], a[52:55], v[40:43]
    v_mfma_f32_16x16x32_bf16 v[12:15], v[188:191], a[52:55], v[12:15]
    s_waitcnt lgkmcnt(13)
    v_mfma_f32_16x16x32_bf16 v[36:39], v[160:163], a[48:51], v[36:39]
    s_add_u32 s47, s45, 110592
    v_mfma_f32_16x16x32_bf16 v[64:67], v[164:167], a[48:51], v[64:67]
    buffer_load_dwordx4 v[144:147], v4, s[16:19], s47 offen offset:0
    v_mfma_f32_16x16x32_bf16 v[92:95], v[168:171], a[48:51], v[92:95]
    s_waitcnt lgkmcnt(12)
    v_mfma_f32_16x16x32_bf16 v[92:95], v[172:175], a[100:103], v[92:95]
    v_mfma_f32_16x16x32_bf16 v[64:67], v[160:163], a[100:103], v[64:67]
    buffer_load_dwordx4 v[148:151], v4, s[16:19], s47 offen offset:1024
    v_mfma_f32_16x16x32_bf16 v[36:39], v[192:195], a[100:103], v[36:39]
    s_waitcnt lgkmcnt(10)
    v_mfma_f32_16x16x32_bf16 v[32:35], v[192:195], a[96:99], v[32:35]
    v_mfma_f32_16x16x32_bf16 v[60:63], v[160:163], a[96:99], v[60:63]
    buffer_load_dwordx4 v[152:155], v4, s[16:19], s47 offen offset:2048
    v_mfma_f32_16x16x32_bf16 v[88:91], v[172:175], a[96:99], v[88:91]
    v_mfma_f32_16x16x32_bf16 v[88:91], v[168:171], a[44:47], v[88:91]
    v_mfma_f32_16x16x32_bf16 v[60:63], v[164:167], a[44:47], v[60:63]
    buffer_load_dwordx4 v[156:159], v4, s[16:19], s47 offen offset:3072
    v_mfma_f32_16x16x32_bf16 v[32:35], v[160:163], a[44:47], v[32:35]
    s_waitcnt lgkmcnt(9)
    v_mfma_f32_16x16x32_bf16 v[28:31], v[160:163], a[40:43], v[28:31]
    v_mfma_f32_16x16x32_bf16 v[56:59], v[164:167], a[40:43], v[56:59]
    ds_read_b128 a[20:23], v7 offset:800
    v_mfma_f32_16x16x32_bf16 v[84:87], v[168:171], a[40:43], v[84:87]
    s_waitcnt lgkmcnt(9)
    v_mfma_f32_16x16x32_bf16 v[84:87], v[172:175], a[92:95], v[84:87]
    ds_read_b128 a[72:75], v7 offset:864
    v_mfma_f32_16x16x32_bf16 v[56:59], v[160:163], a[92:95], v[56:59]
    v_mfma_f32_16x16x32_bf16 v[28:31], v[192:195], a[92:95], v[28:31]
    s_waitcnt lgkmcnt(8)
    v_mfma_f32_16x16x32_bf16 v[24:27], v[192:195], a[88:91], v[24:27]
    v_mfma_f32_16x16x32_bf16 v[52:55], v[160:163], a[88:91], v[52:55]
    v_mfma_f32_16x16x32_bf16 v[80:83], v[172:175], a[88:91], v[80:83]
    v_mfma_f32_16x16x32_bf16 v[80:83], v[168:171], a[36:39], v[80:83]
    v_mfma_f32_16x16x32_bf16 v[52:55], v[164:167], a[36:39], v[52:55]
    v_mfma_f32_16x16x32_bf16 v[24:27], v[160:163], a[36:39], v[24:27]
    s_waitcnt lgkmcnt(7)
    v_mfma_f32_16x16x32_bf16 v[20:23], v[160:163], a[32:35], v[20:23]
    v_mfma_f32_16x16x32_bf16 v[48:51], v[164:167], a[32:35], v[48:51]
    s_waitcnt vmcnt(14)
    v_xor_b32 v176, 0x80008000, v100
    v_mfma_f32_16x16x32_bf16 v[76:79], v[168:171], a[32:35], v[76:79]
    s_waitcnt lgkmcnt(6)
    v_mfma_f32_16x16x32_bf16 v[76:79], v[172:175], a[84:87], v[76:79]
    v_xor_b32 v177, 0x80008000, v101
    v_mfma_f32_16x16x32_bf16 v[48:51], v[160:163], a[84:87], v[48:51]
    v_mfma_f32_16x16x32_bf16 v[20:23], v[192:195], a[84:87], v[20:23]
    v_xor_b32 v178, 0x80008000, v102
    s_waitcnt lgkmcnt(4)
    v_mfma_f32_16x16x32_bf16 v[16:19], v[192:195], a[80:83], v[16:19]
    v_mfma_f32_16x16x32_bf16 v[44:47], v[160:163], a[80:83], v[44:47]
    v_xor_b32 v179, 0x80008000, v103
    v_mfma_f32_16x16x32_bf16 v[72:75], v[172:175], a[80:83], v[72:75]
    v_mfma_f32_16x16x32_bf16 v[72:75], v[168:171], a[28:31], v[72:75]
    s_waitcnt vmcnt(12)
    v_xor_b32 v108, 0x80008000, v108
    v_mfma_f32_16x16x32_bf16 v[44:47], v[164:167], a[28:31], v[44:47]
    v_mfma_f32_16x16x32_bf16 v[16:19], v[160:163], a[28:31], v[16:19]
    v_xor_b32 v109, 0x80008000, v109
    s_waitcnt lgkmcnt(3)
    v_mfma_f32_16x16x32_bf16 v[12:15], v[160:163], a[24:27], v[12:15]
    v_mfma_f32_16x16x32_bf16 v[40:43], v[164:167], a[24:27], v[40:43]
    v_xor_b32 v110, 0x80008000, v110
    v_mfma_f32_16x16x32_bf16 v[68:71], v[168:171], a[24:27], v[68:71]
    s_waitcnt lgkmcnt(2)
    v_mfma_f32_16x16x32_bf16 v[68:71], v[172:175], a[76:79], v[68:71]
    v_xor_b32 v111, 0x80008000, v111
    v_mfma_f32_16x16x32_bf16 v[40:43], v[160:163], a[76:79], v[40:43]
    v_mfma_f32_16x16x32_bf16 v[12:15], v[192:195], a[76:79], v[12:15]
    v_mfma_f32_16x16x32_bf16 v[36:39], v[96:99], a[44:47], v[36:39]
    s_add_u32 s47, s45, 116736
    v_mfma_f32_16x16x32_bf16 v[64:67], v[100:103], a[44:47], v[64:67]
    buffer_load_dwordx4 v[160:163], v4, s[16:19], s47 offen offset:0
    v_mfma_f32_16x16x32_bf16 v[92:95], v[104:107], a[44:47], v[92:95]
    v_mfma_f32_16x16x32_bf16 v[92:95], v[108:111], a[96:99], v[92:95]
    v_mfma_f32_16x16x32_bf16 v[64:67], v[96:99], a[96:99], v[64:67]
    buffer_load_dwordx4 v[164:167], v4, s[16:19], s47 offen offset:1024
    v_mfma_f32_16x16x32_bf16 v[36:39], v[176:179], a[96:99], v[36:39]
    v_mfma_f32_16x16x32_bf16 v[32:35], v[176:179], a[92:95], v[32:35]
    v_mfma_f32_16x16x32_bf16 v[60:63], v[96:99], a[92:95], v[60:63]
    buffer_load_dwordx4 v[168:171], v4, s[16:19], s47 offen offset:2048
    v_mfma_f32_16x16x32_bf16 v[88:91], v[108:111], a[92:95], v[88:91]
    v_mfma_f32_16x16x32_bf16 v[88:91], v[104:107], a[40:43], v[88:91]
    v_mfma_f32_16x16x32_bf16 v[60:63], v[100:103], a[40:43], v[60:63]
    buffer_load_dwordx4 v[172:175], v4, s[16:19], s47 offen offset:3072
    v_mfma_f32_16x16x32_bf16 v[32:35], v[96:99], a[40:43], v[32:35]
    v_mfma_f32_16x16x32_bf16 v[28:31], v[96:99], a[36:39], v[28:31]
    v_mfma_f32_16x16x32_bf16 v[56:59], v[100:103], a[36:39], v[56:59]
    ds_read_b128 a[16:19], v7 offset:640
    v_mfma_f32_16x16x32_bf16 v[84:87], v[104:107], a[36:39], v[84:87]
    v_mfma_f32_16x16x32_bf16 v[84:87], v[108:111], a[88:91], v[84:87]
    ds_read_b128 a[68:71], v7 offset:704
    v_mfma_f32_16x16x32_bf16 v[56:59], v[96:99], a[88:91], v[56:59]
    v_mfma_f32_16x16x32_bf16 v[28:31], v[176:179], a[88:91], v[28:31]
    v_mfma_f32_16x16x32_bf16 v[24:27], v[176:179], a[84:87], v[24:27]
    v_mfma_f32_16x16x32_bf16 v[52:55], v[96:99], a[84:87], v[52:55]
    v_mfma_f32_16x16x32_bf16 v[80:83], v[108:111], a[84:87], v[80:83]
    v_mfma_f32_16x16x32_bf16 v[80:83], v[104:107], a[32:35], v[80:83]
    v_mfma_f32_16x16x32_bf16 v[52:55], v[100:103], a[32:35], v[52:55]
    v_mfma_f32_16x16x32_bf16 v[24:27], v[96:99], a[32:35], v[24:27]
    v_mfma_f32_16x16x32_bf16 v[20:23], v[96:99], a[28:31], v[20:23]
    v_mfma_f32_16x16x32_bf16 v[48:51], v[100:103], a[28:31], v[48:51]
    s_waitcnt vmcnt(14)
    v_xor_b32 v180, 0x80008000, v116
    v_mfma_f32_16x16x32_bf16 v[76:79], v[104:107], a[28:31], v[76:79]
    v_mfma_f32_16x16x32_bf16 v[76:79], v[108:111], a[80:83], v[76:79]
    v_xor_b32 v181, 0x80008000, v117
    v_mfma_f32_16x16x32_bf16 v[48:51], v[96:99], a[80:83], v[48:51]
    v_mfma_f32_16x16x32_bf16 v[20:23], v[176:179], a[80:83], v[20:23]
    v_xor_b32 v182, 0x80008000, v118
    v_mfma_f32_16x16x32_bf16 v[16:19], v[176:179], a[76:79], v[16:19]
    v_mfma_f32_16x16x32_bf16 v[44:47], v[96:99], a[76:79], v[44:47]
    v_xor_b32 v183, 0x80008000, v119
    v_mfma_f32_16x16x32_bf16 v[72:75], v[108:111], a[76:79], v[72:75]
    v_mfma_f32_16x16x32_bf16 v[72:75], v[104:107], a[24:27], v[72:75]
    s_waitcnt vmcnt(12)
    v_xor_b32 v124, 0x80008000, v124
    v_mfma_f32_16x16x32_bf16 v[44:47], v[100:103], a[24:27], v[44:47]
    v_mfma_f32_16x16x32_bf16 v[16:19], v[96:99], a[24:27], v[16:19]
    v_xor_b32 v125, 0x80008000, v125
    s_waitcnt lgkmcnt(3)
    v_mfma_f32_16x16x32_bf16 v[12:15], v[96:99], a[20:23], v[12:15]
    v_mfma_f32_16x16x32_bf16 v[40:43], v[100:103], a[20:23], v[40:43]
    v_xor_b32 v126, 0x80008000, v126
    v_mfma_f32_16x16x32_bf16 v[68:71], v[104:107], a[20:23], v[68:71]
    s_waitcnt lgkmcnt(2)
    v_mfma_f32_16x16x32_bf16 v[68:71], v[108:111], a[72:75], v[68:71]
    v_xor_b32 v127, 0x80008000, v127
    v_mfma_f32_16x16x32_bf16 v[40:43], v[96:99], a[72:75], v[40:43]
    v_mfma_f32_16x16x32_bf16 v[12:15], v[176:179], a[72:75], v[12:15]
    v_mfma_f32_16x16x32_bf16 v[36:39], v[112:115], a[40:43], v[36:39]
    s_add_u32 s47, s45, 122880
    v_mfma_f32_16x16x32_bf16 v[64:67], v[116:119], a[40:43], v[64:67]
    buffer_load_dwordx4 v[96:99], v4, s[16:19], s47 offen offset:0
    v_mfma_f32_16x16x32_bf16 v[92:95], v[120:123], a[40:43], v[92:95]
    v_mfma_f32_16x16x32_bf16 v[92:95], v[124:127], a[92:95], v[92:95]
    v_mfma_f32_16x16x32_bf16 v[64:67], v[112:115], a[92:95], v[64:67]
    buffer_load_dwordx4 v[100:103], v4, s[16:19], s47 offen offset:1024
    v_mfma_f32_16x16x32_bf16 v[36:39], v[180:183], a[92:95], v[36:39]
    v_mfma_f32_16x16x32_bf16 v[32:35], v[180:183], a[88:91], v[32:35]
    v_mfma_f32_16x16x32_bf16 v[60:63], v[112:115], a[88:91], v[60:63]
    buffer_load_dwordx4 v[104:107], v4, s[16:19], s47 offen offset:2048
    v_mfma_f32_16x16x32_bf16 v[88:91], v[124:127], a[88:91], v[88:91]
    v_mfma_f32_16x16x32_bf16 v[88:91], v[120:123], a[36:39], v[88:91]
    v_mfma_f32_16x16x32_bf16 v[60:63], v[116:119], a[36:39], v[60:63]
    buffer_load_dwordx4 v[108:111], v4, s[16:19], s47 offen offset:3072
    v_mfma_f32_16x16x32_bf16 v[32:35], v[112:115], a[36:39], v[32:35]
    v_mfma_f32_16x16x32_bf16 v[28:31], v[112:115], a[32:35], v[28:31]
    v_mfma_f32_16x16x32_bf16 v[56:59], v[116:119], a[32:35], v[56:59]
    ds_read_b128 a[12:15], v7 offset:480
    v_mfma_f32_16x16x32_bf16 v[84:87], v[120:123], a[32:35], v[84:87]
    v_mfma_f32_16x16x32_bf16 v[84:87], v[124:127], a[84:87], v[84:87]
    ds_read_b128 a[64:67], v7 offset:544
    v_mfma_f32_16x16x32_bf16 v[56:59], v[112:115], a[84:87], v[56:59]
    s_waitcnt vmcnt(14)
    v_xor_b32 v184, 0x80008000, v132
    v_mfma_f32_16x16x32_bf16 v[28:31], v[180:183], a[84:87], v[28:31]
    ds_read_b128 a[8:11], v7 offset:320
    v_xor_b32 v185, 0x80008000, v133
    v_mfma_f32_16x16x32_bf16 v[24:27], v[180:183], a[80:83], v[24:27]
    v_xor_b32 v186, 0x80008000, v134
    v_mfma_f32_16x16x32_bf16 v[52:55], v[112:115], a[80:83], v[52:55]
    ds_read_b128 a[60:63], v7 offset:384
    v_xor_b32 v187, 0x80008000, v135
    v_mfma_f32_16x16x32_bf16 v[80:83], v[124:127], a[80:83], v[80:83]
    s_waitcnt vmcnt(12)
    v_xor_b32 v140, 0x80008000, v140
    v_mfma_f32_16x16x32_bf16 v[80:83], v[120:123], a[28:31], v[80:83]
    ds_read_b128 a[4:7], v7 offset:160
    v_xor_b32 v141, 0x80008000, v141
    v_mfma_f32_16x16x32_bf16 v[52:55], v[116:119], a[28:31], v[52:55]
    v_xor_b32 v142, 0x80008000, v142
    v_mfma_f32_16x16x32_bf16 v[24:27], v[112:115], a[28:31], v[24:27]
    ds_read_b128 a[56:59], v7 offset:224
    v_xor_b32 v143, 0x80008000, v143
    v_mfma_f32_16x16x32_bf16 v[20:23], v[112:115], a[24:27], v[20:23]
    s_waitcnt vmcnt(10)
    v_xor_b32 v188, 0x80008000, v148
    v_mfma_f32_16x16x32_bf16 v[48:51], v[116:119], a[24:27], v[48:51]
    ds_read_b128 a[0:3], v7 offset:0
    v_xor_b32 v189, 0x80008000, v149
    v_mfma_f32_16x16x32_bf16 v[76:79], v[120:123], a[24:27], v[76:79]
    v_xor_b32 v190, 0x80008000, v150
    v_mfma_f32_16x16x32_bf16 v[76:79], v[124:127], a[76:79], v[76:79]
    ds_read_b128 a[52:55], v7 offset:64
    v_xor_b32 v191, 0x80008000, v151
    v_mfma_f32_16x16x32_bf16 v[48:51], v[112:115], a[76:79], v[48:51]
    s_waitcnt vmcnt(8)
    v_xor_b32 v156, 0x80008000, v156
    v_mfma_f32_16x16x32_bf16 v[20:23], v[180:183], a[76:79], v[20:23]
    v_xor_b32 v157, 0x80008000, v157
    v_mfma_f32_16x16x32_bf16 v[16:19], v[180:183], a[72:75], v[16:19]
    v_xor_b32 v158, 0x80008000, v158
    v_mfma_f32_16x16x32_bf16 v[44:47], v[112:115], a[72:75], v[44:47]
    v_xor_b32 v159, 0x80008000, v159
    v_mfma_f32_16x16x32_bf16 v[72:75], v[124:127], a[72:75], v[72:75]
    s_waitcnt vmcnt(6)
    v_xor_b32 v192, 0x80008000, v164
    v_mfma_f32_16x16x32_bf16 v[72:75], v[120:123], a[20:23], v[72:75]
    v_xor_b32 v193, 0x80008000, v165
    v_mfma_f32_16x16x32_bf16 v[44:47], v[116:119], a[20:23], v[44:47]
    v_xor_b32 v194, 0x80008000, v166
    v_mfma_f32_16x16x32_bf16 v[16:19], v[112:115], a[20:23], v[16:19]
    v_xor_b32 v195, 0x80008000, v167
    s_waitcnt lgkmcnt(9)
    v_mfma_f32_16x16x32_bf16 v[12:15], v[112:115], a[16:19], v[12:15]
    s_waitcnt vmcnt(4)
    v_xor_b32 v172, 0x80008000, v172
    v_mfma_f32_16x16x32_bf16 v[40:43], v[116:119], a[16:19], v[40:43]
    v_xor_b32 v173, 0x80008000, v173
    v_mfma_f32_16x16x32_bf16 v[68:71], v[120:123], a[16:19], v[68:71]
    v_xor_b32 v174, 0x80008000, v174
    s_waitcnt lgkmcnt(8)
    v_mfma_f32_16x16x32_bf16 v[68:71], v[124:127], a[68:71], v[68:71]
    v_xor_b32 v175, 0x80008000, v175
    v_mfma_f32_16x16x32_bf16 v[40:43], v[112:115], a[68:71], v[40:43]
    v_mfma_f32_16x16x32_bf16 v[12:15], v[180:183], a[68:71], v[12:15]
    s_waitcnt vmcnt(2)
    v_xor_b32 v176, 0x80008000, v100
    v_mfma_f32_16x16x32_bf16 v[92:95], v[136:139], a[36:39], v[92:95]
    v_xor_b32 v177, 0x80008000, v101
    v_mfma_f32_16x16x32_bf16 v[92:95], v[152:155], a[32:35], v[92:95]
    v_xor_b32 v178, 0x80008000, v102
    v_mfma_f32_16x16x32_bf16 v[92:95], v[168:171], a[28:31], v[92:95]
    v_xor_b32 v179, 0x80008000, v103
    s_waitcnt vmcnt(1)
    v_mfma_f32_16x16x32_bf16 v[92:95], v[104:107], a[24:27], v[92:95]
    s_waitcnt vmcnt(0)
    v_xor_b32 v108, 0x80008000, v108
    v_mfma_f32_16x16x32_bf16 v[92:95], v[140:143], a[88:91], v[92:95]
    v_xor_b32 v109, 0x80008000, v109
    v_mfma_f32_16x16x32_bf16 v[92:95], v[156:159], a[84:87], v[92:95]
    v_xor_b32 v110, 0x80008000, v110
    v_mfma_f32_16x16x32_bf16 v[92:95], v[172:175], a[80:83], v[92:95]
    v_xor_b32 v111, 0x80008000, v111
    s_nop 1
    v_mfma_f32_16x16x32_bf16 v[92:95], v[108:111], a[76:79], v[92:95]
    v_mfma_f32_16x16x32_bf16 v[88:91], v[136:139], a[32:35], v[88:91]
    v_mfma_f32_16x16x32_bf16 v[88:91], v[152:155], a[28:31], v[88:91]
    v_mfma_f32_16x16x32_bf16 v[88:91], v[168:171], a[24:27], v[88:91]
    v_mfma_f32_16x16x32_bf16 v[88:91], v[104:107], a[20:23], v[88:91]
    v_mfma_f32_16x16x32_bf16 v[88:91], v[140:143], a[84:87], v[88:91]
    v_mfma_f32_16x16x32_bf16 v[88:91], v[156:159], a[80:83], v[88:91]
    v_mfma_f32_16x16x32_bf16 v[88:91], v[172:175], a[76:79], v[88:91]
    v_mfma_f32_16x16x32_bf16 v[88:91], v[108:111], a[72:75], v[88:91]
    v_cvt_pk_bf16_f32 v92, v92, v93
    v_mfma_f32_16x16x32_bf16 v[84:87], v[136:139], a[28:31], v[84:87]
    v_cvt_pk_bf16_f32 v93, v94, v95
    v_mfma_f32_16x16x32_bf16 v[84:87], v[152:155], a[24:27], v[84:87]
    v_mfma_f32_16x16x32_bf16 v[84:87], v[168:171], a[20:23], v[84:87]
    ds_write_b64 v10, v[92:93] offset:3072
    v_mfma_f32_16x16x32_bf16 v[84:87], v[104:107], a[16:19], v[84:87]
    v_mfma_f32_16x16x32_bf16 v[84:87], v[140:143], a[80:83], v[84:87]
    v_mfma_f32_16x16x32_bf16 v[84:87], v[156:159], a[76:79], v[84:87]
    v_mfma_f32_16x16x32_bf16 v[84:87], v[172:175], a[72:75], v[84:87]
    v_mfma_f32_16x16x32_bf16 v[84:87], v[108:111], a[68:71], v[84:87]
    v_cvt_pk_bf16_f32 v88, v88, v89
    v_mfma_f32_16x16x32_bf16 v[80:83], v[136:139], a[24:27], v[80:83]
    v_cvt_pk_bf16_f32 v89, v90, v91
    v_mfma_f32_16x16x32_bf16 v[80:83], v[152:155], a[20:23], v[80:83]
    v_mfma_f32_16x16x32_bf16 v[80:83], v[168:171], a[16:19], v[80:83]
    s_waitcnt lgkmcnt(8)
    v_mfma_f32_16x16x32_bf16 v[80:83], v[104:107], a[12:15], v[80:83]
    v_mfma_f32_16x16x32_bf16 v[80:83], v[140:143], a[76:79], v[80:83]
    v_mfma_f32_16x16x32_bf16 v[80:83], v[156:159], a[72:75], v[80:83]
    v_mfma_f32_16x16x32_bf16 v[80:83], v[172:175], a[68:71], v[80:83]
    s_waitcnt lgkmcnt(7)
    v_mfma_f32_16x16x32_bf16 v[80:83], v[108:111], a[64:67], v[80:83]
    v_cvt_pk_bf16_f32 v84, v84, v85
    v_mfma_f32_16x16x32_bf16 v[76:79], v[136:139], a[20:23], v[76:79]
    v_cvt_pk_bf16_f32 v85, v86, v87
    v_mfma_f32_16x16x32_bf16 v[76:79], v[152:155], a[16:19], v[76:79]
    v_mfma_f32_16x16x32_bf16 v[76:79], v[168:171], a[12:15], v[76:79]
    ds_write_b64 v10, v[84:85] offset:2048
    s_waitcnt lgkmcnt(7)
    v_mfma_f32_16x16x32_bf16 v[76:79], v[104:107], a[8:11], v[76:79]
    v_mfma_f32_16x16x32_bf16 v[76:79], v[140:143], a[72:75], v[76:79]
    v_mfma_f32_16x16x32_bf16 v[76:79], v[156:159], a[68:71], v[76:79]
    v_mfma_f32_16x16x32_bf16 v[76:79], v[172:175], a[64:67], v[76:79]
    s_waitcnt lgkmcnt(6)
    v_mfma_f32_16x16x32_bf16 v[76:79], v[108:111], a[60:63], v[76:79]
    v_cvt_pk_bf16_f32 v80, v80, v81
    v_mfma_f32_16x16x32_bf16 v[72:75], v[136:139], a[16:19], v[72:75]
    v_cvt_pk_bf16_f32 v81, v82, v83
    v_mfma_f32_16x16x32_bf16 v[72:75], v[152:155], a[12:15], v[72:75]
    v_mfma_f32_16x16x32_bf16 v[72:75], v[168:171], a[8:11], v[72:75]
    s_waitcnt lgkmcnt(5)
    v_mfma_f32_16x16x32_bf16 v[72:75], v[104:107], a[4:7], v[72:75]
    v_mfma_f32_16x16x32_bf16 v[72:75], v[140:143], a[68:71], v[72:75]
    v_mfma_f32_16x16x32_bf16 v[72:75], v[156:159], a[64:67], v[72:75]
    v_mfma_f32_16x16x32_bf16 v[72:75], v[172:175], a[60:63], v[72:75]
    s_waitcnt lgkmcnt(4)
    v_mfma_f32_16x16x32_bf16 v[72:75], v[108:111], a[56:59], v[72:75]
    v_cvt_pk_bf16_f32 v76, v76, v77
    v_mfma_f32_16x16x32_bf16 v[68:71], v[136:139], a[12:15], v[68:71]
    v_cvt_pk_bf16_f32 v77, v78, v79
    v_mfma_f32_16x16x32_bf16 v[68:71], v[152:155], a[8:11], v[68:71]
    v_mfma_f32_16x16x32_bf16 v[68:71], v[168:171], a[4:7], v[68:71]
    ds_write_b64 v10, v[76:77] offset:1024
    s_waitcnt lgkmcnt(4)
    v_mfma_f32_16x16x32_bf16 v[68:71], v[104:107], a[0:3], v[68:71]
    v_mfma_f32_16x16x32_bf16 v[68:71], v[140:143], a[64:67], v[68:71]
    v_mfma_f32_16x16x32_bf16 v[68:71], v[156:159], a[60:63], v[68:71]
    v_mfma_f32_16x16x32_bf16 v[68:71], v[172:175], a[56:59], v[68:71]
    s_waitcnt lgkmcnt(3)
    v_mfma_f32_16x16x32_bf16 v[68:71], v[108:111], a[52:55], v[68:71]
    v_cvt_pk_bf16_f32 v72, v72, v73
    v_mfma_f32_16x16x32_bf16 v[36:39], v[128:131], a[36:39], v[36:39]
    v_cvt_pk_bf16_f32 v73, v74, v75
    v_mfma_f32_16x16x32_bf16 v[36:39], v[144:147], a[32:35], v[36:39]
    v_mfma_f32_16x16x32_bf16 v[36:39], v[160:163], a[28:31], v[36:39]
    v_mfma_f32_16x16x32_bf16 v[36:39], v[96:99], a[24:27], v[36:39]
    v_mfma_f32_16x16x32_bf16 v[36:39], v[184:187], a[88:91], v[36:39]
    v_mfma_f32_16x16x32_bf16 v[36:39], v[188:191], a[84:87], v[36:39]
    v_mfma_f32_16x16x32_bf16 v[36:39], v[192:195], a[80:83], v[36:39]
    v_mfma_f32_16x16x32_bf16 v[36:39], v[176:179], a[76:79], v[36:39]
    v_cvt_pk_bf16_f32 v68, v68, v69
    v_mfma_f32_16x16x32_bf16 v[64:67], v[128:131], a[88:91], v[64:67]
    v_cvt_pk_bf16_f32 v69, v70, v71
    v_mfma_f32_16x16x32_bf16 v[64:67], v[144:147], a[84:87], v[64:67]
    v_mfma_f32_16x16x32_bf16 v[64:67], v[160:163], a[80:83], v[64:67]
    v_mfma_f32_16x16x32_bf16 v[64:67], v[96:99], a[76:79], v[64:67]
    v_mfma_f32_16x16x32_bf16 v[64:67], v[132:135], a[36:39], v[64:67]
    s_waitcnt lgkmcnt(0)
    s_barrier
    v_mfma_f32_16x16x32_bf16 v[64:67], v[148:151], a[32:35], v[64:67]
    ds_read_b64 v[90:91], v10 offset:2560
    v_mfma_f32_16x16x32_bf16 v[64:67], v[164:167], a[28:31], v[64:67]
    ds_read_b64 v[82:83], v10 offset:1536
    v_mfma_f32_16x16x32_bf16 v[64:67], v[100:103], a[24:27], v[64:67]
    ds_read_b64 v[74:75], v10 offset:512
    v_cvt_pk_bf16_f32 v196, v36, v37
    v_mfma_f32_16x16x32_bf16 v[32:35], v[128:131], a[32:35], v[32:35]
    ds_read_b64 v[70:71], v10 offset:0
    v_cvt_pk_bf16_f32 v197, v38, v39
    v_mfma_f32_16x16x32_bf16 v[32:35], v[144:147], a[28:31], v[32:35]
    v_mfma_f32_16x16x32_bf16 v[32:35], v[160:163], a[24:27], v[32:35]
    v_mfma_f32_16x16x32_bf16 v[32:35], v[96:99], a[20:23], v[32:35]
    v_mfma_f32_16x16x32_bf16 v[32:35], v[184:187], a[84:87], v[32:35]
    v_mfma_f32_16x16x32_bf16 v[32:35], v[188:191], a[80:83], v[32:35]
    v_mfma_f32_16x16x32_bf16 v[32:35], v[192:195], a[76:79], v[32:35]
    v_mfma_f32_16x16x32_bf16 v[32:35], v[176:179], a[72:75], v[32:35]
    v_cvt_pk_bf16_f32 v198, v64, v65
    v_mfma_f32_16x16x32_bf16 v[60:63], v[128:131], a[84:87], v[60:63]
    s_mov_b32 s47, 245760
    v_cvt_pk_bf16_f32 v199, v66, v67
    v_mfma_f32_16x16x32_bf16 v[60:63], v[144:147], a[80:83], v[60:63]
    s_waitcnt lgkmcnt(3)
    buffer_store_dwordx4 v[88:91], v9, s[20:23], s47 offen offset:64 sc1
    s_mov_b32 s48, 294912
    v_mfma_f32_16x16x32_bf16 v[60:63], v[160:163], a[76:79], v[60:63]
    buffer_store_dwordx4 v[196:199], v9, s[20:23], s48 offen offset:0 sc1
    v_mfma_f32_16x16x32_bf16 v[60:63], v[96:99], a[72:75], v[60:63]
    v_mfma_f32_16x16x32_bf16 v[60:63], v[132:135], a[32:35], v[60:63]
    v_mfma_f32_16x16x32_bf16 v[60:63], v[148:151], a[28:31], v[60:63]
    v_mfma_f32_16x16x32_bf16 v[60:63], v[164:167], a[24:27], v[60:63]
    s_mov_b32 s47, 147456
    v_mfma_f32_16x16x32_bf16 v[60:63], v[100:103], a[20:23], v[60:63]
    s_waitcnt lgkmcnt(2)
    buffer_store_dwordx4 v[80:83], v9, s[20:23], s47 offen offset:64 sc1
    v_cvt_pk_bf16_f32 v200, v32, v33
    v_mfma_f32_16x16x32_bf16 v[28:31], v[128:131], a[28:31], v[28:31]
    v_cvt_pk_bf16_f32 v201, v34, v35
    v_mfma_f32_16x16x32_bf16 v[28:31], v[144:147], a[24:27], v[28:31]
    v_mfma_f32_16x16x32_bf16 v[28:31], v[160:163], a[20:23], v[28:31]
    v_mfma_f32_16x16x32_bf16 v[28:31], v[96:99], a[16:19], v[28:31]
    v_mfma_f32_16x16x32_bf16 v[28:31], v[184:187], a[80:83], v[28:31]
    s_mov_b32 s47, 49152
    v_mfma_f32_16x16x32_bf16 v[28:31], v[188:191], a[76:79], v[28:31]
    s_waitcnt lgkmcnt(1)
    buffer_store_dwordx4 v[72:75], v9, s[20:23], s47 offen offset:64 sc1
    v_mfma_f32_16x16x32_bf16 v[28:31], v[192:195], a[72:75], v[28:31]
    v_mfma_f32_16x16x32_bf16 v[28:31], v[176:179], a[68:71], v[28:31]
    v_cvt_pk_bf16_f32 v202, v60, v61
    v_mfma_f32_16x16x32_bf16 v[56:59], v[128:131], a[80:83], v[56:59]
    v_cvt_pk_bf16_f32 v203, v62, v63
    v_mfma_f32_16x16x32_bf16 v[56:59], v[144:147], a[76:79], v[56:59]
    s_mov_b32 s48, 245760
    v_mfma_f32_16x16x32_bf16 v[56:59], v[160:163], a[72:75], v[56:59]
    s_mov_b32 s47, 0
    buffer_store_dwordx4 v[200:203], v9, s[20:23], s48 offen offset:0 sc1
    v_mfma_f32_16x16x32_bf16 v[56:59], v[96:99], a[68:71], v[56:59]
    s_waitcnt lgkmcnt(0)
    buffer_store_dwordx4 v[68:71], v9, s[20:23], s47 offen offset:64 sc1
    v_mfma_f32_16x16x32_bf16 v[56:59], v[132:135], a[28:31], v[56:59]
    v_mfma_f32_16x16x32_bf16 v[56:59], v[148:151], a[24:27], v[56:59]
    v_mfma_f32_16x16x32_bf16 v[56:59], v[164:167], a[20:23], v[56:59]
    v_mfma_f32_16x16x32_bf16 v[56:59], v[100:103], a[16:19], v[56:59]
    v_cvt_pk_bf16_f32 v204, v28, v29
    v_mfma_f32_16x16x32_bf16 v[24:27], v[128:131], a[24:27], v[24:27]
    v_cvt_pk_bf16_f32 v205, v30, v31
    v_mfma_f32_16x16x32_bf16 v[24:27], v[144:147], a[20:23], v[24:27]
    v_mfma_f32_16x16x32_bf16 v[24:27], v[160:163], a[16:19], v[24:27]
    v_mfma_f32_16x16x32_bf16 v[24:27], v[96:99], a[12:15], v[24:27]
    v_mfma_f32_16x16x32_bf16 v[24:27], v[184:187], a[76:79], v[24:27]
    v_mfma_f32_16x16x32_bf16 v[24:27], v[188:191], a[72:75], v[24:27]
    v_mfma_f32_16x16x32_bf16 v[24:27], v[192:195], a[68:71], v[24:27]
    v_mfma_f32_16x16x32_bf16 v[24:27], v[176:179], a[64:67], v[24:27]
    v_cvt_pk_bf16_f32 v206, v56, v57
    v_mfma_f32_16x16x32_bf16 v[52:55], v[128:131], a[76:79], v[52:55]
    v_cvt_pk_bf16_f32 v207, v58, v59
    v_mfma_f32_16x16x32_bf16 v[52:55], v[144:147], a[72:75], v[52:55]
    s_mov_b32 s48, 196608
    v_mfma_f32_16x16x32_bf16 v[52:55], v[160:163], a[68:71], v[52:55]
    buffer_store_dwordx4 v[204:207], v9, s[20:23], s48 offen offset:0 sc1
    v_mfma_f32_16x16x32_bf16 v[52:55], v[96:99], a[64:67], v[52:55]
    v_mfma_f32_16x16x32_bf16 v[52:55], v[132:135], a[24:27], v[52:55]
    v_mfma_f32_16x16x32_bf16 v[52:55], v[148:151], a[20:23], v[52:55]
    v_mfma_f32_16x16x32_bf16 v[52:55], v[164:167], a[16:19], v[52:55]
    v_mfma_f32_16x16x32_bf16 v[52:55], v[100:103], a[12:15], v[52:55]
    v_cvt_pk_bf16_f32 v208, v24, v25
    v_mfma_f32_16x16x32_bf16 v[20:23], v[128:131], a[20:23], v[20:23]
    v_cvt_pk_bf16_f32 v209, v26, v27
    v_mfma_f32_16x16x32_bf16 v[20:23], v[144:147], a[16:19], v[20:23]
    v_mfma_f32_16x16x32_bf16 v[20:23], v[160:163], a[12:15], v[20:23]
    v_mfma_f32_16x16x32_bf16 v[20:23], v[96:99], a[8:11], v[20:23]
    v_mfma_f32_16x16x32_bf16 v[20:23], v[184:187], a[72:75], v[20:23]
    v_mfma_f32_16x16x32_bf16 v[20:23], v[188:191], a[68:71], v[20:23]
    v_mfma_f32_16x16x32_bf16 v[20:23], v[192:195], a[64:67], v[20:23]
    v_mfma_f32_16x16x32_bf16 v[20:23], v[176:179], a[60:63], v[20:23]
    v_cvt_pk_bf16_f32 v210, v52, v53
    v_mfma_f32_16x16x32_bf16 v[48:51], v[128:131], a[72:75], v[48:51]
    v_cvt_pk_bf16_f32 v211, v54, v55
    v_mfma_f32_16x16x32_bf16 v[48:51], v[144:147], a[68:71], v[48:51]
    s_mov_b32 s48, 147456
    v_mfma_f32_16x16x32_bf16 v[48:51], v[160:163], a[64:67], v[48:51]
    buffer_store_dwordx4 v[208:211], v9, s[20:23], s48 offen offset:0 sc1
    v_mfma_f32_16x16x32_bf16 v[48:51], v[96:99], a[60:63], v[48:51]
    v_mfma_f32_16x16x32_bf16 v[48:51], v[132:135], a[20:23], v[48:51]
    v_mfma_f32_16x16x32_bf16 v[48:51], v[148:151], a[16:19], v[48:51]
    v_mfma_f32_16x16x32_bf16 v[48:51], v[164:167], a[12:15], v[48:51]
    v_mfma_f32_16x16x32_bf16 v[48:51], v[100:103], a[8:11], v[48:51]
    v_cvt_pk_bf16_f32 v196, v20, v21
    v_mfma_f32_16x16x32_bf16 v[16:19], v[128:131], a[16:19], v[16:19]
    v_cvt_pk_bf16_f32 v197, v22, v23
    v_mfma_f32_16x16x32_bf16 v[16:19], v[144:147], a[12:15], v[16:19]
    v_mfma_f32_16x16x32_bf16 v[16:19], v[160:163], a[8:11], v[16:19]
    v_mfma_f32_16x16x32_bf16 v[16:19], v[96:99], a[4:7], v[16:19]
    v_mfma_f32_16x16x32_bf16 v[16:19], v[184:187], a[68:71], v[16:19]
    v_mfma_f32_16x16x32_bf16 v[16:19], v[188:191], a[64:67], v[16:19]
    v_mfma_f32_16x16x32_bf16 v[16:19], v[192:195], a[60:63], v[16:19]
    v_mfma_f32_16x16x32_bf16 v[16:19], v[176:179], a[56:59], v[16:19]
    v_cvt_pk_bf16_f32 v198, v48, v49
    v_mfma_f32_16x16x32_bf16 v[44:47], v[128:131], a[68:71], v[44:47]
    v_cvt_pk_bf16_f32 v199, v50, v51
    v_mfma_f32_16x16x32_bf16 v[44:47], v[144:147], a[64:67], v[44:47]
    s_mov_b32 s48, 98304
    v_mfma_f32_16x16x32_bf16 v[44:47], v[160:163], a[60:63], v[44:47]
    buffer_store_dwordx4 v[196:199], v9, s[20:23], s48 offen offset:0 sc1
    v_mfma_f32_16x16x32_bf16 v[44:47], v[96:99], a[56:59], v[44:47]
    v_mfma_f32_16x16x32_bf16 v[44:47], v[132:135], a[16:19], v[44:47]
    v_mfma_f32_16x16x32_bf16 v[44:47], v[148:151], a[12:15], v[44:47]
    v_mfma_f32_16x16x32_bf16 v[44:47], v[164:167], a[8:11], v[44:47]
    v_mfma_f32_16x16x32_bf16 v[44:47], v[100:103], a[4:7], v[44:47]
    v_cvt_pk_bf16_f32 v200, v16, v17
    v_mfma_f32_16x16x32_bf16 v[12:15], v[128:131], a[12:15], v[12:15]
    v_cvt_pk_bf16_f32 v201, v18, v19
    v_mfma_f32_16x16x32_bf16 v[12:15], v[144:147], a[8:11], v[12:15]
    v_mfma_f32_16x16x32_bf16 v[12:15], v[160:163], a[4:7], v[12:15]
    v_mfma_f32_16x16x32_bf16 v[12:15], v[96:99], a[0:3], v[12:15]
    v_mfma_f32_16x16x32_bf16 v[12:15], v[184:187], a[64:67], v[12:15]
    v_mfma_f32_16x16x32_bf16 v[12:15], v[188:191], a[60:63], v[12:15]
    v_mfma_f32_16x16x32_bf16 v[12:15], v[192:195], a[56:59], v[12:15]
    v_mfma_f32_16x16x32_bf16 v[12:15], v[176:179], a[52:55], v[12:15]
    v_cvt_pk_bf16_f32 v202, v44, v45
    v_mfma_f32_16x16x32_bf16 v[40:43], v[128:131], a[64:67], v[40:43]
    v_cvt_pk_bf16_f32 v203, v46, v47
    v_mfma_f32_16x16x32_bf16 v[40:43], v[144:147], a[60:63], v[40:43]
    s_mov_b32 s48, 49152
    v_mfma_f32_16x16x32_bf16 v[40:43], v[160:163], a[56:59], v[40:43]
    buffer_store_dwordx4 v[200:203], v9, s[20:23], s48 offen offset:0 sc1
    v_mfma_f32_16x16x32_bf16 v[40:43], v[96:99], a[52:55], v[40:43]
    v_mfma_f32_16x16x32_bf16 v[40:43], v[132:135], a[12:15], v[40:43]
    v_mfma_f32_16x16x32_bf16 v[40:43], v[148:151], a[8:11], v[40:43]
    v_mfma_f32_16x16x32_bf16 v[40:43], v[164:167], a[4:7], v[40:43]
    v_mfma_f32_16x16x32_bf16 v[40:43], v[100:103], a[0:3], v[40:43]
    v_cvt_pk_bf16_f32 v204, v12, v13
    v_cvt_pk_bf16_f32 v205, v14, v15
    s_nop 5
    v_cvt_pk_bf16_f32 v206, v40, v41
    v_cvt_pk_bf16_f32 v207, v42, v43
    s_mov_b32 s48, 0
    buffer_store_dwordx4 v[204:207], v9, s[20:23], s48 offen offset:0 sc1
    s_endpgm
K2_q1:
    s_waitcnt vmcnt(16)
    s_barrier
    ds_read_b128 a[48:51], v5 offset:1920
    ds_read_b128 a[100:103], v5 offset:1984
    ds_read_b128 a[44:47], v5 offset:1760
    ds_read_b128 a[96:99], v5 offset:1824
    ds_read_b128 a[40:43], v5 offset:1600
    ds_read_b128 a[92:95], v5 offset:1664
    ds_read_b128 a[36:39], v5 offset:1440
    ds_read_b128 a[88:91], v5 offset:1504
    ds_read_b128 a[32:35], v5 offset:1280
    ds_read_b128 a[84:87], v5 offset:1344
    ds_read_b128 a[28:31], v5 offset:1120
    ds_read_b128 a[80:83], v5 offset:1184
    ds_read_b128 a[24:27], v5 offset:960
    ds_read_b128 a[76:79], v5 offset:1024
    s_waitcnt vmcnt(12)
    v_xor_b32 v176, 0x80008000, v108
    v_xor_b32 v177, 0x80008000, v109
    v_xor_b32 v178, 0x80008000, v110
    v_xor_b32 v179, 0x80008000, v111
    s_waitcnt lgkmcnt(13)
    v_mfma_f32_16x16x32_bf16 v[36:39], v[100:103], a[48:51], 0
    s_add_u32 s47, s45, 24576
    v_mfma_f32_16x16x32_bf16 v[64:67], v[104:107], a[48:51], 0
    buffer_load_dwordx4 v[160:163], v4, s[16:19], s47 offen offset:0
    v_mfma_f32_16x16x32_bf16 v[92:95], v[108:111], a[48:51], 0
    s_waitcnt lgkmcnt(12)
    v_mfma_f32_16x16x32_bf16 v[92:95], v[104:107], a[100:103], v[92:95]
    v_mfma_f32_16x16x32_bf16 v[64:67], v[176:179], a[100:103], v[64:67]
    buffer_load_dwordx4 v[164:167], v4, s[16:19], s47 offen offset:1024
    v_mfma_f32_16x16x32_bf16 v[36:39], v[96:99], a[100:103], v[36:39]
    s_waitcnt lgkmcnt(10)
    v_mfma_f32_16x16x32_bf16 v[32:35], v[96:99], a[96:99], 0
    v_mfma_f32_16x16x32_bf16 v[60:63], v[176:179], a[96:99], 0
    buffer_load_dwordx4 v[168:171], v4, s[16:19], s47 offen offset:2048
    v_mfma_f32_16x16x32_bf16 v[88:91], v[104:107], a[96:99], 0
    v_mfma_f32_16x16x32_bf16 v[88:91], v[108:111], a[44:47], v[88:91]
    v_mfma_f32_16x16x32_bf16 v[60:63], v[104:107], a[44:47], v[60:63]
    buffer_load_dwordx4 v[172:175], v4, s[16:19], s47 offen offset:3072
    v_mfma_f32_16x16x32_bf16 v[32:35], v[100:103], a[44:47], v[32:35]
    s_waitcnt lgkmcnt(9)
    v_mfma_f32_16x16x32_bf16 v[28:31], v[100:103], a[40:43], 0
    v_mfma_f32_16x16x32_bf16 v[56:59], v[104:107], a[40:43], 0
    ds_read_b128 a[20:23], v5 offset:800
    v_mfma_f32_16x16x32_bf16 v[84:87], v[108:111], a[40:43], 0
    s_waitcnt lgkmcnt(9)
    v_mfma_f32_16x16x32_bf16 v[84:87], v[104:107], a[92:95], v[84:87]
    ds_read_b128 a[72:75], v5 offset:864
    v_mfma_f32_16x16x32_bf16 v[56:59], v[176:179], a[92:95], v[56:59]
    v_mfma_f32_16x16x32_bf16 v[28:31], v[96:99], a[92:95], v[28:31]
    s_add_u32 m0, s42, 38400
    s_add_u32 s46, s44, 4096
    s_mov_b64 exec, s[40:41]
    buffer_load_dwordx4 v3, s[12:15], s46 offen lds
    s_mov_b64 exec, -1
    s_waitcnt lgkmcnt(8)
    v_mfma_f32_16x16x32_bf16 v[24:27], v[96:99], a[88:91], 0
    v_mfma_f32_16x16x32_bf16 v[52:55], v[176:179], a[88:91], 0
    v_mfma_f32_16x16x32_bf16 v[80:83], v[104:107], a[88:91], 0
    s_add_u32 m0, s42, 42240
    s_add_u32 s46, s43, 4096
    s_mov_b64 exec, s[40:41]
    buffer_load_dwordx4 v3, s[12:15], s46 offen lds
    s_mov_b64 exec, -1
    v_mfma_f32_16x16x32_bf16 v[80:83], v[108:111], a[36:39], v[80:83]
    v_mfma_f32_16x16x32_bf16 v[52:55], v[104:107], a[36:39], v[52:55]
    v_mfma_f32_16x16x32_bf16 v[24:27], v[100:103], a[36:39], v[24:27]
    s_add_u32 m0, s42, 46080
    s_add_u32 s46, s43, 1183744
    s_mov_b64 exec, s[40:41]
    buffer_load_dwordx4 v3, s[12:15], s46 offen lds
    s_mov_b64 exec, -1
    s_waitcnt lgkmcnt(7)
    v_mfma_f32_16x16x32_bf16 v[20:23], v[100:103], a[32:35], 0
    v_mfma_f32_16x16x32_bf16 v[48:51], v[104:107], a[32:35], 0
    v_mfma_f32_16x16x32_bf16 v[76:79], v[108:111], a[32:35], 0
    s_waitcnt lgkmcnt(6)
    v_mfma_f32_16x16x32_bf16 v[76:79], v[104:107], a[84:87], v[76:79]
    v_mfma_f32_16x16x32_bf16 v[48:51], v[176:179], a[84:87], v[48:51]
    v_mfma_f32_16x16x32_bf16 v[20:23], v[96:99], a[84:87], v[20:23]
    s_waitcnt lgkmcnt(4)
    v_mfma_f32_16x16x32_bf16 v[16:19], v[96:99], a[80:83], 0
    v_mfma_f32_16x16x32_bf16 v[44:47], v[176:179], a[80:83], 0
    v_mfma_f32_16x16x32_bf16 v[72:75], v[104:107], a[80:83], 0
    v_mfma_f32_16x16x32_bf16 v[72:75], v[108:111], a[28:31], v[72:75]
    s_waitcnt vmcnt(15)
    v_xor_b32 v180, 0x80008000, v124
    v_mfma_f32_16x16x32_bf16 v[44:47], v[104:107], a[28:31], v[44:47]
    v_mfma_f32_16x16x32_bf16 v[16:19], v[100:103], a[28:31], v[16:19]
    v_xor_b32 v181, 0x80008000, v125
    s_waitcnt lgkmcnt(3)
    v_mfma_f32_16x16x32_bf16 v[12:15], v[100:103], a[24:27], 0
    v_mfma_f32_16x16x32_bf16 v[40:43], v[104:107], a[24:27], 0
    v_xor_b32 v182, 0x80008000, v126
    v_mfma_f32_16x16x32_bf16 v[68:71], v[108:111], a[24:27], 0
    s_waitcnt lgkmcnt(2)
    v_mfma_f32_16x16x32_bf16 v[68:71], v[104:107], a[76:79], v[68:71]
    v_xor_b32 v183, 0x80008000, v127
    v_mfma_f32_16x16x32_bf16 v[40:43], v[176:179], a[76:79], v[40:43]
    v_mfma_f32_16x16x32_bf16 v[12:15], v[96:99], a[76:79], v[12:15]
    v_mfma_f32_16x16x32_bf16 v[36:39], v[116:119], a[44:47], v[36:39]
    s_add_u32 s47, s45, 30720
    v_mfma_f32_16x16x32_bf16 v[64:67], v[120:123], a[44:47], v[64:67]
    buffer_load_dwordx4 v[96:99], v4, s[16:19], s47 offen offset:0
    v_mfma_f32_16x16x32_bf16 v[92:95], v[124:127], a[44:47], v[92:95]
    v_mfma_f32_16x16x32_bf16 v[92:95], v[120:123], a[96:99], v[92:95]
    v_mfma_f32_16x16x32_bf16 v[64:67], v[180:183], a[96:99], v[64:67]
    buffer_load_dwordx4 v[100:103], v4, s[16:19], s47 offen offset:1024
    v_mfma_f32_16x16x32_bf16 v[36:39], v[112:115], a[96:99], v[36:39]
    v_mfma_f32_16x16x32_bf16 v[32:35], v[112:115], a[92:95], v[32:35]
    v_mfma_f32_16x16x32_bf16 v[60:63], v[180:183], a[92:95], v[60:63]
    buffer_load_dwordx4 v[104:107], v4, s[16:19], s47 offen offset:2048
    v_mfma_f32_16x16x32_bf16 v[88:91], v[120:123], a[92:95], v[88:91]
    v_mfma_f32_16x16x32_bf16 v[88:91], v[124:127], a[40:43], v[88:91]
    v_mfma_f32_16x16x32_bf16 v[60:63], v[120:123], a[40:43], v[60:63]
    buffer_load_dwordx4 v[108:111], v4, s[16:19], s47 offen offset:3072
    v_mfma_f32_16x16x32_bf16 v[32:35], v[116:119], a[40:43], v[32:35]
    v_mfma_f32_16x16x32_bf16 v[28:31], v[116:119], a[36:39], v[28:31]
    v_mfma_f32_16x16x32_bf16 v[56:59], v[120:123], a[36:39], v[56:59]
    ds_read_b128 a[16:19], v5 offset:640
    v_mfma_f32_16x16x32_bf16 v[84:87], v[124:127], a[36:39], v[84:87]
    v_mfma_f32_16x16x32_bf16 v[84:87], v[120:123], a[88:91], v[84:87]
    ds_read_b128 a[68:71], v5 offset:704
    v_mfma_f32_16x16x32_bf16 v[56:59], v[180:183], a[88:91], v[56:59]
    v_mfma_f32_16x16x32_bf16 v[28:31], v[112:115], a[88:91], v[28:31]
    s_add_u32 m0, s42, 49920
    s_add_u32 s46, s43, 2363392
    s_mov_b64 exec, s[40:41]
    buffer_load_dwordx4 v3, s[12:15], s46 offen lds
    s_mov_b64 exec, -1
    v_mfma_f32_16x16x32_bf16 v[24:27], v[112:115], a[84:87], v[24:27]
    v_mfma_f32_16x16x32_bf16 v[52:55], v[180:183], a[84:87], v[52:55]
    v_mfma_f32_16x16x32_bf16 v[80:83], v[120:123], a[84:87], v[80:83]
    s_add_u32 m0, s42, 53760
    s_add_u32 s46, s43, 3543040
    s_mov_b64 exec, s[40:41]
    buffer_load_dwordx4 v3, s[12:15], s46 offen lds
    s_mov_b64 exec, -1
    v_mfma_f32_16x16x32_bf16 v[80:83], v[124:127], a[32:35], v[80:83]
    v_mfma_f32_16x16x32_bf16 v[52:55], v[120:123], a[32:35], v[52:55]
    v_mfma_f32_16x16x32_bf16 v[24:27], v[116:119], a[32:35], v[24:27]
    s_add_u32 m0, s42, 57600
    s_add_u32 s46, s43, 4722688
    s_mov_b64 exec, s[40:41]
    buffer_load_dwordx4 v3, s[12:15], s46 offen lds
    s_mov_b64 exec, -1
    v_mfma_f32_16x16x32_bf16 v[20:23], v[116:119], a[28:31], v[20:23]
    v_mfma_f32_16x16x32_bf16 v[48:51], v[120:123], a[28:31], v[48:51]
    v_mfma_f32_16x16x32_bf16 v[76:79], v[124:127], a[28:31], v[76:79]
    v_mfma_f32_16x16x32_bf16 v[76:79], v[120:123], a[80:83], v[76:79]
    v_mfma_f32_16x16x32_bf16 v[48:51], v[180:183], a[80:83], v[48:51]
    v_mfma_f32_16x16x32_bf16 v[20:23], v[112:115], a[80:83], v[20:23]
    v_mfma_f32_16x16x32_bf16 v[16:19], v[112:115], a[76:79], v[16:19]
    v_mfma_f32_16x16x32_bf16 v[44:47], v[180:183], a[76:79], v[44:47]
    v_mfma_f32_16x16x32_bf16 v[72:75], v[120:123], a[76:79], v[72:75]
    v_mfma_f32_16x16x32_bf16 v[72:75], v[124:127], a[24:27], v[72:75]
    s_waitcnt vmcnt(18)
    v_xor_b32 v184, 0x80008000, v140
    v_mfma_f32_16x16x32_bf16 v[44:47], v[120:123], a[24:27], v[44:47]
    v_mfma_f32_16x16x32_bf16 v[16:19], v[116:119], a[24:27], v[16:19]
    v_xor_b32 v185, 0x80008000, v141
    s_waitcnt lgkmcnt(3)
    v_mfma_f32_16x16x32_bf16 v[12:15], v[116:119], a[20:23], v[12:15]
    v_mfma_f32_16x16x32_bf16 v[40:43], v[120:123], a[20:23], v[40:43]
    v_xor_b32 v186, 0x80008000, v142
    v_mfma_f32_16x16x32_bf16 v[68:71], v[124:127], a[20:23], v[68:71]
    s_waitcnt lgkmcnt(2)
    v_mfma_f32_16x16x32_bf16 v[68:71], v[120:123], a[72:75], v[68:71]
    v_xor_b32 v187, 0x80008000, v143
    v_mfma_f32_16x16x32_bf16 v[40:43], v[180:183], a[72:75], v[40:43]
    v_mfma_f32_16x16x32_bf16 v[12:15], v[112:115], a[72:75], v[12:15]
    v_mfma_f32_16x16x32_bf16 v[36:39], v[132:135], a[40:43], v[36:39]
    s_add_u32 s47, s45, 36864
    v_mfma_f32_16x16x32_bf16 v[64:67], v[136:139], a[40:43], v[64:67]
    buffer_load_dwordx4 v[112:115], v4, s[16:19], s47 offen offset:0
    v_mfma_f32_16x16x32_bf16 v[92:95], v[140:143], a[40:43], v[92:95]
    v_mfma_f32_16x16x32_bf16 v[92:95], v[136:139], a[92:95], v[92:95]
    v_mfma_f32_16x16x32_bf16 v[64:67], v[184:187], a[92:95], v[64:67]
    buffer_load_dwordx4 v[116:119], v4, s[16:19], s47 offen offset:1024
    v_mfma_f32_16x16x32_bf16 v[36:39], v[128:131], a[92:95], v[36:39]
    v_mfma_f32_16x16x32_bf16 v[32:35], v[128:131], a[88:91], v[32:35]
    v_mfma_f32_16x16x32_bf16 v[60:63], v[184:187], a[88:91], v[60:63]
    buffer_load_dwordx4 v[120:123], v4, s[16:19], s47 offen offset:2048
    v_mfma_f32_16x16x32_bf16 v[88:91], v[136:139], a[88:91], v[88:91]
    v_mfma_f32_16x16x32_bf16 v[88:91], v[140:143], a[36:39], v[88:91]
    v_mfma_f32_16x16x32_bf16 v[60:63], v[136:139], a[36:39], v[60:63]
    buffer_load_dwordx4 v[124:127], v4, s[16:19], s47 offen offset:3072
    v_mfma_f32_16x16x32_bf16 v[32:35], v[132:135], a[36:39], v[32:35]
    v_mfma_f32_16x16x32_bf16 v[28:31], v[132:135], a[32:35], v[28:31]
    v_mfma_f32_16x16x32_bf16 v[56:59], v[136:139], a[32:35], v[56:59]
    ds_read_b128 a[12:15], v5 offset:480
    v_mfma_f32_16x16x32_bf16 v[84:87], v[140:143], a[32:35], v[84:87]
    v_mfma_f32_16x16x32_bf16 v[84:87], v[136:139], a[84:87], v[84:87]
    ds_read_b128 a[64:67], v5 offset:544
    v_mfma_f32_16x16x32_bf16 v[56:59], v[184:187], a[84:87], v[56:59]
    v_mfma_f32_16x16x32_bf16 v[28:31], v[128:131], a[84:87], v[28:31]
    s_add_u32 m0, s42, 61440
    s_add_u32 s46, s43, 5902336
    s_mov_b64 exec, s[40:41]
    buffer_load_dwordx4 v3, s[12:15], s46 offen lds
    s_mov_b64 exec, -1
    v_mfma_f32_16x16x32_bf16 v[24:27], v[128:131], a[80:83], v[24:27]
    v_mfma_f32_16x16x32_bf16 v[52:55], v[184:187], a[80:83], v[52:55]
    v_mfma_f32_16x16x32_bf16 v[80:83], v[136:139], a[80:83], v[80:83]
    s_add_u32 m0, s42, 65280
    s_add_u32 s46, s43, 7081984
    s_mov_b64 exec, s[40:41]
    buffer_load_dwordx4 v3, s[12:15], s46 offen lds
    s_mov_b64 exec, -1
    v_mfma_f32_16x16x32_bf16 v[80:83], v[140:143], a[28:31], v[80:83]
    v_mfma_f32_16x16x32_bf16 v[52:55], v[136:139], a[28:31], v[52:55]
    v_mfma_f32_16x16x32_bf16 v[24:27], v[132:135], a[28:31], v[24:27]
    v_mfma_f32_16x16x32_bf16 v[20:23], v[132:135], a[24:27], v[20:23]
    v_mfma_f32_16x16x32_bf16 v[48:51], v[136:139], a[24:27], v[48:51]
    v_mfma_f32_16x16x32_bf16 v[76:79], v[140:143], a[24:27], v[76:79]
    v_mfma_f32_16x16x32_bf16 v[76:79], v[136:139], a[76:79], v[76:79]
    v_mfma_f32_16x16x32_bf16 v[48:51], v[184:187], a[76:79], v[48:51]
    v_mfma_f32_16x16x32_bf16 v[20:23], v[128:131], a[76:79], v[20:23]
    v_mfma_f32_16x16x32_bf16 v[16:19], v[128:131], a[72:75], v[16:19]
    v_mfma_f32_16x16x32_bf16 v[44:47], v[184:187], a[72:75], v[44:47]
    v_mfma_f32_16x16x32_bf16 v[72:75], v[136:139], a[72:75], v[72:75]
    v_mfma_f32_16x16x32_bf16 v[72:75], v[140:143], a[20:23], v[72:75]
    s_waitcnt vmcnt(20)
    v_xor_b32 v188, 0x80008000, v156
    v_mfma_f32_16x16x32_bf16 v[44:47], v[136:139], a[20:23], v[44:47]
    v_mfma_f32_16x16x32_bf16 v[16:19], v[132:135], a[20:23], v[16:19]
    v_xor_b32 v189, 0x80008000, v157
    s_waitcnt lgkmcnt(3)
    v_mfma_f32_16x16x32_bf16 v[12:15], v[132:135], a[16:19], v[12:15]
    v_mfma_f32_16x16x32_bf16 v[40:43], v[136:139], a[16:19], v[40:43]
    v_xor_b32 v190, 0x80008000, v158
    v_mfma_f32_16x16x32_bf16 v[68:71], v[140:143], a[16:19], v[68:71]
    s_waitcnt lgkmcnt(2)
    v_mfma_f32_16x16x32_bf16 v[68:71], v[136:139], a[68:71], v[68:71]
    v_xor_b32 v191, 0x80008000, v159
    v_mfma_f32_16x16x32_bf16 v[40:43], v[184:187], a[68:71], v[40:43]
    v_mfma_f32_16x16x32_bf16 v[12:15], v[128:131], a[68:71], v[12:15]
    v_mfma_f32_16x16x32_bf16 v[36:39], v[148:151], a[36:39], v[36:39]
    s_add_u32 s47, s45, 43008
    v_mfma_f32_16x16x32_bf16 v[64:67], v[152:155], a[36:39], v[64:67]
    buffer_load_dwordx4 v[128:131], v4, s[16:19], s47 offen offset:0
    v_mfma_f32_16x16x32_bf16 v[92:95], v[156:159], a[36:39], v[92:95]
    v_mfma_f32_16x16x32_bf16 v[92:95], v[152:155], a[88:91], v[92:95]
    v_mfma_f32_16x16x32_bf16 v[64:67], v[188:191], a[88:91], v[64:67]
    buffer_load_dwordx4 v[132:135], v4, s[16:19], s47 offen offset:1024
    v_mfma_f32_16x16x32_bf16 v[36:39], v[144:147], a[88:91], v[36:39]
    v_mfma_f32_16x16x32_bf16 v[32:35], v[144:147], a[84:87], v[32:35]
    v_mfma_f32_16x16x32_bf16 v[60:63], v[188:191], a[84:87], v[60:63]
    buffer_load_dwordx4 v[136:139], v4, s[16:19], s47 offen offset:2048
    v_mfma_f32_16x16x32_bf16 v[88:91], v[152:155], a[84:87], v[88:91]
    v_mfma_f32_16x16x32_bf16 v[88:91], v[156:159], a[32:35], v[88:91]
    v_mfma_f32_16x16x32_bf16 v[60:63], v[152:155], a[32:35], v[60:63]
    buffer_load_dwordx4 v[140:143], v4, s[16:19], s47 offen offset:3072
    v_mfma_f32_16x16x32_bf16 v[32:35], v[148:151], a[32:35], v[32:35]
    v_mfma_f32_16x16x32_bf16 v[28:31], v[148:151], a[28:31], v[28:31]
    v_mfma_f32_16x16x32_bf16 v[56:59], v[152:155], a[28:31], v[56:59]
    ds_read_b128 a[8:11], v5 offset:320
    v_mfma_f32_16x16x32_bf16 v[84:87], v[156:159], a[28:31], v[84:87]
    v_mfma_f32_16x16x32_bf16 v[84:87], v[152:155], a[80:83], v[84:87]
    ds_read_b128 a[60:63], v5 offset:384
    v_mfma_f32_16x16x32_bf16 v[56:59], v[188:191], a[80:83], v[56:59]
    v_mfma_f32_16x16x32_bf16 v[28:31], v[144:147], a[80:83], v[28:31]
    s_add_u32 m0, s42, 69120
    s_add_u32 s46, s43, 8261632
    s_mov_b64 exec, s[40:41]
    buffer_load_dwordx4 v3, s[12:15], s46 offen lds
    s_mov_b64 exec, -1
    v_mfma_f32_16x16x32_bf16 v[24:27], v[144:147], a[76:79], v[24:27]
    v_mfma_f32_16x16x32_bf16 v[52:55], v[188:191], a[76:79], v[52:55]
    v_mfma_f32_16x16x32_bf16 v[80:83], v[152:155], a[76:79], v[80:83]
    s_add_u32 m0, s42, 72960
    s_add_u32 s46, s43, 9441280
    s_mov_b64 exec, s[40:41]
    buffer_load_dwordx4 v3, s[12:15], s46 offen lds
    s_mov_b64 exec, -1
    v_mfma_f32_16x16x32_bf16 v[80:83], v[156:159], a[24:27], v[80:83]
    v_mfma_f32_16x16x32_bf16 v[52:55], v[152:155], a[24:27], v[52:55]
    v_mfma_f32_16x16x32_bf16 v[24:27], v[148:151], a[24:27], v[24:27]
    v_mfma_f32_16x16x32_bf16 v[20:23], v[148:151], a[20:23], v[20:23]
    v_mfma_f32_16x16x32_bf16 v[48:51], v[152:155], a[20:23], v[48:51]
    v_mfma_f32_16x16x32_bf16 v[76:79], v[156:159], a[20:23], v[76:79]
    v_mfma_f32_16x16x32_bf16 v[76:79], v[152:155], a[72:75], v[76:79]
    v_mfma_f32_16x16x32_bf16 v[48:51], v[188:191], a[72:75], v[48:51]
    v_mfma_f32_16x16x32_bf16 v[20:23], v[144:147], a[72:75], v[20:23]
    v_mfma_f32_16x16x32_bf16 v[16:19], v[144:147], a[68:71], v[16:19]
    v_mfma_f32_16x16x32_bf16 v[44:47], v[188:191], a[68:71], v[44:47]
    v_mfma_f32_16x16x32_bf16 v[72:75], v[152:155], a[68:71], v[72:75]
    v_mfma_f32_16x16x32_bf16 v[72:75], v[156:159], a[16:19], v[72:75]
    s_waitcnt vmcnt(22)
    v_xor_b32 v192, 0x80008000, v172
    v_mfma_f32_16x16x32_bf16 v[44:47], v[152:155], a[16:19], v[44:47]
    v_mfma_f32_16x16x32_bf16 v[16:19], v[148:151], a[16:19], v[16:19]
    v_xor_b32 v193, 0x80008000, v173
    s_waitcnt lgkmcnt(3)
    v_mfma_f32_16x16x32_bf16 v[12:15], v[148:151], a[12:15], v[12:15]
    v_mfma_f32_16x16x32_bf16 v[40:43], v[152:155], a[12:15], v[40:43]
    v_xor_b32 v194, 0x80008000, v174
    v_mfma_f32_16x16x32_bf16 v[68:71], v[156:159], a[12:15], v[68:71]
    s_waitcnt lgkmcnt(2)
    v_mfma_f32_16x16x32_bf16 v[68:71], v[152:155], a[64:67], v[68:71]
    v_xor_b32 v195, 0x80008000, v175
    v_mfma_f32_16x16x32_bf16 v[40:43], v[188:191], a[64:67], v[40:43]
    v_mfma_f32_16x16x32_bf16 v[12:15], v[144:147], a[64:67], v[12:15]
    v_mfma_f32_16x16x32_bf16 v[36:39], v[164:167], a[32:35], v[36:39]
    s_add_u32 s47, s45, 49152
    v_mfma_f32_16x16x32_bf16 v[64:67], v[168:171], a[32:35], v[64:67]
    buffer_load_dwordx4 v[144:147], v4, s[16:19], s47 offen offset:0
    v_mfma_f32_16x16x32_bf16 v[92:95], v[172:175], a[32:35], v[92:95]
    v_mfma_f32_16x16x32_bf16 v[92:95], v[168:171], a[84:87], v[92:95]
    v_mfma_f32_16x16x32_bf16 v[64:67], v[192:195], a[84:87], v[64:67]
    buffer_load_dwordx4 v[148:151], v4, s[16:19], s47 offen offset:1024
    v_mfma_f32_16x16x32_bf16 v[36:39], v[160:163], a[84:87], v[36:39]
    v_mfma_f32_16x16x32_bf16 v[32:35], v[160:163], a[80:83], v[32:35]
    v_mfma_f32_16x16x32_bf16 v[60:63], v[192:195], a[80:83], v[60:63]
    buffer_load_dwordx4 v[152:155], v4, s[16:19], s47 offen offset:2048
    v_mfma_f32_16x16x32_bf16 v[88:91], v[168:171], a[80:83], v[88:91]
    v_mfma_f32_16x16x32_bf16 v[88:91], v[172:175], a[28:31], v[88:91]
    v_mfma_f32_16x16x32_bf16 v[60:63], v[168:171], a[28:31], v[60:63]
    buffer_load_dwordx4 v[156:159], v4, s[16:19], s47 offen offset:3072
    v_mfma_f32_16x16x32_bf16 v[32:35], v[164:167], a[28:31], v[32:35]
    v_mfma_f32_16x16x32_bf16 v[28:31], v[164:167], a[24:27], v[28:31]
    v_mfma_f32_16x16x32_bf16 v[56:59], v[168:171], a[24:27], v[56:59]
    ds_read_b128 a[4:7], v5 offset:160
    v_mfma_f32_16x16x32_bf16 v[84:87], v[172:175], a[24:27], v[84:87]
    v_mfma_f32_16x16x32_bf16 v[84:87], v[168:171], a[76:79], v[84:87]
    ds_read_b128 a[56:59], v5 offset:224
    v_mfma_f32_16x16x32_bf16 v[56:59], v[192:195], a[76:79], v[56:59]
    v_mfma_f32_16x16x32_bf16 v[28:31], v[160:163], a[76:79], v[28:31]
    v_mfma_f32_16x16x32_bf16 v[24:27], v[160:163], a[72:75], v[24:27]
    v_mfma_f32_16x16x32_bf16 v[52:55], v[192:195], a[72:75], v[52:55]
    v_mfma_f32_16x16x32_bf16 v[80:83], v[168:171], a[72:75], v[80:83]
    v_mfma_f32_16x16x32_bf16 v[80:83], v[172:175], a[20:23], v[80:83]
    v_mfma_f32_16x16x32_bf16 v[52:55], v[168:171], a[20:23], v[52:55]
    v_mfma_f32_16x16x32_bf16 v[24:27], v[164:167], a[20:23], v[24:27]
    v_mfma_f32_16x16x32_bf16 v[20:23], v[164:167], a[16:19], v[20:23]
    v_mfma_f32_16x16x32_bf16 v[48:51], v[168:171], a[16:19], v[48:51]
    v_mfma_f32_16x16x32_bf16 v[76:79], v[172:175], a[16:19], v[76:79]
    v_mfma_f32_16x16x32_bf16 v[76:79], v[168:171], a[68:71], v[76:79]
    v_mfma_f32_16x16x32_bf16 v[48:51], v[192:195], a[68:71], v[48:51]
    v_mfma_f32_16x16x32_bf16 v[20:23], v[160:163], a[68:71], v[20:23]
    v_mfma_f32_16x16x32_bf16 v[16:19], v[160:163], a[64:67], v[16:19]
    v_mfma_f32_16x16x32_bf16 v[44:47], v[192:195], a[64:67], v[44:47]
    v_mfma_f32_16x16x32_bf16 v[72:75], v[168:171], a[64:67], v[72:75]
    v_mfma_f32_16x16x32_bf16 v[72:75], v[172:175], a[12:15], v[72:75]
    s_waitcnt vmcnt(19)
    v_xor_b32 v176, 0x80008000, v108
    v_mfma_f32_16x16x32_bf16 v[44:47], v[168:171], a[12:15], v[44:47]
    v_mfma_f32_16x16x32_bf16 v[16:19], v[164:167], a[12:15], v[16:19]
    v_xor_b32 v177, 0x80008000, v109
    s_waitcnt lgkmcnt(3)
    v_mfma_f32_16x16x32_bf16 v[12:15], v[164:167], a[8:11], v[12:15]
    v_mfma_f32_16x16x32_bf16 v[40:43], v[168:171], a[8:11], v[40:43]
    v_xor_b32 v178, 0x80008000, v110
    v_mfma_f32_16x16x32_bf16 v[68:71], v[172:175], a[8:11], v[68:71]
    s_waitcnt lgkmcnt(2)
    v_mfma_f32_16x16x32_bf16 v[68:71], v[168:171], a[60:63], v[68:71]
    v_xor_b32 v179, 0x80008000, v111
    v_mfma_f32_16x16x32_bf16 v[40:43], v[192:195], a[60:63], v[40:43]
    v_mfma_f32_16x16x32_bf16 v[12:15], v[160:163], a[60:63], v[12:15]
    v_mfma_f32_16x16x32_bf16 v[36:39], v[100:103], a[28:31], v[36:39]
    s_add_u32 s47, s45, 55296
    v_mfma_f32_16x16x32_bf16 v[64:67], v[104:107], a[28:31], v[64:67]
    buffer_load_dwordx4 v[160:163], v4, s[16:19], s47 offen offset:0
    v_mfma_f32_16x16x32_bf16 v[92:95], v[108:111], a[28:31], v[92:95]
    v_mfma_f32_16x16x32_bf16 v[92:95], v[104:107], a[80:83], v[92:95]
    v_mfma_f32_16x16x32_bf16 v[64:67], v[176:179], a[80:83], v[64:67]
    buffer_load_dwordx4 v[164:167], v4, s[16:19], s47 offen offset:1024
    v_mfma_f32_16x16x32_bf16 v[36:39], v[96:99], a[80:83], v[36:39]
    v_mfma_f32_16x16x32_bf16 v[32:35], v[96:99], a[76:79], v[32:35]
    v_mfma_f32_16x16x32_bf16 v[60:63], v[176:179], a[76:79], v[60:63]
    buffer_load_dwordx4 v[168:171], v4, s[16:19], s47 offen offset:2048
    v_mfma_f32_16x16x32_bf16 v[88:91], v[104:107], a[76:79], v[88:91]
    v_mfma_f32_16x16x32_bf16 v[88:91], v[108:111], a[24:27], v[88:91]
    v_mfma_f32_16x16x32_bf16 v[60:63], v[104:107], a[24:27], v[60:63]
    buffer_load_dwordx4 v[172:175], v4, s[16:19], s47 offen offset:3072
    v_mfma_f32_16x16x32_bf16 v[32:35], v[100:103], a[24:27], v[32:35]
    s_waitcnt vmcnt(8)
    s_barrier
    v_mfma_f32_16x16x32_bf16 v[28:31], v[100:103], a[20:23], v[28:31]
    v_mfma_f32_16x16x32_bf16 v[56:59], v[104:107], a[20:23], v[56:59]
    ds_read_b128 a[0:3], v5 offset:0
    v_mfma_f32_16x16x32_bf16 v[84:87], v[108:111], a[20:23], v[84:87]
    v_mfma_f32_16x16x32_bf16 v[84:87], v[104:107], a[72:75], v[84:87]
    ds_read_b128 a[52:55], v5 offset:64
    v_mfma_f32_16x16x32_bf16 v[56:59], v[176:179], a[72:75], v[56:59]
    v_mfma_f32_16x16x32_bf16 v[28:31], v[96:99], a[72:75], v[28:31]
    ds_read_b128 a[48:51], v6 offset:1920
    v_mfma_f32_16x16x32_bf16 v[24:27], v[96:99], a[68:71], v[24:27]
    v_mfma_f32_16x16x32_bf16 v[52:55], v[176:179], a[68:71], v[52:55]
    ds_read_b128 a[100:103], v6 offset:1984
    v_mfma_f32_16x16x32_bf16 v[80:83], v[104:107], a[68:71], v[80:83]
    v_mfma_f32_16x16x32_bf16 v[80:83], v[108:111], a[16:19], v[80:83]
    ds_read_b128 a[44:47], v6 offset:1760
    v_mfma_f32_16x16x32_bf16 v[52:55], v[104:107], a[16:19], v[52:55]
    v_mfma_f32_16x16x32_bf16 v[24:27], v[100:103], a[16:19], v[24:27]
    ds_read_b128 a[96:99], v6 offset:1824
    v_mfma_f32_16x16x32_bf16 v[20:23], v[100:103], a[12:15], v[20:23]
    v_mfma_f32_16x16x32_bf16 v[48:51], v[104:107], a[12:15], v[48:51]
    ds_read_b128 a[40:43], v6 offset:1600
    v_mfma_f32_16x16x32_bf16 v[76:79], v[108:111], a[12:15], v[76:79]
    v_mfma_f32_16x16x32_bf16 v[76:79], v[104:107], a[64:67], v[76:79]
    ds_read_b128 a[92:95], v6 offset:1664
    v_mfma_f32_16x16x32_bf16 v[48:51], v[176:179], a[64:67], v[48:51]
    v_mfma_f32_16x16x32_bf16 v[20:23], v[96:99], a[64:67], v[20:23]
    v_mfma_f32_16x16x32_bf16 v[16:19], v[96:99], a[60:63], v[16:19]
    v_mfma_f32_16x16x32_bf16 v[44:47], v[176:179], a[60:63], v[44:47]
    v_mfma_f32_16x16x32_bf16 v[72:75], v[104:107], a[60:63], v[72:75]
    v_mfma_f32_16x16x32_bf16 v[72:75], v[108:111], a[8:11], v[72:75]
    v_xor_b32 v180, 0x80008000, v124
    v_mfma_f32_16x16x32_bf16 v[44:47], v[104:107], a[8:11], v[44:47]
    v_mfma_f32_16x16x32_bf16 v[16:19], v[100:103], a[8:11], v[16:19]
    v_xor_b32 v181, 0x80008000, v125
    s_waitcnt lgkmcnt(9)
    v_mfma_f32_16x16x32_bf16 v[12:15], v[100:103], a[4:7], v[12:15]
    v_mfma_f32_16x16x32_bf16 v[40:43], v[104:107], a[4:7], v[40:43]
    v_xor_b32 v182, 0x80008000, v126
    v_mfma_f32_16x16x32_bf16 v[68:71], v[108:111], a[4:7], v[68:71]
    s_waitcnt lgkmcnt(8)
    v_mfma_f32_16x16x32_bf16 v[68:71], v[104:107], a[56:59], v[68:71]
    v_xor_b32 v183, 0x80008000, v127
    v_mfma_f32_16x16x32_bf16 v[40:43], v[176:179], a[56:59], v[40:43]
    v_mfma_f32_16x16x32_bf16 v[12:15], v[96:99], a[56:59], v[12:15]
    v_mfma_f32_16x16x32_bf16 v[36:39], v[116:119], a[24:27], v[36:39]
    s_add_u32 s47, s45, 61440
    v_mfma_f32_16x16x32_bf16 v[64:67], v[120:123], a[24:27], v[64:67]
    buffer_load_dwordx4 v[96:99], v4, s[16:19], s47 offen offset:0
    v_mfma_f32_16x16x32_bf16 v[92:95], v[124:127], a[24:27], v[92:95]
    v_mfma_f32_16x16x32_bf16 v[92:95], v[120:123], a[76:79], v[92:95]
    v_mfma_f32_16x16x32_bf16 v[64:67], v[180:183], a[76:79], v[64:67]
    buffer_load_dwordx4 v[100:103], v4, s[16:19], s47 offen offset:1024
    v_mfma_f32_16x16x32_bf16 v[36:39], v[112:115], a[76:79], v[36:39]
    v_mfma_f32_16x16x32_bf16 v[32:35], v[112:115], a[72:75], v[32:35]
    v_mfma_f32_16x16x32_bf16 v[60:63], v[180:183], a[72:75], v[60:63]
    buffer_load_dwordx4 v[104:107], v4, s[16:19], s47 offen offset:2048
    v_mfma_f32_16x16x32_bf16 v[88:91], v[120:123], a[72:75], v[88:91]
    v_mfma_f32_16x16x32_bf16 v[88:91], v[124:127], a[20:23], v[88:91]
    v_mfma_f32_16x16x32_bf16 v[60:63], v[120:123], a[20:23], v[60:63]
    buffer_load_dwordx4 v[108:111], v4, s[16:19], s47 offen offset:3072
    v_mfma_f32_16x16x32_bf16 v[32:35], v[116:119], a[20:23], v[32:35]
    v_mfma_f32_16x16x32_bf16 v[28:31], v[116:119], a[16:19], v[28:31]
    v_mfma_f32_16x16x32_bf16 v[56:59], v[120:123], a[16:19], v[56:59]
    ds_read_b128 a[36:39], v6 offset:1440
    v_mfma_f32_16x16x32_bf16 v[84:87], v[124:127], a[16:19], v[84:87]
    v_mfma_f32_16x16x32_bf16 v[84:87], v[120:123], a[68:71], v[84:87]
    ds_read_b128 a[88:91], v6 offset:1504
    v_mfma_f32_16x16x32_bf16 v[56:59], v[180:183], a[68:71], v[56:59]
    v_mfma_f32_16x16x32_bf16 v[28:31], v[112:115], a[68:71], v[28:31]
    ds_read_b128 a[32:35], v6 offset:1280
    v_mfma_f32_16x16x32_bf16 v[24:27], v[112:115], a[64:67], v[24:27]
    v_mfma_f32_16x16x32_bf16 v[52:55], v[180:183], a[64:67], v[52:55]
    ds_read_b128 a[84:87], v6 offset:1344
    v_mfma_f32_16x16x32_bf16 v[80:83], v[120:123], a[64:67], v[80:83]
    v_mfma_f32_16x16x32_bf16 v[80:83], v[124:127], a[12:15], v[80:83]
    ds_read_b128 a[28:31], v6 offset:1120
    v_mfma_f32_16x16x32_bf16 v[52:55], v[120:123], a[12:15], v[52:55]
    v_mfma_f32_16x16x32_bf16 v[24:27], v[116:119], a[12:15], v[24:27]
    ds_read_b128 a[80:83], v6 offset:1184
    v_mfma_f32_16x16x32_bf16 v[20:23], v[116:119], a[8:11], v[20:23]
    v_mfma_f32_16x16x32_bf16 v[48:51], v[120:123], a[8:11], v[48:51]
    ds_read_b128 a[24:27], v6 offset:960
    v_mfma_f32_16x16x32_bf16 v[76:79], v[124:127], a[8:11], v[76:79]
    v_mfma_f32_16x16x32_bf16 v[76:79], v[120:123], a[60:63], v[76:79]
    ds_read_b128 a[76:79], v6 offset:1024
    v_mfma_f32_16x16x32_bf16 v[48:51], v[180:183], a[60:63], v[48:51]
    v_mfma_f32_16x16x32_bf16 v[20:23], v[112:115], a[60:63], v[20:23]
    v_mfma_f32_16x16x32_bf16 v[16:19], v[112:115], a[56:59], v[16:19]
    v_mfma_f32_16x16x32_bf16 v[44:47], v[180:183], a[56:59], v[44:47]
    v_mfma_f32_16x16x32_bf16 v[72:75], v[120:123], a[56:59], v[72:75]
    v_mfma_f32_16x16x32_bf16 v[72:75], v[124:127], a[4:7], v[72:75]
    v_mfma_f32_16x16x32_bf16 v[44:47], v[120:123], a[4:7], v[44:47]
    v_mfma_f32_16x16x32_bf16 v[16:19], v[116:119], a[4:7], v[16:19]
    s_waitcnt lgkmcnt(15)
    v_mfma_f32_16x16x32_bf16 v[12:15], v[116:119], a[0:3], v[12:15]
    v_xor_b32 v184, 0x80008000, v140
    v_mfma_f32_16x16x32_bf16 v[40:43], v[120:123], a[0:3], v[40:43]
    v_xor_b32 v185, 0x80008000, v141
    v_mfma_f32_16x16x32_bf16 v[68:71], v[124:127], a[0:3], v[68:71]
    v_xor_b32 v186, 0x80008000, v142
    s_waitcnt lgkmcnt(14)
    v_mfma_f32_16x16x32_bf16 v[68:71], v[120:123], a[52:55], v[68:71]
    v_xor_b32 v187, 0x80008000, v143
    v_mfma_f32_16x16x32_bf16 v[40:43], v[180:183], a[52:55], v[40:43]
    v_mfma_f32_16x16x32_bf16 v[12:15], v[112:115], a[52:55], v[12:15]
    s_waitcnt lgkmcnt(13)
    v_mfma_f32_16x16x32_bf16 v[36:39], v[132:135], a[48:51], v[36:39]
    s_add_u32 s47, s45, 67584
    v_mfma_f32_16x16x32_bf16 v[64:67], v[136:139], a[48:51], v[64:67]
    buffer_load_dwordx4 v[112:115], v4, s[16:19], s47 offen offset:0
    v_mfma_f32_16x16x32_bf16 v[92:95], v[140:143], a[48:51], v[92:95]
    s_waitcnt lgkmcnt(12)
    v_mfma_f32_16x16x32_bf16 v[92:95], v[136:139], a[100:103], v[92:95]
    v_mfma_f32_16x16x32_bf16 v[64:67], v[184:187], a[100:103], v[64:67]
    buffer_load_dwordx4 v[116:119], v4, s[16:19], s47 offen offset:1024
    v_mfma_f32_16x16x32_bf16 v[36:39], v[128:131], a[100:103], v[36:39]
    s_waitcnt lgkmcnt(10)
    v_mfma_f32_16x16x32_bf16 v[32:35], v[128:131], a[96:99], v[32:35]
    v_mfma_f32_16x16x32_bf16 v[60:63], v[184:187], a[96:99], v[60:63]
    buffer_load_dwordx4 v[120:123], v4, s[16:19], s47 offen offset:2048
    v_mfma_f32_16x16x32_bf16 v[88:91], v[136:139], a[96:99], v[88:91]
    v_mfma_f32_16x16x32_bf16 v[88:91], v[140:143], a[44:47], v[88:91]
    v_mfma_f32_16x16x32_bf16 v[60:63], v[136:139], a[44:47], v[60:63]
    buffer_load_dwordx4 v[124:127], v4, s[16:19], s47 offen offset:3072
    v_mfma_f32_16x16x32_bf16 v[32:35], v[132:135], a[44:47], v[32:35]
    s_waitcnt lgkmcnt(9)
    v_mfma_f32_16x16x32_bf16 v[28:31], v[132:135], a[40:43], v[28:31]
    v_mfma_f32_16x16x32_bf16 v[56:59], v[136:139], a[40:43], v[56:59]
    ds_read_b128 a[20:23], v6 offset:800
    v_mfma_f32_16x16x32_bf16 v[84:87], v[140:143], a[40:43], v[84:87]
    s_waitcnt lgkmcnt(9)
    v_mfma_f32_16x16x32_bf16 v[84:87], v[136:139], a[92:95], v[84:87]
    ds_read_b128 a[72:75], v6 offset:864
    v_mfma_f32_16x16x32_bf16 v[56:59], v[184:187], a[92:95], v[56:59]
    v_mfma_f32_16x16x32_bf16 v[28:31], v[128:131], a[92:95], v[28:31]
    s_add_u32 m0, s42, 76800
    s_add_u32 s46, s44, 8192
    s_mov_b64 exec, s[40:41]
    buffer_load_dwordx4 v3, s[12:15], s46 offen lds
    s_mov_b64 exec, -1
    s_waitcnt lgkmcnt(8)
    v_mfma_f32_16x16x32_bf16 v[24:27], v[128:131], a[88:91], v[24:27]
    v_mfma_f32_16x16x32_bf16 v[52:55], v[184:187], a[88:91], v[52:55]
    v_mfma_f32_16x16x32_bf16 v[80:83], v[136:139], a[88:91], v[80:83]
    s_add_u32 m0, s42, 80640
    s_add_u32 s46, s43, 8192
    s_mov_b64 exec, s[40:41]
    buffer_load_dwordx4 v3, s[12:15], s46 offen lds
    s_mov_b64 exec, -1
    v_mfma_f32_16x16x32_bf16 v[80:83], v[140:143], a[36:39], v[80:83]
    v_mfma_f32_16x16x32_bf16 v[52:55], v[136:139], a[36:39], v[52:55]
    v_mfma_f32_16x16x32_bf16 v[24:27], v[132:135], a[36:39], v[24:27]
    s_add_u32 m0, s42, 84480
    s_add_u32 s46, s43, 1187840
    s_mov_b64 exec, s[40:41]
    buffer_load_dwordx4 v3, s[12:15], s46 offen lds
    s_mov_b64 exec, -1
    s_waitcnt lgkmcnt(7)
    v_mfma_f32_16x16x32_bf16 v[20:23], v[132:135], a[32:35], v[20:23]
    v_mfma_f32_16x16x32_bf16 v[48:51], v[136:139], a[32:35], v[48:51]
    v_mfma_f32_16x16x32_bf16 v[76:79], v[140:143], a[32:35], v[76:79]
    s_waitcnt lgkmcnt(6)
    v_mfma_f32_16x16x32_bf16 v[76:79], v[136:139], a[84:87], v[76:79]
    v_mfma_f32_16x16x32_bf16 v[48:51], v[184:187], a[84:87], v[48:51]
    v_mfma_f32_16x16x32_bf16 v[20:23], v[128:131], a[84:87], v[20:23]
    s_waitcnt lgkmcnt(4)
    v_mfma_f32_16x16x32_bf16 v[16:19], v[128:131], a[80:83], v[16:19]
    v_mfma_f32_16x16x32_bf16 v[44:47], v[184:187], a[80:83], v[44:47]
    v_mfma_f32_16x16x32_bf16 v[72:75], v[136:139], a[80:83], v[72:75]
    v_mfma_f32_16x16x32_bf16 v[72:75], v[140:143], a[28:31], v[72:75]
    s_waitcnt vmcnt(15)
    v_xor_b32 v188, 0x80008000, v156
    v_mfma_f32_16x16x32_bf16 v[44:47], v[136:139], a[28:31], v[44:47]
    v_mfma_f32_16x16x32_bf16 v[16:19], v[132:135], a[28:31], v[16:19]
    v_xor_b32 v189, 0x80008000, v157
    s_waitcnt lgkmcnt(3)
    v_mfma_f32_16x16x32_bf16 v[12:15], v[132:135], a[24:27], v[12:15]
    v_mfma_f32_16x16x32_bf16 v[40:43], v[136:139], a[24:27], v[40:43]
    v_xor_b32 v190, 0x80008000, v158
    v_mfma_f32_16x16x32_bf16 v[68:71], v[140:143], a[24:27], v[68:71]
    s_waitcnt lgkmcnt(2)
    v_mfma_f32_16x16x32_bf16 v[68:71], v[136:139], a[76:79], v[68:71]
    v_xor_b32 v191, 0x80008000, v159
    v_mfma_f32_16x16x32_bf16 v[40:43], v[184:187], a[76:79], v[40:43]
    v_mfma_f32_16x16x32_bf16 v[12:15], v[128:131], a[76:79], v[12:15]
    v_mfma_f32_16x16x32_bf16 v[36:39], v[148:151], a[44:47], v[36:39]
    s_add_u32 s47, s45, 73728
    v_mfma_f32_16x16x32_bf16 v[64:67], v[152:155], a[44:47], v[64:67]
    buffer_load_dwordx4 v[128:131], v4, s[16:19], s47 offen offset:0
    v_mfma_f32_16x16x32_bf16 v[92:95], v[156:159], a[44:47], v[92:95]
    v_mfma_f32_16x16x32_bf16 v[92:95], v[152:155], a[96:99], v[92:95]
    v_mfma_f32_16x16x32_bf16 v[64:67], v[188:191], a[96:99], v[64:67]
    buffer_load_dwordx4 v[132:135], v4, s[16:19], s47 offen offset:1024
    v_mfma_f32_16x16x32_bf16 v[36:39], v[144:147], a[96:99], v[36:39]
    v_mfma_f32_16x16x32_bf16 v[32:35], v[144:147], a[92:95], v[32:35]
    v_mfma_f32_16x16x32_bf16 v[60:63], v[188:191], a[92:95], v[60:63]
    buffer_load_dwordx4 v[136:139], v4, s[16:19], s47 offen offset:2048
    v_mfma_f32_16x16x32_bf16 v[88:91], v[152:155], a[92:95], v[88:91]
    v_mfma_f32_16x16x32_bf16 v[88:91], v[156:159], a[40:43], v[88:91]
    v_mfma_f32_16x16x32_bf16 v[60:63], v[152:155], a[40:43], v[60:63]
    buffer_load_dwordx4 v[140:143], v4, s[16:19], s47 offen offset:3072
    v_mfma_f32_16x16x32_bf16 v[32:35], v[148:151], a[40:43], v[32:35]
    v_mfma_f32_16x16x32_bf16 v[28:31], v[148:151], a[36:39], v[28:31]
    v_mfma_f32_16x16x32_bf16 v[56:59], v[152:155], a[36:39], v[56:59]
    ds_read_b128 a[16:19], v6 offset:640
    v_mfma_f32_16x16x32_bf16 v[84:87], v[156:159], a[36:39], v[84:87]
    v_mfma_f32_16x16x32_bf16 v[84:87], v[152:155], a[88:91], v[84:87]
    ds_read_b128 a[68:71], v6 offset:704
    v_mfma_f32_16x16x32_bf16 v[56:59], v[188:191], a[88:91], v[56:59]
    v_mfma_f32_16x16x32_bf16 v[28:31], v[144:147], a[88:91], v[28:31]
    s_add_u32 m0, s42, 88320
    s_add_u32 s46, s43, 2367488
    s_mov_b64 exec, s[40:41]
    buffer_load_dwordx4 v3, s[12:15], s46 offen lds
    s_mov_b64 exec, -1
    v_mfma_f32_16x16x32_bf16 v[24:27], v[144:147], a[84:87], v[24:27]
    v_mfma_f32_16x16x32_bf16 v[52:55], v[188:191], a[84:87], v[52:55]
    v_mfma_f32_16x16x32_bf16 v[80:83], v[152:155], a[84:87], v[80:83]
    s_add_u32 m0, s42, 92160
    s_add_u32 s46, s43, 3547136
    s_mov_b64 exec, s[40:41]
    buffer_load_dwordx4 v3, s[12:15], s46 offen lds
    s_mov_b64 exec, -1
    v_mfma_f32_16x16x32_bf16 v[80:83], v[156:159], a[32:35], v[80:83]
    v_mfma_f32_16x16x32_bf16 v[52:55], v[152:155], a[32:35], v[52:55]
    v_mfma_f32_16x16x32_bf16 v[24:27], v[148:151], a[32:35], v[24:27]
    s_add_u32 m0, s42, 96000
    s_add_u32 s46, s43, 4726784
    s_mov_b64 exec, s[40:41]
    buffer_load_dwordx4 v3, s[12:15], s46 offen lds
    s_mov_b64 exec, -1
    v_mfma_f32_16x16x32_bf16 v[20:23], v[148:151], a[28:31], v[20:23]
    v_mfma_f32_16x16x32_bf16 v[48:51], v[152:155], a[28:31], v[48:51]
    v_mfma_f32_16x16x32_bf16 v[76:79], v[156:159], a[28:31], v[76:79]
    v_mfma_f32_16x16x32_bf16 v[76:79], v[152:155], a[80:83], v[76:79]
    v_mfma_f32_16x16x32_bf16 v[48:51], v[188:191], a[80:83], v[48:51]
    v_mfma_f32_16x16x32_bf16 v[20:23], v[144:147], a[80:83], v[20:23]
    v_mfma_f32_16x16x32_bf16 v[16:19], v[144:147], a[76:79], v[16:19]
    v_mfma_f32_16x16x32_bf16 v[44:47], v[188:191], a[76:79], v[44:47]
    v_mfma_f32_16x16x32_bf16 v[72:75], v[152:155], a[76:79], v[72:75]
    v_mfma_f32_16x16x32_bf16 v[72:75], v[156:159], a[24:27], v[72:75]
    s_waitcnt vmcnt(18)
    v_xor_b32 v192, 0x80008000, v172
    v_mfma_f32_16x16x32_bf16 v[44:47], v[152:155], a[24:27], v[44:47]
    v_mfma_f32_16x16x32_bf16 v[16:19], v[148:151], a[24:27], v[16:19]
    v_xor_b32 v193, 0x80008000, v173
    s_waitcnt lgkmcnt(3)
    v_mfma_f32_16x16x32_bf16 v[12:15], v[148:151], a[20:23], v[12:15]
    v_mfma_f32_16x16x32_bf16 v[40:43], v[152:155], a[20:23], v[40:43]
    v_xor_b32 v194, 0x80008000, v174
    v_mfma_f32_16x16x32_bf16 v[68:71], v[156:159], a[20:23], v[68:71]
    s_waitcnt lgkmcnt(2)
    v_mfma_f32_16x16x32_bf16 v[68:71], v[152:155], a[72:75], v[68:71]
    v_xor_b32 v195, 0x80008000, v175
    v_mfma_f32_16x16x32_bf16 v[40:43], v[188:191], a[72:75], v[40:43]
    v_mfma_f32_16x16x32_bf16 v[12:15], v[144:147], a[72:75], v[12:15]
    v_mfma_f32_16x16x32_bf16 v[36:39], v[164:167], a[40:43], v[36:39]
    s_add_u32 s47, s45, 79872
    v_mfma_f32_16x16x32_bf16 v[64:67], v[168:171], a[40:43], v[64:67]
    buffer_load_dwordx4 v[144:147], v4, s[16:19], s47 offen offset:0
    v_mfma_f32_16x16x32_bf16 v[92:95], v[172:175], a[40:43], v[92:95]
    v_mfma_f32_16x16x32_bf16 v[92:95], v[168:171], a[92:95], v[92:95]
    v_mfma_f32_16x16x32_bf16 v[64:67], v[192:195], a[92:95], v[64:67]
    buffer_load_dwordx4 v[148:151], v4, s[16:19], s47 offen offset:1024
    v_mfma_f32_16x16x32_bf16 v[36:39], v[160:163], a[92:95], v[36:39]
    v_mfma_f32_16x16x32_bf16 v[32:35], v[160:163], a[88:91], v[32:35]
    v_mfma_f32_16x16x32_bf16 v[60:63], v[192:195], a[88:91], v[60:63]
    buffer_load_dwordx4 v[152:155], v4, s[16:19], s47 offen offset:2048
    v_mfma_f32_16x16x32_bf16 v[88:91], v[168:171], a[88:91], v[88:91]
    v_mfma_f32_16x16x32_bf16 v[88:91], v[172:175], a[36:39], v[88:91]
    v_mfma_f32_16x16x32_bf16 v[60:63], v[168:171], a[36:39], v[60:63]
    buffer_load_dwordx4 v[156:159], v4, s[16:19], s47 offen offset:3072
    v_mfma_f32_16x16x32_bf16 v[32:35], v[164:167], a[36:39], v[32:35]
    v_mfma_f32_16x16x32_bf16 v[28:31], v[164:167], a[32:35], v[28:31]
    v_mfma_f32_16x16x32_bf16 v[56:59], v[168:171], a[32:35], v[56:59]
    ds_read_b128 a[12:15], v6 offset:480
    v_mfma_f32_16x16x32_bf16 v[84:87], v[172:175], a[32:35], v[84:87]
    v_mfma_f32_16x16x32_bf16 v[84:87], v[168:171], a[84:87], v[84:87]
    ds_read_b128 a[64:67], v6 offset:544
    v_mfma_f32_16x16x32_bf16 v[56:59], v[192:195], a[84:87], v[56:59]
    v_mfma_f32_16x16x32_bf16 v[28:31], v[160:163], a[84:87], v[28:31]
    s_add_u32 m0, s42, 99840
    s_add_u32 s46, s43, 5906432
    s_mov_b64 exec, s[40:41]
    buffer_load_dwordx4 v3, s[12:15], s46 offen lds
    s_mov_b64 exec, -1
    v_mfma_f32_16x16x32_bf16 v[24:27], v[160:163], a[80:83], v[24:27]
    v_mfma_f32_16x16x32_bf16 v[52:55], v[192:195], a[80:83], v[52:55]
    v_mfma_f32_16x16x32_bf16 v[80:83], v[168:171], a[80:83], v[80:83]
    s_add_u32 m0, s42, 103680
    s_add_u32 s46, s43, 7086080
    s_mov_b64 exec, s[40:41]
    buffer_load_dwordx4 v3, s[12:15], s46 offen lds
    s_mov_b64 exec, -1
    v_mfma_f32_16x16x32_bf16 v[80:83], v[172:175], a[28:31], v[80:83]
    v_mfma_f32_16x16x32_bf16 v[52:55], v[168:171], a[28:31], v[52:55]
    v_mfma_f32_16x16x32_bf16 v[24:27], v[164:167], a[28:31], v[24:27]
    v_mfma_f32_16x16x32_bf16 v[20:23], v[164:167], a[24:27], v[20:23]
    v_mfma_f32_16x16x32_bf16 v[48:51], v[168:171], a[24:27], v[48:51]
    v_mfma_f32_16x16x32_bf16 v[76:79], v[172:175], a[24:27], v[76:79]
    v_mfma_f32_16x16x32_bf16 v[76:79], v[168:171], a[76:79], v[76:79]
    v_mfma_f32_16x16x32_bf16 v[48:51], v[192:195], a[76:79], v[48:51]
    v_mfma_f32_16x16x32_bf16 v[20:23], v[160:163], a[76:79], v[20:23]
    v_mfma_f32_16x16x32_bf16 v[16:19], v[160:163], a[72:75], v[16:19]
    v_mfma_f32_16x16x32_bf16 v[44:47], v[192:195], a[72:75], v[44:47]
    v_mfma_f32_16x16x32_bf16 v[72:75], v[168:171], a[72:75], v[72:75]
    v_mfma_f32_16x16x32_bf16 v[72:75], v[172:175], a[20:23], v[72:75]
    s_waitcnt vmcnt(20)
    v_xor_b32 v176, 0x80008000, v108
    v_mfma_f32_16x16x32_bf16 v[44:47], v[168:171], a[20:23], v[44:47]
    v_mfma_f32_16x16x32_bf16 v[16:19], v[164:167], a[20:23], v[16:19]
    v_xor_b32 v177, 0x80008000, v109
    s_waitcnt lgkmcnt(3)
    v_mfma_f32_16x16x32_bf16 v[12:15], v[164:167], a[16:19], v[12:15]
    v_mfma_f32_16x16x32_bf16 v[40:43], v[168:171], a[16:19], v[40:43]
    v_xor_b32 v178, 0x80008000, v110
    v_mfma_f32_16x16x32_bf16 v[68:71], v[172:175], a[16:19], v[68:71]
    s_waitcnt lgkmcnt(2)
    v_mfma_f32_16x16x32_bf16 v[68:71], v[168:171], a[68:71], v[68:71]
    v_xor_b32 v179, 0x80008000, v111
    v_mfma_f32_16x16x32_bf16 v[40:43], v[192:195], a[68:71], v[40:43]
    v_mfma_f32_16x16x32_bf16 v[12:15], v[160:163], a[68:71], v[12:15]
    v_mfma_f32_16x16x32_bf16 v[36:39], v[100:103], a[36:39], v[36:39]
    s_add_u32 s47, s45, 86016
    v_mfma_f32_16x16x32_bf16 v[64:67], v[104:107], a[36:39], v[64:67]
    buffer_load_dwordx4 v[160:163], v4, s[16:19], s47 offen offset:0
    v_mfma_f32_16x16x32_bf16 v[92:95], v[108:111], a[36:39], v[92:95]
    v_mfma_f32_16x16x32_bf16 v[92:95], v[104:107], a[88:91], v[92:95]
    v_mfma_f32_16x16x32_bf16 v[64:67], v[176:179], a[88:91], v[64:67]
    buffer_load_dwordx4 v[164:167], v4, s[16:19], s47 offen offset:1024
    v_mfma_f32_16x16x32_bf16 v[36:39], v[96:99], a[88:91], v[36:39]
    v_mfma_f32_16x16x32_bf16 v[32:35], v[96:99], a[84:87], v[32:35]
    v_mfma_f32_16x16x32_bf16 v[60:63], v[176:179], a[84:87], v[60:63]
    buffer_load_dwordx4 v[168:171], v4, s[16:19], s47 offen offset:2048
    v_mfma_f32_16x16x32_bf16 v[88:91], v[104:107], a[84:87], v[88:91]
    v_mfma_f32_16x16x32_bf16 v[88:91], v[108:111], a[32:35], v[88:91]
    v_mfma_f32_16x16x32_bf16 v[60:63], v[104:107], a[32:35], v[60:63]
    buffer_load_dwordx4 v[172:175], v4, s[16:19], s47 offen offset:3072
    v_mfma_f32_16x16x32_bf16 v[32:35], v[100:103], a[32:35], v[32:35]
    v_mfma_f32_16x16x32_bf16 v[28:31], v[100:103], a[28:31], v[28:31]
    v_mfma_f32_16x16x32_bf16 v[56:59], v[104:107], a[28:31], v[56:59]
    ds_read_b128 a[8:11], v6 offset:320
    v_mfma_f32_16x16x32_bf16 v[84:87], v[108:111], a[28:31], v[84:87]
    v_mfma_f32_16x16x32_bf16 v[84:87], v[104:107], a[80:83], v[84:87]
    ds_read_b128 a[60:63], v6 offset:384
    v_mfma_f32_16x16x32_bf16 v[56:59], v[176:179], a[80:83], v[56:59]
    v_mfma_f32_16x16x32_bf16 v[28:31], v[96:99], a[80:83], v[28:31]
    s_add_u32 m0, s42, 107520
    s_add_u32 s46, s43, 8265728
    s_mov_b64 exec, s[40:41]
    buffer_load_dwordx4 v3, s[12:15], s46 offen lds
    s_mov_b64 exec, -1
    v_mfma_f32_16x16x32_bf16 v[24:27], v[96:99], a[76:79], v[24:27]
    v_mfma_f32_16x16x32_bf16 v[52:55], v[176:179], a[76:79], v[52:55]
    v_mfma_f32_16x16x32_bf16 v[80:83], v[104:107], a[76:79], v[80:83]
    s_add_u32 m0, s42, 111360
    s_add_u32 s46, s43, 9445376
    s_mov_b64 exec, s[40:41]
    buffer_load_dwordx4 v3, s[12:15], s46 offen lds
    s_mov_b64 exec, -1
    v_mfma_f32_16x16x32_bf16 v[80:83], v[108:111], a[24:27], v[80:83]
    v_mfma_f32_16x16x32_bf16 v[52:55], v[104:107], a[24:27], v[52:55]
    v_mfma_f32_16x16x32_bf16 v[24:27], v[100:103], a[24:27], v[24:27]
    v_mfma_f32_16x16x32_bf16 v[20:23], v[100:103], a[20:23], v[20:23]
    v_mfma_f32_16x16x32_bf16 v[48:51], v[104:107], a[20:23], v[48:51]
    v_mfma_f32_16x16x32_bf16 v[76:79], v[108:111], a[20:23], v[76:79]
    v_mfma_f32_16x16x32_bf16 v[76:79], v[104:107], a[72:75], v[76:79]
    v_mfma_f32_16x16x32_bf16 v[48:51], v[176:179], a[72:75], v[48:51]
    v_mfma_f32_16x16x32_bf16 v[20:23], v[96:99], a[72:75], v[20:23]
    v_mfma_f32_16x16x32_bf16 v[16:19], v[96:99], a[68:71], v[16:19]
    v_mfma_f32_16x16x32_bf16 v[44:47], v[176:179], a[68:71], v[44:47]
    v_mfma_f32_16x16x32_bf16 v[72:75], v[104:107], a[68:71], v[72:75]
    v_mfma_f32_16x16x32_bf16 v[72:75], v[108:111], a[16:19], v[72:75]
    s_waitcnt vmcnt(22)
    v_xor_b32 v180, 0x80008000, v124
    v_mfma_f32_16x16x32_bf16 v[44:47], v[104:107], a[16:19], v[44:47]
    v_mfma_f32_16x16x32_bf16 v[16:19], v[100:103], a[16:19], v[16:19]
    v_xor_b32 v181, 0x80008000, v125
    s_waitcnt lgkmcnt(3)
    v_mfma_f32_16x16x32_bf16 v[12:15], v[100:103], a[12:15], v[12:15]
    v_mfma_f32_16x16x32_bf16 v[40:43], v[104:107], a[12:15], v[40:43]
    v_xor_b32 v182, 0x80008000, v126
    v_mfma_f32_16x16x32_bf16 v[68:71], v[108:111], a[12:15], v[68:71]
    s_waitcnt lgkmcnt(2)
    v_mfma_f32_16x16x32_bf16 v[68:71], v[104:107], a[64:67], v[68:71]
    v_xor_b32 v183, 0x80008000, v127
    v_mfma_f32_16x16x32_bf16 v[40:43], v[176:179], a[64:67], v[40:43]
    v_mfma_f32_16x16x32_bf16 v[12:15], v[96:99], a[64:67], v[12:15]
    v_mfma_f32_16x16x32_bf16 v[36:39], v[116:119], a[32:35], v[36:39]
    s_add_u32 s47, s45, 92160
    v_mfma_f32_16x16x32_bf16 v[64:67], v[120:123], a[32:35], v[64:67]
    buffer_load_dwordx4 v[96:99], v4, s[16:19], s47 offen offset:0
    v_mfma_f32_16x16x32_bf16 v[92:95], v[124:127], a[32:35], v[92:95]
    v_mfma_f32_16x16x32_bf16 v[92:95], v[120:123], a[84:87], v[92:95]
    v_mfma_f32_16x16x32_bf16 v[64:67], v[180:183], a[84:87], v[64:67]
    buffer_load_dwordx4 v[100:103], v4, s[16:19], s47 offen offset:1024
    v_mfma_f32_16x16x32_bf16 v[36:39], v[112:115], a[84:87], v[36:39]
    v_mfma_f32_16x16x32_bf16 v[32:35], v[112:115], a[80:83], v[32:35]
    v_mfma_f32_16x16x32_bf16 v[60:63], v[180:183], a[80:83], v[60:63]
    buffer_load_dwordx4 v[104:107], v4, s[16:19], s47 offen offset:2048
    v_mfma_f32_16x16x32_bf16 v[88:91], v[120:123], a[80:83], v[88:91]
    v_mfma_f32_16x16x32_bf16 v[88:91], v[124:127], a[28:31], v[88:91]
    v_mfma_f32_16x16x32_bf16 v[60:63], v[120:123], a[28:31], v[60:63]
    buffer_load_dwordx4 v[108:111], v4, s[16:19], s47 offen offset:3072
    v_mfma_f32_16x16x32_bf16 v[32:35], v[116:119], a[28:31], v[32:35]
    v_mfma_f32_16x16x32_bf16 v[28:31], v[116:119], a[24:27], v[28:31]
    v_mfma_f32_16x16x32_bf16 v[56:59], v[120:123], a[24:27], v[56:59]
    ds_read_b128 a[4:7], v6 offset:160
    v_mfma_f32_16x16x32_bf16 v[84:87], v[124:127], a[24:27], v[84:87]
    v_mfma_f32_16x16x32_bf16 v[84:87], v[120:123], a[76:79], v[84:87]
    ds_read_b128 a[56:59], v6 offset:224
    v_mfma_f32_16x16x32_bf16 v[56:59], v[180:183], a[76:79], v[56:59]
    v_mfma_f32_16x16x32_bf16 v[28:31], v[112:115], a[76:79], v[28:31]
    v_mfma_f32_16x16x32_bf16 v[24:27], v[112:115], a[72:75], v[24:27]
    v_mfma_f32_16x16x32_bf16 v[52:55], v[180:183], a[72:75], v[52:55]
    v_mfma_f32_16x16x32_bf16 v[80:83], v[120:123], a[72:75], v[80:83]
    v_mfma_f32_16x16x32_bf16 v[80:83], v[124:127], a[20:23], v[80:83]
    v_mfma_f32_16x16x32_bf16 v[52:55], v[120:123], a[20:23], v[52:55]
    v_mfma_f32_16x16x32_bf16 v[24:27], v[116:119], a[20:23], v[24:27]
    v_mfma_f32_16x16x32_bf16 v[20:23], v[116:119], a[16:19], v[20:23]
    v_mfma_f32_16x16x32_bf16 v[48:51], v[120:123], a[16:19], v[48:51]
    v_mfma_f32_16x16x32_bf16 v[76:79], v[124:127], a[16:19], v[76:79]
    v_mfma_f32_16x16x32_bf16 v[76:79], v[120:123], a[68:71], v[76:79]
    v_mfma_f32_16x16x32_bf16 v[48:51], v[180:183], a[68:71], v[48:51]
    v_mfma_f32_16x16x32_bf16 v[20:23], v[112:115], a[68:71], v[20:23]
    v_mfma_f32_16x16x32_bf16 v[16:19], v[112:115], a[64:67], v[16:19]
    v_mfma_f32_16x16x32_bf16 v[44:47], v[180:183], a[64:67], v[44:47]
    v_mfma_f32_16x16x32_bf16 v[72:75], v[120:123], a[64:67], v[72:75]
    v_mfma_f32_16x16x32_bf16 v[72:75], v[124:127], a[12:15], v[72:75]
    s_waitcnt vmcnt(19)
    v_xor_b32 v184, 0x80008000, v140
    v_mfma_f32_16x16x32_bf16 v[44:47], v[120:123], a[12:15], v[44:47]
    v_mfma_f32_16x16x32_bf16 v[16:19], v[116:119], a[12:15], v[16:19]
    v_xor_b32 v185, 0x80008000, v141
    s_waitcnt lgkmcnt(3)
    v_mfma_f32_16x16x32_bf16 v[12:15], v[116:119], a[8:11], v[12:15]
    v_mfma_f32_16x16x32_bf16 v[40:43], v[120:123], a[8:11], v[40:43]
    v_xor_b32 v186, 0x80008000, v142
    v_mfma_f32_16x16x32_bf16 v[68:71], v[124:127], a[8:11], v[68:71]
    s_waitcnt lgkmcnt(2)
    v_mfma_f32_16x16x32_bf16 v[68:71], v[120:123], a[60:63], v[68:71]
    v_xor_b32 v187, 0x80008000, v143
    v_mfma_f32_16x16x32_bf16 v[40:43], v[180:183], a[60:63], v[40:43]
    v_mfma_f32_16x16x32_bf16 v[12:15], v[112:115], a[60:63], v[12:15]
    v_mfma_f32_16x16x32_bf16 v[36:39], v[132:135], a[28:31], v[36:39]
    s_add_u32 s47, s45, 98304
    v_mfma_f32_16x16x32_bf16 v[64:67], v[136:139], a[28:31], v[64:67]
    buffer_load_dwordx4 v[112:115], v4, s[16:19], s47 offen offset:0
    v_mfma_f32_16x16x32_bf16 v[92:95], v[140:143], a[28:31], v[92:95]
    v_mfma_f32_16x16x32_bf16 v[92:95], v[136:139], a[80:83], v[92:95]
    v_mfma_f32_16x16x32_bf16 v[64:67], v[184:187], a[80:83], v[64:67]
    buffer_load_dwordx4 v[116:119], v4, s[16:19], s47 offen offset:1024
    v_mfma_f32_16x16x32_bf16 v[36:39], v[128:131], a[80:83], v[36:39]
    v_mfma_f32_16x16x32_bf16 v[32:35], v[128:131], a[76:79], v[32:35]
    v_mfma_f32_16x16x32_bf16 v[60:63], v[184:187], a[76:79], v[60:63]
    buffer_load_dwordx4 v[120:123], v4, s[16:19], s47 offen offset:2048
    v_mfma_f32_16x16x32_bf16 v[88:91], v[136:139], a[76:79], v[88:91]
    v_mfma_f32_16x16x32_bf16 v[88:91], v[140:143], a[24:27], v[88:91]
    v_mfma_f32_16x16x32_bf16 v[60:63], v[136:139], a[24:27], v[60:63]
    buffer_load_dwordx4 v[124:127], v4, s[16:19], s47 offen offset:3072
    v_mfma_f32_16x16x32_bf16 v[32:35], v[132:135], a[24:27], v[32:35]
    s_waitcnt vmcnt(8)
    s_barrier
    v_mfma_f32_16x16x32_bf16 v[28:31], v[132:135], a[20:23], v[28:31]
    v_mfma_f32_16x16x32_bf16 v[56:59], v[136:139], a[20:23], v[56:59]
    ds_read_b128 a[0:3], v6 offset:0
    v_mfma_f32_16x16x32_bf16 v[84:87], v[140:143], a[20:23], v[84:87]
    v_mfma_f32_16x16x32_bf16 v[84:87], v[136:139], a[72:75], v[84:87]
    ds_read_b128 a[52:55], v6 offset:64
    v_mfma_f32_16x16x32_bf16 v[56:59], v[184:187], a[72:75], v[56:59]
    v_mfma_f32_16x16x32_bf16 v[28:31], v[128:131], a[72:75], v[28:31]
    ds_read_b128 a[48:51], v7 offset:1920
    v_mfma_f32_16x16x32_bf16 v[24:27], v[128:131], a[68:71], v[24:27]
    v_mfma_f32_16x16x32_bf16 v[52:55], v[184:187], a[68:71], v[52:55]
    ds_read_b128 a[100:103], v7 offset:1984
    v_mfma_f32_16x16x32_bf16 v[80:83], v[136:139], a[68:71], v[80:83]
    v_mfma_f32_16x16x32_bf16 v[80:83], v[140:143], a[16:19], v[80:83]
    ds_read_b128 a[44:47], v7 offset:1760
    v_mfma_f32_16x16x32_bf16 v[52:55], v[136:139], a[16:19], v[52:55]
    v_mfma_f32_16x16x32_bf16 v[24:27], v[132:135], a[16:19], v[24:27]
    ds_read_b128 a[96:99], v7 offset:1824
    v_mfma_f32_16x16x32_bf16 v[20:23], v[132:135], a[12:15], v[20:23]
    v_mfma_f32_16x16x32_bf16 v[48:51], v[136:139], a[12:15], v[48:51]
    ds_read_b128 a[40:43], v7 offset:1600
    v_mfma_f32_16x16x32_bf16 v[76:79], v[140:143], a[12:15], v[76:79]
    v_mfma_f32_16x16x32_bf16 v[76:79], v[136:139], a[64:67], v[76:79]
    ds_read_b128 a[92:95], v7 offset:1664
    v_mfma_f32_16x16x32_bf16 v[48:51], v[184:187], a[64:67], v[48:51]
    v_mfma_f32_16x16x32_bf16 v[20:23], v[128:131], a[64:67], v[20:23]
    v_mfma_f32_16x16x32_bf16 v[16:19], v[128:131], a[60:63], v[16:19]
    v_mfma_f32_16x16x32_bf16 v[44:47], v[184:187], a[60:63], v[44:47]
    v_mfma_f32_16x16x32_bf16 v[72:75], v[136:139], a[60:63], v[72:75]
    v_mfma_f32_16x16x32_bf16 v[72:75], v[140:143], a[8:11], v[72:75]
    v_xor_b32 v188, 0x80008000, v156
    v_mfma_f32_16x16x32_bf16 v[44:47], v[136:139], a[8:11], v[44:47]
    v_mfma_f32_16x16x32_bf16 v[16:19], v[132:135], a[8:11], v[16:19]
    v_xor_b32 v189, 0x80008000, v157
    s_waitcnt lgkmcnt(9)
    v_mfma_f32_16x16x32_bf16 v[12:15], v[132:135], a[4:7], v[12:15]
    v_mfma_f32_16x16x32_bf16 v[40:43], v[136:139], a[4:7], v[40:43]
    v_xor_b32 v190, 0x80008000, v158
    v_mfma_f32_16x16x32_bf16 v[68:71], v[140:143], a[4:7], v[68:71]
    s_waitcnt lgkmcnt(8)
    v_mfma_f32_16x16x32_bf16 v[68:71], v[136:139], a[56:59], v[68:71]
    v_xor_b32 v191, 0x80008000, v159
    v_mfma_f32_16x16x32_bf16 v[40:43], v[184:187], a[56:59], v[40:43]
    v_mfma_f32_16x16x32_bf16 v[12:15], v[128:131], a[56:59], v[12:15]
    v_mfma_f32_16x16x32_bf16 v[36:39], v[148:151], a[24:27], v[36:39]
    s_add_u32 s47, s45, 104448
    v_mfma_f32_16x16x32_bf16 v[64:67], v[152:155], a[24:27], v[64:67]
    buffer_load_dwordx4 v[128:131], v4, s[16:19], s47 offen offset:0
    v_mfma_f32_16x16x32_bf16 v[92:95], v[156:159], a[24:27], v[92:95]
    v_mfma_f32_16x16x32_bf16 v[92:95], v[152:155], a[76:79], v[92:95]
    v_mfma_f32_16x16x32_bf16 v[64:67], v[188:191], a[76:79], v[64:67]
    buffer_load_dwordx4 v[132:135], v4, s[16:19], s47 offen offset:1024
    v_mfma_f32_16x16x32_bf16 v[36:39], v[144:147], a[76:79], v[36:39]
    v_mfma_f32_16x16x32_bf16 v[32:35], v[144:147], a[72:75], v[32:35]
    v_mfma_f32_16x16x32_bf16 v[60:63], v[188:191], a[72:75], v[60:63]
    buffer_load_dwordx4 v[136:139], v4, s[16:19], s47 offen offset:2048
    v_mfma_f32_16x16x32_bf16 v[88:91], v[152:155], a[72:75], v[88:91]
    v_mfma_f32_16x16x32_bf16 v[88:91], v[156:159], a[20:23], v[88:91]
    v_mfma_f32_16x16x32_bf16 v[60:63], v[152:155], a[20:23], v[60:63]
    buffer_load_dwordx4 v[140:143], v4, s[16:19], s47 offen offset:3072
    v_mfma_f32_16x16x32_bf16 v[32:35], v[148:151], a[20:23], v[32:35]
    v_mfma_f32_16x16x32_bf16 v[28:31], v[148:151], a[16:19], v[28:31]
    v_mfma_f32_16x16x32_bf16 v[56:59], v[152:155], a[16:19], v[56:59]
    ds_read_b128 a[36:39], v7 offset:1440
    v_mfma_f32_16x16x32_bf16 v[84:87], v[156:159], a[16:19], v[84:87]
    v_mfma_f32_16x16x32_bf16 v[84:87], v[152:155], a[68:71], v[84:87]
    ds_read_b128 a[88:91], v7 offset:1504
    v_mfma_f32_16x16x32_bf16 v[56:59], v[188:191], a[68:71], v[56:59]
    v_mfma_f32_16x16x32_bf16 v[28:31], v[144:147], a[68:71], v[28:31]
    ds_read_b128 a[32:35], v7 offset:1280
    v_mfma_f32_16x16x32_bf16 v[24:27], v[144:147], a[64:67], v[24:27]
    v_mfma_f32_16x16x32_bf16 v[52:55], v[188:191], a[64:67], v[52:55]
    ds_read_b128 a[84:87], v7 offset:1344
    v_mfma_f32_16x16x32_bf16 v[80:83], v[152:155], a[64:67], v[80:83]
    v_mfma_f32_16x16x32_bf16 v[80:83], v[156:159], a[12:15], v[80:83]
    ds_read_b128 a[28:31], v7 offset:1120
    v_mfma_f32_16x16x32_bf16 v[52:55], v[152:155], a[12:15], v[52:55]
    v_mfma_f32_16x16x32_bf16 v[24:27], v[148:151], a[12:15], v[24:27]
    ds_read_b128 a[80:83], v7 offset:1184
    v_mfma_f32_16x16x32_bf16 v[20:23], v[148:151], a[8:11], v[20:23]
    v_mfma_f32_16x16x32_bf16 v[48:51], v[152:155], a[8:11], v[48:51]
    ds_read_b128 a[24:27], v7 offset:960
    v_mfma_f32_16x16x32_bf16 v[76:79], v[156:159], a[8:11], v[76:79]
    v_mfma_f32_16x16x32_bf16 v[76:79], v[152:155], a[60:63], v[76:79]
    ds_read_b128 a[76:79], v7 offset:1024
    v_mfma_f32_16x16x32_bf16 v[48:51], v[188:191], a[60:63], v[48:51]
    v_mfma_f32_16x16x32_bf16 v[20:23], v[144:147], a[60:63], v[20:23]
    v_mfma_f32_16x16x32_bf16 v[16:19], v[144:147], a[56:59], v[16:19]
    v_mfma_f32_16x16x32_bf16 v[44:47], v[188:191], a[56:59], v[44:47]
    v_mfma_f32_16x16x32_bf16 v[72:75], v[152:155], a[56:59], v[72:75]
    v_mfma_f32_16x16x32_bf16 v[72:75], v[156:159], a[4:7], v[72:75]
    v_mfma_f32_16x16x32_bf16 v[44:47], v[152:155], a[4:7], v[44:47]
    v_mfma_f32_16x16x32_bf16 v[16:19], v[148:151], a[4:7], v[16:19]
    s_waitcnt lgkmcnt(15)
    v_mfma_f32_16x16x32_bf16 v[12:15], v[148:151], a[0:3], v[12:15]
    v_xor_b32 v192, 0x80008000, v172
    v_mfma_f32_16x16x32_bf16 v[40:43], v[152:155], a[0:3], v[40:43]
    v_xor_b32 v193, 0x80008000, v173
    v_mfma_f32_16x16x32_bf16 v[68:71], v[156:159], a[0:3], v[68:71]
    v_xor_b32 v194, 0x80008000, v174
    s_waitcnt lgkmcnt(14)
    v_mfma_f32_16x16x32_bf16 v[68:71], v[152:155], a[52:55], v[68:71]
    v_xor_b32 v195, 0x80008000, v175
    v_mfma_f32_16x16x32_bf16 v[40:43], v[188:191], a[52:55], v[40:43]
    v_mfma_f32_16x16x32_bf16 v[12:15], v[144:147], a[52:55], v[12:15]
    s_waitcnt lgkmcnt(13)
    v_mfma_f32_16x16x32_bf16 v[36:39], v[164:167], a[48:51], v[36:39]
    s_add_u32 s47, s45, 110592
    v_mfma_f32_16x16x32_bf16 v[64:67], v[168:171], a[48:51], v[64:67]
    buffer_load_dwordx4 v[144:147], v4, s[16:19], s47 offen offset:0
    v_mfma_f32_16x16x32_bf16 v[92:95], v[172:175], a[48:51], v[92:95]
    s_waitcnt lgkmcnt(12)
    v_mfma_f32_16x16x32_bf16 v[92:95], v[168:171], a[100:103], v[92:95]
    v_mfma_f32_16x16x32_bf16 v[64:67], v[192:195], a[100:103], v[64:67]
    buffer_load_dwordx4 v[148:151], v4, s[16:19], s47 offen offset:1024
    v_mfma_f32_16x16x32_bf16 v[36:39], v[160:163], a[100:103], v[36:39]
    s_waitcnt lgkmcnt(10)
    v_mfma_f32_16x16x32_bf16 v[32:35], v[160:163], a[96:99], v[32:35]
    v_mfma_f32_16x16x32_bf16 v[60:63], v[192:195], a[96:99], v[60:63]
    buffer_load_dwordx4 v[152:155], v4, s[16:19], s47 offen offset:2048
    v_mfma_f32_16x16x32_bf16 v[88:91], v[168:171], a[96:99], v[88:91]
    v_mfma_f32_16x16x32_bf16 v[88:91], v[172:175], a[44:47], v[88:91]
    v_mfma_f32_16x16x32_bf16 v[60:63], v[168:171], a[44:47], v[60:63]
    buffer_load_dwordx4 v[156:159], v4, s[16:19], s47 offen offset:3072
    v_mfma_f32_16x16x32_bf16 v[32:35], v[164:167], a[44:47], v[32:35]
    s_waitcnt lgkmcnt(9)
    v_mfma_f32_16x16x32_bf16 v[28:31], v[164:167], a[40:43], v[28:31]
    v_mfma_f32_16x16x32_bf16 v[56:59], v[168:171], a[40:43], v[56:59]
    ds_read_b128 a[20:23], v7 offset:800
    v_mfma_f32_16x16x32_bf16 v[84:87], v[172:175], a[40:43], v[84:87]
    s_waitcnt lgkmcnt(9)
    v_mfma_f32_16x16x32_bf16 v[84:87], v[168:171], a[92:95], v[84:87]
    ds_read_b128 a[72:75], v7 offset:864
    v_mfma_f32_16x16x32_bf16 v[56:59], v[192:195], a[92:95], v[56:59]
    v_mfma_f32_16x16x32_bf16 v[28:31], v[160:163], a[92:95], v[28:31]
    s_waitcnt lgkmcnt(8)
    v_mfma_f32_16x16x32_bf16 v[24:27], v[160:163], a[88:91], v[24:27]
    v_mfma_f32_16x16x32_bf16 v[52:55], v[192:195], a[88:91], v[52:55]
    v_mfma_f32_16x16x32_bf16 v[80:83], v[168:171], a[88:91], v[80:83]
    v_mfma_f32_16x16x32_bf16 v[80:83], v[172:175], a[36:39], v[80:83]
    v_mfma_f32_16x16x32_bf16 v[52:55], v[168:171], a[36:39], v[52:55]
    v_mfma_f32_16x16x32_bf16 v[24:27], v[164:167], a[36:39], v[24:27]
    s_waitcnt lgkmcnt(7)
    v_mfma_f32_16x16x32_bf16 v[20:23], v[164:167], a[32:35], v[20:23]
    v_mfma_f32_16x16x32_bf16 v[48:51], v[168:171], a[32:35], v[48:51]
    v_mfma_f32_16x16x32_bf16 v[76:79], v[172:175], a[32:35], v[76:79]
    s_waitcnt lgkmcnt(6)
    v_mfma_f32_16x16x32_bf16 v[76:79], v[168:171], a[84:87], v[76:79]
    v_mfma_f32_16x16x32_bf16 v[48:51], v[192:195], a[84:87], v[48:51]
    v_mfma_f32_16x16x32_bf16 v[20:23], v[160:163], a[84:87], v[20:23]
    s_waitcnt lgkmcnt(4)
    v_mfma_f32_16x16x32_bf16 v[16:19], v[160:163], a[80:83], v[16:19]
    v_mfma_f32_16x16x32_bf16 v[44:47], v[192:195], a[80:83], v[44:47]
    v_mfma_f32_16x16x32_bf16 v[72:75], v[168:171], a[80:83], v[72:75]
    v_mfma_f32_16x16x32_bf16 v[72:75], v[172:175], a[28:31], v[72:75]
    s_waitcnt vmcnt(12)
    v_xor_b32 v176, 0x80008000, v108
    v_mfma_f32_16x16x32_bf16 v[44:47], v[168:171], a[28:31], v[44:47]
    v_mfma_f32_16x16x32_bf16 v[16:19], v[164:167], a[28:31], v[16:19]
    v_xor_b32 v177, 0x80008000, v109
    s_waitcnt lgkmcnt(3)
    v_mfma_f32_16x16x32_bf16 v[12:15], v[164:167], a[24:27], v[12:15]
    v_mfma_f32_16x16x32_bf16 v[40:43], v[168:171], a[24:27], v[40:43]
    v_xor_b32 v178, 0x80008000, v110
    v_mfma_f32_16x16x32_bf16 v[68:71], v[172:175], a[24:27], v[68:71]
    s_waitcnt lgkmcnt(2)
    v_mfma_f32_16x16x32_bf16 v[68:71], v[168:171], a[76:79], v[68:71]
    v_xor_b32 v179, 0x80008000, v111
    v_mfma_f32_16x16x32_bf16 v[40:43], v[192:195], a[76:79], v[40:43]
    v_mfma_f32_16x16x32_bf16 v[12:15], v[160:163], a[76:79], v[12:15]
    v_mfma_f32_16x16x32_bf16 v[36:39], v[100:103], a[44:47], v[36:39]
    s_add_u32 s47, s45, 116736
    v_mfma_f32_16x16x32_bf16 v[64:67], v[104:107], a[44:47], v[64:67]
    buffer_load_dwordx4 v[160:163], v4, s[16:19], s47 offen offset:0
    v_mfma_f32_16x16x32_bf16 v[92:95], v[108:111], a[44:47], v[92:95]
    v_mfma_f32_16x16x32_bf16 v[92:95], v[104:107], a[96:99], v[92:95]
    v_mfma_f32_16x16x32_bf16 v[64:67], v[176:179], a[96:99], v[64:67]
    buffer_load_dwordx4 v[164:167], v4, s[16:19], s47 offen offset:1024
    v_mfma_f32_16x16x32_bf16 v[36:39], v[96:99], a[96:99], v[36:39]
    v_mfma_f32_16x16x32_bf16 v[32:35], v[96:99], a[92:95], v[32:35]
    v_mfma_f32_16x16x32_bf16 v[60:63], v[176:179], a[92:95], v[60:63]
    buffer_load_dwordx4 v[168:171], v4, s[16:19], s47 offen offset:2048
    v_mfma_f32_16x16x32_bf16 v[88:91], v[104:107], a[92:95], v[88:91]
    v_mfma_f32_16x16x32_bf16 v[88:91], v[108:111], a[40:43], v[88:91]
    v_mfma_f32_16x16x32_bf16 v[60:63], v[104:107], a[40:43], v[60:63]
    buffer_load_dwordx4 v[172:175], v4, s[16:19], s47 offen offset:3072
    v_mfma_f32_16x16x32_bf16 v[32:35], v[100:103], a[40:43], v[32:35]
    v_mfma_f32_16x16x32_bf16 v[28:31], v[100:103], a[36:39], v[28:31]
    v_mfma_f32_16x16x32_bf16 v[56:59], v[104:107], a[36:39], v[56:59]
    ds_read_b128 a[16:19], v7 offset:640
    v_mfma_f32_16x16x32_bf16 v[84:87], v[108:111], a[36:39], v[84:87]
    v_mfma_f32_16x16x32_bf16 v[84:87], v[104:107], a[88:91], v[84:87]
    ds_read_b128 a[68:71], v7 offset:704
    v_mfma_f32_16x16x32_bf16 v[56:59], v[176:179], a[88:91], v[56:59]
    v_mfma_f32_16x16x32_bf16 v[28:31], v[96:99], a[88:91], v[28:31]
    v_mfma_f32_16x16x32_bf16 v[24:27], v[96:99], a[84:87], v[24:27]
    v_mfma_f32_16x16x32_bf16 v[52:55], v[176:179], a[84:87], v[52:55]
    v_mfma_f32_16x16x32_bf16 v[80:83], v[104:107], a[84:87], v[80:83]
    v_mfma_f32_16x16x32_bf16 v[80:83], v[108:111], a[32:35], v[80:83]
    v_mfma_f32_16x16x32_bf16 v[52:55], v[104:107], a[32:35], v[52:55]
    v_mfma_f32_16x16x32_bf16 v[24:27], v[100:103], a[32:35], v[24:27]
    v_mfma_f32_16x16x32_bf16 v[20:23], v[100:103], a[28:31], v[20:23]
    v_mfma_f32_16x16x32_bf16 v[48:51], v[104:107], a[28:31], v[48:51]
    v_mfma_f32_16x16x32_bf16 v[76:79], v[108:111], a[28:31], v[76:79]
    v_mfma_f32_16x16x32_bf16 v[76:79], v[104:107], a[80:83], v[76:79]
    v_mfma_f32_16x16x32_bf16 v[48:51], v[176:179], a[80:83], v[48:51]
    v_mfma_f32_16x16x32_bf16 v[20:23], v[96:99], a[80:83], v[20:23]
    v_mfma_f32_16x16x32_bf16 v[16:19], v[96:99], a[76:79], v[16:19]
    v_mfma_f32_16x16x32_bf16 v[44:47], v[176:179], a[76:79], v[44:47]
    v_mfma_f32_16x16x32_bf16 v[72:75], v[104:107], a[76:79], v[72:75]
    v_mfma_f32_16x16x32_bf16 v[72:75], v[108:111], a[24:27], v[72:75]
    s_waitcnt vmcnt(12)
    v_xor_b32 v180, 0x80008000, v124
    v_mfma_f32_16x16x32_bf16 v[44:47], v[104:107], a[24:27], v[44:47]
    v_mfma_f32_16x16x32_bf16 v[16:19], v[100:103], a[24:27], v[16:19]
    v_xor_b32 v181, 0x80008000, v125
    s_waitcnt lgkmcnt(3)
    v_mfma_f32_16x16x32_bf16 v[12:15], v[100:103], a[20:23], v[12:15]
    v_mfma_f32_16x16x32_bf16 v[40:43], v[104:107], a[20:23], v[40:43]
    v_xor_b32 v182, 0x80008000, v126
    v_mfma_f32_16x16x32_bf16 v[68:71], v[108:111], a[20:23], v[68:71]
    s_waitcnt lgkmcnt(2)
    v_mfma_f32_16x16x32_bf16 v[68:71], v[104:107], a[72:75], v[68:71]
    v_xor_b32 v183, 0x80008000, v127
    v_mfma_f32_16x16x32_bf16 v[40:43], v[176:179], a[72:75], v[40:43]
    v_mfma_f32_16x16x32_bf16 v[12:15], v[96:99], a[72:75], v[12:15]
    v_mfma_f32_16x16x32_bf16 v[36:39], v[116:119], a[40:43], v[36:39]
    s_add_u32 s47, s45, 122880
    v_mfma_f32_16x16x32_bf16 v[64:67], v[120:123], a[40:43], v[64:67]
    buffer_load_dwordx4 v[96:99], v4, s[16:19], s47 offen offset:0
    v_mfma_f32_16x16x32_bf16 v[92:95], v[124:127], a[40:43], v[92:95]
    v_mfma_f32_16x16x32_bf16 v[92:95], v[120:123], a[92:95], v[92:95]
    v_mfma_f32_16x16x32_bf16 v[64:67], v[180:183], a[92:95], v[64:67]
    buffer_load_dwordx4 v[100:103], v4, s[16:19], s47 offen offset:1024
    v_mfma_f32_16x16x32_bf16 v[36:39], v[112:115], a[92:95], v[36:39]
    v_mfma_f32_16x16x32_bf16 v[32:35], v[112:115], a[88:91], v[32:35]
    v_mfma_f32_16x16x32_bf16 v[60:63], v[180:183], a[88:91], v[60:63]
    buffer_load_dwordx4 v[104:107], v4, s[16:19], s47 offen offset:2048
    v_mfma_f32_16x16x32_bf16 v[88:91], v[120:123], a[88:91], v[88:91]
    v_mfma_f32_16x16x32_bf16 v[88:91], v[124:127], a[36:39], v[88:91]
    v_mfma_f32_16x16x32_bf16 v[60:63], v[120:123], a[36:39], v[60:63]
    buffer_load_dwordx4 v[108:111], v4, s[16:19], s47 offen offset:3072
    v_mfma_f32_16x16x32_bf16 v[32:35], v[116:119], a[36:39], v[32:35]
    v_mfma_f32_16x16x32_bf16 v[28:31], v[116:119], a[32:35], v[28:31]
    v_mfma_f32_16x16x32_bf16 v[56:59], v[120:123], a[32:35], v[56:59]
    ds_read_b128 a[12:15], v7 offset:480
    v_mfma_f32_16x16x32_bf16 v[84:87], v[124:127], a[32:35], v[84:87]
    v_mfma_f32_16x16x32_bf16 v[84:87], v[120:123], a[84:87], v[84:87]
    ds_read_b128 a[64:67], v7 offset:544
    v_mfma_f32_16x16x32_bf16 v[56:59], v[180:183], a[84:87], v[56:59]
    v_mfma_f32_16x16x32_bf16 v[28:31], v[112:115], a[84:87], v[28:31]
    ds_read_b128 a[8:11], v7 offset:320
    v_mfma_f32_16x16x32_bf16 v[24:27], v[112:115], a[80:83], v[24:27]
    v_mfma_f32_16x16x32_bf16 v[52:55], v[180:183], a[80:83], v[52:55]
    ds_read_b128 a[60:63], v7 offset:384
    v_mfma_f32_16x16x32_bf16 v[80:83], v[120:123], a[80:83], v[80:83]
    v_mfma_f32_16x16x32_bf16 v[80:83], v[124:127], a[28:31], v[80:83]
    ds_read_b128 a[4:7], v7 offset:160
    v_mfma_f32_16x16x32_bf16 v[52:55], v[120:123], a[28:31], v[52:55]
    v_mfma_f32_16x16x32_bf16 v[24:27], v[116:119], a[28:31], v[24:27]
    ds_read_b128 a[56:59], v7 offset:224
    v_mfma_f32_16x16x32_bf16 v[20:23], v[116:119], a[24:27], v[20:23]
    v_mfma_f32_16x16x32_bf16 v[48:51], v[120:123], a[24:27], v[48:51]
    ds_read_b128 a[0:3], v7 offset:0
    v_mfma_f32_16x16x32_bf16 v[76:79], v[124:127], a[24:27], v[76:79]
    v_mfma_f32_16x16x32_bf16 v[76:79], v[120:123], a[76:79], v[76:79]
    ds_read_b128 a[52:55], v7 offset:64
    v_mfma_f32_16x16x32_bf16 v[48:51], v[180:183], a[76:79], v[48:51]
    s_waitcnt vmcnt(12)
    v_xor_b32 v184, 0x80008000, v140
    v_mfma_f32_16x16x32_bf16 v[20:23], v[112:115], a[76:79], v[20:23]
    v_xor_b32 v185, 0x80008000, v141
    v_mfma_f32_16x16x32_bf16 v[16:19], v[112:115], a[72:75], v[16:19]
    v_xor_b32 v186, 0x80008000, v142
    v_mfma_f32_16x16x32_bf16 v[44:47], v[180:183], a[72:75], v[44:47]
    v_xor_b32 v187, 0x80008000, v143
    v_mfma_f32_16x16x32_bf16 v[72:75], v[120:123], a[72:75], v[72:75]
    s_waitcnt vmcnt(8)
    v_xor_b32 v188, 0x80008000, v156
    v_mfma_f32_16x16x32_bf16 v[72:75], v[124:127], a[20:23], v[72:75]
    v_xor_b32 v189, 0x80008000, v157
    v_mfma_f32_16x16x32_bf16 v[44:47], v[120:123], a[20:23], v[44:47]
    v_xor_b32 v190, 0x80008000, v158
    v_mfma_f32_16x16x32_bf16 v[16:19], v[116:119], a[20:23], v[16:19]
    v_xor_b32 v191, 0x80008000, v159
    s_waitcnt lgkmcnt(9)
    v_mfma_f32_16x16x32_bf16 v[12:15], v[116:119], a[16:19], v[12:15]
    s_waitcnt vmcnt(4)
    v_xor_b32 v192, 0x80008000, v172
    v_mfma_f32_16x16x32_bf16 v[40:43], v[120:123], a[16:19], v[40:43]
    v_xor_b32 v193, 0x80008000, v173
    v_mfma_f32_16x16x32_bf16 v[68:71], v[124:127], a[16:19], v[68:71]
    v_xor_b32 v194, 0x80008000, v174
    s_waitcnt lgkmcnt(8)
    v_mfma_f32_16x16x32_bf16 v[68:71], v[120:123], a[68:71], v[68:71]
    v_xor_b32 v195, 0x80008000, v175
    v_mfma_f32_16x16x32_bf16 v[40:43], v[180:183], a[68:71], v[40:43]
    v_mfma_f32_16x16x32_bf16 v[12:15], v[112:115], a[68:71], v[12:15]
    s_waitcnt vmcnt(0)
    v_xor_b32 v176, 0x80008000, v108
    v_mfma_f32_16x16x32_bf16 v[36:39], v[132:135], a[36:39], v[36:39]
    v_xor_b32 v177, 0x80008000, v109
    v_mfma_f32_16x16x32_bf16 v[36:39], v[148:151], a[32:35], v[36:39]
    v_xor_b32 v178, 0x80008000, v110
    v_mfma_f32_16x16x32_bf16 v[36:39], v[164:167], a[28:31], v[36:39]
    v_xor_b32 v179, 0x80008000, v111
    v_mfma_f32_16x16x32_bf16 v[36:39], v[100:103], a[24:27], v[36:39]
    v_mfma_f32_16x16x32_bf16 v[36:39], v[128:131], a[88:91], v[36:39]
    v_mfma_f32_16x16x32_bf16 v[36:39], v[144:147], a[84:87], v[36:39]
    v_mfma_f32_16x16x32_bf16 v[36:39], v[160:163], a[80:83], v[36:39]
    v_mfma_f32_16x16x32_bf16 v[36:39], v[96:99], a[76:79], v[36:39]
    v_mfma_f32_16x16x32_bf16 v[32:35], v[132:135], a[32:35], v[32:35]
    v_mfma_f32_16x16x32_bf16 v[32:35], v[148:151], a[28:31], v[32:35]
    v_mfma_f32_16x16x32_bf16 v[32:35], v[164:167], a[24:27], v[32:35]
    v_mfma_f32_16x16x32_bf16 v[32:35], v[100:103], a[20:23], v[32:35]
    v_mfma_f32_16x16x32_bf16 v[32:35], v[128:131], a[84:87], v[32:35]
    v_mfma_f32_16x16x32_bf16 v[32:35], v[144:147], a[80:83], v[32:35]
    v_mfma_f32_16x16x32_bf16 v[32:35], v[160:163], a[76:79], v[32:35]
    v_mfma_f32_16x16x32_bf16 v[32:35], v[96:99], a[72:75], v[32:35]
    v_cvt_pk_bf16_f32 v39, v38, v39
    v_mfma_f32_16x16x32_bf16 v[28:31], v[132:135], a[28:31], v[28:31]
    v_cvt_pk_bf16_f32 v38, v36, v37
    v_mfma_f32_16x16x32_bf16 v[28:31], v[148:151], a[24:27], v[28:31]
    v_mfma_f32_16x16x32_bf16 v[28:31], v[164:167], a[20:23], v[28:31]
    v_mfma_f32_16x16x32_bf16 v[28:31], v[100:103], a[16:19], v[28:31]
    v_mfma_f32_16x16x32_bf16 v[28:31], v[128:131], a[80:83], v[28:31]
    v_mfma_f32_16x16x32_bf16 v[28:31], v[144:147], a[76:79], v[28:31]
    v_mfma_f32_16x16x32_bf16 v[28:31], v[160:163], a[72:75], v[28:31]
    v_mfma_f32_16x16x32_bf16 v[28:31], v[96:99], a[68:71], v[28:31]
    v_cvt_pk_bf16_f32 v32, v32, v33
    v_mfma_f32_16x16x32_bf16 v[24:27], v[132:135], a[24:27], v[24:27]
    v_cvt_pk_bf16_f32 v33, v34, v35
    v_mfma_f32_16x16x32_bf16 v[24:27], v[148:151], a[20:23], v[24:27]
    v_mfma_f32_16x16x32_bf16 v[24:27], v[164:167], a[16:19], v[24:27]
    ds_write_b64 v10, v[32:33] offset:2560
    s_waitcnt lgkmcnt(8)
    v_mfma_f32_16x16x32_bf16 v[24:27], v[100:103], a[12:15], v[24:27]
    v_mfma_f32_16x16x32_bf16 v[24:27], v[128:131], a[76:79], v[24:27]
    v_mfma_f32_16x16x32_bf16 v[24:27], v[144:147], a[72:75], v[24:27]
    v_mfma_f32_16x16x32_bf16 v[24:27], v[160:163], a[68:71], v[24:27]
    s_waitcnt lgkmcnt(7)
    v_mfma_f32_16x16x32_bf16 v[24:27], v[96:99], a[64:67], v[24:27]
    v_cvt_pk_bf16_f32 v31, v30, v31
    v_mfma_f32_16x16x32_bf16 v[20:23], v[132:135], a[20:23], v[20:23]
    v_cvt_pk_bf16_f32 v30, v28, v29
    v_mfma_f32_16x16x32_bf16 v[20:23], v[148:151], a[16:19], v[20:23]
    v_mfma_f32_16x16x32_bf16 v[20:23], v[164:167], a[12:15], v[20:23]
    s_waitcnt lgkmcnt(6)
    v_mfma_f32_16x16x32_bf16 v[20:23], v[100:103], a[8:11], v[20:23]
    v_mfma_f32_16x16x32_bf16 v[20:23], v[128:131], a[72:75], v[20:23]
    v_mfma_f32_16x16x32_bf16 v[20:23], v[144:147], a[68:71], v[20:23]
    v_mfma_f32_16x16x32_bf16 v[20:23], v[160:163], a[64:67], v[20:23]
    s_waitcnt lgkmcnt(5)
    v_mfma_f32_16x16x32_bf16 v[20:23], v[96:99], a[60:63], v[20:23]
    v_cvt_pk_bf16_f32 v24, v24, v25
    v_mfma_f32_16x16x32_bf16 v[16:19], v[132:135], a[16:19], v[16:19]
    v_cvt_pk_bf16_f32 v25, v26, v27
    v_mfma_f32_16x16x32_bf16 v[16:19], v[148:151], a[12:15], v[16:19]
    v_mfma_f32_16x16x32_bf16 v[16:19], v[164:167], a[8:11], v[16:19]
    ds_write_b64 v10, v[24:25] offset:1536
    s_waitcnt lgkmcnt(5)
    v_mfma_f32_16x16x32_bf16 v[16:19], v[100:103], a[4:7], v[16:19]
    v_mfma_f32_16x16x32_bf16 v[16:19], v[128:131], a[68:71], v[16:19]
    v_mfma_f32_16x16x32_bf16 v[16:19], v[144:147], a[64:67], v[16:19]
    v_mfma_f32_16x16x32_bf16 v[16:19], v[160:163], a[60:63], v[16:19]
    s_waitcnt lgkmcnt(4)
    v_mfma_f32_16x16x32_bf16 v[16:19], v[96:99], a[56:59], v[16:19]
    v_cvt_pk_bf16_f32 v23, v22, v23
    v_mfma_f32_16x16x32_bf16 v[12:15], v[132:135], a[12:15], v[12:15]
    v_cvt_pk_bf16_f32 v22, v20, v21
    v_mfma_f32_16x16x32_bf16 v[12:15], v[148:151], a[8:11], v[12:15]
    v_mfma_f32_16x16x32_bf16 v[12:15], v[164:167], a[4:7], v[12:15]
    s_waitcnt lgkmcnt(3)
    v_mfma_f32_16x16x32_bf16 v[12:15], v[100:103], a[0:3], v[12:15]
    v_mfma_f32_16x16x32_bf16 v[12:15], v[128:131], a[64:67], v[12:15]
    v_mfma_f32_16x16x32_bf16 v[12:15], v[144:147], a[60:63], v[12:15]
    v_mfma_f32_16x16x32_bf16 v[12:15], v[160:163], a[56:59], v[12:15]
    s_waitcnt lgkmcnt(2)
    v_mfma_f32_16x16x32_bf16 v[12:15], v[96:99], a[52:55], v[12:15]
    v_cvt_pk_bf16_f32 v16, v16, v17
    v_mfma_f32_16x16x32_bf16 v[64:67], v[136:139], a[36:39], v[64:67]
    v_cvt_pk_bf16_f32 v17, v18, v19
    v_mfma_f32_16x16x32_bf16 v[64:67], v[152:155], a[32:35], v[64:67]
    v_mfma_f32_16x16x32_bf16 v[64:67], v[168:171], a[28:31], v[64:67]
    ds_write_b64 v10, v[16:17] offset:512
    v_mfma_f32_16x16x32_bf16 v[64:67], v[104:107], a[24:27], v[64:67]
    v_mfma_f32_16x16x32_bf16 v[64:67], v[184:187], a[88:91], v[64:67]
    v_mfma_f32_16x16x32_bf16 v[64:67], v[188:191], a[84:87], v[64:67]
    v_mfma_f32_16x16x32_bf16 v[64:67], v[192:195], a[80:83], v[64:67]
    v_mfma_f32_16x16x32_bf16 v[64:67], v[176:179], a[76:79], v[64:67]
    v_cvt_pk_bf16_f32 v12, v12, v13
    v_mfma_f32_16x16x32_bf16 v[92:95], v[136:139], a[88:91], v[92:95]
    v_cvt_pk_bf16_f32 v13, v14, v15
    v_mfma_f32_16x16x32_bf16 v[92:95], v[152:155], a[84:87], v[92:95]
    v_mfma_f32_16x16x32_bf16 v[92:95], v[168:171], a[80:83], v[92:95]
    ds_write_b64 v10, v[12:13] offset:0
    v_mfma_f32_16x16x32_bf16 v[92:95], v[104:107], a[76:79], v[92:95]
    v_mfma_f32_16x16x32_bf16 v[92:95], v[140:143], a[36:39], v[92:95]
    s_waitcnt lgkmcnt(0)
    s_barrier
    v_mfma_f32_16x16x32_bf16 v[92:95], v[156:159], a[32:35], v[92:95]
    ds_read_b64 v[36:37], v10 offset:3072
    v_mfma_f32_16x16x32_bf16 v[92:95], v[172:175], a[28:31], v[92:95]
    ds_read_b64 v[28:29], v10 offset:2048
    v_mfma_f32_16x16x32_bf16 v[92:95], v[108:111], a[24:27], v[92:95]
    ds_read_b64 v[20:21], v10 offset:1024
    v_cvt_pk_bf16_f32 v196, v64, v65
    v_mfma_f32_16x16x32_bf16 v[60:63], v[136:139], a[32:35], v[60:63]
    v_cvt_pk_bf16_f32 v197, v66, v67
    v_mfma_f32_16x16x32_bf16 v[60:63], v[152:155], a[28:31], v[60:63]
    v_mfma_f32_16x16x32_bf16 v[60:63], v[168:171], a[24:27], v[60:63]
    v_mfma_f32_16x16x32_bf16 v[60:63], v[104:107], a[20:23], v[60:63]
    v_mfma_f32_16x16x32_bf16 v[60:63], v[184:187], a[84:87], v[60:63]
    v_mfma_f32_16x16x32_bf16 v[60:63], v[188:191], a[80:83], v[60:63]
    v_mfma_f32_16x16x32_bf16 v[60:63], v[192:195], a[76:79], v[60:63]
    v_mfma_f32_16x16x32_bf16 v[60:63], v[176:179], a[72:75], v[60:63]
    v_cvt_pk_bf16_f32 v198, v92, v93
    v_mfma_f32_16x16x32_bf16 v[88:91], v[136:139], a[84:87], v[88:91]
    s_mov_b32 s47, 294912
    v_cvt_pk_bf16_f32 v199, v94, v95
    v_mfma_f32_16x16x32_bf16 v[88:91], v[152:155], a[80:83], v[88:91]
    s_waitcnt lgkmcnt(2)
    buffer_store_dwordx4 v[36:39], v9, s[20:23], s47 offen offset:64 sc1
    s_mov_b32 s48, 294912
    v_mfma_f32_16x16x32_bf16 v[88:91], v[168:171], a[76:79], v[88:91]
    buffer_store_dwordx4 v[196:199], v9, s[20:23], s48 offen offset:128 sc1
    v_mfma_f32_16x16x32_bf16 v[88:91], v[104:107], a[72:75], v[88:91]
    v_mfma_f32_16x16x32_bf16 v[88:91], v[140:143], a[32:35], v[88:91]
    v_mfma_f32_16x16x32_bf16 v[88:91], v[156:159], a[28:31], v[88:91]
    v_mfma_f32_16x16x32_bf16 v[88:91], v[172:175], a[24:27], v[88:91]
    s_mov_b32 s47, 196608
    v_mfma_f32_16x16x32_bf16 v[88:91], v[108:111], a[20:23], v[88:91]
    s_waitcnt lgkmcnt(1)
    buffer_store_dwordx4 v[28:31], v9, s[20:23], s47 offen offset:64 sc1
    v_cvt_pk_bf16_f32 v200, v60, v61
    v_mfma_f32_16x16x32_bf16 v[56:59], v[136:139], a[28:31], v[56:59]
    v_cvt_pk_bf16_f32 v201, v62, v63
    v_mfma_f32_16x16x32_bf16 v[56:59], v[152:155], a[24:27], v[56:59]
    v_mfma_f32_16x16x32_bf16 v[56:59], v[168:171], a[20:23], v[56:59]
    v_mfma_f32_16x16x32_bf16 v[56:59], v[104:107], a[16:19], v[56:59]
    v_mfma_f32_16x16x32_bf16 v[56:59], v[184:187], a[80:83], v[56:59]
    s_mov_b32 s47, 98304
    v_mfma_f32_16x16x32_bf16 v[56:59], v[188:191], a[76:79], v[56:59]
    s_waitcnt lgkmcnt(0)
    buffer_store_dwordx4 v[20:23], v9, s[20:23], s47 offen offset:64 sc1
    v_mfma_f32_16x16x32_bf16 v[56:59], v[192:195], a[72:75], v[56:59]
    v_mfma_f32_16x16x32_bf16 v[56:59], v[176:179], a[68:71], v[56:59]
    v_cvt_pk_bf16_f32 v202, v88, v89
    v_mfma_f32_16x16x32_bf16 v[84:87], v[136:139], a[80:83], v[84:87]
    v_cvt_pk_bf16_f32 v203, v90, v91
    v_mfma_f32_16x16x32_bf16 v[84:87], v[152:155], a[76:79], v[84:87]
    s_mov_b32 s48, 245760
    v_mfma_f32_16x16x32_bf16 v[84:87], v[168:171], a[72:75], v[84:87]
    buffer_store_dwordx4 v[200:203], v9, s[20:23], s48 offen offset:128 sc1
    v_mfma_f32_16x16x32_bf16 v[84:87], v[104:107], a[68:71], v[84:87]
    v_mfma_f32_16x16x32_bf16 v[84:87], v[140:143], a[28:31], v[84:87]
    v_mfma_f32_16x16x32_bf16 v[84:87], v[156:159], a[24:27], v[84:87]
    v_mfma_f32_16x16x32_bf16 v[84:87], v[172:175], a[20:23], v[84:87]
    v_mfma_f32_16x16x32_bf16 v[84:87], v[108:111], a[16:19], v[84:87]
    v_cvt_pk_bf16_f32 v204, v56, v57
    v_mfma_f32_16x16x32_bf16 v[52:55], v[136:139], a[24:27], v[52:55]
    v_cvt_pk_bf16_f32 v205, v58, v59
    v_mfma_f32_16x16x32_bf16 v[52:55], v[152:155], a[20:23], v[52:55]
    v_mfma_f32_16x16x32_bf16 v[52:55], v[168:171], a[16:19], v[52:55]
    v_mfma_f32_16x16x32_bf16 v[52:55], v[104:107], a[12:15], v[52:55]
    v_mfma_f32_16x16x32_bf16 v[52:55], v[184:187], a[76:79], v[52:55]
    v_mfma_f32_16x16x32_bf16 v[52:55], v[188:191], a[72:75], v[52:55]
    v_mfma_f32_16x16x32_bf16 v[52:55], v[192:195], a[68:71], v[52:55]
    v_mfma_f32_16x16x32_bf16 v[52:55], v[176:179], a[64:67], v[52:55]
    v_cvt_pk_bf16_f32 v206, v84, v85
    v_mfma_f32_16x16x32_bf16 v[80:83], v[136:139], a[76:79], v[80:83]
    v_cvt_pk_bf16_f32 v207, v86, v87
    v_mfma_f32_16x16x32_bf16 v[80:83], v[152:155], a[72:75], v[80:83]
    s_mov_b32 s48, 196608
    v_mfma_f32_16x16x32_bf16 v[80:83], v[168:171], a[68:71], v[80:83]
    buffer_store_dwordx4 v[204:207], v9, s[20:23], s48 offen offset:128 sc1
    v_mfma_f32_16x16x32_bf16 v[80:83], v[104:107], a[64:67], v[80:83]
    v_mfma_f32_16x16x32_bf16 v[80:83], v[140:143], a[24:27], v[80:83]
    v_mfma_f32_16x16x32_bf16 v[80:83], v[156:159], a[20:23], v[80:83]
    v_mfma_f32_16x16x32_bf16 v[80:83], v[172:175], a[16:19], v[80:83]
    v_mfma_f32_16x16x32_bf16 v[80:83], v[108:111], a[12:15], v[80:83]
    v_cvt_pk_bf16_f32 v208, v52, v53
    v_mfma_f32_16x16x32_bf16 v[48:51], v[136:139], a[20:23], v[48:51]
    v_cvt_pk_bf16_f32 v209, v54, v55
    v_mfma_f32_16x16x32_bf16 v[48:51], v[152:155], a[16:19], v[48:51]
    v_mfma_f32_16x16x32_bf16 v[48:51], v[168:171], a[12:15], v[48:51]
    v_mfma_f32_16x16x32_bf16 v[48:51], v[104:107], a[8:11], v[48:51]
    v_mfma_f32_16x16x32_bf16 v[48:51], v[184:187], a[72:75], v[48:51]
    v_mfma_f32_16x16x32_bf16 v[48:51], v[188:191], a[68:71], v[48:51]
    v_mfma_f32_16x16x32_bf16 v[48:51], v[192:195], a[64:67], v[48:51]
    v_mfma_f32_16x16x32_bf16 v[48:51], v[176:179], a[60:63], v[48:51]
    v_cvt_pk_bf16_f32 v210, v80, v81
    v_mfma_f32_16x16x32_bf16 v[76:79], v[136:139], a[72:75], v[76:79]
    v_cvt_pk_bf16_f32 v211, v82, v83
    v_mfma_f32_16x16x32_bf16 v[76:79], v[152:155], a[68:71], v[76:79]
    s_mov_b32 s48, 147456
    v_mfma_f32_16x16x32_bf16 v[76:79], v[168:171], a[64:67], v[76:79]
    buffer_store_dwordx4 v[208:211], v9, s[20:23], s48 offen offset:128 sc1
    v_mfma_f32_16x16x32_bf16 v[76:79], v[104:107], a[60:63], v[76:79]
    v_mfma_f32_16x16x32_bf16 v[76:79], v[140:143], a[20:23], v[76:79]
    v_mfma_f32_16x16x32_bf16 v[76:79], v[156:159], a[16:19], v[76:79]
    v_mfma_f32_16x16x32_bf16 v[76:79], v[172:175], a[12:15], v[76:79]
    v_mfma_f32_16x16x32_bf16 v[76:79], v[108:111], a[8:11], v[76:79]
    v_cvt_pk_bf16_f32 v196, v48, v49
    v_mfma_f32_16x16x32_bf16 v[44:47], v[136:139], a[16:19], v[44:47]
    v_cvt_pk_bf16_f32 v197, v50, v51
    v_mfma_f32_16x16x32_bf16 v[44:47], v[152:155], a[12:15], v[44:47]
    v_mfma_f32_16x16x32_bf16 v[44:47], v[168:171], a[8:11], v[44:47]
    v_mfma_f32_16x16x32_bf16 v[44:47], v[104:107], a[4:7], v[44:47]
    v_mfma_f32_16x16x32_bf16 v[44:47], v[184:187], a[68:71], v[44:47]
    v_mfma_f32_16x16x32_bf16 v[44:47], v[188:191], a[64:67], v[44:47]
    v_mfma_f32_16x16x32_bf16 v[44:47], v[192:195], a[60:63], v[44:47]
    v_mfma_f32_16x16x32_bf16 v[44:47], v[176:179], a[56:59], v[44:47]
    v_cvt_pk_bf16_f32 v198, v76, v77
    v_mfma_f32_16x16x32_bf16 v[72:75], v[136:139], a[68:71], v[72:75]
    v_cvt_pk_bf16_f32 v199, v78, v79
    v_mfma_f32_16x16x32_bf16 v[72:75], v[152:155], a[64:67], v[72:75]
    s_mov_b32 s48, 98304
    v_mfma_f32_16x16x32_bf16 v[72:75], v[168:171], a[60:63], v[72:75]
    buffer_store_dwordx4 v[196:199], v9, s[20:23], s48 offen offset:128 sc1
    v_mfma_f32_16x16x32_bf16 v[72:75], v[104:107], a[56:59], v[72:75]
    v_mfma_f32_16x16x32_bf16 v[72:75], v[140:143], a[16:19], v[72:75]
    v_mfma_f32_16x16x32_bf16 v[72:75], v[156:159], a[12:15], v[72:75]
    v_mfma_f32_16x16x32_bf16 v[72:75], v[172:175], a[8:11], v[72:75]
    v_mfma_f32_16x16x32_bf16 v[72:75], v[108:111], a[4:7], v[72:75]
    v_cvt_pk_bf16_f32 v200, v44, v45
    v_mfma_f32_16x16x32_bf16 v[40:43], v[136:139], a[12:15], v[40:43]
    v_cvt_pk_bf16_f32 v201, v46, v47
    v_mfma_f32_16x16x32_bf16 v[40:43], v[152:155], a[8:11], v[40:43]
    v_mfma_f32_16x16x32_bf16 v[40:43], v[168:171], a[4:7], v[40:43]
    v_mfma_f32_16x16x32_bf16 v[40:43], v[104:107], a[0:3], v[40:43]
    v_mfma_f32_16x16x32_bf16 v[40:43], v[184:187], a[64:67], v[40:43]
    v_mfma_f32_16x16x32_bf16 v[40:43], v[188:191], a[60:63], v[40:43]
    v_mfma_f32_16x16x32_bf16 v[40:43], v[192:195], a[56:59], v[40:43]
    v_mfma_f32_16x16x32_bf16 v[40:43], v[176:179], a[52:55], v[40:43]
    v_cvt_pk_bf16_f32 v202, v72, v73
    v_mfma_f32_16x16x32_bf16 v[68:71], v[136:139], a[64:67], v[68:71]
    v_cvt_pk_bf16_f32 v203, v74, v75
    v_mfma_f32_16x16x32_bf16 v[68:71], v[152:155], a[60:63], v[68:71]
    s_mov_b32 s48, 49152
    v_mfma_f32_16x16x32_bf16 v[68:71], v[168:171], a[56:59], v[68:71]
    buffer_store_dwordx4 v[200:203], v9, s[20:23], s48 offen offset:128 sc1
    v_mfma_f32_16x16x32_bf16 v[68:71], v[104:107], a[52:55], v[68:71]
    v_mfma_f32_16x16x32_bf16 v[68:71], v[140:143], a[12:15], v[68:71]
    v_mfma_f32_16x16x32_bf16 v[68:71], v[156:159], a[8:11], v[68:71]
    v_mfma_f32_16x16x32_bf16 v[68:71], v[172:175], a[4:7], v[68:71]
    v_mfma_f32_16x16x32_bf16 v[68:71], v[108:111], a[0:3], v[68:71]
    v_cvt_pk_bf16_f32 v204, v40, v41
    v_cvt_pk_bf16_f32 v205, v42, v43
    s_nop 5
    v_cvt_pk_bf16_f32 v206, v68, v69
    v_cvt_pk_bf16_f32 v207, v70, v71
    s_mov_b32 s48, 0
    buffer_store_dwordx4 v[204:207], v9, s[20:23], s48 offen offset:128 sc1
    s_endpgm
K2_end:
    s_endpgm
.globl k3_kernel
.p2align 8
.type k3_kernel,@function
k3_kernel:
    s_load_dwordx2 s[4:5], s[0:1], 16
    s_load_dwordx2 s[8:9], s[0:1], 32
    s_getpc_b64 s[10:11]
K3_pc:
    s_cmp_ge_u32 s2, 224
    s_cbranch_scc1 K3_end
    v_lshrrev_b32 v5, 6, v0
    v_lshlrev_b32 v251, 7, v0
    v_min_u32 v251, K3_end-K3_pc, v251
    global_load_dword v250, v251, s[10:11]
    v_and_b32 v0, 63, v0
    v_readfirstlane_b32 s28, v5
    v_lshlrev_b32 v6, 4, v0
    v_add_u32 v7, fft_tables-K3_pc+24576, v6
    v_add_u32 v8, 4096, v7
    global_load_dwordx4 v[48:51], v7, s[10:11] offset:0
    global_load_dwordx4 v[52:55], v7, s[10:11] offset:1024
    global_load_dwordx4 v[56:59], v7, s[10:11] offset:2048
    global_load_dwordx4 v[60:63], v7, s[10:11] offset:3072
    global_load_dwordx4 v[64:67], v8, s[10:11] offset:0
    global_load_dwordx4 v[68:71], v8, s[10:11] offset:1024
    global_load_dwordx4 v[72:75], v8, s[10:11] offset:2048
    global_load_dwordx4 v[76:79], v8, s[10:11] offset:3072
    s_mul_i32 s29, s28, 12288
    s_and_b32 s30, s2, 0xfffe
    s_and_b32 s31, s28, 1
    s_add_u32 s30, s30, s31
    s_and_b32 s31, s2, 1
    s_lshl_b32 s31, s31, 1
    s_lshr_b32 s32, s28, 1
    s_add_u32 s31, s31, s32
    s_lshl_b32 s33, s30, 2
    s_add_u32 s33, s33, s31
    s_mul_i32 s33, s33, 12288
    s_add_u32 s38, s33, 4096
    s_add_u32 s39, s33, 8192
    s_waitcnt lgkmcnt(0)
    s_add_u32 s12, s8, 0x1400000
    s_addc_u32 s13, s9, 0
    s_and_b32 s13, s13, 0xffff
    s_mov_b32 s14, 11010048
    s_mov_b32 s15, 0x00020000
    s_add_u32 m0, s29, 0
    s_nop 0
    buffer_load_dwordx4 v6, s[12:15], s33 offen offset:0 lds
    buffer_load_dwordx4 v6, s[12:15], s33 offen offset:1024 lds
    buffer_load_dwordx4 v6, s[12:15], s33 offen offset:2048 lds
    buffer_load_dwordx4 v6, s[12:15], s33 offen offset:3072 lds
    s_add_u32 m0, s29, 4096
    s_nop 0
    buffer_load_dwordx4 v6, s[12:15], s38 offen offset:0 lds
    buffer_load_dwordx4 v6, s[12:15], s38 offen offset:1024 lds
    buffer_load_dwordx4 v6, s[12:15], s38 offen offset:2048 lds
    buffer_load_dwordx4 v6, s[12:15], s38 offen offset:3072 lds
    s_add_u32 m0, s29, 8192
    s_nop 0
    buffer_load_dwordx4 v6, s[12:15], s39 offen offset:0 lds
    buffer_load_dwordx4 v6, s[12:15], s39 offen offset:1024 lds
    buffer_load_dwordx4 v6, s[12:15], s39 offen offset:2048 lds
    buffer_load_dwordx4 v6, s[12:15], s39 offen offset:3072 lds
    s_mov_b32 s16, s4
    s_and_b32 s17, s5, 0xffff
    s_mov_b32 s18, 9633792
    s_mov_b32 s19, 0x00020000
    v_and_b32 v1, 15, v0
    v_lshrrev_b32 v2, 4, v0
    v_bfe_u32 v3, v0, 2, 2
    v_and_b32 v4, 3, v0
    v_lshrrev_b32 v23, 1, v2
    v_lshlrev_b32 v23, 3, v23
    v_and_b32 v24, 1, v2
    v_lshl_add_u32 v23, v24, 1, v23
    v_lshrrev_b32 v25, 1, v3
    v_add_u32 v23, v23, v25
    v_mul_u32_u24 v23, 384, v23
    v_lshl_add_u32 v23, v4, 5, v23
    v_and_b32 v25, 1, v3
    v_lshl_add_u32 v23, v25, 3, v23
    v_add_u32 v20, s29, v23
    v_mul_u32_u24 v23, 192, v1
    v_lshl_add_u32 v25, v2, 4, v23
    v_cmp_gt_u32 vcc, 8, v1
    v_mov_b32 v23, 0x40000000
    s_nop 0
    v_cndmask_b32 v26, v23, v25, vcc
    s_mul_i32 s35, s30, 43008
    s_mul_i32 s36, s31, 10752
    s_add_u32 s35, s35, s36
    s_waitcnt vmcnt(6)
    ds_read_b64_tr_b16 v[80:81], v20 offset:0
    ds_read_b64_tr_b16 v[82:83], v20 offset:1536
    ds_read_b64_tr_b16 v[84:85], v20 offset:16
    ds_read_b64_tr_b16 v[86:87], v20 offset:1552
    ds_read_b64_tr_b16 v[88:89], v20 offset:128
    ds_read_b64_tr_b16 v[90:91], v20 offset:1664
    ds_read_b64_tr_b16 v[92:93], v20 offset:144
    ds_read_b64_tr_b16 v[94:95], v20 offset:1680
    ds_read_b64_tr_b16 v[96:97], v20 offset:256
    ds_read_b64_tr_b16 v[98:99], v20 offset:1792
    ds_read_b64_tr_b16 v[100:101], v20 offset:272
    ds_read_b64_tr_b16 v[102:103], v20 offset:1808
    s_waitcnt lgkmcnt(10)
    v_mfma_f32_16x16x32_bf16 v[128:131], v[80:83], v[48:51], 0
    v_mfma_f32_16x16x32_bf16 v[132:135], v[80:83], v[56:59], 0
    v_mfma_f32_16x16x32_bf16 v[136:139], v[80:83], v[64:67], 0
    v_mfma_f32_16x16x32_bf16 v[140:143], v[80:83], v[72:75], 0
    s_waitcnt lgkmcnt(8)
    v_mfma_f32_16x16x32_bf16 v[144:147], v[84:87], v[48:51], 0
    v_mfma_f32_16x16x32_bf16 v[148:151], v[84:87], v[56:59], 0
    v_mfma_f32_16x16x32_bf16 v[152:155], v[84:87], v[64:67], 0
    v_mfma_f32_16x16x32_bf16 v[156:159], v[84:87], v[72:75], 0
    s_waitcnt lgkmcnt(6)
    v_mfma_f32_16x16x32_bf16 v[160:163], v[88:91], v[48:51], 0
    v_mfma_f32_16x16x32_bf16 v[164:167], v[88:91], v[56:59], 0
    v_mfma_f32_16x16x32_bf16 v[168:171], v[88:91], v[64:67], 0
    v_mfma_f32_16x16x32_bf16 v[172:175], v[88:91], v[72:75], 0
    s_waitcnt lgkmcnt(4)
    v_mfma_f32_16x16x32_bf16 v[176:179], v[92:95], v[48:51], 0
    v_mfma_f32_16x16x32_bf16 v[180:183], v[92:95], v[56:59], 0
    v_mfma_f32_16x16x32_bf16 v[184:187], v[92:95], v[64:67], 0
    v_mfma_f32_16x16x32_bf16 v[188:191], v[92:95], v[72:75], 0
    s_waitcnt lgkmcnt(2)
    v_mfma_f32_16x16x32_bf16 v[192:195], v[96:99], v[48:51], 0
    v_mfma_f32_16x16x32_bf16 v[196:199], v[96:99], v[56:59], 0
    v_mfma_f32_16x16x32_bf16 v[200:203], v[96:99], v[64:67], 0
    v_mfma_f32_16x16x32_bf16 v[204:207], v[96:99], v[72:75], 0
    s_waitcnt lgkmcnt(0)
    v_mfma_f32_16x16x32_bf16 v[208:211], v[100:103], v[48:51], 0
    v_mfma_f32_16x16x32_bf16 v[212:215], v[100:103], v[56:59], 0
    v_mfma_f32_16x16x32_bf16 v[216:219], v[100:103], v[64:67], 0
    v_mfma_f32_16x16x32_bf16 v[220:223], v[100:103], v[72:75], 0
    s_waitcnt vmcnt(0)
    ds_read_b64_tr_b16 v[104:105], v20 offset:6144
    ds_read_b64_tr_b16 v[106:107], v20 offset:7680
    ds_read_b64_tr_b16 v[108:109], v20 offset:6160
    ds_read_b64_tr_b16 v[110:111], v20 offset:7696
    ds_read_b64_tr_b16 v[112:113], v20 offset:6272
    ds_read_b64_tr_b16 v[114:115], v20 offset:7808
    ds_read_b64_tr_b16 v[116:117], v20 offset:6288
    ds_read_b64_tr_b16 v[118:119], v20 offset:7824
    ds_read_b64_tr_b16 v[120:121], v20 offset:6400
    ds_read_b64_tr_b16 v[122:123], v20 offset:7936
    ds_read_b64_tr_b16 v[124:125], v20 offset:6416
    ds_read_b64_tr_b16 v[126:127], v20 offset:7952
    s_waitcnt lgkmcnt(10)
    v_mfma_f32_16x16x32_bf16 v[128:131], v[104:107], v[52:55], v[128:131]
    s_waitcnt lgkmcnt(8)
    v_mfma_f32_16x16x32_bf16 v[144:147], v[108:111], v[52:55], v[144:147]
    s_waitcnt lgkmcnt(6)
    v_mfma_f32_16x16x32_bf16 v[160:163], v[112:115], v[52:55], v[160:163]
    s_waitcnt lgkmcnt(4)
    v_mfma_f32_16x16x32_bf16 v[176:179], v[116:119], v[52:55], v[176:179]
    s_waitcnt lgkmcnt(2)
    v_mfma_f32_16x16x32_bf16 v[192:195], v[120:123], v[52:55], v[192:195]
    s_waitcnt lgkmcnt(0)
    v_mfma_f32_16x16x32_bf16 v[208:211], v[124:127], v[52:55], v[208:211]
    v_mfma_f32_16x16x32_bf16 v[132:135], v[104:107], v[60:63], v[132:135]
    v_mfma_f32_16x16x32_bf16 v[148:151], v[108:111], v[60:63], v[148:151]
    v_cvt_pk_bf16_f32 v224, v128, v129
    v_cvt_pk_bf16_f32 v225, v130, v131
    v_cvt_pk_bf16_f32 v226, v144, v145
    v_cvt_pk_bf16_f32 v227, v146, v147
    s_add_u32 s37, s35, 0
    buffer_store_dwordx4 v[224:227], v25, s[16:19], s37 offen offset:0 sc1
    v_mfma_f32_16x16x32_bf16 v[164:167], v[112:115], v[60:63], v[164:167]
    v_mfma_f32_16x16x32_bf16 v[180:183], v[116:119], v[60:63], v[180:183]
    v_cvt_pk_bf16_f32 v228, v160, v161
    v_cvt_pk_bf16_f32 v229, v162, v163
    v_cvt_pk_bf16_f32 v230, v176, v177
    v_cvt_pk_bf16_f32 v231, v178, v179
    s_add_u32 s37, s35, 0
    buffer_store_dwordx4 v[228:231], v25, s[16:19], s37 offen offset:64 sc1
    v_mfma_f32_16x16x32_bf16 v[196:199], v[120:123], v[60:63], v[196:199]
    v_mfma_f32_16x16x32_bf16 v[212:215], v[124:127], v[60:63], v[212:215]
    v_cvt_pk_bf16_f32 v232, v192, v193
    v_cvt_pk_bf16_f32 v233, v194, v195
    v_cvt_pk_bf16_f32 v234, v208, v209
    v_cvt_pk_bf16_f32 v235, v210, v211
    s_add_u32 s37, s35, 0
    buffer_store_dwordx4 v[232:235], v25, s[16:19], s37 offen offset:128 sc1
    v_mfma_f32_16x16x32_bf16 v[136:139], v[104:107], v[68:71], v[136:139]
    v_mfma_f32_16x16x32_bf16 v[152:155], v[108:111], v[68:71], v[152:155]
    v_cvt_pk_bf16_f32 v236, v132, v133
    v_cvt_pk_bf16_f32 v237, v134, v135
    v_cvt_pk_bf16_f32 v238, v148, v149
    v_cvt_pk_bf16_f32 v239, v150, v151
    s_add_u32 s37, s35, 3072
    buffer_store_dwordx4 v[236:239], v25, s[16:19], s37 offen offset:0 sc1
    v_mfma_f32_16x16x32_bf16 v[168:171], v[112:115], v[68:71], v[168:171]
    v_mfma_f32_16x16x32_bf16 v[184:187], v[116:119], v[68:71], v[184:187]
    v_cvt_pk_bf16_f32 v224, v164, v165
    v_cvt_pk_bf16_f32 v225, v166, v167
    v_cvt_pk_bf16_f32 v226, v180, v181
    v_cvt_pk_bf16_f32 v227, v182, v183
    s_add_u32 s37, s35, 3072
    buffer_store_dwordx4 v[224:227], v25, s[16:19], s37 offen offset:64 sc1
    v_mfma_f32_16x16x32_bf16 v[200:203], v[120:123], v[68:71], v[200:203]
    v_mfma_f32_16x16x32_bf16 v[216:219], v[124:127], v[68:71], v[216:219]
    v_cvt_pk_bf16_f32 v228, v196, v197
    v_cvt_pk_bf16_f32 v229, v198, v199
    v_cvt_pk_bf16_f32 v230, v212, v213
    v_cvt_pk_bf16_f32 v231, v214, v215
    s_add_u32 s37, s35, 3072
    buffer_store_dwordx4 v[228:231], v25, s[16:19], s37 offen offset:128 sc1
    v_mfma_f32_16x16x32_bf16 v[140:143], v[104:107], v[76:79], v[140:143]
    v_mfma_f32_16x16x32_bf16 v[156:159], v[108:111], v[76:79], v[156:159]
    v_cvt_pk_bf16_f32 v232, v136, v137
    v_cvt_pk_bf16_f32 v233, v138, v139
    v_cvt_pk_bf16_f32 v234, v152, v153
    v_cvt_pk_bf16_f32 v235, v154, v155
    s_add_u32 s37, s35, 6144
    buffer_store_dwordx4 v[232:235], v25, s[16:19], s37 offen offset:0 sc1
    v_mfma_f32_16x16x32_bf16 v[172:175], v[112:115], v[76:79], v[172:175]
    v_mfma_f32_16x16x32_bf16 v[188:191], v[116:119], v[76:79], v[188:191]
    v_cvt_pk_bf16_f32 v236, v168, v169
    v_cvt_pk_bf16_f32 v237, v170, v171
    v_cvt_pk_bf16_f32 v238, v184, v185
    v_cvt_pk_bf16_f32 v239, v186, v187
    s_add_u32 s37, s35, 6144
    buffer_store_dwordx4 v[236:239], v25, s[16:19], s37 offen offset:64 sc1
    v_mfma_f32_16x16x32_bf16 v[204:207], v[120:123], v[76:79], v[204:207]
    v_mfma_f32_16x16x32_bf16 v[220:223], v[124:127], v[76:79], v[220:223]
    v_cvt_pk_bf16_f32 v224, v200, v201
    v_cvt_pk_bf16_f32 v225, v202, v203
    v_cvt_pk_bf16_f32 v226, v216, v217
    v_cvt_pk_bf16_f32 v227, v218, v219
    s_add_u32 s37, s35, 6144
    buffer_store_dwordx4 v[224:227], v25, s[16:19], s37 offen offset:128 sc1
    v_cvt_pk_bf16_f32 v228, v140, v141
    v_cvt_pk_bf16_f32 v229, v142, v143
    v_cvt_pk_bf16_f32 v230, v156, v157
    v_cvt_pk_bf16_f32 v231, v158, v159
    s_add_u32 s37, s35, 9216
    buffer_store_dwordx4 v[228:231], v26, s[16:19], s37 offen offset:0 sc1
    v_cvt_pk_bf16_f32 v232, v172, v173
    v_cvt_pk_bf16_f32 v233, v174, v175
    v_cvt_pk_bf16_f32 v234, v188, v189
    v_cvt_pk_bf16_f32 v235, v190, v191
    s_add_u32 s37, s35, 9216
    buffer_store_dwordx4 v[232:235], v26, s[16:19], s37 offen offset:64 sc1
    v_cvt_pk_bf16_f32 v236, v204, v205
    v_cvt_pk_bf16_f32 v237, v206, v207
    v_cvt_pk_bf16_f32 v238, v220, v221
    v_cvt_pk_bf16_f32 v239, v222, v223
    s_add_u32 s37, s35, 9216
    buffer_store_dwordx4 v[236:239], v26, s[16:19], s37 offen offset:128 sc1
K3_end:
    s_endpgm
.p2align 8
.type fft_tables,@object
fft_tables:
.long 0x3f803f80, 0x3f803f80, 0x3f803f80, 0x00003f80, 0x00000000, 0x00000000, 0x00000000, 0x00000000
.long 0x3f7f3f80, 0x3f743f7b, 0x3f603f6b, 0x00003f52, 0xbdcf0000, 0xbe99be4e, 0xbef8beca, 0x0000bf12
.long 0x00000000, 0x00000000, 0x00000000, 0x00000000, 0x00000000, 0x00000000, 0x00000000, 0x00000000
.long 0x00000000, 0x00000000, 0x00000000, 0x00000000, 0x00000000, 0x00000000, 0x00000000, 0x00000000
.long 0x00000000, 0x00000000, 0x00000000, 0x00000000, 0x00000000, 0x00000000, 0x00000000, 0x00000000
.long 0x00000000, 0x00000000, 0x00000000, 0x00000000, 0x00000000, 0x00000000, 0x00000000, 0x00000000
.long 0x00000000, 0x00000000, 0x00000000, 0x00000000, 0x00000000, 0x00000000, 0x00000000, 0x00000000
.long 0x00000000, 0x00000000, 0x00000000, 0x00000000, 0x00000000, 0x00000000, 0x00000000, 0x00000000
.long 0x00000000, 0x00000000, 0x00000000, 0x00000000, 0x00000000, 0x00000000, 0x00000000, 0x00000000
.long 0x00000000, 0x00000000, 0x00000000, 0x00000000, 0x00000000, 0x00000000, 0x00000000, 0x00000000
.long 0x3f803f80, 0x3f803f80, 0x3f803f80, 0x00003f80, 0x00000000, 0x00000000, 0x00000000, 0x00000000
.long 0x3f7f3f80, 0x3f743f7b, 0x3f603f6b, 0x00003f52, 0xbdcf0000, 0xbe99be4e, 0xbef8beca, 0x0000bf12
.long 0x00000000, 0x00000000, 0x00000000, 0x00000000, 0x00000000, 0x00000000, 0x00000000, 0x00000000
.long 0x00000000, 0x00000000, 0x00000000, 0x00000000, 0x00000000, 0x00000000, 0x00000000, 0x00000000
.long 0x00000000, 0x00000000, 0x00000000, 0x00000000, 0x00000000, 0x00000000, 0x00000000, 0x00000000
.long 0x00000000, 0x00000000, 0x00000000, 0x00000000, 0x00000000, 0x00000000, 0x00000000, 0x00000000
.long 0x00000000, 0x00000000, 0x00000000, 0x00000000, 0x00000000, 0x00000000, 0x00000000, 0x00000000
.long 0x00000000, 0x00000000, 0x00000000, 0x00000000, 0x00000000, 0x00000000, 0x00000000, 0x00000000
.long 0x00000000, 0x00000000, 0x00000000, 0x00000000, 0x00000000, 0x00000000, 0x00000000, 0x00000000
.long 0x00000000, 0x00000000, 0x00000000, 0x00000000, 0x00000000, 0x00000000, 0x00000000, 0x00000000
.long 0x3f803f80, 0x3f803f80, 0x3f803f80, 0x00003f80, 0x00000000, 0x00000000, 0x00000000, 0x00000000
.long 0x3f7f3f80, 0x3f743f7b, 0x3f603f6b, 0x00003f52, 0xbdcf0000, 0xbe99be4e, 0xbef8beca, 0x0000bf12
.long 0x00000000, 0x00000000, 0x00000000, 0x00000000, 0x00000000, 0x00000000, 0x00000000, 0x00000000
.long 0x00000000, 0x00000000, 0x00000000, 0x00000000, 0x00000000, 0x00000000, 0x00000000, 0x00000000
.long 0x00000000, 0x00000000, 0x00000000, 0x00000000, 0x00000000, 0x00000000, 0x00000000, 0x00000000
.long 0x00000000, 0x00000000, 0x00000000, 0x00000000, 0x00000000, 0x00000000, 0x00000000, 0x00000000
.long 0x00000000, 0x00000000, 0x00000000, 0x00000000, 0x00000000, 0x00000000, 0x00000000, 0x00000000
.long 0x00000000, 0x00000000, 0x00000000, 0x00000000, 0x00000000, 0x00000000, 0x00000000, 0x00000000
.long 0x00000000, 0x00000000, 0x00000000, 0x00000000, 0x00000000, 0x00000000, 0x00000000, 0x00000000
.long 0x00000000, 0x00000000, 0x00000000, 0x00000000, 0x00000000, 0x00000000, 0x00000000, 0x00000000
.long 0x3f803f80, 0x3f803f80, 0x3f803f80, 0x00003f80, 0x00000000, 0x00000000, 0x00000000, 0x00000000
.long 0x3f7f3f80, 0x3f743f7b, 0x3f603f6b, 0x00003f52, 0xbdcf0000, 0xbe99be4e, 0xbef8beca, 0x0000bf12
.long 0x3f7b3f80, 0x3f523f6b, 0x3f073f30, 0x00003eb2, 0xbe4e0000, 0xbf12beca, 0xbf59bf3a, 0x0000bf70
.long 0x3f743f80, 0x3f1d3f52, 0x3d4f3eb2, 0x0000be80, 0xbe990000, 0xbf4abf12, 0xbf80bf70, 0x0000bf78
.long 0x00000000, 0x00000000, 0x00000000, 0x00000000, 0x00000000, 0x00000000, 0x00000000, 0x00000000
.long 0x00000000, 0x00000000, 0x00000000, 0x00000000, 0x00000000, 0x00000000, 0x00000000, 0x00000000
.long 0x00000000, 0x00000000, 0x00000000, 0x00000000, 0x00000000, 0x00000000, 0x00000000, 0x00000000
.long 0x00000000, 0x00000000, 0x00000000, 0x00000000, 0x00000000, 0x00000000, 0x00000000, 0x00000000
.long 0x00000000, 0x00000000, 0x00000000, 0x00000000, 0x00000000, 0x00000000, 0x00000000, 0x00000000
.long 0x00000000, 0x00000000, 0x00000000, 0x00000000, 0x00000000, 0x00000000, 0x00000000, 0x00000000
.long 0x00000000, 0x00000000, 0x00000000, 0x00000000, 0x00000000, 0x00000000, 0x00000000, 0x00000000
.long 0x00000000, 0x00000000, 0x00000000, 0x00000000, 0x00000000, 0x00000000, 0x00000000, 0x00000000
.long 0x3f7b3f80, 0x3f523f6b, 0x3f073f30, 0x00003eb2, 0xbe4e0000, 0xbf12beca, 0xbf59bf3a, 0x0000bf70
.long 0x3f743f80, 0x3f1d3f52, 0x3d4f3eb2, 0x0000be80, 0xbe990000, 0xbf4abf12, 0xbf80bf70, 0x0000bf78
.long 0x00000000, 0x00000000, 0x00000000, 0x00000000, 0x00000000, 0x00000000, 0x00000000, 0x00000000
.long 0x00000000, 0x00000000, 0x00000000, 0x00000000, 0x00000000, 0x00000000, 0x00000000, 0x00000000
.long 0x00000000, 0x00000000, 0x00000000, 0x00000000, 0x00000000, 0x00000000, 0x00000000, 0x00000000
.long 0x00000000, 0x00000000, 0x00000000, 0x00000000, 0x00000000, 0x00000000, 0x00000000, 0x00000000
.long 0x00000000, 0x00000000, 0x00000000, 0x00000000, 0x00000000, 0x00000000, 0x00000000, 0x00000000
.long 0x00000000, 0x00000000, 0x00000000, 0x00000000, 0x00000000, 0x00000000, 0x00000000, 0x00000000
.long 0x00000000, 0x00000000, 0x00000000, 0x00000000, 0x00000000, 0x00000000, 0x00000000, 0x00000000
.long 0x00000000, 0x00000000, 0x00000000, 0x00000000, 0x00000000, 0x00000000, 0x00000000, 0x00000000
.long 0x3f7b3f80, 0x3f523f6b, 0x3f073f30, 0x00003eb2, 0xbe4e0000, 0xbf12beca, 0xbf59bf3a, 0x0000bf70
.long 0x3f743f80, 0x3f1d3f52, 0x3d4f3eb2, 0x0000be80, 0xbe990000, 0xbf4abf12, 0xbf80bf70, 0x0000bf78
.long 0x00000000, 0x00000000, 0x00000000, 0x00000000, 0x00000000, 0x00000000, 0x00000000, 0x00000000
.long 0x00000000, 0x00000000, 0x00000000, 0x00000000, 0x00000000, 0x00000000, 0x00000000, 0x00000000
.long 0x00000000, 0x00000000, 0x00000000, 0x00000000, 0x00000000, 0x00000000, 0x00000000, 0x00000000
.long 0x00000000, 0x00000000, 0x00000000, 0x00000000, 0x00000000, 0x00000000, 0x00000000, 0x00000000
.long 0x00000000, 0x00000000, 0x00000000, 0x00000000, 0x00000000, 0x00000000, 0x00000000, 0x00000000
.long 0x00000000, 0x00000000, 0x00000000, 0x00000000, 0x00000000, 0x00000000, 0x00000000, 0x00000000
.long 0x00000000, 0x00000000, 0x00000000, 0x00000000, 0x00000000, 0x00000000, 0x00000000, 0x00000000
.long 0x00000000, 0x00000000, 0x00000000, 0x00000000, 0x00000000, 0x00000000, 0x00000000, 0x00000000
.long 0x3f7b3f80, 0x3f523f6b, 0x3f073f30, 0x00003eb2, 0xbe4e0000, 0xbf12beca, 0xbf59bf3a, 0x0000bf70
.long 0x3f743f80, 0x3f1d3f52, 0x3d4f3eb2, 0x0000be80, 0xbe990000, 0xbf4abf12, 0xbf80bf70, 0x0000bf78
.long 0x3f6b3f80, 0x3eb23f30, 0xbee1bd4f, 0x0000bf42, 0xbeca0000, 0xbf70bf3a, 0xbf66bf80, 0x0000bf27
.long 0x3f603f80, 0x3d4f3f07, 0xbf52bee1, 0x0000bf7f, 0xbef80000, 0xbf80bf59, 0xbf12bf66, 0x0000bdcf
.long 0x00000000, 0x00000000, 0x00000000, 0x00000000, 0x00000000, 0x00000000, 0x00000000, 0x00000000
.long 0x00000000, 0x00000000, 0x00000000, 0x00000000, 0x00000000, 0x00000000, 0x00000000, 0x00000000
.long 0x00000000, 0x00000000, 0x00000000, 0x00000000, 0x00000000, 0x00000000, 0x00000000, 0x00000000
.long 0x00000000, 0x00000000, 0x00000000, 0x00000000, 0x00000000, 0x00000000, 0x00000000, 0x00000000
.long 0x00000000, 0x00000000, 0x00000000, 0x00000000, 0x00000000, 0x00000000, 0x00000000, 0x00000000
.long 0x00000000, 0x00000000, 0x00000000, 0x00000000, 0x00000000, 0x00000000, 0x00000000, 0x00000000
.long 0x00000000, 0x00000000, 0x00000000, 0x00000000, 0x00000000, 0x00000000, 0x00000000, 0x00000000
.long 0x00000000, 0x00000000, 0x00000000, 0x00000000, 0x00000000, 0x00000000, 0x00000000, 0x00000000
.long 0x3f6b3f80, 0x3eb23f30, 0xbee1bd4f, 0x0000bf42, 0xbeca0000, 0xbf70bf3a, 0xbf66bf80, 0x0000bf27
.long 0x3f603f80, 0x3d4f3f07, 0xbf52bee1, 0x0000bf7f, 0xbef80000, 0xbf80bf59, 0xbf12bf66, 0x0000bdcf
.long 0x00000000, 0x00000000, 0x00000000, 0x00000000, 0x00000000, 0x00000000, 0x00000000, 0x00000000
.long 0x00000000, 0x00000000, 0x00000000, 0x00000000, 0x00000000, 0x00000000, 0x00000000, 0x00000000
.long 0x00000000, 0x00000000, 0x00000000, 0x00000000, 0x00000000, 0x00000000, 0x00000000, 0x00000000
.long 0x00000000, 0x00000000, 0x00000000, 0x00000000, 0x00000000, 0x00000000, 0x00000000, 0x00000000
.long 0x00000000, 0x00000000, 0x00000000, 0x00000000, 0x00000000, 0x00000000, 0x00000000, 0x00000000
.long 0x00000000, 0x00000000, 0x00000000, 0x00000000, 0x00000000, 0x00000000, 0x00000000, 0x00000000
.long 0x00000000, 0x00000000, 0x00000000, 0x00000000, 0x00000000, 0x00000000, 0x00000000, 0x00000000
.long 0x00000000, 0x00000000, 0x00000000, 0x00000000, 0x00000000, 0x00000000, 0x00000000, 0x00000000
.long 0x3f6b3f80, 0x3eb23f30, 0xbee1bd4f, 0x0000bf42, 0xbeca0000, 0xbf70bf3a, 0xbf66bf80, 0x0000bf27
.long 0x3f603f80, 0x3d4f3f07, 0xbf52bee1, 0x0000bf7f, 0xbef80000, 0xbf80bf59, 0xbf12bf66, 0x0000bdcf
.long 0x00000000, 0x00000000, 0x00000000, 0x00000000, 0x00000000, 0x00000000, 0x00000000, 0x00000000
.long 0x00000000, 0x00000000, 0x00000000, 0x00000000, 0x00000000, 0x00000000, 0x00000000, 0x00000000
.long 0x00000000, 0x00000000, 0x00000000, 0x00000000, 0x00000000, 0x00000000, 0x00000000, 0x00000000
.long 0x00000000, 0x00000000, 0x00000000, 0x00000000, 0x00000000, 0x00000000, 0x00000000, 0x00000000
.long 0x00000000, 0x00000000, 0x00000000, 0x00000000, 0x00000000, 0x00000000, 0x00000000, 0x00000000
.long 0x00000000, 0x00000000, 0x00000000, 0x00000000, 0x00000000, 0x00000000, 0x00000000, 0x00000000
.long 0x00000000, 0x00000000, 0x00000000, 0x00000000, 0x00000000, 0x00000000, 0x00000000, 0x00000000
.long 0x00000000, 0x00000000, 0x00000000, 0x00000000, 0x00000000, 0x00000000, 0x00000000, 0x00000000
.long 0x3f6b3f80, 0x3eb23f30, 0xbee1bd4f, 0x0000bf42, 0xbeca0000, 0xbf70bf3a, 0xbf66bf80, 0x0000bf27
.long 0x3f603f80, 0x3d4f3f07, 0xbf52bee1, 0x0000bf7f, 0xbef80000, 0xbf80bf59, 0xbf12bf66, 0x0000bdcf
.long 0x3f523f80, 0xbe803eb2, 0xbf7fbf42, 0x0000bf60, 0xbf120000, 0xbf78bf70, 0xbdcfbf27, 0x00003ef8
.long 0x3f423f80, 0xbf073e1b, 0xbf6bbf74, 0x0000bee1, 0xbf270000, 0xbf59bf7d, 0x3ecabe99, 0x00003f66
.long 0x00000000, 0x00000000, 0x00000000, 0x00000000, 0x00000000, 0x00000000, 0x00000000, 0x00000000
.long 0x00000000, 0x00000000, 0x00000000, 0x00000000, 0x00000000, 0x00000000, 0x00000000, 0x00000000
.long 0x00000000, 0x00000000, 0x00000000, 0x00000000, 0x00000000, 0x00000000, 0x00000000, 0x00000000
.long 0x00000000, 0x00000000, 0x00000000, 0x00000000, 0x00000000, 0x00000000, 0x00000000, 0x00000000
.long 0x00000000, 0x00000000, 0x00000000, 0x00000000, 0x00000000, 0x00000000, 0x00000000, 0x00000000
.long 0x00000000, 0x00000000, 0x00000000, 0x00000000, 0x00000000, 0x00000000, 0x00000000, 0x00000000
.long 0x00000000, 0x00000000, 0x00000000, 0x00000000, 0x00000000, 0x00000000, 0x00000000, 0x00000000
.long 0x00000000, 0x00000000, 0x00000000, 0x00000000, 0x00000000, 0x00000000, 0x00000000, 0x00000000
.long 0x3f523f80, 0xbe803eb2, 0xbf7fbf42, 0x0000bf60, 0xbf120000, 0xbf78bf70, 0xbdcfbf27, 0x00003ef8
.long 0x3f423f80, 0xbf073e1b, 0xbf6bbf74, 0x0000bee1, 0xbf270000, 0xbf59bf7d, 0x3ecabe99, 0x00003f66
.long 0x00000000, 0x00000000, 0x00000000, 0x00000000, 0x00000000, 0x00000000, 0x00000000, 0x00000000
.long 0x00000000, 0x00000000, 0x00000000, 0x00000000, 0x00000000, 0x00000000, 0x00000000, 0x00000000
.long 0x00000000, 0x00000000, 0x00000000, 0x00000000, 0x00000000, 0x00000000, 0x00000000, 0x00000000
.long 0x00000000, 0x00000000, 0x00000000, 0x00000000, 0x00000000, 0x00000000, 0x00000000, 0x00000000
.long 0x00000000, 0x00000000, 0x00000000, 0x00000000, 0x00000000, 0x00000000, 0x00000000, 0x00000000
.long 0x00000000, 0x00000000, 0x00000000, 0x00000000, 0x00000000, 0x00000000, 0x00000000, 0x00000000
.long 0x00000000, 0x00000000, 0x00000000, 0x00000000, 0x00000000, 0x00000000, 0x00000000, 0x00000000
.long 0x00000000, 0x00000000, 0x00000000, 0x00000000, 0x00000000, 0x00000000, 0x00000000, 0x00000000
.long 0x3f523f80, 0xbe803eb2, 0xbf7fbf42, 0x0000bf60, 0xbf120000, 0xbf78bf70, 0xbdcfbf27, 0x00003ef8
.long 0x3f423f80, 0xbf073e1b, 0xbf6bbf74, 0x0000bee1, 0xbf270000, 0xbf59bf7d, 0x3ecabe99, 0x00003f66
.long 0x00000000, 0x00000000, 0x00000000, 0x00000000, 0x00000000, 0x00000000, 0x00000000, 0x00000000
.long 0x00000000, 0x00000000, 0x00000000, 0x00000000, 0x00000000, 0x00000000, 0x00000000, 0x00000000
.long 0x00000000, 0x00000000, 0x00000000, 0x00000000, 0x00000000, 0x00000000, 0x00000000, 0x00000000
.long 0x00000000, 0x00000000, 0x00000000, 0x00000000, 0x00000000, 0x00000000, 0x00000000, 0x00000000
.long 0x00000000, 0x00000000, 0x00000000, 0x00000000, 0x00000000, 0x00000000, 0x00000000, 0x00000000
.long 0x00000000, 0x00000000, 0x00000000, 0x00000000, 0x00000000, 0x00000000, 0x00000000, 0x00000000
.long 0x00000000, 0x00000000, 0x00000000, 0x00000000, 0x00000000, 0x00000000, 0x00000000, 0x00000000
.long 0x00000000, 0x00000000, 0x00000000, 0x00000000, 0x00000000, 0x00000000, 0x00000000, 0x00000000
.long 0x3f523f80, 0xbe803eb2, 0xbf7fbf42, 0x0000bf60, 0xbf120000, 0xbf78bf70, 0xbdcfbf27, 0x00003ef8
.long 0x3f423f80, 0xbf073e1b, 0xbf6bbf74, 0x0000bee1, 0xbf270000, 0xbf59bf7d, 0x3ecabe99, 0x00003f66
.long 0x3f303f80, 0xbf42bd4f, 0xbf1dbf7f, 0x00003e1b, 0xbf3a0000, 0xbf27bf80, 0x3f4a3dcf, 0x00003f7d
.long 0x3f1d3f80, 0xbf6bbe80, 0xbe1bbf60, 0x00003f30, 0xbf4a0000, 0xbecabf78, 0x3f7d3ef8, 0x00003f3a
.long 0x00000000, 0x00000000, 0x00000000, 0x00000000, 0x00000000, 0x00000000, 0x00000000, 0x00000000
.long 0x00000000, 0x00000000, 0x00000000, 0x00000000, 0x00000000, 0x00000000, 0x00000000, 0x00000000
.long 0x00000000, 0x00000000, 0x00000000, 0x00000000, 0x00000000, 0x00000000, 0x00000000, 0x00000000
.long 0x00000000, 0x00000000, 0x00000000, 0x00000000, 0x00000000, 0x00000000, 0x00000000, 0x00000000
.long 0x00000000, 0x00000000, 0x00000000, 0x00000000, 0x00000000, 0x00000000, 0x00000000, 0x00000000
.long 0x00000000, 0x00000000, 0x00000000, 0x00000000, 0x00000000, 0x00000000, 0x00000000, 0x00000000
.long 0x00000000, 0x00000000, 0x00000000, 0x00000000, 0x00000000, 0x00000000, 0x00000000, 0x00000000
.long 0x00000000, 0x00000000, 0x00000000, 0x00000000, 0x00000000, 0x00000000, 0x00000000, 0x00000000
.long 0x3f303f80, 0xbf42bd4f, 0xbf1dbf7f, 0x00003e1b, 0xbf3a0000, 0xbf27bf80, 0x3f4a3dcf, 0x00003f7d
.long 0x3f1d3f80, 0xbf6bbe80, 0xbe1bbf60, 0x00003f30, 0xbf4a0000, 0xbecabf78, 0x3f7d3ef8, 0x00003f3a
.long 0x00000000, 0x00000000, 0x00000000, 0x00000000, 0x00000000, 0x00000000, 0x00000000, 0x00000000
.long 0x00000000, 0x00000000, 0x00000000, 0x00000000, 0x00000000, 0x00000000, 0x00000000, 0x00000000
.long 0x00000000, 0x00000000, 0x00000000, 0x00000000, 0x00000000, 0x00000000, 0x00000000, 0x00000000
.long 0x00000000, 0x00000000, 0x00000000, 0x00000000, 0x00000000, 0x00000000, 0x00000000, 0x00000000
.long 0x00000000, 0x00000000, 0x00000000, 0x00000000, 0x00000000, 0x00000000, 0x00000000, 0x00000000
.long 0x00000000, 0x00000000, 0x00000000, 0x00000000, 0x00000000, 0x00000000, 0x00000000, 0x00000000
.long 0x00000000, 0x00000000, 0x00000000, 0x00000000, 0x00000000, 0x00000000, 0x00000000, 0x00000000
.long 0x00000000, 0x00000000, 0x00000000, 0x00000000, 0x00000000, 0x00000000, 0x00000000, 0x00000000
.long 0x3f303f80, 0xbf42bd4f, 0xbf1dbf7f, 0x00003e1b, 0xbf3a0000, 0xbf27bf80, 0x3f4a3dcf, 0x00003f7d
.long 0x3f1d3f80, 0xbf6bbe80, 0xbe1bbf60, 0x00003f30, 0xbf4a0000, 0xbecabf78, 0x3f7d3ef8, 0x00003f3a
.long 0x00000000, 0x00000000, 0x00000000, 0x00000000, 0x00000000, 0x00000000, 0x00000000, 0x00000000
.long 0x00000000, 0x00000000, 0x00000000, 0x00000000, 0x00000000, 0x00000000, 0x00000000, 0x00000000
.long 0x00000000, 0x00000000, 0x00000000, 0x00000000, 0x00000000, 0x00000000, 0x00000000, 0x00000000
.long 0x00000000, 0x00000000, 0x00000000, 0x00000000, 0x00000000, 0x00000000, 0x00000000, 0x00000000
.long 0x00000000, 0x00000000, 0x00000000, 0x00000000, 0x00000000, 0x00000000, 0x00000000, 0x00000000
.long 0x00000000, 0x00000000, 0x00000000, 0x00000000, 0x00000000, 0x00000000, 0x00000000, 0x00000000
.long 0x00000000, 0x00000000, 0x00000000, 0x00000000, 0x00000000, 0x00000000, 0x00000000, 0x00000000
.long 0x00000000, 0x00000000, 0x00000000, 0x00000000, 0x00000000, 0x00000000, 0x00000000, 0x00000000
.long 0x3f303f80, 0xbf42bd4f, 0xbf1dbf7f, 0x00003e1b, 0xbf3a0000, 0xbf27bf80, 0x3f4a3dcf, 0x00003f7d
.long 0x3f1d3f80, 0xbf6bbe80, 0xbe1bbf60, 0x00003f30, 0xbf4a0000, 0xbecabf78, 0x3f7d3ef8, 0x00003f3a
.long 0x3f073f80, 0xbf7fbee1, 0x3eb2bf1d, 0x00003f7b, 0xbf590000, 0xbdcfbf66, 0x3f703f4a, 0x00003e4e
.long 0x3ee13f80, 0xbf7bbf1d, 0x3f42be80, 0x00003f6b, 0xbf660000, 0x3e4ebf4a, 0x3f273f78, 0x0000beca
.long 0x00000000, 0x00000000, 0x00000000, 0x00000000, 0x00000000, 0x00000000, 0x00000000, 0x00000000
.long 0x00000000, 0x00000000, 0x00000000, 0x00000000, 0x00000000, 0x00000000, 0x00000000, 0x00000000
.long 0x00000000, 0x00000000, 0x00000000, 0x00000000, 0x00000000, 0x00000000, 0x00000000, 0x00000000
.long 0x00000000, 0x00000000, 0x00000000, 0x00000000, 0x00000000, 0x00000000, 0x00000000, 0x00000000
.long 0x00000000, 0x00000000, 0x00000000, 0x00000000, 0x00000000, 0x00000000, 0x00000000, 0x00000000
.long 0x00000000, 0x00000000, 0x00000000, 0x00000000, 0x00000000, 0x00000000, 0x00000000, 0x00000000
.long 0x00000000, 0x00000000, 0x00000000, 0x00000000, 0x00000000, 0x00000000, 0x00000000, 0x00000000
.long 0x00000000, 0x00000000, 0x00000000, 0x00000000, 0x00000000, 0x00000000, 0x00000000, 0x00000000
.long 0x3f073f80, 0xbf7fbee1, 0x3eb2bf1d, 0x00003f7b, 0xbf590000, 0xbdcfbf66, 0x3f703f4a, 0x00003e4e
.long 0x3ee13f80, 0xbf7bbf1d, 0x3f42be80, 0x00003f6b, 0xbf660000, 0x3e4ebf4a, 0x3f273f78, 0x0000beca
.long 0x00000000, 0x00000000, 0x00000000, 0x00000000, 0x00000000, 0x00000000, 0x00000000, 0x00000000
.long 0x00000000, 0x00000000, 0x00000000, 0x00000000, 0x00000000, 0x00000000, 0x00000000, 0x00000000
.long 0x00000000, 0x00000000, 0x00000000, 0x00000000, 0x00000000, 0x00000000, 0x00000000, 0x00000000
.long 0x00000000, 0x00000000, 0x00000000, 0x00000000, 0x00000000, 0x00000000, 0x00000000, 0x00000000
.long 0x00000000, 0x00000000, 0x00000000, 0x00000000, 0x00000000, 0x00000000, 0x00000000, 0x00000000
.long 0x00000000, 0x00000000, 0x00000000, 0x00000000, 0x00000000, 0x00000000, 0x00000000, 0x00000000
.long 0x00000000, 0x00000000, 0x00000000, 0x00000000, 0x00000000, 0x00000000, 0x00000000, 0x00000000
.long 0x00000000, 0x00000000, 0x00000000, 0x00000000, 0x00000000, 0x00000000, 0x00000000, 0x00000000
.long 0x3f073f80, 0xbf7fbee1, 0x3eb2bf1d, 0x00003f7b, 0xbf590000, 0xbdcfbf66, 0x3f703f4a, 0x00003e4e
.long 0x3ee13f80, 0xbf7bbf1d, 0x3f42be80, 0x00003f6b, 0xbf660000, 0x3e4ebf4a, 0x3f273f78, 0x0000beca
.long 0x00000000, 0x00000000, 0x00000000, 0x00000000, 0x00000000, 0x00000000, 0x00000000, 0x00000000
.long 0x00000000, 0x00000000, 0x00000000, 0x00000000, 0x00000000, 0x00000000, 0x00000000, 0x00000000
.long 0x00000000, 0x00000000, 0x00000000, 0x00000000, 0x00000000, 0x00000000, 0x00000000, 0x00000000
.long 0x00000000, 0x00000000, 0x00000000, 0x00000000, 0x00000000, 0x00000000, 0x00000000, 0x00000000
.long 0x00000000, 0x00000000, 0x00000000, 0x00000000, 0x00000000, 0x00000000, 0x00000000, 0x00000000
.long 0x00000000, 0x00000000, 0x00000000, 0x00000000, 0x00000000, 0x00000000, 0x00000000, 0x00000000
.long 0x00000000, 0x00000000, 0x00000000, 0x00000000, 0x00000000, 0x00000000, 0x00000000, 0x00000000
.long 0x00000000, 0x00000000, 0x00000000, 0x00000000, 0x00000000, 0x00000000, 0x00000000, 0x00000000
.long 0x3f073f80, 0xbf7fbee1, 0x3eb2bf1d, 0x00003f7b, 0xbf590000, 0xbdcfbf66, 0x3f703f4a, 0x00003e4e
.long 0x3ee13f80, 0xbf7bbf1d, 0x3f42be80, 0x00003f6b, 0xbf660000, 0x3e4ebf4a, 0x3f273f78, 0x0000beca
.long 0x3eb23f80, 0xbf60bf42, 0x3f7b3e1b, 0x00003f07, 0xbf700000, 0x3ef8bf27, 0x3e4e3f7d, 0x0000bf59
.long 0x3e803f80, 0xbf30bf60, 0x3f743f07, 0x0000bd4f, 0xbf780000, 0x3f3abef8, 0xbe993f59, 0x0000bf80
.long 0x00000000, 0x00000000, 0x00000000, 0x00000000, 0x00000000, 0x00000000, 0x00000000, 0x00000000
.long 0x00000000, 0x00000000, 0x00000000, 0x00000000, 0x00000000, 0x00000000, 0x00000000, 0x00000000
.long 0x00000000, 0x00000000, 0x00000000, 0x00000000, 0x00000000, 0x00000000, 0x00000000, 0x00000000
.long 0x00000000, 0x00000000, 0x00000000, 0x00000000, 0x00000000, 0x00000000, 0x00000000, 0x00000000
.long 0x00000000, 0x00000000, 0x00000000, 0x00000000, 0x00000000, 0x00000000, 0x00000000, 0x00000000
.long 0x00000000, 0x00000000, 0x00000000, 0x00000000, 0x00000000, 0x00000000, 0x00000000, 0x00000000
.long 0x00000000, 0x00000000, 0x00000000, 0x00000000, 0x00000000, 0x00000000, 0x00000000, 0x00000000
.long 0x00000000, 0x00000000, 0x00000000, 0x00000000, 0x00000000, 0x00000000, 0x00000000, 0x00000000
.long 0x3eb23f80, 0xbf60bf42, 0x3f7b3e1b, 0x00003f07, 0xbf700000, 0x3ef8bf27, 0x3e4e3f7d, 0x0000bf59
.long 0x3e803f80, 0xbf30bf60, 0x3f743f07, 0x0000bd4f, 0xbf780000, 0x3f3abef8, 0xbe993f59, 0x0000bf80
.long 0x00000000, 0x00000000, 0x00000000, 0x00000000, 0x00000000, 0x00000000, 0x00000000, 0x00000000
.long 0x00000000, 0x00000000, 0x00000000, 0x00000000, 0x00000000, 0x00000000, 0x00000000, 0x00000000
.long 0x00000000, 0x00000000, 0x00000000, 0x00000000, 0x00000000, 0x00000000, 0x00000000, 0x00000000
.long 0x00000000, 0x00000000, 0x00000000, 0x00000000, 0x00000000, 0x00000000, 0x00000000, 0x00000000
.long 0x00000000, 0x00000000, 0x00000000, 0x00000000, 0x00000000, 0x00000000, 0x00000000, 0x00000000
.long 0x00000000, 0x00000000, 0x00000000, 0x00000000, 0x00000000, 0x00000000, 0x00000000, 0x00000000
.long 0x00000000, 0x00000000, 0x00000000, 0x00000000, 0x00000000, 0x00000000, 0x00000000, 0x00000000
.long 0x00000000, 0x00000000, 0x00000000, 0x00000000, 0x00000000, 0x00000000, 0x00000000, 0x00000000
.long 0x3eb23f80, 0xbf60bf42, 0x3f7b3e1b, 0x00003f07, 0xbf700000, 0x3ef8bf27, 0x3e4e3f7d, 0x0000bf59
.long 0x3e803f80, 0xbf30bf60, 0x3f743f07, 0x0000bd4f, 0xbf780000, 0x3f3abef8, 0xbe993f59, 0x0000bf80
.long 0x00000000, 0x00000000, 0x00000000, 0x00000000, 0x00000000, 0x00000000, 0x00000000, 0x00000000
.long 0x00000000, 0x00000000, 0x00000000, 0x00000000, 0x00000000, 0x00000000, 0x00000000, 0x00000000
.long 0x00000000, 0x00000000, 0x00000000, 0x00000000, 0x00000000, 0x00000000, 0x00000000, 0x00000000
.long 0x00000000, 0x00000000, 0x00000000, 0x00000000, 0x00000000, 0x00000000, 0x00000000, 0x00000000
.long 0x00000000, 0x00000000, 0x00000000, 0x00000000, 0x00000000, 0x00000000, 0x00000000, 0x00000000
.long 0x00000000, 0x00000000, 0x00000000, 0x00000000, 0x00000000, 0x00000000, 0x00000000, 0x00000000
.long 0x00000000, 0x00000000, 0x00000000, 0x00000000, 0x00000000, 0x00000000, 0x00000000, 0x00000000
.long 0x00000000, 0x00000000, 0x00000000, 0x00000000, 0x00000000, 0x00000000, 0x00000000, 0x00000000
.long 0x3eb23f80, 0xbf60bf42, 0x3f7b3e1b, 0x00003f07, 0xbf700000, 0x3ef8bf27, 0x3e4e3f7d, 0x0000bf59
.long 0x3e803f80, 0xbf30bf60, 0x3f743f07, 0x0000bd4f, 0xbf780000, 0x3f3abef8, 0xbe993f59, 0x0000bf80
.long 0x3e1b3f80, 0xbee1bf74, 0x3f303f52, 0x0000bf1d, 0xbf7d0000, 0x3f66be99, 0xbf3a3f12, 0x0000bf4a
.long 0x3d4f3f80, 0xbe1bbf7f, 0x3e803f7b, 0x0000bf74, 0xbf800000, 0x3f7dbdcf, 0xbf783e4e, 0x0000be99
.long 0x00000000, 0x00000000, 0x00000000, 0x00000000, 0x00000000, 0x00000000, 0x00000000, 0x00000000
.long 0x00000000, 0x00000000, 0x00000000, 0x00000000, 0x00000000, 0x00000000, 0x00000000, 0x00000000
.long 0x00000000, 0x00000000, 0x00000000, 0x00000000, 0x00000000, 0x00000000, 0x00000000, 0x00000000
.long 0x00000000, 0x00000000, 0x00000000, 0x00000000, 0x00000000, 0x00000000, 0x00000000, 0x00000000
.long 0x00000000, 0x00000000, 0x00000000, 0x00000000, 0x00000000, 0x00000000, 0x00000000, 0x00000000
.long 0x00000000, 0x00000000, 0x00000000, 0x00000000, 0x00000000, 0x00000000, 0x00000000, 0x00000000
.long 0x00000000, 0x00000000, 0x00000000, 0x00000000, 0x00000000, 0x00000000, 0x00000000, 0x00000000
.long 0x00000000, 0x00000000, 0x00000000, 0x00000000, 0x00000000, 0x00000000, 0x00000000, 0x00000000
.long 0x3e1b3f80, 0xbee1bf74, 0x3f303f52, 0x0000bf1d, 0xbf7d0000, 0x3f66be99, 0xbf3a3f12, 0x0000bf4a
.long 0x3d4f3f80, 0xbe1bbf7f, 0x3e803f7b, 0x0000bf74, 0xbf800000, 0x3f7dbdcf, 0xbf783e4e, 0x0000be99
.long 0x00000000, 0x00000000, 0x00000000, 0x00000000, 0x00000000, 0x00000000, 0x00000000, 0x00000000
.long 0x00000000, 0x00000000, 0x00000000, 0x00000000, 0x00000000, 0x00000000, 0x00000000, 0x00000000
.long 0x00000000, 0x00000000, 0x00000000, 0x00000000, 0x00000000, 0x00000000, 0x00000000, 0x00000000
.long 0x00000000, 0x00000000, 0x00000000, 0x00000000, 0x00000000, 0x00000000, 0x00000000, 0x00000000
.long 0x00000000, 0x00000000, 0x00000000, 0x00000000, 0x00000000, 0x00000000, 0x00000000, 0x00000000
.long 0x00000000, 0x00000000, 0x00000000, 0x00000000, 0x00000000, 0x00000000, 0x00000000, 0x00000000
.long 0x00000000, 0x00000000, 0x00000000, 0x00000000, 0x00000000, 0x00000000, 0x00000000, 0x00000000
.long 0x00000000, 0x00000000, 0x00000000, 0x00000000, 0x00000000, 0x00000000, 0x00000000, 0x00000000
.long 0x3e1b3f80, 0xbee1bf74, 0x3f303f52, 0x0000bf1d, 0xbf7d0000, 0x3f66be99, 0xbf3a3f12, 0x0000bf4a
.long 0x3d4f3f80, 0xbe1bbf7f, 0x3e803f7b, 0x0000bf74, 0xbf800000, 0x3f7dbdcf, 0xbf783e4e, 0x0000be99
.long 0x00000000, 0x00000000, 0x00000000, 0x00000000, 0x00000000, 0x00000000, 0x00000000, 0x00000000
.long 0x00000000, 0x00000000, 0x00000000, 0x00000000, 0x00000000, 0x00000000, 0x00000000, 0x00000000
.long 0x00000000, 0x00000000, 0x00000000, 0x00000000, 0x00000000, 0x00000000, 0x00000000, 0x00000000
.long 0x00000000, 0x00000000, 0x00000000, 0x00000000, 0x00000000, 0x00000000, 0x00000000, 0x00000000
.long 0x00000000, 0x00000000, 0x00000000, 0x00000000, 0x00000000, 0x00000000, 0x00000000, 0x00000000
.long 0x00000000, 0x00000000, 0x00000000, 0x00000000, 0x00000000, 0x00000000, 0x00000000, 0x00000000
.long 0x00000000, 0x00000000, 0x00000000, 0x00000000, 0x00000000, 0x00000000, 0x00000000, 0x00000000
.long 0x00000000, 0x00000000, 0x00000000, 0x00000000, 0x00000000, 0x00000000, 0x00000000, 0x00000000
.long 0x3e1b3f80, 0xbee1bf74, 0x3f303f52, 0x0000bf1d, 0xbf7d0000, 0x3f66be99, 0xbf3a3f12, 0x0000bf4a
.long 0x3d4f3f80, 0xbe1bbf7f, 0x3e803f7b, 0x0000bf74, 0xbf800000, 0x3f7dbdcf, 0xbf783e4e, 0x0000be99
.long 0xbd4f3f80, 0x3e1bbf7f, 0xbe803f7b, 0x0000bf74, 0xbf800000, 0x3f7d3dcf, 0xbf78be4e, 0x00003e99
.long 0xbe1b3f80, 0x3ee1bf74, 0xbf303f52, 0x0000bf1d, 0xbf7d0000, 0x3f663e99, 0xbf3abf12, 0x00003f4a
.long 0x00000000, 0x00000000, 0x00000000, 0x00000000, 0x00000000, 0x00000000, 0x00000000, 0x00000000
.long 0x00000000, 0x00000000, 0x00000000, 0x00000000, 0x00000000, 0x00000000, 0x00000000, 0x00000000
.long 0x00000000, 0x00000000, 0x00000000, 0x00000000, 0x00000000, 0x00000000, 0x00000000, 0x00000000
.long 0x00000000, 0x00000000, 0x00000000, 0x00000000, 0x00000000, 0x00000000, 0x00000000, 0x00000000
.long 0x00000000, 0x00000000, 0x00000000, 0x00000000, 0x00000000, 0x00000000, 0x00000000, 0x00000000
.long 0x00000000, 0x00000000, 0x00000000, 0x00000000, 0x00000000, 0x00000000, 0x00000000, 0x00000000
.long 0x00000000, 0x00000000, 0x00000000, 0x00000000, 0x00000000, 0x00000000, 0x00000000, 0x00000000
.long 0x00000000, 0x00000000, 0x00000000, 0x00000000, 0x00000000, 0x00000000, 0x00000000, 0x00000000
.long 0xbd4f3f80, 0x3e1bbf7f, 0xbe803f7b, 0x0000bf74, 0xbf800000, 0x3f7d3dcf, 0xbf78be4e, 0x00003e99
.long 0xbe1b3f80, 0x3ee1bf74, 0xbf303f52, 0x0000bf1d, 0xbf7d0000, 0x3f663e99, 0xbf3abf12, 0x00003f4a
.long 0x00000000, 0x00000000, 0x00000000, 0x00000000, 0x00000000, 0x00000000, 0x00000000, 0x00000000
.long 0x00000000, 0x00000000, 0x00000000, 0x00000000, 0x00000000, 0x00000000, 0x00000000, 0x00000000
.long 0x00000000, 0x00000000, 0x00000000, 0x00000000, 0x00000000, 0x00000000, 0x00000000, 0x00000000
.long 0x00000000, 0x00000000, 0x00000000, 0x00000000, 0x00000000, 0x00000000, 0x00000000, 0x00000000
.long 0x00000000, 0x00000000, 0x00000000, 0x00000000, 0x00000000, 0x00000000, 0x00000000, 0x00000000
.long 0x00000000, 0x00000000, 0x00000000, 0x00000000, 0x00000000, 0x00000000, 0x00000000, 0x00000000
.long 0x00000000, 0x00000000, 0x00000000, 0x00000000, 0x00000000, 0x00000000, 0x00000000, 0x00000000
.long 0x00000000, 0x00000000, 0x00000000, 0x00000000, 0x00000000, 0x00000000, 0x00000000, 0x00000000
.long 0xbd4f3f80, 0x3e1bbf7f, 0xbe803f7b, 0x0000bf74, 0xbf800000, 0x3f7d3dcf, 0xbf78be4e, 0x00003e99
.long 0xbe1b3f80, 0x3ee1bf74, 0xbf303f52, 0x0000bf1d, 0xbf7d0000, 0x3f663e99, 0xbf3abf12, 0x00003f4a
.long 0x00000000, 0x00000000, 0x00000000, 0x00000000, 0x00000000, 0x00000000, 0x00000000, 0x00000000
.long 0x00000000, 0x00000000, 0x00000000, 0x00000000, 0x00000000, 0x00000000, 0x00000000, 0x00000000
.long 0x00000000, 0x00000000, 0x00000000, 0x00000000, 0x00000000, 0x00000000, 0x00000000, 0x00000000
.long 0x00000000, 0x00000000, 0x00000000, 0x00000000, 0x00000000, 0x00000000, 0x00000000, 0x00000000
.long 0x00000000, 0x00000000, 0x00000000, 0x00000000, 0x00000000, 0x00000000, 0x00000000, 0x00000000
.long 0x00000000, 0x00000000, 0x00000000, 0x00000000, 0x00000000, 0x00000000, 0x00000000, 0x00000000
.long 0x00000000, 0x00000000, 0x00000000, 0x00000000, 0x00000000, 0x00000000, 0x00000000, 0x00000000
.long 0x00000000, 0x00000000, 0x00000000, 0x00000000, 0x00000000, 0x00000000, 0x00000000, 0x00000000
.long 0xbd4f3f80, 0x3e1bbf7f, 0xbe803f7b, 0x0000bf74, 0xbf800000, 0x3f7d3dcf, 0xbf78be4e, 0x00003e99
.long 0xbe1b3f80, 0x3ee1bf74, 0xbf303f52, 0x0000bf1d, 0xbf7d0000, 0x3f663e99, 0xbf3abf12, 0x00003f4a
.long 0xbe803f80, 0x3f30bf60, 0xbf743f07, 0x0000bd4f, 0xbf780000, 0x3f3a3ef8, 0xbe99bf59, 0x00003f80
.long 0xbeb23f80, 0x3f60bf42, 0xbf7b3e1b, 0x00003f07, 0xbf700000, 0x3ef83f27, 0x3e4ebf7d, 0x00003f59
.long 0x00000000, 0x00000000, 0x00000000, 0x00000000, 0x00000000, 0x00000000, 0x00000000, 0x00000000
.long 0x00000000, 0x00000000, 0x00000000, 0x00000000, 0x00000000, 0x00000000, 0x00000000, 0x00000000
.long 0x00000000, 0x00000000, 0x00000000, 0x00000000, 0x00000000, 0x00000000, 0x00000000, 0x00000000
.long 0x00000000, 0x00000000, 0x00000000, 0x00000000, 0x00000000, 0x00000000, 0x00000000, 0x00000000
.long 0x00000000, 0x00000000, 0x00000000, 0x00000000, 0x00000000, 0x00000000, 0x00000000, 0x00000000
.long 0x00000000, 0x00000000, 0x00000000, 0x00000000, 0x00000000, 0x00000000, 0x00000000, 0x00000000
.long 0x00000000, 0x00000000, 0x00000000, 0x00000000, 0x00000000, 0x00000000, 0x00000000, 0x00000000
.long 0x00000000, 0x00000000, 0x00000000, 0x00000000, 0x00000000, 0x00000000, 0x00000000, 0x00000000
.long 0xbe803f80, 0x3f30bf60, 0xbf743f07, 0x0000bd4f, 0xbf780000, 0x3f3a3ef8, 0xbe99bf59, 0x00003f80
.long 0xbeb23f80, 0x3f60bf42, 0xbf7b3e1b, 0x00003f07, 0xbf700000, 0x3ef83f27, 0x3e4ebf7d, 0x00003f59
.long 0x00000000, 0x00000000, 0x00000000, 0x00000000, 0x00000000, 0x00000000, 0x00000000, 0x00000000
.long 0x00000000, 0x00000000, 0x00000000, 0x00000000, 0x00000000, 0x00000000, 0x00000000, 0x00000000
.long 0x00000000, 0x00000000, 0x00000000, 0x00000000, 0x00000000, 0x00000000, 0x00000000, 0x00000000
.long 0x00000000, 0x00000000, 0x00000000, 0x00000000, 0x00000000, 0x00000000, 0x00000000, 0x00000000
.long 0x00000000, 0x00000000, 0x00000000, 0x00000000, 0x00000000, 0x00000000, 0x00000000, 0x00000000
.long 0x00000000, 0x00000000, 0x00000000, 0x00000000, 0x00000000, 0x00000000, 0x00000000, 0x00000000
.long 0x00000000, 0x00000000, 0x00000000, 0x00000000, 0x00000000, 0x00000000, 0x00000000, 0x00000000
.long 0x00000000, 0x00000000, 0x00000000, 0x00000000, 0x00000000, 0x00000000, 0x00000000, 0x00000000
.long 0xbe803f80, 0x3f30bf60, 0xbf743f07, 0x0000bd4f, 0xbf780000, 0x3f3a3ef8, 0xbe99bf59, 0x00003f80
.long 0xbeb23f80, 0x3f60bf42, 0xbf7b3e1b, 0x00003f07, 0xbf700000, 0x3ef83f27, 0x3e4ebf7d, 0x00003f59
.long 0x00000000, 0x00000000, 0x00000000, 0x00000000, 0x00000000, 0x00000000, 0x00000000, 0x00000000
.long 0x00000000, 0x00000000, 0x00000000, 0x00000000, 0x00000000, 0x00000000, 0x00000000, 0x00000000
.long 0x00000000, 0x00000000, 0x00000000, 0x00000000, 0x00000000, 0x00000000, 0x00000000, 0x00000000
.long 0x00000000, 0x00000000, 0x00000000, 0x00000000, 0x00000000, 0x00000000, 0x00000000, 0x00000000
.long 0x00000000, 0x00000000, 0x00000000, 0x00000000, 0x00000000, 0x00000000, 0x00000000, 0x00000000
.long 0x00000000, 0x00000000, 0x00000000, 0x00000000, 0x00000000, 0x00000000, 0x00000000, 0x00000000
.long 0x00000000, 0x00000000, 0x00000000, 0x00000000, 0x00000000, 0x00000000, 0x00000000, 0x00000000
.long 0x00000000, 0x00000000, 0x00000000, 0x00000000, 0x00000000, 0x00000000, 0x00000000, 0x00000000
.long 0xbe803f80, 0x3f30bf60, 0xbf743f07, 0x0000bd4f, 0xbf780000, 0x3f3a3ef8, 0xbe99bf59, 0x00003f80
.long 0xbeb23f80, 0x3f60bf42, 0xbf7b3e1b, 0x00003f07, 0xbf700000, 0x3ef83f27, 0x3e4ebf7d, 0x00003f59
.long 0xbee13f80, 0x3f7bbf1d, 0xbf42be80, 0x00003f6b, 0xbf660000, 0x3e4e3f4a, 0x3f27bf78, 0x00003eca
.long 0xbf073f80, 0x3f7fbee1, 0xbeb2bf1d, 0x00003f7b, 0xbf590000, 0xbdcf3f66, 0x3f70bf4a, 0x0000be4e
.long 0x00000000, 0x00000000, 0x00000000, 0x00000000, 0x00000000, 0x00000000, 0x00000000, 0x00000000
.long 0x00000000, 0x00000000, 0x00000000, 0x00000000, 0x00000000, 0x00000000, 0x00000000, 0x00000000
.long 0x00000000, 0x00000000, 0x00000000, 0x00000000, 0x00000000, 0x00000000, 0x00000000, 0x00000000
.long 0x00000000, 0x00000000, 0x00000000, 0x00000000, 0x00000000, 0x00000000, 0x00000000, 0x00000000
.long 0x00000000, 0x00000000, 0x00000000, 0x00000000, 0x00000000, 0x00000000, 0x00000000, 0x00000000
.long 0x00000000, 0x00000000, 0x00000000, 0x00000000, 0x00000000, 0x00000000, 0x00000000, 0x00000000
.long 0x00000000, 0x00000000, 0x00000000, 0x00000000, 0x00000000, 0x00000000, 0x00000000, 0x00000000
.long 0x00000000, 0x00000000, 0x00000000, 0x00000000, 0x00000000, 0x00000000, 0x00000000, 0x00000000
.long 0xbee13f80, 0x3f7bbf1d, 0xbf42be80, 0x00003f6b, 0xbf660000, 0x3e4e3f4a, 0x3f27bf78, 0x00003eca
.long 0xbf073f80, 0x3f7fbee1, 0xbeb2bf1d, 0x00003f7b, 0xbf590000, 0xbdcf3f66, 0x3f70bf4a, 0x0000be4e
.long 0x00000000, 0x00000000, 0x00000000, 0x00000000, 0x00000000, 0x00000000, 0x00000000, 0x00000000
.long 0x00000000, 0x00000000, 0x00000000, 0x00000000, 0x00000000, 0x00000000, 0x00000000, 0x00000000
.long 0x00000000, 0x00000000, 0x00000000, 0x00000000, 0x00000000, 0x00000000, 0x00000000, 0x00000000
.long 0x00000000, 0x00000000, 0x00000000, 0x00000000, 0x00000000, 0x00000000, 0x00000000, 0x00000000
.long 0x00000000, 0x00000000, 0x00000000, 0x00000000, 0x00000000, 0x00000000, 0x00000000, 0x00000000
.long 0x00000000, 0x00000000, 0x00000000, 0x00000000, 0x00000000, 0x00000000, 0x00000000, 0x00000000
.long 0x00000000, 0x00000000, 0x00000000, 0x00000000, 0x00000000, 0x00000000, 0x00000000, 0x00000000
.long 0x00000000, 0x00000000, 0x00000000, 0x00000000, 0x00000000, 0x00000000, 0x00000000, 0x00000000
.long 0xbee13f80, 0x3f7bbf1d, 0xbf42be80, 0x00003f6b, 0xbf660000, 0x3e4e3f4a, 0x3f27bf78, 0x00003eca
.long 0xbf073f80, 0x3f7fbee1, 0xbeb2bf1d, 0x00003f7b, 0xbf590000, 0xbdcf3f66, 0x3f70bf4a, 0x0000be4e
.long 0x00000000, 0x00000000, 0x00000000, 0x00000000, 0x00000000, 0x00000000, 0x00000000, 0x00000000
.long 0x00000000, 0x00000000, 0x00000000, 0x00000000, 0x00000000, 0x00000000, 0x00000000, 0x00000000
.long 0x00000000, 0x00000000, 0x00000000, 0x00000000, 0x00000000, 0x00000000, 0x00000000, 0x00000000
.long 0x00000000, 0x00000000, 0x00000000, 0x00000000, 0x00000000, 0x00000000, 0x00000000, 0x00000000
.long 0x00000000, 0x00000000, 0x00000000, 0x00000000, 0x00000000, 0x00000000, 0x00000000, 0x00000000
.long 0x00000000, 0x00000000, 0x00000000, 0x00000000, 0x00000000, 0x00000000, 0x00000000, 0x00000000
.long 0x00000000, 0x00000000, 0x00000000, 0x00000000, 0x00000000, 0x00000000, 0x00000000, 0x00000000
.long 0x00000000, 0x00000000, 0x00000000, 0x00000000, 0x00000000, 0x00000000, 0x00000000, 0x00000000
.long 0xbee13f80, 0x3f7bbf1d, 0xbf42be80, 0x00003f6b, 0xbf660000, 0x3e4e3f4a, 0x3f27bf78, 0x00003eca
.long 0xbf073f80, 0x3f7fbee1, 0xbeb2bf1d, 0x00003f7b, 0xbf590000, 0xbdcf3f66, 0x3f70bf4a, 0x0000be4e
.long 0xbf1d3f80, 0x3f6bbe80, 0x3e1bbf60, 0x00003f30, 0xbf4a0000, 0xbeca3f78, 0x3f7dbef8, 0x0000bf3a
.long 0xbf303f80, 0x3f42bd4f, 0x3f1dbf7f, 0x00003e1b, 0xbf3a0000, 0xbf273f80, 0x3f4abdcf, 0x0000bf7d
.long 0x00000000, 0x00000000, 0x00000000, 0x00000000, 0x00000000, 0x00000000, 0x00000000, 0x00000000
.long 0x00000000, 0x00000000, 0x00000000, 0x00000000, 0x00000000, 0x00000000, 0x00000000, 0x00000000
.long 0x00000000, 0x00000000, 0x00000000, 0x00000000, 0x00000000, 0x00000000, 0x00000000, 0x00000000
.long 0x00000000, 0x00000000, 0x00000000, 0x00000000, 0x00000000, 0x00000000, 0x00000000, 0x00000000
.long 0x00000000, 0x00000000, 0x00000000, 0x00000000, 0x00000000, 0x00000000, 0x00000000, 0x00000000
.long 0x00000000, 0x00000000, 0x00000000, 0x00000000, 0x00000000, 0x00000000, 0x00000000, 0x00000000
.long 0x00000000, 0x00000000, 0x00000000, 0x00000000, 0x00000000, 0x00000000, 0x00000000, 0x00000000
.long 0x00000000, 0x00000000, 0x00000000, 0x00000000, 0x00000000, 0x00000000, 0x00000000, 0x00000000
.long 0xbf1d3f80, 0x3f6bbe80, 0x3e1bbf60, 0x00003f30, 0xbf4a0000, 0xbeca3f78, 0x3f7dbef8, 0x0000bf3a
.long 0xbf303f80, 0x3f42bd4f, 0x3f1dbf7f, 0x00003e1b, 0xbf3a0000, 0xbf273f80, 0x3f4abdcf, 0x0000bf7d
.long 0x00000000, 0x00000000, 0x00000000, 0x00000000, 0x00000000, 0x00000000, 0x00000000, 0x00000000
.long 0x00000000, 0x00000000, 0x00000000, 0x00000000, 0x00000000, 0x00000000, 0x00000000, 0x00000000
.long 0x00000000, 0x00000000, 0x00000000, 0x00000000, 0x00000000, 0x00000000, 0x00000000, 0x00000000
.long 0x00000000, 0x00000000, 0x00000000, 0x00000000, 0x00000000, 0x00000000, 0x00000000, 0x00000000
.long 0x00000000, 0x00000000, 0x00000000, 0x00000000, 0x00000000, 0x00000000, 0x00000000, 0x00000000
.long 0x00000000, 0x00000000, 0x00000000, 0x00000000, 0x00000000, 0x00000000, 0x00000000, 0x00000000
.long 0x00000000, 0x00000000, 0x00000000, 0x00000000, 0x00000000, 0x00000000, 0x00000000, 0x00000000
.long 0x00000000, 0x00000000, 0x00000000, 0x00000000, 0x00000000, 0x00000000, 0x00000000, 0x00000000
.long 0xbf1d3f80, 0x3f6bbe80, 0x3e1bbf60, 0x00003f30, 0xbf4a0000, 0xbeca3f78, 0x3f7dbef8, 0x0000bf3a
.long 0xbf303f80, 0x3f42bd4f, 0x3f1dbf7f, 0x00003e1b, 0xbf3a0000, 0xbf273f80, 0x3f4abdcf, 0x0000bf7d
.long 0x00000000, 0x00000000, 0x00000000, 0x00000000, 0x00000000, 0x00000000, 0x00000000, 0x00000000
.long 0x00000000, 0x00000000, 0x00000000, 0x00000000, 0x00000000, 0x00000000, 0x00000000, 0x00000000
.long 0x00000000, 0x00000000, 0x00000000, 0x00000000, 0x00000000, 0x00000000, 0x00000000, 0x00000000
.long 0x00000000, 0x00000000, 0x00000000, 0x00000000, 0x00000000, 0x00000000, 0x00000000, 0x00000000
.long 0x00000000, 0x00000000, 0x00000000, 0x00000000, 0x00000000, 0x00000000, 0x00000000, 0x00000000
.long 0x00000000, 0x00000000, 0x00000000, 0x00000000, 0x00000000, 0x00000000, 0x00000000, 0x00000000
.long 0x00000000, 0x00000000, 0x00000000, 0x00000000, 0x00000000, 0x00000000, 0x00000000, 0x00000000
.long 0x00000000, 0x00000000, 0x00000000, 0x00000000, 0x00000000, 0x00000000, 0x00000000, 0x00000000
.long 0xbf1d3f80, 0x3f6bbe80, 0x3e1bbf60, 0x00003f30, 0xbf4a0000, 0xbeca3f78, 0x3f7dbef8, 0x0000bf3a
.long 0xbf303f80, 0x3f42bd4f, 0x3f1dbf7f, 0x00003e1b, 0xbf3a0000, 0xbf273f80, 0x3f4abdcf, 0x0000bf7d
.long 0xbf423f80, 0x3f073e1b, 0x3f6bbf74, 0x0000bee1, 0xbf270000, 0xbf593f7d, 0x3eca3e99, 0x0000bf66
.long 0xbf523f80, 0x3e803eb2, 0x3f7fbf42, 0x0000bf60, 0xbf120000, 0xbf783f70, 0xbdcf3f27, 0x0000bef8
.long 0x00000000, 0x00000000, 0x00000000, 0x00000000, 0x00000000, 0x00000000, 0x00000000, 0x00000000
.long 0x00000000, 0x00000000, 0x00000000, 0x00000000, 0x00000000, 0x00000000, 0x00000000, 0x00000000
.long 0x00000000, 0x00000000, 0x00000000, 0x00000000, 0x00000000, 0x00000000, 0x00000000, 0x00000000
.long 0x00000000, 0x00000000, 0x00000000, 0x00000000, 0x00000000, 0x00000000, 0x00000000, 0x00000000
.long 0x00000000, 0x00000000, 0x00000000, 0x00000000, 0x00000000, 0x00000000, 0x00000000, 0x00000000
.long 0x00000000, 0x00000000, 0x00000000, 0x00000000, 0x00000000, 0x00000000, 0x00000000, 0x00000000
.long 0x00000000, 0x00000000, 0x00000000, 0x00000000, 0x00000000, 0x00000000, 0x00000000, 0x00000000
.long 0x00000000, 0x00000000, 0x00000000, 0x00000000, 0x00000000, 0x00000000, 0x00000000, 0x00000000
.long 0xbf423f80, 0x3f073e1b, 0x3f6bbf74, 0x0000bee1, 0xbf270000, 0xbf593f7d, 0x3eca3e99, 0x0000bf66
.long 0xbf523f80, 0x3e803eb2, 0x3f7fbf42, 0x0000bf60, 0xbf120000, 0xbf783f70, 0xbdcf3f27, 0x0000bef8
.long 0x00000000, 0x00000000, 0x00000000, 0x00000000, 0x00000000, 0x00000000, 0x00000000, 0x00000000
.long 0x00000000, 0x00000000, 0x00000000, 0x00000000, 0x00000000, 0x00000000, 0x00000000, 0x00000000
.long 0x00000000, 0x00000000, 0x00000000, 0x00000000, 0x00000000, 0x00000000, 0x00000000, 0x00000000
.long 0x00000000, 0x00000000, 0x00000000, 0x00000000, 0x00000000, 0x00000000, 0x00000000, 0x00000000
.long 0x00000000, 0x00000000, 0x00000000, 0x00000000, 0x00000000, 0x00000000, 0x00000000, 0x00000000
.long 0x00000000, 0x00000000, 0x00000000, 0x00000000, 0x00000000, 0x00000000, 0x00000000, 0x00000000
.long 0x00000000, 0x00000000, 0x00000000, 0x00000000, 0x00000000, 0x00000000, 0x00000000, 0x00000000
.long 0x00000000, 0x00000000, 0x00000000, 0x00000000, 0x00000000, 0x00000000, 0x00000000, 0x00000000
.long 0xbf423f80, 0x3f073e1b, 0x3f6bbf74, 0x0000bee1, 0xbf270000, 0xbf593f7d, 0x3eca3e99, 0x0000bf66
.long 0xbf523f80, 0x3e803eb2, 0x3f7fbf42, 0x0000bf60, 0xbf120000, 0xbf783f70, 0xbdcf3f27, 0x0000bef8
.long 0x00000000, 0x00000000, 0x00000000, 0x00000000, 0x00000000, 0x00000000, 0x00000000, 0x00000000
.long 0x00000000, 0x00000000, 0x00000000, 0x00000000, 0x00000000, 0x00000000, 0x00000000, 0x00000000
.long 0x00000000, 0x00000000, 0x00000000, 0x00000000, 0x00000000, 0x00000000, 0x00000000, 0x00000000
.long 0x00000000, 0x00000000, 0x00000000, 0x00000000, 0x00000000, 0x00000000, 0x00000000, 0x00000000
.long 0x00000000, 0x00000000, 0x00000000, 0x00000000, 0x00000000, 0x00000000, 0x00000000, 0x00000000
.long 0x00000000, 0x00000000, 0x00000000, 0x00000000, 0x00000000, 0x00000000, 0x00000000, 0x00000000
.long 0x00000000, 0x00000000, 0x00000000, 0x00000000, 0x00000000, 0x00000000, 0x00000000, 0x00000000
.long 0x00000000, 0x00000000, 0x00000000, 0x00000000, 0x00000000, 0x00000000, 0x00000000, 0x00000000
.long 0xbf423f80, 0x3f073e1b, 0x3f6bbf74, 0x0000bee1, 0xbf270000, 0xbf593f7d, 0x3eca3e99, 0x0000bf66
.long 0xbf523f80, 0x3e803eb2, 0x3f7fbf42, 0x0000bf60, 0xbf120000, 0xbf783f70, 0xbdcf3f27, 0x0000bef8
.long 0xbf603f80, 0xbd4f3f07, 0x3f52bee1, 0x0000bf7f, 0xbef80000, 0xbf803f59, 0xbf123f66, 0x00003dcf
.long 0xbf6b3f80, 0xbeb23f30, 0x3ee1bd4f, 0x0000bf42, 0xbeca0000, 0xbf703f3a, 0xbf663f80, 0x00003f27
.long 0x00000000, 0x00000000, 0x00000000, 0x00000000, 0x00000000, 0x00000000, 0x00000000, 0x00000000
.long 0x00000000, 0x00000000, 0x00000000, 0x00000000, 0x00000000, 0x00000000, 0x00000000, 0x00000000
.long 0x00000000, 0x00000000, 0x00000000, 0x00000000, 0x00000000, 0x00000000, 0x00000000, 0x00000000
.long 0x00000000, 0x00000000, 0x00000000, 0x00000000, 0x00000000, 0x00000000, 0x00000000, 0x00000000
.long 0x00000000, 0x00000000, 0x00000000, 0x00000000, 0x00000000, 0x00000000, 0x00000000, 0x00000000
.long 0x00000000, 0x00000000, 0x00000000, 0x00000000, 0x00000000, 0x00000000, 0x00000000, 0x00000000
.long 0x00000000, 0x00000000, 0x00000000, 0x00000000, 0x00000000, 0x00000000, 0x00000000, 0x00000000
.long 0x00000000, 0x00000000, 0x00000000, 0x00000000, 0x00000000, 0x00000000, 0x00000000, 0x00000000
.long 0xbf603f80, 0xbd4f3f07, 0x3f52bee1, 0x0000bf7f, 0xbef80000, 0xbf803f59, 0xbf123f66, 0x00003dcf
.long 0xbf6b3f80, 0xbeb23f30, 0x3ee1bd4f, 0x0000bf42, 0xbeca0000, 0xbf703f3a, 0xbf663f80, 0x00003f27
.long 0x00000000, 0x00000000, 0x00000000, 0x00000000, 0x00000000, 0x00000000, 0x00000000, 0x00000000
.long 0x00000000, 0x00000000, 0x00000000, 0x00000000, 0x00000000, 0x00000000, 0x00000000, 0x00000000
.long 0x00000000, 0x00000000, 0x00000000, 0x00000000, 0x00000000, 0x00000000, 0x00000000, 0x00000000
.long 0x00000000, 0x00000000, 0x00000000, 0x00000000, 0x00000000, 0x00000000, 0x00000000, 0x00000000
.long 0x00000000, 0x00000000, 0x00000000, 0x00000000, 0x00000000, 0x00000000, 0x00000000, 0x00000000
.long 0x00000000, 0x00000000, 0x00000000, 0x00000000, 0x00000000, 0x00000000, 0x00000000, 0x00000000
.long 0x00000000, 0x00000000, 0x00000000, 0x00000000, 0x00000000, 0x00000000, 0x00000000, 0x00000000
.long 0x00000000, 0x00000000, 0x00000000, 0x00000000, 0x00000000, 0x00000000, 0x00000000, 0x00000000
.long 0xbf603f80, 0xbd4f3f07, 0x3f52bee1, 0x0000bf7f, 0xbef80000, 0xbf803f59, 0xbf123f66, 0x00003dcf
.long 0xbf6b3f80, 0xbeb23f30, 0x3ee1bd4f, 0x0000bf42, 0xbeca0000, 0xbf703f3a, 0xbf663f80, 0x00003f27
.long 0x00000000, 0x00000000, 0x00000000, 0x00000000, 0x00000000, 0x00000000, 0x00000000, 0x00000000
.long 0x00000000, 0x00000000, 0x00000000, 0x00000000, 0x00000000, 0x00000000, 0x00000000, 0x00000000
.long 0x00000000, 0x00000000, 0x00000000, 0x00000000, 0x00000000, 0x00000000, 0x00000000, 0x00000000
.long 0x00000000, 0x00000000, 0x00000000, 0x00000000, 0x00000000, 0x00000000, 0x00000000, 0x00000000
.long 0x00000000, 0x00000000, 0x00000000, 0x00000000, 0x00000000, 0x00000000, 0x00000000, 0x00000000
.long 0x00000000, 0x00000000, 0x00000000, 0x00000000, 0x00000000, 0x00000000, 0x00000000, 0x00000000
.long 0x00000000, 0x00000000, 0x00000000, 0x00000000, 0x00000000, 0x00000000, 0x00000000, 0x00000000
.long 0x00000000, 0x00000000, 0x00000000, 0x00000000, 0x00000000, 0x00000000, 0x00000000, 0x00000000
.long 0xbf603f80, 0xbd4f3f07, 0x3f52bee1, 0x0000bf7f, 0xbef80000, 0xbf803f59, 0xbf123f66, 0x00003dcf
.long 0xbf6b3f80, 0xbeb23f30, 0x3ee1bd4f, 0x0000bf42, 0xbeca0000, 0xbf703f3a, 0xbf663f80, 0x00003f27
.long 0xbf743f80, 0xbf1d3f52, 0xbd4f3eb2, 0x0000be80, 0xbe990000, 0xbf4a3f12, 0xbf803f70, 0x00003f78
.long 0xbf7b3f80, 0xbf523f6b, 0xbf073f30, 0x00003eb2, 0xbe4e0000, 0xbf123eca, 0xbf593f3a, 0x00003f70
.long 0x00000000, 0x00000000, 0x00000000, 0x00000000, 0x00000000, 0x00000000, 0x00000000, 0x00000000
.long 0x00000000, 0x00000000, 0x00000000, 0x00000000, 0x00000000, 0x00000000, 0x00000000, 0x00000000
.long 0x00000000, 0x00000000, 0x00000000, 0x00000000, 0x00000000, 0x00000000, 0x00000000, 0x00000000
.long 0x00000000, 0x00000000, 0x00000000, 0x00000000, 0x00000000, 0x00000000, 0x00000000, 0x00000000
.long 0x00000000, 0x00000000, 0x00000000, 0x00000000, 0x00000000, 0x00000000, 0x00000000, 0x00000000
.long 0x00000000, 0x00000000, 0x00000000, 0x00000000, 0x00000000, 0x00000000, 0x00000000, 0x00000000
.long 0x00000000, 0x00000000, 0x00000000, 0x00000000, 0x00000000, 0x00000000, 0x00000000, 0x00000000
.long 0x00000000, 0x00000000, 0x00000000, 0x00000000, 0x00000000, 0x00000000, 0x00000000, 0x00000000
.long 0xbf743f80, 0xbf1d3f52, 0xbd4f3eb2, 0x0000be80, 0xbe990000, 0xbf4a3f12, 0xbf803f70, 0x00003f78
.long 0xbf7b3f80, 0xbf523f6b, 0xbf073f30, 0x00003eb2, 0xbe4e0000, 0xbf123eca, 0xbf593f3a, 0x00003f70
.long 0x00000000, 0x00000000, 0x00000000, 0x00000000, 0x00000000, 0x00000000, 0x00000000, 0x00000000
.long 0x00000000, 0x00000000, 0x00000000, 0x00000000, 0x00000000, 0x00000000, 0x00000000, 0x00000000
.long 0x00000000, 0x00000000, 0x00000000, 0x00000000, 0x00000000, 0x00000000, 0x00000000, 0x00000000
.long 0x00000000, 0x00000000, 0x00000000, 0x00000000, 0x00000000, 0x00000000, 0x00000000, 0x00000000
.long 0x00000000, 0x00000000, 0x00000000, 0x00000000, 0x00000000, 0x00000000, 0x00000000, 0x00000000
.long 0x00000000, 0x00000000, 0x00000000, 0x00000000, 0x00000000, 0x00000000, 0x00000000, 0x00000000
.long 0x00000000, 0x00000000, 0x00000000, 0x00000000, 0x00000000, 0x00000000, 0x00000000, 0x00000000
.long 0x00000000, 0x00000000, 0x00000000, 0x00000000, 0x00000000, 0x00000000, 0x00000000, 0x00000000
.long 0xbf743f80, 0xbf1d3f52, 0xbd4f3eb2, 0x0000be80, 0xbe990000, 0xbf4a3f12, 0xbf803f70, 0x00003f78
.long 0xbf7b3f80, 0xbf523f6b, 0xbf073f30, 0x00003eb2, 0xbe4e0000, 0xbf123eca, 0xbf593f3a, 0x00003f70
.long 0x00000000, 0x00000000, 0x00000000, 0x00000000, 0x00000000, 0x00000000, 0x00000000, 0x00000000
.long 0x00000000, 0x00000000, 0x00000000, 0x00000000, 0x00000000, 0x00000000, 0x00000000, 0x00000000
.long 0x00000000, 0x00000000, 0x00000000, 0x00000000, 0x00000000, 0x00000000, 0x00000000, 0x00000000
.long 0x00000000, 0x00000000, 0x00000000, 0x00000000, 0x00000000, 0x00000000, 0x00000000, 0x00000000
.long 0x00000000, 0x00000000, 0x00000000, 0x00000000, 0x00000000, 0x00000000, 0x00000000, 0x00000000
.long 0x00000000, 0x00000000, 0x00000000, 0x00000000, 0x00000000, 0x00000000, 0x00000000, 0x00000000
.long 0x00000000, 0x00000000, 0x00000000, 0x00000000, 0x00000000, 0x00000000, 0x00000000, 0x00000000
.long 0x00000000, 0x00000000, 0x00000000, 0x00000000, 0x00000000, 0x00000000, 0x00000000, 0x00000000
.long 0xbf743f80, 0xbf1d3f52, 0xbd4f3eb2, 0x0000be80, 0xbe990000, 0xbf4a3f12, 0xbf803f70, 0x00003f78
.long 0xbf7b3f80, 0xbf523f6b, 0xbf073f30, 0x00003eb2, 0xbe4e0000, 0xbf123eca, 0xbf593f3a, 0x00003f70
.long 0xbf7f3f80, 0xbf743f7b, 0xbf603f6b, 0x00003f52, 0xbdcf0000, 0xbe993e4e, 0xbef83eca, 0x00003f12
.long 0xbf803f80, 0xbf803f80, 0xbf803f80, 0x00003f80, 0x00000000, 0x00000000, 0x00000000, 0x00000000
.long 0x00000000, 0x00000000, 0x00000000, 0x00000000, 0x00000000, 0x00000000, 0x00000000, 0x00000000
.long 0x00000000, 0x00000000, 0x00000000, 0x00000000, 0x00000000, 0x00000000, 0x00000000, 0x00000000
.long 0x00000000, 0x00000000, 0x00000000, 0x00000000, 0x00000000, 0x00000000, 0x00000000, 0x00000000
.long 0x00000000, 0x00000000, 0x00000000, 0x00000000, 0x00000000, 0x00000000, 0x00000000, 0x00000000
.long 0x00000000, 0x00000000, 0x00000000, 0x00000000, 0x00000000, 0x00000000, 0x00000000, 0x00000000
.long 0x00000000, 0x00000000, 0x00000000, 0x00000000, 0x00000000, 0x00000000, 0x00000000, 0x00000000
.long 0x00000000, 0x00000000, 0x00000000, 0x00000000, 0x00000000, 0x00000000, 0x00000000, 0x00000000
.long 0x00000000, 0x00000000, 0x00000000, 0x00000000, 0x00000000, 0x00000000, 0x00000000, 0x00000000
.long 0xbf7f3f80, 0xbf743f7b, 0xbf603f6b, 0x00003f52, 0xbdcf0000, 0xbe993e4e, 0xbef83eca, 0x00003f12
.long 0xbf803f80, 0xbf803f80, 0xbf803f80, 0x00003f80, 0x00000000, 0x00000000, 0x00000000, 0x00000000
.long 0x00000000, 0x00000000, 0x00000000, 0x00000000, 0x00000000, 0x00000000, 0x00000000, 0x00000000
.long 0x00000000, 0x00000000, 0x00000000, 0x00000000, 0x00000000, 0x00000000, 0x00000000, 0x00000000
.long 0x00000000, 0x00000000, 0x00000000, 0x00000000, 0x00000000, 0x00000000, 0x00000000, 0x00000000
.long 0x00000000, 0x00000000, 0x00000000, 0x00000000, 0x00000000, 0x00000000, 0x00000000, 0x00000000
.long 0x00000000, 0x00000000, 0x00000000, 0x00000000, 0x00000000, 0x00000000, 0x00000000, 0x00000000
.long 0x00000000, 0x00000000, 0x00000000, 0x00000000, 0x00000000, 0x00000000, 0x00000000, 0x00000000
.long 0x00000000, 0x00000000, 0x00000000, 0x00000000, 0x00000000, 0x00000000, 0x00000000, 0x00000000
.long 0x00000000, 0x00000000, 0x00000000, 0x00000000, 0x00000000, 0x00000000, 0x00000000, 0x00000000
.long 0xbf7f3f80, 0xbf743f7b, 0xbf603f6b, 0x00003f52, 0xbdcf0000, 0xbe993e4e, 0xbef83eca, 0x00003f12
.long 0xbf803f80, 0xbf803f80, 0xbf803f80, 0x00003f80, 0x00000000, 0x00000000, 0x00000000, 0x00000000
.long 0x00000000, 0x00000000, 0x00000000, 0x00000000, 0x00000000, 0x00000000, 0x00000000, 0x00000000
.long 0x00000000, 0x00000000, 0x00000000, 0x00000000, 0x00000000, 0x00000000, 0x00000000, 0x00000000
.long 0x00000000, 0x00000000, 0x00000000, 0x00000000, 0x00000000, 0x00000000, 0x00000000, 0x00000000
.long 0x00000000, 0x00000000, 0x00000000, 0x00000000, 0x00000000, 0x00000000, 0x00000000, 0x00000000
.long 0x00000000, 0x00000000, 0x00000000, 0x00000000, 0x00000000, 0x00000000, 0x00000000, 0x00000000
.long 0x00000000, 0x00000000, 0x00000000, 0x00000000, 0x00000000, 0x00000000, 0x00000000, 0x00000000
.long 0x00000000, 0x00000000, 0x00000000, 0x00000000, 0x00000000, 0x00000000, 0x00000000, 0x00000000
.long 0x00000000, 0x00000000, 0x00000000, 0x00000000, 0x00000000, 0x00000000, 0x00000000, 0x00000000
.long 0xbf7f3f80, 0xbf743f7b, 0xbf603f6b, 0x00003f52, 0xbdcf0000, 0xbe993e4e, 0xbef83eca, 0x00003f12
.long 0xbf803f80, 0xbf803f80, 0xbf803f80, 0x00003f80, 0x00000000, 0x00000000, 0x00000000, 0x00000000
.long 0x3f803f80, 0x3f803f80, 0x3f803f80, 0x3f803f80, 0x00000000, 0x00000000, 0x00000000, 0x00000000
.long 0x3f7f3f80, 0x3f743f7b, 0x3f1d3f30, 0x3ee13f07, 0xbdcf0000, 0xbe99be4e, 0xbf4abf3a, 0xbf66bf59
.long 0x3f7b3f80, 0x3f523f6b, 0xbe80bd4f, 0xbf1dbee1, 0xbe4e0000, 0xbf12beca, 0xbf78bf80, 0xbf4abf66
.long 0x3f743f80, 0x3f1d3f52, 0xbf6bbf42, 0xbf7bbf7f, 0xbe990000, 0xbf4abf12, 0xbecabf27, 0x3e4ebdcf
.long 0x3f6b3f80, 0x3eb23f30, 0xbf60bf7f, 0xbe80bf1d, 0xbeca0000, 0xbf70bf3a, 0x3ef83dcf, 0x3f783f4a
.long 0x3f603f80, 0x3d4f3f07, 0xbe1bbf1d, 0x3f423eb2, 0xbef80000, 0xbf80bf59, 0x3f7d3f4a, 0x3f273f70
.long 0x3f523f80, 0xbe803eb2, 0x3f303e1b, 0x3f6b3f7b, 0xbf120000, 0xbf78bf70, 0x3f3a3f7d, 0xbeca3e4e
.long 0x3f423f80, 0xbf073e1b, 0x3f7f3f52, 0x3d4f3f30, 0xbf270000, 0xbf59bf7d, 0xbdcf3f12, 0xbf80bf3a
.long 0x3f803f80, 0x3f803f80, 0x3f803f80, 0x3f803f80, 0x00000000, 0x00000000, 0x00000000, 0x00000000
.long 0x3f603f6b, 0x3f423f52, 0x3e803eb2, 0x3d4f3e1b, 0xbef8beca, 0xbf27bf12, 0xbf78bf70, 0xbf80bf7d
.long 0x3f073f30, 0x3e1b3eb2, 0xbf60bf42, 0xbf7fbf74, 0xbf59bf3a, 0xbf7dbf70, 0xbef8bf27, 0xbdcfbe99
.long 0x3d4f3eb2, 0xbf07be80, 0xbf30bf60, 0xbe1bbee1, 0xbf80bf70, 0xbf59bf78, 0x3f3a3ef8, 0x3f7d3f66
.long 0xbee1bd4f, 0xbf74bf42, 0x3f073e1b, 0x3f7b3f52, 0xbf66bf80, 0xbe99bf27, 0x3f593f7d, 0x3e4e3f12
.long 0xbf52bee1, 0xbf6bbf7f, 0x3f743f7b, 0x3e803f30, 0xbf12bf66, 0x3ecabdcf, 0xbe993e4e, 0xbf78bf3a
.long 0xbf7fbf42, 0xbee1bf60, 0xbd4f3f07, 0xbf74bf1d, 0xbdcfbf27, 0x3f663ef8, 0xbf80bf59, 0xbe99bf4a
.long 0xbf6bbf74, 0x3e80bee1, 0xbf7bbf1d, 0xbeb2bf60, 0x3ecabe99, 0x3f783f66, 0xbe4ebf4a, 0x3f703ef8
.long 0x3f803f80, 0x3f803f80, 0x3f803f80, 0x3f803f80, 0x00000000, 0x00000000, 0x00000000, 0x00000000
.long 0xbe1bbd4f, 0xbeb2be80, 0xbf52bf42, 0xbf6bbf60, 0xbf7dbf80, 0xbf70bf78, 0xbf12bf27, 0xbecabef8
.long 0xbf74bf7f, 0xbf42bf60, 0x3eb23e1b, 0x3f303f07, 0x3e993dcf, 0x3f273ef8, 0x3f703f7d, 0x3f3a3f59
.long 0x3ee13e1b, 0x3f603f30, 0x3e803f07, 0xbeb2bd4f, 0x3f663f7d, 0x3ef83f3a, 0xbf78bf59, 0xbf70bf80
.long 0x3f523f7b, 0x3e1b3f07, 0xbf42bf74, 0xbd4fbee1, 0xbf12be4e, 0xbf7dbf59, 0x3f273e99, 0x3f803f66
.long 0xbf30be80, 0xbf7bbf74, 0x3f7f3f6b, 0x3ee13f52, 0xbf3abf78, 0x3e4ebe99, 0xbdcf3eca, 0xbf66bf12
.long 0xbf1dbf74, 0x3f07bd4f, 0xbf60bee1, 0xbf42bf7f, 0x3f4a3e99, 0x3f593f80, 0xbef8bf66, 0x3f273dcf
.long 0x3f603eb2, 0x3f1d3f7b, 0x3ee1be80, 0x3f743f6b, 0x3ef83f70, 0xbf4abe4e, 0x3f663f78, 0xbe993eca
.long 0x3f803f80, 0x3f803f80, 0x3f803f80, 0x3f803f80, 0x00000000, 0x00000000, 0x00000000, 0x00000000
.long 0xbf07bee1, 0xbf30bf1d, 0xbf7bbf74, 0xbf80bf7f, 0xbf59bf66, 0xbf3abf4a, 0xbe4ebe99, 0x0000bdcf
.long 0xbee1bf1d, 0xbd4fbe80, 0x3f6b3f52, 0x3f803f7b, 0x3f663f4a, 0x3f803f78, 0x3eca3f12, 0x00003e4e
.long 0x3f7f3f7b, 0x3f423f6b, 0xbf52bf1d, 0xbf80bf74, 0xbdcf3e4e, 0xbf27beca, 0xbf12bf4a, 0x0000be99
.long 0xbf1dbe80, 0xbf7fbf60, 0x3f303eb2, 0x3f803f6b, 0xbf4abf78, 0xbdcfbef8, 0x3f3a3f70, 0x00003eca
.long 0xbeb2bf42, 0x3f1d3e1b, 0xbf07bd4f, 0xbf80bf60, 0x3f703f27, 0x3f4a3f7d, 0xbf59bf80, 0x0000bef8
.long 0x3f7b3f6b, 0x3e1b3f30, 0x3eb2be80, 0x3f803f52, 0xbe4e3eca, 0xbf7dbf3a, 0x3f703f78, 0x00003f12
.long 0xbf30bd4f, 0xbf52bf7f, 0xbe1b3f07, 0xbf80bf42, 0xbf3abf80, 0x3f12bdcf, 0xbf7dbf59, 0x0000bf27
.long 0x3f803f80, 0x3f803f80, 0x3f803f80, 0x3f803f80, 0x00000000, 0x00000000, 0x00000000, 0x00000000
.long 0xbf7bbf7f, 0xbf6bbf74, 0xbf07bf1d, 0xbeb2bee1, 0x3e4e3dcf, 0x3eca3e99, 0x3f593f4a, 0x3f703f66
.long 0x3f6b3f7b, 0x3f303f52, 0xbee1be80, 0xbf42bf1d, 0xbecabe4e, 0xbf3abf12, 0xbf66bf78, 0xbf27bf4a
.long 0xbf52bf74, 0xbeb2bf1d, 0x3f7f3f6b, 0x3f603f7b, 0x3f123e99, 0x3f703f4a, 0x3dcf3eca, 0xbef8be4e
.long 0x3f303f6b, 0xbd4f3eb2, 0xbf1dbf60, 0x3e1bbe80, 0xbf3abeca, 0xbf80bf70, 0x3f4a3ef8, 0x3f7d3f78
.long 0xbf07bf60, 0x3ee1bd4f, 0xbeb23e1b, 0xbf7bbf42, 0x3f593ef8, 0x3f663f80, 0xbf70bf7d, 0xbe4ebf27
.long 0x3eb23f52, 0xbf42be80, 0x3f7b3f30, 0x3f073f6b, 0xbf70bf12, 0xbf27bf78, 0x3e4e3f3a, 0xbf59beca
.long 0xbe1bbf42, 0x3f743f07, 0xbf30bf7f, 0x3f1dbd4f, 0x3f7d3f27, 0x3e993f59, 0x3f3a3dcf, 0x3f4a3f80
.long 0x3f803f80, 0x3f803f80, 0x3f803f80, 0x3f803f80, 0x00000000, 0x00000000, 0x00000000, 0x00000000
.long 0xbf52bf60, 0xbf30bf42, 0xbe1bbe80, 0x3d4fbd4f, 0x3f123ef8, 0x3f3a3f27, 0x3f7d3f78, 0x3f803f80
.long 0x3eb23f07, 0xbd4f3e1b, 0xbf74bf60, 0xbf7fbf7f, 0xbf70bf59, 0xbf80bf7d, 0xbe99bef8, 0x3dcfbdcf
.long 0x3e80bd4f, 0x3f423f07, 0x3ee13f30, 0xbe1b3e1b, 0x3f783f80, 0x3f273f59, 0xbf66bf3a, 0xbf7dbf7d
.long 0xbf42bee1, 0xbf7fbf74, 0x3f523f07, 0x3f7b3f7b, 0xbf27bf66, 0x3dcfbe99, 0x3f123f59, 0xbe4e3e4e
.long 0x3f7f3f52, 0x3f1d3f6b, 0xbf30bf74, 0x3e80be80, 0x3dcf3f12, 0xbf4abeca, 0x3f3a3e99, 0x3f783f78
.long 0xbf60bf7f, 0x3e1bbee1, 0xbf1dbd4f, 0xbf74bf74, 0x3ef8bdcf, 0x3f7d3f66, 0xbf4abf80, 0x3e99be99
.long 0x3ee13f6b, 0xbf52be80, 0x3f603f7b, 0xbeb23eb2, 0xbf66beca, 0xbf12bf78, 0xbef83e4e, 0xbf70bf70
.long 0x3f803f80, 0x3f803f80, 0x3f803f80, 0x3f803f80, 0x00000000, 0x00000000, 0x00000000, 0x00000000
.long 0x3e803e1b, 0x3ee13eb2, 0x3f603f52, 0x3f743f6b, 0x3f783f7d, 0x3f663f70, 0x3ef83f12, 0x3e993eca
.long 0xbf60bf74, 0xbf1dbf42, 0x3f073eb2, 0x3f523f30, 0x3ef83e99, 0x3f4a3f27, 0x3f593f70, 0x3f123f3a
.long 0xbf30bee1, 0xbf7bbf60, 0x3d4fbe80, 0x3f1d3eb2, 0xbf3abf66, 0xbe4ebef8, 0x3f803f78, 0x3f4a3f70
.long 0x3f073f52, 0xbe803e1b, 0xbee1bf42, 0x3eb2bd4f, 0xbf59bf12, 0xbf78bf7d, 0x3f663f27, 0x3f703f80
.long 0x3f743f30, 0x3f423f7b, 0xbf52bf7f, 0x3d4fbee1, 0x3e993f3a, 0xbf27be4e, 0x3f123dcf, 0x3f803f66
.long 0xbd4fbf1d, 0x3f6b3f07, 0xbf7fbf60, 0xbe80bf42, 0x3f803f4a, 0x3eca3f59, 0x3dcfbef8, 0x3f783f27
.long 0xbf7bbf60, 0x3d4fbf1d, 0xbf6bbee1, 0xbf07bf74, 0x3e4ebef8, 0x3f803f4a, 0xbecabf66, 0x3f593e99
.long 0x3f803f80, 0x3f803f80, 0x3f803f80, 0x00000000, 0x00000000, 0x00000000, 0x00000000, 0x00000000
.long 0x3f1d3f07, 0x3f423f30, 0x3f7f3f7b, 0x00000000, 0x3f4a3f59, 0x3f273f3a, 0x3dcf3e4e, 0x00000000
.long 0xbe80bee1, 0x3e1bbd4f, 0x3f7b3f6b, 0x00000000, 0x3f783f66, 0x3f7d3f80, 0x3e4e3eca, 0x00000000
.long 0xbf6bbf7f, 0xbf07bf42, 0x3f743f52, 0x00000000, 0x3eca3dcf, 0x3f593f27, 0x3e993f12, 0x00000000
.long 0xbf60bf1d, 0xbf74bf7f, 0x3f6b3f30, 0x00000000, 0xbef8bf4a, 0x3e99bdcf, 0x3eca3f3a, 0x00000000
.long 0xbe1b3eb2, 0xbf6bbf1d, 0x3f603f07, 0x00000000, 0xbf7dbf70, 0xbecabf4a, 0x3ef83f59, 0x00000000
.long 0x3f303f7b, 0xbee13e1b, 0x3f523eb2, 0x00000000, 0xbf3abe4e, 0xbf66bf7d, 0x3f123f70, 0x00000000
.long 0x3f7f3f30, 0x3e803f52, 0x3f423e1b, 0x00000000, 0x3dcf3f3a, 0xbf78bf12, 0x3f273f7d, 0x00000000
.long 0x3f303f80, 0xbf42bd4f, 0x3f073f7b, 0xbf60be80, 0xbf3a0000, 0xbf27bf80, 0xbf59be4e, 0xbef8bf78
.long 0x3f1d3f80, 0xbf6bbe80, 0xbeb23f07, 0xbf52bf74, 0xbf4a0000, 0xbecabf78, 0xbf70bf59, 0x3f12be99
.long 0x3f073f80, 0xbf7fbee1, 0xbf74be80, 0x3e1bbf42, 0xbf590000, 0xbdcfbf66, 0xbe99bf78, 0x3f7d3f27
.long 0x3ee13f80, 0xbf7bbf1d, 0xbf52bf60, 0x3f743e1b, 0xbf660000, 0x3e4ebf4a, 0x3f12bef8, 0x3e993f7d
.long 0x3eb23f80, 0xbf60bf42, 0xbd4fbf74, 0x3f303f6b, 0xbf700000, 0x3ef8bf27, 0x3f803e99, 0xbf3a3eca
.long 0x3e803f80, 0xbf30bf60, 0x3f42bee1, 0xbeb23f52, 0xbf780000, 0x3f3abef8, 0x3f273f66, 0xbf70bf12
.long 0x3e1b3f80, 0xbee1bf74, 0x3f7b3eb2, 0xbf7fbd4f, 0xbf7d0000, 0x3f66be99, 0xbe4e3f70, 0xbdcfbf80
.long 0x3d4f3f80, 0xbe1bbf7f, 0x3ee13f6b, 0xbf07bf60, 0xbf800000, 0x3f7dbdcf, 0xbf663eca, 0x3f59bef8
.long 0xbf1dbf7f, 0x3f523e1b, 0xbee1bf74, 0x3f6b3eb2, 0x3f4a3dcf, 0x3f123f7d, 0x3f663e99, 0x3eca3f70
.long 0xbe1bbf60, 0x3f7f3f30, 0x3f42bd4f, 0x3ee13f7b, 0x3f7d3ef8, 0xbdcf3f3a, 0x3f273f80, 0xbf66be4e
.long 0x3eb2bf1d, 0x3f303f7b, 0x3f523f6b, 0xbf60bd4f, 0x3f703f4a, 0xbf3a3e4e, 0xbf123eca, 0xbef8bf80
.long 0x3f42be80, 0x3d4f3f6b, 0xbeb23f30, 0xbf07bf7f, 0x3f273f78, 0xbf80beca, 0xbf70bf3a, 0x3f59bdcf
.long 0x3f7b3e1b, 0xbf1d3f07, 0xbf7fbee1, 0x3f52be80, 0x3e4e3f7d, 0xbf4abf59, 0x3dcfbf66, 0x3f123f78
.long 0x3f743f07, 0xbf7bbd4f, 0xbe1bbf7f, 0x3f1d3f6b, 0xbe993f59, 0xbe4ebf80, 0x3f7d3dcf, 0xbf4a3eca
.long 0x3f303f52, 0xbf60bf1d, 0x3f6bbe80, 0xbf423f07, 0xbf3a3f12, 0x3ef8bf4a, 0x3eca3f78, 0xbf27bf59
.long 0x3e803f7b, 0xbeb2bf74, 0x3f1d3f52, 0xbf30bf42, 0xbf783e4e, 0x3f70be99, 0xbf4a3f12, 0x3f3abf27
.long 0x3eb23f6b, 0xbf74bee1, 0x3e1b3f52, 0xbf7fbf1d, 0xbf70beca, 0xbe99bf66, 0xbf7dbf12, 0xbdcfbf4a
.long 0xbf7bbee1, 0x3d4fbf42, 0xbf30bf7f, 0x3f603e1b, 0xbe4ebf66, 0x3f803f27, 0x3f3abdcf, 0x3ef83f7d
.long 0xbd4fbf60, 0x3f6b3f52, 0x3f7b3f30, 0xbf1d3eb2, 0x3f803ef8, 0xbeca3f12, 0xbe4e3f3a, 0xbf4abf70
.long 0x3f7f3f07, 0xbf303eb2, 0xbf6bbd4f, 0x3e80bf42, 0xbdcf3f59, 0xbf3abf70, 0xbecabf80, 0x3f783f27
.long 0xbe803f52, 0xbee1bf7f, 0x3f07bf1d, 0x3e1b3f7b, 0xbf78bf12, 0x3f66bdcf, 0x3f593f4a, 0xbf7dbe4e
.long 0xbf6bbf1d, 0x3f7f3e1b, 0x3d4f3f7b, 0xbf07bf74, 0x3ecabf4a, 0x3dcf3f7d, 0xbf80be4e, 0x3f59be99
.long 0x3f07bf42, 0xbe803f6b, 0xbf1dbf60, 0x3f523f30, 0x3f593f27, 0xbf78beca, 0x3f4abef8, 0xbf123f3a
.long 0x3f423f30, 0xbf52bf1d, 0x3f743eb2, 0xbf7bbe80, 0xbf273f3a, 0x3f12bf4a, 0xbe993f70, 0x3e4ebf78
.long 0xbe80bf60, 0x3f7b3f07, 0xbd4fbf42, 0x3f803f30, 0x3f783ef8, 0x3e4e3f59, 0x3f803f27, 0x00003f3a
.long 0x3f743f52, 0xbf073eb2, 0x3e803f6b, 0xbf80bf1d, 0xbe993f12, 0xbf59bf70, 0xbf78beca, 0x0000bf4a
.long 0xbf423e1b, 0xbe80bf74, 0xbee1bf7f, 0x3f803f07, 0xbf27bf7d, 0x3f783e99, 0x3f663dcf, 0x00003f59
.long 0xbe1bbf74, 0x3f603f52, 0x3f1d3f7b, 0xbf80bee1, 0x3f7d3e99, 0xbef83f12, 0xbf4a3e4e, 0x0000bf66
.long 0x3f6b3f30, 0xbf74bd4f, 0xbf42bf60, 0x3f803eb2, 0xbeca3f3a, 0xbe99bf80, 0x3f27bef8, 0x00003f70
.long 0xbf523eb2, 0x3ee1bf42, 0x3f603f30, 0xbf80be80, 0xbf12bf70, 0x3f663f27, 0xbef83f3a, 0x0000bf78
.long 0xbd4fbf7f, 0x3eb23f7b, 0xbf74bee1, 0x3f803e1b, 0x3f803dcf, 0xbf703e4e, 0x3e99bf66, 0x00003f7d
.long 0x3f603f07, 0xbf6bbee1, 0x3f7f3e1b, 0xbf80bd4f, 0xbef83f59, 0x3ecabf66, 0xbdcf3f7d, 0x0000bf80
.long 0xbd4f3f30, 0xbf7fbf42, 0xbe803f07, 0xbf74bf60, 0xbf80bf3a, 0x3dcfbf27, 0xbf78bf59, 0x3e99bef8
.long 0x3e80bf1d, 0x3f603f6b, 0x3f743eb2, 0x3d4f3f52, 0x3f783f4a, 0xbef83eca, 0x3e993f70, 0xbf80bf12
.long 0xbee13f07, 0xbf1dbf7f, 0xbf42bf74, 0x3f6b3e1b, 0xbf66bf59, 0x3f4abdcf, 0x3f27be99, 0x3eca3f7d
.long 0x3f1dbee1, 0x3e803f7b, 0xbe1b3f52, 0xbf30bf74, 0x3f4a3f66, 0xbf78be4e, 0xbf7dbf12, 0x3f3abe99
.long 0xbf423eb2, 0x3e1bbf60, 0x3f6bbd4f, 0xbee13f30, 0xbf27bf70, 0x3f7d3ef8, 0x3eca3f80, 0xbf66bf3a
.long 0x3f60be80, 0xbf073f30, 0xbf52bf42, 0x3f7f3eb2, 0x3ef83f78, 0xbf59bf3a, 0x3f12bf27, 0xbdcf3f70
.long 0xbf743e1b, 0x3f52bee1, 0xbd4f3f7b, 0xbe80bf7f, 0xbe99bf7d, 0x3f123f66, 0xbf80be4e, 0x3f78bdcf
.long 0x3f7fbd4f, 0xbf7b3e1b, 0x3f60bee1, 0xbf523f07, 0x3dcf3f80, 0xbe4ebf7d, 0x3ef83f66, 0xbf12bf59
.long 0x3e1bbf1d, 0x3f7b3f52, 0x3eb2bee1, 0x3f6b3f6b, 0x3f7d3f4a, 0xbe4e3f12, 0x3f703f66, 0xbeca3eca
.long 0xbf303e1b, 0xbf07bf7f, 0xbf7bbf42, 0x3ee1bee1, 0xbf3abf7d, 0x3f593dcf, 0x3e4ebf27, 0x3f663f66
.long 0x3f7b3eb2, 0xbe803f30, 0xbd4f3f52, 0xbf60bf60, 0x3e4e3f70, 0xbf78bf3a, 0xbf80bf12, 0x3ef8bef8
.long 0xbf6bbf42, 0x3f60bd4f, 0x3f7f3eb2, 0xbf073f07, 0x3ecabf27, 0x3ef83f80, 0x3dcf3f70, 0xbf59bf59
.long 0x3f073f7b, 0xbf74bf1d, 0xbe80bf7f, 0x3f523f52, 0xbf593e4e, 0x3e99bf4a, 0x3f783dcf, 0xbf123f12
.long 0x3d4fbf74, 0x3ee13f7b, 0xbf6b3e1b, 0x3f1dbf1d, 0x3f803e99, 0xbf663e4e, 0xbecabf7d, 0x3f4a3f4a
.long 0xbf1d3f30, 0x3eb2bf60, 0x3f073f6b, 0xbf42bf42, 0xbf4abf3a, 0x3f703ef8, 0xbf593eca, 0x3f27bf27
.long 0x3f74be80, 0xbf6b3eb2, 0x3f42bf1d, 0xbf303f30, 0x3e993f78, 0xbecabf70, 0x3f273f4a, 0xbf3abf3a
.long 0xbee13eb2, 0xbf60bf74, 0xbf1d3e1b, 0xbf42bf7f, 0xbf66bf70, 0x3ef8be99, 0xbf4abf7d, 0x3f27bdcf
.long 0x3f423f7b, 0xbf52bd4f, 0xbe1b3f30, 0xbf6bbf60, 0xbf273e4e, 0xbf12bf80, 0xbf7dbf3a, 0x3ecabef8
.long 0x3f52bd4f, 0x3e1b3f6b, 0x3eb23f7b, 0xbf7fbf1d, 0x3f123f80, 0xbf7dbeca, 0xbf70be4e, 0x3dcfbf4a
.long 0xbeb2bf7f, 0x3f743f30, 0x3f423f6b, 0xbf7bbe80, 0x3f703dcf, 0xbe993f3a, 0xbf273eca, 0xbe4ebf78
.long 0xbf7fbe80, 0x3f30bee1, 0x3f7b3f07, 0xbf603e1b, 0xbdcfbf78, 0x3f3a3f66, 0xbe4e3f59, 0xbef8bf7d
.long 0xbe1b3f6b, 0xbeb2bf7f, 0x3f74bd4f, 0xbf303f07, 0xbf7dbeca, 0x3f70bdcf, 0x3e993f80, 0xbf3abf59
.long 0x3f6b3f07, 0xbf7fbe80, 0x3f30bf1d, 0xbee13f52, 0xbeca3f59, 0x3dcfbf78, 0x3f3a3f4a, 0xbf66bf12
.long 0x3f1dbf42, 0xbf073f52, 0x3e80bf74, 0xbe1b3f7b, 0x3f4a3f27, 0xbf59bf12, 0x3f783e99, 0xbf7dbe4e
.long 0x3f07be80, 0x3f523f7b, 0x3f30bd4f, 0x00000000, 0x3f593f78, 0xbf123e4e, 0x3f3a3f80, 0x00000000
.long 0xbeb2bf74, 0x3f7f3f07, 0x3f1dbe80, 0x00000000, 0x3f703e99, 0x3dcf3f59, 0x3f4a3f78, 0x00000000
.long 0xbf74bf42, 0x3f30be80, 0x3f07bee1, 0x00000000, 0x3e99bf27, 0x3f3a3f78, 0x3f593f66, 0x00000000
.long 0xbf523e1b, 0x3d4fbf60, 0x3ee1bf1d, 0x00000000, 0xbf12bf7d, 0x3f803ef8, 0x3f663f4a, 0x00000000
.long 0xbd4f3f6b, 0xbf1dbf74, 0x3eb2bf42, 0x00000000, 0xbf80beca, 0x3f4abe99, 0x3f703f27, 0x00000000
.long 0x3f423f52, 0xbf7bbee1, 0x3e80bf60, 0x00000000, 0xbf273f12, 0x3e4ebf66, 0x3f783ef8, 0x00000000
.long 0x3f7bbd4f, 0xbf603eb2, 0x3e1bbf74, 0x00000000, 0x3e4e3f80, 0xbef8bf70, 0x3f7d3e99, 0x00000000
.long 0x3ee1bf60, 0xbeb23f6b, 0x3d4fbf7f, 0x00000000, 0x3f663ef8, 0xbf70beca, 0x3f803dcf, 0x00000000
.long 0xbd4f3f80, 0x3e1bbf7f, 0xbee13f6b, 0x3f07bf60, 0xbf800000, 0x3f7d3dcf, 0xbf66beca, 0x3f593ef8
.long 0xbe1b3f80, 0x3ee1bf74, 0xbf7b3eb2, 0x3f7fbd4f, 0xbf7d0000, 0x3f663e99, 0xbe4ebf70, 0xbdcf3f80
.long 0xbe803f80, 0x3f30bf60, 0xbf42bee1, 0x3eb23f52, 0xbf780000, 0x3f3a3ef8, 0x3f27bf66, 0xbf703f12
.long 0xbeb23f80, 0x3f60bf42, 0x3d4fbf74, 0xbf303f6b, 0xbf700000, 0x3ef83f27, 0x3f80be99, 0xbf3abeca
.long 0xbee13f80, 0x3f7bbf1d, 0x3f52bf60, 0xbf743e1b, 0xbf660000, 0x3e4e3f4a, 0x3f123ef8, 0x3e99bf7d
.long 0xbf073f80, 0x3f7fbee1, 0x3f74be80, 0xbe1bbf42, 0xbf590000, 0xbdcf3f66, 0xbe993f78, 0x3f7dbf27
.long 0xbf1d3f80, 0x3f6bbe80, 0x3eb23f07, 0x3f52bf74, 0xbf4a0000, 0xbeca3f78, 0xbf703f59, 0x3f123e99
.long 0xbf303f80, 0x3f42bd4f, 0xbf073f7b, 0x3f60be80, 0xbf3a0000, 0xbf273f80, 0xbf593e4e, 0xbef83f78
.long 0xbe803f7b, 0x3eb2bf74, 0xbf1d3f52, 0x3f30bf42, 0xbf78be4e, 0x3f703e99, 0xbf4abf12, 0x3f3a3f27
.long 0xbf303f52, 0x3f60bf1d, 0xbf6bbe80, 0x3f423f07, 0xbf3abf12, 0x3ef83f4a, 0x3ecabf78, 0xbf273f59
.long 0xbf743f07, 0x3f7bbd4f, 0x3e1bbf7f, 0xbf1d3f6b, 0xbe99bf59, 0xbe4e3f80, 0x3f7dbdcf, 0xbf4abeca
.long 0xbf7b3e1b, 0x3f1d3f07, 0x3f7fbee1, 0xbf52be80, 0x3e4ebf7d, 0xbf4a3f59, 0x3dcf3f66, 0x3f12bf78
.long 0xbf42be80, 0xbd4f3f6b, 0x3eb23f30, 0x3f07bf7f, 0x3f27bf78, 0xbf803eca, 0xbf703f3a, 0x3f593dcf
.long 0xbeb2bf1d, 0xbf303f7b, 0xbf523f6b, 0x3f60bd4f, 0x3f70bf4a, 0xbf3abe4e, 0xbf12beca, 0xbef83f80
.long 0x3e1bbf60, 0xbf7f3f30, 0xbf42bd4f, 0xbee13f7b, 0x3f7dbef8, 0xbdcfbf3a, 0x3f27bf80, 0xbf663e4e
.long 0x3f1dbf7f, 0xbf523e1b, 0x3ee1bf74, 0xbf6b3eb2, 0x3f4abdcf, 0x3f12bf7d, 0x3f66be99, 0x3ecabf70
.long 0xbf423f30, 0x3f52bf1d, 0xbf743eb2, 0x3f7bbe80, 0xbf27bf3a, 0x3f123f4a, 0xbe99bf70, 0x3e4e3f78
.long 0xbf07bf42, 0x3e803f6b, 0x3f1dbf60, 0xbf523f30, 0x3f59bf27, 0xbf783eca, 0x3f4a3ef8, 0xbf12bf3a
.long 0x3f6bbf1d, 0xbf7f3e1b, 0xbd4f3f7b, 0x3f07bf74, 0x3eca3f4a, 0x3dcfbf7d, 0xbf803e4e, 0x3f593e99
.long 0x3e803f52, 0x3ee1bf7f, 0xbf07bf1d, 0xbe1b3f7b, 0xbf783f12, 0x3f663dcf, 0x3f59bf4a, 0xbf7d3e4e
.long 0xbf7f3f07, 0x3f303eb2, 0x3f6bbd4f, 0xbe80bf42, 0xbdcfbf59, 0xbf3a3f70, 0xbeca3f80, 0x3f78bf27
.long 0x3d4fbf60, 0xbf6b3f52, 0xbf7b3f30, 0x3f1d3eb2, 0x3f80bef8, 0xbecabf12, 0xbe4ebf3a, 0xbf4a3f70
.long 0x3f7bbee1, 0xbd4fbf42, 0x3f30bf7f, 0xbf603e1b, 0xbe4e3f66, 0x3f80bf27, 0x3f3a3dcf, 0x3ef8bf7d
.long 0xbeb23f6b, 0x3f74bee1, 0xbe1b3f52, 0x3f7fbf1d, 0xbf703eca, 0xbe993f66, 0xbf7d3f12, 0xbdcf3f4a
.long 0xbf603f07, 0x3f6bbee1, 0xbf7f3e1b, 0x3f80bd4f, 0xbef8bf59, 0x3eca3f66, 0xbdcfbf7d, 0x00003f80
.long 0x3d4fbf7f, 0xbeb23f7b, 0x3f74bee1, 0xbf803e1b, 0x3f80bdcf, 0xbf70be4e, 0x3e993f66, 0x0000bf7d
.long 0x3f523eb2, 0xbee1bf42, 0xbf603f30, 0x3f80be80, 0xbf123f70, 0x3f66bf27, 0xbef8bf3a, 0x00003f78
.long 0xbf6b3f30, 0x3f74bd4f, 0x3f42bf60, 0xbf803eb2, 0xbecabf3a, 0xbe993f80, 0x3f273ef8, 0x0000bf70
.long 0x3e1bbf74, 0xbf603f52, 0xbf1d3f7b, 0x3f80bee1, 0x3f7dbe99, 0xbef8bf12, 0xbf4abe4e, 0x00003f66
.long 0x3f423e1b, 0x3e80bf74, 0x3ee1bf7f, 0xbf803f07, 0xbf273f7d, 0x3f78be99, 0x3f66bdcf, 0x0000bf59
.long 0xbf743f52, 0x3f073eb2, 0xbe803f6b, 0x3f80bf1d, 0xbe99bf12, 0xbf593f70, 0xbf783eca, 0x00003f4a
.long 0x3e80bf60, 0xbf7b3f07, 0x3d4fbf42, 0xbf803f30, 0x3f78bef8, 0x3e4ebf59, 0x3f80bf27, 0x0000bf3a
.long 0xbf7fbd4f, 0x3f7b3e1b, 0xbf60bee1, 0x3f523f07, 0x3dcfbf80, 0xbe4e3f7d, 0x3ef8bf66, 0xbf123f59
.long 0x3f743e1b, 0xbf52bee1, 0x3d4f3f7b, 0x3e80bf7f, 0xbe993f7d, 0x3f12bf66, 0xbf803e4e, 0x3f783dcf
.long 0xbf60be80, 0x3f073f30, 0x3f52bf42, 0xbf7f3eb2, 0x3ef8bf78, 0xbf593f3a, 0x3f123f27, 0xbdcfbf70
.long 0x3f423eb2, 0xbe1bbf60, 0xbf6bbd4f, 0x3ee13f30, 0xbf273f70, 0x3f7dbef8, 0x3ecabf80, 0xbf663f3a
.long 0xbf1dbee1, 0xbe803f7b, 0x3e1b3f52, 0x3f30bf74, 0x3f4abf66, 0xbf783e4e, 0xbf7d3f12, 0x3f3a3e99
.long 0x3ee13f07, 0x3f1dbf7f, 0x3f42bf74, 0xbf6b3e1b, 0xbf663f59, 0x3f4a3dcf, 0x3f273e99, 0x3ecabf7d
.long 0xbe80bf1d, 0xbf603f6b, 0xbf743eb2, 0xbd4f3f52, 0x3f78bf4a, 0xbef8beca, 0x3e99bf70, 0xbf803f12
.long 0x3d4f3f30, 0x3f7fbf42, 0x3e803f07, 0x3f74bf60, 0xbf803f3a, 0x3dcf3f27, 0xbf783f59, 0x3e993ef8
.long 0xbf74be80, 0x3f6b3eb2, 0xbf42bf1d, 0x3f303f30, 0x3e99bf78, 0xbeca3f70, 0x3f27bf4a, 0xbf3a3f3a
.long 0x3f1d3f30, 0xbeb2bf60, 0xbf073f6b, 0x3f42bf42, 0xbf4a3f3a, 0x3f70bef8, 0xbf59beca, 0x3f273f27
.long 0xbd4fbf74, 0xbee13f7b, 0x3f6b3e1b, 0xbf1dbf1d, 0x3f80be99, 0xbf66be4e, 0xbeca3f7d, 0x3f4abf4a
.long 0xbf073f7b, 0x3f74bf1d, 0x3e80bf7f, 0xbf523f52, 0xbf59be4e, 0x3e993f4a, 0x3f78bdcf, 0xbf12bf12
.long 0x3f6bbf42, 0xbf60bd4f, 0xbf7f3eb2, 0x3f073f07, 0x3eca3f27, 0x3ef8bf80, 0x3dcfbf70, 0xbf593f59
.long 0xbf7b3eb2, 0x3e803f30, 0x3d4f3f52, 0x3f60bf60, 0x3e4ebf70, 0xbf783f3a, 0xbf803f12, 0x3ef83ef8
.long 0x3f303e1b, 0x3f07bf7f, 0x3f7bbf42, 0xbee1bee1, 0xbf3a3f7d, 0x3f59bdcf, 0x3e4e3f27, 0x3f66bf66
.long 0xbe1bbf1d, 0xbf7b3f52, 0xbeb2bee1, 0xbf6b3f6b, 0x3f7dbf4a, 0xbe4ebf12, 0x3f70bf66, 0xbecabeca
.long 0xbf1dbf42, 0x3f073f52, 0xbe80bf74, 0x3e1b3f7b, 0x3f4abf27, 0xbf593f12, 0x3f78be99, 0xbf7d3e4e
.long 0xbf6b3f07, 0x3f7fbe80, 0xbf30bf1d, 0x3ee13f52, 0xbecabf59, 0x3dcf3f78, 0x3f3abf4a, 0xbf663f12
.long 0x3e1b3f6b, 0x3eb2bf7f, 0xbf74bd4f, 0x3f303f07, 0xbf7d3eca, 0x3f703dcf, 0x3e99bf80, 0xbf3a3f59
.long 0x3f7fbe80, 0xbf30bee1, 0xbf7b3f07, 0x3f603e1b, 0xbdcf3f78, 0x3f3abf66, 0xbe4ebf59, 0xbef83f7d
.long 0x3eb2bf7f, 0xbf743f30, 0xbf423f6b, 0x3f7bbe80, 0x3f70bdcf, 0xbe99bf3a, 0xbf27beca, 0xbe4e3f78
.long 0xbf52bd4f, 0xbe1b3f6b, 0xbeb23f7b, 0x3f7fbf1d, 0x3f12bf80, 0xbf7d3eca, 0xbf703e4e, 0x3dcf3f4a
.long 0xbf423f7b, 0x3f52bd4f, 0x3e1b3f30, 0x3f6bbf60, 0xbf27be4e, 0xbf123f80, 0xbf7d3f3a, 0x3eca3ef8
.long 0x3ee13eb2, 0x3f60bf74, 0x3f1d3e1b, 0x3f42bf7f, 0xbf663f70, 0x3ef83e99, 0xbf4a3f7d, 0x3f273dcf
.long 0xbee1bf60, 0x3eb23f6b, 0xbd4fbf7f, 0x00000000, 0x3f66bef8, 0xbf703eca, 0x3f80bdcf, 0x00000000
.long 0xbf7bbd4f, 0x3f603eb2, 0xbe1bbf74, 0x00000000, 0x3e4ebf80, 0xbef83f70, 0x3f7dbe99, 0x00000000
.long 0xbf423f52, 0x3f7bbee1, 0xbe80bf60, 0x00000000, 0xbf27bf12, 0x3e4e3f66, 0x3f78bef8, 0x00000000
.long 0x3d4f3f6b, 0x3f1dbf74, 0xbeb2bf42, 0x00000000, 0xbf803eca, 0x3f4a3e99, 0x3f70bf27, 0x00000000
.long 0x3f523e1b, 0xbd4fbf60, 0xbee1bf1d, 0x00000000, 0xbf123f7d, 0x3f80bef8, 0x3f66bf4a, 0x00000000
.long 0x3f74bf42, 0xbf30be80, 0xbf07bee1, 0x00000000, 0x3e993f27, 0x3f3abf78, 0x3f59bf66, 0x00000000
.long 0x3eb2bf74, 0xbf7f3f07, 0xbf1dbe80, 0x00000000, 0x3f70be99, 0x3dcfbf59, 0x3f4abf78, 0x00000000
.long 0xbf07be80, 0xbf523f7b, 0xbf30bd4f, 0x00000000, 0x3f59bf78, 0xbf12be4e, 0x3f3abf80, 0x00000000
.long 0xbf423f80, 0x3f073e1b, 0xbf7f3f52, 0xbd4f3f30, 0xbf270000, 0xbf593f7d, 0xbdcfbf12, 0xbf803f3a
.long 0xbf523f80, 0x3e803eb2, 0xbf303e1b, 0xbf6b3f7b, 0xbf120000, 0xbf783f70, 0x3f3abf7d, 0xbecabe4e
.long 0xbf603f80, 0xbd4f3f07, 0x3e1bbf1d, 0xbf423eb2, 0xbef80000, 0xbf803f59, 0x3f7dbf4a, 0x3f27bf70
.long 0xbf6b3f80, 0xbeb23f30, 0x3f60bf7f, 0x3e80bf1d, 0xbeca0000, 0xbf703f3a, 0x3ef8bdcf, 0x3f78bf4a
.long 0xbf743f80, 0xbf1d3f52, 0x3f6bbf42, 0x3f7bbf7f, 0xbe990000, 0xbf4a3f12, 0xbeca3f27, 0x3e4e3dcf
.long 0xbf7b3f80, 0xbf523f6b, 0x3e80bd4f, 0x3f1dbee1, 0xbe4e0000, 0xbf123eca, 0xbf783f80, 0xbf4a3f66
.long 0xbf7f3f80, 0xbf743f7b, 0xbf1d3f30, 0xbee13f07, 0xbdcf0000, 0xbe993e4e, 0xbf4a3f3a, 0xbf663f59
.long 0xbf803f80, 0xbf803f80, 0xbf803f80, 0xbf803f80, 0x00000000, 0x00000000, 0x00000000, 0x00000000
.long 0x3f6bbf74, 0xbe80bee1, 0x3f7bbf1d, 0x3eb2bf60, 0x3eca3e99, 0x3f78bf66, 0xbe4e3f4a, 0x3f70bef8
.long 0x3f7fbf42, 0x3ee1bf60, 0x3d4f3f07, 0x3f74bf1d, 0xbdcf3f27, 0x3f66bef8, 0xbf803f59, 0xbe993f4a
.long 0x3f52bee1, 0x3f6bbf7f, 0xbf743f7b, 0xbe803f30, 0xbf123f66, 0x3eca3dcf, 0xbe99be4e, 0xbf783f3a
.long 0x3ee1bd4f, 0x3f74bf42, 0xbf073e1b, 0xbf7b3f52, 0xbf663f80, 0xbe993f27, 0x3f59bf7d, 0x3e4ebf12
.long 0xbd4f3eb2, 0x3f07be80, 0x3f30bf60, 0x3e1bbee1, 0xbf803f70, 0xbf593f78, 0x3f3abef8, 0x3f7dbf66
.long 0xbf073f30, 0xbe1b3eb2, 0x3f60bf42, 0x3f7fbf74, 0xbf593f3a, 0xbf7d3f70, 0xbef83f27, 0xbdcf3e99
.long 0xbf603f6b, 0xbf423f52, 0xbe803eb2, 0xbd4f3e1b, 0xbef83eca, 0xbf273f12, 0xbf783f70, 0xbf803f7d
.long 0xbf803f80, 0xbf803f80, 0xbf803f80, 0xbf803f80, 0x00000000, 0x00000000, 0x00000000, 0x00000000
.long 0xbf603eb2, 0xbf1d3f7b, 0xbee1be80, 0xbf743f6b, 0x3ef8bf70, 0xbf4a3e4e, 0x3f66bf78, 0xbe99beca
.long 0x3f1dbf74, 0xbf07bd4f, 0x3f60bee1, 0x3f42bf7f, 0x3f4abe99, 0x3f59bf80, 0xbef83f66, 0x3f27bdcf
.long 0x3f30be80, 0x3f7bbf74, 0xbf7f3f6b, 0xbee13f52, 0xbf3a3f78, 0x3e4e3e99, 0xbdcfbeca, 0xbf663f12
.long 0xbf523f7b, 0xbe1b3f07, 0x3f42bf74, 0x3d4fbee1, 0xbf123e4e, 0xbf7d3f59, 0x3f27be99, 0x3f80bf66
.long 0xbee13e1b, 0xbf603f30, 0xbe803f07, 0x3eb2bd4f, 0x3f66bf7d, 0x3ef8bf3a, 0xbf783f59, 0xbf703f80
.long 0x3f74bf7f, 0x3f42bf60, 0xbeb23e1b, 0xbf303f07, 0x3e99bdcf, 0x3f27bef8, 0x3f70bf7d, 0x3f3abf59
.long 0x3e1bbd4f, 0x3eb2be80, 0x3f52bf42, 0x3f6bbf60, 0xbf7d3f80, 0xbf703f78, 0xbf123f27, 0xbeca3ef8
.long 0xbf803f80, 0xbf803f80, 0xbf803f80, 0xbf803f80, 0x00000000, 0x00000000, 0x00000000, 0x00000000
.long 0x3f30bd4f, 0x3f52bf7f, 0x3e1b3f07, 0x3f80bf42, 0xbf3a3f80, 0x3f123dcf, 0xbf7d3f59, 0x00003f27
.long 0xbf7b3f6b, 0xbe1b3f30, 0xbeb2be80, 0xbf803f52, 0xbe4ebeca, 0xbf7d3f3a, 0x3f70bf78, 0x0000bf12
.long 0x3eb2bf42, 0xbf1d3e1b, 0x3f07bd4f, 0x3f80bf60, 0x3f70bf27, 0x3f4abf7d, 0xbf593f80, 0x00003ef8
.long 0x3f1dbe80, 0x3f7fbf60, 0xbf303eb2, 0xbf803f6b, 0xbf4a3f78, 0xbdcf3ef8, 0x3f3abf70, 0x0000beca
.long 0xbf7f3f7b, 0xbf423f6b, 0x3f52bf1d, 0x3f80bf74, 0xbdcfbe4e, 0xbf273eca, 0xbf123f4a, 0x00003e99
.long 0x3ee1bf1d, 0x3d4fbe80, 0xbf6b3f52, 0xbf803f7b, 0x3f66bf4a, 0x3f80bf78, 0x3ecabf12, 0x0000be4e
.long 0x3f07bee1, 0x3f30bf1d, 0x3f7bbf74, 0x3f80bf7f, 0xbf593f66, 0xbf3a3f4a, 0xbe4e3e99, 0x00003dcf
.long 0xbf803f80, 0xbf803f80, 0xbf803f80, 0xbf803f80, 0x00000000, 0x00000000, 0x00000000, 0x00000000
.long 0x3e1bbf42, 0xbf743f07, 0x3f30bf7f, 0xbf1dbd4f, 0x3f7dbf27, 0x3e99bf59, 0x3f3abdcf, 0x3f4abf80
.long 0xbeb23f52, 0x3f42be80, 0xbf7b3f30, 0xbf073f6b, 0xbf703f12, 0xbf273f78, 0x3e4ebf3a, 0xbf593eca
.long 0x3f07bf60, 0xbee1bd4f, 0x3eb23e1b, 0x3f7bbf42, 0x3f59bef8, 0x3f66bf80, 0xbf703f7d, 0xbe4e3f27
.long 0xbf303f6b, 0x3d4f3eb2, 0x3f1dbf60, 0xbe1bbe80, 0xbf3a3eca, 0xbf803f70, 0x3f4abef8, 0x3f7dbf78
.long 0x3f52bf74, 0x3eb2bf1d, 0xbf7f3f6b, 0xbf603f7b, 0x3f12be99, 0x3f70bf4a, 0x3dcfbeca, 0xbef83e4e
.long 0xbf6b3f7b, 0xbf303f52, 0x3ee1be80, 0x3f42bf1d, 0xbeca3e4e, 0xbf3a3f12, 0xbf663f78, 0xbf273f4a
.long 0x3f7bbf7f, 0x3f6bbf74, 0x3f07bf1d, 0x3eb2bee1, 0x3e4ebdcf, 0x3ecabe99, 0x3f59bf4a, 0x3f70bf66
.long 0xbf803f80, 0xbf803f80, 0xbf803f80, 0xbf803f80, 0x00000000, 0x00000000, 0x00000000, 0x00000000
.long 0xbee13f6b, 0x3f52be80, 0xbf603f7b, 0x3eb23eb2, 0xbf663eca, 0xbf123f78, 0xbef8be4e, 0xbf703f70
.long 0x3f60bf7f, 0xbe1bbee1, 0x3f1dbd4f, 0x3f74bf74, 0x3ef83dcf, 0x3f7dbf66, 0xbf4a3f80, 0x3e993e99
.long 0xbf7f3f52, 0xbf1d3f6b, 0x3f30bf74, 0xbe80be80, 0x3dcfbf12, 0xbf4a3eca, 0x3f3abe99, 0x3f78bf78
.long 0x3f42bee1, 0x3f7fbf74, 0xbf523f07, 0xbf7b3f7b, 0xbf273f66, 0x3dcf3e99, 0x3f12bf59, 0xbe4ebe4e
.long 0xbe80bd4f, 0xbf423f07, 0xbee13f30, 0x3e1b3e1b, 0x3f78bf80, 0x3f27bf59, 0xbf663f3a, 0xbf7d3f7d
.long 0xbeb23f07, 0x3d4f3e1b, 0x3f74bf60, 0x3f7fbf7f, 0xbf703f59, 0xbf803f7d, 0xbe993ef8, 0x3dcf3dcf
.long 0x3f52bf60, 0x3f30bf42, 0x3e1bbe80, 0xbd4fbd4f, 0x3f12bef8, 0x3f3abf27, 0x3f7dbf78, 0x3f80bf80
.long 0xbf803f80, 0xbf803f80, 0xbf803f80, 0xbf803f80, 0x00000000, 0x00000000, 0x00000000, 0x00000000
.long 0x3f7bbf60, 0xbd4fbf1d, 0x3f6bbee1, 0x3f07bf74, 0x3e4e3ef8, 0x3f80bf4a, 0xbeca3f66, 0x3f59be99
.long 0x3d4fbf1d, 0xbf6b3f07, 0x3f7fbf60, 0x3e80bf42, 0x3f80bf4a, 0x3ecabf59, 0x3dcf3ef8, 0x3f78bf27
.long 0xbf743f30, 0xbf423f7b, 0x3f52bf7f, 0xbd4fbee1, 0x3e99bf3a, 0xbf273e4e, 0x3f12bdcf, 0x3f80bf66
.long 0xbf073f52, 0x3e803e1b, 0x3ee1bf42, 0xbeb2bd4f, 0xbf593f12, 0xbf783f7d, 0x3f66bf27, 0x3f70bf80
.long 0x3f30bee1, 0x3f7bbf60, 0xbd4fbe80, 0xbf1d3eb2, 0xbf3a3f66, 0xbe4e3ef8, 0x3f80bf78, 0x3f4abf70
.long 0x3f60bf74, 0x3f1dbf42, 0xbf073eb2, 0xbf523f30, 0x3ef8be99, 0x3f4abf27, 0x3f59bf70, 0x3f12bf3a
.long 0xbe803e1b, 0xbee13eb2, 0xbf603f52, 0xbf743f6b, 0x3f78bf7d, 0x3f66bf70, 0x3ef8bf12, 0x3e99beca
.long 0xbf803f80, 0xbf803f80, 0xbf803f80, 0xbf803f80, 0x00000000, 0x00000000, 0x00000000, 0x00000000
.long 0xbf7f3f30, 0xbe803f52, 0xbf423e1b, 0x00000000, 0x3dcfbf3a, 0xbf783f12, 0x3f27bf7d, 0x00000000
.long 0xbf303f7b, 0x3ee13e1b, 0xbf523eb2, 0x00000000, 0xbf3a3e4e, 0xbf663f7d, 0x3f12bf70, 0x00000000
.long 0x3e1b3eb2, 0x3f6bbf1d, 0xbf603f07, 0x00000000, 0xbf7d3f70, 0xbeca3f4a, 0x3ef8bf59, 0x00000000
.long 0x3f60bf1d, 0x3f74bf7f, 0xbf6b3f30, 0x00000000, 0xbef83f4a, 0x3e993dcf, 0x3ecabf3a, 0x00000000
.long 0x3f6bbf7f, 0x3f07bf42, 0xbf743f52, 0x00000000, 0x3ecabdcf, 0x3f59bf27, 0x3e99bf12, 0x00000000
.long 0x3e80bee1, 0xbe1bbd4f, 0xbf7b3f6b, 0x00000000, 0x3f78bf66, 0x3f7dbf80, 0x3e4ebeca, 0x00000000
.long 0xbf1d3f07, 0xbf423f30, 0xbf7f3f7b, 0x00000000, 0x3f4abf59, 0x3f27bf3a, 0x3dcfbe4e, 0x00000000
.long 0xbf803f80, 0xbf803f80, 0xbf803f80, 0x00000000, 0x00000000, 0x00000000, 0x00000000, 0x00000000
.long 0x00003c84, 0xbc973cd9, 0xbcacbcc9, 0xbb56bd03, 0x00003c84, 0xbcac3cc9, 0xbc1ebcfc, 0x3c50bcf3
.long 0x00003c84, 0xbcc03cb6, 0x3b56bd03, 0x3cd1bca2, 0x00003c84, 0xbcd13ca2, 0x3c80bce7, 0x3d03bba0
.long 0x00003c84, 0xbce03c8c, 0x3cd1bca2, 0x3cf83c38, 0x00003c84, 0xbced3c69, 0x3d00bc04, 0x3cac3cc9
.long 0x00003c84, 0xbcf83c38, 0x3d033ba0, 0x3bd53d01, 0x00003c84, 0xbd003c04, 0x3ce03c8c, 0xbc1e3cfc
.long 0x00003c84, 0xbd033ba0, 0x3c973cd9, 0xbcc03cb6, 0x00003c84, 0xbd043ad6, 0x3bd53d01, 0xbd003c04
.long 0x00003c84, 0xbd04bad6, 0xbbd53d01, 0xbd00bc04, 0x00003c84, 0xbd03bba0, 0xbc973cd9, 0xbcc0bcb6
.long 0x00003c84, 0xbd00bc04, 0xbce03c8c, 0xbc1ebcfc, 0x00003c84, 0xbcf8bc38, 0xbd033ba0, 0x3bd5bd01
.long 0x00003c84, 0xbcedbc69, 0xbd00bc04, 0x3cacbcc9, 0x00003c84, 0xbce0bc8c, 0xbcd1bca2, 0x3cf8bc38
.long 0xbcf83c38, 0xbd00bc04, 0x3c80bce7, 0x3cedbc69, 0xbd033ba0, 0xbce0bc8c, 0x3cedbc69, 0x3d003c04
.long 0xbd04bad6, 0xbcacbcc9, 0x3d033ba0, 0x3c973cd9, 0xbd00bc04, 0xbc50bcf3, 0x3cc03cb6, 0xbb563d03
.long 0xbcedbc69, 0xbb56bd03, 0x3bd53d01, 0xbcc03cb6, 0xbcd1bca2, 0x3bd5bd01, 0xbc503cf3, 0xbd043ad6
.long 0xbcacbcc9, 0x3c80bce7, 0xbce03c8c, 0xbcd1bca2, 0xbc80bce7, 0x3cc0bcb6, 0xbd04bad6, 0xbbd5bd01
.long 0xbc1ebcfc, 0x3cedbc69, 0xbcd1bca2, 0x3c80bce7, 0xbb56bd03, 0x3d03bba0, 0xbc1ebcfc, 0x3cf8bc38
.long 0x3b56bd03, 0x3d033ba0, 0x3c1ebcfc, 0x3cf83c38, 0x3c1ebcfc, 0x3ced3c69, 0x3cd1bca2, 0x3c803ce7
.long 0x3c80bce7, 0x3cc03cb6, 0x3d04bad6, 0xbbd53d01, 0x3cacbcc9, 0x3c803ce7, 0x3ce03c8c, 0xbcd13ca2
.long 0x3cd1bca2, 0x3bd53d01, 0x3c503cf3, 0xbd04bad6, 0x3cedbc69, 0xbb563d03, 0xbbd53d01, 0xbcc0bcb6
.long 0x3d033ba0, 0x3cc03cb6, 0xbce03c8c, 0xbd04bad6, 0x3c973cd9, 0xbb563d03, 0xbcd1bca2, 0xbbd5bd01
.long 0xbbd53d01, 0xbce03c8c, 0x3c1ebcfc, 0x3cedbc69, 0xbce03c8c, 0xbcf8bc38, 0x3d04bad6, 0x3cac3cc9
.long 0xbd00bc04, 0xbc1ebcfc, 0x3c503cf3, 0xbc973cd9, 0xbc80bce7, 0x3c97bcd9, 0xbcc03cb6, 0xbcf8bc38
.long 0x3c1ebcfc, 0x3d04bad6, 0xbcedbc69, 0x3b56bd03, 0x3cedbc69, 0x3cac3cc9, 0x3b56bd03, 0x3d03bba0
.long 0x3cf83c38, 0xbbd53d01, 0x3d00bc04, 0x3c503cf3, 0x3c503cf3, 0xbced3c69, 0x3c973cd9, 0xbcd13ca2
.long 0xbc503cf3, 0xbcedbc69, 0xbc973cd9, 0xbcd1bca2, 0xbcf83c38, 0xbbd5bd01, 0xbd00bc04, 0x3c50bcf3
.long 0xbcedbc69, 0x3cacbcc9, 0xbb56bd03, 0x3d033ba0, 0xbc1ebcfc, 0x3d043ad6, 0x3cedbc69, 0x3b563d03
.long 0x3c80bce7, 0x3c973cd9, 0x3cc03cb6, 0xbcf83c38, 0x3d00bc04, 0xbc1e3cfc, 0xbc503cf3, 0xbc97bcd9
.long 0x3bd53d01, 0xbc503cf3, 0xbcd1bca2, 0xbc1ebcfc, 0xbcc03cb6, 0xbd043ad6, 0x3c80bce7, 0x3cf8bc38
.long 0xbd00bc04, 0xbc80bce7, 0x3cf83c38, 0x3c503cf3, 0xbc1ebcfc, 0x3c97bcd9, 0xbbd53d01, 0xbced3c69
.long 0x3cacbcc9, 0x3d033ba0, 0xbd04bad6, 0xbc80bce7, 0x3d033ba0, 0x3c1e3cfc, 0xbb56bd03, 0x3ce0bc8c
.long 0x3c503cf3, 0xbcc03cb6, 0x3d00bc04, 0x3c973cd9, 0xbc973cd9, 0xbcf8bc38, 0x3c503cf3, 0xbcd13ca2
.long 0xbd04bad6, 0xbb56bd03, 0xbce03c8c, 0xbcacbcc9, 0xbc80bce7, 0x3ce0bc8c, 0xbcacbcc9, 0x3cc0bcb6
.long 0x3c80bce7, 0x3ce03c8c, 0x3cacbcc9, 0x3cc03cb6, 0x3d04bad6, 0xbb563d03, 0x3ce03c8c, 0xbcac3cc9
.long 0x3c973cd9, 0xbcf83c38, 0xbc503cf3, 0xbcd1bca2, 0xbc503cf3, 0xbcc0bcb6, 0xbd00bc04, 0x3c97bcd9
.long 0xbd033ba0, 0x3c1ebcfc, 0x3b56bd03, 0x3ce03c8c, 0xbcacbcc9, 0x3d03bba0, 0x3d04bad6, 0xbc803ce7
.long 0x3c1ebcfc, 0x3cd1bca2, 0x3c503cf3, 0xbbd53d01, 0x3cf83c38, 0x3c803ce7, 0xbd04bad6, 0xbcc0bcb6
.long 0xbc503cf3, 0xbcf83c38, 0x3c80bce7, 0x3d00bc04, 0xbcedbc69, 0xbbd5bd01, 0x3c973cd9, 0xbc1e3cfc
.long 0x3c80bce7, 0x3d04bad6, 0xbd033ba0, 0xbcacbcc9, 0x3ce03c8c, 0xbb563d03, 0x3c1ebcfc, 0x3d03bba0
.long 0xbc973cd9, 0xbd00bc04, 0x3cc03cb6, 0xbc503cf3, 0xbcd1bca2, 0x3c50bcf3, 0xbcf83c38, 0xbc97bcd9
.long 0x3cacbcc9, 0x3ce03c8c, 0x3b56bd03, 0x3d04bad6, 0x3cc03cb6, 0xbcac3cc9, 0x3ce03c8c, 0xbc803ce7
.long 0xbcc03cb6, 0xbcacbcc9, 0xbce03c8c, 0xbc80bce7, 0xbcacbcc9, 0x3ce0bc8c, 0xbb56bd03, 0x3d043ad6
.long 0x3cd1bca2, 0x3c503cf3, 0x3cf83c38, 0xbc973cd9, 0x3c973cd9, 0xbd003c04, 0xbcc03cb6, 0xbc50bcf3
.long 0xbce03c8c, 0xbb56bd03, 0xbc1ebcfc, 0x3d033ba0, 0xbc80bce7, 0x3d043ad6, 0x3d033ba0, 0xbcac3cc9
.long 0x3d04bad6, 0x3ce03c8c, 0xbcc03cb6, 0xbd033ba0, 0xbbd53d01, 0xbcd13ca2, 0xbb56bd03, 0x3c97bcd9
.long 0xbcedbc69, 0xbc1ebcfc, 0x3ce03c8c, 0x3bd53d01, 0x3cacbcc9, 0x3d043ad6, 0xbcf83c38, 0xbce0bc8c
.long 0x3c973cd9, 0xbc503cf3, 0x3c1ebcfc, 0x3d00bc04, 0xbcf83c38, 0xbcc0bcb6, 0x3c973cd9, 0xbc803ce7
.long 0xbb56bd03, 0x3cedbc69, 0xbd04bad6, 0xbc1ebcfc, 0x3d033ba0, 0x3b563d03, 0x3cacbcc9, 0x3ced3c69
.long 0xbc503cf3, 0xbd00bc04, 0x3bd53d01, 0xbcf83c38, 0xbcd1bca2, 0x3c97bcd9, 0xbcedbc69, 0x3c50bcf3
.long 0x3cd1bca2, 0x3c973cd9, 0x3cedbc69, 0x3c503cf3, 0x3c503cf3, 0xbd003c04, 0xbbd53d01, 0xbcf8bc38
.long 0xbd033ba0, 0x3b56bd03, 0xbcacbcc9, 0x3cedbc69, 0x3b56bd03, 0x3ced3c69, 0x3d04bad6, 0xbc1e3cfc
.long 0x3cf83c38, 0xbcc03cb6, 0xbc973cd9, 0xbc80bce7, 0xbc973cd9, 0xbc50bcf3, 0xbc1ebcfc, 0x3d003c04
.long 0xbcedbc69, 0xbc80bce7, 0x3d00bc04, 0x3cf83c38, 0x3d00bc04, 0x3ced3c69, 0xbce03c8c, 0xbd03bba0
.long 0xbc973cd9, 0xbd033ba0, 0x3cacbcc9, 0x3d04bad6, 0xbb56bd03, 0x3cc0bcb6, 0xbc503cf3, 0xbd003c04
.long 0x3cc03cb6, 0xbbd53d01, 0x3b56bd03, 0x3cedbc69, 0xbd04bad6, 0xbc50bcf3, 0x3bd53d01, 0xbcd13ca2
.long 0x3cd1bca2, 0x3ce03c8c, 0xbc80bce7, 0x3cacbcc9, 0xbbd53d01, 0xbd043ad6, 0x3cc03cb6, 0xbc803ce7
.long 0xbc80bce7, 0x3cd1bca2, 0xbcedbc69, 0x3c1ebcfc, 0x3cf83c38, 0xbc1e3cfc, 0x3d033ba0, 0xbb563d03
.long 0xbcf83c38, 0xbc1ebcfc, 0xbd033ba0, 0xbb56bd03, 0x3c80bce7, 0x3cd13ca2, 0x3cedbc69, 0x3c1e3cfc
.long 0x3bd53d01, 0xbd04bad6, 0xbcc03cb6, 0xbc80bce7, 0xbcd1bca2, 0x3ce0bc8c, 0x3c80bce7, 0x3cac3cc9
.long 0x3d04bad6, 0xbc503cf3, 0xbbd53d01, 0xbcd1bca2, 0xbcc03cb6, 0xbbd5bd01, 0xbb56bd03, 0x3ced3c69
.long 0x3b56bd03, 0x3cacbcc9, 0x3c973cd9, 0x00003c84, 0x3c503cf3, 0xbc1e3cfc, 0xbcacbcc9, 0x0000bc84
.long 0xbcd1bca2, 0xbb56bd03, 0x3cc03cb6, 0x00003c84, 0x3d033ba0, 0x3c803ce7, 0xbcd1bca2, 0x0000bc84
.long 0xbcf83c38, 0xbcd1bca2, 0x3ce03c8c, 0x00003c84, 0x3cacbcc9, 0x3d003c04, 0xbcedbc69, 0x0000bc84
.long 0xbbd53d01, 0xbd033ba0, 0x3cf83c38, 0x00003c84, 0xbc1ebcfc, 0x3ce0bc8c, 0xbd00bc04, 0x0000bc84
.long 0x3cc03cb6, 0xbc973cd9, 0x3d033ba0, 0x00003c84, 0xbd00bc04, 0x3bd5bd01, 0xbd04bad6, 0x0000bc84
.long 0x3d00bc04, 0x3bd53d01, 0x3d04bad6, 0x00003c84, 0xbcc03cb6, 0xbc97bcd9, 0xbd033ba0, 0x0000bc84
.long 0x3c1ebcfc, 0x3ce03c8c, 0x3d00bc04, 0x00003c84, 0x3bd53d01, 0xbd03bba0, 0xbcf83c38, 0x0000bc84
.long 0xbcacbcc9, 0x3d00bc04, 0x3cedbc69, 0x00003c84, 0x3cf83c38, 0xbcd13ca2, 0xbce03c8c, 0x0000bc84
.long 0x00003c84, 0xbcd1bca2, 0xbc80bce7, 0x3d033ba0, 0x00003c84, 0xbcc0bcb6, 0xbb56bd03, 0x3cd13ca2
.long 0x00003c84, 0xbcacbcc9, 0x3c1ebcfc, 0x3c503cf3, 0x00003c84, 0xbc97bcd9, 0x3cacbcc9, 0xbb563d03
.long 0x00003c84, 0xbc80bce7, 0x3cedbc69, 0xbc973cd9, 0x00003c84, 0xbc50bcf3, 0x3d04bad6, 0xbced3c69
.long 0x00003c84, 0xbc1ebcfc, 0x3cf83c38, 0xbd04bad6, 0x00003c84, 0xbbd5bd01, 0x3cc03cb6, 0xbce0bc8c
.long 0x00003c84, 0xbb56bd03, 0x3c503cf3, 0xbc80bce7, 0x00003c84, 0x0000bd04, 0x00003d04, 0x0000bd04
.long 0x00003c84, 0x3b56bd03, 0xbc503cf3, 0x3c80bce7, 0x00003c84, 0x3bd5bd01, 0xbcc03cb6, 0x3ce0bc8c
.long 0x00003c84, 0x3c1ebcfc, 0xbcf83c38, 0x3d04bad6, 0x00003c84, 0x3c50bcf3, 0xbd04bad6, 0x3ced3c69
.long 0x00003c84, 0x3c80bce7, 0xbcedbc69, 0x3c973cd9, 0x00003c84, 0x3c97bcd9, 0xbcacbcc9, 0x3b563d03
.long 0x3d00bc04, 0xbc503cf3, 0xbcc03cb6, 0xbb56bd03, 0x3d04bad6, 0xbcac3cc9, 0xbd033ba0, 0x3c97bcd9
.long 0x3d033ba0, 0xbce03c8c, 0xbcedbc69, 0x3d00bc04, 0x3cf83c38, 0xbd003c04, 0xbc80bce7, 0x3ced3c69
.long 0x3ce03c8c, 0xbd04bad6, 0x3b56bd03, 0x3c503cf3, 0x3cc03cb6, 0xbcf8bc38, 0x3cacbcc9, 0xbc1e3cfc
.long 0x3c973cd9, 0xbcd1bca2, 0x3d00bc04, 0xbce03c8c, 0x3c503cf3, 0xbc97bcd9, 0x3cf83c38, 0xbd03bba0
.long 0x3bd53d01, 0xbc1ebcfc, 0x3c973cd9, 0xbcacbcc9, 0x00003d04, 0x0000bd04, 0x00003d04, 0x0000bd04
.long 0xbbd53d01, 0x3c1ebcfc, 0xbc973cd9, 0x3cacbcc9, 0xbc503cf3, 0x3c97bcd9, 0xbcf83c38, 0x3d03bba0
.long 0xbc973cd9, 0x3cd1bca2, 0xbd00bc04, 0x3ce03c8c, 0xbcc03cb6, 0x3cf8bc38, 0xbcacbcc9, 0x3c1e3cfc
.long 0xbce03c8c, 0x3d04bad6, 0xbb56bd03, 0xbc503cf3, 0xbcf83c38, 0x3d003c04, 0x3c80bce7, 0xbced3c69
.long 0x3ce03c8c, 0xbcf83c38, 0xbd04bad6, 0x3cacbcc9, 0x3bd53d01, 0xbce0bc8c, 0xbc1ebcfc, 0x3ced3c69
.long 0xbc973cd9, 0xbb56bd03, 0x3cd1bca2, 0xbbd53d01, 0xbd033ba0, 0x3cc0bcb6, 0x3ce03c8c, 0xbd043ad6
.long 0xbcd1bca2, 0x3d033ba0, 0xbbd53d01, 0xbc1ebcfc, 0xbb56bd03, 0x3c803ce7, 0xbd033ba0, 0x3ce0bc8c
.long 0x3cacbcc9, 0xbc503cf3, 0xbc80bce7, 0x3cc03cb6, 0x3d04bad6, 0xbd003c04, 0x3cacbcc9, 0xbc803ce7
.long 0x3cc03cb6, 0xbcd1bca2, 0x3cf83c38, 0xbd00bc04, 0x00003d04, 0x0000bd04, 0x00003d04, 0x0000bd04
.long 0xbcc03cb6, 0x3cd1bca2, 0xbcf83c38, 0x3d00bc04, 0xbd04bad6, 0x3d003c04, 0xbcacbcc9, 0x3c803ce7
.long 0xbcacbcc9, 0x3c503cf3, 0x3c80bce7, 0xbcc03cb6, 0x3b56bd03, 0xbc803ce7, 0x3d033ba0, 0xbce0bc8c
.long 0x3cd1bca2, 0xbd033ba0, 0x3bd53d01, 0x3c1ebcfc, 0x3d033ba0, 0xbcc0bcb6, 0xbce03c8c, 0x3d043ad6
.long 0x3c1ebcfc, 0x3c973cd9, 0x3bd53d01, 0xbcedbc69, 0x3d00bc04, 0xbc803ce7, 0xbcf83c38, 0x3c50bcf3
.long 0x3cc03cb6, 0xbd04bad6, 0xbc80bce7, 0x3cf83c38, 0xbbd53d01, 0xbc50bcf3, 0x3cd1bca2, 0xbc1e3cfc
.long 0xbcf83c38, 0x3cacbcc9, 0x3cc03cb6, 0xbd00bc04, 0xbcd1bca2, 0x3d003c04, 0xbc973cd9, 0x3bd5bd01
.long 0x3b56bd03, 0x3bd53d01, 0xbcedbc69, 0x3d033ba0, 0x3cedbc69, 0xbcd13ca2, 0x3c1ebcfc, 0xbb563d03
.long 0x3ce03c8c, 0xbcedbc69, 0x3d033ba0, 0xbd04bad6, 0x00003d04, 0x0000bd04, 0x00003d04, 0x0000bd04
.long 0xbce03c8c, 0x3cedbc69, 0xbd033ba0, 0x3d04bad6, 0xbcedbc69, 0x3cd13ca2, 0xbc1ebcfc, 0x3b563d03
.long 0xbb56bd03, 0xbbd53d01, 0x3cedbc69, 0xbd033ba0, 0x3cd1bca2, 0xbd003c04, 0x3c973cd9, 0xbbd5bd01
.long 0x3cf83c38, 0xbcacbcc9, 0xbcc03cb6, 0x3d00bc04, 0x3bd53d01, 0x3c50bcf3, 0xbcd1bca2, 0x3c1e3cfc
.long 0x3cedbc69, 0xbbd53d01, 0xbc973cd9, 0xbc1ebcfc, 0x3c503cf3, 0xbcf8bc38, 0xbc80bce7, 0x3d003c04
.long 0xbcf83c38, 0x3c80bce7, 0x3d04bad6, 0xbcc03cb6, 0xbc1ebcfc, 0x3cd13ca2, 0xbc503cf3, 0xbbd5bd01
.long 0x3d00bc04, 0xbcc03cb6, 0xbcacbcc9, 0x3cf83c38, 0x3bd53d01, 0xbc97bcd9, 0x3d00bc04, 0xbcd13ca2
.long 0xbd033ba0, 0x3cedbc69, 0xbbd53d01, 0xbb56bd03, 0xbb56bd03, 0x3c1e3cfc, 0xbcd1bca2, 0x3ced3c69
.long 0x3d04bad6, 0xbd033ba0, 0x3cedbc69, 0xbce03c8c, 0x00003d04, 0x0000bd04, 0x00003d04, 0x0000bd04
.long 0xbd04bad6, 0x3d033ba0, 0xbcedbc69, 0x3ce03c8c, 0x3b56bd03, 0xbc1e3cfc, 0x3cd1bca2, 0xbced3c69
.long 0x3d033ba0, 0xbcedbc69, 0x3bd53d01, 0x3b56bd03, 0xbbd53d01, 0x3c97bcd9, 0xbd00bc04, 0x3cd13ca2
.long 0xbd00bc04, 0x3cc03cb6, 0x3cacbcc9, 0xbcf83c38, 0x3c1ebcfc, 0xbcd13ca2, 0x3c503cf3, 0x3bd5bd01
.long 0xbcacbcc9, 0x3d04bad6, 0x3cf83c38, 0xbce03c8c, 0x3cedbc69, 0xbc1e3cfc, 0xbce03c8c, 0x3bd5bd01
.long 0x3bd53d01, 0xbcd1bca2, 0x3b56bd03, 0x3c973cd9, 0xbd04bad6, 0x3ce0bc8c, 0x3cc03cb6, 0xbd03bba0
.long 0x3c1ebcfc, 0x3bd53d01, 0xbd033ba0, 0x3cd1bca2, 0x3ce03c8c, 0xbd03bba0, 0x3c80bce7, 0xbb563d03
.long 0xbcc03cb6, 0x3c80bce7, 0x3c503cf3, 0xbcacbcc9, 0xbc80bce7, 0x3cac3cc9, 0xbd00bc04, 0x3d043ad6
.long 0x3d00bc04, 0xbcf83c38, 0x3cd1bca2, 0xbcc03cb6, 0x00003d04, 0x0000bd04, 0x00003d04, 0x0000bd04
.long 0xbd00bc04, 0x3cf83c38, 0xbcd1bca2, 0x3cc03cb6, 0x3c80bce7, 0xbcac3cc9, 0x3d00bc04, 0xbd043ad6
.long 0x3cc03cb6, 0xbc80bce7, 0xbc503cf3, 0x3cacbcc9, 0xbce03c8c, 0x3d03bba0, 0xbc80bce7, 0x3b563d03
.long 0xbc1ebcfc, 0xbbd53d01, 0x3d033ba0, 0xbcd1bca2, 0x3d04bad6, 0xbce0bc8c, 0xbcc03cb6, 0x3d03bba0
.long 0x3b56bd03, 0x3cc03cb6, 0x3c503cf3, 0xbd00bc04, 0x3c973cd9, 0xbd03bba0, 0xbcacbcc9, 0x3d043ad6
.long 0xbd00bc04, 0x3cedbc69, 0x3ce03c8c, 0xbd033ba0, 0x3cedbc69, 0xbc803ce7, 0xbd00bc04, 0x3cf8bc38
.long 0xbc503cf3, 0xbb56bd03, 0x3d04bad6, 0xbce03c8c, 0xbc1ebcfc, 0x3cac3cc9, 0xbcf83c38, 0x3cc0bcb6
.long 0x3ce03c8c, 0xbd00bc04, 0x3cd1bca2, 0xbc973cd9, 0xbd033ba0, 0x3cf8bc38, 0xbc973cd9, 0x3c50bcf3
.long 0x3cacbcc9, 0xbc973cd9, 0x3c1ebcfc, 0xbbd53d01, 0x00003d04, 0x0000bd04, 0x00003d04, 0x0000bd04
.long 0xbcacbcc9, 0x3c973cd9, 0xbc1ebcfc, 0x3bd53d01, 0x3d033ba0, 0xbcf8bc38, 0x3c973cd9, 0xbc50bcf3
.long 0xbce03c8c, 0x3d00bc04, 0xbcd1bca2, 0x3c973cd9, 0x3c1ebcfc, 0xbcac3cc9, 0x3cf83c38, 0xbcc0bcb6
.long 0x3c503cf3, 0x3b56bd03, 0xbd04bad6, 0x3ce03c8c, 0xbcedbc69, 0x3c803ce7, 0x3d00bc04, 0xbcf8bc38
.long 0xbd033ba0, 0x3c80bce7, 0x3cd1bca2, 0x00003c84, 0x3cd1bca2, 0xbb563d03, 0xbcc03cb6, 0x0000bc84
.long 0xbc503cf3, 0xbc1ebcfc, 0x3cacbcc9, 0x00003c84, 0xbb56bd03, 0x3cac3cc9, 0xbc973cd9, 0x0000bc84
.long 0x3c973cd9, 0xbcedbc69, 0x3c80bce7, 0x00003c84, 0xbcedbc69, 0x3d043ad6, 0xbc503cf3, 0x0000bc84
.long 0x3d04bad6, 0xbcf83c38, 0x3c1ebcfc, 0x00003c84, 0xbce03c8c, 0x3cc0bcb6, 0xbbd53d01, 0x0000bc84
.long 0x3c80bce7, 0xbc503cf3, 0x3b56bd03, 0x00003c84, 0x00003d04, 0x0000bd04, 0x00003d04, 0x0000bc84
.long 0xbc80bce7, 0x3c503cf3, 0xbb56bd03, 0x00003c84, 0x3ce03c8c, 0xbcc0bcb6, 0x3bd53d01, 0x0000bc84
.long 0xbd04bad6, 0x3cf83c38, 0xbc1ebcfc, 0x00003c84, 0x3cedbc69, 0xbd043ad6, 0x3c503cf3, 0x0000bc84
.long 0xbc973cd9, 0x3cedbc69, 0xbc80bce7, 0x00003c84, 0x3b56bd03, 0xbcac3cc9, 0x3c973cd9, 0x0000bc84
.long 0x00003c84, 0x3cacbcc9, 0xbc1ebcfc, 0xbc503cf3, 0x00003c84, 0x3cc0bcb6, 0x3b56bd03, 0xbcd13ca2
.long 0x00003c84, 0x3cd1bca2, 0x3c80bce7, 0xbd033ba0, 0x00003c84, 0x3ce0bc8c, 0x3cd1bca2, 0xbcf8bc38
.long 0x00003c84, 0x3cedbc69, 0x3d00bc04, 0xbcacbcc9, 0x00003c84, 0x3cf8bc38, 0x3d033ba0, 0xbbd5bd01
.long 0x00003c84, 0x3d00bc04, 0x3ce03c8c, 0x3c1ebcfc, 0x00003c84, 0x3d03bba0, 0x3c973cd9, 0x3cc0bcb6
.long 0x00003c84, 0x3d04bad6, 0x3bd53d01, 0x3d00bc04, 0x00003c84, 0x3d043ad6, 0xbbd53d01, 0x3d003c04
.long 0x00003c84, 0x3d033ba0, 0xbc973cd9, 0x3cc03cb6, 0x00003c84, 0x3d003c04, 0xbce03c8c, 0x3c1e3cfc
.long 0x00003c84, 0x3cf83c38, 0xbd033ba0, 0xbbd53d01, 0x00003c84, 0x3ced3c69, 0xbd00bc04, 0xbcac3cc9
.long 0x00003c84, 0x3ce03c8c, 0xbcd1bca2, 0xbcf83c38, 0x00003c84, 0x3cd13ca2, 0xbc80bce7, 0xbd03bba0
.long 0xbd033ba0, 0x3ce03c8c, 0x3cedbc69, 0xbd00bc04, 0xbd04bad6, 0x3cac3cc9, 0x3d033ba0, 0xbc97bcd9
.long 0xbd00bc04, 0x3c503cf3, 0x3cc03cb6, 0x3b56bd03, 0xbcedbc69, 0x3b563d03, 0x3bd53d01, 0x3cc0bcb6
.long 0xbcd1bca2, 0xbbd53d01, 0xbc503cf3, 0x3d04bad6, 0xbcacbcc9, 0xbc803ce7, 0xbce03c8c, 0x3cd13ca2
.long 0xbc80bce7, 0xbcc03cb6, 0xbd04bad6, 0x3bd53d01, 0xbc1ebcfc, 0xbced3c69, 0xbcd1bca2, 0xbc803ce7
.long 0xbb56bd03, 0xbd033ba0, 0xbc1ebcfc, 0xbcf83c38, 0x3b56bd03, 0xbd03bba0, 0x3c1ebcfc, 0xbcf8bc38
.long 0x3c1ebcfc, 0xbcedbc69, 0x3cd1bca2, 0xbc80bce7, 0x3c80bce7, 0xbcc0bcb6, 0x3d04bad6, 0x3bd5bd01
.long 0x3cacbcc9, 0xbc80bce7, 0x3ce03c8c, 0x3cd1bca2, 0x3cd1bca2, 0xbbd5bd01, 0x3c503cf3, 0x3d043ad6
.long 0x3cedbc69, 0x3b56bd03, 0xbbd53d01, 0x3cc03cb6, 0x3d00bc04, 0x3c50bcf3, 0xbcc03cb6, 0x3b563d03
.long 0x3c973cd9, 0x3b56bd03, 0xbcd1bca2, 0x3bd53d01, 0xbbd53d01, 0x3ce0bc8c, 0x3c1ebcfc, 0xbced3c69
.long 0xbce03c8c, 0x3cf83c38, 0x3d04bad6, 0xbcacbcc9, 0xbd00bc04, 0x3c1e3cfc, 0x3c503cf3, 0x3c97bcd9
.long 0xbc80bce7, 0xbc973cd9, 0xbcc03cb6, 0x3cf83c38, 0x3c1ebcfc, 0xbd043ad6, 0xbcedbc69, 0xbb563d03
.long 0x3cedbc69, 0xbcacbcc9, 0x3b56bd03, 0xbd033ba0, 0x3cf83c38, 0x3bd5bd01, 0x3d00bc04, 0xbc50bcf3
.long 0x3c503cf3, 0x3cedbc69, 0x3c973cd9, 0x3cd1bca2, 0xbc503cf3, 0x3ced3c69, 0xbc973cd9, 0x3cd13ca2
.long 0xbcf83c38, 0x3bd53d01, 0xbd00bc04, 0xbc503cf3, 0xbcedbc69, 0xbcac3cc9, 0xbb56bd03, 0xbd03bba0
.long 0xbc1ebcfc, 0xbd04bad6, 0x3cedbc69, 0xbb56bd03, 0x3c80bce7, 0xbc97bcd9, 0x3cc03cb6, 0x3cf8bc38
.long 0x3d00bc04, 0x3c1ebcfc, 0xbc503cf3, 0x3c973cd9, 0x3ce03c8c, 0x3cf8bc38, 0xbd04bad6, 0xbcac3cc9
.long 0xbcc03cb6, 0x3d04bad6, 0x3c80bce7, 0xbcf83c38, 0xbd00bc04, 0x3c803ce7, 0x3cf83c38, 0xbc50bcf3
.long 0xbc1ebcfc, 0xbc973cd9, 0xbbd53d01, 0x3cedbc69, 0x3cacbcc9, 0xbd03bba0, 0xbd04bad6, 0x3c803ce7
.long 0x3d033ba0, 0xbc1ebcfc, 0xbb56bd03, 0xbce03c8c, 0x3c503cf3, 0x3cc0bcb6, 0x3d00bc04, 0xbc97bcd9
.long 0xbc973cd9, 0x3cf83c38, 0x3c503cf3, 0x3cd1bca2, 0xbd04bad6, 0x3b563d03, 0xbce03c8c, 0x3cac3cc9
.long 0xbc80bce7, 0xbce03c8c, 0xbcacbcc9, 0xbcc03cb6, 0x3c80bce7, 0xbce0bc8c, 0x3cacbcc9, 0xbcc0bcb6
.long 0x3d04bad6, 0x3b56bd03, 0x3ce03c8c, 0x3cacbcc9, 0x3c973cd9, 0x3cf8bc38, 0xbc503cf3, 0x3cd13ca2
.long 0xbc503cf3, 0x3cc03cb6, 0xbd00bc04, 0xbc973cd9, 0xbd033ba0, 0xbc1e3cfc, 0x3b56bd03, 0xbce0bc8c
.long 0xbcacbcc9, 0xbd033ba0, 0x3d04bad6, 0x3c80bce7, 0x3c1ebcfc, 0xbc97bcd9, 0x3bd53d01, 0x3ced3c69
.long 0x3cf83c38, 0xbc80bce7, 0xbd04bad6, 0x3cc03cb6, 0xbc503cf3, 0x3cf8bc38, 0x3c80bce7, 0xbd003c04
.long 0xbcedbc69, 0x3bd53d01, 0x3c973cd9, 0x3c1ebcfc, 0x3c80bce7, 0xbd043ad6, 0xbd033ba0, 0x3cac3cc9
.long 0x3ce03c8c, 0x3b56bd03, 0x3c1ebcfc, 0xbd033ba0, 0xbc973cd9, 0x3d003c04, 0x3cc03cb6, 0x3c50bcf3
.long 0xbcd1bca2, 0xbc503cf3, 0xbcf83c38, 0x3c973cd9, 0x3cacbcc9, 0xbce0bc8c, 0x3b56bd03, 0xbd043ad6
.long 0x3cc03cb6, 0x3cacbcc9, 0x3ce03c8c, 0x3c80bce7, 0xbcc03cb6, 0x3cac3cc9, 0xbce03c8c, 0x3c803ce7
.long 0xbcacbcc9, 0xbce03c8c, 0xbb56bd03, 0xbd04bad6, 0x3cd1bca2, 0xbc50bcf3, 0x3cf83c38, 0x3c97bcd9
.long 0x3c973cd9, 0x3d00bc04, 0xbcc03cb6, 0x3c503cf3, 0xbce03c8c, 0x3b563d03, 0xbc1ebcfc, 0xbd03bba0
.long 0xbc80bce7, 0xbd04bad6, 0x3d033ba0, 0x3cacbcc9, 0x3cedbc69, 0x3bd5bd01, 0xbc973cd9, 0x3c1e3cfc
.long 0xbbd53d01, 0x3cd1bca2, 0xbb56bd03, 0xbc973cd9, 0xbcedbc69, 0x3c1e3cfc, 0x3ce03c8c, 0xbbd5bd01
.long 0x3cacbcc9, 0xbd04bad6, 0xbcf83c38, 0x3ce03c8c, 0x3c973cd9, 0x3c50bcf3, 0x3c1ebcfc, 0xbd003c04
.long 0xbcf83c38, 0x3cc03cb6, 0x3c973cd9, 0x3c80bce7, 0xbb56bd03, 0xbced3c69, 0xbd04bad6, 0x3c1e3cfc
.long 0x3d033ba0, 0xbb56bd03, 0x3cacbcc9, 0xbcedbc69, 0xbc503cf3, 0x3d003c04, 0x3bd53d01, 0x3cf8bc38
.long 0xbcd1bca2, 0xbc973cd9, 0xbcedbc69, 0xbc503cf3, 0x3cd1bca2, 0xbc97bcd9, 0x3cedbc69, 0xbc50bcf3
.long 0x3c503cf3, 0x3d00bc04, 0xbbd53d01, 0x3cf83c38, 0xbd033ba0, 0xbb563d03, 0xbcacbcc9, 0xbced3c69
.long 0x3b56bd03, 0xbcedbc69, 0x3d04bad6, 0x3c1ebcfc, 0x3cf83c38, 0x3cc0bcb6, 0xbc973cd9, 0x3c803ce7
.long 0xbc973cd9, 0x3c503cf3, 0xbc1ebcfc, 0xbd00bc04, 0xbcacbcc9, 0xbd043ad6, 0x3cf83c38, 0x3ce0bc8c
.long 0x3d00bc04, 0xbcedbc69, 0xbce03c8c, 0x3d033ba0, 0xbc973cd9, 0x3d03bba0, 0x3cacbcc9, 0xbd043ad6
.long 0xbb56bd03, 0xbcc03cb6, 0xbc503cf3, 0x3d00bc04, 0x3cc03cb6, 0x3bd5bd01, 0x3b56bd03, 0xbced3c69
.long 0xbd04bad6, 0x3c503cf3, 0x3bd53d01, 0x3cd1bca2, 0x3cd1bca2, 0xbce0bc8c, 0xbc80bce7, 0xbcac3cc9
.long 0xbbd53d01, 0x3d04bad6, 0x3cc03cb6, 0x3c80bce7, 0xbc80bce7, 0xbcd13ca2, 0xbcedbc69, 0xbc1e3cfc
.long 0x3cf83c38, 0x3c1ebcfc, 0x3d033ba0, 0x3b56bd03, 0xbcf83c38, 0x3c1e3cfc, 0xbd033ba0, 0x3b563d03
.long 0x3c80bce7, 0xbcd1bca2, 0x3cedbc69, 0xbc1ebcfc, 0x3bd53d01, 0x3d043ad6, 0xbcc03cb6, 0x3c803ce7
.long 0xbcd1bca2, 0xbce03c8c, 0x3c80bce7, 0xbcacbcc9, 0x3d04bad6, 0x3c50bcf3, 0xbbd53d01, 0x3cd13ca2
.long 0xbcc03cb6, 0x3bd53d01, 0xbb56bd03, 0xbcedbc69, 0x3b56bd03, 0xbcc0bcb6, 0x3c503cf3, 0x3d003c04
.long 0x3c503cf3, 0x3c1ebcfc, 0xbcacbcc9, 0x00003c84, 0xbcd1bca2, 0x3b563d03, 0x3cc03cb6, 0x0000bc84
.long 0x3d033ba0, 0xbc80bce7, 0xbcd1bca2, 0x00003c84, 0xbcf83c38, 0x3cd13ca2, 0x3ce03c8c, 0x0000bc84
.long 0x3cacbcc9, 0xbd00bc04, 0xbcedbc69, 0x00003c84, 0xbbd53d01, 0x3d03bba0, 0x3cf83c38, 0x0000bc84
.long 0xbc1ebcfc, 0xbce03c8c, 0xbd00bc04, 0x00003c84, 0x3cc03cb6, 0x3c97bcd9, 0x3d033ba0, 0x0000bc84
.long 0xbd00bc04, 0xbbd53d01, 0xbd04bad6, 0x00003c84, 0x3d00bc04, 0xbbd5bd01, 0x3d04bad6, 0x0000bc84
.long 0xbcc03cb6, 0x3c973cd9, 0xbd033ba0, 0x00003c84, 0x3c1ebcfc, 0xbce0bc8c, 0x3d00bc04, 0x0000bc84
.long 0x3bd53d01, 0x3d033ba0, 0xbcf83c38, 0x00003c84, 0xbcacbcc9, 0xbd003c04, 0x3cedbc69, 0x0000bc84
.long 0x3cf83c38, 0x3cd1bca2, 0xbce03c8c, 0x00003c84, 0xbd033ba0, 0xbc803ce7, 0x3cd1bca2, 0x0000bc84
.long 0x00003c84, 0x3cc03cb6, 0xbb56bd03, 0xbcd1bca2, 0x00003c84, 0x3cac3cc9, 0x3c1ebcfc, 0xbc50bcf3
.long 0x00003c84, 0x3c973cd9, 0x3cacbcc9, 0x3b56bd03, 0x00003c84, 0x3c803ce7, 0x3cedbc69, 0x3c97bcd9
.long 0x00003c84, 0x3c503cf3, 0x3d04bad6, 0x3cedbc69, 0x00003c84, 0x3c1e3cfc, 0x3cf83c38, 0x3d043ad6
.long 0x00003c84, 0x3bd53d01, 0x3cc03cb6, 0x3ce03c8c, 0x00003c84, 0x3b563d03, 0x3c503cf3, 0x3c803ce7
.long 0x00000000, 0x00000000, 0x00000000, 0x00000000, 0x00000000, 0x00000000, 0x00000000, 0x00000000
.long 0x00000000, 0x00000000, 0x00000000, 0x00000000, 0x00000000, 0x00000000, 0x00000000, 0x00000000
.long 0x00000000, 0x00000000, 0x00000000, 0x00000000, 0x00000000, 0x00000000, 0x00000000, 0x00000000
.long 0x00000000, 0x00000000, 0x00000000, 0x00000000, 0x00000000, 0x00000000, 0x00000000, 0x00000000
.long 0x3d04bad6, 0x3cacbcc9, 0xbd033ba0, 0xbc973cd9, 0x3d033ba0, 0x3ce0bc8c, 0xbcedbc69, 0xbd003c04
.long 0x3cf83c38, 0x3d00bc04, 0xbc80bce7, 0xbcedbc69, 0x3ce03c8c, 0x3d043ad6, 0x3b56bd03, 0xbc50bcf3
.long 0x3cc03cb6, 0x3cf83c38, 0x3cacbcc9, 0x3c1ebcfc, 0x3c973cd9, 0x3cd13ca2, 0x3d00bc04, 0x3ce0bc8c
.long 0x3c503cf3, 0x3c973cd9, 0x3cf83c38, 0x3d033ba0, 0x3bd53d01, 0x3c1e3cfc, 0x3c973cd9, 0x3cac3cc9
.long 0x00000000, 0x00000000, 0x00000000, 0x00000000, 0x00000000, 0x00000000, 0x00000000, 0x00000000
.long 0x00000000, 0x00000000, 0x00000000, 0x00000000, 0x00000000, 0x00000000, 0x00000000, 0x00000000
.long 0x00000000, 0x00000000, 0x00000000, 0x00000000, 0x00000000, 0x00000000, 0x00000000, 0x00000000
.long 0x00000000, 0x00000000, 0x00000000, 0x00000000, 0x00000000, 0x00000000, 0x00000000, 0x00000000
.long 0x3bd53d01, 0x3ce03c8c, 0xbc1ebcfc, 0xbcedbc69, 0xbc973cd9, 0x3b563d03, 0x3cd1bca2, 0x3bd5bd01
.long 0xbd033ba0, 0xbcc03cb6, 0x3ce03c8c, 0x3d04bad6, 0xbcd1bca2, 0xbd03bba0, 0xbbd53d01, 0x3c1e3cfc
.long 0xbb56bd03, 0xbc80bce7, 0xbd033ba0, 0xbce03c8c, 0x3cacbcc9, 0x3c50bcf3, 0xbc80bce7, 0xbcc0bcb6
.long 0x3d04bad6, 0x3d00bc04, 0x3cacbcc9, 0x3c80bce7, 0x3cc03cb6, 0x3cd13ca2, 0x3cf83c38, 0x3d003c04
.long 0x00000000, 0x00000000, 0x00000000, 0x00000000, 0x00000000, 0x00000000, 0x00000000, 0x00000000
.long 0x00000000, 0x00000000, 0x00000000, 0x00000000, 0x00000000, 0x00000000, 0x00000000, 0x00000000
.long 0x00000000, 0x00000000, 0x00000000, 0x00000000, 0x00000000, 0x00000000, 0x00000000, 0x00000000
.long 0x00000000, 0x00000000, 0x00000000, 0x00000000, 0x00000000, 0x00000000, 0x00000000, 0x00000000
.long 0x3d00bc04, 0x3c80bce7, 0xbcf83c38, 0xbc503cf3, 0x3cc03cb6, 0x3d043ad6, 0xbc80bce7, 0xbcf8bc38
.long 0xbbd53d01, 0x3c503cf3, 0x3cd1bca2, 0x3c1ebcfc, 0xbcf83c38, 0xbcac3cc9, 0x3cc03cb6, 0x3d003c04
.long 0xbcd1bca2, 0xbd00bc04, 0xbc973cd9, 0xbbd53d01, 0x3b56bd03, 0xbbd5bd01, 0xbcedbc69, 0xbd03bba0
.long 0x3cedbc69, 0x3cd1bca2, 0x3c1ebcfc, 0x3b56bd03, 0x3ce03c8c, 0x3ced3c69, 0x3d033ba0, 0x3d043ad6
.long 0x00000000, 0x00000000, 0x00000000, 0x00000000, 0x00000000, 0x00000000, 0x00000000, 0x00000000
.long 0x00000000, 0x00000000, 0x00000000, 0x00000000, 0x00000000, 0x00000000, 0x00000000, 0x00000000
.long 0x00000000, 0x00000000, 0x00000000, 0x00000000, 0x00000000, 0x00000000, 0x00000000, 0x00000000
.long 0x00000000, 0x00000000, 0x00000000, 0x00000000, 0x00000000, 0x00000000, 0x00000000, 0x00000000
.long 0x3c503cf3, 0x3cf83c38, 0xbc80bce7, 0xbd00bc04, 0xbcf83c38, 0xbc803ce7, 0x3d04bad6, 0x3cc0bcb6
.long 0xbc1ebcfc, 0xbcd1bca2, 0xbc503cf3, 0x3bd53d01, 0x3d00bc04, 0x3cc0bcb6, 0xbcacbcc9, 0xbcf8bc38
.long 0x3bd53d01, 0x3c973cd9, 0x3d00bc04, 0x3cd1bca2, 0xbd033ba0, 0xbced3c69, 0xbbd53d01, 0x3b563d03
.long 0xbb56bd03, 0xbc1ebcfc, 0xbcd1bca2, 0xbcedbc69, 0x3d04bad6, 0x3d03bba0, 0x3cedbc69, 0x3ce0bc8c
.long 0x00000000, 0x00000000, 0x00000000, 0x00000000, 0x00000000, 0x00000000, 0x00000000, 0x00000000
.long 0x00000000, 0x00000000, 0x00000000, 0x00000000, 0x00000000, 0x00000000, 0x00000000, 0x00000000
.long 0x00000000, 0x00000000, 0x00000000, 0x00000000, 0x00000000, 0x00000000, 0x00000000, 0x00000000
.long 0x00000000, 0x00000000, 0x00000000, 0x00000000, 0x00000000, 0x00000000, 0x00000000, 0x00000000
.long 0x3cedbc69, 0x3c1ebcfc, 0xbce03c8c, 0xbbd53d01, 0x3bd53d01, 0x3cd13ca2, 0x3b56bd03, 0xbc97bcd9
.long 0xbd04bad6, 0xbce03c8c, 0x3cc03cb6, 0x3d033ba0, 0x3c1ebcfc, 0xbbd5bd01, 0xbd033ba0, 0xbcd13ca2
.long 0x3ce03c8c, 0x3d033ba0, 0x3c80bce7, 0x3b56bd03, 0xbcc03cb6, 0xbc803ce7, 0x3c503cf3, 0x3cac3cc9
.long 0xbc80bce7, 0xbcacbcc9, 0xbd00bc04, 0xbd04bad6, 0x3d00bc04, 0x3cf8bc38, 0x3cd1bca2, 0x3cc0bcb6
.long 0x00000000, 0x00000000, 0x00000000, 0x00000000, 0x00000000, 0x00000000, 0x00000000, 0x00000000
.long 0x00000000, 0x00000000, 0x00000000, 0x00000000, 0x00000000, 0x00000000, 0x00000000, 0x00000000
.long 0x00000000, 0x00000000, 0x00000000, 0x00000000, 0x00000000, 0x00000000, 0x00000000, 0x00000000
.long 0x00000000, 0x00000000, 0x00000000, 0x00000000, 0x00000000, 0x00000000, 0x00000000, 0x00000000
.long 0x3c973cd9, 0x3d033ba0, 0xbcacbcc9, 0xbd04bad6, 0xbd00bc04, 0xbced3c69, 0x3ce03c8c, 0x3d03bba0
.long 0x3cedbc69, 0x3c80bce7, 0xbd00bc04, 0xbcf83c38, 0xbc503cf3, 0x3b563d03, 0x3d04bad6, 0x3ce0bc8c
.long 0xbc1ebcfc, 0xbcacbcc9, 0xbcf83c38, 0xbcc03cb6, 0x3ce03c8c, 0x3d003c04, 0x3cd1bca2, 0x3c97bcd9
.long 0xbd033ba0, 0xbcf83c38, 0xbc973cd9, 0xbc503cf3, 0x3cacbcc9, 0x3c97bcd9, 0x3c1ebcfc, 0x3bd5bd01
.long 0x00000000, 0x00000000, 0x00000000, 0x00000000, 0x00000000, 0x00000000, 0x00000000, 0x00000000
.long 0x00000000, 0x00000000, 0x00000000, 0x00000000, 0x00000000, 0x00000000, 0x00000000, 0x00000000
.long 0x00000000, 0x00000000, 0x00000000, 0x00000000, 0x00000000, 0x00000000, 0x00000000, 0x00000000
.long 0x00000000, 0x00000000, 0x00000000, 0x00000000, 0x00000000, 0x00000000, 0x00000000, 0x00000000
.long 0x3cd1bca2, 0x3b56bd03, 0xbcc03cb6, 0x00003c84, 0xbc503cf3, 0x3c1e3cfc, 0x3cacbcc9, 0x0000bc84
.long 0xbb56bd03, 0xbcacbcc9, 0xbc973cd9, 0x00003c84, 0x3c973cd9, 0x3ced3c69, 0x3c80bce7, 0x0000bc84
.long 0xbcedbc69, 0xbd04bad6, 0xbc503cf3, 0x00003c84, 0x3d04bad6, 0x3cf8bc38, 0x3c1ebcfc, 0x0000bc84
.long 0xbce03c8c, 0xbcc03cb6, 0xbbd53d01, 0x00003c84, 0x3c80bce7, 0x3c50bcf3, 0x3b56bd03, 0x0000bc84
.long 0x00000000, 0x00000000, 0x00000000, 0x00000000, 0x00000000, 0x00000000, 0x00000000, 0x00000000
.long 0x00000000, 0x00000000, 0x00000000, 0x00000000, 0x00000000, 0x00000000, 0x00000000, 0x00000000
.long 0x00000000, 0x00000000, 0x00000000, 0x00000000, 0x00000000, 0x00000000, 0x00000000, 0x00000000
.long 0x00000000, 0x00000000, 0x00000000, 0x00000000, 0x00000000, 0x00000000, 0x00000000, 0x00000000
fft_tables_end:
.size fft_tables, fft_tables_end-fft_tables
.section .rodata,"a"
.p2align 6
.amdhsa_kernel k1_kernel
  .amdhsa_next_free_vgpr 240
  .amdhsa_next_free_sgpr 72
  .amdhsa_accum_offset 240
  .amdhsa_group_segment_fixed_size 0
  .amdhsa_kernarg_size 40
  .amdhsa_user_sgpr_count 2
  .amdhsa_user_sgpr_kernarg_segment_ptr 1
  .amdhsa_system_sgpr_workgroup_id_x 1
.end_amdhsa_kernel
.p2align 6
.amdhsa_kernel k2_kernel
  .amdhsa_next_free_vgpr 316
  .amdhsa_next_free_sgpr 72
  .amdhsa_accum_offset 212
  .amdhsa_group_segment_fixed_size 0
  .amdhsa_kernarg_size 40
  .amdhsa_user_sgpr_count 2
  .amdhsa_user_sgpr_kernarg_segment_ptr 1
  .amdhsa_system_sgpr_workgroup_id_x 1
.end_amdhsa_kernel
.p2align 6
.amdhsa_kernel k3_kernel
  .amdhsa_next_free_vgpr 252
  .amdhsa_next_free_sgpr 72
  .amdhsa_accum_offset 252
  .amdhsa_group_segment_fixed_size 0
  .amdhsa_kernarg_size 40
  .amdhsa_user_sgpr_count 2
  .amdhsa_user_sgpr_kernarg_segment_ptr 1
  .amdhsa_system_sgpr_workgroup_id_x 1
.end_amdhsa_kernel
```

```asm
; @launch kernel=k1_kernel grid=(256,1,1) block=(384,1,1) lds=64000
; @launch kernel=k2_kernel grid=(256,1,1) block=(256,1,1) lds=122368
; @launch kernel=k3_kernel grid=(224,1,1) block=(256,1,1) lds=49152
.amdgcn_target "amdgcn-amd-amdhsa--gfx950"
.text
.globl k1_kernel
.p2align 8
.type k1_kernel,@function
k1_kernel:
    s_load_dwordx4 s[4:7], s[0:1], 0
    s_load_dwordx2 s[8:9], s[0:1], 32
    s_getpc_b64 s[10:11]
K1_pc:
    v_lshrrev_b32 v5, 6, v0
    v_and_b32 v0, 63, v0
    v_readfirstlane_b32 s28, v5
    v_lshlrev_b32 v6, 4, v0
    s_nop 2
    s_lshr_b32 s26, s28, 2
    s_and_b32 s30, s2, 7
    s_lshl_b32 s30, s30, 5
    s_lshr_b32 s31, s2, 3
    s_add_u32 s30, s30, s31
    s_cmp_eq_u32 s26, 1
    s_cselect_b32 s31, s30, s2
    s_mul_i32 s27, s26, 28
    s_add_u32 s27, s27, 224
    s_cmp_ge_u32 s31, s27
    s_cbranch_scc1 K1_end
    s_cmp_ge_u32 s2, 256
    s_cbranch_scc1 K1_end
    s_and_b32 s45, s28, 3
    s_lshr_b32 s31, s30, 2
    s_mul_i32 s32, s31, 57
    s_lshr_b32 s32, s32, 9
    s_mul_i32 s33, s32, 9
    s_sub_u32 s33, s31, s33
    s_mul_i32 s34, s33, 43
    s_lshr_b32 s34, s34, 7
    s_mul_i32 s35, s34, 3
    s_sub_u32 s35, s33, s35
    s_mul_i32 s36, s32, 129024
    s_mul_i32 s37, s34, 6144
    s_add_u32 s36, s36, s37
    s_lshl_b32 s35, s35, 1
    s_add_u32 s35, s35, s45
    s_lshl_b32 s37, s35, 5
    s_add_u32 s36, s36, s37
    s_mul_i32 s50, s45, 7424
    s_add_u32 s50, s50, 49152
    v_lshrrev_b32 v8, 1, v0
    v_mul_u32_u24 v8, 192, v8
    v_and_b32 v9, 1, v0
    v_lshl_add_u32 v10, v9, 4, v8
    s_mul_i32 s38, s2, 43008
    s_mul_i32 s39, s45, 10752
    s_add_u32 s38, s38, s39
    s_cmp_eq_u32 s28, 0
    s_cselect_b32 s39, 43008, 0
    v_mov_b32 v9, s39
    v_cmp_gt_u32 vcc, 8, v0
    s_nop 1
    v_cndmask_b32 v9, 0, v9, vcc
    s_mul_i32 s29, s45, 12288
    s_cmp_eq_u32 s26, 1
    s_cselect_b32 s40, s36, s38
    s_cselect_b32 m0, s50, s29
    s_cselect_b64 vcc, -1, 0
    s_mul_i32 s41, s26, 17408
    s_add_u32 s41, s41, 1024
    s_mul_i32 s42, s26, 32
    s_add_u32 s42, s42, 1024
    s_mul_i32 s49, s26, 8731776
    s_sub_u32 s14, 9634944, s49
    v_cndmask_b32 v11, v6, v10, vcc
    v_add_u32 v12, v9, v11
    s_add_u32 s48, s40, s39
    s_add_u32 s40, s40, s41
    s_mov_b32 s15, 0x00020000
    s_waitcnt lgkmcnt(0)
    s_sub_u32 s4, s4, 1152
    s_subb_u32 s5, s5, 0
    s_cmp_eq_u32 s26, 1
    s_cselect_b32 s12, s6, s4
    s_cselect_b32 s13, s7, s5
    s_and_b32 s13, s13, 0xffff
    buffer_load_dwordx4 v11, s[12:15], s48 offen lds
    s_add_u32 m0, m0, s42
    s_nop 0
    buffer_load_dwordx4 v12, s[12:15], s40 offen lds
    s_add_u32 m0, m0, s42
    s_add_u32 s40, s40, s41
    buffer_load_dwordx4 v11, s[12:15], s40 offen lds
    s_add_u32 m0, m0, s42
    s_add_u32 s40, s40, s41
    buffer_load_dwordx4 v11, s[12:15], s40 offen lds
    s_add_u32 m0, m0, s42
    s_add_u32 s40, s40, s41
    buffer_load_dwordx4 v11, s[12:15], s40 offen lds
    s_add_u32 m0, m0, s42
    s_add_u32 s40, s40, s41
    buffer_load_dwordx4 v11, s[12:15], s40 offen lds
    s_add_u32 m0, m0, s42
    s_add_u32 s40, s40, s41
    s_cmp_eq_u32 s26, 1
    buffer_load_dwordx4 v11, s[12:15], s40 offen lds
    s_cbranch_scc1 K1_w
    s_add_u32 m0, m0, s42
    s_add_u32 s40, s40, s41
    buffer_load_dwordx4 v11, s[12:15], s40 offen lds
    s_add_u32 m0, m0, s42
    s_add_u32 s40, s40, s41
    buffer_load_dwordx4 v11, s[12:15], s40 offen lds
    s_add_u32 m0, m0, s42
    s_add_u32 s40, s40, s41
    buffer_load_dwordx4 v11, s[12:15], s40 offen lds
    s_add_u32 m0, m0, s42
    s_add_u32 s40, s40, s41
    buffer_load_dwordx4 v11, s[12:15], s40 offen lds
    s_add_u32 m0, m0, s42
    s_add_u32 s40, s40, s41
    buffer_load_dwordx4 v11, s[12:15], s40 offen lds
    v_bfe_u32 v80, v0, 1, 3
    v_lshrrev_b32 v81, 5, v0
    v_lshlrev_b32 v81, 4, v81
    v_bfe_u32 v82, v0, 4, 1
    v_lshl_add_u32 v81, v82, 2, v81
    v_cvt_f32_u32 v81, v81
    v_and_b32 v82, 1, v0
    v_cvt_f32_u32 v82, v82
    v_mul_f32 v82, 0x3e800000, v82
    v_add_u32 v83, 0, v80
    v_cvt_f32_u32 v83, v83
    v_mul_f32 v40, 0x3c842108, v83
    v_fma_f32 v44, v40, v81, v82
    v_add_u32 v83, 8, v80
    v_cvt_f32_u32 v83, v83
    v_mul_f32 v41, 0x3c842108, v83
    v_fma_f32 v45, v41, v81, v82
    v_add_u32 v83, 16, v80
    v_cvt_f32_u32 v83, v83
    v_mul_f32 v42, 0x3c842108, v83
    v_fma_f32 v46, v42, v81, v82
    v_add_u32 v83, 24, v80
    v_cvt_f32_u32 v83, v83
    v_mul_f32 v43, 0x3c842108, v83
    v_fma_f32 v47, v43, v81, v82
    v_cos_f32 v32, v44
    v_fmamk_f32 v33, v40, 0x3f800000, v44
    v_fmamk_f32 v34, v40, 0x40000000, v44
    v_fmamk_f32 v35, v40, 0x40400000, v44
    v_fmamk_f32 v36, v40, 0x41000000, v44
    v_fmamk_f32 v37, v40, 0x41100000, v44
    v_fmamk_f32 v38, v40, 0x41200000, v44
    v_fmamk_f32 v39, v40, 0x41300000, v44
    v_cos_f32 v33, v33
    v_cos_f32 v34, v34
    v_cos_f32 v35, v35
    v_cos_f32 v36, v36
    v_cos_f32 v37, v37
    v_cos_f32 v38, v38
    v_cos_f32 v39, v39
    v_cvt_pk_bf16_f32 v48, v32, v33
    v_cvt_pk_bf16_f32 v49, v34, v35
    v_cvt_pk_bf16_f32 v50, v36, v37
    v_cvt_pk_bf16_f32 v51, v38, v39
    v_fmamk_f32 v32, v40, 0x42000000, v44
    v_fmamk_f32 v33, v40, 0x42040000, v44
    v_fmamk_f32 v34, v40, 0x42080000, v44
    v_fmamk_f32 v35, v40, 0x420c0000, v44
    v_fmamk_f32 v36, v40, 0x42200000, v44
    v_fmamk_f32 v37, v40, 0x42240000, v44
    v_fmamk_f32 v38, v40, 0x42280000, v44
    v_fmamk_f32 v39, v40, 0x422c0000, v44
    v_cos_f32 v32, v32
    v_cos_f32 v33, v33
    v_cos_f32 v34, v34
    v_cos_f32 v35, v35
    v_cos_f32 v36, v36
    v_cos_f32 v37, v37
    v_cos_f32 v38, v38
    v_cos_f32 v39, v39
    v_cvt_pk_bf16_f32 v52, v32, v33
    v_cvt_pk_bf16_f32 v53, v34, v35
    v_cvt_pk_bf16_f32 v54, v36, v37
    v_cvt_pk_bf16_f32 v55, v38, v39
    v_cos_f32 v32, v45
    v_fmamk_f32 v33, v41, 0x3f800000, v45
    v_fmamk_f32 v34, v41, 0x40000000, v45
    v_fmamk_f32 v35, v41, 0x40400000, v45
    v_fmamk_f32 v36, v41, 0x41000000, v45
    v_fmamk_f32 v37, v41, 0x41100000, v45
    v_fmamk_f32 v38, v41, 0x41200000, v45
    v_fmamk_f32 v39, v41, 0x41300000, v45
    v_cos_f32 v33, v33
    v_cos_f32 v34, v34
    v_cos_f32 v35, v35
    v_cos_f32 v36, v36
    v_cos_f32 v37, v37
    v_cos_f32 v38, v38
    v_cos_f32 v39, v39
    v_cvt_pk_bf16_f32 v56, v32, v33
    v_cvt_pk_bf16_f32 v57, v34, v35
    v_cvt_pk_bf16_f32 v58, v36, v37
    v_cvt_pk_bf16_f32 v59, v38, v39
    v_fmamk_f32 v32, v41, 0x42000000, v45
    v_fmamk_f32 v33, v41, 0x42040000, v45
    v_fmamk_f32 v34, v41, 0x42080000, v45
    v_fmamk_f32 v35, v41, 0x420c0000, v45
    v_fmamk_f32 v36, v41, 0x42200000, v45
    v_fmamk_f32 v37, v41, 0x42240000, v45
    v_fmamk_f32 v38, v41, 0x42280000, v45
    v_fmamk_f32 v39, v41, 0x422c0000, v45
    v_cos_f32 v32, v32
    v_cos_f32 v33, v33
    v_cos_f32 v34, v34
    v_cos_f32 v35, v35
    v_cos_f32 v36, v36
    v_cos_f32 v37, v37
    v_cos_f32 v38, v38
    v_cos_f32 v39, v39
    v_cvt_pk_bf16_f32 v60, v32, v33
    v_cvt_pk_bf16_f32 v61, v34, v35
    v_cvt_pk_bf16_f32 v62, v36, v37
    v_cvt_pk_bf16_f32 v63, v38, v39
    v_cos_f32 v32, v46
    v_fmamk_f32 v33, v42, 0x3f800000, v46
    v_fmamk_f32 v34, v42, 0x40000000, v46
    v_fmamk_f32 v35, v42, 0x40400000, v46
    v_fmamk_f32 v36, v42, 0x41000000, v46
    v_fmamk_f32 v37, v42, 0x41100000, v46
    v_fmamk_f32 v38, v42, 0x41200000, v46
    v_fmamk_f32 v39, v42, 0x41300000, v46
    v_cos_f32 v33, v33
    v_cos_f32 v34, v34
    v_cos_f32 v35, v35
    v_cos_f32 v36, v36
    v_cos_f32 v37, v37
    v_cos_f32 v38, v38
    v_cos_f32 v39, v39
    v_cvt_pk_bf16_f32 v64, v32, v33
    v_cvt_pk_bf16_f32 v65, v34, v35
    v_cvt_pk_bf16_f32 v66, v36, v37
    v_cvt_pk_bf16_f32 v67, v38, v39
    v_fmamk_f32 v32, v42, 0x42000000, v46
    v_fmamk_f32 v33, v42, 0x42040000, v46
    v_fmamk_f32 v34, v42, 0x42080000, v46
    v_fmamk_f32 v35, v42, 0x420c0000, v46
    v_fmamk_f32 v36, v42, 0x42200000, v46
    v_fmamk_f32 v37, v42, 0x42240000, v46
    v_fmamk_f32 v38, v42, 0x42280000, v46
    v_fmamk_f32 v39, v42, 0x422c0000, v46
    v_cos_f32 v32, v32
    v_cos_f32 v33, v33
    v_cos_f32 v34, v34
    v_cos_f32 v35, v35
    v_cos_f32 v36, v36
    v_cos_f32 v37, v37
    v_cos_f32 v38, v38
    v_cos_f32 v39, v39
    v_cvt_pk_bf16_f32 v68, v32, v33
    v_cvt_pk_bf16_f32 v69, v34, v35
    v_cvt_pk_bf16_f32 v70, v36, v37
    v_cvt_pk_bf16_f32 v71, v38, v39
    v_cos_f32 v32, v47
    v_fmamk_f32 v33, v43, 0x3f800000, v47
    v_fmamk_f32 v34, v43, 0x40000000, v47
    v_fmamk_f32 v35, v43, 0x40400000, v47
    v_fmamk_f32 v36, v43, 0x41000000, v47
    v_fmamk_f32 v37, v43, 0x41100000, v47
    v_fmamk_f32 v38, v43, 0x41200000, v47
    v_fmamk_f32 v39, v43, 0x41300000, v47
    v_cos_f32 v33, v33
    v_cos_f32 v34, v34
    v_cos_f32 v35, v35
    v_cos_f32 v36, v36
    v_cos_f32 v37, v37
    v_cos_f32 v38, v38
    v_cos_f32 v39, v39
    v_cvt_pk_bf16_f32 v72, v32, v33
    v_cvt_pk_bf16_f32 v73, v34, v35
    v_cvt_pk_bf16_f32 v74, v36, v37
    v_cvt_pk_bf16_f32 v75, v38, v39
    v_fmamk_f32 v32, v43, 0x42000000, v47
    v_fmamk_f32 v33, v43, 0x42040000, v47
    v_fmamk_f32 v34, v43, 0x42080000, v47
    v_fmamk_f32 v35, v43, 0x420c0000, v47
    v_fmamk_f32 v36, v43, 0x42200000, v47
    v_fmamk_f32 v37, v43, 0x42240000, v47
    v_fmamk_f32 v38, v43, 0x42280000, v47
    v_fmamk_f32 v39, v43, 0x422c0000, v47
    v_cos_f32 v32, v32
    v_cos_f32 v33, v33
    v_cos_f32 v34, v34
    v_cos_f32 v35, v35
    v_cos_f32 v36, v36
    v_cos_f32 v37, v37
    v_cos_f32 v38, v38
    v_cos_f32 v39, v39
    v_cvt_pk_bf16_f32 v76, v32, v33
    v_cvt_pk_bf16_f32 v77, v34, v35
    v_cvt_pk_bf16_f32 v78, v36, v37
    v_cvt_pk_bf16_f32 v79, v38, v39
    v_cmp_gt_u32 vcc, 48, v0
    s_nop 1
    v_cndmask_b32 v55, 0, v55, vcc
    v_cndmask_b32 v63, 0, v63, vcc
    v_cndmask_b32 v71, 0, v71, vcc
    v_cndmask_b32 v79, 0, v79, vcc
    s_mov_b32 s16, s8
    s_and_b32 s17, s9, 0xffff
    s_mov_b32 s18, 11010048
    s_mov_b32 s19, 0x00020000
    v_and_b32 v1, 15, v0
    v_lshrrev_b32 v2, 4, v0
    v_bfe_u32 v3, v0, 2, 2
    v_and_b32 v4, 3, v0
    v_lshrrev_b32 v23, 1, v2
    v_lshlrev_b32 v23, 4, v23
    v_add_u32 v23, v23, v3
    v_and_b32 v24, 1, v2
    v_lshl_add_u32 v23, v24, 2, v23
    v_mul_u32_u24 v23, 192, v23
    v_lshl_add_u32 v23, v4, 3, v23
    v_add_u32 v20, s29, v23
    v_lshlrev_b32 v23, 6, v1
    v_lshl_add_u32 v25, v2, 4, v23
    s_lshl_b32 s53, s2, 2
    s_add_u32 s53, s53, s28
    s_mul_i32 s53, s53, 12288
    s_waitcnt vmcnt(6)
    ds_read_b64_tr_b16 v[80:81], v20 offset:0
    ds_read_b64_tr_b16 v[82:83], v20 offset:1536
    ds_read_b64_tr_b16 v[84:85], v20 offset:32
    ds_read_b64_tr_b16 v[86:87], v20 offset:1568
    ds_read_b64_tr_b16 v[88:89], v20 offset:64
    ds_read_b64_tr_b16 v[90:91], v20 offset:1600
    ds_read_b64_tr_b16 v[92:93], v20 offset:96
    ds_read_b64_tr_b16 v[94:95], v20 offset:1632
    ds_read_b64_tr_b16 v[96:97], v20 offset:128
    ds_read_b64_tr_b16 v[98:99], v20 offset:1664
    ds_read_b64_tr_b16 v[100:101], v20 offset:160
    ds_read_b64_tr_b16 v[102:103], v20 offset:1696
    s_waitcnt lgkmcnt(10)
    v_mfma_f32_16x16x32_bf16 v[128:131], v[80:83], v[48:51], 0
    v_mfma_f32_16x16x32_bf16 v[132:135], v[80:83], v[56:59], 0
    v_mfma_f32_16x16x32_bf16 v[136:139], v[80:83], v[64:67], 0
    v_mfma_f32_16x16x32_bf16 v[140:143], v[80:83], v[72:75], 0
    s_waitcnt lgkmcnt(8)
    v_mfma_f32_16x16x32_bf16 v[144:147], v[84:87], v[48:51], 0
    v_mfma_f32_16x16x32_bf16 v[148:151], v[84:87], v[56:59], 0
    v_mfma_f32_16x16x32_bf16 v[152:155], v[84:87], v[64:67], 0
    v_mfma_f32_16x16x32_bf16 v[156:159], v[84:87], v[72:75], 0
    s_waitcnt lgkmcnt(6)
    v_mfma_f32_16x16x32_bf16 v[160:163], v[88:91], v[48:51], 0
    v_mfma_f32_16x16x32_bf16 v[164:167], v[88:91], v[56:59], 0
    v_mfma_f32_16x16x32_bf16 v[168:171], v[88:91], v[64:67], 0
    v_mfma_f32_16x16x32_bf16 v[172:175], v[88:91], v[72:75], 0
    s_waitcnt lgkmcnt(4)
    v_mfma_f32_16x16x32_bf16 v[176:179], v[92:95], v[48:51], 0
    v_mfma_f32_16x16x32_bf16 v[180:183], v[92:95], v[56:59], 0
    v_mfma_f32_16x16x32_bf16 v[184:187], v[92:95], v[64:67], 0
    v_mfma_f32_16x16x32_bf16 v[188:191], v[92:95], v[72:75], 0
    s_waitcnt lgkmcnt(2)
    v_mfma_f32_16x16x32_bf16 v[192:195], v[96:99], v[48:51], 0
    v_mfma_f32_16x16x32_bf16 v[196:199], v[96:99], v[56:59], 0
    v_mfma_f32_16x16x32_bf16 v[200:203], v[96:99], v[64:67], 0
    v_mfma_f32_16x16x32_bf16 v[204:207], v[96:99], v[72:75], 0
    s_waitcnt lgkmcnt(0)
    v_mfma_f32_16x16x32_bf16 v[208:211], v[100:103], v[48:51], 0
    v_mfma_f32_16x16x32_bf16 v[212:215], v[100:103], v[56:59], 0
    v_mfma_f32_16x16x32_bf16 v[216:219], v[100:103], v[64:67], 0
    v_mfma_f32_16x16x32_bf16 v[220:223], v[100:103], v[72:75], 0
    s_waitcnt vmcnt(0)
    ds_read_b64_tr_b16 v[104:105], v20 offset:6144
    ds_read_b64_tr_b16 v[106:107], v20 offset:7680
    ds_read_b64_tr_b16 v[108:109], v20 offset:6176
    ds_read_b64_tr_b16 v[110:111], v20 offset:7712
    ds_read_b64_tr_b16 v[112:113], v20 offset:6208
    ds_read_b64_tr_b16 v[114:115], v20 offset:7744
    ds_read_b64_tr_b16 v[116:117], v20 offset:6240
    ds_read_b64_tr_b16 v[118:119], v20 offset:7776
    ds_read_b64_tr_b16 v[120:121], v20 offset:6272
    ds_read_b64_tr_b16 v[122:123], v20 offset:7808
    ds_read_b64_tr_b16 v[124:125], v20 offset:6304
    ds_read_b64_tr_b16 v[126:127], v20 offset:7840
    s_waitcnt lgkmcnt(10)
    v_mfma_f32_16x16x32_bf16 v[128:131], v[104:107], v[52:55], v[128:131]
    s_waitcnt lgkmcnt(8)
    v_mfma_f32_16x16x32_bf16 v[144:147], v[108:111], v[52:55], v[144:147]
    v_mfma_f32_16x16x32_bf16 v[132:135], v[104:107], v[60:63], v[132:135]
    v_mfma_f32_16x16x32_bf16 v[148:151], v[108:111], v[60:63], v[148:151]
    v_mfma_f32_16x16x32_bf16 v[136:139], v[104:107], v[68:71], v[136:139]
    v_mfma_f32_16x16x32_bf16 v[152:155], v[108:111], v[68:71], v[152:155]
    v_mfma_f32_16x16x32_bf16 v[140:143], v[104:107], v[76:79], v[140:143]
    v_mfma_f32_16x16x32_bf16 v[156:159], v[108:111], v[76:79], v[156:159]
    v_cvt_pk_bf16_f32 v224, v128, v129
    v_cvt_pk_bf16_f32 v225, v130, v131
    v_cvt_pk_bf16_f32 v226, v144, v145
    v_cvt_pk_bf16_f32 v227, v146, v147
    s_add_u32 s54, s53, 0
    buffer_store_dwordx4 v[224:227], v25, s[16:19], s54 offen sc1
    s_waitcnt lgkmcnt(6)
    v_mfma_f32_16x16x32_bf16 v[160:163], v[112:115], v[52:55], v[160:163]
    s_waitcnt lgkmcnt(4)
    v_mfma_f32_16x16x32_bf16 v[176:179], v[116:119], v[52:55], v[176:179]
    v_cvt_pk_bf16_f32 v228, v132, v133
    v_cvt_pk_bf16_f32 v229, v134, v135
    v_cvt_pk_bf16_f32 v230, v148, v149
    v_cvt_pk_bf16_f32 v231, v150, v151
    s_add_u32 s54, s53, 1024
    buffer_store_dwordx4 v[228:231], v25, s[16:19], s54 offen sc1
    v_mfma_f32_16x16x32_bf16 v[164:167], v[112:115], v[60:63], v[164:167]
    v_mfma_f32_16x16x32_bf16 v[180:183], v[116:119], v[60:63], v[180:183]
    v_cvt_pk_bf16_f32 v232, v136, v137
    v_cvt_pk_bf16_f32 v233, v138, v139
    v_cvt_pk_bf16_f32 v234, v152, v153
    v_cvt_pk_bf16_f32 v235, v154, v155
    s_add_u32 s54, s53, 2048
    buffer_store_dwordx4 v[232:235], v25, s[16:19], s54 offen sc1
    v_mfma_f32_16x16x32_bf16 v[168:171], v[112:115], v[68:71], v[168:171]
    v_mfma_f32_16x16x32_bf16 v[184:187], v[116:119], v[68:71], v[184:187]
    v_cvt_pk_bf16_f32 v236, v140, v141
    v_cvt_pk_bf16_f32 v237, v142, v143
    v_cvt_pk_bf16_f32 v238, v156, v157
    v_cvt_pk_bf16_f32 v239, v158, v159
    s_add_u32 s54, s53, 3072
    buffer_store_dwordx4 v[236:239], v25, s[16:19], s54 offen sc1
    v_mfma_f32_16x16x32_bf16 v[172:175], v[112:115], v[76:79], v[172:175]
    v_mfma_f32_16x16x32_bf16 v[188:191], v[116:119], v[76:79], v[188:191]
    v_cvt_pk_bf16_f32 v224, v160, v161
    v_cvt_pk_bf16_f32 v225, v162, v163
    v_cvt_pk_bf16_f32 v226, v176, v177
    v_cvt_pk_bf16_f32 v227, v178, v179
    s_add_u32 s54, s53, 4096
    buffer_store_dwordx4 v[224:227], v25, s[16:19], s54 offen sc1
    s_waitcnt lgkmcnt(2)
    v_mfma_f32_16x16x32_bf16 v[192:195], v[120:123], v[52:55], v[192:195]
    s_waitcnt lgkmcnt(0)
    v_mfma_f32_16x16x32_bf16 v[208:211], v[124:127], v[52:55], v[208:211]
    v_cvt_pk_bf16_f32 v228, v164, v165
    v_cvt_pk_bf16_f32 v229, v166, v167
    v_cvt_pk_bf16_f32 v230, v180, v181
    v_cvt_pk_bf16_f32 v231, v182, v183
    s_add_u32 s54, s53, 5120
    buffer_store_dwordx4 v[228:231], v25, s[16:19], s54 offen sc1
    v_mfma_f32_16x16x32_bf16 v[196:199], v[120:123], v[60:63], v[196:199]
    v_mfma_f32_16x16x32_bf16 v[212:215], v[124:127], v[60:63], v[212:215]
    v_cvt_pk_bf16_f32 v232, v168, v169
    v_cvt_pk_bf16_f32 v233, v170, v171
    v_cvt_pk_bf16_f32 v234, v184, v185
    v_cvt_pk_bf16_f32 v235, v186, v187
    s_add_u32 s54, s53, 6144
    buffer_store_dwordx4 v[232:235], v25, s[16:19], s54 offen sc1
    v_mfma_f32_16x16x32_bf16 v[200:203], v[120:123], v[68:71], v[200:203]
    v_mfma_f32_16x16x32_bf16 v[216:219], v[124:127], v[68:71], v[216:219]
    v_cvt_pk_bf16_f32 v236, v172, v173
    v_cvt_pk_bf16_f32 v237, v174, v175
    v_cvt_pk_bf16_f32 v238, v188, v189
    v_cvt_pk_bf16_f32 v239, v190, v191
    s_add_u32 s54, s53, 7168
    buffer_store_dwordx4 v[236:239], v25, s[16:19], s54 offen sc1
    v_mfma_f32_16x16x32_bf16 v[204:207], v[120:123], v[76:79], v[204:207]
    v_mfma_f32_16x16x32_bf16 v[220:223], v[124:127], v[76:79], v[220:223]
    v_cvt_pk_bf16_f32 v224, v192, v193
    v_cvt_pk_bf16_f32 v225, v194, v195
    v_cvt_pk_bf16_f32 v226, v208, v209
    v_cvt_pk_bf16_f32 v227, v210, v211
    s_add_u32 s54, s53, 8192
    buffer_store_dwordx4 v[224:227], v25, s[16:19], s54 offen sc1
    v_cvt_pk_bf16_f32 v228, v196, v197
    v_cvt_pk_bf16_f32 v229, v198, v199
    v_cvt_pk_bf16_f32 v230, v212, v213
    v_cvt_pk_bf16_f32 v231, v214, v215
    s_add_u32 s54, s53, 9216
    buffer_store_dwordx4 v[228:231], v25, s[16:19], s54 offen sc1
    v_cvt_pk_bf16_f32 v232, v200, v201
    v_cvt_pk_bf16_f32 v233, v202, v203
    v_cvt_pk_bf16_f32 v234, v216, v217
    v_cvt_pk_bf16_f32 v235, v218, v219
    s_add_u32 s54, s53, 10240
    buffer_store_dwordx4 v[232:235], v25, s[16:19], s54 offen sc1
    v_cvt_pk_bf16_f32 v236, v204, v205
    v_cvt_pk_bf16_f32 v237, v206, v207
    v_cvt_pk_bf16_f32 v238, v220, v221
    v_cvt_pk_bf16_f32 v239, v222, v223
    s_add_u32 s54, s53, 11264
    buffer_store_dwordx4 v[236:239], v25, s[16:19], s54 offen sc1
    s_endpgm
K1_w:
    s_mov_b32 s51, s50
    s_and_b32 s43, s30, 3
    s_lshl_b32 s43, s43, 2
    v_bfe_u32 v40, v0, 1, 1
    v_and_b32 v41, 1, v0
    v_cvt_f32_u32 v41, v41
    v_mul_f32 v41, 0x3e800000, v41
    v_bfe_u32 v42, v0, 2, 2
    v_lshrrev_b32 v43, 4, v0
    v_cmp_eq_u32 s[46:47], v42, v43
    s_lshl_b32 s44, s43, 1
    v_add_u32 v40, s44, v40
    v_cvt_f32_u32 v40, v40
    v_mul_f32 v42, 0x3c842108, v40
    v_cos_f32 v32, v41
    v_fmamk_f32 v33, v42, 0x3f800000, v41
    v_fmamk_f32 v34, v42, 0x40000000, v41
    v_fmamk_f32 v35, v42, 0x40400000, v41
    v_fmamk_f32 v36, v42, 0x40800000, v41
    v_fmamk_f32 v37, v42, 0x40a00000, v41
    v_fmamk_f32 v38, v42, 0x40c00000, v41
    v_cos_f32 v33, v33
    v_cos_f32 v34, v34
    v_cos_f32 v35, v35
    v_cos_f32 v36, v36
    v_cos_f32 v37, v37
    v_cos_f32 v38, v38
    v_mov_b32 v39, 0
    v_cvt_pk_bf16_f32 v48, v32, v33
    v_cvt_pk_bf16_f32 v49, v34, v35
    v_cvt_pk_bf16_f32 v50, v36, v37
    v_cvt_pk_bf16_f32 v51, v38, v39
    v_cndmask_b32 v48, 0, v48, s[46:47]
    v_cndmask_b32 v49, 0, v49, s[46:47]
    v_cndmask_b32 v50, 0, v50, s[46:47]
    v_cndmask_b32 v51, 0, v51, s[46:47]
    v_add_f32 v42, 0x3d042108, v42
    v_cos_f32 v32, v41
    v_fmamk_f32 v33, v42, 0x3f800000, v41
    v_fmamk_f32 v34, v42, 0x40000000, v41
    v_fmamk_f32 v35, v42, 0x40400000, v41
    v_fmamk_f32 v36, v42, 0x40800000, v41
    v_fmamk_f32 v37, v42, 0x40a00000, v41
    v_fmamk_f32 v38, v42, 0x40c00000, v41
    v_cos_f32 v33, v33
    v_cos_f32 v34, v34
    v_cos_f32 v35, v35
    v_cos_f32 v36, v36
    v_cos_f32 v37, v37
    v_cos_f32 v38, v38
    v_mov_b32 v39, 0
    v_cvt_pk_bf16_f32 v52, v32, v33
    v_cvt_pk_bf16_f32 v53, v34, v35
    v_cvt_pk_bf16_f32 v54, v36, v37
    v_cvt_pk_bf16_f32 v55, v38, v39
    v_cndmask_b32 v52, 0, v52, s[46:47]
    v_cndmask_b32 v53, 0, v53, s[46:47]
    v_cndmask_b32 v54, 0, v54, s[46:47]
    v_cndmask_b32 v55, 0, v55, s[46:47]
    v_add_f32 v42, 0x3d042108, v42
    v_cos_f32 v32, v41
    v_fmamk_f32 v33, v42, 0x3f800000, v41
    v_fmamk_f32 v34, v42, 0x40000000, v41
    v_fmamk_f32 v35, v42, 0x40400000, v41
    v_fmamk_f32 v36, v42, 0x40800000, v41
    v_fmamk_f32 v37, v42, 0x40a00000, v41
    v_fmamk_f32 v38, v42, 0x40c00000, v41
    v_cos_f32 v33, v33
    v_cos_f32 v34, v34
    v_cos_f32 v35, v35
    v_cos_f32 v36, v36
    v_cos_f32 v37, v37
    v_cos_f32 v38, v38
    v_mov_b32 v39, 0
    v_cvt_pk_bf16_f32 v56, v32, v33
    v_cvt_pk_bf16_f32 v57, v34, v35
    v_cvt_pk_bf16_f32 v58, v36, v37
    v_cvt_pk_bf16_f32 v59, v38, v39
    v_cndmask_b32 v56, 0, v56, s[46:47]
    v_cndmask_b32 v57, 0, v57, s[46:47]
    v_cndmask_b32 v58, 0, v58, s[46:47]
    v_cndmask_b32 v59, 0, v59, s[46:47]
    v_add_f32 v42, 0x3d042108, v42
    v_cos_f32 v32, v41
    v_fmamk_f32 v33, v42, 0x3f800000, v41
    v_fmamk_f32 v34, v42, 0x40000000, v41
    v_fmamk_f32 v35, v42, 0x40400000, v41
    v_fmamk_f32 v36, v42, 0x40800000, v41
    v_fmamk_f32 v37, v42, 0x40a00000, v41
    v_fmamk_f32 v38, v42, 0x40c00000, v41
    v_cos_f32 v33, v33
    v_cos_f32 v34, v34
    v_cos_f32 v35, v35
    v_cos_f32 v36, v36
    v_cos_f32 v37, v37
    v_cos_f32 v38, v38
    v_mov_b32 v39, 0
    v_cvt_pk_bf16_f32 v60, v32, v33
    v_cvt_pk_bf16_f32 v61, v34, v35
    v_cvt_pk_bf16_f32 v62, v36, v37
    v_cvt_pk_bf16_f32 v63, v38, v39
    v_cndmask_b32 v60, 0, v60, s[46:47]
    v_cndmask_b32 v61, 0, v61, s[46:47]
    v_cndmask_b32 v62, 0, v62, s[46:47]
    v_cndmask_b32 v63, 0, v63, s[46:47]
    s_add_u32 s16, s8, 0xb00000
    s_addc_u32 s17, s9, 0
    s_and_b32 s17, s17, 0xffff
    s_mov_b32 s18, 8257536
    s_mov_b32 s19, 0x00020000
    v_lshrrev_b32 v2, 4, v0
    v_bfe_u32 v3, v0, 2, 2
    v_and_b32 v4, 3, v0
    v_mul_u32_u24 v22, 1056, v3
    v_lshl_add_u32 v23, v2, 7, v22
    v_lshl_add_u32 v23, v4, 3, v23
    v_add_u32 v20, s51, v23
    v_add_u32 v22, 4, v3
    v_min_u32 v22, 6, v22
    v_sub_u32 v22, v22, v3
    v_mul_u32_u24 v22, 1056, v22
    v_add_u32 v21, v20, v22
    s_cmp_ge_u32 s35, 3
    s_cselect_b32 s48, 1, 0
    s_mul_i32 s49, s48, 3
    s_sub_u32 s49, s35, s49
    s_lshl_b32 s50, s43, 2
    s_add_u32 s50, s50, s48
    s_mul_i32 s50, s50, 21
    s_mul_i32 s51, s34, 7
    s_add_u32 s50, s50, s51
    s_add_u32 s50, s50, s32
    s_mul_i32 s50, s50, 6144
    s_lshl_b32 s49, s49, 11
    s_add_u32 s50, s50, s49
    s_waitcnt vmcnt(0)
    ds_read_b64_tr_b16 v[80:81], v20 offset:0
    ds_read_b64_tr_b16 v[82:83], v21 offset:0
    ds_read_b64_tr_b16 v[84:85], v20 offset:32
    ds_read_b64_tr_b16 v[86:87], v21 offset:32
    ds_read_b64_tr_b16 v[88:89], v20 offset:64
    ds_read_b64_tr_b16 v[90:91], v21 offset:64
    ds_read_b64_tr_b16 v[92:93], v20 offset:96
    ds_read_b64_tr_b16 v[94:95], v21 offset:96
    ds_read_b64_tr_b16 v[96:97], v20 offset:512
    ds_read_b64_tr_b16 v[98:99], v21 offset:512
    ds_read_b64_tr_b16 v[100:101], v20 offset:544
    ds_read_b64_tr_b16 v[102:103], v21 offset:544
    ds_read_b64_tr_b16 v[104:105], v20 offset:576
    ds_read_b64_tr_b16 v[106:107], v21 offset:576
    ds_read_b64_tr_b16 v[108:109], v20 offset:608
    ds_read_b64_tr_b16 v[110:111], v21 offset:608
    s_waitcnt lgkmcnt(14)
    v_mfma_f32_16x16x32_bf16 v[112:115], v[48:51], v[80:83], 0
    s_waitcnt lgkmcnt(12)
    v_mfma_f32_16x16x32_bf16 v[116:119], v[48:51], v[84:87], 0
    s_waitcnt lgkmcnt(10)
    v_mfma_f32_16x16x32_bf16 v[120:123], v[48:51], v[88:91], 0
    s_waitcnt lgkmcnt(8)
    v_mfma_f32_16x16x32_bf16 v[124:127], v[48:51], v[92:95], 0
    s_waitcnt lgkmcnt(6)
    v_mfma_f32_16x16x32_bf16 v[128:131], v[48:51], v[96:99], 0
    s_waitcnt lgkmcnt(4)
    v_mfma_f32_16x16x32_bf16 v[132:135], v[48:51], v[100:103], 0
    s_waitcnt lgkmcnt(2)
    v_mfma_f32_16x16x32_bf16 v[136:139], v[48:51], v[104:107], 0
    s_waitcnt lgkmcnt(0)
    v_mfma_f32_16x16x32_bf16 v[140:143], v[48:51], v[108:111], 0
    v_mfma_f32_16x16x32_bf16 v[144:147], v[52:55], v[80:83], 0
    v_mfma_f32_16x16x32_bf16 v[148:151], v[52:55], v[84:87], 0
    v_mfma_f32_16x16x32_bf16 v[152:155], v[52:55], v[88:91], 0
    v_mfma_f32_16x16x32_bf16 v[156:159], v[52:55], v[92:95], 0
    v_mfma_f32_16x16x32_bf16 v[160:163], v[52:55], v[96:99], 0
    v_mfma_f32_16x16x32_bf16 v[164:167], v[52:55], v[100:103], 0
    v_mfma_f32_16x16x32_bf16 v[168:171], v[52:55], v[104:107], 0
    v_mfma_f32_16x16x32_bf16 v[172:175], v[52:55], v[108:111], 0
    v_cvt_pk_bf16_f32 v176, v112, v116
    v_cvt_pk_bf16_f32 v177, v120, v124
    v_cvt_pk_bf16_f32 v178, v128, v132
    v_cvt_pk_bf16_f32 v179, v136, v140
    buffer_store_dwordx4 v[176:179], v6, s[16:19], s50 offen offset:0 sc1
    v_cvt_pk_bf16_f32 v180, v113, v117
    v_cvt_pk_bf16_f32 v181, v121, v125
    v_cvt_pk_bf16_f32 v182, v129, v133
    v_cvt_pk_bf16_f32 v183, v137, v141
    buffer_store_dwordx4 v[180:183], v6, s[16:19], s50 offen offset:1024 sc1
    v_cvt_pk_bf16_f32 v184, v114, v118
    v_cvt_pk_bf16_f32 v185, v122, v126
    v_cvt_pk_bf16_f32 v186, v130, v134
    v_cvt_pk_bf16_f32 v187, v138, v142
    s_add_u32 s50, s50, 258048
    buffer_store_dwordx4 v[184:187], v6, s[16:19], s50 offen offset:0 sc1
    v_cvt_pk_bf16_f32 v188, v115, v119
    v_cvt_pk_bf16_f32 v189, v123, v127
    v_cvt_pk_bf16_f32 v190, v131, v135
    v_cvt_pk_bf16_f32 v191, v139, v143
    buffer_store_dwordx4 v[188:191], v6, s[16:19], s50 offen offset:1024 sc1
    v_mfma_f32_16x16x32_bf16 v[112:115], v[56:59], v[80:83], 0
    v_mfma_f32_16x16x32_bf16 v[116:119], v[56:59], v[84:87], 0
    v_mfma_f32_16x16x32_bf16 v[120:123], v[56:59], v[88:91], 0
    v_mfma_f32_16x16x32_bf16 v[124:127], v[56:59], v[92:95], 0
    v_mfma_f32_16x16x32_bf16 v[128:131], v[56:59], v[96:99], 0
    v_mfma_f32_16x16x32_bf16 v[132:135], v[56:59], v[100:103], 0
    v_mfma_f32_16x16x32_bf16 v[136:139], v[56:59], v[104:107], 0
    v_mfma_f32_16x16x32_bf16 v[140:143], v[56:59], v[108:111], 0
    v_cvt_pk_bf16_f32 v192, v144, v148
    v_cvt_pk_bf16_f32 v193, v152, v156
    v_cvt_pk_bf16_f32 v194, v160, v164
    v_cvt_pk_bf16_f32 v195, v168, v172
    s_add_u32 s50, s50, 258048
    buffer_store_dwordx4 v[192:195], v6, s[16:19], s50 offen offset:0 sc1
    v_cvt_pk_bf16_f32 v196, v145, v149
    v_cvt_pk_bf16_f32 v197, v153, v157
    v_cvt_pk_bf16_f32 v198, v161, v165
    v_cvt_pk_bf16_f32 v199, v169, v173
    buffer_store_dwordx4 v[196:199], v6, s[16:19], s50 offen offset:1024 sc1
    v_cvt_pk_bf16_f32 v200, v146, v150
    v_cvt_pk_bf16_f32 v201, v154, v158
    v_cvt_pk_bf16_f32 v202, v162, v166
    v_cvt_pk_bf16_f32 v203, v170, v174
    s_add_u32 s50, s50, 258048
    buffer_store_dwordx4 v[200:203], v6, s[16:19], s50 offen offset:0 sc1
    v_cvt_pk_bf16_f32 v204, v147, v151
    v_cvt_pk_bf16_f32 v205, v155, v159
    v_cvt_pk_bf16_f32 v206, v163, v167
    v_cvt_pk_bf16_f32 v207, v171, v175
    buffer_store_dwordx4 v[204:207], v6, s[16:19], s50 offen offset:1024 sc1
    v_mfma_f32_16x16x32_bf16 v[144:147], v[60:63], v[80:83], 0
    v_mfma_f32_16x16x32_bf16 v[148:151], v[60:63], v[84:87], 0
    v_mfma_f32_16x16x32_bf16 v[152:155], v[60:63], v[88:91], 0
    v_mfma_f32_16x16x32_bf16 v[156:159], v[60:63], v[92:95], 0
    v_mfma_f32_16x16x32_bf16 v[160:163], v[60:63], v[96:99], 0
    v_mfma_f32_16x16x32_bf16 v[164:167], v[60:63], v[100:103], 0
    v_mfma_f32_16x16x32_bf16 v[168:171], v[60:63], v[104:107], 0
    v_mfma_f32_16x16x32_bf16 v[172:175], v[60:63], v[108:111], 0
    v_cvt_pk_bf16_f32 v176, v112, v116
    v_cvt_pk_bf16_f32 v177, v120, v124
    v_cvt_pk_bf16_f32 v178, v128, v132
    v_cvt_pk_bf16_f32 v179, v136, v140
    s_add_u32 s50, s50, 258048
    buffer_store_dwordx4 v[176:179], v6, s[16:19], s50 offen offset:0 sc1
    v_cvt_pk_bf16_f32 v180, v113, v117
    v_cvt_pk_bf16_f32 v181, v121, v125
    v_cvt_pk_bf16_f32 v182, v129, v133
    v_cvt_pk_bf16_f32 v183, v137, v141
    buffer_store_dwordx4 v[180:183], v6, s[16:19], s50 offen offset:1024 sc1
    v_cvt_pk_bf16_f32 v184, v114, v118
    v_cvt_pk_bf16_f32 v185, v122, v126
    v_cvt_pk_bf16_f32 v186, v130, v134
    v_cvt_pk_bf16_f32 v187, v138, v142
    s_add_u32 s50, s50, 258048
    buffer_store_dwordx4 v[184:187], v6, s[16:19], s50 offen offset:0 sc1
    v_cvt_pk_bf16_f32 v188, v115, v119
    v_cvt_pk_bf16_f32 v189, v123, v127
    v_cvt_pk_bf16_f32 v190, v131, v135
    v_cvt_pk_bf16_f32 v191, v139, v143
    buffer_store_dwordx4 v[188:191], v6, s[16:19], s50 offen offset:1024 sc1
    v_cvt_pk_bf16_f32 v192, v144, v148
    v_cvt_pk_bf16_f32 v193, v152, v156
    v_cvt_pk_bf16_f32 v194, v160, v164
    v_cvt_pk_bf16_f32 v195, v168, v172
    s_add_u32 s50, s50, 258048
    buffer_store_dwordx4 v[192:195], v6, s[16:19], s50 offen offset:0 sc1
    v_cvt_pk_bf16_f32 v196, v145, v149
    v_cvt_pk_bf16_f32 v197, v153, v157
    v_cvt_pk_bf16_f32 v198, v161, v165
    v_cvt_pk_bf16_f32 v199, v169, v173
    buffer_store_dwordx4 v[196:199], v6, s[16:19], s50 offen offset:1024 sc1
    v_cvt_pk_bf16_f32 v200, v146, v150
    v_cvt_pk_bf16_f32 v201, v154, v158
    v_cvt_pk_bf16_f32 v202, v162, v166
    v_cvt_pk_bf16_f32 v203, v170, v174
    s_add_u32 s50, s50, 258048
    buffer_store_dwordx4 v[200:203], v6, s[16:19], s50 offen offset:0 sc1
    v_cvt_pk_bf16_f32 v204, v147, v151
    v_cvt_pk_bf16_f32 v205, v155, v159
    v_cvt_pk_bf16_f32 v206, v163, v167
    v_cvt_pk_bf16_f32 v207, v171, v175
    buffer_store_dwordx4 v[204:207], v6, s[16:19], s50 offen offset:1024 sc1
    s_cmp_lg_u32 s28, 5
    s_cbranch_scc1 K1_nopf
    s_bfe_u32 s52, s2, 0x30003
    s_lshl_b32 s52, s52, 13
    v_lshlrev_b32 v24, 7, v0
    v_add_u32 v24, s52, v24
    v_add_u32 v24, k2_kernel-K1_pc, v24
    v_min_u32 v24, fft_tables_end-K1_pc-4, v24
    global_load_dword v25, v24, s[10:11]
K1_nopf:
K1_end:
    s_endpgm
.globl k2_kernel
.p2align 8
.type k2_kernel,@function
k2_kernel:
    s_load_dwordx2 s[8:9], s[0:1], 32
    s_getpc_b64 s[10:11]
K2_pc:
    s_cmp_ge_u32 s2, 256
    s_cbranch_scc1 K2_end
    v_lshrrev_b32 v5, 6, v0
    v_lshlrev_b32 v11, 7, v0
    v_min_u32 v11, K2_end-K2_pc, v11
    global_load_dword v11, v11, s[10:11]
    v_and_b32 v0, 63, v0
    v_readfirstlane_b32 s28, v5
    v_and_b32 v1, 15, v0
    v_lshrrev_b32 v2, 4, v0
    s_and_b32 s30, s2, 7
    s_lshl_b32 s30, s30, 2
    s_lshr_b32 s31, s2, 6
    s_add_u32 s30, s30, s31
    s_bfe_u32 s31, s2, 0x20004
    s_bfe_u32 s32, s2, 0x10003
    s_mul_i32 s33, s31, 12288
    s_lshl_b32 s39, s30, 7
    s_add_u32 s33, s33, s39
    s_lshl_b32 s34, s30, 1
    s_add_u32 s34, s34, s32
    s_mul_i32 s34, s34, 129024
    s_add_u32 s34, s34, 0xb00000
    s_lshl_b32 s35, s31, 5
    s_add_u32 s35, s35, s30
    s_lshl_b32 s35, s35, 1
    s_add_u32 s35, s35, s32
    s_mul_i32 s35, s35, 192
    s_and_b32 s36, s28, 1
    s_lshr_b32 s37, s28, 1
    s_mov_b32 s40, 0xcff3fcff
    s_mov_b32 s41, 0x03fcff3f
    v_mul_u32_u24 v5, 205, v0
    v_lshrrev_b32 v5, 11, v5
    v_mul_u32_u24 v6, 10, v5
    v_sub_u32 v6, v0, v6
    v_lshlrev_b32 v6, 4, v6
    v_mul_u32_u24 v5, 49152, v5
    v_add_u32 v3, v5, v6
    v_lshlrev_b32 v4, 4, v0
    v_mul_u32_u24 v8, 1120, v1
    v_lshl_add_u32 v8, v2, 4, v8
    s_mul_i32 s38, s36, 17920
    v_add_u32 v5, s38, v8
    v_add_u32 v6, 38400, v5
    v_add_u32 v7, 76800, v5
    v_mul_u32_u24 v9, 344064, v1
    v_lshl_add_u32 v9, v2, 4, v9
    s_mul_i32 s38, s36, 5505024
    s_add_u32 s38, s38, s35
    v_add_u32 v9, s38, v9
    v_lshlrev_b32 v10, 3, v0
    s_mul_i32 s38, s36, 3584
    s_add_u32 s38, s38, 115200
    v_add_u32 v10, s38, v10
    s_mul_i32 s42, s28, 960
    s_mul_i32 s43, s28, 294912
    s_sub_u32 s43, s43, 294912
    s_cmp_eq_u32 s28, 0
    s_cselect_b32 s44, 10715136, s43
    s_add_u32 s43, s43, 1179648
    s_lshl_b32 s45, s37, 11
    s_waitcnt lgkmcnt(0)
    s_sub_u32 s39, 11010048, s33
    s_add_u32 s12, s8, s33
    s_addc_u32 s13, s9, 0
    s_and_b32 s13, s13, 0xffff
    s_mov_b32 s14, 0
    s_mov_b32 s15, 0x00020000
    s_mov_b32 s14, s39
    s_add_u32 s16, s8, s34
    s_addc_u32 s17, s9, 0
    s_and_b32 s17, s17, 0xffff
    s_mov_b32 s18, 129024
    s_mov_b32 s19, 0x00020000
    s_add_u32 m0, s42, 0
    s_add_u32 s46, s44, 0
    s_mov_b64 exec, s[40:41]
    buffer_load_dwordx4 v3, s[12:15], s46 offen lds
    s_mov_b64 exec, -1
    s_add_u32 m0, s42, 3840
    s_add_u32 s46, s43, 0
    s_mov_b64 exec, s[40:41]
    buffer_load_dwordx4 v3, s[12:15], s46 offen lds
    s_mov_b64 exec, -1
    s_add_u32 m0, s42, 7680
    s_add_u32 s46, s43, 1179648
    s_mov_b64 exec, s[40:41]
    buffer_load_dwordx4 v3, s[12:15], s46 offen lds
    s_mov_b64 exec, -1
    s_add_u32 m0, s42, 11520
    s_add_u32 s46, s43, 2359296
    s_mov_b64 exec, s[40:41]
    buffer_load_dwordx4 v3, s[12:15], s46 offen lds
    s_mov_b64 exec, -1
    s_add_u32 m0, s42, 15360
    s_add_u32 s46, s43, 3538944
    s_mov_b64 exec, s[40:41]
    buffer_load_dwordx4 v3, s[12:15], s46 offen lds
    s_mov_b64 exec, -1
    s_add_u32 m0, s42, 19200
    s_add_u32 s46, s43, 4718592
    s_mov_b64 exec, s[40:41]
    buffer_load_dwordx4 v3, s[12:15], s46 offen lds
    s_mov_b64 exec, -1
    s_add_u32 m0, s42, 23040
    s_add_u32 s46, s43, 5898240
    s_mov_b64 exec, s[40:41]
    buffer_load_dwordx4 v3, s[12:15], s46 offen lds
    s_mov_b64 exec, -1
    s_add_u32 m0, s42, 26880
    s_add_u32 s46, s43, 7077888
    s_mov_b64 exec, s[40:41]
    buffer_load_dwordx4 v3, s[12:15], s46 offen lds
    s_mov_b64 exec, -1
    s_add_u32 m0, s42, 30720
    s_add_u32 s46, s43, 8257536
    s_mov_b64 exec, s[40:41]
    buffer_load_dwordx4 v3, s[12:15], s46 offen lds
    s_mov_b64 exec, -1
    s_add_u32 m0, s42, 34560
    s_add_u32 s46, s43, 9437184
    s_mov_b64 exec, s[40:41]
    buffer_load_dwordx4 v3, s[12:15], s46 offen lds
    s_mov_b64 exec, -1
    s_add_u32 s47, s45, 0
    buffer_load_dwordx4 a[104:107], v4, s[16:19], s47 offen offset:0
    buffer_load_dwordx4 a[108:111], v4, s[16:19], s47 offen offset:1024
    buffer_load_dwordx4 a[112:115], v4, s[16:19], s47 offen offset:2048
    buffer_load_dwordx4 a[116:119], v4, s[16:19], s47 offen offset:3072
    s_add_u32 s47, s45, 6144
    buffer_load_dwordx4 a[120:123], v4, s[16:19], s47 offen offset:0
    buffer_load_dwordx4 a[124:127], v4, s[16:19], s47 offen offset:1024
    buffer_load_dwordx4 a[128:131], v4, s[16:19], s47 offen offset:2048
    buffer_load_dwordx4 a[132:135], v4, s[16:19], s47 offen offset:3072
    s_add_u32 s47, s45, 12288
    buffer_load_dwordx4 a[136:139], v4, s[16:19], s47 offen offset:0
    buffer_load_dwordx4 a[140:143], v4, s[16:19], s47 offen offset:1024
    buffer_load_dwordx4 a[144:147], v4, s[16:19], s47 offen offset:2048
    buffer_load_dwordx4 a[148:151], v4, s[16:19], s47 offen offset:3072
    s_add_u32 s20, s8, 0x1400000
    s_addc_u32 s21, s9, 0
    s_and_b32 s21, s21, 0xffff
    s_mov_b32 s22, 11010048
    s_mov_b32 s23, 0x00020000
    s_cmp_eq_u32 s37, 1
    s_cbranch_scc1 K2_q1
    s_waitcnt vmcnt(12)
    s_barrier
    ds_read_b128 a[48:51], v5 offset:1920
    ds_read_b128 a[100:103], v5 offset:1984
    ds_read_b128 a[44:47], v5 offset:1760
    ds_read_b128 a[96:99], v5 offset:1824
    ds_read_b128 a[40:43], v5 offset:1600
    ds_read_b128 a[92:95], v5 offset:1664
    ds_read_b128 a[36:39], v5 offset:1440
    ds_read_b128 a[88:91], v5 offset:1504
    ds_read_b128 a[32:35], v5 offset:1280
    ds_read_b128 a[84:87], v5 offset:1344
    ds_read_b128 a[28:31], v5 offset:1120
    ds_read_b128 a[80:83], v5 offset:1184
    ds_read_b128 a[24:27], v5 offset:960
    ds_read_b128 a[76:79], v5 offset:1024
    s_waitcnt vmcnt(11)
    s_waitcnt lgkmcnt(13)
    v_mfma_f32_16x16x32_bf16 v[36:39], a[104:107], a[48:51], 0
    s_add_u32 s47, s45, 18432
    s_waitcnt vmcnt(10)
    v_mfma_f32_16x16x32_bf16 v[92:95], a[108:111], a[48:51], 0
    buffer_load_dwordx4 a[152:155], v4, s[16:19], s47 offen offset:0
    s_waitcnt vmcnt(10)
    v_mfma_f32_16x16x32_bf16 v[120:123], a[112:115], a[48:51], 0
    s_waitcnt vmcnt(9)
    s_waitcnt lgkmcnt(12)
    v_mfma_f32_16x16x32_bf16 v[148:151], a[116:119], a[100:103], 0
    buffer_load_dwordx4 a[156:159], v4, s[16:19], s47 offen offset:1024
    v_mfma_f32_16x16x32_bf16 v[92:95], a[104:107], a[100:103], v[92:95]
    v_mfma_f32_16x16x32_bf16 v[64:67], a[108:111], a[100:103], 0
    buffer_load_dwordx4 a[160:163], v4, s[16:19], s47 offen offset:2048
    s_waitcnt lgkmcnt(10)
    v_mfma_f32_16x16x32_bf16 v[60:63], a[108:111], a[96:99], 0
    v_mfma_f32_16x16x32_bf16 v[88:91], a[104:107], a[96:99], 0
    buffer_load_dwordx4 a[164:167], v4, s[16:19], s47 offen offset:3072
    v_mfma_f32_16x16x32_bf16 v[144:147], a[116:119], a[96:99], 0
    v_mfma_f32_16x16x32_bf16 v[116:119], a[112:115], a[44:47], 0
    s_add_u32 s47, s45, 43008
    v_mfma_f32_16x16x32_bf16 v[88:91], a[108:111], a[44:47], v[88:91]
    buffer_load_dwordx4 a[216:219], v4, s[16:19], s47 offen offset:0
    v_mfma_f32_16x16x32_bf16 v[32:35], a[104:107], a[44:47], 0
    s_waitcnt lgkmcnt(9)
    v_mfma_f32_16x16x32_bf16 v[28:31], a[104:107], a[40:43], 0
    buffer_load_dwordx4 a[220:223], v4, s[16:19], s47 offen offset:1024
    v_mfma_f32_16x16x32_bf16 v[84:87], a[108:111], a[40:43], 0
    v_mfma_f32_16x16x32_bf16 v[112:115], a[112:115], a[40:43], 0
    buffer_load_dwordx4 a[224:227], v4, s[16:19], s47 offen offset:2048
    s_waitcnt lgkmcnt(8)
    v_mfma_f32_16x16x32_bf16 v[140:143], a[116:119], a[92:95], 0
    v_mfma_f32_16x16x32_bf16 v[84:87], a[104:107], a[92:95], v[84:87]
    buffer_load_dwordx4 a[228:231], v4, s[16:19], s47 offen offset:3072
    v_mfma_f32_16x16x32_bf16 v[56:59], a[108:111], a[92:95], 0
    s_waitcnt lgkmcnt(6)
    v_mfma_f32_16x16x32_bf16 v[52:55], a[108:111], a[88:91], 0
    v_mfma_f32_16x16x32_bf16 v[80:83], a[104:107], a[88:91], 0
    ds_read_b128 a[20:23], v5 offset:800
    v_mfma_f32_16x16x32_bf16 v[136:139], a[116:119], a[88:91], 0
    v_mfma_f32_16x16x32_bf16 v[108:111], a[112:115], a[36:39], 0
    ds_read_b128 a[72:75], v5 offset:864
    v_mfma_f32_16x16x32_bf16 v[80:83], a[108:111], a[36:39], v[80:83]
    v_mfma_f32_16x16x32_bf16 v[24:27], a[104:107], a[36:39], 0
    s_waitcnt lgkmcnt(7)
    v_mfma_f32_16x16x32_bf16 v[20:23], a[104:107], a[32:35], 0
    v_mfma_f32_16x16x32_bf16 v[76:79], a[108:111], a[32:35], 0
    s_add_u32 m0, s42, 38400
    s_add_u32 s46, s44, 4096
    s_mov_b64 exec, s[40:41]
    buffer_load_dwordx4 v3, s[12:15], s46 offen lds
    s_mov_b64 exec, -1
    v_mfma_f32_16x16x32_bf16 v[104:107], a[112:115], a[32:35], 0
    s_waitcnt lgkmcnt(6)
    v_mfma_f32_16x16x32_bf16 v[132:135], a[116:119], a[84:87], 0
    v_mfma_f32_16x16x32_bf16 v[76:79], a[104:107], a[84:87], v[76:79]
    v_mfma_f32_16x16x32_bf16 v[48:51], a[108:111], a[84:87], 0
    s_waitcnt lgkmcnt(4)
    v_mfma_f32_16x16x32_bf16 v[44:47], a[108:111], a[80:83], 0
    s_add_u32 m0, s42, 42240
    s_add_u32 s46, s43, 4096
    s_mov_b64 exec, s[40:41]
    buffer_load_dwordx4 v3, s[12:15], s46 offen lds
    s_mov_b64 exec, -1
    v_mfma_f32_16x16x32_bf16 v[72:75], a[104:107], a[80:83], 0
    v_mfma_f32_16x16x32_bf16 v[128:131], a[116:119], a[80:83], 0
    v_mfma_f32_16x16x32_bf16 v[100:103], a[112:115], a[28:31], 0
    v_mfma_f32_16x16x32_bf16 v[72:75], a[108:111], a[28:31], v[72:75]
    v_mfma_f32_16x16x32_bf16 v[16:19], a[104:107], a[28:31], 0
    s_add_u32 m0, s42, 46080
    s_add_u32 s46, s43, 1183744
    s_mov_b64 exec, s[40:41]
    buffer_load_dwordx4 v3, s[12:15], s46 offen lds
    s_mov_b64 exec, -1
    s_waitcnt lgkmcnt(3)
    v_mfma_f32_16x16x32_bf16 v[12:15], a[104:107], a[24:27], 0
    v_mfma_f32_16x16x32_bf16 v[68:71], a[108:111], a[24:27], 0
    v_mfma_f32_16x16x32_bf16 v[96:99], a[112:115], a[24:27], 0
    s_waitcnt lgkmcnt(2)
    v_mfma_f32_16x16x32_bf16 v[124:127], a[116:119], a[76:79], 0
    v_mfma_f32_16x16x32_bf16 v[68:71], a[104:107], a[76:79], v[68:71]
    v_mfma_f32_16x16x32_bf16 v[40:43], a[108:111], a[76:79], 0
    s_waitcnt vmcnt(18)
    v_mfma_f32_16x16x32_bf16 v[36:39], a[120:123], a[44:47], v[36:39]
    s_add_u32 s47, s45, 24576
    s_waitcnt vmcnt(17)
    v_mfma_f32_16x16x32_bf16 v[92:95], a[124:127], a[44:47], v[92:95]
    buffer_load_dwordx4 a[168:171], v4, s[16:19], s47 offen offset:0
    s_waitcnt vmcnt(17)
    v_mfma_f32_16x16x32_bf16 v[120:123], a[128:131], a[44:47], v[120:123]
    s_waitcnt vmcnt(16)
    v_mfma_f32_16x16x32_bf16 v[148:151], a[132:135], a[96:99], v[148:151]
    buffer_load_dwordx4 a[172:175], v4, s[16:19], s47 offen offset:1024
    v_mfma_f32_16x16x32_bf16 v[92:95], a[120:123], a[96:99], v[92:95]
    v_mfma_f32_16x16x32_bf16 v[64:67], a[124:127], a[96:99], v[64:67]
    buffer_load_dwordx4 a[176:179], v4, s[16:19], s47 offen offset:2048
    v_mfma_f32_16x16x32_bf16 v[60:63], a[124:127], a[92:95], v[60:63]
    v_mfma_f32_16x16x32_bf16 v[88:91], a[120:123], a[92:95], v[88:91]
    buffer_load_dwordx4 a[180:183], v4, s[16:19], s47 offen offset:3072
    v_mfma_f32_16x16x32_bf16 v[144:147], a[132:135], a[92:95], v[144:147]
    v_mfma_f32_16x16x32_bf16 v[116:119], a[128:131], a[40:43], v[116:119]
    s_add_u32 s47, s45, 49152
    v_mfma_f32_16x16x32_bf16 v[88:91], a[124:127], a[40:43], v[88:91]
    buffer_load_dwordx4 a[232:235], v4, s[16:19], s47 offen offset:0
    v_mfma_f32_16x16x32_bf16 v[32:35], a[120:123], a[40:43], v[32:35]
    v_mfma_f32_16x16x32_bf16 v[28:31], a[120:123], a[36:39], v[28:31]
    buffer_load_dwordx4 a[236:239], v4, s[16:19], s47 offen offset:1024
    v_mfma_f32_16x16x32_bf16 v[84:87], a[124:127], a[36:39], v[84:87]
    v_mfma_f32_16x16x32_bf16 v[112:115], a[128:131], a[36:39], v[112:115]
    buffer_load_dwordx4 a[240:243], v4, s[16:19], s47 offen offset:2048
    v_mfma_f32_16x16x32_bf16 v[140:143], a[132:135], a[88:91], v[140:143]
    v_mfma_f32_16x16x32_bf16 v[84:87], a[120:123], a[88:91], v[84:87]
    buffer_load_dwordx4 a[244:247], v4, s[16:19], s47 offen offset:3072
    v_mfma_f32_16x16x32_bf16 v[56:59], a[124:127], a[88:91], v[56:59]
    v_mfma_f32_16x16x32_bf16 v[52:55], a[124:127], a[84:87], v[52:55]
    v_mfma_f32_16x16x32_bf16 v[80:83], a[120:123], a[84:87], v[80:83]
    ds_read_b128 a[16:19], v5 offset:640
    v_mfma_f32_16x16x32_bf16 v[136:139], a[132:135], a[84:87], v[136:139]
    v_mfma_f32_16x16x32_bf16 v[108:111], a[128:131], a[32:35], v[108:111]
    ds_read_b128 a[68:71], v5 offset:704
    v_mfma_f32_16x16x32_bf16 v[80:83], a[124:127], a[32:35], v[80:83]
    v_mfma_f32_16x16x32_bf16 v[24:27], a[120:123], a[32:35], v[24:27]
    v_mfma_f32_16x16x32_bf16 v[20:23], a[120:123], a[28:31], v[20:23]
    v_mfma_f32_16x16x32_bf16 v[76:79], a[124:127], a[28:31], v[76:79]
    s_add_u32 m0, s42, 49920
    s_add_u32 s46, s43, 2363392
    s_mov_b64 exec, s[40:41]
    buffer_load_dwordx4 v3, s[12:15], s46 offen lds
    s_mov_b64 exec, -1
    v_mfma_f32_16x16x32_bf16 v[104:107], a[128:131], a[28:31], v[104:107]
    v_mfma_f32_16x16x32_bf16 v[132:135], a[132:135], a[80:83], v[132:135]
    v_mfma_f32_16x16x32_bf16 v[76:79], a[120:123], a[80:83], v[76:79]
    v_mfma_f32_16x16x32_bf16 v[48:51], a[124:127], a[80:83], v[48:51]
    v_mfma_f32_16x16x32_bf16 v[44:47], a[124:127], a[76:79], v[44:47]
    s_add_u32 m0, s42, 53760
    s_add_u32 s46, s43, 3543040
    s_mov_b64 exec, s[40:41]
    buffer_load_dwordx4 v3, s[12:15], s46 offen lds
    s_mov_b64 exec, -1
    v_mfma_f32_16x16x32_bf16 v[72:75], a[120:123], a[76:79], v[72:75]
    v_mfma_f32_16x16x32_bf16 v[128:131], a[132:135], a[76:79], v[128:131]
    v_mfma_f32_16x16x32_bf16 v[100:103], a[128:131], a[24:27], v[100:103]
    v_mfma_f32_16x16x32_bf16 v[72:75], a[124:127], a[24:27], v[72:75]
    v_mfma_f32_16x16x32_bf16 v[16:19], a[120:123], a[24:27], v[16:19]
    s_add_u32 m0, s42, 57600
    s_add_u32 s46, s43, 4722688
    s_mov_b64 exec, s[40:41]
    buffer_load_dwordx4 v3, s[12:15], s46 offen lds
    s_mov_b64 exec, -1
    s_waitcnt lgkmcnt(3)
    v_mfma_f32_16x16x32_bf16 v[12:15], a[120:123], a[20:23], v[12:15]
    v_mfma_f32_16x16x32_bf16 v[68:71], a[124:127], a[20:23], v[68:71]
    v_mfma_f32_16x16x32_bf16 v[96:99], a[128:131], a[20:23], v[96:99]
    s_waitcnt lgkmcnt(2)
    v_mfma_f32_16x16x32_bf16 v[124:127], a[132:135], a[72:75], v[124:127]
    v_mfma_f32_16x16x32_bf16 v[68:71], a[120:123], a[72:75], v[68:71]
    v_mfma_f32_16x16x32_bf16 v[40:43], a[124:127], a[72:75], v[40:43]
    s_waitcnt vmcnt(25)
    v_mfma_f32_16x16x32_bf16 v[36:39], a[136:139], a[40:43], v[36:39]
    s_add_u32 s47, s45, 30720
    s_waitcnt vmcnt(24)
    v_mfma_f32_16x16x32_bf16 v[92:95], a[140:143], a[40:43], v[92:95]
    buffer_load_dwordx4 a[184:187], v4, s[16:19], s47 offen offset:0
    s_waitcnt vmcnt(24)
    v_mfma_f32_16x16x32_bf16 v[120:123], a[144:147], a[40:43], v[120:123]
    s_waitcnt vmcnt(23)
    v_mfma_f32_16x16x32_bf16 v[148:151], a[148:151], a[92:95], v[148:151]
    buffer_load_dwordx4 a[188:191], v4, s[16:19], s47 offen offset:1024
    v_mfma_f32_16x16x32_bf16 v[92:95], a[136:139], a[92:95], v[92:95]
    v_mfma_f32_16x16x32_bf16 v[64:67], a[140:143], a[92:95], v[64:67]
    buffer_load_dwordx4 a[192:195], v4, s[16:19], s47 offen offset:2048
    v_mfma_f32_16x16x32_bf16 v[60:63], a[140:143], a[88:91], v[60:63]
    v_mfma_f32_16x16x32_bf16 v[88:91], a[136:139], a[88:91], v[88:91]
    buffer_load_dwordx4 a[196:199], v4, s[16:19], s47 offen offset:3072
    v_mfma_f32_16x16x32_bf16 v[144:147], a[148:151], a[88:91], v[144:147]
    v_mfma_f32_16x16x32_bf16 v[116:119], a[144:147], a[36:39], v[116:119]
    s_add_u32 s47, s45, 55296
    v_mfma_f32_16x16x32_bf16 v[88:91], a[140:143], a[36:39], v[88:91]
    buffer_load_dwordx4 a[248:251], v4, s[16:19], s47 offen offset:0
    v_mfma_f32_16x16x32_bf16 v[32:35], a[136:139], a[36:39], v[32:35]
    v_mfma_f32_16x16x32_bf16 v[28:31], a[136:139], a[32:35], v[28:31]
    buffer_load_dwordx4 a[252:255], v4, s[16:19], s47 offen offset:1024
    v_mfma_f32_16x16x32_bf16 v[84:87], a[140:143], a[32:35], v[84:87]
    v_mfma_f32_16x16x32_bf16 v[112:115], a[144:147], a[32:35], v[112:115]
    buffer_load_dwordx4 v[168:171], v4, s[16:19], s47 offen offset:2048
    v_mfma_f32_16x16x32_bf16 v[140:143], a[148:151], a[84:87], v[140:143]
    v_mfma_f32_16x16x32_bf16 v[84:87], a[136:139], a[84:87], v[84:87]
    buffer_load_dwordx4 v[172:175], v4, s[16:19], s47 offen offset:3072
    v_mfma_f32_16x16x32_bf16 v[56:59], a[140:143], a[84:87], v[56:59]
    v_mfma_f32_16x16x32_bf16 v[52:55], a[140:143], a[80:83], v[52:55]
    v_mfma_f32_16x16x32_bf16 v[80:83], a[136:139], a[80:83], v[80:83]
    ds_read_b128 a[12:15], v5 offset:480
    v_mfma_f32_16x16x32_bf16 v[136:139], a[148:151], a[80:83], v[136:139]
    v_mfma_f32_16x16x32_bf16 v[108:111], a[144:147], a[28:31], v[108:111]
    ds_read_b128 a[64:67], v5 offset:544
    v_mfma_f32_16x16x32_bf16 v[80:83], a[140:143], a[28:31], v[80:83]
    v_mfma_f32_16x16x32_bf16 v[24:27], a[136:139], a[28:31], v[24:27]
    v_mfma_f32_16x16x32_bf16 v[20:23], a[136:139], a[24:27], v[20:23]
    v_mfma_f32_16x16x32_bf16 v[76:79], a[140:143], a[24:27], v[76:79]
    s_add_u32 m0, s42, 61440
    s_add_u32 s46, s43, 5902336
    s_mov_b64 exec, s[40:41]
    buffer_load_dwordx4 v3, s[12:15], s46 offen lds
    s_mov_b64 exec, -1
    v_mfma_f32_16x16x32_bf16 v[104:107], a[144:147], a[24:27], v[104:107]
    v_mfma_f32_16x16x32_bf16 v[132:135], a[148:151], a[76:79], v[132:135]
    v_mfma_f32_16x16x32_bf16 v[76:79], a[136:139], a[76:79], v[76:79]
    v_mfma_f32_16x16x32_bf16 v[48:51], a[140:143], a[76:79], v[48:51]
    v_mfma_f32_16x16x32_bf16 v[44:47], a[140:143], a[72:75], v[44:47]
    s_add_u32 m0, s42, 65280
    s_add_u32 s46, s43, 7081984
    s_mov_b64 exec, s[40:41]
    buffer_load_dwordx4 v3, s[12:15], s46 offen lds
    s_mov_b64 exec, -1
    v_mfma_f32_16x16x32_bf16 v[72:75], a[136:139], a[72:75], v[72:75]
    v_mfma_f32_16x16x32_bf16 v[128:131], a[148:151], a[72:75], v[128:131]
    v_mfma_f32_16x16x32_bf16 v[100:103], a[144:147], a[20:23], v[100:103]
    v_mfma_f32_16x16x32_bf16 v[72:75], a[140:143], a[20:23], v[72:75]
    v_mfma_f32_16x16x32_bf16 v[16:19], a[136:139], a[20:23], v[16:19]
    s_waitcnt lgkmcnt(3)
    v_mfma_f32_16x16x32_bf16 v[12:15], a[136:139], a[16:19], v[12:15]
    v_mfma_f32_16x16x32_bf16 v[68:71], a[140:143], a[16:19], v[68:71]
    v_mfma_f32_16x16x32_bf16 v[96:99], a[144:147], a[16:19], v[96:99]
    s_waitcnt lgkmcnt(2)
    v_mfma_f32_16x16x32_bf16 v[124:127], a[148:151], a[68:71], v[124:127]
    v_mfma_f32_16x16x32_bf16 v[68:71], a[136:139], a[68:71], v[68:71]
    v_mfma_f32_16x16x32_bf16 v[40:43], a[140:143], a[68:71], v[40:43]
    s_waitcnt vmcnt(31)
    v_mfma_f32_16x16x32_bf16 v[36:39], a[152:155], a[36:39], v[36:39]
    s_add_u32 s47, s45, 36864
    s_waitcnt vmcnt(30)
    v_mfma_f32_16x16x32_bf16 v[92:95], a[156:159], a[36:39], v[92:95]
    buffer_load_dwordx4 a[200:203], v4, s[16:19], s47 offen offset:0
    s_waitcnt vmcnt(30)
    v_mfma_f32_16x16x32_bf16 v[120:123], a[160:163], a[36:39], v[120:123]
    s_waitcnt vmcnt(29)
    v_mfma_f32_16x16x32_bf16 v[148:151], a[164:167], a[88:91], v[148:151]
    buffer_load_dwordx4 a[204:207], v4, s[16:19], s47 offen offset:1024
    v_mfma_f32_16x16x32_bf16 v[92:95], a[152:155], a[88:91], v[92:95]
    v_mfma_f32_16x16x32_bf16 v[64:67], a[156:159], a[88:91], v[64:67]
    buffer_load_dwordx4 a[208:211], v4, s[16:19], s47 offen offset:2048
    v_mfma_f32_16x16x32_bf16 v[60:63], a[156:159], a[84:87], v[60:63]
    v_mfma_f32_16x16x32_bf16 v[88:91], a[152:155], a[84:87], v[88:91]
    buffer_load_dwordx4 a[212:215], v4, s[16:19], s47 offen offset:3072
    v_mfma_f32_16x16x32_bf16 v[144:147], a[164:167], a[84:87], v[144:147]
    v_mfma_f32_16x16x32_bf16 v[116:119], a[160:163], a[32:35], v[116:119]
    s_add_u32 s47, s45, 61440
    v_mfma_f32_16x16x32_bf16 v[88:91], a[156:159], a[32:35], v[88:91]
    buffer_load_dwordx4 v[176:179], v4, s[16:19], s47 offen offset:0
    v_mfma_f32_16x16x32_bf16 v[32:35], a[152:155], a[32:35], v[32:35]
    v_mfma_f32_16x16x32_bf16 v[28:31], a[152:155], a[28:31], v[28:31]
    buffer_load_dwordx4 v[180:183], v4, s[16:19], s47 offen offset:1024
    v_mfma_f32_16x16x32_bf16 v[84:87], a[156:159], a[28:31], v[84:87]
    v_mfma_f32_16x16x32_bf16 v[112:115], a[160:163], a[28:31], v[112:115]
    buffer_load_dwordx4 v[184:187], v4, s[16:19], s47 offen offset:2048
    v_mfma_f32_16x16x32_bf16 v[140:143], a[164:167], a[80:83], v[140:143]
    v_mfma_f32_16x16x32_bf16 v[84:87], a[152:155], a[80:83], v[84:87]
    buffer_load_dwordx4 v[188:191], v4, s[16:19], s47 offen offset:3072
    v_mfma_f32_16x16x32_bf16 v[56:59], a[156:159], a[80:83], v[56:59]
    v_mfma_f32_16x16x32_bf16 v[52:55], a[156:159], a[76:79], v[52:55]
    v_mfma_f32_16x16x32_bf16 v[80:83], a[152:155], a[76:79], v[80:83]
    ds_read_b128 a[8:11], v5 offset:320
    v_mfma_f32_16x16x32_bf16 v[136:139], a[164:167], a[76:79], v[136:139]
    v_mfma_f32_16x16x32_bf16 v[108:111], a[160:163], a[24:27], v[108:111]
    ds_read_b128 a[60:63], v5 offset:384
    v_mfma_f32_16x16x32_bf16 v[80:83], a[156:159], a[24:27], v[80:83]
    v_mfma_f32_16x16x32_bf16 v[24:27], a[152:155], a[24:27], v[24:27]
    v_mfma_f32_16x16x32_bf16 v[20:23], a[152:155], a[20:23], v[20:23]
    v_mfma_f32_16x16x32_bf16 v[76:79], a[156:159], a[20:23], v[76:79]
    s_add_u32 m0, s42, 69120
    s_add_u32 s46, s43, 8261632
    s_mov_b64 exec, s[40:41]
    buffer_load_dwordx4 v3, s[12:15], s46 offen lds
    s_mov_b64 exec, -1
    v_mfma_f32_16x16x32_bf16 v[104:107], a[160:163], a[20:23], v[104:107]
    v_mfma_f32_16x16x32_bf16 v[132:135], a[164:167], a[72:75], v[132:135]
    v_mfma_f32_16x16x32_bf16 v[76:79], a[152:155], a[72:75], v[76:79]
    v_mfma_f32_16x16x32_bf16 v[48:51], a[156:159], a[72:75], v[48:51]
    v_mfma_f32_16x16x32_bf16 v[44:47], a[156:159], a[68:71], v[44:47]
    s_add_u32 m0, s42, 72960
    s_add_u32 s46, s43, 9441280
    s_mov_b64 exec, s[40:41]
    buffer_load_dwordx4 v3, s[12:15], s46 offen lds
    s_mov_b64 exec, -1
    v_mfma_f32_16x16x32_bf16 v[72:75], a[152:155], a[68:71], v[72:75]
    v_mfma_f32_16x16x32_bf16 v[128:131], a[164:167], a[68:71], v[128:131]
    v_mfma_f32_16x16x32_bf16 v[100:103], a[160:163], a[16:19], v[100:103]
    v_mfma_f32_16x16x32_bf16 v[72:75], a[156:159], a[16:19], v[72:75]
    v_mfma_f32_16x16x32_bf16 v[16:19], a[152:155], a[16:19], v[16:19]
    s_waitcnt lgkmcnt(3)
    v_mfma_f32_16x16x32_bf16 v[12:15], a[152:155], a[12:15], v[12:15]
    v_mfma_f32_16x16x32_bf16 v[68:71], a[156:159], a[12:15], v[68:71]
    v_mfma_f32_16x16x32_bf16 v[96:99], a[160:163], a[12:15], v[96:99]
    s_waitcnt lgkmcnt(2)
    v_mfma_f32_16x16x32_bf16 v[124:127], a[164:167], a[64:67], v[124:127]
    v_mfma_f32_16x16x32_bf16 v[68:71], a[152:155], a[64:67], v[68:71]
    v_mfma_f32_16x16x32_bf16 v[40:43], a[156:159], a[64:67], v[40:43]
    s_waitcnt vmcnt(30)
    v_mfma_f32_16x16x32_bf16 v[36:39], a[168:171], a[32:35], v[36:39]
    s_waitcnt vmcnt(29)
    v_mfma_f32_16x16x32_bf16 v[92:95], a[172:175], a[32:35], v[92:95]
    s_waitcnt vmcnt(28)
    v_mfma_f32_16x16x32_bf16 v[120:123], a[176:179], a[32:35], v[120:123]
    s_waitcnt vmcnt(27)
    v_mfma_f32_16x16x32_bf16 v[148:151], a[180:183], a[84:87], v[148:151]
    v_mfma_f32_16x16x32_bf16 v[92:95], a[168:171], a[84:87], v[92:95]
    v_mfma_f32_16x16x32_bf16 v[64:67], a[172:175], a[84:87], v[64:67]
    v_mfma_f32_16x16x32_bf16 v[60:63], a[172:175], a[80:83], v[60:63]
    v_mfma_f32_16x16x32_bf16 v[88:91], a[168:171], a[80:83], v[88:91]
    v_mfma_f32_16x16x32_bf16 v[144:147], a[180:183], a[80:83], v[144:147]
    v_mfma_f32_16x16x32_bf16 v[116:119], a[176:179], a[28:31], v[116:119]
    s_add_u32 s47, s45, 67584
    v_mfma_f32_16x16x32_bf16 v[88:91], a[172:175], a[28:31], v[88:91]
    buffer_load_dwordx4 v[192:195], v4, s[16:19], s47 offen offset:0
    v_mfma_f32_16x16x32_bf16 v[32:35], a[168:171], a[28:31], v[32:35]
    v_mfma_f32_16x16x32_bf16 v[28:31], a[168:171], a[24:27], v[28:31]
    buffer_load_dwordx4 v[196:199], v4, s[16:19], s47 offen offset:1024
    v_mfma_f32_16x16x32_bf16 v[84:87], a[172:175], a[24:27], v[84:87]
    v_mfma_f32_16x16x32_bf16 v[112:115], a[176:179], a[24:27], v[112:115]
    buffer_load_dwordx4 v[200:203], v4, s[16:19], s47 offen offset:2048
    v_mfma_f32_16x16x32_bf16 v[140:143], a[180:183], a[76:79], v[140:143]
    v_mfma_f32_16x16x32_bf16 v[84:87], a[168:171], a[76:79], v[84:87]
    buffer_load_dwordx4 v[204:207], v4, s[16:19], s47 offen offset:3072
    v_mfma_f32_16x16x32_bf16 v[56:59], a[172:175], a[76:79], v[56:59]
    v_mfma_f32_16x16x32_bf16 v[52:55], a[172:175], a[72:75], v[52:55]
    v_mfma_f32_16x16x32_bf16 v[80:83], a[168:171], a[72:75], v[80:83]
    ds_read_b128 a[4:7], v5 offset:160
    v_mfma_f32_16x16x32_bf16 v[136:139], a[180:183], a[72:75], v[136:139]
    v_mfma_f32_16x16x32_bf16 v[108:111], a[176:179], a[20:23], v[108:111]
    ds_read_b128 a[56:59], v5 offset:224
    v_mfma_f32_16x16x32_bf16 v[80:83], a[172:175], a[20:23], v[80:83]
    v_mfma_f32_16x16x32_bf16 v[24:27], a[168:171], a[20:23], v[24:27]
    v_mfma_f32_16x16x32_bf16 v[20:23], a[168:171], a[16:19], v[20:23]
    v_mfma_f32_16x16x32_bf16 v[76:79], a[172:175], a[16:19], v[76:79]
    v_mfma_f32_16x16x32_bf16 v[104:107], a[176:179], a[16:19], v[104:107]
    v_mfma_f32_16x16x32_bf16 v[132:135], a[180:183], a[68:71], v[132:135]
    v_mfma_f32_16x16x32_bf16 v[76:79], a[168:171], a[68:71], v[76:79]
    v_mfma_f32_16x16x32_bf16 v[48:51], a[172:175], a[68:71], v[48:51]
    v_mfma_f32_16x16x32_bf16 v[44:47], a[172:175], a[64:67], v[44:47]
    v_mfma_f32_16x16x32_bf16 v[72:75], a[168:171], a[64:67], v[72:75]
    v_mfma_f32_16x16x32_bf16 v[128:131], a[180:183], a[64:67], v[128:131]
    v_mfma_f32_16x16x32_bf16 v[100:103], a[176:179], a[12:15], v[100:103]
    v_mfma_f32_16x16x32_bf16 v[72:75], a[172:175], a[12:15], v[72:75]
    v_mfma_f32_16x16x32_bf16 v[16:19], a[168:171], a[12:15], v[16:19]
    s_waitcnt lgkmcnt(3)
    v_mfma_f32_16x16x32_bf16 v[12:15], a[168:171], a[8:11], v[12:15]
    v_mfma_f32_16x16x32_bf16 v[68:71], a[172:175], a[8:11], v[68:71]
    v_mfma_f32_16x16x32_bf16 v[96:99], a[176:179], a[8:11], v[96:99]
    s_waitcnt lgkmcnt(2)
    v_mfma_f32_16x16x32_bf16 v[124:127], a[180:183], a[60:63], v[124:127]
    v_mfma_f32_16x16x32_bf16 v[68:71], a[168:171], a[60:63], v[68:71]
    v_mfma_f32_16x16x32_bf16 v[40:43], a[172:175], a[60:63], v[40:43]
    s_waitcnt vmcnt(23)
    v_mfma_f32_16x16x32_bf16 v[36:39], a[184:187], a[28:31], v[36:39]
    s_waitcnt vmcnt(22)
    v_mfma_f32_16x16x32_bf16 v[92:95], a[188:191], a[28:31], v[92:95]
    s_waitcnt vmcnt(21)
    v_mfma_f32_16x16x32_bf16 v[120:123], a[192:195], a[28:31], v[120:123]
    s_waitcnt vmcnt(20)
    v_mfma_f32_16x16x32_bf16 v[148:151], a[196:199], a[80:83], v[148:151]
    v_mfma_f32_16x16x32_bf16 v[92:95], a[184:187], a[80:83], v[92:95]
    v_mfma_f32_16x16x32_bf16 v[64:67], a[188:191], a[80:83], v[64:67]
    v_mfma_f32_16x16x32_bf16 v[60:63], a[188:191], a[76:79], v[60:63]
    v_mfma_f32_16x16x32_bf16 v[88:91], a[184:187], a[76:79], v[88:91]
    v_mfma_f32_16x16x32_bf16 v[144:147], a[196:199], a[76:79], v[144:147]
    v_mfma_f32_16x16x32_bf16 v[116:119], a[192:195], a[24:27], v[116:119]
    s_add_u32 s47, s45, 73728
    v_mfma_f32_16x16x32_bf16 v[88:91], a[188:191], a[24:27], v[88:91]
    buffer_load_dwordx4 v[208:211], v4, s[16:19], s47 offen offset:0
    v_mfma_f32_16x16x32_bf16 v[32:35], a[184:187], a[24:27], v[32:35]
    v_mfma_f32_16x16x32_bf16 v[28:31], a[184:187], a[20:23], v[28:31]
    buffer_load_dwordx4 v[212:215], v4, s[16:19], s47 offen offset:1024
    v_mfma_f32_16x16x32_bf16 v[84:87], a[188:191], a[20:23], v[84:87]
    v_mfma_f32_16x16x32_bf16 v[112:115], a[192:195], a[20:23], v[112:115]
    buffer_load_dwordx4 v[216:219], v4, s[16:19], s47 offen offset:2048
    v_mfma_f32_16x16x32_bf16 v[140:143], a[196:199], a[72:75], v[140:143]
    v_mfma_f32_16x16x32_bf16 v[84:87], a[184:187], a[72:75], v[84:87]
    buffer_load_dwordx4 v[220:223], v4, s[16:19], s47 offen offset:3072
    v_mfma_f32_16x16x32_bf16 v[56:59], a[188:191], a[72:75], v[56:59]
    v_mfma_f32_16x16x32_bf16 v[52:55], a[188:191], a[68:71], v[52:55]
    s_waitcnt vmcnt(8)
    s_barrier
    v_mfma_f32_16x16x32_bf16 v[80:83], a[184:187], a[68:71], v[80:83]
    ds_read_b128 a[0:3], v5 offset:0
    v_mfma_f32_16x16x32_bf16 v[136:139], a[196:199], a[68:71], v[136:139]
    v_mfma_f32_16x16x32_bf16 v[108:111], a[192:195], a[16:19], v[108:111]
    ds_read_b128 a[52:55], v5 offset:64
    v_mfma_f32_16x16x32_bf16 v[80:83], a[188:191], a[16:19], v[80:83]
    v_mfma_f32_16x16x32_bf16 v[24:27], a[184:187], a[16:19], v[24:27]
    ds_read_b128 a[48:51], v6 offset:1920
    v_mfma_f32_16x16x32_bf16 v[20:23], a[184:187], a[12:15], v[20:23]
    v_mfma_f32_16x16x32_bf16 v[76:79], a[188:191], a[12:15], v[76:79]
    ds_read_b128 a[100:103], v6 offset:1984
    v_mfma_f32_16x16x32_bf16 v[104:107], a[192:195], a[12:15], v[104:107]
    v_mfma_f32_16x16x32_bf16 v[132:135], a[196:199], a[64:67], v[132:135]
    ds_read_b128 a[44:47], v6 offset:1760
    v_mfma_f32_16x16x32_bf16 v[76:79], a[184:187], a[64:67], v[76:79]
    v_mfma_f32_16x16x32_bf16 v[48:51], a[188:191], a[64:67], v[48:51]
    ds_read_b128 a[96:99], v6 offset:1824
    v_mfma_f32_16x16x32_bf16 v[44:47], a[188:191], a[60:63], v[44:47]
    v_mfma_f32_16x16x32_bf16 v[72:75], a[184:187], a[60:63], v[72:75]
    s_add_u32 s47, s45, 79872
    ds_read_b128 a[40:43], v6 offset:1600
    v_mfma_f32_16x16x32_bf16 v[128:131], a[196:199], a[60:63], v[128:131]
    buffer_load_dwordx4 v[224:227], v4, s[16:19], s47 offen offset:0
    v_mfma_f32_16x16x32_bf16 v[100:103], a[192:195], a[8:11], v[100:103]
    ds_read_b128 a[92:95], v6 offset:1664
    v_mfma_f32_16x16x32_bf16 v[72:75], a[188:191], a[8:11], v[72:75]
    buffer_load_dwordx4 v[228:231], v4, s[16:19], s47 offen offset:1024
    v_mfma_f32_16x16x32_bf16 v[16:19], a[184:187], a[8:11], v[16:19]
    s_waitcnt lgkmcnt(9)
    v_mfma_f32_16x16x32_bf16 v[12:15], a[184:187], a[4:7], v[12:15]
    buffer_load_dwordx4 v[232:235], v4, s[16:19], s47 offen offset:2048
    v_mfma_f32_16x16x32_bf16 v[68:71], a[188:191], a[4:7], v[68:71]
    v_mfma_f32_16x16x32_bf16 v[96:99], a[192:195], a[4:7], v[96:99]
    buffer_load_dwordx4 v[236:239], v4, s[16:19], s47 offen offset:3072
    s_waitcnt lgkmcnt(8)
    v_mfma_f32_16x16x32_bf16 v[124:127], a[196:199], a[56:59], v[124:127]
    v_mfma_f32_16x16x32_bf16 v[68:71], a[184:187], a[56:59], v[68:71]
    v_mfma_f32_16x16x32_bf16 v[40:43], a[188:191], a[56:59], v[40:43]
    v_mfma_f32_16x16x32_bf16 v[36:39], a[200:203], a[24:27], v[36:39]
    v_mfma_f32_16x16x32_bf16 v[92:95], a[204:207], a[24:27], v[92:95]
    v_mfma_f32_16x16x32_bf16 v[120:123], a[208:211], a[24:27], v[120:123]
    v_mfma_f32_16x16x32_bf16 v[148:151], a[212:215], a[76:79], v[148:151]
    v_mfma_f32_16x16x32_bf16 v[92:95], a[200:203], a[76:79], v[92:95]
    v_mfma_f32_16x16x32_bf16 v[64:67], a[204:207], a[76:79], v[64:67]
    v_mfma_f32_16x16x32_bf16 v[60:63], a[204:207], a[72:75], v[60:63]
    v_mfma_f32_16x16x32_bf16 v[88:91], a[200:203], a[72:75], v[88:91]
    v_mfma_f32_16x16x32_bf16 v[144:147], a[212:215], a[72:75], v[144:147]
    v_mfma_f32_16x16x32_bf16 v[116:119], a[208:211], a[20:23], v[116:119]
    v_mfma_f32_16x16x32_bf16 v[88:91], a[204:207], a[20:23], v[88:91]
    v_mfma_f32_16x16x32_bf16 v[32:35], a[200:203], a[20:23], v[32:35]
    v_mfma_f32_16x16x32_bf16 v[28:31], a[200:203], a[16:19], v[28:31]
    v_mfma_f32_16x16x32_bf16 v[84:87], a[204:207], a[16:19], v[84:87]
    v_mfma_f32_16x16x32_bf16 v[112:115], a[208:211], a[16:19], v[112:115]
    v_mfma_f32_16x16x32_bf16 v[140:143], a[212:215], a[68:71], v[140:143]
    v_mfma_f32_16x16x32_bf16 v[84:87], a[200:203], a[68:71], v[84:87]
    v_mfma_f32_16x16x32_bf16 v[56:59], a[204:207], a[68:71], v[56:59]
    v_mfma_f32_16x16x32_bf16 v[52:55], a[204:207], a[64:67], v[52:55]
    v_mfma_f32_16x16x32_bf16 v[80:83], a[200:203], a[64:67], v[80:83]
    ds_read_b128 a[36:39], v6 offset:1440
    v_mfma_f32_16x16x32_bf16 v[136:139], a[212:215], a[64:67], v[136:139]
    v_mfma_f32_16x16x32_bf16 v[108:111], a[208:211], a[12:15], v[108:111]
    ds_read_b128 a[88:91], v6 offset:1504
    v_mfma_f32_16x16x32_bf16 v[80:83], a[204:207], a[12:15], v[80:83]
    v_mfma_f32_16x16x32_bf16 v[24:27], a[200:203], a[12:15], v[24:27]
    ds_read_b128 a[32:35], v6 offset:1280
    v_mfma_f32_16x16x32_bf16 v[20:23], a[200:203], a[8:11], v[20:23]
    v_mfma_f32_16x16x32_bf16 v[76:79], a[204:207], a[8:11], v[76:79]
    ds_read_b128 a[84:87], v6 offset:1344
    v_mfma_f32_16x16x32_bf16 v[104:107], a[208:211], a[8:11], v[104:107]
    v_mfma_f32_16x16x32_bf16 v[132:135], a[212:215], a[60:63], v[132:135]
    ds_read_b128 a[28:31], v6 offset:1120
    v_mfma_f32_16x16x32_bf16 v[76:79], a[200:203], a[60:63], v[76:79]
    v_mfma_f32_16x16x32_bf16 v[48:51], a[204:207], a[60:63], v[48:51]
    ds_read_b128 a[80:83], v6 offset:1184
    v_mfma_f32_16x16x32_bf16 v[44:47], a[204:207], a[56:59], v[44:47]
    v_mfma_f32_16x16x32_bf16 v[72:75], a[200:203], a[56:59], v[72:75]
    ds_read_b128 a[24:27], v6 offset:960
    v_mfma_f32_16x16x32_bf16 v[128:131], a[212:215], a[56:59], v[128:131]
    v_mfma_f32_16x16x32_bf16 v[100:103], a[208:211], a[4:7], v[100:103]
    ds_read_b128 a[76:79], v6 offset:1024
    v_mfma_f32_16x16x32_bf16 v[72:75], a[204:207], a[4:7], v[72:75]
    v_mfma_f32_16x16x32_bf16 v[16:19], a[200:203], a[4:7], v[16:19]
    s_waitcnt lgkmcnt(15)
    v_mfma_f32_16x16x32_bf16 v[12:15], a[200:203], a[0:3], v[12:15]
    v_mfma_f32_16x16x32_bf16 v[68:71], a[204:207], a[0:3], v[68:71]
    v_mfma_f32_16x16x32_bf16 v[96:99], a[208:211], a[0:3], v[96:99]
    s_waitcnt lgkmcnt(14)
    v_mfma_f32_16x16x32_bf16 v[124:127], a[212:215], a[52:55], v[124:127]
    v_mfma_f32_16x16x32_bf16 v[68:71], a[200:203], a[52:55], v[68:71]
    v_mfma_f32_16x16x32_bf16 v[40:43], a[204:207], a[52:55], v[40:43]
    s_waitcnt lgkmcnt(13)
    v_mfma_f32_16x16x32_bf16 v[36:39], a[216:219], a[48:51], v[36:39]
    v_mfma_f32_16x16x32_bf16 v[92:95], a[220:223], a[48:51], v[92:95]
    v_mfma_f32_16x16x32_bf16 v[120:123], a[224:227], a[48:51], v[120:123]
    ds_read_b128 a[20:23], v6 offset:800
    s_waitcnt lgkmcnt(12)
    v_mfma_f32_16x16x32_bf16 v[36:39], a[232:235], a[44:47], v[36:39]
    v_mfma_f32_16x16x32_bf16 v[92:95], a[236:239], a[44:47], v[92:95]
    v_mfma_f32_16x16x32_bf16 v[120:123], a[240:243], a[44:47], v[120:123]
    ds_read_b128 a[72:75], v6 offset:864
    s_waitcnt lgkmcnt(11)
    v_mfma_f32_16x16x32_bf16 v[36:39], a[248:251], a[40:43], v[36:39]
    v_mfma_f32_16x16x32_bf16 v[92:95], a[252:255], a[40:43], v[92:95]
    v_mfma_f32_16x16x32_bf16 v[120:123], v[168:171], a[40:43], v[120:123]
    s_add_u32 s47, s45, 86016
    s_waitcnt lgkmcnt(9)
    v_mfma_f32_16x16x32_bf16 v[36:39], v[176:179], a[36:39], v[36:39]
    buffer_load_dwordx4 a[104:107], v4, s[16:19], s47 offen offset:0
    v_mfma_f32_16x16x32_bf16 v[92:95], v[180:183], a[36:39], v[92:95]
    v_mfma_f32_16x16x32_bf16 v[120:123], v[184:187], a[36:39], v[120:123]
    buffer_load_dwordx4 a[108:111], v4, s[16:19], s47 offen offset:1024
    s_waitcnt vmcnt(13)
    s_waitcnt lgkmcnt(7)
    v_mfma_f32_16x16x32_bf16 v[36:39], v[192:195], a[32:35], v[36:39]
    s_waitcnt vmcnt(12)
    v_mfma_f32_16x16x32_bf16 v[92:95], v[196:199], a[32:35], v[92:95]
    buffer_load_dwordx4 a[112:115], v4, s[16:19], s47 offen offset:2048
    s_waitcnt vmcnt(12)
    v_mfma_f32_16x16x32_bf16 v[120:123], v[200:203], a[32:35], v[120:123]
    s_waitcnt vmcnt(10)
    s_waitcnt lgkmcnt(5)
    v_mfma_f32_16x16x32_bf16 v[36:39], v[208:211], a[28:31], v[36:39]
    buffer_load_dwordx4 a[116:119], v4, s[16:19], s47 offen offset:3072
    s_waitcnt vmcnt(10)
    v_mfma_f32_16x16x32_bf16 v[92:95], v[212:215], a[28:31], v[92:95]
    s_waitcnt vmcnt(9)
    v_mfma_f32_16x16x32_bf16 v[120:123], v[216:219], a[28:31], v[120:123]
    s_waitcnt vmcnt(7)
    s_waitcnt lgkmcnt(3)
    v_mfma_f32_16x16x32_bf16 v[36:39], v[224:227], a[24:27], v[36:39]
    s_waitcnt vmcnt(6)
    v_mfma_f32_16x16x32_bf16 v[92:95], v[228:231], a[24:27], v[92:95]
    s_add_u32 m0, s42, 76800
    s_add_u32 s46, s44, 8192
    s_mov_b64 exec, s[40:41]
    buffer_load_dwordx4 v3, s[12:15], s46 offen lds
    s_mov_b64 exec, -1
    s_waitcnt vmcnt(6)
    v_mfma_f32_16x16x32_bf16 v[120:123], v[232:235], a[24:27], v[120:123]
    v_mfma_f32_16x16x32_bf16 v[64:67], a[220:223], a[100:103], v[64:67]
    v_mfma_f32_16x16x32_bf16 v[92:95], a[216:219], a[100:103], v[92:95]
    v_mfma_f32_16x16x32_bf16 v[148:151], a[228:231], a[100:103], v[148:151]
    v_mfma_f32_16x16x32_bf16 v[64:67], a[236:239], a[96:99], v[64:67]
    s_add_u32 m0, s42, 80640
    s_add_u32 s46, s43, 8192
    s_mov_b64 exec, s[40:41]
    buffer_load_dwordx4 v3, s[12:15], s46 offen lds
    s_mov_b64 exec, -1
    v_mfma_f32_16x16x32_bf16 v[92:95], a[232:235], a[96:99], v[92:95]
    v_mfma_f32_16x16x32_bf16 v[148:151], a[244:247], a[96:99], v[148:151]
    v_mfma_f32_16x16x32_bf16 v[64:67], a[252:255], a[92:95], v[64:67]
    v_mfma_f32_16x16x32_bf16 v[92:95], a[248:251], a[92:95], v[92:95]
    v_mfma_f32_16x16x32_bf16 v[148:151], v[172:175], a[92:95], v[148:151]
    s_add_u32 m0, s42, 84480
    s_add_u32 s46, s43, 1187840
    s_mov_b64 exec, s[40:41]
    buffer_load_dwordx4 v3, s[12:15], s46 offen lds
    s_mov_b64 exec, -1
    v_mfma_f32_16x16x32_bf16 v[64:67], v[180:183], a[88:91], v[64:67]
    v_mfma_f32_16x16x32_bf16 v[92:95], v[176:179], a[88:91], v[92:95]
    v_mfma_f32_16x16x32_bf16 v[148:151], v[188:191], a[88:91], v[148:151]
    v_mfma_f32_16x16x32_bf16 v[64:67], v[196:199], a[84:87], v[64:67]
    v_mfma_f32_16x16x32_bf16 v[92:95], v[192:195], a[84:87], v[92:95]
    s_add_u32 m0, s42, 88320
    s_add_u32 s46, s43, 2367488
    s_mov_b64 exec, s[40:41]
    buffer_load_dwordx4 v3, s[12:15], s46 offen lds
    s_mov_b64 exec, -1
    v_mfma_f32_16x16x32_bf16 v[148:151], v[204:207], a[84:87], v[148:151]
    v_mfma_f32_16x16x32_bf16 v[64:67], v[212:215], a[80:83], v[64:67]
    v_mfma_f32_16x16x32_bf16 v[92:95], v[208:211], a[80:83], v[92:95]
    v_mfma_f32_16x16x32_bf16 v[148:151], v[220:223], a[80:83], v[148:151]
    s_waitcnt lgkmcnt(2)
    v_mfma_f32_16x16x32_bf16 v[64:67], v[228:231], a[76:79], v[64:67]
    v_mfma_f32_16x16x32_bf16 v[92:95], v[224:227], a[76:79], v[92:95]
    s_waitcnt vmcnt(8)
    v_mfma_f32_16x16x32_bf16 v[148:151], v[236:239], a[76:79], v[148:151]
    v_mfma_f32_16x16x32_bf16 v[32:35], a[216:219], a[44:47], v[32:35]
    v_mfma_f32_16x16x32_bf16 v[88:91], a[220:223], a[44:47], v[88:91]
    v_mfma_f32_16x16x32_bf16 v[116:119], a[224:227], a[44:47], v[116:119]
    ds_read_b128 a[16:19], v6 offset:640
    v_mfma_f32_16x16x32_bf16 v[32:35], a[232:235], a[40:43], v[32:35]
    v_mfma_f32_16x16x32_bf16 v[88:91], a[236:239], a[40:43], v[88:91]
    v_mfma_f32_16x16x32_bf16 v[116:119], a[240:243], a[40:43], v[116:119]
    ds_read_b128 a[68:71], v6 offset:704
    v_mfma_f32_16x16x32_bf16 v[32:35], a[248:251], a[36:39], v[32:35]
    v_mfma_f32_16x16x32_bf16 v[88:91], a[252:255], a[36:39], v[88:91]
    v_mfma_f32_16x16x32_bf16 v[116:119], v[168:171], a[36:39], v[116:119]
    s_add_u32 s47, s45, 92160
    v_mfma_f32_16x16x32_bf16 v[32:35], v[176:179], a[32:35], v[32:35]
    buffer_load_dwordx4 a[120:123], v4, s[16:19], s47 offen offset:0
    v_mfma_f32_16x16x32_bf16 v[88:91], v[180:183], a[32:35], v[88:91]
    v_mfma_f32_16x16x32_bf16 v[116:119], v[184:187], a[32:35], v[116:119]
    buffer_load_dwordx4 a[124:127], v4, s[16:19], s47 offen offset:1024
    v_mfma_f32_16x16x32_bf16 v[32:35], v[192:195], a[28:31], v[32:35]
    v_mfma_f32_16x16x32_bf16 v[88:91], v[196:199], a[28:31], v[88:91]
    buffer_load_dwordx4 a[128:131], v4, s[16:19], s47 offen offset:2048
    v_mfma_f32_16x16x32_bf16 v[116:119], v[200:203], a[28:31], v[116:119]
    v_mfma_f32_16x16x32_bf16 v[32:35], v[208:211], a[24:27], v[32:35]
    buffer_load_dwordx4 a[132:135], v4, s[16:19], s47 offen offset:3072
    v_mfma_f32_16x16x32_bf16 v[88:91], v[212:215], a[24:27], v[88:91]
    v_mfma_f32_16x16x32_bf16 v[116:119], v[216:219], a[24:27], v[116:119]
    s_waitcnt lgkmcnt(3)
    v_mfma_f32_16x16x32_bf16 v[32:35], v[224:227], a[20:23], v[32:35]
    v_mfma_f32_16x16x32_bf16 v[88:91], v[228:231], a[20:23], v[88:91]
    s_add_u32 m0, s42, 92160
    s_add_u32 s46, s43, 3547136
    s_mov_b64 exec, s[40:41]
    buffer_load_dwordx4 v3, s[12:15], s46 offen lds
    s_mov_b64 exec, -1
    v_mfma_f32_16x16x32_bf16 v[116:119], v[232:235], a[20:23], v[116:119]
    v_mfma_f32_16x16x32_bf16 v[60:63], a[220:223], a[96:99], v[60:63]
    v_mfma_f32_16x16x32_bf16 v[88:91], a[216:219], a[96:99], v[88:91]
    v_mfma_f32_16x16x32_bf16 v[144:147], a[228:231], a[96:99], v[144:147]
    v_mfma_f32_16x16x32_bf16 v[60:63], a[236:239], a[92:95], v[60:63]
    s_add_u32 m0, s42, 96000
    s_add_u32 s46, s43, 4726784
    s_mov_b64 exec, s[40:41]
    buffer_load_dwordx4 v3, s[12:15], s46 offen lds
    s_mov_b64 exec, -1
    v_mfma_f32_16x16x32_bf16 v[88:91], a[232:235], a[92:95], v[88:91]
    v_mfma_f32_16x16x32_bf16 v[144:147], a[244:247], a[92:95], v[144:147]
    v_mfma_f32_16x16x32_bf16 v[60:63], a[252:255], a[88:91], v[60:63]
    v_mfma_f32_16x16x32_bf16 v[88:91], a[248:251], a[88:91], v[88:91]
    v_mfma_f32_16x16x32_bf16 v[144:147], v[172:175], a[88:91], v[144:147]
    s_add_u32 m0, s42, 99840
    s_add_u32 s46, s43, 5906432
    s_mov_b64 exec, s[40:41]
    buffer_load_dwordx4 v3, s[12:15], s46 offen lds
    s_mov_b64 exec, -1
    v_mfma_f32_16x16x32_bf16 v[60:63], v[180:183], a[84:87], v[60:63]
    v_mfma_f32_16x16x32_bf16 v[88:91], v[176:179], a[84:87], v[88:91]
    v_mfma_f32_16x16x32_bf16 v[144:147], v[188:191], a[84:87], v[144:147]
    v_mfma_f32_16x16x32_bf16 v[60:63], v[196:199], a[80:83], v[60:63]
    v_mfma_f32_16x16x32_bf16 v[88:91], v[192:195], a[80:83], v[88:91]
    v_mfma_f32_16x16x32_bf16 v[144:147], v[204:207], a[80:83], v[144:147]
    v_mfma_f32_16x16x32_bf16 v[60:63], v[212:215], a[76:79], v[60:63]
    v_mfma_f32_16x16x32_bf16 v[88:91], v[208:211], a[76:79], v[88:91]
    v_mfma_f32_16x16x32_bf16 v[144:147], v[220:223], a[76:79], v[144:147]
    s_waitcnt lgkmcnt(2)
    v_mfma_f32_16x16x32_bf16 v[60:63], v[228:231], a[72:75], v[60:63]
    v_mfma_f32_16x16x32_bf16 v[88:91], v[224:227], a[72:75], v[88:91]
    v_mfma_f32_16x16x32_bf16 v[144:147], v[236:239], a[72:75], v[144:147]
    v_mfma_f32_16x16x32_bf16 v[28:31], a[216:219], a[40:43], v[28:31]
    v_mfma_f32_16x16x32_bf16 v[84:87], a[220:223], a[40:43], v[84:87]
    v_mfma_f32_16x16x32_bf16 v[112:115], a[224:227], a[40:43], v[112:115]
    ds_read_b128 a[12:15], v6 offset:480
    v_mfma_f32_16x16x32_bf16 v[28:31], a[232:235], a[36:39], v[28:31]
    v_mfma_f32_16x16x32_bf16 v[84:87], a[236:239], a[36:39], v[84:87]
    v_mfma_f32_16x16x32_bf16 v[112:115], a[240:243], a[36:39], v[112:115]
    ds_read_b128 a[64:67], v6 offset:544
    v_mfma_f32_16x16x32_bf16 v[28:31], a[248:251], a[32:35], v[28:31]
    v_mfma_f32_16x16x32_bf16 v[84:87], a[252:255], a[32:35], v[84:87]
    v_mfma_f32_16x16x32_bf16 v[112:115], v[168:171], a[32:35], v[112:115]
    s_add_u32 s47, s45, 98304
    v_mfma_f32_16x16x32_bf16 v[28:31], v[176:179], a[28:31], v[28:31]
    buffer_load_dwordx4 a[136:139], v4, s[16:19], s47 offen offset:0
    v_mfma_f32_16x16x32_bf16 v[84:87], v[180:183], a[28:31], v[84:87]
    v_mfma_f32_16x16x32_bf16 v[112:115], v[184:187], a[28:31], v[112:115]
    buffer_load_dwordx4 a[140:143], v4, s[16:19], s47 offen offset:1024
    v_mfma_f32_16x16x32_bf16 v[28:31], v[192:195], a[24:27], v[28:31]
    v_mfma_f32_16x16x32_bf16 v[84:87], v[196:199], a[24:27], v[84:87]
    buffer_load_dwordx4 a[144:147], v4, s[16:19], s47 offen offset:2048
    v_mfma_f32_16x16x32_bf16 v[112:115], v[200:203], a[24:27], v[112:115]
    v_mfma_f32_16x16x32_bf16 v[28:31], v[208:211], a[20:23], v[28:31]
    buffer_load_dwordx4 a[148:151], v4, s[16:19], s47 offen offset:3072
    v_mfma_f32_16x16x32_bf16 v[84:87], v[212:215], a[20:23], v[84:87]
    v_mfma_f32_16x16x32_bf16 v[112:115], v[216:219], a[20:23], v[112:115]
    s_waitcnt lgkmcnt(3)
    v_mfma_f32_16x16x32_bf16 v[28:31], v[224:227], a[16:19], v[28:31]
    v_mfma_f32_16x16x32_bf16 v[84:87], v[228:231], a[16:19], v[84:87]
    s_add_u32 m0, s42, 103680
    s_add_u32 s46, s43, 7086080
    s_mov_b64 exec, s[40:41]
    buffer_load_dwordx4 v3, s[12:15], s46 offen lds
    s_mov_b64 exec, -1
    v_mfma_f32_16x16x32_bf16 v[112:115], v[232:235], a[16:19], v[112:115]
    v_mfma_f32_16x16x32_bf16 v[56:59], a[220:223], a[92:95], v[56:59]
    v_mfma_f32_16x16x32_bf16 v[84:87], a[216:219], a[92:95], v[84:87]
    v_mfma_f32_16x16x32_bf16 v[140:143], a[228:231], a[92:95], v[140:143]
    v_mfma_f32_16x16x32_bf16 v[56:59], a[236:239], a[88:91], v[56:59]
    s_add_u32 m0, s42, 107520
    s_add_u32 s46, s43, 8265728
    s_mov_b64 exec, s[40:41]
    buffer_load_dwordx4 v3, s[12:15], s46 offen lds
    s_mov_b64 exec, -1
    v_mfma_f32_16x16x32_bf16 v[84:87], a[232:235], a[88:91], v[84:87]
    v_mfma_f32_16x16x32_bf16 v[140:143], a[244:247], a[88:91], v[140:143]
    v_mfma_f32_16x16x32_bf16 v[56:59], a[252:255], a[84:87], v[56:59]
    v_mfma_f32_16x16x32_bf16 v[84:87], a[248:251], a[84:87], v[84:87]
    v_mfma_f32_16x16x32_bf16 v[140:143], v[172:175], a[84:87], v[140:143]
    s_add_u32 m0, s42, 111360
    s_add_u32 s46, s43, 9445376
    s_mov_b64 exec, s[40:41]
    buffer_load_dwordx4 v3, s[12:15], s46 offen lds
    s_mov_b64 exec, -1
    v_mfma_f32_16x16x32_bf16 v[56:59], v[180:183], a[80:83], v[56:59]
    v_mfma_f32_16x16x32_bf16 v[84:87], v[176:179], a[80:83], v[84:87]
    v_mfma_f32_16x16x32_bf16 v[140:143], v[188:191], a[80:83], v[140:143]
    v_mfma_f32_16x16x32_bf16 v[56:59], v[196:199], a[76:79], v[56:59]
    v_mfma_f32_16x16x32_bf16 v[84:87], v[192:195], a[76:79], v[84:87]
    v_mfma_f32_16x16x32_bf16 v[140:143], v[204:207], a[76:79], v[140:143]
    v_mfma_f32_16x16x32_bf16 v[56:59], v[212:215], a[72:75], v[56:59]
    v_mfma_f32_16x16x32_bf16 v[84:87], v[208:211], a[72:75], v[84:87]
    v_mfma_f32_16x16x32_bf16 v[140:143], v[220:223], a[72:75], v[140:143]
    s_waitcnt lgkmcnt(2)
    v_mfma_f32_16x16x32_bf16 v[56:59], v[228:231], a[68:71], v[56:59]
    v_mfma_f32_16x16x32_bf16 v[84:87], v[224:227], a[68:71], v[84:87]
    v_mfma_f32_16x16x32_bf16 v[140:143], v[236:239], a[68:71], v[140:143]
    v_mfma_f32_16x16x32_bf16 v[24:27], a[216:219], a[36:39], v[24:27]
    v_mfma_f32_16x16x32_bf16 v[80:83], a[220:223], a[36:39], v[80:83]
    v_mfma_f32_16x16x32_bf16 v[108:111], a[224:227], a[36:39], v[108:111]
    ds_read_b128 a[8:11], v6 offset:320
    v_mfma_f32_16x16x32_bf16 v[24:27], a[232:235], a[32:35], v[24:27]
    v_mfma_f32_16x16x32_bf16 v[80:83], a[236:239], a[32:35], v[80:83]
    v_mfma_f32_16x16x32_bf16 v[108:111], a[240:243], a[32:35], v[108:111]
    ds_read_b128 a[60:63], v6 offset:384
    v_mfma_f32_16x16x32_bf16 v[24:27], a[248:251], a[28:31], v[24:27]
    v_mfma_f32_16x16x32_bf16 v[80:83], a[252:255], a[28:31], v[80:83]
    v_mfma_f32_16x16x32_bf16 v[108:111], v[168:171], a[28:31], v[108:111]
    s_add_u32 s47, s45, 104448
    v_mfma_f32_16x16x32_bf16 v[24:27], v[176:179], a[24:27], v[24:27]
    buffer_load_dwordx4 a[152:155], v4, s[16:19], s47 offen offset:0
    v_mfma_f32_16x16x32_bf16 v[80:83], v[180:183], a[24:27], v[80:83]
    v_mfma_f32_16x16x32_bf16 v[108:111], v[184:187], a[24:27], v[108:111]
    buffer_load_dwordx4 a[156:159], v4, s[16:19], s47 offen offset:1024
    v_mfma_f32_16x16x32_bf16 v[24:27], v[192:195], a[20:23], v[24:27]
    v_mfma_f32_16x16x32_bf16 v[80:83], v[196:199], a[20:23], v[80:83]
    buffer_load_dwordx4 a[160:163], v4, s[16:19], s47 offen offset:2048
    v_mfma_f32_16x16x32_bf16 v[108:111], v[200:203], a[20:23], v[108:111]
    v_mfma_f32_16x16x32_bf16 v[24:27], v[208:211], a[16:19], v[24:27]
    buffer_load_dwordx4 a[164:167], v4, s[16:19], s47 offen offset:3072
    v_mfma_f32_16x16x32_bf16 v[80:83], v[212:215], a[16:19], v[80:83]
    v_mfma_f32_16x16x32_bf16 v[108:111], v[216:219], a[16:19], v[108:111]
    s_waitcnt lgkmcnt(3)
    v_mfma_f32_16x16x32_bf16 v[24:27], v[224:227], a[12:15], v[24:27]
    v_mfma_f32_16x16x32_bf16 v[80:83], v[228:231], a[12:15], v[80:83]
    v_mfma_f32_16x16x32_bf16 v[108:111], v[232:235], a[12:15], v[108:111]
    v_mfma_f32_16x16x32_bf16 v[52:55], a[220:223], a[88:91], v[52:55]
    v_mfma_f32_16x16x32_bf16 v[80:83], a[216:219], a[88:91], v[80:83]
    v_mfma_f32_16x16x32_bf16 v[136:139], a[228:231], a[88:91], v[136:139]
    v_mfma_f32_16x16x32_bf16 v[52:55], a[236:239], a[84:87], v[52:55]
    v_mfma_f32_16x16x32_bf16 v[80:83], a[232:235], a[84:87], v[80:83]
    v_mfma_f32_16x16x32_bf16 v[136:139], a[244:247], a[84:87], v[136:139]
    v_mfma_f32_16x16x32_bf16 v[52:55], a[252:255], a[80:83], v[52:55]
    v_mfma_f32_16x16x32_bf16 v[80:83], a[248:251], a[80:83], v[80:83]
    v_mfma_f32_16x16x32_bf16 v[136:139], v[172:175], a[80:83], v[136:139]
    v_mfma_f32_16x16x32_bf16 v[52:55], v[180:183], a[76:79], v[52:55]
    v_mfma_f32_16x16x32_bf16 v[80:83], v[176:179], a[76:79], v[80:83]
    v_mfma_f32_16x16x32_bf16 v[136:139], v[188:191], a[76:79], v[136:139]
    v_mfma_f32_16x16x32_bf16 v[52:55], v[196:199], a[72:75], v[52:55]
    v_mfma_f32_16x16x32_bf16 v[80:83], v[192:195], a[72:75], v[80:83]
    v_mfma_f32_16x16x32_bf16 v[136:139], v[204:207], a[72:75], v[136:139]
    v_mfma_f32_16x16x32_bf16 v[52:55], v[212:215], a[68:71], v[52:55]
    v_mfma_f32_16x16x32_bf16 v[80:83], v[208:211], a[68:71], v[80:83]
    v_mfma_f32_16x16x32_bf16 v[136:139], v[220:223], a[68:71], v[136:139]
    s_waitcnt lgkmcnt(2)
    v_mfma_f32_16x16x32_bf16 v[52:55], v[228:231], a[64:67], v[52:55]
    v_mfma_f32_16x16x32_bf16 v[80:83], v[224:227], a[64:67], v[80:83]
    v_mfma_f32_16x16x32_bf16 v[136:139], v[236:239], a[64:67], v[136:139]
    v_mfma_f32_16x16x32_bf16 v[20:23], a[216:219], a[32:35], v[20:23]
    v_mfma_f32_16x16x32_bf16 v[76:79], a[220:223], a[32:35], v[76:79]
    v_mfma_f32_16x16x32_bf16 v[104:107], a[224:227], a[32:35], v[104:107]
    ds_read_b128 a[4:7], v6 offset:160
    v_mfma_f32_16x16x32_bf16 v[20:23], a[232:235], a[28:31], v[20:23]
    v_mfma_f32_16x16x32_bf16 v[76:79], a[236:239], a[28:31], v[76:79]
    v_mfma_f32_16x16x32_bf16 v[104:107], a[240:243], a[28:31], v[104:107]
    ds_read_b128 a[56:59], v6 offset:224
    v_mfma_f32_16x16x32_bf16 v[20:23], a[248:251], a[24:27], v[20:23]
    v_mfma_f32_16x16x32_bf16 v[76:79], a[252:255], a[24:27], v[76:79]
    v_mfma_f32_16x16x32_bf16 v[104:107], v[168:171], a[24:27], v[104:107]
    s_add_u32 s47, s45, 110592
    v_mfma_f32_16x16x32_bf16 v[20:23], v[176:179], a[20:23], v[20:23]
    buffer_load_dwordx4 a[168:171], v4, s[16:19], s47 offen offset:0
    v_mfma_f32_16x16x32_bf16 v[76:79], v[180:183], a[20:23], v[76:79]
    v_mfma_f32_16x16x32_bf16 v[104:107], v[184:187], a[20:23], v[104:107]
    buffer_load_dwordx4 a[172:175], v4, s[16:19], s47 offen offset:1024
    v_mfma_f32_16x16x32_bf16 v[20:23], v[192:195], a[16:19], v[20:23]
    v_mfma_f32_16x16x32_bf16 v[76:79], v[196:199], a[16:19], v[76:79]
    buffer_load_dwordx4 a[176:179], v4, s[16:19], s47 offen offset:2048
    v_mfma_f32_16x16x32_bf16 v[104:107], v[200:203], a[16:19], v[104:107]
    v_mfma_f32_16x16x32_bf16 v[20:23], v[208:211], a[12:15], v[20:23]
    buffer_load_dwordx4 a[180:183], v4, s[16:19], s47 offen offset:3072
    v_mfma_f32_16x16x32_bf16 v[76:79], v[212:215], a[12:15], v[76:79]
    v_mfma_f32_16x16x32_bf16 v[104:107], v[216:219], a[12:15], v[104:107]
    s_waitcnt lgkmcnt(3)
    v_mfma_f32_16x16x32_bf16 v[20:23], v[224:227], a[8:11], v[20:23]
    v_mfma_f32_16x16x32_bf16 v[76:79], v[228:231], a[8:11], v[76:79]
    v_mfma_f32_16x16x32_bf16 v[104:107], v[232:235], a[8:11], v[104:107]
    v_mfma_f32_16x16x32_bf16 v[48:51], a[220:223], a[84:87], v[48:51]
    v_mfma_f32_16x16x32_bf16 v[76:79], a[216:219], a[84:87], v[76:79]
    v_mfma_f32_16x16x32_bf16 v[132:135], a[228:231], a[84:87], v[132:135]
    v_mfma_f32_16x16x32_bf16 v[48:51], a[236:239], a[80:83], v[48:51]
    v_mfma_f32_16x16x32_bf16 v[76:79], a[232:235], a[80:83], v[76:79]
    v_mfma_f32_16x16x32_bf16 v[132:135], a[244:247], a[80:83], v[132:135]
    v_mfma_f32_16x16x32_bf16 v[48:51], a[252:255], a[76:79], v[48:51]
    v_mfma_f32_16x16x32_bf16 v[76:79], a[248:251], a[76:79], v[76:79]
    v_mfma_f32_16x16x32_bf16 v[132:135], v[172:175], a[76:79], v[132:135]
    v_mfma_f32_16x16x32_bf16 v[48:51], v[180:183], a[72:75], v[48:51]
    v_mfma_f32_16x16x32_bf16 v[76:79], v[176:179], a[72:75], v[76:79]
    v_mfma_f32_16x16x32_bf16 v[132:135], v[188:191], a[72:75], v[132:135]
    v_mfma_f32_16x16x32_bf16 v[48:51], v[196:199], a[68:71], v[48:51]
    v_mfma_f32_16x16x32_bf16 v[76:79], v[192:195], a[68:71], v[76:79]
    v_mfma_f32_16x16x32_bf16 v[132:135], v[204:207], a[68:71], v[132:135]
    v_mfma_f32_16x16x32_bf16 v[48:51], v[212:215], a[64:67], v[48:51]
    v_mfma_f32_16x16x32_bf16 v[76:79], v[208:211], a[64:67], v[76:79]
    v_mfma_f32_16x16x32_bf16 v[132:135], v[220:223], a[64:67], v[132:135]
    s_waitcnt lgkmcnt(2)
    v_mfma_f32_16x16x32_bf16 v[48:51], v[228:231], a[60:63], v[48:51]
    v_mfma_f32_16x16x32_bf16 v[76:79], v[224:227], a[60:63], v[76:79]
    v_mfma_f32_16x16x32_bf16 v[132:135], v[236:239], a[60:63], v[132:135]
    v_mfma_f32_16x16x32_bf16 v[16:19], a[216:219], a[28:31], v[16:19]
    s_waitcnt vmcnt(8)
    s_barrier
    v_mfma_f32_16x16x32_bf16 v[72:75], a[220:223], a[28:31], v[72:75]
    v_mfma_f32_16x16x32_bf16 v[100:103], a[224:227], a[28:31], v[100:103]
    ds_read_b128 a[0:3], v6 offset:0
    v_mfma_f32_16x16x32_bf16 v[16:19], a[232:235], a[24:27], v[16:19]
    v_mfma_f32_16x16x32_bf16 v[72:75], a[236:239], a[24:27], v[72:75]
    v_mfma_f32_16x16x32_bf16 v[100:103], a[240:243], a[24:27], v[100:103]
    ds_read_b128 a[52:55], v6 offset:64
    v_mfma_f32_16x16x32_bf16 v[16:19], a[248:251], a[20:23], v[16:19]
    v_mfma_f32_16x16x32_bf16 v[72:75], a[252:255], a[20:23], v[72:75]
    v_mfma_f32_16x16x32_bf16 v[100:103], v[168:171], a[20:23], v[100:103]
    s_add_u32 s47, s45, 116736
    v_mfma_f32_16x16x32_bf16 v[16:19], v[176:179], a[16:19], v[16:19]
    buffer_load_dwordx4 a[184:187], v4, s[16:19], s47 offen offset:0
    v_mfma_f32_16x16x32_bf16 v[72:75], v[180:183], a[16:19], v[72:75]
    v_mfma_f32_16x16x32_bf16 v[100:103], v[184:187], a[16:19], v[100:103]
    buffer_load_dwordx4 a[188:191], v4, s[16:19], s47 offen offset:1024
    v_mfma_f32_16x16x32_bf16 v[16:19], v[192:195], a[12:15], v[16:19]
    v_mfma_f32_16x16x32_bf16 v[72:75], v[196:199], a[12:15], v[72:75]
    buffer_load_dwordx4 a[192:195], v4, s[16:19], s47 offen offset:2048
    v_mfma_f32_16x16x32_bf16 v[100:103], v[200:203], a[12:15], v[100:103]
    v_mfma_f32_16x16x32_bf16 v[16:19], v[208:211], a[8:11], v[16:19]
    buffer_load_dwordx4 a[196:199], v4, s[16:19], s47 offen offset:3072
    v_mfma_f32_16x16x32_bf16 v[72:75], v[212:215], a[8:11], v[72:75]
    v_mfma_f32_16x16x32_bf16 v[100:103], v[216:219], a[8:11], v[100:103]
    s_waitcnt lgkmcnt(3)
    v_mfma_f32_16x16x32_bf16 v[16:19], v[224:227], a[4:7], v[16:19]
    s_add_u32 s47, s45, 122880
    v_mfma_f32_16x16x32_bf16 v[72:75], v[228:231], a[4:7], v[72:75]
    buffer_load_dwordx4 a[200:203], v4, s[16:19], s47 offen offset:0
    v_mfma_f32_16x16x32_bf16 v[100:103], v[232:235], a[4:7], v[100:103]
    v_mfma_f32_16x16x32_bf16 v[44:47], a[220:223], a[80:83], v[44:47]
    buffer_load_dwordx4 a[204:207], v4, s[16:19], s47 offen offset:1024
    v_mfma_f32_16x16x32_bf16 v[72:75], a[216:219], a[80:83], v[72:75]
    v_mfma_f32_16x16x32_bf16 v[128:131], a[228:231], a[80:83], v[128:131]
    buffer_load_dwordx4 a[208:211], v4, s[16:19], s47 offen offset:2048
    v_mfma_f32_16x16x32_bf16 v[44:47], a[236:239], a[76:79], v[44:47]
    v_mfma_f32_16x16x32_bf16 v[72:75], a[232:235], a[76:79], v[72:75]
    buffer_load_dwordx4 a[212:215], v4, s[16:19], s47 offen offset:3072
    v_mfma_f32_16x16x32_bf16 v[128:131], a[244:247], a[76:79], v[128:131]
    v_mfma_f32_16x16x32_bf16 v[44:47], a[252:255], a[72:75], v[44:47]
    ds_read_b128 a[48:51], v7 offset:1920
    v_mfma_f32_16x16x32_bf16 v[72:75], a[248:251], a[72:75], v[72:75]
    ds_read_b128 a[100:103], v7 offset:1984
    v_mfma_f32_16x16x32_bf16 v[128:131], v[172:175], a[72:75], v[128:131]
    ds_read_b128 a[44:47], v7 offset:1760
    v_mfma_f32_16x16x32_bf16 v[44:47], v[180:183], a[68:71], v[44:47]
    ds_read_b128 a[96:99], v7 offset:1824
    v_mfma_f32_16x16x32_bf16 v[72:75], v[176:179], a[68:71], v[72:75]
    ds_read_b128 a[40:43], v7 offset:1600
    v_mfma_f32_16x16x32_bf16 v[128:131], v[188:191], a[68:71], v[128:131]
    ds_read_b128 a[92:95], v7 offset:1664
    v_mfma_f32_16x16x32_bf16 v[44:47], v[196:199], a[64:67], v[44:47]
    ds_read_b128 a[36:39], v7 offset:1440
    v_mfma_f32_16x16x32_bf16 v[72:75], v[192:195], a[64:67], v[72:75]
    ds_read_b128 a[88:91], v7 offset:1504
    v_mfma_f32_16x16x32_bf16 v[128:131], v[204:207], a[64:67], v[128:131]
    ds_read_b128 a[32:35], v7 offset:1280
    v_mfma_f32_16x16x32_bf16 v[44:47], v[212:215], a[60:63], v[44:47]
    ds_read_b128 a[84:87], v7 offset:1344
    v_mfma_f32_16x16x32_bf16 v[72:75], v[208:211], a[60:63], v[72:75]
    v_mfma_f32_16x16x32_bf16 v[128:131], v[220:223], a[60:63], v[128:131]
    s_waitcnt lgkmcnt(12)
    v_mfma_f32_16x16x32_bf16 v[44:47], v[228:231], a[56:59], v[44:47]
    v_mfma_f32_16x16x32_bf16 v[72:75], v[224:227], a[56:59], v[72:75]
    v_mfma_f32_16x16x32_bf16 v[128:131], v[236:239], a[56:59], v[128:131]
    v_mfma_f32_16x16x32_bf16 v[12:15], a[216:219], a[24:27], v[12:15]
    v_mfma_f32_16x16x32_bf16 v[68:71], a[220:223], a[24:27], v[68:71]
    v_mfma_f32_16x16x32_bf16 v[96:99], a[224:227], a[24:27], v[96:99]
    ds_read_b128 a[24:27], v7 offset:960
    v_mfma_f32_16x16x32_bf16 v[12:15], a[232:235], a[20:23], v[12:15]
    v_mfma_f32_16x16x32_bf16 v[68:71], a[236:239], a[20:23], v[68:71]
    v_mfma_f32_16x16x32_bf16 v[96:99], a[240:243], a[20:23], v[96:99]
    v_mfma_f32_16x16x32_bf16 v[12:15], a[248:251], a[16:19], v[12:15]
    v_mfma_f32_16x16x32_bf16 v[68:71], a[252:255], a[16:19], v[68:71]
    v_mfma_f32_16x16x32_bf16 v[96:99], v[168:171], a[16:19], v[96:99]
    ds_read_b128 a[28:31], v7 offset:1120
    v_mfma_f32_16x16x32_bf16 v[12:15], v[176:179], a[12:15], v[12:15]
    ds_read_b128 a[80:83], v7 offset:1184
    v_mfma_f32_16x16x32_bf16 v[68:71], v[180:183], a[12:15], v[68:71]
    v_mfma_f32_16x16x32_bf16 v[96:99], v[184:187], a[12:15], v[96:99]
    v_mfma_f32_16x16x32_bf16 v[12:15], v[192:195], a[8:11], v[12:15]
    v_mfma_f32_16x16x32_bf16 v[68:71], v[196:199], a[8:11], v[68:71]
    v_mfma_f32_16x16x32_bf16 v[96:99], v[200:203], a[8:11], v[96:99]
    v_mfma_f32_16x16x32_bf16 v[12:15], v[208:211], a[4:7], v[12:15]
    v_mfma_f32_16x16x32_bf16 v[68:71], v[212:215], a[4:7], v[68:71]
    v_mfma_f32_16x16x32_bf16 v[96:99], v[216:219], a[4:7], v[96:99]
    s_waitcnt lgkmcnt(14)
    v_mfma_f32_16x16x32_bf16 v[12:15], v[224:227], a[0:3], v[12:15]
    v_mfma_f32_16x16x32_bf16 v[68:71], v[228:231], a[0:3], v[68:71]
    v_mfma_f32_16x16x32_bf16 v[96:99], v[232:235], a[0:3], v[96:99]
    v_mfma_f32_16x16x32_bf16 v[40:43], a[220:223], a[76:79], v[40:43]
    v_mfma_f32_16x16x32_bf16 v[68:71], a[216:219], a[76:79], v[68:71]
    v_mfma_f32_16x16x32_bf16 v[124:127], a[228:231], a[76:79], v[124:127]
    ds_read_b128 a[76:79], v7 offset:1024
    v_mfma_f32_16x16x32_bf16 v[40:43], a[236:239], a[72:75], v[40:43]
    v_mfma_f32_16x16x32_bf16 v[68:71], a[232:235], a[72:75], v[68:71]
    v_mfma_f32_16x16x32_bf16 v[124:127], a[244:247], a[72:75], v[124:127]
    v_mfma_f32_16x16x32_bf16 v[40:43], a[252:255], a[68:71], v[40:43]
    v_mfma_f32_16x16x32_bf16 v[68:71], a[248:251], a[68:71], v[68:71]
    v_mfma_f32_16x16x32_bf16 v[124:127], v[172:175], a[68:71], v[124:127]
    v_mfma_f32_16x16x32_bf16 v[40:43], v[180:183], a[64:67], v[40:43]
    v_mfma_f32_16x16x32_bf16 v[68:71], v[176:179], a[64:67], v[68:71]
    v_mfma_f32_16x16x32_bf16 v[124:127], v[188:191], a[64:67], v[124:127]
    v_mfma_f32_16x16x32_bf16 v[40:43], v[196:199], a[60:63], v[40:43]
    v_mfma_f32_16x16x32_bf16 v[68:71], v[192:195], a[60:63], v[68:71]
    v_mfma_f32_16x16x32_bf16 v[124:127], v[204:207], a[60:63], v[124:127]
    v_mfma_f32_16x16x32_bf16 v[40:43], v[212:215], a[56:59], v[40:43]
    v_mfma_f32_16x16x32_bf16 v[68:71], v[208:211], a[56:59], v[68:71]
    v_mfma_f32_16x16x32_bf16 v[124:127], v[220:223], a[56:59], v[124:127]
    s_waitcnt lgkmcnt(14)
    v_mfma_f32_16x16x32_bf16 v[40:43], v[228:231], a[52:55], v[40:43]
    v_mfma_f32_16x16x32_bf16 v[68:71], v[224:227], a[52:55], v[68:71]
    v_mfma_f32_16x16x32_bf16 v[124:127], v[236:239], a[52:55], v[124:127]
    s_waitcnt lgkmcnt(13)
    v_mfma_f32_16x16x32_bf16 v[36:39], a[104:107], a[48:51], v[36:39]
    v_mfma_f32_16x16x32_bf16 v[92:95], a[108:111], a[48:51], v[92:95]
    v_mfma_f32_16x16x32_bf16 v[120:123], a[112:115], a[48:51], v[120:123]
    ds_read_b128 a[20:23], v7 offset:800
    s_waitcnt lgkmcnt(12)
    v_mfma_f32_16x16x32_bf16 v[36:39], a[120:123], a[44:47], v[36:39]
    v_mfma_f32_16x16x32_bf16 v[92:95], a[124:127], a[44:47], v[92:95]
    v_mfma_f32_16x16x32_bf16 v[120:123], a[128:131], a[44:47], v[120:123]
    ds_read_b128 a[72:75], v7 offset:864
    s_waitcnt lgkmcnt(11)
    v_mfma_f32_16x16x32_bf16 v[36:39], a[136:139], a[40:43], v[36:39]
    v_mfma_f32_16x16x32_bf16 v[92:95], a[140:143], a[40:43], v[92:95]
    v_mfma_f32_16x16x32_bf16 v[120:123], a[144:147], a[40:43], v[120:123]
    s_waitcnt vmcnt(15)
    s_waitcnt lgkmcnt(9)
    v_mfma_f32_16x16x32_bf16 v[36:39], a[152:155], a[36:39], v[36:39]
    s_waitcnt vmcnt(14)
    v_mfma_f32_16x16x32_bf16 v[92:95], a[156:159], a[36:39], v[92:95]
    s_waitcnt vmcnt(13)
    v_mfma_f32_16x16x32_bf16 v[120:123], a[160:163], a[36:39], v[120:123]
    s_waitcnt vmcnt(11)
    s_waitcnt lgkmcnt(7)
    v_mfma_f32_16x16x32_bf16 v[36:39], a[168:171], a[32:35], v[36:39]
    s_waitcnt vmcnt(10)
    v_mfma_f32_16x16x32_bf16 v[92:95], a[172:175], a[32:35], v[92:95]
    s_waitcnt vmcnt(9)
    v_mfma_f32_16x16x32_bf16 v[120:123], a[176:179], a[32:35], v[120:123]
    s_waitcnt vmcnt(7)
    s_waitcnt lgkmcnt(4)
    v_mfma_f32_16x16x32_bf16 v[36:39], a[184:187], a[28:31], v[36:39]
    s_waitcnt vmcnt(6)
    v_mfma_f32_16x16x32_bf16 v[92:95], a[188:191], a[28:31], v[92:95]
    s_waitcnt vmcnt(5)
    v_mfma_f32_16x16x32_bf16 v[120:123], a[192:195], a[28:31], v[120:123]
    s_waitcnt vmcnt(3)
    v_mfma_f32_16x16x32_bf16 v[36:39], a[200:203], a[24:27], v[36:39]
    s_waitcnt vmcnt(2)
    v_mfma_f32_16x16x32_bf16 v[92:95], a[204:207], a[24:27], v[92:95]
    s_waitcnt vmcnt(1)
    v_mfma_f32_16x16x32_bf16 v[120:123], a[208:211], a[24:27], v[120:123]
    v_mfma_f32_16x16x32_bf16 v[64:67], a[108:111], a[100:103], v[64:67]
    v_mfma_f32_16x16x32_bf16 v[92:95], a[104:107], a[100:103], v[92:95]
    v_mfma_f32_16x16x32_bf16 v[148:151], a[116:119], a[100:103], v[148:151]
    v_mfma_f32_16x16x32_bf16 v[64:67], a[124:127], a[96:99], v[64:67]
    v_mfma_f32_16x16x32_bf16 v[92:95], a[120:123], a[96:99], v[92:95]
    v_mfma_f32_16x16x32_bf16 v[148:151], a[132:135], a[96:99], v[148:151]
    v_mfma_f32_16x16x32_bf16 v[64:67], a[140:143], a[92:95], v[64:67]
    v_mfma_f32_16x16x32_bf16 v[92:95], a[136:139], a[92:95], v[92:95]
    v_mfma_f32_16x16x32_bf16 v[148:151], a[148:151], a[92:95], v[148:151]
    v_mfma_f32_16x16x32_bf16 v[64:67], a[156:159], a[88:91], v[64:67]
    v_mfma_f32_16x16x32_bf16 v[92:95], a[152:155], a[88:91], v[92:95]
    v_mfma_f32_16x16x32_bf16 v[148:151], a[164:167], a[88:91], v[148:151]
    v_mfma_f32_16x16x32_bf16 v[64:67], a[172:175], a[84:87], v[64:67]
    v_mfma_f32_16x16x32_bf16 v[92:95], a[168:171], a[84:87], v[92:95]
    v_mfma_f32_16x16x32_bf16 v[148:151], a[180:183], a[84:87], v[148:151]
    s_waitcnt lgkmcnt(3)
    v_mfma_f32_16x16x32_bf16 v[64:67], a[188:191], a[80:83], v[64:67]
    v_mfma_f32_16x16x32_bf16 v[92:95], a[184:187], a[80:83], v[92:95]
    v_mfma_f32_16x16x32_bf16 v[148:151], a[196:199], a[80:83], v[148:151]
    s_waitcnt lgkmcnt(2)
    v_mfma_f32_16x16x32_bf16 v[64:67], a[204:207], a[76:79], v[64:67]
    v_mfma_f32_16x16x32_bf16 v[92:95], a[200:203], a[76:79], v[92:95]
    s_waitcnt vmcnt(0)
    v_mfma_f32_16x16x32_bf16 v[148:151], a[212:215], a[76:79], v[148:151]
    v_mfma_f32_16x16x32_bf16 v[32:35], a[104:107], a[44:47], v[32:35]
    v_mfma_f32_16x16x32_bf16 v[88:91], a[108:111], a[44:47], v[88:91]
    v_mfma_f32_16x16x32_bf16 v[116:119], a[112:115], a[44:47], v[116:119]
    ds_read_b128 a[16:19], v7 offset:640
    v_mfma_f32_16x16x32_bf16 v[32:35], a[120:123], a[40:43], v[32:35]
    v_mfma_f32_16x16x32_bf16 v[88:91], a[124:127], a[40:43], v[88:91]
    v_mfma_f32_16x16x32_bf16 v[116:119], a[128:131], a[40:43], v[116:119]
    ds_read_b128 a[68:71], v7 offset:704
    v_mfma_f32_16x16x32_bf16 v[32:35], a[136:139], a[36:39], v[32:35]
    v_mfma_f32_16x16x32_bf16 v[88:91], a[140:143], a[36:39], v[88:91]
    v_sub_f32 v36, v36, v64
    v_mfma_f32_16x16x32_bf16 v[116:119], a[144:147], a[36:39], v[116:119]
    v_sub_f32 v37, v37, v65
    v_mfma_f32_16x16x32_bf16 v[32:35], a[152:155], a[32:35], v[32:35]
    v_sub_f32 v38, v38, v66
    v_mfma_f32_16x16x32_bf16 v[88:91], a[156:159], a[32:35], v[88:91]
    v_sub_f32 v39, v39, v67
    v_mfma_f32_16x16x32_bf16 v[116:119], a[160:163], a[32:35], v[116:119]
    v_cvt_pk_bf16_f32 v152, v36, v37
    v_mfma_f32_16x16x32_bf16 v[32:35], a[168:171], a[28:31], v[32:35]
    v_cvt_pk_bf16_f32 v153, v38, v39
    v_mfma_f32_16x16x32_bf16 v[88:91], a[172:175], a[28:31], v[88:91]
    v_cvt_pk_bf16_f32 v154, v92, v93
    v_mfma_f32_16x16x32_bf16 v[116:119], a[176:179], a[28:31], v[116:119]
    v_cvt_pk_bf16_f32 v155, v94, v95
    v_mfma_f32_16x16x32_bf16 v[32:35], a[184:187], a[24:27], v[32:35]
    s_mov_b32 s48, 294912
    v_mfma_f32_16x16x32_bf16 v[88:91], a[188:191], a[24:27], v[88:91]
    buffer_store_dwordx4 v[152:155], v9, s[20:23], s48 offen offset:0 sc1
    v_mfma_f32_16x16x32_bf16 v[116:119], a[192:195], a[24:27], v[116:119]
    v_sub_f32 v120, v120, v148
    s_waitcnt lgkmcnt(3)
    v_mfma_f32_16x16x32_bf16 v[32:35], a[200:203], a[20:23], v[32:35]
    v_sub_f32 v121, v121, v149
    v_mfma_f32_16x16x32_bf16 v[88:91], a[204:207], a[20:23], v[88:91]
    v_sub_f32 v122, v122, v150
    v_mfma_f32_16x16x32_bf16 v[116:119], a[208:211], a[20:23], v[116:119]
    v_sub_f32 v123, v123, v151
    v_mfma_f32_16x16x32_bf16 v[60:63], a[108:111], a[96:99], v[60:63]
    v_cvt_pk_bf16_f32 v120, v120, v121
    v_mfma_f32_16x16x32_bf16 v[88:91], a[104:107], a[96:99], v[88:91]
    v_cvt_pk_bf16_f32 v121, v122, v123
    v_mfma_f32_16x16x32_bf16 v[144:147], a[116:119], a[96:99], v[144:147]
    ds_write_b64 v10, v[120:121] offset:3072
    v_mfma_f32_16x16x32_bf16 v[60:63], a[124:127], a[92:95], v[60:63]
    v_mfma_f32_16x16x32_bf16 v[88:91], a[120:123], a[92:95], v[88:91]
    v_mfma_f32_16x16x32_bf16 v[144:147], a[132:135], a[92:95], v[144:147]
    v_mfma_f32_16x16x32_bf16 v[60:63], a[140:143], a[88:91], v[60:63]
    s_waitcnt lgkmcnt(0)
    s_barrier
    v_mfma_f32_16x16x32_bf16 v[88:91], a[136:139], a[88:91], v[88:91]
    v_mfma_f32_16x16x32_bf16 v[144:147], a[148:151], a[88:91], v[144:147]
    v_mfma_f32_16x16x32_bf16 v[60:63], a[156:159], a[84:87], v[60:63]
    v_mfma_f32_16x16x32_bf16 v[88:91], a[152:155], a[84:87], v[88:91]
    v_mfma_f32_16x16x32_bf16 v[144:147], a[164:167], a[84:87], v[144:147]
    v_mfma_f32_16x16x32_bf16 v[60:63], a[172:175], a[80:83], v[60:63]
    v_mfma_f32_16x16x32_bf16 v[88:91], a[168:171], a[80:83], v[88:91]
    v_mfma_f32_16x16x32_bf16 v[144:147], a[180:183], a[80:83], v[144:147]
    v_mfma_f32_16x16x32_bf16 v[60:63], a[188:191], a[76:79], v[60:63]
    v_mfma_f32_16x16x32_bf16 v[88:91], a[184:187], a[76:79], v[88:91]
    v_mfma_f32_16x16x32_bf16 v[144:147], a[196:199], a[76:79], v[144:147]
    v_mfma_f32_16x16x32_bf16 v[60:63], a[204:207], a[72:75], v[60:63]
    v_mfma_f32_16x16x32_bf16 v[88:91], a[200:203], a[72:75], v[88:91]
    v_mfma_f32_16x16x32_bf16 v[144:147], a[212:215], a[72:75], v[144:147]
    v_mfma_f32_16x16x32_bf16 v[28:31], a[104:107], a[40:43], v[28:31]
    v_mfma_f32_16x16x32_bf16 v[84:87], a[108:111], a[40:43], v[84:87]
    v_mfma_f32_16x16x32_bf16 v[112:115], a[112:115], a[40:43], v[112:115]
    ds_read_b128 a[12:15], v7 offset:480
    v_mfma_f32_16x16x32_bf16 v[28:31], a[120:123], a[36:39], v[28:31]
    v_mfma_f32_16x16x32_bf16 v[84:87], a[124:127], a[36:39], v[84:87]
    v_mfma_f32_16x16x32_bf16 v[112:115], a[128:131], a[36:39], v[112:115]
    ds_read_b128 a[64:67], v7 offset:544
    v_mfma_f32_16x16x32_bf16 v[28:31], a[136:139], a[32:35], v[28:31]
    v_mfma_f32_16x16x32_bf16 v[84:87], a[140:143], a[32:35], v[84:87]
    v_sub_f32 v32, v32, v60
    v_mfma_f32_16x16x32_bf16 v[112:115], a[144:147], a[32:35], v[112:115]
    v_sub_f32 v33, v33, v61
    v_mfma_f32_16x16x32_bf16 v[28:31], a[152:155], a[28:31], v[28:31]
    v_sub_f32 v34, v34, v62
    v_mfma_f32_16x16x32_bf16 v[84:87], a[156:159], a[28:31], v[84:87]
    v_sub_f32 v35, v35, v63
    v_mfma_f32_16x16x32_bf16 v[112:115], a[160:163], a[28:31], v[112:115]
    v_cvt_pk_bf16_f32 v156, v32, v33
    v_mfma_f32_16x16x32_bf16 v[28:31], a[168:171], a[24:27], v[28:31]
    v_cvt_pk_bf16_f32 v157, v34, v35
    v_mfma_f32_16x16x32_bf16 v[84:87], a[172:175], a[24:27], v[84:87]
    v_cvt_pk_bf16_f32 v158, v88, v89
    v_mfma_f32_16x16x32_bf16 v[112:115], a[176:179], a[24:27], v[112:115]
    v_cvt_pk_bf16_f32 v159, v90, v91
    v_mfma_f32_16x16x32_bf16 v[28:31], a[184:187], a[20:23], v[28:31]
    s_mov_b32 s48, 245760
    v_mfma_f32_16x16x32_bf16 v[84:87], a[188:191], a[20:23], v[84:87]
    buffer_store_dwordx4 v[156:159], v9, s[20:23], s48 offen offset:0 sc1
    v_mfma_f32_16x16x32_bf16 v[112:115], a[192:195], a[20:23], v[112:115]
    v_sub_f32 v116, v116, v144
    v_mfma_f32_16x16x32_bf16 v[28:31], a[200:203], a[16:19], v[28:31]
    v_sub_f32 v117, v117, v145
    v_mfma_f32_16x16x32_bf16 v[84:87], a[204:207], a[16:19], v[84:87]
    v_sub_f32 v118, v118, v146
    v_mfma_f32_16x16x32_bf16 v[112:115], a[208:211], a[16:19], v[112:115]
    v_sub_f32 v119, v119, v147
    v_mfma_f32_16x16x32_bf16 v[56:59], a[108:111], a[92:95], v[56:59]
    v_cvt_pk_bf16_f32 v116, v116, v117
    v_mfma_f32_16x16x32_bf16 v[84:87], a[104:107], a[92:95], v[84:87]
    v_cvt_pk_bf16_f32 v117, v118, v119
    v_mfma_f32_16x16x32_bf16 v[140:143], a[116:119], a[92:95], v[140:143]
    v_mfma_f32_16x16x32_bf16 v[56:59], a[124:127], a[88:91], v[56:59]
    v_mfma_f32_16x16x32_bf16 v[84:87], a[120:123], a[88:91], v[84:87]
    v_mfma_f32_16x16x32_bf16 v[140:143], a[132:135], a[88:91], v[140:143]
    v_mfma_f32_16x16x32_bf16 v[56:59], a[140:143], a[84:87], v[56:59]
    s_waitcnt lgkmcnt(0)
    s_barrier
    v_mfma_f32_16x16x32_bf16 v[84:87], a[136:139], a[84:87], v[84:87]
    ds_read_b64 v[118:119], v10 offset:2560
    v_mfma_f32_16x16x32_bf16 v[140:143], a[148:151], a[84:87], v[140:143]
    v_mfma_f32_16x16x32_bf16 v[56:59], a[156:159], a[80:83], v[56:59]
    v_mfma_f32_16x16x32_bf16 v[84:87], a[152:155], a[80:83], v[84:87]
    v_mfma_f32_16x16x32_bf16 v[140:143], a[164:167], a[80:83], v[140:143]
    v_mfma_f32_16x16x32_bf16 v[56:59], a[172:175], a[76:79], v[56:59]
    v_mfma_f32_16x16x32_bf16 v[84:87], a[168:171], a[76:79], v[84:87]
    s_mov_b32 s47, 245760
    v_mfma_f32_16x16x32_bf16 v[140:143], a[180:183], a[76:79], v[140:143]
    s_waitcnt lgkmcnt(0)
    buffer_store_dwordx4 v[116:119], v9, s[20:23], s47 offen offset:64 sc1
    v_mfma_f32_16x16x32_bf16 v[56:59], a[188:191], a[72:75], v[56:59]
    v_mfma_f32_16x16x32_bf16 v[84:87], a[184:187], a[72:75], v[84:87]
    v_mfma_f32_16x16x32_bf16 v[140:143], a[196:199], a[72:75], v[140:143]
    v_mfma_f32_16x16x32_bf16 v[56:59], a[204:207], a[68:71], v[56:59]
    v_mfma_f32_16x16x32_bf16 v[84:87], a[200:203], a[68:71], v[84:87]
    v_mfma_f32_16x16x32_bf16 v[140:143], a[212:215], a[68:71], v[140:143]
    v_mfma_f32_16x16x32_bf16 v[24:27], a[104:107], a[36:39], v[24:27]
    v_mfma_f32_16x16x32_bf16 v[80:83], a[108:111], a[36:39], v[80:83]
    v_mfma_f32_16x16x32_bf16 v[108:111], a[112:115], a[36:39], v[108:111]
    ds_read_b128 a[8:11], v7 offset:320
    v_mfma_f32_16x16x32_bf16 v[24:27], a[120:123], a[32:35], v[24:27]
    v_mfma_f32_16x16x32_bf16 v[80:83], a[124:127], a[32:35], v[80:83]
    v_mfma_f32_16x16x32_bf16 v[108:111], a[128:131], a[32:35], v[108:111]
    ds_read_b128 a[60:63], v7 offset:384
    v_mfma_f32_16x16x32_bf16 v[24:27], a[136:139], a[28:31], v[24:27]
    v_mfma_f32_16x16x32_bf16 v[80:83], a[140:143], a[28:31], v[80:83]
    v_sub_f32 v28, v28, v56
    v_mfma_f32_16x16x32_bf16 v[108:111], a[144:147], a[28:31], v[108:111]
    v_sub_f32 v29, v29, v57
    v_mfma_f32_16x16x32_bf16 v[24:27], a[152:155], a[24:27], v[24:27]
    v_sub_f32 v30, v30, v58
    v_mfma_f32_16x16x32_bf16 v[80:83], a[156:159], a[24:27], v[80:83]
    v_sub_f32 v31, v31, v59
    v_mfma_f32_16x16x32_bf16 v[108:111], a[160:163], a[24:27], v[108:111]
    v_cvt_pk_bf16_f32 v160, v28, v29
    v_mfma_f32_16x16x32_bf16 v[24:27], a[168:171], a[20:23], v[24:27]
    v_cvt_pk_bf16_f32 v161, v30, v31
    v_mfma_f32_16x16x32_bf16 v[80:83], a[172:175], a[20:23], v[80:83]
    v_cvt_pk_bf16_f32 v162, v84, v85
    v_mfma_f32_16x16x32_bf16 v[108:111], a[176:179], a[20:23], v[108:111]
    v_cvt_pk_bf16_f32 v163, v86, v87
    v_mfma_f32_16x16x32_bf16 v[24:27], a[184:187], a[16:19], v[24:27]
    s_mov_b32 s48, 196608
    v_mfma_f32_16x16x32_bf16 v[80:83], a[188:191], a[16:19], v[80:83]
    buffer_store_dwordx4 v[160:163], v9, s[20:23], s48 offen offset:0 sc1
    v_mfma_f32_16x16x32_bf16 v[108:111], a[192:195], a[16:19], v[108:111]
    v_sub_f32 v112, v112, v140
    v_mfma_f32_16x16x32_bf16 v[24:27], a[200:203], a[12:15], v[24:27]
    v_sub_f32 v113, v113, v141
    v_mfma_f32_16x16x32_bf16 v[80:83], a[204:207], a[12:15], v[80:83]
    v_sub_f32 v114, v114, v142
    v_mfma_f32_16x16x32_bf16 v[108:111], a[208:211], a[12:15], v[108:111]
    v_sub_f32 v115, v115, v143
    v_mfma_f32_16x16x32_bf16 v[52:55], a[108:111], a[88:91], v[52:55]
    v_cvt_pk_bf16_f32 v112, v112, v113
    v_mfma_f32_16x16x32_bf16 v[80:83], a[104:107], a[88:91], v[80:83]
    v_cvt_pk_bf16_f32 v113, v114, v115
    v_mfma_f32_16x16x32_bf16 v[136:139], a[116:119], a[88:91], v[136:139]
    ds_write_b64 v10, v[112:113] offset:2048
    v_mfma_f32_16x16x32_bf16 v[52:55], a[124:127], a[84:87], v[52:55]
    v_mfma_f32_16x16x32_bf16 v[80:83], a[120:123], a[84:87], v[80:83]
    v_mfma_f32_16x16x32_bf16 v[136:139], a[132:135], a[84:87], v[136:139]
    v_mfma_f32_16x16x32_bf16 v[52:55], a[140:143], a[80:83], v[52:55]
    s_waitcnt lgkmcnt(0)
    s_barrier
    v_mfma_f32_16x16x32_bf16 v[80:83], a[136:139], a[80:83], v[80:83]
    v_mfma_f32_16x16x32_bf16 v[136:139], a[148:151], a[80:83], v[136:139]
    v_mfma_f32_16x16x32_bf16 v[52:55], a[156:159], a[76:79], v[52:55]
    v_mfma_f32_16x16x32_bf16 v[80:83], a[152:155], a[76:79], v[80:83]
    v_mfma_f32_16x16x32_bf16 v[136:139], a[164:167], a[76:79], v[136:139]
    v_mfma_f32_16x16x32_bf16 v[52:55], a[172:175], a[72:75], v[52:55]
    v_mfma_f32_16x16x32_bf16 v[80:83], a[168:171], a[72:75], v[80:83]
    v_mfma_f32_16x16x32_bf16 v[136:139], a[180:183], a[72:75], v[136:139]
    v_mfma_f32_16x16x32_bf16 v[52:55], a[188:191], a[68:71], v[52:55]
    v_mfma_f32_16x16x32_bf16 v[80:83], a[184:187], a[68:71], v[80:83]
    v_mfma_f32_16x16x32_bf16 v[136:139], a[196:199], a[68:71], v[136:139]
    v_mfma_f32_16x16x32_bf16 v[52:55], a[204:207], a[64:67], v[52:55]
    v_mfma_f32_16x16x32_bf16 v[80:83], a[200:203], a[64:67], v[80:83]
    v_mfma_f32_16x16x32_bf16 v[136:139], a[212:215], a[64:67], v[136:139]
    v_mfma_f32_16x16x32_bf16 v[20:23], a[104:107], a[32:35], v[20:23]
    v_mfma_f32_16x16x32_bf16 v[76:79], a[108:111], a[32:35], v[76:79]
    v_mfma_f32_16x16x32_bf16 v[104:107], a[112:115], a[32:35], v[104:107]
    ds_read_b128 a[4:7], v7 offset:160
    v_mfma_f32_16x16x32_bf16 v[20:23], a[120:123], a[28:31], v[20:23]
    v_mfma_f32_16x16x32_bf16 v[76:79], a[124:127], a[28:31], v[76:79]
    v_mfma_f32_16x16x32_bf16 v[104:107], a[128:131], a[28:31], v[104:107]
    ds_read_b128 a[56:59], v7 offset:224
    v_mfma_f32_16x16x32_bf16 v[20:23], a[136:139], a[24:27], v[20:23]
    v_mfma_f32_16x16x32_bf16 v[76:79], a[140:143], a[24:27], v[76:79]
    v_sub_f32 v24, v24, v52
    v_mfma_f32_16x16x32_bf16 v[104:107], a[144:147], a[24:27], v[104:107]
    v_sub_f32 v25, v25, v53
    v_mfma_f32_16x16x32_bf16 v[20:23], a[152:155], a[20:23], v[20:23]
    v_sub_f32 v26, v26, v54
    v_mfma_f32_16x16x32_bf16 v[76:79], a[156:159], a[20:23], v[76:79]
    v_sub_f32 v27, v27, v55
    v_mfma_f32_16x16x32_bf16 v[104:107], a[160:163], a[20:23], v[104:107]
    v_cvt_pk_bf16_f32 v164, v24, v25
    v_mfma_f32_16x16x32_bf16 v[20:23], a[168:171], a[16:19], v[20:23]
    v_cvt_pk_bf16_f32 v165, v26, v27
    v_mfma_f32_16x16x32_bf16 v[76:79], a[172:175], a[16:19], v[76:79]
    v_cvt_pk_bf16_f32 v166, v80, v81
    v_mfma_f32_16x16x32_bf16 v[104:107], a[176:179], a[16:19], v[104:107]
    v_cvt_pk_bf16_f32 v167, v82, v83
    v_mfma_f32_16x16x32_bf16 v[20:23], a[184:187], a[12:15], v[20:23]
    s_mov_b32 s48, 147456
    v_mfma_f32_16x16x32_bf16 v[76:79], a[188:191], a[12:15], v[76:79]
    buffer_store_dwordx4 v[164:167], v9, s[20:23], s48 offen offset:0 sc1
    v_mfma_f32_16x16x32_bf16 v[104:107], a[192:195], a[12:15], v[104:107]
    v_sub_f32 v108, v108, v136
    v_mfma_f32_16x16x32_bf16 v[20:23], a[200:203], a[8:11], v[20:23]
    v_sub_f32 v109, v109, v137
    v_mfma_f32_16x16x32_bf16 v[76:79], a[204:207], a[8:11], v[76:79]
    v_sub_f32 v110, v110, v138
    v_mfma_f32_16x16x32_bf16 v[104:107], a[208:211], a[8:11], v[104:107]
    v_sub_f32 v111, v111, v139
    v_mfma_f32_16x16x32_bf16 v[48:51], a[108:111], a[84:87], v[48:51]
    v_cvt_pk_bf16_f32 v108, v108, v109
    v_mfma_f32_16x16x32_bf16 v[76:79], a[104:107], a[84:87], v[76:79]
    v_cvt_pk_bf16_f32 v109, v110, v111
    v_mfma_f32_16x16x32_bf16 v[132:135], a[116:119], a[84:87], v[132:135]
    v_mfma_f32_16x16x32_bf16 v[48:51], a[124:127], a[80:83], v[48:51]
    v_mfma_f32_16x16x32_bf16 v[76:79], a[120:123], a[80:83], v[76:79]
    v_mfma_f32_16x16x32_bf16 v[132:135], a[132:135], a[80:83], v[132:135]
    v_mfma_f32_16x16x32_bf16 v[48:51], a[140:143], a[76:79], v[48:51]
    s_waitcnt lgkmcnt(0)
    s_barrier
    v_mfma_f32_16x16x32_bf16 v[76:79], a[136:139], a[76:79], v[76:79]
    ds_read_b64 v[110:111], v10 offset:1536
    v_mfma_f32_16x16x32_bf16 v[132:135], a[148:151], a[76:79], v[132:135]
    v_mfma_f32_16x16x32_bf16 v[48:51], a[156:159], a[72:75], v[48:51]
    v_mfma_f32_16x16x32_bf16 v[76:79], a[152:155], a[72:75], v[76:79]
    v_mfma_f32_16x16x32_bf16 v[132:135], a[164:167], a[72:75], v[132:135]
    v_mfma_f32_16x16x32_bf16 v[48:51], a[172:175], a[68:71], v[48:51]
    v_mfma_f32_16x16x32_bf16 v[76:79], a[168:171], a[68:71], v[76:79]
    s_mov_b32 s47, 147456
    v_mfma_f32_16x16x32_bf16 v[132:135], a[180:183], a[68:71], v[132:135]
    s_waitcnt lgkmcnt(0)
    buffer_store_dwordx4 v[108:111], v9, s[20:23], s47 offen offset:64 sc1
    v_mfma_f32_16x16x32_bf16 v[48:51], a[188:191], a[64:67], v[48:51]
    v_mfma_f32_16x16x32_bf16 v[76:79], a[184:187], a[64:67], v[76:79]
    v_mfma_f32_16x16x32_bf16 v[132:135], a[196:199], a[64:67], v[132:135]
    v_mfma_f32_16x16x32_bf16 v[48:51], a[204:207], a[60:63], v[48:51]
    v_mfma_f32_16x16x32_bf16 v[76:79], a[200:203], a[60:63], v[76:79]
    v_mfma_f32_16x16x32_bf16 v[132:135], a[212:215], a[60:63], v[132:135]
    v_mfma_f32_16x16x32_bf16 v[16:19], a[104:107], a[28:31], v[16:19]
    v_mfma_f32_16x16x32_bf16 v[72:75], a[108:111], a[28:31], v[72:75]
    v_mfma_f32_16x16x32_bf16 v[100:103], a[112:115], a[28:31], v[100:103]
    ds_read_b128 a[0:3], v7 offset:0
    v_mfma_f32_16x16x32_bf16 v[16:19], a[120:123], a[24:27], v[16:19]
    v_mfma_f32_16x16x32_bf16 v[72:75], a[124:127], a[24:27], v[72:75]
    v_mfma_f32_16x16x32_bf16 v[100:103], a[128:131], a[24:27], v[100:103]
    ds_read_b128 a[52:55], v7 offset:64
    v_mfma_f32_16x16x32_bf16 v[16:19], a[136:139], a[20:23], v[16:19]
    v_mfma_f32_16x16x32_bf16 v[72:75], a[140:143], a[20:23], v[72:75]
    v_sub_f32 v20, v20, v48
    v_mfma_f32_16x16x32_bf16 v[100:103], a[144:147], a[20:23], v[100:103]
    v_sub_f32 v21, v21, v49
    v_mfma_f32_16x16x32_bf16 v[16:19], a[152:155], a[16:19], v[16:19]
    v_sub_f32 v22, v22, v50
    v_mfma_f32_16x16x32_bf16 v[72:75], a[156:159], a[16:19], v[72:75]
    v_sub_f32 v23, v23, v51
    v_mfma_f32_16x16x32_bf16 v[100:103], a[160:163], a[16:19], v[100:103]
    v_cvt_pk_bf16_f32 v152, v20, v21
    v_mfma_f32_16x16x32_bf16 v[16:19], a[168:171], a[12:15], v[16:19]
    v_cvt_pk_bf16_f32 v153, v22, v23
    v_mfma_f32_16x16x32_bf16 v[72:75], a[172:175], a[12:15], v[72:75]
    v_cvt_pk_bf16_f32 v154, v76, v77
    v_mfma_f32_16x16x32_bf16 v[100:103], a[176:179], a[12:15], v[100:103]
    v_cvt_pk_bf16_f32 v155, v78, v79
    v_mfma_f32_16x16x32_bf16 v[16:19], a[184:187], a[8:11], v[16:19]
    s_mov_b32 s48, 98304
    v_mfma_f32_16x16x32_bf16 v[72:75], a[188:191], a[8:11], v[72:75]
    buffer_store_dwordx4 v[152:155], v9, s[20:23], s48 offen offset:0 sc1
    v_mfma_f32_16x16x32_bf16 v[100:103], a[192:195], a[8:11], v[100:103]
    v_sub_f32 v104, v104, v132
    v_mfma_f32_16x16x32_bf16 v[16:19], a[200:203], a[4:7], v[16:19]
    v_sub_f32 v105, v105, v133
    v_mfma_f32_16x16x32_bf16 v[72:75], a[204:207], a[4:7], v[72:75]
    v_sub_f32 v106, v106, v134
    v_mfma_f32_16x16x32_bf16 v[100:103], a[208:211], a[4:7], v[100:103]
    v_sub_f32 v107, v107, v135
    v_mfma_f32_16x16x32_bf16 v[44:47], a[108:111], a[80:83], v[44:47]
    v_cvt_pk_bf16_f32 v104, v104, v105
    v_mfma_f32_16x16x32_bf16 v[72:75], a[104:107], a[80:83], v[72:75]
    v_cvt_pk_bf16_f32 v105, v106, v107
    v_mfma_f32_16x16x32_bf16 v[128:131], a[116:119], a[80:83], v[128:131]
    ds_write_b64 v10, v[104:105] offset:1024
    v_mfma_f32_16x16x32_bf16 v[44:47], a[124:127], a[76:79], v[44:47]
    v_mfma_f32_16x16x32_bf16 v[72:75], a[120:123], a[76:79], v[72:75]
    v_mfma_f32_16x16x32_bf16 v[128:131], a[132:135], a[76:79], v[128:131]
    v_mfma_f32_16x16x32_bf16 v[44:47], a[140:143], a[72:75], v[44:47]
    s_waitcnt lgkmcnt(0)
    s_barrier
    v_mfma_f32_16x16x32_bf16 v[72:75], a[136:139], a[72:75], v[72:75]
    v_mfma_f32_16x16x32_bf16 v[128:131], a[148:151], a[72:75], v[128:131]
    v_mfma_f32_16x16x32_bf16 v[44:47], a[156:159], a[68:71], v[44:47]
    v_mfma_f32_16x16x32_bf16 v[72:75], a[152:155], a[68:71], v[72:75]
    v_mfma_f32_16x16x32_bf16 v[128:131], a[164:167], a[68:71], v[128:131]
    v_mfma_f32_16x16x32_bf16 v[44:47], a[172:175], a[64:67], v[44:47]
    v_mfma_f32_16x16x32_bf16 v[72:75], a[168:171], a[64:67], v[72:75]
    v_mfma_f32_16x16x32_bf16 v[128:131], a[180:183], a[64:67], v[128:131]
    v_mfma_f32_16x16x32_bf16 v[44:47], a[188:191], a[60:63], v[44:47]
    v_mfma_f32_16x16x32_bf16 v[72:75], a[184:187], a[60:63], v[72:75]
    v_mfma_f32_16x16x32_bf16 v[128:131], a[196:199], a[60:63], v[128:131]
    v_mfma_f32_16x16x32_bf16 v[44:47], a[204:207], a[56:59], v[44:47]
    v_mfma_f32_16x16x32_bf16 v[72:75], a[200:203], a[56:59], v[72:75]
    v_mfma_f32_16x16x32_bf16 v[128:131], a[212:215], a[56:59], v[128:131]
    v_mfma_f32_16x16x32_bf16 v[96:99], a[112:115], a[24:27], v[96:99]
    v_mfma_f32_16x16x32_bf16 v[124:127], a[116:119], a[76:79], v[124:127]
    v_mfma_f32_16x16x32_bf16 v[96:99], a[128:131], a[20:23], v[96:99]
    v_mfma_f32_16x16x32_bf16 v[124:127], a[132:135], a[72:75], v[124:127]
    v_mfma_f32_16x16x32_bf16 v[96:99], a[144:147], a[16:19], v[96:99]
    v_mfma_f32_16x16x32_bf16 v[124:127], a[148:151], a[68:71], v[124:127]
    v_mfma_f32_16x16x32_bf16 v[96:99], a[160:163], a[12:15], v[96:99]
    v_mfma_f32_16x16x32_bf16 v[124:127], a[164:167], a[64:67], v[124:127]
    v_sub_f32 v16, v16, v44
    v_mfma_f32_16x16x32_bf16 v[96:99], a[176:179], a[8:11], v[96:99]
    v_sub_f32 v17, v17, v45
    v_mfma_f32_16x16x32_bf16 v[124:127], a[180:183], a[60:63], v[124:127]
    v_sub_f32 v18, v18, v46
    v_mfma_f32_16x16x32_bf16 v[96:99], a[192:195], a[4:7], v[96:99]
    v_sub_f32 v19, v19, v47
    v_mfma_f32_16x16x32_bf16 v[124:127], a[196:199], a[56:59], v[124:127]
    v_cvt_pk_bf16_f32 v156, v16, v17
    v_mfma_f32_16x16x32_bf16 v[96:99], a[208:211], a[0:3], v[96:99]
    v_cvt_pk_bf16_f32 v157, v18, v19
    v_mfma_f32_16x16x32_bf16 v[124:127], a[212:215], a[52:55], v[124:127]
    v_cvt_pk_bf16_f32 v158, v72, v73
    v_mfma_f32_16x16x32_bf16 v[12:15], a[104:107], a[24:27], v[12:15]
    v_cvt_pk_bf16_f32 v159, v74, v75
    v_mfma_f32_16x16x32_bf16 v[68:71], a[108:111], a[24:27], v[68:71]
    s_mov_b32 s48, 49152
    v_mfma_f32_16x16x32_bf16 v[12:15], a[120:123], a[20:23], v[12:15]
    buffer_store_dwordx4 v[156:159], v9, s[20:23], s48 offen offset:0 sc1
    v_mfma_f32_16x16x32_bf16 v[68:71], a[124:127], a[20:23], v[68:71]
    v_sub_f32 v100, v100, v128
    v_mfma_f32_16x16x32_bf16 v[12:15], a[136:139], a[16:19], v[12:15]
    v_sub_f32 v101, v101, v129
    v_mfma_f32_16x16x32_bf16 v[68:71], a[140:143], a[16:19], v[68:71]
    v_sub_f32 v102, v102, v130
    v_mfma_f32_16x16x32_bf16 v[12:15], a[152:155], a[12:15], v[12:15]
    v_sub_f32 v103, v103, v131
    v_mfma_f32_16x16x32_bf16 v[68:71], a[156:159], a[12:15], v[68:71]
    v_cvt_pk_bf16_f32 v100, v100, v101
    v_sub_f32 v96, v96, v124
    v_mfma_f32_16x16x32_bf16 v[12:15], a[168:171], a[8:11], v[12:15]
    v_cvt_pk_bf16_f32 v101, v102, v103
    v_sub_f32 v97, v97, v125
    v_mfma_f32_16x16x32_bf16 v[68:71], a[172:175], a[8:11], v[68:71]
    v_sub_f32 v98, v98, v126
    v_mfma_f32_16x16x32_bf16 v[12:15], a[184:187], a[4:7], v[12:15]
    v_sub_f32 v99, v99, v127
    v_mfma_f32_16x16x32_bf16 v[68:71], a[188:191], a[4:7], v[68:71]
    v_cvt_pk_bf16_f32 v96, v96, v97
    v_mfma_f32_16x16x32_bf16 v[12:15], a[200:203], a[0:3], v[12:15]
    v_cvt_pk_bf16_f32 v97, v98, v99
    v_mfma_f32_16x16x32_bf16 v[68:71], a[204:207], a[0:3], v[68:71]
    s_waitcnt lgkmcnt(0)
    s_barrier
    ds_write_b64 v10, v[96:97] offset:0
    v_mfma_f32_16x16x32_bf16 v[40:43], a[108:111], a[76:79], v[40:43]
    ds_read_b64 v[102:103], v10 offset:512
    v_mfma_f32_16x16x32_bf16 v[68:71], a[104:107], a[76:79], v[68:71]
    v_mfma_f32_16x16x32_bf16 v[40:43], a[124:127], a[72:75], v[40:43]
    v_mfma_f32_16x16x32_bf16 v[68:71], a[120:123], a[72:75], v[68:71]
    s_waitcnt lgkmcnt(0)
    s_barrier
    v_mfma_f32_16x16x32_bf16 v[40:43], a[140:143], a[68:71], v[40:43]
    v_mfma_f32_16x16x32_bf16 v[68:71], a[136:139], a[68:71], v[68:71]
    v_mfma_f32_16x16x32_bf16 v[40:43], a[156:159], a[64:67], v[40:43]
    s_mov_b32 s47, 49152
    v_mfma_f32_16x16x32_bf16 v[68:71], a[152:155], a[64:67], v[68:71]
    buffer_store_dwordx4 v[100:103], v9, s[20:23], s47 offen offset:64 sc1
    v_mfma_f32_16x16x32_bf16 v[40:43], a[172:175], a[60:63], v[40:43]
    v_mfma_f32_16x16x32_bf16 v[68:71], a[168:171], a[60:63], v[68:71]
    v_mfma_f32_16x16x32_bf16 v[40:43], a[188:191], a[56:59], v[40:43]
    v_mfma_f32_16x16x32_bf16 v[68:71], a[184:187], a[56:59], v[68:71]
    v_mfma_f32_16x16x32_bf16 v[40:43], a[204:207], a[52:55], v[40:43]
    v_mfma_f32_16x16x32_bf16 v[68:71], a[200:203], a[52:55], v[68:71]
    s_nop 6
    v_sub_f32 v12, v12, v40
    v_sub_f32 v13, v13, v41
    v_sub_f32 v14, v14, v42
    v_sub_f32 v15, v15, v43
    v_cvt_pk_bf16_f32 v160, v12, v13
    v_cvt_pk_bf16_f32 v161, v14, v15
    v_cvt_pk_bf16_f32 v162, v68, v69
    v_cvt_pk_bf16_f32 v163, v70, v71
    s_mov_b32 s48, 0
    buffer_store_dwordx4 v[160:163], v9, s[20:23], s48 offen offset:0 sc1
    s_endpgm
K2_q1:
    s_waitcnt vmcnt(12)
    s_barrier
    ds_read_b128 a[48:51], v5 offset:1920
    ds_read_b128 a[100:103], v5 offset:1984
    ds_read_b128 a[44:47], v5 offset:1760
    ds_read_b128 a[96:99], v5 offset:1824
    ds_read_b128 a[40:43], v5 offset:1600
    ds_read_b128 a[92:95], v5 offset:1664
    ds_read_b128 a[36:39], v5 offset:1440
    ds_read_b128 a[88:91], v5 offset:1504
    ds_read_b128 a[32:35], v5 offset:1280
    ds_read_b128 a[84:87], v5 offset:1344
    ds_read_b128 a[28:31], v5 offset:1120
    ds_read_b128 a[80:83], v5 offset:1184
    ds_read_b128 a[24:27], v5 offset:960
    ds_read_b128 a[76:79], v5 offset:1024
    s_waitcnt vmcnt(10)
    s_waitcnt lgkmcnt(13)
    v_mfma_f32_16x16x32_bf16 v[36:39], a[108:111], a[48:51], 0
    s_add_u32 s47, s45, 18432
    s_waitcnt vmcnt(9)
    v_mfma_f32_16x16x32_bf16 v[64:67], a[112:115], a[48:51], 0
    buffer_load_dwordx4 a[152:155], v4, s[16:19], s47 offen offset:0
    s_waitcnt vmcnt(9)
    v_mfma_f32_16x16x32_bf16 v[120:123], a[116:119], a[48:51], 0
    s_waitcnt lgkmcnt(12)
    v_mfma_f32_16x16x32_bf16 v[120:123], a[112:115], a[100:103], v[120:123]
    buffer_load_dwordx4 a[156:159], v4, s[16:19], s47 offen offset:1024
    v_mfma_f32_16x16x32_bf16 v[92:95], a[116:119], a[100:103], 0
    v_mfma_f32_16x16x32_bf16 v[36:39], a[104:107], a[100:103], v[36:39]
    buffer_load_dwordx4 a[160:163], v4, s[16:19], s47 offen offset:2048
    s_waitcnt lgkmcnt(10)
    v_mfma_f32_16x16x32_bf16 v[32:35], a[104:107], a[96:99], 0
    v_mfma_f32_16x16x32_bf16 v[88:91], a[116:119], a[96:99], 0
    buffer_load_dwordx4 a[164:167], v4, s[16:19], s47 offen offset:3072
    v_mfma_f32_16x16x32_bf16 v[116:119], a[112:115], a[96:99], 0
    v_mfma_f32_16x16x32_bf16 v[116:119], a[116:119], a[44:47], v[116:119]
    s_add_u32 s47, s45, 43008
    v_mfma_f32_16x16x32_bf16 v[60:63], a[112:115], a[44:47], 0
    buffer_load_dwordx4 a[216:219], v4, s[16:19], s47 offen offset:0
    v_mfma_f32_16x16x32_bf16 v[32:35], a[108:111], a[44:47], v[32:35]
    s_waitcnt lgkmcnt(9)
    v_mfma_f32_16x16x32_bf16 v[28:31], a[108:111], a[40:43], 0
    buffer_load_dwordx4 a[220:223], v4, s[16:19], s47 offen offset:1024
    v_mfma_f32_16x16x32_bf16 v[56:59], a[112:115], a[40:43], 0
    v_mfma_f32_16x16x32_bf16 v[112:115], a[116:119], a[40:43], 0
    buffer_load_dwordx4 a[224:227], v4, s[16:19], s47 offen offset:2048
    s_waitcnt lgkmcnt(8)
    v_mfma_f32_16x16x32_bf16 v[112:115], a[112:115], a[92:95], v[112:115]
    v_mfma_f32_16x16x32_bf16 v[84:87], a[116:119], a[92:95], 0
    buffer_load_dwordx4 a[228:231], v4, s[16:19], s47 offen offset:3072
    v_mfma_f32_16x16x32_bf16 v[28:31], a[104:107], a[92:95], v[28:31]
    s_waitcnt lgkmcnt(6)
    v_mfma_f32_16x16x32_bf16 v[24:27], a[104:107], a[88:91], 0
    v_mfma_f32_16x16x32_bf16 v[80:83], a[116:119], a[88:91], 0
    ds_read_b128 a[20:23], v5 offset:800
    v_mfma_f32_16x16x32_bf16 v[108:111], a[112:115], a[88:91], 0
    v_mfma_f32_16x16x32_bf16 v[108:111], a[116:119], a[36:39], v[108:111]
    ds_read_b128 a[72:75], v5 offset:864
    v_mfma_f32_16x16x32_bf16 v[52:55], a[112:115], a[36:39], 0
    v_mfma_f32_16x16x32_bf16 v[24:27], a[108:111], a[36:39], v[24:27]
    s_waitcnt lgkmcnt(7)
    v_mfma_f32_16x16x32_bf16 v[20:23], a[108:111], a[32:35], 0
    v_mfma_f32_16x16x32_bf16 v[48:51], a[112:115], a[32:35], 0
    s_add_u32 m0, s42, 38400
    s_add_u32 s46, s44, 4096
    s_mov_b64 exec, s[40:41]
    buffer_load_dwordx4 v3, s[12:15], s46 offen lds
    s_mov_b64 exec, -1
    v_mfma_f32_16x16x32_bf16 v[104:107], a[116:119], a[32:35], 0
    s_waitcnt lgkmcnt(6)
    v_mfma_f32_16x16x32_bf16 v[104:107], a[112:115], a[84:87], v[104:107]
    v_mfma_f32_16x16x32_bf16 v[76:79], a[116:119], a[84:87], 0
    v_mfma_f32_16x16x32_bf16 v[20:23], a[104:107], a[84:87], v[20:23]
    s_waitcnt lgkmcnt(4)
    v_mfma_f32_16x16x32_bf16 v[16:19], a[104:107], a[80:83], 0
    s_add_u32 m0, s42, 42240
    s_add_u32 s46, s43, 4096
    s_mov_b64 exec, s[40:41]
    buffer_load_dwordx4 v3, s[12:15], s46 offen lds
    s_mov_b64 exec, -1
    v_mfma_f32_16x16x32_bf16 v[72:75], a[116:119], a[80:83], 0
    v_mfma_f32_16x16x32_bf16 v[100:103], a[112:115], a[80:83], 0
    v_mfma_f32_16x16x32_bf16 v[100:103], a[116:119], a[28:31], v[100:103]
    v_mfma_f32_16x16x32_bf16 v[44:47], a[112:115], a[28:31], 0
    v_mfma_f32_16x16x32_bf16 v[16:19], a[108:111], a[28:31], v[16:19]
    s_add_u32 m0, s42, 46080
    s_add_u32 s46, s43, 1183744
    s_mov_b64 exec, s[40:41]
    buffer_load_dwordx4 v3, s[12:15], s46 offen lds
    s_mov_b64 exec, -1
    s_waitcnt lgkmcnt(3)
    v_mfma_f32_16x16x32_bf16 v[12:15], a[108:111], a[24:27], 0
    v_mfma_f32_16x16x32_bf16 v[40:43], a[112:115], a[24:27], 0
    v_mfma_f32_16x16x32_bf16 v[96:99], a[116:119], a[24:27], 0
    s_waitcnt lgkmcnt(2)
    v_mfma_f32_16x16x32_bf16 v[96:99], a[112:115], a[76:79], v[96:99]
    v_mfma_f32_16x16x32_bf16 v[68:71], a[116:119], a[76:79], 0
    v_mfma_f32_16x16x32_bf16 v[12:15], a[104:107], a[76:79], v[12:15]
    s_waitcnt vmcnt(17)
    v_mfma_f32_16x16x32_bf16 v[36:39], a[124:127], a[44:47], v[36:39]
    s_add_u32 s47, s45, 24576
    s_waitcnt vmcnt(16)
    v_mfma_f32_16x16x32_bf16 v[64:67], a[128:131], a[44:47], v[64:67]
    buffer_load_dwordx4 a[168:171], v4, s[16:19], s47 offen offset:0
    s_waitcnt vmcnt(16)
    v_mfma_f32_16x16x32_bf16 v[120:123], a[132:135], a[44:47], v[120:123]
    v_mfma_f32_16x16x32_bf16 v[120:123], a[128:131], a[96:99], v[120:123]
    buffer_load_dwordx4 a[172:175], v4, s[16:19], s47 offen offset:1024
    v_mfma_f32_16x16x32_bf16 v[92:95], a[132:135], a[96:99], v[92:95]
    v_mfma_f32_16x16x32_bf16 v[36:39], a[120:123], a[96:99], v[36:39]
    buffer_load_dwordx4 a[176:179], v4, s[16:19], s47 offen offset:2048
    v_mfma_f32_16x16x32_bf16 v[32:35], a[120:123], a[92:95], v[32:35]
    v_mfma_f32_16x16x32_bf16 v[88:91], a[132:135], a[92:95], v[88:91]
    buffer_load_dwordx4 a[180:183], v4, s[16:19], s47 offen offset:3072
    v_mfma_f32_16x16x32_bf16 v[116:119], a[128:131], a[92:95], v[116:119]
    v_mfma_f32_16x16x32_bf16 v[116:119], a[132:135], a[40:43], v[116:119]
    s_add_u32 s47, s45, 49152
    v_mfma_f32_16x16x32_bf16 v[60:63], a[128:131], a[40:43], v[60:63]
    buffer_load_dwordx4 a[232:235], v4, s[16:19], s47 offen offset:0
    v_mfma_f32_16x16x32_bf16 v[32:35], a[124:127], a[40:43], v[32:35]
    v_mfma_f32_16x16x32_bf16 v[28:31], a[124:127], a[36:39], v[28:31]
    buffer_load_dwordx4 a[236:239], v4, s[16:19], s47 offen offset:1024
    v_mfma_f32_16x16x32_bf16 v[56:59], a[128:131], a[36:39], v[56:59]
    v_mfma_f32_16x16x32_bf16 v[112:115], a[132:135], a[36:39], v[112:115]
    buffer_load_dwordx4 a[240:243], v4, s[16:19], s47 offen offset:2048
    v_mfma_f32_16x16x32_bf16 v[112:115], a[128:131], a[88:91], v[112:115]
    v_mfma_f32_16x16x32_bf16 v[84:87], a[132:135], a[88:91], v[84:87]
    buffer_load_dwordx4 a[244:247], v4, s[16:19], s47 offen offset:3072
    v_mfma_f32_16x16x32_bf16 v[28:31], a[120:123], a[88:91], v[28:31]
    v_mfma_f32_16x16x32_bf16 v[24:27], a[120:123], a[84:87], v[24:27]
    v_mfma_f32_16x16x32_bf16 v[80:83], a[132:135], a[84:87], v[80:83]
    ds_read_b128 a[16:19], v5 offset:640
    v_mfma_f32_16x16x32_bf16 v[108:111], a[128:131], a[84:87], v[108:111]
    v_mfma_f32_16x16x32_bf16 v[108:111], a[132:135], a[32:35], v[108:111]
    ds_read_b128 a[68:71], v5 offset:704
    v_mfma_f32_16x16x32_bf16 v[52:55], a[128:131], a[32:35], v[52:55]
    v_mfma_f32_16x16x32_bf16 v[24:27], a[124:127], a[32:35], v[24:27]
    v_mfma_f32_16x16x32_bf16 v[20:23], a[124:127], a[28:31], v[20:23]
    v_mfma_f32_16x16x32_bf16 v[48:51], a[128:131], a[28:31], v[48:51]
    s_add_u32 m0, s42, 49920
    s_add_u32 s46, s43, 2363392
    s_mov_b64 exec, s[40:41]
    buffer_load_dwordx4 v3, s[12:15], s46 offen lds
    s_mov_b64 exec, -1
    v_mfma_f32_16x16x32_bf16 v[104:107], a[132:135], a[28:31], v[104:107]
    v_mfma_f32_16x16x32_bf16 v[104:107], a[128:131], a[80:83], v[104:107]
    v_mfma_f32_16x16x32_bf16 v[76:79], a[132:135], a[80:83], v[76:79]
    v_mfma_f32_16x16x32_bf16 v[20:23], a[120:123], a[80:83], v[20:23]
    v_mfma_f32_16x16x32_bf16 v[16:19], a[120:123], a[76:79], v[16:19]
    s_add_u32 m0, s42, 53760
    s_add_u32 s46, s43, 3543040
    s_mov_b64 exec, s[40:41]
    buffer_load_dwordx4 v3, s[12:15], s46 offen lds
    s_mov_b64 exec, -1
    v_mfma_f32_16x16x32_bf16 v[72:75], a[132:135], a[76:79], v[72:75]
    v_mfma_f32_16x16x32_bf16 v[100:103], a[128:131], a[76:79], v[100:103]
    v_mfma_f32_16x16x32_bf16 v[100:103], a[132:135], a[24:27], v[100:103]
    v_mfma_f32_16x16x32_bf16 v[44:47], a[128:131], a[24:27], v[44:47]
    v_mfma_f32_16x16x32_bf16 v[16:19], a[124:127], a[24:27], v[16:19]
    s_add_u32 m0, s42, 57600
    s_add_u32 s46, s43, 4722688
    s_mov_b64 exec, s[40:41]
    buffer_load_dwordx4 v3, s[12:15], s46 offen lds
    s_mov_b64 exec, -1
    s_waitcnt lgkmcnt(3)
    v_mfma_f32_16x16x32_bf16 v[12:15], a[124:127], a[20:23], v[12:15]
    v_mfma_f32_16x16x32_bf16 v[40:43], a[128:131], a[20:23], v[40:43]
    v_mfma_f32_16x16x32_bf16 v[96:99], a[132:135], a[20:23], v[96:99]
    s_waitcnt lgkmcnt(2)
    v_mfma_f32_16x16x32_bf16 v[96:99], a[128:131], a[72:75], v[96:99]
    v_mfma_f32_16x16x32_bf16 v[68:71], a[132:135], a[72:75], v[68:71]
    v_mfma_f32_16x16x32_bf16 v[12:15], a[120:123], a[72:75], v[12:15]
    s_waitcnt vmcnt(24)
    v_mfma_f32_16x16x32_bf16 v[36:39], a[140:143], a[40:43], v[36:39]
    s_add_u32 s47, s45, 30720
    s_waitcnt vmcnt(23)
    v_mfma_f32_16x16x32_bf16 v[64:67], a[144:147], a[40:43], v[64:67]
    buffer_load_dwordx4 a[184:187], v4, s[16:19], s47 offen offset:0
    s_waitcnt vmcnt(23)
    v_mfma_f32_16x16x32_bf16 v[120:123], a[148:151], a[40:43], v[120:123]
    v_mfma_f32_16x16x32_bf16 v[120:123], a[144:147], a[92:95], v[120:123]
    buffer_load_dwordx4 a[188:191], v4, s[16:19], s47 offen offset:1024
    v_mfma_f32_16x16x32_bf16 v[92:95], a[148:151], a[92:95], v[92:95]
    v_mfma_f32_16x16x32_bf16 v[36:39], a[136:139], a[92:95], v[36:39]
    buffer_load_dwordx4 a[192:195], v4, s[16:19], s47 offen offset:2048
    v_mfma_f32_16x16x32_bf16 v[32:35], a[136:139], a[88:91], v[32:35]
    v_mfma_f32_16x16x32_bf16 v[88:91], a[148:151], a[88:91], v[88:91]
    buffer_load_dwordx4 a[196:199], v4, s[16:19], s47 offen offset:3072
    v_mfma_f32_16x16x32_bf16 v[116:119], a[144:147], a[88:91], v[116:119]
    v_mfma_f32_16x16x32_bf16 v[116:119], a[148:151], a[36:39], v[116:119]
    s_add_u32 s47, s45, 55296
    v_mfma_f32_16x16x32_bf16 v[60:63], a[144:147], a[36:39], v[60:63]
    buffer_load_dwordx4 a[248:251], v4, s[16:19], s47 offen offset:0
    v_mfma_f32_16x16x32_bf16 v[32:35], a[140:143], a[36:39], v[32:35]
    v_mfma_f32_16x16x32_bf16 v[28:31], a[140:143], a[32:35], v[28:31]
    buffer_load_dwordx4 a[252:255], v4, s[16:19], s47 offen offset:1024
    v_mfma_f32_16x16x32_bf16 v[56:59], a[144:147], a[32:35], v[56:59]
    v_mfma_f32_16x16x32_bf16 v[112:115], a[148:151], a[32:35], v[112:115]
    buffer_load_dwordx4 v[168:171], v4, s[16:19], s47 offen offset:2048
    v_mfma_f32_16x16x32_bf16 v[112:115], a[144:147], a[84:87], v[112:115]
    v_mfma_f32_16x16x32_bf16 v[84:87], a[148:151], a[84:87], v[84:87]
    buffer_load_dwordx4 v[172:175], v4, s[16:19], s47 offen offset:3072
    v_mfma_f32_16x16x32_bf16 v[28:31], a[136:139], a[84:87], v[28:31]
    v_mfma_f32_16x16x32_bf16 v[24:27], a[136:139], a[80:83], v[24:27]
    v_mfma_f32_16x16x32_bf16 v[80:83], a[148:151], a[80:83], v[80:83]
    ds_read_b128 a[12:15], v5 offset:480
    v_mfma_f32_16x16x32_bf16 v[108:111], a[144:147], a[80:83], v[108:111]
    v_mfma_f32_16x16x32_bf16 v[108:111], a[148:151], a[28:31], v[108:111]
    ds_read_b128 a[64:67], v5 offset:544
    v_mfma_f32_16x16x32_bf16 v[52:55], a[144:147], a[28:31], v[52:55]
    v_mfma_f32_16x16x32_bf16 v[24:27], a[140:143], a[28:31], v[24:27]
    v_mfma_f32_16x16x32_bf16 v[20:23], a[140:143], a[24:27], v[20:23]
    v_mfma_f32_16x16x32_bf16 v[48:51], a[144:147], a[24:27], v[48:51]
    s_add_u32 m0, s42, 61440
    s_add_u32 s46, s43, 5902336
    s_mov_b64 exec, s[40:41]
    buffer_load_dwordx4 v3, s[12:15], s46 offen lds
    s_mov_b64 exec, -1
    v_mfma_f32_16x16x32_bf16 v[104:107], a[148:151], a[24:27], v[104:107]
    v_mfma_f32_16x16x32_bf16 v[104:107], a[144:147], a[76:79], v[104:107]
    v_mfma_f32_16x16x32_bf16 v[76:79], a[148:151], a[76:79], v[76:79]
    v_mfma_f32_16x16x32_bf16 v[20:23], a[136:139], a[76:79], v[20:23]
    v_mfma_f32_16x16x32_bf16 v[16:19], a[136:139], a[72:75], v[16:19]
    s_add_u32 m0, s42, 65280
    s_add_u32 s46, s43, 7081984
    s_mov_b64 exec, s[40:41]
    buffer_load_dwordx4 v3, s[12:15], s46 offen lds
    s_mov_b64 exec, -1
    v_mfma_f32_16x16x32_bf16 v[72:75], a[148:151], a[72:75], v[72:75]
    v_mfma_f32_16x16x32_bf16 v[100:103], a[144:147], a[72:75], v[100:103]
    v_mfma_f32_16x16x32_bf16 v[100:103], a[148:151], a[20:23], v[100:103]
    v_mfma_f32_16x16x32_bf16 v[44:47], a[144:147], a[20:23], v[44:47]
    v_mfma_f32_16x16x32_bf16 v[16:19], a[140:143], a[20:23], v[16:19]
    s_waitcnt lgkmcnt(3)
    v_mfma_f32_16x16x32_bf16 v[12:15], a[140:143], a[16:19], v[12:15]
    v_mfma_f32_16x16x32_bf16 v[40:43], a[144:147], a[16:19], v[40:43]
    v_mfma_f32_16x16x32_bf16 v[96:99], a[148:151], a[16:19], v[96:99]
    s_waitcnt lgkmcnt(2)
    v_mfma_f32_16x16x32_bf16 v[96:99], a[144:147], a[68:71], v[96:99]
    v_mfma_f32_16x16x32_bf16 v[68:71], a[148:151], a[68:71], v[68:71]
    v_mfma_f32_16x16x32_bf16 v[12:15], a[136:139], a[68:71], v[12:15]
    s_waitcnt vmcnt(30)
    v_mfma_f32_16x16x32_bf16 v[36:39], a[156:159], a[36:39], v[36:39]
    s_add_u32 s47, s45, 36864
    s_waitcnt vmcnt(29)
    v_mfma_f32_16x16x32_bf16 v[64:67], a[160:163], a[36:39], v[64:67]
    buffer_load_dwordx4 a[200:203], v4, s[16:19], s47 offen offset:0
    s_waitcnt vmcnt(29)
    v_mfma_f32_16x16x32_bf16 v[120:123], a[164:167], a[36:39], v[120:123]
    v_mfma_f32_16x16x32_bf16 v[120:123], a[160:163], a[88:91], v[120:123]
    buffer_load_dwordx4 a[204:207], v4, s[16:19], s47 offen offset:1024
    v_mfma_f32_16x16x32_bf16 v[92:95], a[164:167], a[88:91], v[92:95]
    v_mfma_f32_16x16x32_bf16 v[36:39], a[152:155], a[88:91], v[36:39]
    buffer_load_dwordx4 a[208:211], v4, s[16:19], s47 offen offset:2048
    v_mfma_f32_16x16x32_bf16 v[32:35], a[152:155], a[84:87], v[32:35]
    v_mfma_f32_16x16x32_bf16 v[88:91], a[164:167], a[84:87], v[88:91]
    buffer_load_dwordx4 a[212:215], v4, s[16:19], s47 offen offset:3072
    v_mfma_f32_16x16x32_bf16 v[116:119], a[160:163], a[84:87], v[116:119]
    v_mfma_f32_16x16x32_bf16 v[116:119], a[164:167], a[32:35], v[116:119]
    s_add_u32 s47, s45, 61440
    v_mfma_f32_16x16x32_bf16 v[60:63], a[160:163], a[32:35], v[60:63]
    buffer_load_dwordx4 v[176:179], v4, s[16:19], s47 offen offset:0
    v_mfma_f32_16x16x32_bf16 v[32:35], a[156:159], a[32:35], v[32:35]
    v_mfma_f32_16x16x32_bf16 v[28:31], a[156:159], a[28:31], v[28:31]
    buffer_load_dwordx4 v[180:183], v4, s[16:19], s47 offen offset:1024
    v_mfma_f32_16x16x32_bf16 v[56:59], a[160:163], a[28:31], v[56:59]
    v_mfma_f32_16x16x32_bf16 v[112:115], a[164:167], a[28:31], v[112:115]
    buffer_load_dwordx4 v[184:187], v4, s[16:19], s47 offen offset:2048
    v_mfma_f32_16x16x32_bf16 v[112:115], a[160:163], a[80:83], v[112:115]
    v_mfma_f32_16x16x32_bf16 v[84:87], a[164:167], a[80:83], v[84:87]
    buffer_load_dwordx4 v[188:191], v4, s[16:19], s47 offen offset:3072
    v_mfma_f32_16x16x32_bf16 v[28:31], a[152:155], a[80:83], v[28:31]
    v_mfma_f32_16x16x32_bf16 v[24:27], a[152:155], a[76:79], v[24:27]
    v_mfma_f32_16x16x32_bf16 v[80:83], a[164:167], a[76:79], v[80:83]
    ds_read_b128 a[8:11], v5 offset:320
    v_mfma_f32_16x16x32_bf16 v[108:111], a[160:163], a[76:79], v[108:111]
    v_mfma_f32_16x16x32_bf16 v[108:111], a[164:167], a[24:27], v[108:111]
    ds_read_b128 a[60:63], v5 offset:384
    v_mfma_f32_16x16x32_bf16 v[52:55], a[160:163], a[24:27], v[52:55]
    v_mfma_f32_16x16x32_bf16 v[24:27], a[156:159], a[24:27], v[24:27]
    v_mfma_f32_16x16x32_bf16 v[20:23], a[156:159], a[20:23], v[20:23]
    v_mfma_f32_16x16x32_bf16 v[48:51], a[160:163], a[20:23], v[48:51]
    s_add_u32 m0, s42, 69120
    s_add_u32 s46, s43, 8261632
    s_mov_b64 exec, s[40:41]
    buffer_load_dwordx4 v3, s[12:15], s46 offen lds
    s_mov_b64 exec, -1
    v_mfma_f32_16x16x32_bf16 v[104:107], a[164:167], a[20:23], v[104:107]
    v_mfma_f32_16x16x32_bf16 v[104:107], a[160:163], a[72:75], v[104:107]
    v_mfma_f32_16x16x32_bf16 v[76:79], a[164:167], a[72:75], v[76:79]
    v_mfma_f32_16x16x32_bf16 v[20:23], a[152:155], a[72:75], v[20:23]
    v_mfma_f32_16x16x32_bf16 v[16:19], a[152:155], a[68:71], v[16:19]
    s_add_u32 m0, s42, 72960
    s_add_u32 s46, s43, 9441280
    s_mov_b64 exec, s[40:41]
    buffer_load_dwordx4 v3, s[12:15], s46 offen lds
    s_mov_b64 exec, -1
    v_mfma_f32_16x16x32_bf16 v[72:75], a[164:167], a[68:71], v[72:75]
    v_mfma_f32_16x16x32_bf16 v[100:103], a[160:163], a[68:71], v[100:103]
    v_mfma_f32_16x16x32_bf16 v[100:103], a[164:167], a[16:19], v[100:103]
    v_mfma_f32_16x16x32_bf16 v[44:47], a[160:163], a[16:19], v[44:47]
    v_mfma_f32_16x16x32_bf16 v[16:19], a[156:159], a[16:19], v[16:19]
    s_waitcnt lgkmcnt(3)
    v_mfma_f32_16x16x32_bf16 v[12:15], a[156:159], a[12:15], v[12:15]
    v_mfma_f32_16x16x32_bf16 v[40:43], a[160:163], a[12:15], v[40:43]
    v_mfma_f32_16x16x32_bf16 v[96:99], a[164:167], a[12:15], v[96:99]
    s_waitcnt lgkmcnt(2)
    v_mfma_f32_16x16x32_bf16 v[96:99], a[160:163], a[64:67], v[96:99]
    v_mfma_f32_16x16x32_bf16 v[68:71], a[164:167], a[64:67], v[68:71]
    v_mfma_f32_16x16x32_bf16 v[12:15], a[152:155], a[64:67], v[12:15]
    s_waitcnt vmcnt(29)
    v_mfma_f32_16x16x32_bf16 v[36:39], a[172:175], a[32:35], v[36:39]
    s_waitcnt vmcnt(28)
    v_mfma_f32_16x16x32_bf16 v[64:67], a[176:179], a[32:35], v[64:67]
    s_waitcnt vmcnt(27)
    v_mfma_f32_16x16x32_bf16 v[120:123], a[180:183], a[32:35], v[120:123]
    v_mfma_f32_16x16x32_bf16 v[120:123], a[176:179], a[84:87], v[120:123]
    v_mfma_f32_16x16x32_bf16 v[92:95], a[180:183], a[84:87], v[92:95]
    v_mfma_f32_16x16x32_bf16 v[36:39], a[168:171], a[84:87], v[36:39]
    v_mfma_f32_16x16x32_bf16 v[32:35], a[168:171], a[80:83], v[32:35]
    v_mfma_f32_16x16x32_bf16 v[88:91], a[180:183], a[80:83], v[88:91]
    v_mfma_f32_16x16x32_bf16 v[116:119], a[176:179], a[80:83], v[116:119]
    v_mfma_f32_16x16x32_bf16 v[116:119], a[180:183], a[28:31], v[116:119]
    s_add_u32 s47, s45, 67584
    v_mfma_f32_16x16x32_bf16 v[60:63], a[176:179], a[28:31], v[60:63]
    buffer_load_dwordx4 v[192:195], v4, s[16:19], s47 offen offset:0
    v_mfma_f32_16x16x32_bf16 v[32:35], a[172:175], a[28:31], v[32:35]
    v_mfma_f32_16x16x32_bf16 v[28:31], a[172:175], a[24:27], v[28:31]
    buffer_load_dwordx4 v[196:199], v4, s[16:19], s47 offen offset:1024
    v_mfma_f32_16x16x32_bf16 v[56:59], a[176:179], a[24:27], v[56:59]
    v_mfma_f32_16x16x32_bf16 v[112:115], a[180:183], a[24:27], v[112:115]
    buffer_load_dwordx4 v[200:203], v4, s[16:19], s47 offen offset:2048
    v_mfma_f32_16x16x32_bf16 v[112:115], a[176:179], a[76:79], v[112:115]
    v_mfma_f32_16x16x32_bf16 v[84:87], a[180:183], a[76:79], v[84:87]
    buffer_load_dwordx4 v[204:207], v4, s[16:19], s47 offen offset:3072
    v_mfma_f32_16x16x32_bf16 v[28:31], a[168:171], a[76:79], v[28:31]
    v_mfma_f32_16x16x32_bf16 v[24:27], a[168:171], a[72:75], v[24:27]
    v_mfma_f32_16x16x32_bf16 v[80:83], a[180:183], a[72:75], v[80:83]
    ds_read_b128 a[4:7], v5 offset:160
    v_mfma_f32_16x16x32_bf16 v[108:111], a[176:179], a[72:75], v[108:111]
    v_mfma_f32_16x16x32_bf16 v[108:111], a[180:183], a[20:23], v[108:111]
    ds_read_b128 a[56:59], v5 offset:224
    v_mfma_f32_16x16x32_bf16 v[52:55], a[176:179], a[20:23], v[52:55]
    v_mfma_f32_16x16x32_bf16 v[24:27], a[172:175], a[20:23], v[24:27]
    v_mfma_f32_16x16x32_bf16 v[20:23], a[172:175], a[16:19], v[20:23]
    v_mfma_f32_16x16x32_bf16 v[48:51], a[176:179], a[16:19], v[48:51]
    v_mfma_f32_16x16x32_bf16 v[104:107], a[180:183], a[16:19], v[104:107]
    v_mfma_f32_16x16x32_bf16 v[104:107], a[176:179], a[68:71], v[104:107]
    v_mfma_f32_16x16x32_bf16 v[76:79], a[180:183], a[68:71], v[76:79]
    v_mfma_f32_16x16x32_bf16 v[20:23], a[168:171], a[68:71], v[20:23]
    v_mfma_f32_16x16x32_bf16 v[16:19], a[168:171], a[64:67], v[16:19]
    v_mfma_f32_16x16x32_bf16 v[72:75], a[180:183], a[64:67], v[72:75]
    v_mfma_f32_16x16x32_bf16 v[100:103], a[176:179], a[64:67], v[100:103]
    v_mfma_f32_16x16x32_bf16 v[100:103], a[180:183], a[12:15], v[100:103]
    v_mfma_f32_16x16x32_bf16 v[44:47], a[176:179], a[12:15], v[44:47]
    v_mfma_f32_16x16x32_bf16 v[16:19], a[172:175], a[12:15], v[16:19]
    s_waitcnt lgkmcnt(3)
    v_mfma_f32_16x16x32_bf16 v[12:15], a[172:175], a[8:11], v[12:15]
    v_mfma_f32_16x16x32_bf16 v[40:43], a[176:179], a[8:11], v[40:43]
    v_mfma_f32_16x16x32_bf16 v[96:99], a[180:183], a[8:11], v[96:99]
    s_waitcnt lgkmcnt(2)
    v_mfma_f32_16x16x32_bf16 v[96:99], a[176:179], a[60:63], v[96:99]
    v_mfma_f32_16x16x32_bf16 v[68:71], a[180:183], a[60:63], v[68:71]
    v_mfma_f32_16x16x32_bf16 v[12:15], a[168:171], a[60:63], v[12:15]
    s_waitcnt vmcnt(22)
    v_mfma_f32_16x16x32_bf16 v[36:39], a[188:191], a[28:31], v[36:39]
    s_waitcnt vmcnt(21)
    v_mfma_f32_16x16x32_bf16 v[64:67], a[192:195], a[28:31], v[64:67]
    s_waitcnt vmcnt(20)
    v_mfma_f32_16x16x32_bf16 v[120:123], a[196:199], a[28:31], v[120:123]
    v_mfma_f32_16x16x32_bf16 v[120:123], a[192:195], a[80:83], v[120:123]
    v_mfma_f32_16x16x32_bf16 v[92:95], a[196:199], a[80:83], v[92:95]
    v_mfma_f32_16x16x32_bf16 v[36:39], a[184:187], a[80:83], v[36:39]
    v_mfma_f32_16x16x32_bf16 v[32:35], a[184:187], a[76:79], v[32:35]
    v_mfma_f32_16x16x32_bf16 v[88:91], a[196:199], a[76:79], v[88:91]
    v_mfma_f32_16x16x32_bf16 v[116:119], a[192:195], a[76:79], v[116:119]
    v_mfma_f32_16x16x32_bf16 v[116:119], a[196:199], a[24:27], v[116:119]
    s_add_u32 s47, s45, 73728
    v_mfma_f32_16x16x32_bf16 v[60:63], a[192:195], a[24:27], v[60:63]
    buffer_load_dwordx4 v[208:211], v4, s[16:19], s47 offen offset:0
    v_mfma_f32_16x16x32_bf16 v[32:35], a[188:191], a[24:27], v[32:35]
    v_mfma_f32_16x16x32_bf16 v[28:31], a[188:191], a[20:23], v[28:31]
    buffer_load_dwordx4 v[212:215], v4, s[16:19], s47 offen offset:1024
    v_mfma_f32_16x16x32_bf16 v[56:59], a[192:195], a[20:23], v[56:59]
    v_mfma_f32_16x16x32_bf16 v[112:115], a[196:199], a[20:23], v[112:115]
    buffer_load_dwordx4 v[216:219], v4, s[16:19], s47 offen offset:2048
    v_mfma_f32_16x16x32_bf16 v[112:115], a[192:195], a[72:75], v[112:115]
    v_mfma_f32_16x16x32_bf16 v[84:87], a[196:199], a[72:75], v[84:87]
    buffer_load_dwordx4 v[220:223], v4, s[16:19], s47 offen offset:3072
    v_mfma_f32_16x16x32_bf16 v[28:31], a[184:187], a[72:75], v[28:31]
    v_mfma_f32_16x16x32_bf16 v[24:27], a[184:187], a[68:71], v[24:27]
    s_waitcnt vmcnt(8)
    s_barrier
    v_mfma_f32_16x16x32_bf16 v[80:83], a[196:199], a[68:71], v[80:83]
    ds_read_b128 a[0:3], v5 offset:0
    v_mfma_f32_16x16x32_bf16 v[108:111], a[192:195], a[68:71], v[108:111]
    v_mfma_f32_16x16x32_bf16 v[108:111], a[196:199], a[16:19], v[108:111]
    ds_read_b128 a[52:55], v5 offset:64
    v_mfma_f32_16x16x32_bf16 v[52:55], a[192:195], a[16:19], v[52:55]
    v_mfma_f32_16x16x32_bf16 v[24:27], a[188:191], a[16:19], v[24:27]
    ds_read_b128 a[48:51], v6 offset:1920
    v_mfma_f32_16x16x32_bf16 v[20:23], a[188:191], a[12:15], v[20:23]
    v_mfma_f32_16x16x32_bf16 v[48:51], a[192:195], a[12:15], v[48:51]
    ds_read_b128 a[100:103], v6 offset:1984
    v_mfma_f32_16x16x32_bf16 v[104:107], a[196:199], a[12:15], v[104:107]
    v_mfma_f32_16x16x32_bf16 v[104:107], a[192:195], a[64:67], v[104:107]
    ds_read_b128 a[44:47], v6 offset:1760
    v_mfma_f32_16x16x32_bf16 v[76:79], a[196:199], a[64:67], v[76:79]
    v_mfma_f32_16x16x32_bf16 v[20:23], a[184:187], a[64:67], v[20:23]
    ds_read_b128 a[96:99], v6 offset:1824
    v_mfma_f32_16x16x32_bf16 v[16:19], a[184:187], a[60:63], v[16:19]
    v_mfma_f32_16x16x32_bf16 v[72:75], a[196:199], a[60:63], v[72:75]
    s_add_u32 s47, s45, 79872
    ds_read_b128 a[40:43], v6 offset:1600
    v_mfma_f32_16x16x32_bf16 v[100:103], a[192:195], a[60:63], v[100:103]
    buffer_load_dwordx4 v[224:227], v4, s[16:19], s47 offen offset:0
    v_mfma_f32_16x16x32_bf16 v[100:103], a[196:199], a[8:11], v[100:103]
    ds_read_b128 a[92:95], v6 offset:1664
    v_mfma_f32_16x16x32_bf16 v[44:47], a[192:195], a[8:11], v[44:47]
    buffer_load_dwordx4 v[228:231], v4, s[16:19], s47 offen offset:1024
    v_mfma_f32_16x16x32_bf16 v[16:19], a[188:191], a[8:11], v[16:19]
    s_waitcnt lgkmcnt(9)
    v_mfma_f32_16x16x32_bf16 v[12:15], a[188:191], a[4:7], v[12:15]
    buffer_load_dwordx4 v[232:235], v4, s[16:19], s47 offen offset:2048
    v_mfma_f32_16x16x32_bf16 v[40:43], a[192:195], a[4:7], v[40:43]
    v_mfma_f32_16x16x32_bf16 v[96:99], a[196:199], a[4:7], v[96:99]
    buffer_load_dwordx4 v[236:239], v4, s[16:19], s47 offen offset:3072
    s_waitcnt lgkmcnt(8)
    v_mfma_f32_16x16x32_bf16 v[96:99], a[192:195], a[56:59], v[96:99]
    v_mfma_f32_16x16x32_bf16 v[68:71], a[196:199], a[56:59], v[68:71]
    v_mfma_f32_16x16x32_bf16 v[12:15], a[184:187], a[56:59], v[12:15]
    v_mfma_f32_16x16x32_bf16 v[36:39], a[204:207], a[24:27], v[36:39]
    v_mfma_f32_16x16x32_bf16 v[64:67], a[208:211], a[24:27], v[64:67]
    v_mfma_f32_16x16x32_bf16 v[120:123], a[212:215], a[24:27], v[120:123]
    v_mfma_f32_16x16x32_bf16 v[120:123], a[208:211], a[76:79], v[120:123]
    v_mfma_f32_16x16x32_bf16 v[92:95], a[212:215], a[76:79], v[92:95]
    v_mfma_f32_16x16x32_bf16 v[36:39], a[200:203], a[76:79], v[36:39]
    v_mfma_f32_16x16x32_bf16 v[32:35], a[200:203], a[72:75], v[32:35]
    v_mfma_f32_16x16x32_bf16 v[88:91], a[212:215], a[72:75], v[88:91]
    v_mfma_f32_16x16x32_bf16 v[116:119], a[208:211], a[72:75], v[116:119]
    v_mfma_f32_16x16x32_bf16 v[116:119], a[212:215], a[20:23], v[116:119]
    v_mfma_f32_16x16x32_bf16 v[60:63], a[208:211], a[20:23], v[60:63]
    v_mfma_f32_16x16x32_bf16 v[32:35], a[204:207], a[20:23], v[32:35]
    v_mfma_f32_16x16x32_bf16 v[28:31], a[204:207], a[16:19], v[28:31]
    v_mfma_f32_16x16x32_bf16 v[56:59], a[208:211], a[16:19], v[56:59]
    v_mfma_f32_16x16x32_bf16 v[112:115], a[212:215], a[16:19], v[112:115]
    v_mfma_f32_16x16x32_bf16 v[112:115], a[208:211], a[68:71], v[112:115]
    v_mfma_f32_16x16x32_bf16 v[84:87], a[212:215], a[68:71], v[84:87]
    v_mfma_f32_16x16x32_bf16 v[28:31], a[200:203], a[68:71], v[28:31]
    v_mfma_f32_16x16x32_bf16 v[24:27], a[200:203], a[64:67], v[24:27]
    v_mfma_f32_16x16x32_bf16 v[80:83], a[212:215], a[64:67], v[80:83]
    ds_read_b128 a[36:39], v6 offset:1440
    v_mfma_f32_16x16x32_bf16 v[108:111], a[208:211], a[64:67], v[108:111]
    v_mfma_f32_16x16x32_bf16 v[108:111], a[212:215], a[12:15], v[108:111]
    ds_read_b128 a[88:91], v6 offset:1504
    v_mfma_f32_16x16x32_bf16 v[52:55], a[208:211], a[12:15], v[52:55]
    v_mfma_f32_16x16x32_bf16 v[24:27], a[204:207], a[12:15], v[24:27]
    ds_read_b128 a[32:35], v6 offset:1280
    v_mfma_f32_16x16x32_bf16 v[20:23], a[204:207], a[8:11], v[20:23]
    v_mfma_f32_16x16x32_bf16 v[48:51], a[208:211], a[8:11], v[48:51]
    ds_read_b128 a[84:87], v6 offset:1344
    v_mfma_f32_16x16x32_bf16 v[104:107], a[212:215], a[8:11], v[104:107]
    v_mfma_f32_16x16x32_bf16 v[104:107], a[208:211], a[60:63], v[104:107]
    ds_read_b128 a[28:31], v6 offset:1120
    v_mfma_f32_16x16x32_bf16 v[76:79], a[212:215], a[60:63], v[76:79]
    v_mfma_f32_16x16x32_bf16 v[20:23], a[200:203], a[60:63], v[20:23]
    ds_read_b128 a[80:83], v6 offset:1184
    v_mfma_f32_16x16x32_bf16 v[16:19], a[200:203], a[56:59], v[16:19]
    v_mfma_f32_16x16x32_bf16 v[72:75], a[212:215], a[56:59], v[72:75]
    ds_read_b128 a[24:27], v6 offset:960
    v_mfma_f32_16x16x32_bf16 v[100:103], a[208:211], a[56:59], v[100:103]
    v_mfma_f32_16x16x32_bf16 v[100:103], a[212:215], a[4:7], v[100:103]
    ds_read_b128 a[76:79], v6 offset:1024
    v_mfma_f32_16x16x32_bf16 v[44:47], a[208:211], a[4:7], v[44:47]
    v_mfma_f32_16x16x32_bf16 v[16:19], a[204:207], a[4:7], v[16:19]
    s_waitcnt lgkmcnt(15)
    v_mfma_f32_16x16x32_bf16 v[12:15], a[204:207], a[0:3], v[12:15]
    v_mfma_f32_16x16x32_bf16 v[40:43], a[208:211], a[0:3], v[40:43]
    v_mfma_f32_16x16x32_bf16 v[96:99], a[212:215], a[0:3], v[96:99]
    s_waitcnt lgkmcnt(14)
    v_mfma_f32_16x16x32_bf16 v[96:99], a[208:211], a[52:55], v[96:99]
    v_mfma_f32_16x16x32_bf16 v[68:71], a[212:215], a[52:55], v[68:71]
    v_mfma_f32_16x16x32_bf16 v[12:15], a[200:203], a[52:55], v[12:15]
    s_waitcnt lgkmcnt(13)
    v_mfma_f32_16x16x32_bf16 v[36:39], a[220:223], a[48:51], v[36:39]
    v_mfma_f32_16x16x32_bf16 v[64:67], a[224:227], a[48:51], v[64:67]
    v_mfma_f32_16x16x32_bf16 v[120:123], a[228:231], a[48:51], v[120:123]
    ds_read_b128 a[20:23], v6 offset:800
    s_waitcnt lgkmcnt(12)
    v_mfma_f32_16x16x32_bf16 v[36:39], a[236:239], a[44:47], v[36:39]
    v_mfma_f32_16x16x32_bf16 v[64:67], a[240:243], a[44:47], v[64:67]
    v_mfma_f32_16x16x32_bf16 v[120:123], a[244:247], a[44:47], v[120:123]
    ds_read_b128 a[72:75], v6 offset:864
    s_waitcnt lgkmcnt(11)
    v_mfma_f32_16x16x32_bf16 v[36:39], a[252:255], a[40:43], v[36:39]
    v_mfma_f32_16x16x32_bf16 v[64:67], v[168:171], a[40:43], v[64:67]
    v_mfma_f32_16x16x32_bf16 v[120:123], v[172:175], a[40:43], v[120:123]
    s_add_u32 s47, s45, 86016
    s_waitcnt lgkmcnt(9)
    v_mfma_f32_16x16x32_bf16 v[36:39], v[180:183], a[36:39], v[36:39]
    buffer_load_dwordx4 a[104:107], v4, s[16:19], s47 offen offset:0
    v_mfma_f32_16x16x32_bf16 v[64:67], v[184:187], a[36:39], v[64:67]
    v_mfma_f32_16x16x32_bf16 v[120:123], v[188:191], a[36:39], v[120:123]
    buffer_load_dwordx4 a[108:111], v4, s[16:19], s47 offen offset:1024
    s_waitcnt vmcnt(12)
    s_waitcnt lgkmcnt(7)
    v_mfma_f32_16x16x32_bf16 v[36:39], v[196:199], a[32:35], v[36:39]
    s_waitcnt vmcnt(11)
    v_mfma_f32_16x16x32_bf16 v[64:67], v[200:203], a[32:35], v[64:67]
    buffer_load_dwordx4 a[112:115], v4, s[16:19], s47 offen offset:2048
    s_waitcnt vmcnt(11)
    v_mfma_f32_16x16x32_bf16 v[120:123], v[204:207], a[32:35], v[120:123]
    s_waitcnt vmcnt(9)
    s_waitcnt lgkmcnt(5)
    v_mfma_f32_16x16x32_bf16 v[36:39], v[212:215], a[28:31], v[36:39]
    buffer_load_dwordx4 a[116:119], v4, s[16:19], s47 offen offset:3072
    s_waitcnt vmcnt(9)
    v_mfma_f32_16x16x32_bf16 v[64:67], v[216:219], a[28:31], v[64:67]
    s_waitcnt vmcnt(8)
    v_mfma_f32_16x16x32_bf16 v[120:123], v[220:223], a[28:31], v[120:123]
    s_waitcnt vmcnt(6)
    s_waitcnt lgkmcnt(3)
    v_mfma_f32_16x16x32_bf16 v[36:39], v[228:231], a[24:27], v[36:39]
    s_waitcnt vmcnt(5)
    v_mfma_f32_16x16x32_bf16 v[64:67], v[232:235], a[24:27], v[64:67]
    s_add_u32 m0, s42, 76800
    s_add_u32 s46, s44, 8192
    s_mov_b64 exec, s[40:41]
    buffer_load_dwordx4 v3, s[12:15], s46 offen lds
    s_mov_b64 exec, -1
    s_waitcnt vmcnt(5)
    v_mfma_f32_16x16x32_bf16 v[120:123], v[236:239], a[24:27], v[120:123]
    v_mfma_f32_16x16x32_bf16 v[36:39], a[216:219], a[100:103], v[36:39]
    v_mfma_f32_16x16x32_bf16 v[92:95], a[228:231], a[100:103], v[92:95]
    v_mfma_f32_16x16x32_bf16 v[120:123], a[224:227], a[100:103], v[120:123]
    v_mfma_f32_16x16x32_bf16 v[36:39], a[232:235], a[96:99], v[36:39]
    s_add_u32 m0, s42, 80640
    s_add_u32 s46, s43, 8192
    s_mov_b64 exec, s[40:41]
    buffer_load_dwordx4 v3, s[12:15], s46 offen lds
    s_mov_b64 exec, -1
    v_mfma_f32_16x16x32_bf16 v[92:95], a[244:247], a[96:99], v[92:95]
    v_mfma_f32_16x16x32_bf16 v[120:123], a[240:243], a[96:99], v[120:123]
    v_mfma_f32_16x16x32_bf16 v[36:39], a[248:251], a[92:95], v[36:39]
    v_mfma_f32_16x16x32_bf16 v[92:95], v[172:175], a[92:95], v[92:95]
    v_mfma_f32_16x16x32_bf16 v[120:123], v[168:171], a[92:95], v[120:123]
    s_add_u32 m0, s42, 84480
    s_add_u32 s46, s43, 1187840
    s_mov_b64 exec, s[40:41]
    buffer_load_dwordx4 v3, s[12:15], s46 offen lds
    s_mov_b64 exec, -1
    v_mfma_f32_16x16x32_bf16 v[36:39], v[176:179], a[88:91], v[36:39]
    v_mfma_f32_16x16x32_bf16 v[92:95], v[188:191], a[88:91], v[92:95]
    v_mfma_f32_16x16x32_bf16 v[120:123], v[184:187], a[88:91], v[120:123]
    v_mfma_f32_16x16x32_bf16 v[36:39], v[192:195], a[84:87], v[36:39]
    v_mfma_f32_16x16x32_bf16 v[92:95], v[204:207], a[84:87], v[92:95]
    s_add_u32 m0, s42, 88320
    s_add_u32 s46, s43, 2367488
    s_mov_b64 exec, s[40:41]
    buffer_load_dwordx4 v3, s[12:15], s46 offen lds
    s_mov_b64 exec, -1
    v_mfma_f32_16x16x32_bf16 v[120:123], v[200:203], a[84:87], v[120:123]
    v_mfma_f32_16x16x32_bf16 v[36:39], v[208:211], a[80:83], v[36:39]
    v_mfma_f32_16x16x32_bf16 v[92:95], v[220:223], a[80:83], v[92:95]
    v_mfma_f32_16x16x32_bf16 v[120:123], v[216:219], a[80:83], v[120:123]
    s_waitcnt lgkmcnt(2)
    v_mfma_f32_16x16x32_bf16 v[36:39], v[224:227], a[76:79], v[36:39]
    v_mfma_f32_16x16x32_bf16 v[92:95], v[236:239], a[76:79], v[92:95]
    v_mfma_f32_16x16x32_bf16 v[120:123], v[232:235], a[76:79], v[120:123]
    v_mfma_f32_16x16x32_bf16 v[32:35], a[220:223], a[44:47], v[32:35]
    v_mfma_f32_16x16x32_bf16 v[60:63], a[224:227], a[44:47], v[60:63]
    v_mfma_f32_16x16x32_bf16 v[116:119], a[228:231], a[44:47], v[116:119]
    ds_read_b128 a[16:19], v6 offset:640
    v_mfma_f32_16x16x32_bf16 v[32:35], a[236:239], a[40:43], v[32:35]
    v_mfma_f32_16x16x32_bf16 v[60:63], a[240:243], a[40:43], v[60:63]
    v_mfma_f32_16x16x32_bf16 v[116:119], a[244:247], a[40:43], v[116:119]
    ds_read_b128 a[68:71], v6 offset:704
    v_mfma_f32_16x16x32_bf16 v[32:35], a[252:255], a[36:39], v[32:35]
    v_mfma_f32_16x16x32_bf16 v[60:63], v[168:171], a[36:39], v[60:63]
    v_mfma_f32_16x16x32_bf16 v[116:119], v[172:175], a[36:39], v[116:119]
    s_add_u32 s47, s45, 92160
    v_mfma_f32_16x16x32_bf16 v[32:35], v[180:183], a[32:35], v[32:35]
    buffer_load_dwordx4 a[120:123], v4, s[16:19], s47 offen offset:0
    v_mfma_f32_16x16x32_bf16 v[60:63], v[184:187], a[32:35], v[60:63]
    v_mfma_f32_16x16x32_bf16 v[116:119], v[188:191], a[32:35], v[116:119]
    buffer_load_dwordx4 a[124:127], v4, s[16:19], s47 offen offset:1024
    v_mfma_f32_16x16x32_bf16 v[32:35], v[196:199], a[28:31], v[32:35]
    v_mfma_f32_16x16x32_bf16 v[60:63], v[200:203], a[28:31], v[60:63]
    buffer_load_dwordx4 a[128:131], v4, s[16:19], s47 offen offset:2048
    v_mfma_f32_16x16x32_bf16 v[116:119], v[204:207], a[28:31], v[116:119]
    v_mfma_f32_16x16x32_bf16 v[32:35], v[212:215], a[24:27], v[32:35]
    buffer_load_dwordx4 a[132:135], v4, s[16:19], s47 offen offset:3072
    v_mfma_f32_16x16x32_bf16 v[60:63], v[216:219], a[24:27], v[60:63]
    v_mfma_f32_16x16x32_bf16 v[116:119], v[220:223], a[24:27], v[116:119]
    s_waitcnt lgkmcnt(3)
    v_mfma_f32_16x16x32_bf16 v[32:35], v[228:231], a[20:23], v[32:35]
    v_mfma_f32_16x16x32_bf16 v[60:63], v[232:235], a[20:23], v[60:63]
    s_add_u32 m0, s42, 92160
    s_add_u32 s46, s43, 3547136
    s_mov_b64 exec, s[40:41]
    buffer_load_dwordx4 v3, s[12:15], s46 offen lds
    s_mov_b64 exec, -1
    v_mfma_f32_16x16x32_bf16 v[116:119], v[236:239], a[20:23], v[116:119]
    v_mfma_f32_16x16x32_bf16 v[32:35], a[216:219], a[96:99], v[32:35]
    v_mfma_f32_16x16x32_bf16 v[88:91], a[228:231], a[96:99], v[88:91]
    v_mfma_f32_16x16x32_bf16 v[116:119], a[224:227], a[96:99], v[116:119]
    v_mfma_f32_16x16x32_bf16 v[32:35], a[232:235], a[92:95], v[32:35]
    s_add_u32 m0, s42, 96000
    s_add_u32 s46, s43, 4726784
    s_mov_b64 exec, s[40:41]
    buffer_load_dwordx4 v3, s[12:15], s46 offen lds
    s_mov_b64 exec, -1
    v_mfma_f32_16x16x32_bf16 v[88:91], a[244:247], a[92:95], v[88:91]
    v_mfma_f32_16x16x32_bf16 v[116:119], a[240:243], a[92:95], v[116:119]
    v_mfma_f32_16x16x32_bf16 v[32:35], a[248:251], a[88:91], v[32:35]
    v_mfma_f32_16x16x32_bf16 v[88:91], v[172:175], a[88:91], v[88:91]
    v_mfma_f32_16x16x32_bf16 v[116:119], v[168:171], a[88:91], v[116:119]
    s_add_u32 m0, s42, 99840
    s_add_u32 s46, s43, 5906432
    s_mov_b64 exec, s[40:41]
    buffer_load_dwordx4 v3, s[12:15], s46 offen lds
    s_mov_b64 exec, -1
    v_mfma_f32_16x16x32_bf16 v[32:35], v[176:179], a[84:87], v[32:35]
    v_mfma_f32_16x16x32_bf16 v[88:91], v[188:191], a[84:87], v[88:91]
    v_mfma_f32_16x16x32_bf16 v[116:119], v[184:187], a[84:87], v[116:119]
    v_mfma_f32_16x16x32_bf16 v[32:35], v[192:195], a[80:83], v[32:35]
    v_mfma_f32_16x16x32_bf16 v[88:91], v[204:207], a[80:83], v[88:91]
    v_mfma_f32_16x16x32_bf16 v[116:119], v[200:203], a[80:83], v[116:119]
    v_mfma_f32_16x16x32_bf16 v[32:35], v[208:211], a[76:79], v[32:35]
    v_mfma_f32_16x16x32_bf16 v[88:91], v[220:223], a[76:79], v[88:91]
    v_mfma_f32_16x16x32_bf16 v[116:119], v[216:219], a[76:79], v[116:119]
    s_waitcnt lgkmcnt(2)
    v_mfma_f32_16x16x32_bf16 v[32:35], v[224:227], a[72:75], v[32:35]
    v_mfma_f32_16x16x32_bf16 v[88:91], v[236:239], a[72:75], v[88:91]
    v_mfma_f32_16x16x32_bf16 v[116:119], v[232:235], a[72:75], v[116:119]
    v_mfma_f32_16x16x32_bf16 v[28:31], a[220:223], a[40:43], v[28:31]
    v_mfma_f32_16x16x32_bf16 v[56:59], a[224:227], a[40:43], v[56:59]
    v_mfma_f32_16x16x32_bf16 v[112:115], a[228:231], a[40:43], v[112:115]
    ds_read_b128 a[12:15], v6 offset:480
    v_mfma_f32_16x16x32_bf16 v[28:31], a[236:239], a[36:39], v[28:31]
    v_mfma_f32_16x16x32_bf16 v[56:59], a[240:243], a[36:39], v[56:59]
    v_mfma_f32_16x16x32_bf16 v[112:115], a[244:247], a[36:39], v[112:115]
    ds_read_b128 a[64:67], v6 offset:544
    v_mfma_f32_16x16x32_bf16 v[28:31], a[252:255], a[32:35], v[28:31]
    v_mfma_f32_16x16x32_bf16 v[56:59], v[168:171], a[32:35], v[56:59]
    v_mfma_f32_16x16x32_bf16 v[112:115], v[172:175], a[32:35], v[112:115]
    s_add_u32 s47, s45, 98304
    v_mfma_f32_16x16x32_bf16 v[28:31], v[180:183], a[28:31], v[28:31]
    buffer_load_dwordx4 a[136:139], v4, s[16:19], s47 offen offset:0
    v_mfma_f32_16x16x32_bf16 v[56:59], v[184:187], a[28:31], v[56:59]
    v_mfma_f32_16x16x32_bf16 v[112:115], v[188:191], a[28:31], v[112:115]
    buffer_load_dwordx4 a[140:143], v4, s[16:19], s47 offen offset:1024
    v_mfma_f32_16x16x32_bf16 v[28:31], v[196:199], a[24:27], v[28:31]
    v_mfma_f32_16x16x32_bf16 v[56:59], v[200:203], a[24:27], v[56:59]
    buffer_load_dwordx4 a[144:147], v4, s[16:19], s47 offen offset:2048
    v_mfma_f32_16x16x32_bf16 v[112:115], v[204:207], a[24:27], v[112:115]
    v_mfma_f32_16x16x32_bf16 v[28:31], v[212:215], a[20:23], v[28:31]
    buffer_load_dwordx4 a[148:151], v4, s[16:19], s47 offen offset:3072
    v_mfma_f32_16x16x32_bf16 v[56:59], v[216:219], a[20:23], v[56:59]
    v_mfma_f32_16x16x32_bf16 v[112:115], v[220:223], a[20:23], v[112:115]
    s_waitcnt lgkmcnt(3)
    v_mfma_f32_16x16x32_bf16 v[28:31], v[228:231], a[16:19], v[28:31]
    v_mfma_f32_16x16x32_bf16 v[56:59], v[232:235], a[16:19], v[56:59]
    s_add_u32 m0, s42, 103680
    s_add_u32 s46, s43, 7086080
    s_mov_b64 exec, s[40:41]
    buffer_load_dwordx4 v3, s[12:15], s46 offen lds
    s_mov_b64 exec, -1
    v_mfma_f32_16x16x32_bf16 v[112:115], v[236:239], a[16:19], v[112:115]
    v_mfma_f32_16x16x32_bf16 v[28:31], a[216:219], a[92:95], v[28:31]
    v_mfma_f32_16x16x32_bf16 v[84:87], a[228:231], a[92:95], v[84:87]
    v_mfma_f32_16x16x32_bf16 v[112:115], a[224:227], a[92:95], v[112:115]
    v_mfma_f32_16x16x32_bf16 v[28:31], a[232:235], a[88:91], v[28:31]
    s_add_u32 m0, s42, 107520
    s_add_u32 s46, s43, 8265728
    s_mov_b64 exec, s[40:41]
    buffer_load_dwordx4 v3, s[12:15], s46 offen lds
    s_mov_b64 exec, -1
    v_mfma_f32_16x16x32_bf16 v[84:87], a[244:247], a[88:91], v[84:87]
    v_mfma_f32_16x16x32_bf16 v[112:115], a[240:243], a[88:91], v[112:115]
    v_mfma_f32_16x16x32_bf16 v[28:31], a[248:251], a[84:87], v[28:31]
    v_mfma_f32_16x16x32_bf16 v[84:87], v[172:175], a[84:87], v[84:87]
    v_mfma_f32_16x16x32_bf16 v[112:115], v[168:171], a[84:87], v[112:115]
    s_add_u32 m0, s42, 111360
    s_add_u32 s46, s43, 9445376
    s_mov_b64 exec, s[40:41]
    buffer_load_dwordx4 v3, s[12:15], s46 offen lds
    s_mov_b64 exec, -1
    v_mfma_f32_16x16x32_bf16 v[28:31], v[176:179], a[80:83], v[28:31]
    v_mfma_f32_16x16x32_bf16 v[84:87], v[188:191], a[80:83], v[84:87]
    v_mfma_f32_16x16x32_bf16 v[112:115], v[184:187], a[80:83], v[112:115]
    v_mfma_f32_16x16x32_bf16 v[28:31], v[192:195], a[76:79], v[28:31]
    v_mfma_f32_16x16x32_bf16 v[84:87], v[204:207], a[76:79], v[84:87]
    v_mfma_f32_16x16x32_bf16 v[112:115], v[200:203], a[76:79], v[112:115]
    v_mfma_f32_16x16x32_bf16 v[28:31], v[208:211], a[72:75], v[28:31]
    v_mfma_f32_16x16x32_bf16 v[84:87], v[220:223], a[72:75], v[84:87]
    v_mfma_f32_16x16x32_bf16 v[112:115], v[216:219], a[72:75], v[112:115]
    s_waitcnt lgkmcnt(2)
    v_mfma_f32_16x16x32_bf16 v[28:31], v[224:227], a[68:71], v[28:31]
    v_mfma_f32_16x16x32_bf16 v[84:87], v[236:239], a[68:71], v[84:87]
    v_mfma_f32_16x16x32_bf16 v[112:115], v[232:235], a[68:71], v[112:115]
    v_mfma_f32_16x16x32_bf16 v[24:27], a[220:223], a[36:39], v[24:27]
    v_mfma_f32_16x16x32_bf16 v[52:55], a[224:227], a[36:39], v[52:55]
    v_mfma_f32_16x16x32_bf16 v[108:111], a[228:231], a[36:39], v[108:111]
    ds_read_b128 a[8:11], v6 offset:320
    v_mfma_f32_16x16x32_bf16 v[24:27], a[236:239], a[32:35], v[24:27]
    v_mfma_f32_16x16x32_bf16 v[52:55], a[240:243], a[32:35], v[52:55]
    v_mfma_f32_16x16x32_bf16 v[108:111], a[244:247], a[32:35], v[108:111]
    ds_read_b128 a[60:63], v6 offset:384
    v_mfma_f32_16x16x32_bf16 v[24:27], a[252:255], a[28:31], v[24:27]
    v_mfma_f32_16x16x32_bf16 v[52:55], v[168:171], a[28:31], v[52:55]
    v_mfma_f32_16x16x32_bf16 v[108:111], v[172:175], a[28:31], v[108:111]
    s_add_u32 s47, s45, 104448
    v_mfma_f32_16x16x32_bf16 v[24:27], v[180:183], a[24:27], v[24:27]
    buffer_load_dwordx4 a[152:155], v4, s[16:19], s47 offen offset:0
    v_mfma_f32_16x16x32_bf16 v[52:55], v[184:187], a[24:27], v[52:55]
    v_mfma_f32_16x16x32_bf16 v[108:111], v[188:191], a[24:27], v[108:111]
    buffer_load_dwordx4 a[156:159], v4, s[16:19], s47 offen offset:1024
    v_mfma_f32_16x16x32_bf16 v[24:27], v[196:199], a[20:23], v[24:27]
    v_mfma_f32_16x16x32_bf16 v[52:55], v[200:203], a[20:23], v[52:55]
    buffer_load_dwordx4 a[160:163], v4, s[16:19], s47 offen offset:2048
    v_mfma_f32_16x16x32_bf16 v[108:111], v[204:207], a[20:23], v[108:111]
    v_mfma_f32_16x16x32_bf16 v[24:27], v[212:215], a[16:19], v[24:27]
    buffer_load_dwordx4 a[164:167], v4, s[16:19], s47 offen offset:3072
    v_mfma_f32_16x16x32_bf16 v[52:55], v[216:219], a[16:19], v[52:55]
    v_mfma_f32_16x16x32_bf16 v[108:111], v[220:223], a[16:19], v[108:111]
    s_waitcnt lgkmcnt(3)
    v_mfma_f32_16x16x32_bf16 v[24:27], v[228:231], a[12:15], v[24:27]
    v_mfma_f32_16x16x32_bf16 v[52:55], v[232:235], a[12:15], v[52:55]
    v_mfma_f32_16x16x32_bf16 v[108:111], v[236:239], a[12:15], v[108:111]
    v_mfma_f32_16x16x32_bf16 v[24:27], a[216:219], a[88:91], v[24:27]
    v_mfma_f32_16x16x32_bf16 v[80:83], a[228:231], a[88:91], v[80:83]
    v_mfma_f32_16x16x32_bf16 v[108:111], a[224:227], a[88:91], v[108:111]
    v_mfma_f32_16x16x32_bf16 v[24:27], a[232:235], a[84:87], v[24:27]
    v_mfma_f32_16x16x32_bf16 v[80:83], a[244:247], a[84:87], v[80:83]
    v_mfma_f32_16x16x32_bf16 v[108:111], a[240:243], a[84:87], v[108:111]
    v_mfma_f32_16x16x32_bf16 v[24:27], a[248:251], a[80:83], v[24:27]
    v_mfma_f32_16x16x32_bf16 v[80:83], v[172:175], a[80:83], v[80:83]
    v_mfma_f32_16x16x32_bf16 v[108:111], v[168:171], a[80:83], v[108:111]
    v_mfma_f32_16x16x32_bf16 v[24:27], v[176:179], a[76:79], v[24:27]
    v_mfma_f32_16x16x32_bf16 v[80:83], v[188:191], a[76:79], v[80:83]
    v_mfma_f32_16x16x32_bf16 v[108:111], v[184:187], a[76:79], v[108:111]
    v_mfma_f32_16x16x32_bf16 v[24:27], v[192:195], a[72:75], v[24:27]
    v_mfma_f32_16x16x32_bf16 v[80:83], v[204:207], a[72:75], v[80:83]
    v_mfma_f32_16x16x32_bf16 v[108:111], v[200:203], a[72:75], v[108:111]
    v_mfma_f32_16x16x32_bf16 v[24:27], v[208:211], a[68:71], v[24:27]
    v_mfma_f32_16x16x32_bf16 v[80:83], v[220:223], a[68:71], v[80:83]
    v_mfma_f32_16x16x32_bf16 v[108:111], v[216:219], a[68:71], v[108:111]
    s_waitcnt lgkmcnt(2)
    v_mfma_f32_16x16x32_bf16 v[24:27], v[224:227], a[64:67], v[24:27]
    v_mfma_f32_16x16x32_bf16 v[80:83], v[236:239], a[64:67], v[80:83]
    v_mfma_f32_16x16x32_bf16 v[108:111], v[232:235], a[64:67], v[108:111]
    v_mfma_f32_16x16x32_bf16 v[20:23], a[220:223], a[32:35], v[20:23]
    v_mfma_f32_16x16x32_bf16 v[48:51], a[224:227], a[32:35], v[48:51]
    v_mfma_f32_16x16x32_bf16 v[104:107], a[228:231], a[32:35], v[104:107]
    ds_read_b128 a[4:7], v6 offset:160
    v_mfma_f32_16x16x32_bf16 v[20:23], a[236:239], a[28:31], v[20:23]
    v_mfma_f32_16x16x32_bf16 v[48:51], a[240:243], a[28:31], v[48:51]
    v_mfma_f32_16x16x32_bf16 v[104:107], a[244:247], a[28:31], v[104:107]
    ds_read_b128 a[56:59], v6 offset:224
    v_mfma_f32_16x16x32_bf16 v[20:23], a[252:255], a[24:27], v[20:23]
    v_mfma_f32_16x16x32_bf16 v[48:51], v[168:171], a[24:27], v[48:51]
    v_mfma_f32_16x16x32_bf16 v[104:107], v[172:175], a[24:27], v[104:107]
    s_add_u32 s47, s45, 110592
    v_mfma_f32_16x16x32_bf16 v[20:23], v[180:183], a[20:23], v[20:23]
    buffer_load_dwordx4 a[168:171], v4, s[16:19], s47 offen offset:0
    v_mfma_f32_16x16x32_bf16 v[48:51], v[184:187], a[20:23], v[48:51]
    v_mfma_f32_16x16x32_bf16 v[104:107], v[188:191], a[20:23], v[104:107]
    buffer_load_dwordx4 a[172:175], v4, s[16:19], s47 offen offset:1024
    v_mfma_f32_16x16x32_bf16 v[20:23], v[196:199], a[16:19], v[20:23]
    v_mfma_f32_16x16x32_bf16 v[48:51], v[200:203], a[16:19], v[48:51]
    buffer_load_dwordx4 a[176:179], v4, s[16:19], s47 offen offset:2048
    v_mfma_f32_16x16x32_bf16 v[104:107], v[204:207], a[16:19], v[104:107]
    v_mfma_f32_16x16x32_bf16 v[20:23], v[212:215], a[12:15], v[20:23]
    buffer_load_dwordx4 a[180:183], v4, s[16:19], s47 offen offset:3072
    v_mfma_f32_16x16x32_bf16 v[48:51], v[216:219], a[12:15], v[48:51]
    v_mfma_f32_16x16x32_bf16 v[104:107], v[220:223], a[12:15], v[104:107]
    s_waitcnt lgkmcnt(3)
    v_mfma_f32_16x16x32_bf16 v[20:23], v[228:231], a[8:11], v[20:23]
    v_mfma_f32_16x16x32_bf16 v[48:51], v[232:235], a[8:11], v[48:51]
    v_mfma_f32_16x16x32_bf16 v[104:107], v[236:239], a[8:11], v[104:107]
    v_mfma_f32_16x16x32_bf16 v[20:23], a[216:219], a[84:87], v[20:23]
    v_mfma_f32_16x16x32_bf16 v[76:79], a[228:231], a[84:87], v[76:79]
    v_mfma_f32_16x16x32_bf16 v[104:107], a[224:227], a[84:87], v[104:107]
    v_mfma_f32_16x16x32_bf16 v[20:23], a[232:235], a[80:83], v[20:23]
    v_mfma_f32_16x16x32_bf16 v[76:79], a[244:247], a[80:83], v[76:79]
    v_mfma_f32_16x16x32_bf16 v[104:107], a[240:243], a[80:83], v[104:107]
    v_mfma_f32_16x16x32_bf16 v[20:23], a[248:251], a[76:79], v[20:23]
    v_mfma_f32_16x16x32_bf16 v[76:79], v[172:175], a[76:79], v[76:79]
    v_mfma_f32_16x16x32_bf16 v[104:107], v[168:171], a[76:79], v[104:107]
    v_mfma_f32_16x16x32_bf16 v[20:23], v[176:179], a[72:75], v[20:23]
    v_mfma_f32_16x16x32_bf16 v[76:79], v[188:191], a[72:75], v[76:79]
    v_mfma_f32_16x16x32_bf16 v[104:107], v[184:187], a[72:75], v[104:107]
    v_mfma_f32_16x16x32_bf16 v[20:23], v[192:195], a[68:71], v[20:23]
    v_mfma_f32_16x16x32_bf16 v[76:79], v[204:207], a[68:71], v[76:79]
    v_mfma_f32_16x16x32_bf16 v[104:107], v[200:203], a[68:71], v[104:107]
    v_mfma_f32_16x16x32_bf16 v[20:23], v[208:211], a[64:67], v[20:23]
    v_mfma_f32_16x16x32_bf16 v[76:79], v[220:223], a[64:67], v[76:79]
    v_mfma_f32_16x16x32_bf16 v[104:107], v[216:219], a[64:67], v[104:107]
    s_waitcnt lgkmcnt(2)
    v_mfma_f32_16x16x32_bf16 v[20:23], v[224:227], a[60:63], v[20:23]
    v_mfma_f32_16x16x32_bf16 v[76:79], v[236:239], a[60:63], v[76:79]
    v_mfma_f32_16x16x32_bf16 v[104:107], v[232:235], a[60:63], v[104:107]
    v_mfma_f32_16x16x32_bf16 v[16:19], a[220:223], a[28:31], v[16:19]
    s_waitcnt vmcnt(8)
    s_barrier
    v_mfma_f32_16x16x32_bf16 v[44:47], a[224:227], a[28:31], v[44:47]
    v_mfma_f32_16x16x32_bf16 v[100:103], a[228:231], a[28:31], v[100:103]
    ds_read_b128 a[0:3], v6 offset:0
    v_mfma_f32_16x16x32_bf16 v[16:19], a[236:239], a[24:27], v[16:19]
    v_mfma_f32_16x16x32_bf16 v[44:47], a[240:243], a[24:27], v[44:47]
    v_mfma_f32_16x16x32_bf16 v[100:103], a[244:247], a[24:27], v[100:103]
    ds_read_b128 a[52:55], v6 offset:64
    v_mfma_f32_16x16x32_bf16 v[16:19], a[252:255], a[20:23], v[16:19]
    v_mfma_f32_16x16x32_bf16 v[44:47], v[168:171], a[20:23], v[44:47]
    v_mfma_f32_16x16x32_bf16 v[100:103], v[172:175], a[20:23], v[100:103]
    s_add_u32 s47, s45, 116736
    v_mfma_f32_16x16x32_bf16 v[16:19], v[180:183], a[16:19], v[16:19]
    buffer_load_dwordx4 a[184:187], v4, s[16:19], s47 offen offset:0
    v_mfma_f32_16x16x32_bf16 v[44:47], v[184:187], a[16:19], v[44:47]
    v_mfma_f32_16x16x32_bf16 v[100:103], v[188:191], a[16:19], v[100:103]
    buffer_load_dwordx4 a[188:191], v4, s[16:19], s47 offen offset:1024
    v_mfma_f32_16x16x32_bf16 v[16:19], v[196:199], a[12:15], v[16:19]
    v_mfma_f32_16x16x32_bf16 v[44:47], v[200:203], a[12:15], v[44:47]
    buffer_load_dwordx4 a[192:195], v4, s[16:19], s47 offen offset:2048
    v_mfma_f32_16x16x32_bf16 v[100:103], v[204:207], a[12:15], v[100:103]
    v_mfma_f32_16x16x32_bf16 v[16:19], v[212:215], a[8:11], v[16:19]
    buffer_load_dwordx4 a[196:199], v4, s[16:19], s47 offen offset:3072
    v_mfma_f32_16x16x32_bf16 v[44:47], v[216:219], a[8:11], v[44:47]
    v_mfma_f32_16x16x32_bf16 v[100:103], v[220:223], a[8:11], v[100:103]
    s_waitcnt lgkmcnt(3)
    v_mfma_f32_16x16x32_bf16 v[16:19], v[228:231], a[4:7], v[16:19]
    s_add_u32 s47, s45, 122880
    v_mfma_f32_16x16x32_bf16 v[44:47], v[232:235], a[4:7], v[44:47]
    buffer_load_dwordx4 a[200:203], v4, s[16:19], s47 offen offset:0
    v_mfma_f32_16x16x32_bf16 v[100:103], v[236:239], a[4:7], v[100:103]
    v_mfma_f32_16x16x32_bf16 v[16:19], a[216:219], a[80:83], v[16:19]
    buffer_load_dwordx4 a[204:207], v4, s[16:19], s47 offen offset:1024
    v_mfma_f32_16x16x32_bf16 v[72:75], a[228:231], a[80:83], v[72:75]
    v_mfma_f32_16x16x32_bf16 v[100:103], a[224:227], a[80:83], v[100:103]
    buffer_load_dwordx4 a[208:211], v4, s[16:19], s47 offen offset:2048
    v_mfma_f32_16x16x32_bf16 v[16:19], a[232:235], a[76:79], v[16:19]
    v_mfma_f32_16x16x32_bf16 v[72:75], a[244:247], a[76:79], v[72:75]
    buffer_load_dwordx4 a[212:215], v4, s[16:19], s47 offen offset:3072
    v_mfma_f32_16x16x32_bf16 v[100:103], a[240:243], a[76:79], v[100:103]
    v_mfma_f32_16x16x32_bf16 v[16:19], a[248:251], a[72:75], v[16:19]
    ds_read_b128 a[48:51], v7 offset:1920
    v_mfma_f32_16x16x32_bf16 v[72:75], v[172:175], a[72:75], v[72:75]
    ds_read_b128 a[100:103], v7 offset:1984
    v_mfma_f32_16x16x32_bf16 v[100:103], v[168:171], a[72:75], v[100:103]
    ds_read_b128 a[44:47], v7 offset:1760
    v_mfma_f32_16x16x32_bf16 v[16:19], v[176:179], a[68:71], v[16:19]
    ds_read_b128 a[96:99], v7 offset:1824
    v_mfma_f32_16x16x32_bf16 v[72:75], v[188:191], a[68:71], v[72:75]
    ds_read_b128 a[40:43], v7 offset:1600
    v_mfma_f32_16x16x32_bf16 v[100:103], v[184:187], a[68:71], v[100:103]
    ds_read_b128 a[92:95], v7 offset:1664
    v_mfma_f32_16x16x32_bf16 v[16:19], v[192:195], a[64:67], v[16:19]
    ds_read_b128 a[36:39], v7 offset:1440
    v_mfma_f32_16x16x32_bf16 v[72:75], v[204:207], a[64:67], v[72:75]
    ds_read_b128 a[88:91], v7 offset:1504
    v_mfma_f32_16x16x32_bf16 v[100:103], v[200:203], a[64:67], v[100:103]
    ds_read_b128 a[32:35], v7 offset:1280
    v_mfma_f32_16x16x32_bf16 v[16:19], v[208:211], a[60:63], v[16:19]
    ds_read_b128 a[84:87], v7 offset:1344
    v_mfma_f32_16x16x32_bf16 v[72:75], v[220:223], a[60:63], v[72:75]
    v_mfma_f32_16x16x32_bf16 v[100:103], v[216:219], a[60:63], v[100:103]
    s_waitcnt lgkmcnt(12)
    v_mfma_f32_16x16x32_bf16 v[16:19], v[224:227], a[56:59], v[16:19]
    v_mfma_f32_16x16x32_bf16 v[72:75], v[236:239], a[56:59], v[72:75]
    v_mfma_f32_16x16x32_bf16 v[100:103], v[232:235], a[56:59], v[100:103]
    v_mfma_f32_16x16x32_bf16 v[12:15], a[220:223], a[24:27], v[12:15]
    v_mfma_f32_16x16x32_bf16 v[40:43], a[224:227], a[24:27], v[40:43]
    v_mfma_f32_16x16x32_bf16 v[96:99], a[228:231], a[24:27], v[96:99]
    ds_read_b128 a[24:27], v7 offset:960
    v_mfma_f32_16x16x32_bf16 v[12:15], a[236:239], a[20:23], v[12:15]
    v_mfma_f32_16x16x32_bf16 v[40:43], a[240:243], a[20:23], v[40:43]
    v_mfma_f32_16x16x32_bf16 v[96:99], a[244:247], a[20:23], v[96:99]
    v_mfma_f32_16x16x32_bf16 v[12:15], a[252:255], a[16:19], v[12:15]
    v_mfma_f32_16x16x32_bf16 v[40:43], v[168:171], a[16:19], v[40:43]
    v_mfma_f32_16x16x32_bf16 v[96:99], v[172:175], a[16:19], v[96:99]
    ds_read_b128 a[28:31], v7 offset:1120
    v_mfma_f32_16x16x32_bf16 v[12:15], v[180:183], a[12:15], v[12:15]
    ds_read_b128 a[80:83], v7 offset:1184
    v_mfma_f32_16x16x32_bf16 v[40:43], v[184:187], a[12:15], v[40:43]
    v_mfma_f32_16x16x32_bf16 v[96:99], v[188:191], a[12:15], v[96:99]
    v_mfma_f32_16x16x32_bf16 v[12:15], v[196:199], a[8:11], v[12:15]
    v_mfma_f32_16x16x32_bf16 v[40:43], v[200:203], a[8:11], v[40:43]
    v_mfma_f32_16x16x32_bf16 v[96:99], v[204:207], a[8:11], v[96:99]
    v_mfma_f32_16x16x32_bf16 v[12:15], v[212:215], a[4:7], v[12:15]
    v_mfma_f32_16x16x32_bf16 v[40:43], v[216:219], a[4:7], v[40:43]
    v_mfma_f32_16x16x32_bf16 v[96:99], v[220:223], a[4:7], v[96:99]
    s_waitcnt lgkmcnt(14)
    v_mfma_f32_16x16x32_bf16 v[12:15], v[228:231], a[0:3], v[12:15]
    v_mfma_f32_16x16x32_bf16 v[40:43], v[232:235], a[0:3], v[40:43]
    v_mfma_f32_16x16x32_bf16 v[96:99], v[236:239], a[0:3], v[96:99]
    v_mfma_f32_16x16x32_bf16 v[12:15], a[216:219], a[76:79], v[12:15]
    v_mfma_f32_16x16x32_bf16 v[68:71], a[228:231], a[76:79], v[68:71]
    v_mfma_f32_16x16x32_bf16 v[96:99], a[224:227], a[76:79], v[96:99]
    ds_read_b128 a[76:79], v7 offset:1024
    v_mfma_f32_16x16x32_bf16 v[12:15], a[232:235], a[72:75], v[12:15]
    v_mfma_f32_16x16x32_bf16 v[68:71], a[244:247], a[72:75], v[68:71]
    v_mfma_f32_16x16x32_bf16 v[96:99], a[240:243], a[72:75], v[96:99]
    v_mfma_f32_16x16x32_bf16 v[12:15], a[248:251], a[68:71], v[12:15]
    v_mfma_f32_16x16x32_bf16 v[68:71], v[172:175], a[68:71], v[68:71]
    v_mfma_f32_16x16x32_bf16 v[96:99], v[168:171], a[68:71], v[96:99]
    v_mfma_f32_16x16x32_bf16 v[12:15], v[176:179], a[64:67], v[12:15]
    v_mfma_f32_16x16x32_bf16 v[68:71], v[188:191], a[64:67], v[68:71]
    v_mfma_f32_16x16x32_bf16 v[96:99], v[184:187], a[64:67], v[96:99]
    v_mfma_f32_16x16x32_bf16 v[12:15], v[192:195], a[60:63], v[12:15]
    v_mfma_f32_16x16x32_bf16 v[68:71], v[204:207], a[60:63], v[68:71]
    v_mfma_f32_16x16x32_bf16 v[96:99], v[200:203], a[60:63], v[96:99]
    v_mfma_f32_16x16x32_bf16 v[12:15], v[208:211], a[56:59], v[12:15]
    v_mfma_f32_16x16x32_bf16 v[68:71], v[220:223], a[56:59], v[68:71]
    v_mfma_f32_16x16x32_bf16 v[96:99], v[216:219], a[56:59], v[96:99]
    s_waitcnt lgkmcnt(14)
    v_mfma_f32_16x16x32_bf16 v[12:15], v[224:227], a[52:55], v[12:15]
    v_mfma_f32_16x16x32_bf16 v[68:71], v[236:239], a[52:55], v[68:71]
    v_mfma_f32_16x16x32_bf16 v[96:99], v[232:235], a[52:55], v[96:99]
    s_waitcnt lgkmcnt(13)
    v_mfma_f32_16x16x32_bf16 v[36:39], a[108:111], a[48:51], v[36:39]
    v_mfma_f32_16x16x32_bf16 v[64:67], a[112:115], a[48:51], v[64:67]
    v_mfma_f32_16x16x32_bf16 v[120:123], a[116:119], a[48:51], v[120:123]
    ds_read_b128 a[20:23], v7 offset:800
    s_waitcnt lgkmcnt(12)
    v_mfma_f32_16x16x32_bf16 v[36:39], a[124:127], a[44:47], v[36:39]
    v_mfma_f32_16x16x32_bf16 v[64:67], a[128:131], a[44:47], v[64:67]
    v_mfma_f32_16x16x32_bf16 v[120:123], a[132:135], a[44:47], v[120:123]
    ds_read_b128 a[72:75], v7 offset:864
    s_waitcnt lgkmcnt(11)
    v_mfma_f32_16x16x32_bf16 v[36:39], a[140:143], a[40:43], v[36:39]
    v_mfma_f32_16x16x32_bf16 v[64:67], a[144:147], a[40:43], v[64:67]
    v_mfma_f32_16x16x32_bf16 v[120:123], a[148:151], a[40:43], v[120:123]
    s_waitcnt vmcnt(14)
    s_waitcnt lgkmcnt(9)
    v_mfma_f32_16x16x32_bf16 v[36:39], a[156:159], a[36:39], v[36:39]
    s_waitcnt vmcnt(13)
    v_mfma_f32_16x16x32_bf16 v[64:67], a[160:163], a[36:39], v[64:67]
    s_waitcnt vmcnt(12)
    v_mfma_f32_16x16x32_bf16 v[120:123], a[164:167], a[36:39], v[120:123]
    s_waitcnt vmcnt(10)
    s_waitcnt lgkmcnt(7)
    v_mfma_f32_16x16x32_bf16 v[36:39], a[172:175], a[32:35], v[36:39]
    s_waitcnt vmcnt(9)
    v_mfma_f32_16x16x32_bf16 v[64:67], a[176:179], a[32:35], v[64:67]
    s_waitcnt vmcnt(8)
    v_mfma_f32_16x16x32_bf16 v[120:123], a[180:183], a[32:35], v[120:123]
    s_waitcnt vmcnt(6)
    s_waitcnt lgkmcnt(4)
    v_mfma_f32_16x16x32_bf16 v[36:39], a[188:191], a[28:31], v[36:39]
    s_waitcnt vmcnt(5)
    v_mfma_f32_16x16x32_bf16 v[64:67], a[192:195], a[28:31], v[64:67]
    s_waitcnt vmcnt(4)
    v_mfma_f32_16x16x32_bf16 v[120:123], a[196:199], a[28:31], v[120:123]
    s_waitcnt vmcnt(2)
    v_mfma_f32_16x16x32_bf16 v[36:39], a[204:207], a[24:27], v[36:39]
    s_waitcnt vmcnt(1)
    v_mfma_f32_16x16x32_bf16 v[64:67], a[208:211], a[24:27], v[64:67]
    s_waitcnt vmcnt(0)
    v_mfma_f32_16x16x32_bf16 v[120:123], a[212:215], a[24:27], v[120:123]
    v_mfma_f32_16x16x32_bf16 v[36:39], a[104:107], a[100:103], v[36:39]
    v_mfma_f32_16x16x32_bf16 v[92:95], a[116:119], a[100:103], v[92:95]
    v_mfma_f32_16x16x32_bf16 v[120:123], a[112:115], a[100:103], v[120:123]
    v_mfma_f32_16x16x32_bf16 v[36:39], a[120:123], a[96:99], v[36:39]
    v_mfma_f32_16x16x32_bf16 v[92:95], a[132:135], a[96:99], v[92:95]
    v_mfma_f32_16x16x32_bf16 v[120:123], a[128:131], a[96:99], v[120:123]
    v_mfma_f32_16x16x32_bf16 v[36:39], a[136:139], a[92:95], v[36:39]
    v_mfma_f32_16x16x32_bf16 v[92:95], a[148:151], a[92:95], v[92:95]
    v_mfma_f32_16x16x32_bf16 v[120:123], a[144:147], a[92:95], v[120:123]
    v_mfma_f32_16x16x32_bf16 v[36:39], a[152:155], a[88:91], v[36:39]
    v_mfma_f32_16x16x32_bf16 v[92:95], a[164:167], a[88:91], v[92:95]
    v_mfma_f32_16x16x32_bf16 v[120:123], a[160:163], a[88:91], v[120:123]
    v_mfma_f32_16x16x32_bf16 v[36:39], a[168:171], a[84:87], v[36:39]
    v_mfma_f32_16x16x32_bf16 v[92:95], a[180:183], a[84:87], v[92:95]
    v_mfma_f32_16x16x32_bf16 v[120:123], a[176:179], a[84:87], v[120:123]
    s_waitcnt lgkmcnt(3)
    v_mfma_f32_16x16x32_bf16 v[36:39], a[184:187], a[80:83], v[36:39]
    v_mfma_f32_16x16x32_bf16 v[92:95], a[196:199], a[80:83], v[92:95]
    v_mfma_f32_16x16x32_bf16 v[120:123], a[192:195], a[80:83], v[120:123]
    s_waitcnt lgkmcnt(2)
    v_mfma_f32_16x16x32_bf16 v[36:39], a[200:203], a[76:79], v[36:39]
    v_mfma_f32_16x16x32_bf16 v[92:95], a[212:215], a[76:79], v[92:95]
    v_mfma_f32_16x16x32_bf16 v[120:123], a[208:211], a[76:79], v[120:123]
    v_mfma_f32_16x16x32_bf16 v[32:35], a[108:111], a[44:47], v[32:35]
    v_mfma_f32_16x16x32_bf16 v[60:63], a[112:115], a[44:47], v[60:63]
    v_mfma_f32_16x16x32_bf16 v[116:119], a[116:119], a[44:47], v[116:119]
    ds_read_b128 a[16:19], v7 offset:640
    v_mfma_f32_16x16x32_bf16 v[32:35], a[124:127], a[40:43], v[32:35]
    v_mfma_f32_16x16x32_bf16 v[60:63], a[128:131], a[40:43], v[60:63]
    v_mfma_f32_16x16x32_bf16 v[116:119], a[132:135], a[40:43], v[116:119]
    ds_read_b128 a[68:71], v7 offset:704
    v_mfma_f32_16x16x32_bf16 v[32:35], a[140:143], a[36:39], v[32:35]
    v_mfma_f32_16x16x32_bf16 v[60:63], a[144:147], a[36:39], v[60:63]
    v_sub_f32 v64, v64, v92
    v_mfma_f32_16x16x32_bf16 v[116:119], a[148:151], a[36:39], v[116:119]
    v_sub_f32 v65, v65, v93
    v_mfma_f32_16x16x32_bf16 v[32:35], a[156:159], a[32:35], v[32:35]
    v_sub_f32 v66, v66, v94
    v_mfma_f32_16x16x32_bf16 v[60:63], a[160:163], a[32:35], v[60:63]
    v_sub_f32 v67, v67, v95
    v_mfma_f32_16x16x32_bf16 v[116:119], a[164:167], a[32:35], v[116:119]
    v_cvt_pk_bf16_f32 v152, v64, v65
    v_mfma_f32_16x16x32_bf16 v[32:35], a[172:175], a[28:31], v[32:35]
    v_cvt_pk_bf16_f32 v153, v66, v67
    v_mfma_f32_16x16x32_bf16 v[60:63], a[176:179], a[28:31], v[60:63]
    v_cvt_pk_bf16_f32 v154, v120, v121
    v_mfma_f32_16x16x32_bf16 v[116:119], a[180:183], a[28:31], v[116:119]
    v_cvt_pk_bf16_f32 v155, v122, v123
    v_mfma_f32_16x16x32_bf16 v[32:35], a[188:191], a[24:27], v[32:35]
    s_mov_b32 s48, 294912
    v_mfma_f32_16x16x32_bf16 v[60:63], a[192:195], a[24:27], v[60:63]
    buffer_store_dwordx4 v[152:155], v9, s[20:23], s48 offen offset:128 sc1
    v_mfma_f32_16x16x32_bf16 v[116:119], a[196:199], a[24:27], v[116:119]
    s_waitcnt lgkmcnt(3)
    v_mfma_f32_16x16x32_bf16 v[32:35], a[204:207], a[20:23], v[32:35]
    v_mfma_f32_16x16x32_bf16 v[60:63], a[208:211], a[20:23], v[60:63]
    v_mfma_f32_16x16x32_bf16 v[116:119], a[212:215], a[20:23], v[116:119]
    v_mfma_f32_16x16x32_bf16 v[32:35], a[104:107], a[96:99], v[32:35]
    v_cvt_pk_bf16_f32 v39, v38, v39
    v_mfma_f32_16x16x32_bf16 v[88:91], a[116:119], a[96:99], v[88:91]
    v_cvt_pk_bf16_f32 v38, v36, v37
    v_mfma_f32_16x16x32_bf16 v[116:119], a[112:115], a[96:99], v[116:119]
    v_mfma_f32_16x16x32_bf16 v[32:35], a[120:123], a[92:95], v[32:35]
    v_mfma_f32_16x16x32_bf16 v[88:91], a[132:135], a[92:95], v[88:91]
    v_mfma_f32_16x16x32_bf16 v[116:119], a[128:131], a[92:95], v[116:119]
    v_mfma_f32_16x16x32_bf16 v[32:35], a[136:139], a[88:91], v[32:35]
    s_waitcnt lgkmcnt(0)
    s_barrier
    v_mfma_f32_16x16x32_bf16 v[88:91], a[148:151], a[88:91], v[88:91]
    ds_read_b64 v[36:37], v10 offset:3072
    v_mfma_f32_16x16x32_bf16 v[116:119], a[144:147], a[88:91], v[116:119]
    v_mfma_f32_16x16x32_bf16 v[32:35], a[152:155], a[84:87], v[32:35]
    v_mfma_f32_16x16x32_bf16 v[88:91], a[164:167], a[84:87], v[88:91]
    v_mfma_f32_16x16x32_bf16 v[116:119], a[160:163], a[84:87], v[116:119]
    v_mfma_f32_16x16x32_bf16 v[32:35], a[168:171], a[80:83], v[32:35]
    v_mfma_f32_16x16x32_bf16 v[88:91], a[180:183], a[80:83], v[88:91]
    s_mov_b32 s47, 294912
    v_mfma_f32_16x16x32_bf16 v[116:119], a[176:179], a[80:83], v[116:119]
    s_waitcnt lgkmcnt(0)
    buffer_store_dwordx4 v[36:39], v9, s[20:23], s47 offen offset:64 sc1
    v_mfma_f32_16x16x32_bf16 v[32:35], a[184:187], a[76:79], v[32:35]
    v_mfma_f32_16x16x32_bf16 v[88:91], a[196:199], a[76:79], v[88:91]
    v_mfma_f32_16x16x32_bf16 v[116:119], a[192:195], a[76:79], v[116:119]
    v_mfma_f32_16x16x32_bf16 v[32:35], a[200:203], a[72:75], v[32:35]
    v_mfma_f32_16x16x32_bf16 v[88:91], a[212:215], a[72:75], v[88:91]
    v_mfma_f32_16x16x32_bf16 v[116:119], a[208:211], a[72:75], v[116:119]
    v_mfma_f32_16x16x32_bf16 v[28:31], a[108:111], a[40:43], v[28:31]
    v_mfma_f32_16x16x32_bf16 v[56:59], a[112:115], a[40:43], v[56:59]
    v_mfma_f32_16x16x32_bf16 v[112:115], a[116:119], a[40:43], v[112:115]
    ds_read_b128 a[12:15], v7 offset:480
    v_mfma_f32_16x16x32_bf16 v[28:31], a[124:127], a[36:39], v[28:31]
    v_mfma_f32_16x16x32_bf16 v[56:59], a[128:131], a[36:39], v[56:59]
    v_mfma_f32_16x16x32_bf16 v[112:115], a[132:135], a[36:39], v[112:115]
    ds_read_b128 a[64:67], v7 offset:544
    v_mfma_f32_16x16x32_bf16 v[28:31], a[140:143], a[32:35], v[28:31]
    v_mfma_f32_16x16x32_bf16 v[56:59], a[144:147], a[32:35], v[56:59]
    v_sub_f32 v60, v60, v88
    v_mfma_f32_16x16x32_bf16 v[112:115], a[148:151], a[32:35], v[112:115]
    v_sub_f32 v61, v61, v89
    v_mfma_f32_16x16x32_bf16 v[28:31], a[156:159], a[28:31], v[28:31]
    v_sub_f32 v62, v62, v90
    v_mfma_f32_16x16x32_bf16 v[56:59], a[160:163], a[28:31], v[56:59]
    v_sub_f32 v63, v63, v91
    v_mfma_f32_16x16x32_bf16 v[112:115], a[164:167], a[28:31], v[112:115]
    v_cvt_pk_bf16_f32 v156, v60, v61
    v_mfma_f32_16x16x32_bf16 v[28:31], a[172:175], a[24:27], v[28:31]
    v_cvt_pk_bf16_f32 v157, v62, v63
    v_mfma_f32_16x16x32_bf16 v[56:59], a[176:179], a[24:27], v[56:59]
    v_cvt_pk_bf16_f32 v158, v116, v117
    v_mfma_f32_16x16x32_bf16 v[112:115], a[180:183], a[24:27], v[112:115]
    v_cvt_pk_bf16_f32 v159, v118, v119
    v_mfma_f32_16x16x32_bf16 v[28:31], a[188:191], a[20:23], v[28:31]
    s_mov_b32 s48, 245760
    v_mfma_f32_16x16x32_bf16 v[56:59], a[192:195], a[20:23], v[56:59]
    buffer_store_dwordx4 v[156:159], v9, s[20:23], s48 offen offset:128 sc1
    v_mfma_f32_16x16x32_bf16 v[112:115], a[196:199], a[20:23], v[112:115]
    v_mfma_f32_16x16x32_bf16 v[28:31], a[204:207], a[16:19], v[28:31]
    v_mfma_f32_16x16x32_bf16 v[56:59], a[208:211], a[16:19], v[56:59]
    v_mfma_f32_16x16x32_bf16 v[112:115], a[212:215], a[16:19], v[112:115]
    v_mfma_f32_16x16x32_bf16 v[28:31], a[104:107], a[92:95], v[28:31]
    v_cvt_pk_bf16_f32 v32, v32, v33
    v_mfma_f32_16x16x32_bf16 v[84:87], a[116:119], a[92:95], v[84:87]
    v_cvt_pk_bf16_f32 v33, v34, v35
    v_mfma_f32_16x16x32_bf16 v[112:115], a[112:115], a[92:95], v[112:115]
    ds_write_b64 v10, v[32:33] offset:2560
    v_mfma_f32_16x16x32_bf16 v[28:31], a[120:123], a[88:91], v[28:31]
    v_mfma_f32_16x16x32_bf16 v[84:87], a[132:135], a[88:91], v[84:87]
    v_mfma_f32_16x16x32_bf16 v[112:115], a[128:131], a[88:91], v[112:115]
    v_mfma_f32_16x16x32_bf16 v[28:31], a[136:139], a[84:87], v[28:31]
    s_waitcnt lgkmcnt(0)
    s_barrier
    v_mfma_f32_16x16x32_bf16 v[84:87], a[148:151], a[84:87], v[84:87]
    v_mfma_f32_16x16x32_bf16 v[112:115], a[144:147], a[84:87], v[112:115]
    v_mfma_f32_16x16x32_bf16 v[28:31], a[152:155], a[80:83], v[28:31]
    v_mfma_f32_16x16x32_bf16 v[84:87], a[164:167], a[80:83], v[84:87]
    v_mfma_f32_16x16x32_bf16 v[112:115], a[160:163], a[80:83], v[112:115]
    v_mfma_f32_16x16x32_bf16 v[28:31], a[168:171], a[76:79], v[28:31]
    v_mfma_f32_16x16x32_bf16 v[84:87], a[180:183], a[76:79], v[84:87]
    v_mfma_f32_16x16x32_bf16 v[112:115], a[176:179], a[76:79], v[112:115]
    v_mfma_f32_16x16x32_bf16 v[28:31], a[184:187], a[72:75], v[28:31]
    v_mfma_f32_16x16x32_bf16 v[84:87], a[196:199], a[72:75], v[84:87]
    v_mfma_f32_16x16x32_bf16 v[112:115], a[192:195], a[72:75], v[112:115]
    v_mfma_f32_16x16x32_bf16 v[28:31], a[200:203], a[68:71], v[28:31]
    v_mfma_f32_16x16x32_bf16 v[84:87], a[212:215], a[68:71], v[84:87]
    v_mfma_f32_16x16x32_bf16 v[112:115], a[208:211], a[68:71], v[112:115]
    v_mfma_f32_16x16x32_bf16 v[24:27], a[108:111], a[36:39], v[24:27]
    v_mfma_f32_16x16x32_bf16 v[52:55], a[112:115], a[36:39], v[52:55]
    v_mfma_f32_16x16x32_bf16 v[108:111], a[116:119], a[36:39], v[108:111]
    ds_read_b128 a[8:11], v7 offset:320
    v_mfma_f32_16x16x32_bf16 v[24:27], a[124:127], a[32:35], v[24:27]
    v_mfma_f32_16x16x32_bf16 v[52:55], a[128:131], a[32:35], v[52:55]
    v_mfma_f32_16x16x32_bf16 v[108:111], a[132:135], a[32:35], v[108:111]
    ds_read_b128 a[60:63], v7 offset:384
    v_mfma_f32_16x16x32_bf16 v[24:27], a[140:143], a[28:31], v[24:27]
    v_mfma_f32_16x16x32_bf16 v[52:55], a[144:147], a[28:31], v[52:55]
    v_sub_f32 v56, v56, v84
    v_mfma_f32_16x16x32_bf16 v[108:111], a[148:151], a[28:31], v[108:111]
    v_sub_f32 v57, v57, v85
    v_mfma_f32_16x16x32_bf16 v[24:27], a[156:159], a[24:27], v[24:27]
    v_sub_f32 v58, v58, v86
    v_mfma_f32_16x16x32_bf16 v[52:55], a[160:163], a[24:27], v[52:55]
    v_sub_f32 v59, v59, v87
    v_mfma_f32_16x16x32_bf16 v[108:111], a[164:167], a[24:27], v[108:111]
    v_cvt_pk_bf16_f32 v160, v56, v57
    v_mfma_f32_16x16x32_bf16 v[24:27], a[172:175], a[20:23], v[24:27]
    v_cvt_pk_bf16_f32 v161, v58, v59
    v_mfma_f32_16x16x32_bf16 v[52:55], a[176:179], a[20:23], v[52:55]
    v_cvt_pk_bf16_f32 v162, v112, v113
    v_mfma_f32_16x16x32_bf16 v[108:111], a[180:183], a[20:23], v[108:111]
    v_cvt_pk_bf16_f32 v163, v114, v115
    v_mfma_f32_16x16x32_bf16 v[24:27], a[188:191], a[16:19], v[24:27]
    s_mov_b32 s48, 196608
    v_mfma_f32_16x16x32_bf16 v[52:55], a[192:195], a[16:19], v[52:55]
    buffer_store_dwordx4 v[160:163], v9, s[20:23], s48 offen offset:128 sc1
    v_mfma_f32_16x16x32_bf16 v[108:111], a[196:199], a[16:19], v[108:111]
    v_mfma_f32_16x16x32_bf16 v[24:27], a[204:207], a[12:15], v[24:27]
    v_mfma_f32_16x16x32_bf16 v[52:55], a[208:211], a[12:15], v[52:55]
    v_mfma_f32_16x16x32_bf16 v[108:111], a[212:215], a[12:15], v[108:111]
    v_mfma_f32_16x16x32_bf16 v[24:27], a[104:107], a[88:91], v[24:27]
    v_cvt_pk_bf16_f32 v31, v30, v31
    v_mfma_f32_16x16x32_bf16 v[80:83], a[116:119], a[88:91], v[80:83]
    v_cvt_pk_bf16_f32 v30, v28, v29
    v_mfma_f32_16x16x32_bf16 v[108:111], a[112:115], a[88:91], v[108:111]
    v_mfma_f32_16x16x32_bf16 v[24:27], a[120:123], a[84:87], v[24:27]
    v_mfma_f32_16x16x32_bf16 v[80:83], a[132:135], a[84:87], v[80:83]
    v_mfma_f32_16x16x32_bf16 v[108:111], a[128:131], a[84:87], v[108:111]
    v_mfma_f32_16x16x32_bf16 v[24:27], a[136:139], a[80:83], v[24:27]
    s_waitcnt lgkmcnt(0)
    s_barrier
    v_mfma_f32_16x16x32_bf16 v[80:83], a[148:151], a[80:83], v[80:83]
    ds_read_b64 v[28:29], v10 offset:2048
    v_mfma_f32_16x16x32_bf16 v[108:111], a[144:147], a[80:83], v[108:111]
    v_mfma_f32_16x16x32_bf16 v[24:27], a[152:155], a[76:79], v[24:27]
    v_mfma_f32_16x16x32_bf16 v[80:83], a[164:167], a[76:79], v[80:83]
    v_mfma_f32_16x16x32_bf16 v[108:111], a[160:163], a[76:79], v[108:111]
    v_mfma_f32_16x16x32_bf16 v[24:27], a[168:171], a[72:75], v[24:27]
    v_mfma_f32_16x16x32_bf16 v[80:83], a[180:183], a[72:75], v[80:83]
    s_mov_b32 s47, 196608
    v_mfma_f32_16x16x32_bf16 v[108:111], a[176:179], a[72:75], v[108:111]
    s_waitcnt lgkmcnt(0)
    buffer_store_dwordx4 v[28:31], v9, s[20:23], s47 offen offset:64 sc1
    v_mfma_f32_16x16x32_bf16 v[24:27], a[184:187], a[68:71], v[24:27]
    v_mfma_f32_16x16x32_bf16 v[80:83], a[196:199], a[68:71], v[80:83]
    v_mfma_f32_16x16x32_bf16 v[108:111], a[192:195], a[68:71], v[108:111]
    v_mfma_f32_16x16x32_bf16 v[24:27], a[200:203], a[64:67], v[24:27]
    v_mfma_f32_16x16x32_bf16 v[80:83], a[212:215], a[64:67], v[80:83]
    v_mfma_f32_16x16x32_bf16 v[108:111], a[208:211], a[64:67], v[108:111]
    v_mfma_f32_16x16x32_bf16 v[20:23], a[108:111], a[32:35], v[20:23]
    v_mfma_f32_16x16x32_bf16 v[48:51], a[112:115], a[32:35], v[48:51]
    v_mfma_f32_16x16x32_bf16 v[104:107], a[116:119], a[32:35], v[104:107]
    ds_read_b128 a[4:7], v7 offset:160
    v_mfma_f32_16x16x32_bf16 v[20:23], a[124:127], a[28:31], v[20:23]
    v_mfma_f32_16x16x32_bf16 v[48:51], a[128:131], a[28:31], v[48:51]
    v_mfma_f32_16x16x32_bf16 v[104:107], a[132:135], a[28:31], v[104:107]
    ds_read_b128 a[56:59], v7 offset:224
    v_mfma_f32_16x16x32_bf16 v[20:23], a[140:143], a[24:27], v[20:23]
    v_mfma_f32_16x16x32_bf16 v[48:51], a[144:147], a[24:27], v[48:51]
    v_sub_f32 v52, v52, v80
    v_mfma_f32_16x16x32_bf16 v[104:107], a[148:151], a[24:27], v[104:107]
    v_sub_f32 v53, v53, v81
    v_mfma_f32_16x16x32_bf16 v[20:23], a[156:159], a[20:23], v[20:23]
    v_sub_f32 v54, v54, v82
    v_mfma_f32_16x16x32_bf16 v[48:51], a[160:163], a[20:23], v[48:51]
    v_sub_f32 v55, v55, v83
    v_mfma_f32_16x16x32_bf16 v[104:107], a[164:167], a[20:23], v[104:107]
    v_cvt_pk_bf16_f32 v164, v52, v53
    v_mfma_f32_16x16x32_bf16 v[20:23], a[172:175], a[16:19], v[20:23]
    v_cvt_pk_bf16_f32 v165, v54, v55
    v_mfma_f32_16x16x32_bf16 v[48:51], a[176:179], a[16:19], v[48:51]
    v_cvt_pk_bf16_f32 v166, v108, v109
    v_mfma_f32_16x16x32_bf16 v[104:107], a[180:183], a[16:19], v[104:107]
    v_cvt_pk_bf16_f32 v167, v110, v111
    v_mfma_f32_16x16x32_bf16 v[20:23], a[188:191], a[12:15], v[20:23]
    s_mov_b32 s48, 147456
    v_mfma_f32_16x16x32_bf16 v[48:51], a[192:195], a[12:15], v[48:51]
    buffer_store_dwordx4 v[164:167], v9, s[20:23], s48 offen offset:128 sc1
    v_mfma_f32_16x16x32_bf16 v[104:107], a[196:199], a[12:15], v[104:107]
    v_mfma_f32_16x16x32_bf16 v[20:23], a[204:207], a[8:11], v[20:23]
    v_mfma_f32_16x16x32_bf16 v[48:51], a[208:211], a[8:11], v[48:51]
    v_mfma_f32_16x16x32_bf16 v[104:107], a[212:215], a[8:11], v[104:107]
    v_mfma_f32_16x16x32_bf16 v[20:23], a[104:107], a[84:87], v[20:23]
    v_cvt_pk_bf16_f32 v24, v24, v25
    v_mfma_f32_16x16x32_bf16 v[76:79], a[116:119], a[84:87], v[76:79]
    v_cvt_pk_bf16_f32 v25, v26, v27
    v_mfma_f32_16x16x32_bf16 v[104:107], a[112:115], a[84:87], v[104:107]
    ds_write_b64 v10, v[24:25] offset:1536
    v_mfma_f32_16x16x32_bf16 v[20:23], a[120:123], a[80:83], v[20:23]
    v_mfma_f32_16x16x32_bf16 v[76:79], a[132:135], a[80:83], v[76:79]
    v_mfma_f32_16x16x32_bf16 v[104:107], a[128:131], a[80:83], v[104:107]
    v_mfma_f32_16x16x32_bf16 v[20:23], a[136:139], a[76:79], v[20:23]
    s_waitcnt lgkmcnt(0)
    s_barrier
    v_mfma_f32_16x16x32_bf16 v[76:79], a[148:151], a[76:79], v[76:79]
    v_mfma_f32_16x16x32_bf16 v[104:107], a[144:147], a[76:79], v[104:107]
    v_mfma_f32_16x16x32_bf16 v[20:23], a[152:155], a[72:75], v[20:23]
    v_mfma_f32_16x16x32_bf16 v[76:79], a[164:167], a[72:75], v[76:79]
    v_mfma_f32_16x16x32_bf16 v[104:107], a[160:163], a[72:75], v[104:107]
    v_mfma_f32_16x16x32_bf16 v[20:23], a[168:171], a[68:71], v[20:23]
    v_mfma_f32_16x16x32_bf16 v[76:79], a[180:183], a[68:71], v[76:79]
    v_mfma_f32_16x16x32_bf16 v[104:107], a[176:179], a[68:71], v[104:107]
    v_mfma_f32_16x16x32_bf16 v[20:23], a[184:187], a[64:67], v[20:23]
    v_mfma_f32_16x16x32_bf16 v[76:79], a[196:199], a[64:67], v[76:79]
    v_mfma_f32_16x16x32_bf16 v[104:107], a[192:195], a[64:67], v[104:107]
    v_mfma_f32_16x16x32_bf16 v[20:23], a[200:203], a[60:63], v[20:23]
    v_mfma_f32_16x16x32_bf16 v[76:79], a[212:215], a[60:63], v[76:79]
    v_mfma_f32_16x16x32_bf16 v[104:107], a[208:211], a[60:63], v[104:107]
    v_mfma_f32_16x16x32_bf16 v[16:19], a[108:111], a[28:31], v[16:19]
    v_mfma_f32_16x16x32_bf16 v[44:47], a[112:115], a[28:31], v[44:47]
    v_mfma_f32_16x16x32_bf16 v[100:103], a[116:119], a[28:31], v[100:103]
    ds_read_b128 a[0:3], v7 offset:0
    v_mfma_f32_16x16x32_bf16 v[16:19], a[124:127], a[24:27], v[16:19]
    v_mfma_f32_16x16x32_bf16 v[44:47], a[128:131], a[24:27], v[44:47]
    v_mfma_f32_16x16x32_bf16 v[100:103], a[132:135], a[24:27], v[100:103]
    ds_read_b128 a[52:55], v7 offset:64
    v_mfma_f32_16x16x32_bf16 v[16:19], a[140:143], a[20:23], v[16:19]
    v_mfma_f32_16x16x32_bf16 v[44:47], a[144:147], a[20:23], v[44:47]
    v_sub_f32 v48, v48, v76
    v_mfma_f32_16x16x32_bf16 v[100:103], a[148:151], a[20:23], v[100:103]
    v_sub_f32 v49, v49, v77
    v_mfma_f32_16x16x32_bf16 v[16:19], a[156:159], a[16:19], v[16:19]
    v_sub_f32 v50, v50, v78
    v_mfma_f32_16x16x32_bf16 v[44:47], a[160:163], a[16:19], v[44:47]
    v_sub_f32 v51, v51, v79
    v_mfma_f32_16x16x32_bf16 v[100:103], a[164:167], a[16:19], v[100:103]
    v_cvt_pk_bf16_f32 v152, v48, v49
    v_mfma_f32_16x16x32_bf16 v[16:19], a[172:175], a[12:15], v[16:19]
    v_cvt_pk_bf16_f32 v153, v50, v51
    v_mfma_f32_16x16x32_bf16 v[44:47], a[176:179], a[12:15], v[44:47]
    v_cvt_pk_bf16_f32 v154, v104, v105
    v_mfma_f32_16x16x32_bf16 v[100:103], a[180:183], a[12:15], v[100:103]
    v_cvt_pk_bf16_f32 v155, v106, v107
    v_mfma_f32_16x16x32_bf16 v[16:19], a[188:191], a[8:11], v[16:19]
    s_mov_b32 s48, 98304
    v_mfma_f32_16x16x32_bf16 v[44:47], a[192:195], a[8:11], v[44:47]
    buffer_store_dwordx4 v[152:155], v9, s[20:23], s48 offen offset:128 sc1
    v_mfma_f32_16x16x32_bf16 v[100:103], a[196:199], a[8:11], v[100:103]
    v_mfma_f32_16x16x32_bf16 v[16:19], a[204:207], a[4:7], v[16:19]
    v_mfma_f32_16x16x32_bf16 v[44:47], a[208:211], a[4:7], v[44:47]
    v_mfma_f32_16x16x32_bf16 v[100:103], a[212:215], a[4:7], v[100:103]
    v_mfma_f32_16x16x32_bf16 v[16:19], a[104:107], a[80:83], v[16:19]
    v_cvt_pk_bf16_f32 v23, v22, v23
    v_mfma_f32_16x16x32_bf16 v[72:75], a[116:119], a[80:83], v[72:75]
    v_cvt_pk_bf16_f32 v22, v20, v21
    v_mfma_f32_16x16x32_bf16 v[100:103], a[112:115], a[80:83], v[100:103]
    v_mfma_f32_16x16x32_bf16 v[16:19], a[120:123], a[76:79], v[16:19]
    v_mfma_f32_16x16x32_bf16 v[72:75], a[132:135], a[76:79], v[72:75]
    v_mfma_f32_16x16x32_bf16 v[100:103], a[128:131], a[76:79], v[100:103]
    v_mfma_f32_16x16x32_bf16 v[16:19], a[136:139], a[72:75], v[16:19]
    s_waitcnt lgkmcnt(0)
    s_barrier
    v_mfma_f32_16x16x32_bf16 v[72:75], a[148:151], a[72:75], v[72:75]
    ds_read_b64 v[20:21], v10 offset:1024
    v_mfma_f32_16x16x32_bf16 v[100:103], a[144:147], a[72:75], v[100:103]
    v_mfma_f32_16x16x32_bf16 v[16:19], a[152:155], a[68:71], v[16:19]
    v_mfma_f32_16x16x32_bf16 v[72:75], a[164:167], a[68:71], v[72:75]
    v_mfma_f32_16x16x32_bf16 v[100:103], a[160:163], a[68:71], v[100:103]
    v_mfma_f32_16x16x32_bf16 v[16:19], a[168:171], a[64:67], v[16:19]
    v_mfma_f32_16x16x32_bf16 v[72:75], a[180:183], a[64:67], v[72:75]
    s_mov_b32 s47, 98304
    v_mfma_f32_16x16x32_bf16 v[100:103], a[176:179], a[64:67], v[100:103]
    s_waitcnt lgkmcnt(0)
    buffer_store_dwordx4 v[20:23], v9, s[20:23], s47 offen offset:64 sc1
    v_mfma_f32_16x16x32_bf16 v[16:19], a[184:187], a[60:63], v[16:19]
    v_mfma_f32_16x16x32_bf16 v[72:75], a[196:199], a[60:63], v[72:75]
    v_mfma_f32_16x16x32_bf16 v[100:103], a[192:195], a[60:63], v[100:103]
    v_mfma_f32_16x16x32_bf16 v[16:19], a[200:203], a[56:59], v[16:19]
    v_mfma_f32_16x16x32_bf16 v[72:75], a[212:215], a[56:59], v[72:75]
    v_mfma_f32_16x16x32_bf16 v[100:103], a[208:211], a[56:59], v[100:103]
    v_mfma_f32_16x16x32_bf16 v[12:15], a[108:111], a[24:27], v[12:15]
    v_mfma_f32_16x16x32_bf16 v[12:15], a[104:107], a[76:79], v[12:15]
    v_mfma_f32_16x16x32_bf16 v[12:15], a[124:127], a[20:23], v[12:15]
    v_mfma_f32_16x16x32_bf16 v[12:15], a[120:123], a[72:75], v[12:15]
    v_mfma_f32_16x16x32_bf16 v[12:15], a[140:143], a[16:19], v[12:15]
    v_mfma_f32_16x16x32_bf16 v[12:15], a[136:139], a[68:71], v[12:15]
    v_mfma_f32_16x16x32_bf16 v[12:15], a[156:159], a[12:15], v[12:15]
    v_mfma_f32_16x16x32_bf16 v[12:15], a[152:155], a[64:67], v[12:15]
    v_sub_f32 v44, v44, v72
    v_mfma_f32_16x16x32_bf16 v[12:15], a[172:175], a[8:11], v[12:15]
    v_sub_f32 v45, v45, v73
    v_mfma_f32_16x16x32_bf16 v[12:15], a[168:171], a[60:63], v[12:15]
    v_sub_f32 v46, v46, v74
    v_mfma_f32_16x16x32_bf16 v[12:15], a[188:191], a[4:7], v[12:15]
    v_sub_f32 v47, v47, v75
    v_mfma_f32_16x16x32_bf16 v[12:15], a[184:187], a[56:59], v[12:15]
    v_cvt_pk_bf16_f32 v156, v44, v45
    v_mfma_f32_16x16x32_bf16 v[12:15], a[204:207], a[0:3], v[12:15]
    v_cvt_pk_bf16_f32 v157, v46, v47
    v_mfma_f32_16x16x32_bf16 v[12:15], a[200:203], a[52:55], v[12:15]
    v_cvt_pk_bf16_f32 v158, v100, v101
    v_mfma_f32_16x16x32_bf16 v[40:43], a[112:115], a[24:27], v[40:43]
    v_cvt_pk_bf16_f32 v159, v102, v103
    v_mfma_f32_16x16x32_bf16 v[96:99], a[116:119], a[24:27], v[96:99]
    s_mov_b32 s48, 49152
    v_mfma_f32_16x16x32_bf16 v[40:43], a[128:131], a[20:23], v[40:43]
    buffer_store_dwordx4 v[156:159], v9, s[20:23], s48 offen offset:128 sc1
    v_mfma_f32_16x16x32_bf16 v[96:99], a[132:135], a[20:23], v[96:99]
    v_mfma_f32_16x16x32_bf16 v[40:43], a[144:147], a[16:19], v[40:43]
    v_mfma_f32_16x16x32_bf16 v[96:99], a[148:151], a[16:19], v[96:99]
    v_mfma_f32_16x16x32_bf16 v[40:43], a[160:163], a[12:15], v[40:43]
    v_mfma_f32_16x16x32_bf16 v[96:99], a[164:167], a[12:15], v[96:99]
    v_cvt_pk_bf16_f32 v16, v16, v17
    v_mfma_f32_16x16x32_bf16 v[40:43], a[176:179], a[8:11], v[40:43]
    v_cvt_pk_bf16_f32 v17, v18, v19
    v_mfma_f32_16x16x32_bf16 v[96:99], a[180:183], a[8:11], v[96:99]
    ds_write_b64 v10, v[16:17] offset:512
    v_mfma_f32_16x16x32_bf16 v[40:43], a[192:195], a[4:7], v[40:43]
    v_mfma_f32_16x16x32_bf16 v[96:99], a[196:199], a[4:7], v[96:99]
    v_cvt_pk_bf16_f32 v15, v14, v15
    v_mfma_f32_16x16x32_bf16 v[40:43], a[208:211], a[0:3], v[40:43]
    v_cvt_pk_bf16_f32 v14, v12, v13
    v_mfma_f32_16x16x32_bf16 v[96:99], a[212:215], a[0:3], v[96:99]
    s_waitcnt lgkmcnt(0)
    s_barrier
    v_mfma_f32_16x16x32_bf16 v[68:71], a[116:119], a[76:79], v[68:71]
    v_mfma_f32_16x16x32_bf16 v[96:99], a[112:115], a[76:79], v[96:99]
    v_mfma_f32_16x16x32_bf16 v[68:71], a[132:135], a[72:75], v[68:71]
    v_mfma_f32_16x16x32_bf16 v[96:99], a[128:131], a[72:75], v[96:99]
    s_waitcnt lgkmcnt(0)
    s_barrier
    v_mfma_f32_16x16x32_bf16 v[68:71], a[148:151], a[68:71], v[68:71]
    ds_read_b64 v[12:13], v10 offset:0
    v_mfma_f32_16x16x32_bf16 v[96:99], a[144:147], a[68:71], v[96:99]
    v_mfma_f32_16x16x32_bf16 v[68:71], a[164:167], a[64:67], v[68:71]
    v_mfma_f32_16x16x32_bf16 v[96:99], a[160:163], a[64:67], v[96:99]
    v_mfma_f32_16x16x32_bf16 v[68:71], a[180:183], a[60:63], v[68:71]
    v_mfma_f32_16x16x32_bf16 v[96:99], a[176:179], a[60:63], v[96:99]
    v_mfma_f32_16x16x32_bf16 v[68:71], a[196:199], a[56:59], v[68:71]
    s_mov_b32 s47, 0
    v_mfma_f32_16x16x32_bf16 v[96:99], a[192:195], a[56:59], v[96:99]
    s_waitcnt lgkmcnt(0)
    buffer_store_dwordx4 v[12:15], v9, s[20:23], s47 offen offset:64 sc1
    v_mfma_f32_16x16x32_bf16 v[68:71], a[212:215], a[52:55], v[68:71]
    v_mfma_f32_16x16x32_bf16 v[96:99], a[208:211], a[52:55], v[96:99]
    s_nop 6
    v_sub_f32 v40, v40, v68
    v_sub_f32 v41, v41, v69
    v_sub_f32 v42, v42, v70
    v_sub_f32 v43, v43, v71
    v_cvt_pk_bf16_f32 v160, v40, v41
    v_cvt_pk_bf16_f32 v161, v42, v43
    v_cvt_pk_bf16_f32 v162, v96, v97
    v_cvt_pk_bf16_f32 v163, v98, v99
    s_mov_b32 s48, 0
    buffer_store_dwordx4 v[160:163], v9, s[20:23], s48 offen offset:128 sc1
    s_endpgm
K2_end:
    s_endpgm
.globl k3_kernel
.p2align 8
.type k3_kernel,@function
k3_kernel:
    s_load_dwordx2 s[4:5], s[0:1], 16
    s_load_dwordx2 s[8:9], s[0:1], 32
    s_getpc_b64 s[10:11]
K3_pc:
    s_cmp_ge_u32 s2, 224
    s_cbranch_scc1 K3_end
    v_lshrrev_b32 v5, 6, v0
    v_lshlrev_b32 v251, 7, v0
    v_min_u32 v251, K3_end-K3_pc, v251
    global_load_dword v250, v251, s[10:11]
    v_and_b32 v0, 63, v0
    v_readfirstlane_b32 s28, v5
    v_lshlrev_b32 v6, 4, v0
    v_add_u32 v7, fft_tables-K3_pc+24576, v6
    v_add_u32 v8, 4096, v7
    global_load_dwordx4 v[48:51], v7, s[10:11] offset:0
    global_load_dwordx4 v[52:55], v7, s[10:11] offset:1024
    global_load_dwordx4 v[56:59], v7, s[10:11] offset:2048
    global_load_dwordx4 v[60:63], v7, s[10:11] offset:3072
    global_load_dwordx4 v[64:67], v8, s[10:11] offset:0
    global_load_dwordx4 v[68:71], v8, s[10:11] offset:1024
    global_load_dwordx4 v[72:75], v8, s[10:11] offset:2048
    global_load_dwordx4 v[76:79], v8, s[10:11] offset:3072
    s_mul_i32 s29, s28, 12288
    s_and_b32 s30, s2, 0xfffe
    s_and_b32 s31, s28, 1
    s_add_u32 s30, s30, s31
    s_and_b32 s31, s2, 1
    s_lshl_b32 s31, s31, 1
    s_lshr_b32 s32, s28, 1
    s_add_u32 s31, s31, s32
    s_lshl_b32 s33, s30, 2
    s_add_u32 s33, s33, s31
    s_mul_i32 s33, s33, 12288
    s_add_u32 s38, s33, 4096
    s_add_u32 s39, s33, 8192
    s_waitcnt lgkmcnt(0)
    s_add_u32 s12, s8, 0x1400000
    s_addc_u32 s13, s9, 0
    s_and_b32 s13, s13, 0xffff
    s_mov_b32 s14, 11010048
    s_mov_b32 s15, 0x00020000
    s_add_u32 m0, s29, 0
    s_nop 0
    buffer_load_dwordx4 v6, s[12:15], s33 offen offset:0 lds
    buffer_load_dwordx4 v6, s[12:15], s33 offen offset:1024 lds
    buffer_load_dwordx4 v6, s[12:15], s33 offen offset:2048 lds
    buffer_load_dwordx4 v6, s[12:15], s33 offen offset:3072 lds
    s_add_u32 m0, s29, 4096
    s_nop 0
    buffer_load_dwordx4 v6, s[12:15], s38 offen offset:0 lds
    buffer_load_dwordx4 v6, s[12:15], s38 offen offset:1024 lds
    buffer_load_dwordx4 v6, s[12:15], s38 offen offset:2048 lds
    buffer_load_dwordx4 v6, s[12:15], s38 offen offset:3072 lds
    s_add_u32 m0, s29, 8192
    s_nop 0
    buffer_load_dwordx4 v6, s[12:15], s39 offen offset:0 lds
    buffer_load_dwordx4 v6, s[12:15], s39 offen offset:1024 lds
    buffer_load_dwordx4 v6, s[12:15], s39 offen offset:2048 lds
    buffer_load_dwordx4 v6, s[12:15], s39 offen offset:3072 lds
    s_mov_b32 s16, s4
    s_and_b32 s17, s5, 0xffff
    s_mov_b32 s18, 9633792
    s_mov_b32 s19, 0x00020000
    v_and_b32 v1, 15, v0
    v_lshrrev_b32 v2, 4, v0
    v_bfe_u32 v3, v0, 2, 2
    v_and_b32 v4, 3, v0
    v_lshrrev_b32 v23, 1, v2
    v_lshlrev_b32 v23, 3, v23
    v_and_b32 v24, 1, v2
    v_lshl_add_u32 v23, v24, 1, v23
    v_lshrrev_b32 v25, 1, v3
    v_add_u32 v23, v23, v25
    v_mul_u32_u24 v23, 384, v23
    v_lshl_add_u32 v23, v4, 5, v23
    v_and_b32 v25, 1, v3
    v_lshl_add_u32 v23, v25, 3, v23
    v_add_u32 v20, s29, v23
    v_mul_u32_u24 v23, 192, v1
    v_lshl_add_u32 v25, v2, 4, v23
    v_cmp_gt_u32 vcc, 8, v1
    v_mov_b32 v23, 0x40000000
    s_nop 0
    v_cndmask_b32 v26, v23, v25, vcc
    s_mul_i32 s35, s30, 43008
    s_mul_i32 s36, s31, 10752
    s_add_u32 s35, s35, s36
    s_waitcnt vmcnt(6)
    ds_read_b64_tr_b16 v[80:81], v20 offset:0
    ds_read_b64_tr_b16 v[82:83], v20 offset:1536
    ds_read_b64_tr_b16 v[84:85], v20 offset:16
    ds_read_b64_tr_b16 v[86:87], v20 offset:1552
    ds_read_b64_tr_b16 v[88:89], v20 offset:128
    ds_read_b64_tr_b16 v[90:91], v20 offset:1664
    ds_read_b64_tr_b16 v[92:93], v20 offset:144
    ds_read_b64_tr_b16 v[94:95], v20 offset:1680
    ds_read_b64_tr_b16 v[96:97], v20 offset:256
    ds_read_b64_tr_b16 v[98:99], v20 offset:1792
    ds_read_b64_tr_b16 v[100:101], v20 offset:272
    ds_read_b64_tr_b16 v[102:103], v20 offset:1808
    s_waitcnt lgkmcnt(10)
    v_mfma_f32_16x16x32_bf16 v[128:131], v[80:83], v[48:51], 0
    v_mfma_f32_16x16x32_bf16 v[132:135], v[80:83], v[56:59], 0
    v_mfma_f32_16x16x32_bf16 v[136:139], v[80:83], v[64:67], 0
    v_mfma_f32_16x16x32_bf16 v[140:143], v[80:83], v[72:75], 0
    s_waitcnt lgkmcnt(8)
    v_mfma_f32_16x16x32_bf16 v[144:147], v[84:87], v[48:51], 0
    v_mfma_f32_16x16x32_bf16 v[148:151], v[84:87], v[56:59], 0
    v_mfma_f32_16x16x32_bf16 v[152:155], v[84:87], v[64:67], 0
    v_mfma_f32_16x16x32_bf16 v[156:159], v[84:87], v[72:75], 0
    s_waitcnt lgkmcnt(6)
    v_mfma_f32_16x16x32_bf16 v[160:163], v[88:91], v[48:51], 0
    v_mfma_f32_16x16x32_bf16 v[164:167], v[88:91], v[56:59], 0
    v_mfma_f32_16x16x32_bf16 v[168:171], v[88:91], v[64:67], 0
    v_mfma_f32_16x16x32_bf16 v[172:175], v[88:91], v[72:75], 0
    s_waitcnt lgkmcnt(4)
    v_mfma_f32_16x16x32_bf16 v[176:179], v[92:95], v[48:51], 0
    v_mfma_f32_16x16x32_bf16 v[180:183], v[92:95], v[56:59], 0
    v_mfma_f32_16x16x32_bf16 v[184:187], v[92:95], v[64:67], 0
    v_mfma_f32_16x16x32_bf16 v[188:191], v[92:95], v[72:75], 0
    s_waitcnt lgkmcnt(2)
    v_mfma_f32_16x16x32_bf16 v[192:195], v[96:99], v[48:51], 0
    v_mfma_f32_16x16x32_bf16 v[196:199], v[96:99], v[56:59], 0
    v_mfma_f32_16x16x32_bf16 v[200:203], v[96:99], v[64:67], 0
    v_mfma_f32_16x16x32_bf16 v[204:207], v[96:99], v[72:75], 0
    s_waitcnt lgkmcnt(0)
    v_mfma_f32_16x16x32_bf16 v[208:211], v[100:103], v[48:51], 0
    v_mfma_f32_16x16x32_bf16 v[212:215], v[100:103], v[56:59], 0
    v_mfma_f32_16x16x32_bf16 v[216:219], v[100:103], v[64:67], 0
    v_mfma_f32_16x16x32_bf16 v[220:223], v[100:103], v[72:75], 0
    s_waitcnt vmcnt(0)
    ds_read_b64_tr_b16 v[104:105], v20 offset:6144
    ds_read_b64_tr_b16 v[106:107], v20 offset:7680
    ds_read_b64_tr_b16 v[108:109], v20 offset:6160
    ds_read_b64_tr_b16 v[110:111], v20 offset:7696
    ds_read_b64_tr_b16 v[112:113], v20 offset:6272
    ds_read_b64_tr_b16 v[114:115], v20 offset:7808
    ds_read_b64_tr_b16 v[116:117], v20 offset:6288
    ds_read_b64_tr_b16 v[118:119], v20 offset:7824
    ds_read_b64_tr_b16 v[120:121], v20 offset:6400
    ds_read_b64_tr_b16 v[122:123], v20 offset:7936
    ds_read_b64_tr_b16 v[124:125], v20 offset:6416
    ds_read_b64_tr_b16 v[126:127], v20 offset:7952
    s_waitcnt lgkmcnt(10)
    v_mfma_f32_16x16x32_bf16 v[128:131], v[104:107], v[52:55], v[128:131]
    s_waitcnt lgkmcnt(8)
    v_mfma_f32_16x16x32_bf16 v[144:147], v[108:111], v[52:55], v[144:147]
    s_waitcnt lgkmcnt(6)
    v_mfma_f32_16x16x32_bf16 v[160:163], v[112:115], v[52:55], v[160:163]
    s_waitcnt lgkmcnt(4)
    v_mfma_f32_16x16x32_bf16 v[176:179], v[116:119], v[52:55], v[176:179]
    s_waitcnt lgkmcnt(2)
    v_mfma_f32_16x16x32_bf16 v[192:195], v[120:123], v[52:55], v[192:195]
    s_waitcnt lgkmcnt(0)
    v_mfma_f32_16x16x32_bf16 v[208:211], v[124:127], v[52:55], v[208:211]
    v_mfma_f32_16x16x32_bf16 v[132:135], v[104:107], v[60:63], v[132:135]
    v_mfma_f32_16x16x32_bf16 v[148:151], v[108:111], v[60:63], v[148:151]
    v_cvt_pk_bf16_f32 v224, v128, v129
    v_cvt_pk_bf16_f32 v225, v130, v131
    v_cvt_pk_bf16_f32 v226, v144, v145
    v_cvt_pk_bf16_f32 v227, v146, v147
    s_add_u32 s37, s35, 0
    buffer_store_dwordx4 v[224:227], v25, s[16:19], s37 offen offset:0 sc1
    v_mfma_f32_16x16x32_bf16 v[164:167], v[112:115], v[60:63], v[164:167]
    v_mfma_f32_16x16x32_bf16 v[180:183], v[116:119], v[60:63], v[180:183]
    v_cvt_pk_bf16_f32 v228, v160, v161
    v_cvt_pk_bf16_f32 v229, v162, v163
    v_cvt_pk_bf16_f32 v230, v176, v177
    v_cvt_pk_bf16_f32 v231, v178, v179
    s_add_u32 s37, s35, 0
    buffer_store_dwordx4 v[228:231], v25, s[16:19], s37 offen offset:64 sc1
    v_mfma_f32_16x16x32_bf16 v[196:199], v[120:123], v[60:63], v[196:199]
    v_mfma_f32_16x16x32_bf16 v[212:215], v[124:127], v[60:63], v[212:215]
    v_cvt_pk_bf16_f32 v232, v192, v193
    v_cvt_pk_bf16_f32 v233, v194, v195
    v_cvt_pk_bf16_f32 v234, v208, v209
    v_cvt_pk_bf16_f32 v235, v210, v211
    s_add_u32 s37, s35, 0
    buffer_store_dwordx4 v[232:235], v25, s[16:19], s37 offen offset:128 sc1
    v_mfma_f32_16x16x32_bf16 v[136:139], v[104:107], v[68:71], v[136:139]
    v_mfma_f32_16x16x32_bf16 v[152:155], v[108:111], v[68:71], v[152:155]
    v_cvt_pk_bf16_f32 v236, v132, v133
    v_cvt_pk_bf16_f32 v237, v134, v135
    v_cvt_pk_bf16_f32 v238, v148, v149
    v_cvt_pk_bf16_f32 v239, v150, v151
    s_add_u32 s37, s35, 3072
    buffer_store_dwordx4 v[236:239], v25, s[16:19], s37 offen offset:0 sc1
    v_mfma_f32_16x16x32_bf16 v[168:171], v[112:115], v[68:71], v[168:171]
    v_mfma_f32_16x16x32_bf16 v[184:187], v[116:119], v[68:71], v[184:187]
    v_cvt_pk_bf16_f32 v224, v164, v165
    v_cvt_pk_bf16_f32 v225, v166, v167
    v_cvt_pk_bf16_f32 v226, v180, v181
    v_cvt_pk_bf16_f32 v227, v182, v183
    s_add_u32 s37, s35, 3072
    buffer_store_dwordx4 v[224:227], v25, s[16:19], s37 offen offset:64 sc1
    v_mfma_f32_16x16x32_bf16 v[200:203], v[120:123], v[68:71], v[200:203]
    v_mfma_f32_16x16x32_bf16 v[216:219], v[124:127], v[68:71], v[216:219]
    v_cvt_pk_bf16_f32 v228, v196, v197
    v_cvt_pk_bf16_f32 v229, v198, v199
    v_cvt_pk_bf16_f32 v230, v212, v213
    v_cvt_pk_bf16_f32 v231, v214, v215
    s_add_u32 s37, s35, 3072
    buffer_store_dwordx4 v[228:231], v25, s[16:19], s37 offen offset:128 sc1
    v_mfma_f32_16x16x32_bf16 v[140:143], v[104:107], v[76:79], v[140:143]
    v_mfma_f32_16x16x32_bf16 v[156:159], v[108:111], v[76:79], v[156:159]
    v_cvt_pk_bf16_f32 v232, v136, v137
    v_cvt_pk_bf16_f32 v233, v138, v139
    v_cvt_pk_bf16_f32 v234, v152, v153
    v_cvt_pk_bf16_f32 v235, v154, v155
    s_add_u32 s37, s35, 6144
    buffer_store_dwordx4 v[232:235], v25, s[16:19], s37 offen offset:0 sc1
    v_mfma_f32_16x16x32_bf16 v[172:175], v[112:115], v[76:79], v[172:175]
    v_mfma_f32_16x16x32_bf16 v[188:191], v[116:119], v[76:79], v[188:191]
    v_cvt_pk_bf16_f32 v236, v168, v169
    v_cvt_pk_bf16_f32 v237, v170, v171
    v_cvt_pk_bf16_f32 v238, v184, v185
    v_cvt_pk_bf16_f32 v239, v186, v187
    s_add_u32 s37, s35, 6144
    buffer_store_dwordx4 v[236:239], v25, s[16:19], s37 offen offset:64 sc1
    v_mfma_f32_16x16x32_bf16 v[204:207], v[120:123], v[76:79], v[204:207]
    v_mfma_f32_16x16x32_bf16 v[220:223], v[124:127], v[76:79], v[220:223]
    v_cvt_pk_bf16_f32 v224, v200, v201
    v_cvt_pk_bf16_f32 v225, v202, v203
    v_cvt_pk_bf16_f32 v226, v216, v217
    v_cvt_pk_bf16_f32 v227, v218, v219
    s_add_u32 s37, s35, 6144
    buffer_store_dwordx4 v[224:227], v25, s[16:19], s37 offen offset:128 sc1
    v_cvt_pk_bf16_f32 v228, v140, v141
    v_cvt_pk_bf16_f32 v229, v142, v143
    v_cvt_pk_bf16_f32 v230, v156, v157
    v_cvt_pk_bf16_f32 v231, v158, v159
    s_add_u32 s37, s35, 9216
    buffer_store_dwordx4 v[228:231], v26, s[16:19], s37 offen offset:0 sc1
    v_cvt_pk_bf16_f32 v232, v172, v173
    v_cvt_pk_bf16_f32 v233, v174, v175
    v_cvt_pk_bf16_f32 v234, v188, v189
    v_cvt_pk_bf16_f32 v235, v190, v191
    s_add_u32 s37, s35, 9216
    buffer_store_dwordx4 v[232:235], v26, s[16:19], s37 offen offset:64 sc1
    v_cvt_pk_bf16_f32 v236, v204, v205
    v_cvt_pk_bf16_f32 v237, v206, v207
    v_cvt_pk_bf16_f32 v238, v220, v221
    v_cvt_pk_bf16_f32 v239, v222, v223
    s_add_u32 s37, s35, 9216
    buffer_store_dwordx4 v[236:239], v26, s[16:19], s37 offen offset:128 sc1
K3_end:
    s_endpgm
.p2align 8
.type fft_tables,@object
fft_tables:
.long 0x3f803f80, 0x3f803f80, 0x3f803f80, 0x00003f80, 0x00000000, 0x00000000, 0x00000000, 0x00000000
.long 0x3f7f3f80, 0x3f743f7b, 0x3f603f6b, 0x00003f52, 0xbdcf0000, 0xbe99be4e, 0xbef8beca, 0x0000bf12
.long 0x00000000, 0x00000000, 0x00000000, 0x00000000, 0x00000000, 0x00000000, 0x00000000, 0x00000000
.long 0x00000000, 0x00000000, 0x00000000, 0x00000000, 0x00000000, 0x00000000, 0x00000000, 0x00000000
.long 0x00000000, 0x00000000, 0x00000000, 0x00000000, 0x00000000, 0x00000000, 0x00000000, 0x00000000
.long 0x00000000, 0x00000000, 0x00000000, 0x00000000, 0x00000000, 0x00000000, 0x00000000, 0x00000000
.long 0x00000000, 0x00000000, 0x00000000, 0x00000000, 0x00000000, 0x00000000, 0x00000000, 0x00000000
.long 0x00000000, 0x00000000, 0x00000000, 0x00000000, 0x00000000, 0x00000000, 0x00000000, 0x00000000
.long 0x00000000, 0x00000000, 0x00000000, 0x00000000, 0x00000000, 0x00000000, 0x00000000, 0x00000000
.long 0x00000000, 0x00000000, 0x00000000, 0x00000000, 0x00000000, 0x00000000, 0x00000000, 0x00000000
.long 0x3f803f80, 0x3f803f80, 0x3f803f80, 0x00003f80, 0x00000000, 0x00000000, 0x00000000, 0x00000000
.long 0x3f7f3f80, 0x3f743f7b, 0x3f603f6b, 0x00003f52, 0xbdcf0000, 0xbe99be4e, 0xbef8beca, 0x0000bf12
.long 0x00000000, 0x00000000, 0x00000000, 0x00000000, 0x00000000, 0x00000000, 0x00000000, 0x00000000
.long 0x00000000, 0x00000000, 0x00000000, 0x00000000, 0x00000000, 0x00000000, 0x00000000, 0x00000000
.long 0x00000000, 0x00000000, 0x00000000, 0x00000000, 0x00000000, 0x00000000, 0x00000000, 0x00000000
.long 0x00000000, 0x00000000, 0x00000000, 0x00000000, 0x00000000, 0x00000000, 0x00000000, 0x00000000
.long 0x00000000, 0x00000000, 0x00000000, 0x00000000, 0x00000000, 0x00000000, 0x00000000, 0x00000000
.long 0x00000000, 0x00000000, 0x00000000, 0x00000000, 0x00000000, 0x00000000, 0x00000000, 0x00000000
.long 0x00000000, 0x00000000, 0x00000000, 0x00000000, 0x00000000, 0x00000000, 0x00000000, 0x00000000
.long 0x00000000, 0x00000000, 0x00000000, 0x00000000, 0x00000000, 0x00000000, 0x00000000, 0x00000000
.long 0x3f803f80, 0x3f803f80, 0x3f803f80, 0x00003f80, 0x00000000, 0x00000000, 0x00000000, 0x00000000
.long 0x3f7f3f80, 0x3f743f7b, 0x3f603f6b, 0x00003f52, 0xbdcf0000, 0xbe99be4e, 0xbef8beca, 0x0000bf12
.long 0x00000000, 0x00000000, 0x00000000, 0x00000000, 0x00000000, 0x00000000, 0x00000000, 0x00000000
.long 0x00000000, 0x00000000, 0x00000000, 0x00000000, 0x00000000, 0x00000000, 0x00000000, 0x00000000
.long 0x00000000, 0x00000000, 0x00000000, 0x00000000, 0x00000000, 0x00000000, 0x00000000, 0x00000000
.long 0x00000000, 0x00000000, 0x00000000, 0x00000000, 0x00000000, 0x00000000, 0x00000000, 0x00000000
.long 0x00000000, 0x00000000, 0x00000000, 0x00000000, 0x00000000, 0x00000000, 0x00000000, 0x00000000
.long 0x00000000, 0x00000000, 0x00000000, 0x00000000, 0x00000000, 0x00000000, 0x00000000, 0x00000000
.long 0x00000000, 0x00000000, 0x00000000, 0x00000000, 0x00000000, 0x00000000, 0x00000000, 0x00000000
.long 0x00000000, 0x00000000, 0x00000000, 0x00000000, 0x00000000, 0x00000000, 0x00000000, 0x00000000
.long 0x3f803f80, 0x3f803f80, 0x3f803f80, 0x00003f80, 0x00000000, 0x00000000, 0x00000000, 0x00000000
.long 0x3f7f3f80, 0x3f743f7b, 0x3f603f6b, 0x00003f52, 0xbdcf0000, 0xbe99be4e, 0xbef8beca, 0x0000bf12
.long 0x3f7b3f80, 0x3f523f6b, 0x3f073f30, 0x00003eb2, 0xbe4e0000, 0xbf12beca, 0xbf59bf3a, 0x0000bf70
.long 0x3f743f80, 0x3f1d3f52, 0x3d4f3eb2, 0x0000be80, 0xbe990000, 0xbf4abf12, 0xbf80bf70, 0x0000bf78
.long 0x00000000, 0x00000000, 0x00000000, 0x00000000, 0x00000000, 0x00000000, 0x00000000, 0x00000000
.long 0x00000000, 0x00000000, 0x00000000, 0x00000000, 0x00000000, 0x00000000, 0x00000000, 0x00000000
.long 0x00000000, 0x00000000, 0x00000000, 0x00000000, 0x00000000, 0x00000000, 0x00000000, 0x00000000
.long 0x00000000, 0x00000000, 0x00000000, 0x00000000, 0x00000000, 0x00000000, 0x00000000, 0x00000000
.long 0x00000000, 0x00000000, 0x00000000, 0x00000000, 0x00000000, 0x00000000, 0x00000000, 0x00000000
.long 0x00000000, 0x00000000, 0x00000000, 0x00000000, 0x00000000, 0x00000000, 0x00000000, 0x00000000
.long 0x00000000, 0x00000000, 0x00000000, 0x00000000, 0x00000000, 0x00000000, 0x00000000, 0x00000000
.long 0x00000000, 0x00000000, 0x00000000, 0x00000000, 0x00000000, 0x00000000, 0x00000000, 0x00000000
.long 0x3f7b3f80, 0x3f523f6b, 0x3f073f30, 0x00003eb2, 0xbe4e0000, 0xbf12beca, 0xbf59bf3a, 0x0000bf70
.long 0x3f743f80, 0x3f1d3f52, 0x3d4f3eb2, 0x0000be80, 0xbe990000, 0xbf4abf12, 0xbf80bf70, 0x0000bf78
.long 0x00000000, 0x00000000, 0x00000000, 0x00000000, 0x00000000, 0x00000000, 0x00000000, 0x00000000
.long 0x00000000, 0x00000000, 0x00000000, 0x00000000, 0x00000000, 0x00000000, 0x00000000, 0x00000000
.long 0x00000000, 0x00000000, 0x00000000, 0x00000000, 0x00000000, 0x00000000, 0x00000000, 0x00000000
.long 0x00000000, 0x00000000, 0x00000000, 0x00000000, 0x00000000, 0x00000000, 0x00000000, 0x00000000
.long 0x00000000, 0x00000000, 0x00000000, 0x00000000, 0x00000000, 0x00000000, 0x00000000, 0x00000000
.long 0x00000000, 0x00000000, 0x00000000, 0x00000000, 0x00000000, 0x00000000, 0x00000000, 0x00000000
.long 0x00000000, 0x00000000, 0x00000000, 0x00000000, 0x00000000, 0x00000000, 0x00000000, 0x00000000
.long 0x00000000, 0x00000000, 0x00000000, 0x00000000, 0x00000000, 0x00000000, 0x00000000, 0x00000000
.long 0x3f7b3f80, 0x3f523f6b, 0x3f073f30, 0x00003eb2, 0xbe4e0000, 0xbf12beca, 0xbf59bf3a, 0x0000bf70
.long 0x3f743f80, 0x3f1d3f52, 0x3d4f3eb2, 0x0000be80, 0xbe990000, 0xbf4abf12, 0xbf80bf70, 0x0000bf78
.long 0x00000000, 0x00000000, 0x00000000, 0x00000000, 0x00000000, 0x00000000, 0x00000000, 0x00000000
.long 0x00000000, 0x00000000, 0x00000000, 0x00000000, 0x00000000, 0x00000000, 0x00000000, 0x00000000
.long 0x00000000, 0x00000000, 0x00000000, 0x00000000, 0x00000000, 0x00000000, 0x00000000, 0x00000000
.long 0x00000000, 0x00000000, 0x00000000, 0x00000000, 0x00000000, 0x00000000, 0x00000000, 0x00000000
.long 0x00000000, 0x00000000, 0x00000000, 0x00000000, 0x00000000, 0x00000000, 0x00000000, 0x00000000
.long 0x00000000, 0x00000000, 0x00000000, 0x00000000, 0x00000000, 0x00000000, 0x00000000, 0x00000000
.long 0x00000000, 0x00000000, 0x00000000, 0x00000000, 0x00000000, 0x00000000, 0x00000000, 0x00000000
.long 0x00000000, 0x00000000, 0x00000000, 0x00000000, 0x00000000, 0x00000000, 0x00000000, 0x00000000
.long 0x3f7b3f80, 0x3f523f6b, 0x3f073f30, 0x00003eb2, 0xbe4e0000, 0xbf12beca, 0xbf59bf3a, 0x0000bf70
.long 0x3f743f80, 0x3f1d3f52, 0x3d4f3eb2, 0x0000be80, 0xbe990000, 0xbf4abf12, 0xbf80bf70, 0x0000bf78
.long 0x3f6b3f80, 0x3eb23f30, 0xbee1bd4f, 0x0000bf42, 0xbeca0000, 0xbf70bf3a, 0xbf66bf80, 0x0000bf27
.long 0x3f603f80, 0x3d4f3f07, 0xbf52bee1, 0x0000bf7f, 0xbef80000, 0xbf80bf59, 0xbf12bf66, 0x0000bdcf
.long 0x00000000, 0x00000000, 0x00000000, 0x00000000, 0x00000000, 0x00000000, 0x00000000, 0x00000000
.long 0x00000000, 0x00000000, 0x00000000, 0x00000000, 0x00000000, 0x00000000, 0x00000000, 0x00000000
.long 0x00000000, 0x00000000, 0x00000000, 0x00000000, 0x00000000, 0x00000000, 0x00000000, 0x00000000
.long 0x00000000, 0x00000000, 0x00000000, 0x00000000, 0x00000000, 0x00000000, 0x00000000, 0x00000000
.long 0x00000000, 0x00000000, 0x00000000, 0x00000000, 0x00000000, 0x00000000, 0x00000000, 0x00000000
.long 0x00000000, 0x00000000, 0x00000000, 0x00000000, 0x00000000, 0x00000000, 0x00000000, 0x00000000
.long 0x00000000, 0x00000000, 0x00000000, 0x00000000, 0x00000000, 0x00000000, 0x00000000, 0x00000000
.long 0x00000000, 0x00000000, 0x00000000, 0x00000000, 0x00000000, 0x00000000, 0x00000000, 0x00000000
.long 0x3f6b3f80, 0x3eb23f30, 0xbee1bd4f, 0x0000bf42, 0xbeca0000, 0xbf70bf3a, 0xbf66bf80, 0x0000bf27
.long 0x3f603f80, 0x3d4f3f07, 0xbf52bee1, 0x0000bf7f, 0xbef80000, 0xbf80bf59, 0xbf12bf66, 0x0000bdcf
.long 0x00000000, 0x00000000, 0x00000000, 0x00000000, 0x00000000, 0x00000000, 0x00000000, 0x00000000
.long 0x00000000, 0x00000000, 0x00000000, 0x00000000, 0x00000000, 0x00000000, 0x00000000, 0x00000000
.long 0x00000000, 0x00000000, 0x00000000, 0x00000000, 0x00000000, 0x00000000, 0x00000000, 0x00000000
.long 0x00000000, 0x00000000, 0x00000000, 0x00000000, 0x00000000, 0x00000000, 0x00000000, 0x00000000
.long 0x00000000, 0x00000000, 0x00000000, 0x00000000, 0x00000000, 0x00000000, 0x00000000, 0x00000000
.long 0x00000000, 0x00000000, 0x00000000, 0x00000000, 0x00000000, 0x00000000, 0x00000000, 0x00000000
.long 0x00000000, 0x00000000, 0x00000000, 0x00000000, 0x00000000, 0x00000000, 0x00000000, 0x00000000
.long 0x00000000, 0x00000000, 0x00000000, 0x00000000, 0x00000000, 0x00000000, 0x00000000, 0x00000000
.long 0x3f6b3f80, 0x3eb23f30, 0xbee1bd4f, 0x0000bf42, 0xbeca0000, 0xbf70bf3a, 0xbf66bf80, 0x0000bf27
.long 0x3f603f80, 0x3d4f3f07, 0xbf52bee1, 0x0000bf7f, 0xbef80000, 0xbf80bf59, 0xbf12bf66, 0x0000bdcf
.long 0x00000000, 0x00000000, 0x00000000, 0x00000000, 0x00000000, 0x00000000, 0x00000000, 0x00000000
.long 0x00000000, 0x00000000, 0x00000000, 0x00000000, 0x00000000, 0x00000000, 0x00000000, 0x00000000
.long 0x00000000, 0x00000000, 0x00000000, 0x00000000, 0x00000000, 0x00000000, 0x00000000, 0x00000000
.long 0x00000000, 0x00000000, 0x00000000, 0x00000000, 0x00000000, 0x00000000, 0x00000000, 0x00000000
.long 0x00000000, 0x00000000, 0x00000000, 0x00000000, 0x00000000, 0x00000000, 0x00000000, 0x00000000
.long 0x00000000, 0x00000000, 0x00000000, 0x00000000, 0x00000000, 0x00000000, 0x00000000, 0x00000000
.long 0x00000000, 0x00000000, 0x00000000, 0x00000000, 0x00000000, 0x00000000, 0x00000000, 0x00000000
.long 0x00000000, 0x00000000, 0x00000000, 0x00000000, 0x00000000, 0x00000000, 0x00000000, 0x00000000
.long 0x3f6b3f80, 0x3eb23f30, 0xbee1bd4f, 0x0000bf42, 0xbeca0000, 0xbf70bf3a, 0xbf66bf80, 0x0000bf27
.long 0x3f603f80, 0x3d4f3f07, 0xbf52bee1, 0x0000bf7f, 0xbef80000, 0xbf80bf59, 0xbf12bf66, 0x0000bdcf
.long 0x3f523f80, 0xbe803eb2, 0xbf7fbf42, 0x0000bf60, 0xbf120000, 0xbf78bf70, 0xbdcfbf27, 0x00003ef8
.long 0x3f423f80, 0xbf073e1b, 0xbf6bbf74, 0x0000bee1, 0xbf270000, 0xbf59bf7d, 0x3ecabe99, 0x00003f66
.long 0x00000000, 0x00000000, 0x00000000, 0x00000000, 0x00000000, 0x00000000, 0x00000000, 0x00000000
.long 0x00000000, 0x00000000, 0x00000000, 0x00000000, 0x00000000, 0x00000000, 0x00000000, 0x00000000
.long 0x00000000, 0x00000000, 0x00000000, 0x00000000, 0x00000000, 0x00000000, 0x00000000, 0x00000000
.long 0x00000000, 0x00000000, 0x00000000, 0x00000000, 0x00000000, 0x00000000, 0x00000000, 0x00000000
.long 0x00000000, 0x00000000, 0x00000000, 0x00000000, 0x00000000, 0x00000000, 0x00000000, 0x00000000
.long 0x00000000, 0x00000000, 0x00000000, 0x00000000, 0x00000000, 0x00000000, 0x00000000, 0x00000000
.long 0x00000000, 0x00000000, 0x00000000, 0x00000000, 0x00000000, 0x00000000, 0x00000000, 0x00000000
.long 0x00000000, 0x00000000, 0x00000000, 0x00000000, 0x00000000, 0x00000000, 0x00000000, 0x00000000
.long 0x3f523f80, 0xbe803eb2, 0xbf7fbf42, 0x0000bf60, 0xbf120000, 0xbf78bf70, 0xbdcfbf27, 0x00003ef8
.long 0x3f423f80, 0xbf073e1b, 0xbf6bbf74, 0x0000bee1, 0xbf270000, 0xbf59bf7d, 0x3ecabe99, 0x00003f66
.long 0x00000000, 0x00000000, 0x00000000, 0x00000000, 0x00000000, 0x00000000, 0x00000000, 0x00000000
.long 0x00000000, 0x00000000, 0x00000000, 0x00000000, 0x00000000, 0x00000000, 0x00000000, 0x00000000
.long 0x00000000, 0x00000000, 0x00000000, 0x00000000, 0x00000000, 0x00000000, 0x00000000, 0x00000000
.long 0x00000000, 0x00000000, 0x00000000, 0x00000000, 0x00000000, 0x00000000, 0x00000000, 0x00000000
.long 0x00000000, 0x00000000, 0x00000000, 0x00000000, 0x00000000, 0x00000000, 0x00000000, 0x00000000
.long 0x00000000, 0x00000000, 0x00000000, 0x00000000, 0x00000000, 0x00000000, 0x00000000, 0x00000000
.long 0x00000000, 0x00000000, 0x00000000, 0x00000000, 0x00000000, 0x00000000, 0x00000000, 0x00000000
.long 0x00000000, 0x00000000, 0x00000000, 0x00000000, 0x00000000, 0x00000000, 0x00000000, 0x00000000
.long 0x3f523f80, 0xbe803eb2, 0xbf7fbf42, 0x0000bf60, 0xbf120000, 0xbf78bf70, 0xbdcfbf27, 0x00003ef8
.long 0x3f423f80, 0xbf073e1b, 0xbf6bbf74, 0x0000bee1, 0xbf270000, 0xbf59bf7d, 0x3ecabe99, 0x00003f66
.long 0x00000000, 0x00000000, 0x00000000, 0x00000000, 0x00000000, 0x00000000, 0x00000000, 0x00000000
.long 0x00000000, 0x00000000, 0x00000000, 0x00000000, 0x00000000, 0x00000000, 0x00000000, 0x00000000
.long 0x00000000, 0x00000000, 0x00000000, 0x00000000, 0x00000000, 0x00000000, 0x00000000, 0x00000000
.long 0x00000000, 0x00000000, 0x00000000, 0x00000000, 0x00000000, 0x00000000, 0x00000000, 0x00000000
.long 0x00000000, 0x00000000, 0x00000000, 0x00000000, 0x00000000, 0x00000000, 0x00000000, 0x00000000
.long 0x00000000, 0x00000000, 0x00000000, 0x00000000, 0x00000000, 0x00000000, 0x00000000, 0x00000000
.long 0x00000000, 0x00000000, 0x00000000, 0x00000000, 0x00000000, 0x00000000, 0x00000000, 0x00000000
.long 0x00000000, 0x00000000, 0x00000000, 0x00000000, 0x00000000, 0x00000000, 0x00000000, 0x00000000
.long 0x3f523f80, 0xbe803eb2, 0xbf7fbf42, 0x0000bf60, 0xbf120000, 0xbf78bf70, 0xbdcfbf27, 0x00003ef8
.long 0x3f423f80, 0xbf073e1b, 0xbf6bbf74, 0x0000bee1, 0xbf270000, 0xbf59bf7d, 0x3ecabe99, 0x00003f66
.long 0x3f303f80, 0xbf42bd4f, 0xbf1dbf7f, 0x00003e1b, 0xbf3a0000, 0xbf27bf80, 0x3f4a3dcf, 0x00003f7d
.long 0x3f1d3f80, 0xbf6bbe80, 0xbe1bbf60, 0x00003f30, 0xbf4a0000, 0xbecabf78, 0x3f7d3ef8, 0x00003f3a
.long 0x00000000, 0x00000000, 0x00000000, 0x00000000, 0x00000000, 0x00000000, 0x00000000, 0x00000000
.long 0x00000000, 0x00000000, 0x00000000, 0x00000000, 0x00000000, 0x00000000, 0x00000000, 0x00000000
.long 0x00000000, 0x00000000, 0x00000000, 0x00000000, 0x00000000, 0x00000000, 0x00000000, 0x00000000
.long 0x00000000, 0x00000000, 0x00000000, 0x00000000, 0x00000000, 0x00000000, 0x00000000, 0x00000000
.long 0x00000000, 0x00000000, 0x00000000, 0x00000000, 0x00000000, 0x00000000, 0x00000000, 0x00000000
.long 0x00000000, 0x00000000, 0x00000000, 0x00000000, 0x00000000, 0x00000000, 0x00000000, 0x00000000
.long 0x00000000, 0x00000000, 0x00000000, 0x00000000, 0x00000000, 0x00000000, 0x00000000, 0x00000000
.long 0x00000000, 0x00000000, 0x00000000, 0x00000000, 0x00000000, 0x00000000, 0x00000000, 0x00000000
.long 0x3f303f80, 0xbf42bd4f, 0xbf1dbf7f, 0x00003e1b, 0xbf3a0000, 0xbf27bf80, 0x3f4a3dcf, 0x00003f7d
.long 0x3f1d3f80, 0xbf6bbe80, 0xbe1bbf60, 0x00003f30, 0xbf4a0000, 0xbecabf78, 0x3f7d3ef8, 0x00003f3a
.long 0x00000000, 0x00000000, 0x00000000, 0x00000000, 0x00000000, 0x00000000, 0x00000000, 0x00000000
.long 0x00000000, 0x00000000, 0x00000000, 0x00000000, 0x00000000, 0x00000000, 0x00000000, 0x00000000
.long 0x00000000, 0x00000000, 0x00000000, 0x00000000, 0x00000000, 0x00000000, 0x00000000, 0x00000000
.long 0x00000000, 0x00000000, 0x00000000, 0x00000000, 0x00000000, 0x00000000, 0x00000000, 0x00000000
.long 0x00000000, 0x00000000, 0x00000000, 0x00000000, 0x00000000, 0x00000000, 0x00000000, 0x00000000
.long 0x00000000, 0x00000000, 0x00000000, 0x00000000, 0x00000000, 0x00000000, 0x00000000, 0x00000000
.long 0x00000000, 0x00000000, 0x00000000, 0x00000000, 0x00000000, 0x00000000, 0x00000000, 0x00000000
.long 0x00000000, 0x00000000, 0x00000000, 0x00000000, 0x00000000, 0x00000000, 0x00000000, 0x00000000
.long 0x3f303f80, 0xbf42bd4f, 0xbf1dbf7f, 0x00003e1b, 0xbf3a0000, 0xbf27bf80, 0x3f4a3dcf, 0x00003f7d
.long 0x3f1d3f80, 0xbf6bbe80, 0xbe1bbf60, 0x00003f30, 0xbf4a0000, 0xbecabf78, 0x3f7d3ef8, 0x00003f3a
.long 0x00000000, 0x00000000, 0x00000000, 0x00000000, 0x00000000, 0x00000000, 0x00000000, 0x00000000
.long 0x00000000, 0x00000000, 0x00000000, 0x00000000, 0x00000000, 0x00000000, 0x00000000, 0x00000000
.long 0x00000000, 0x00000000, 0x00000000, 0x00000000, 0x00000000, 0x00000000, 0x00000000, 0x00000000
.long 0x00000000, 0x00000000, 0x00000000, 0x00000000, 0x00000000, 0x00000000, 0x00000000, 0x00000000
.long 0x00000000, 0x00000000, 0x00000000, 0x00000000, 0x00000000, 0x00000000, 0x00000000, 0x00000000
.long 0x00000000, 0x00000000, 0x00000000, 0x00000000, 0x00000000, 0x00000000, 0x00000000, 0x00000000
.long 0x00000000, 0x00000000, 0x00000000, 0x00000000, 0x00000000, 0x00000000, 0x00000000, 0x00000000
.long 0x00000000, 0x00000000, 0x00000000, 0x00000000, 0x00000000, 0x00000000, 0x00000000, 0x00000000
.long 0x3f303f80, 0xbf42bd4f, 0xbf1dbf7f, 0x00003e1b, 0xbf3a0000, 0xbf27bf80, 0x3f4a3dcf, 0x00003f7d
.long 0x3f1d3f80, 0xbf6bbe80, 0xbe1bbf60, 0x00003f30, 0xbf4a0000, 0xbecabf78, 0x3f7d3ef8, 0x00003f3a
.long 0x3f073f80, 0xbf7fbee1, 0x3eb2bf1d, 0x00003f7b, 0xbf590000, 0xbdcfbf66, 0x3f703f4a, 0x00003e4e
.long 0x3ee13f80, 0xbf7bbf1d, 0x3f42be80, 0x00003f6b, 0xbf660000, 0x3e4ebf4a, 0x3f273f78, 0x0000beca
.long 0x00000000, 0x00000000, 0x00000000, 0x00000000, 0x00000000, 0x00000000, 0x00000000, 0x00000000
.long 0x00000000, 0x00000000, 0x00000000, 0x00000000, 0x00000000, 0x00000000, 0x00000000, 0x00000000
.long 0x00000000, 0x00000000, 0x00000000, 0x00000000, 0x00000000, 0x00000000, 0x00000000, 0x00000000
.long 0x00000000, 0x00000000, 0x00000000, 0x00000000, 0x00000000, 0x00000000, 0x00000000, 0x00000000
.long 0x00000000, 0x00000000, 0x00000000, 0x00000000, 0x00000000, 0x00000000, 0x00000000, 0x00000000
.long 0x00000000, 0x00000000, 0x00000000, 0x00000000, 0x00000000, 0x00000000, 0x00000000, 0x00000000
.long 0x00000000, 0x00000000, 0x00000000, 0x00000000, 0x00000000, 0x00000000, 0x00000000, 0x00000000
.long 0x00000000, 0x00000000, 0x00000000, 0x00000000, 0x00000000, 0x00000000, 0x00000000, 0x00000000
.long 0x3f073f80, 0xbf7fbee1, 0x3eb2bf1d, 0x00003f7b, 0xbf590000, 0xbdcfbf66, 0x3f703f4a, 0x00003e4e
.long 0x3ee13f80, 0xbf7bbf1d, 0x3f42be80, 0x00003f6b, 0xbf660000, 0x3e4ebf4a, 0x3f273f78, 0x0000beca
.long 0x00000000, 0x00000000, 0x00000000, 0x00000000, 0x00000000, 0x00000000, 0x00000000, 0x00000000
.long 0x00000000, 0x00000000, 0x00000000, 0x00000000, 0x00000000, 0x00000000, 0x00000000, 0x00000000
.long 0x00000000, 0x00000000, 0x00000000, 0x00000000, 0x00000000, 0x00000000, 0x00000000, 0x00000000
.long 0x00000000, 0x00000000, 0x00000000, 0x00000000, 0x00000000, 0x00000000, 0x00000000, 0x00000000
.long 0x00000000, 0x00000000, 0x00000000, 0x00000000, 0x00000000, 0x00000000, 0x00000000, 0x00000000
.long 0x00000000, 0x00000000, 0x00000000, 0x00000000, 0x00000000, 0x00000000, 0x00000000, 0x00000000
.long 0x00000000, 0x00000000, 0x00000000, 0x00000000, 0x00000000, 0x00000000, 0x00000000, 0x00000000
.long 0x00000000, 0x00000000, 0x00000000, 0x00000000, 0x00000000, 0x00000000, 0x00000000, 0x00000000
.long 0x3f073f80, 0xbf7fbee1, 0x3eb2bf1d, 0x00003f7b, 0xbf590000, 0xbdcfbf66, 0x3f703f4a, 0x00003e4e
.long 0x3ee13f80, 0xbf7bbf1d, 0x3f42be80, 0x00003f6b, 0xbf660000, 0x3e4ebf4a, 0x3f273f78, 0x0000beca
.long 0x00000000, 0x00000000, 0x00000000, 0x00000000, 0x00000000, 0x00000000, 0x00000000, 0x00000000
.long 0x00000000, 0x00000000, 0x00000000, 0x00000000, 0x00000000, 0x00000000, 0x00000000, 0x00000000
.long 0x00000000, 0x00000000, 0x00000000, 0x00000000, 0x00000000, 0x00000000, 0x00000000, 0x00000000
.long 0x00000000, 0x00000000, 0x00000000, 0x00000000, 0x00000000, 0x00000000, 0x00000000, 0x00000000
.long 0x00000000, 0x00000000, 0x00000000, 0x00000000, 0x00000000, 0x00000000, 0x00000000, 0x00000000
.long 0x00000000, 0x00000000, 0x00000000, 0x00000000, 0x00000000, 0x00000000, 0x00000000, 0x00000000
.long 0x00000000, 0x00000000, 0x00000000, 0x00000000, 0x00000000, 0x00000000, 0x00000000, 0x00000000
.long 0x00000000, 0x00000000, 0x00000000, 0x00000000, 0x00000000, 0x00000000, 0x00000000, 0x00000000
.long 0x3f073f80, 0xbf7fbee1, 0x3eb2bf1d, 0x00003f7b, 0xbf590000, 0xbdcfbf66, 0x3f703f4a, 0x00003e4e
.long 0x3ee13f80, 0xbf7bbf1d, 0x3f42be80, 0x00003f6b, 0xbf660000, 0x3e4ebf4a, 0x3f273f78, 0x0000beca
.long 0x3eb23f80, 0xbf60bf42, 0x3f7b3e1b, 0x00003f07, 0xbf700000, 0x3ef8bf27, 0x3e4e3f7d, 0x0000bf59
.long 0x3e803f80, 0xbf30bf60, 0x3f743f07, 0x0000bd4f, 0xbf780000, 0x3f3abef8, 0xbe993f59, 0x0000bf80
.long 0x00000000, 0x00000000, 0x00000000, 0x00000000, 0x00000000, 0x00000000, 0x00000000, 0x00000000
.long 0x00000000, 0x00000000, 0x00000000, 0x00000000, 0x00000000, 0x00000000, 0x00000000, 0x00000000
.long 0x00000000, 0x00000000, 0x00000000, 0x00000000, 0x00000000, 0x00000000, 0x00000000, 0x00000000
.long 0x00000000, 0x00000000, 0x00000000, 0x00000000, 0x00000000, 0x00000000, 0x00000000, 0x00000000
.long 0x00000000, 0x00000000, 0x00000000, 0x00000000, 0x00000000, 0x00000000, 0x00000000, 0x00000000
.long 0x00000000, 0x00000000, 0x00000000, 0x00000000, 0x00000000, 0x00000000, 0x00000000, 0x00000000
.long 0x00000000, 0x00000000, 0x00000000, 0x00000000, 0x00000000, 0x00000000, 0x00000000, 0x00000000
.long 0x00000000, 0x00000000, 0x00000000, 0x00000000, 0x00000000, 0x00000000, 0x00000000, 0x00000000
.long 0x3eb23f80, 0xbf60bf42, 0x3f7b3e1b, 0x00003f07, 0xbf700000, 0x3ef8bf27, 0x3e4e3f7d, 0x0000bf59
.long 0x3e803f80, 0xbf30bf60, 0x3f743f07, 0x0000bd4f, 0xbf780000, 0x3f3abef8, 0xbe993f59, 0x0000bf80
.long 0x00000000, 0x00000000, 0x00000000, 0x00000000, 0x00000000, 0x00000000, 0x00000000, 0x00000000
.long 0x00000000, 0x00000000, 0x00000000, 0x00000000, 0x00000000, 0x00000000, 0x00000000, 0x00000000
.long 0x00000000, 0x00000000, 0x00000000, 0x00000000, 0x00000000, 0x00000000, 0x00000000, 0x00000000
.long 0x00000000, 0x00000000, 0x00000000, 0x00000000, 0x00000000, 0x00000000, 0x00000000, 0x00000000
.long 0x00000000, 0x00000000, 0x00000000, 0x00000000, 0x00000000, 0x00000000, 0x00000000, 0x00000000
.long 0x00000000, 0x00000000, 0x00000000, 0x00000000, 0x00000000, 0x00000000, 0x00000000, 0x00000000
.long 0x00000000, 0x00000000, 0x00000000, 0x00000000, 0x00000000, 0x00000000, 0x00000000, 0x00000000
.long 0x00000000, 0x00000000, 0x00000000, 0x00000000, 0x00000000, 0x00000000, 0x00000000, 0x00000000
.long 0x3eb23f80, 0xbf60bf42, 0x3f7b3e1b, 0x00003f07, 0xbf700000, 0x3ef8bf27, 0x3e4e3f7d, 0x0000bf59
.long 0x3e803f80, 0xbf30bf60, 0x3f743f07, 0x0000bd4f, 0xbf780000, 0x3f3abef8, 0xbe993f59, 0x0000bf80
.long 0x00000000, 0x00000000, 0x00000000, 0x00000000, 0x00000000, 0x00000000, 0x00000000, 0x00000000
.long 0x00000000, 0x00000000, 0x00000000, 0x00000000, 0x00000000, 0x00000000, 0x00000000, 0x00000000
.long 0x00000000, 0x00000000, 0x00000000, 0x00000000, 0x00000000, 0x00000000, 0x00000000, 0x00000000
.long 0x00000000, 0x00000000, 0x00000000, 0x00000000, 0x00000000, 0x00000000, 0x00000000, 0x00000000
.long 0x00000000, 0x00000000, 0x00000000, 0x00000000, 0x00000000, 0x00000000, 0x00000000, 0x00000000
.long 0x00000000, 0x00000000, 0x00000000, 0x00000000, 0x00000000, 0x00000000, 0x00000000, 0x00000000
.long 0x00000000, 0x00000000, 0x00000000, 0x00000000, 0x00000000, 0x00000000, 0x00000000, 0x00000000
.long 0x00000000, 0x00000000, 0x00000000, 0x00000000, 0x00000000, 0x00000000, 0x00000000, 0x00000000
.long 0x3eb23f80, 0xbf60bf42, 0x3f7b3e1b, 0x00003f07, 0xbf700000, 0x3ef8bf27, 0x3e4e3f7d, 0x0000bf59
.long 0x3e803f80, 0xbf30bf60, 0x3f743f07, 0x0000bd4f, 0xbf780000, 0x3f3abef8, 0xbe993f59, 0x0000bf80
.long 0x3e1b3f80, 0xbee1bf74, 0x3f303f52, 0x0000bf1d, 0xbf7d0000, 0x3f66be99, 0xbf3a3f12, 0x0000bf4a
.long 0x3d4f3f80, 0xbe1bbf7f, 0x3e803f7b, 0x0000bf74, 0xbf800000, 0x3f7dbdcf, 0xbf783e4e, 0x0000be99
.long 0x00000000, 0x00000000, 0x00000000, 0x00000000, 0x00000000, 0x00000000, 0x00000000, 0x00000000
.long 0x00000000, 0x00000000, 0x00000000, 0x00000000, 0x00000000, 0x00000000, 0x00000000, 0x00000000
.long 0x00000000, 0x00000000, 0x00000000, 0x00000000, 0x00000000, 0x00000000, 0x00000000, 0x00000000
.long 0x00000000, 0x00000000, 0x00000000, 0x00000000, 0x00000000, 0x00000000, 0x00000000, 0x00000000
.long 0x00000000, 0x00000000, 0x00000000, 0x00000000, 0x00000000, 0x00000000, 0x00000000, 0x00000000
.long 0x00000000, 0x00000000, 0x00000000, 0x00000000, 0x00000000, 0x00000000, 0x00000000, 0x00000000
.long 0x00000000, 0x00000000, 0x00000000, 0x00000000, 0x00000000, 0x00000000, 0x00000000, 0x00000000
.long 0x00000000, 0x00000000, 0x00000000, 0x00000000, 0x00000000, 0x00000000, 0x00000000, 0x00000000
.long 0x3e1b3f80, 0xbee1bf74, 0x3f303f52, 0x0000bf1d, 0xbf7d0000, 0x3f66be99, 0xbf3a3f12, 0x0000bf4a
.long 0x3d4f3f80, 0xbe1bbf7f, 0x3e803f7b, 0x0000bf74, 0xbf800000, 0x3f7dbdcf, 0xbf783e4e, 0x0000be99
.long 0x00000000, 0x00000000, 0x00000000, 0x00000000, 0x00000000, 0x00000000, 0x00000000, 0x00000000
.long 0x00000000, 0x00000000, 0x00000000, 0x00000000, 0x00000000, 0x00000000, 0x00000000, 0x00000000
.long 0x00000000, 0x00000000, 0x00000000, 0x00000000, 0x00000000, 0x00000000, 0x00000000, 0x00000000
.long 0x00000000, 0x00000000, 0x00000000, 0x00000000, 0x00000000, 0x00000000, 0x00000000, 0x00000000
.long 0x00000000, 0x00000000, 0x00000000, 0x00000000, 0x00000000, 0x00000000, 0x00000000, 0x00000000
.long 0x00000000, 0x00000000, 0x00000000, 0x00000000, 0x00000000, 0x00000000, 0x00000000, 0x00000000
.long 0x00000000, 0x00000000, 0x00000000, 0x00000000, 0x00000000, 0x00000000, 0x00000000, 0x00000000
.long 0x00000000, 0x00000000, 0x00000000, 0x00000000, 0x00000000, 0x00000000, 0x00000000, 0x00000000
.long 0x3e1b3f80, 0xbee1bf74, 0x3f303f52, 0x0000bf1d, 0xbf7d0000, 0x3f66be99, 0xbf3a3f12, 0x0000bf4a
.long 0x3d4f3f80, 0xbe1bbf7f, 0x3e803f7b, 0x0000bf74, 0xbf800000, 0x3f7dbdcf, 0xbf783e4e, 0x0000be99
.long 0x00000000, 0x00000000, 0x00000000, 0x00000000, 0x00000000, 0x00000000, 0x00000000, 0x00000000
.long 0x00000000, 0x00000000, 0x00000000, 0x00000000, 0x00000000, 0x00000000, 0x00000000, 0x00000000
.long 0x00000000, 0x00000000, 0x00000000, 0x00000000, 0x00000000, 0x00000000, 0x00000000, 0x00000000
.long 0x00000000, 0x00000000, 0x00000000, 0x00000000, 0x00000000, 0x00000000, 0x00000000, 0x00000000
.long 0x00000000, 0x00000000, 0x00000000, 0x00000000, 0x00000000, 0x00000000, 0x00000000, 0x00000000
.long 0x00000000, 0x00000000, 0x00000000, 0x00000000, 0x00000000, 0x00000000, 0x00000000, 0x00000000
.long 0x00000000, 0x00000000, 0x00000000, 0x00000000, 0x00000000, 0x00000000, 0x00000000, 0x00000000
.long 0x00000000, 0x00000000, 0x00000000, 0x00000000, 0x00000000, 0x00000000, 0x00000000, 0x00000000
.long 0x3e1b3f80, 0xbee1bf74, 0x3f303f52, 0x0000bf1d, 0xbf7d0000, 0x3f66be99, 0xbf3a3f12, 0x0000bf4a
.long 0x3d4f3f80, 0xbe1bbf7f, 0x3e803f7b, 0x0000bf74, 0xbf800000, 0x3f7dbdcf, 0xbf783e4e, 0x0000be99
.long 0xbd4f3f80, 0x3e1bbf7f, 0xbe803f7b, 0x0000bf74, 0xbf800000, 0x3f7d3dcf, 0xbf78be4e, 0x00003e99
.long 0xbe1b3f80, 0x3ee1bf74, 0xbf303f52, 0x0000bf1d, 0xbf7d0000, 0x3f663e99, 0xbf3abf12, 0x00003f4a
.long 0x00000000, 0x00000000, 0x00000000, 0x00000000, 0x00000000, 0x00000000, 0x00000000, 0x00000000
.long 0x00000000, 0x00000000, 0x00000000, 0x00000000, 0x00000000, 0x00000000, 0x00000000, 0x00000000
.long 0x00000000, 0x00000000, 0x00000000, 0x00000000, 0x00000000, 0x00000000, 0x00000000, 0x00000000
.long 0x00000000, 0x00000000, 0x00000000, 0x00000000, 0x00000000, 0x00000000, 0x00000000, 0x00000000
.long 0x00000000, 0x00000000, 0x00000000, 0x00000000, 0x00000000, 0x00000000, 0x00000000, 0x00000000
.long 0x00000000, 0x00000000, 0x00000000, 0x00000000, 0x00000000, 0x00000000, 0x00000000, 0x00000000
.long 0x00000000, 0x00000000, 0x00000000, 0x00000000, 0x00000000, 0x00000000, 0x00000000, 0x00000000
.long 0x00000000, 0x00000000, 0x00000000, 0x00000000, 0x00000000, 0x00000000, 0x00000000, 0x00000000
.long 0xbd4f3f80, 0x3e1bbf7f, 0xbe803f7b, 0x0000bf74, 0xbf800000, 0x3f7d3dcf, 0xbf78be4e, 0x00003e99
.long 0xbe1b3f80, 0x3ee1bf74, 0xbf303f52, 0x0000bf1d, 0xbf7d0000, 0x3f663e99, 0xbf3abf12, 0x00003f4a
.long 0x00000000, 0x00000000, 0x00000000, 0x00000000, 0x00000000, 0x00000000, 0x00000000, 0x00000000
.long 0x00000000, 0x00000000, 0x00000000, 0x00000000, 0x00000000, 0x00000000, 0x00000000, 0x00000000
.long 0x00000000, 0x00000000, 0x00000000, 0x00000000, 0x00000000, 0x00000000, 0x00000000, 0x00000000
.long 0x00000000, 0x00000000, 0x00000000, 0x00000000, 0x00000000, 0x00000000, 0x00000000, 0x00000000
.long 0x00000000, 0x00000000, 0x00000000, 0x00000000, 0x00000000, 0x00000000, 0x00000000, 0x00000000
.long 0x00000000, 0x00000000, 0x00000000, 0x00000000, 0x00000000, 0x00000000, 0x00000000, 0x00000000
.long 0x00000000, 0x00000000, 0x00000000, 0x00000000, 0x00000000, 0x00000000, 0x00000000, 0x00000000
.long 0x00000000, 0x00000000, 0x00000000, 0x00000000, 0x00000000, 0x00000000, 0x00000000, 0x00000000
.long 0xbd4f3f80, 0x3e1bbf7f, 0xbe803f7b, 0x0000bf74, 0xbf800000, 0x3f7d3dcf, 0xbf78be4e, 0x00003e99
.long 0xbe1b3f80, 0x3ee1bf74, 0xbf303f52, 0x0000bf1d, 0xbf7d0000, 0x3f663e99, 0xbf3abf12, 0x00003f4a
.long 0x00000000, 0x00000000, 0x00000000, 0x00000000, 0x00000000, 0x00000000, 0x00000000, 0x00000000
.long 0x00000000, 0x00000000, 0x00000000, 0x00000000, 0x00000000, 0x00000000, 0x00000000, 0x00000000
.long 0x00000000, 0x00000000, 0x00000000, 0x00000000, 0x00000000, 0x00000000, 0x00000000, 0x00000000
.long 0x00000000, 0x00000000, 0x00000000, 0x00000000, 0x00000000, 0x00000000, 0x00000000, 0x00000000
.long 0x00000000, 0x00000000, 0x00000000, 0x00000000, 0x00000000, 0x00000000, 0x00000000, 0x00000000
.long 0x00000000, 0x00000000, 0x00000000, 0x00000000, 0x00000000, 0x00000000, 0x00000000, 0x00000000
.long 0x00000000, 0x00000000, 0x00000000, 0x00000000, 0x00000000, 0x00000000, 0x00000000, 0x00000000
.long 0x00000000, 0x00000000, 0x00000000, 0x00000000, 0x00000000, 0x00000000, 0x00000000, 0x00000000
.long 0xbd4f3f80, 0x3e1bbf7f, 0xbe803f7b, 0x0000bf74, 0xbf800000, 0x3f7d3dcf, 0xbf78be4e, 0x00003e99
.long 0xbe1b3f80, 0x3ee1bf74, 0xbf303f52, 0x0000bf1d, 0xbf7d0000, 0x3f663e99, 0xbf3abf12, 0x00003f4a
.long 0xbe803f80, 0x3f30bf60, 0xbf743f07, 0x0000bd4f, 0xbf780000, 0x3f3a3ef8, 0xbe99bf59, 0x00003f80
.long 0xbeb23f80, 0x3f60bf42, 0xbf7b3e1b, 0x00003f07, 0xbf700000, 0x3ef83f27, 0x3e4ebf7d, 0x00003f59
.long 0x00000000, 0x00000000, 0x00000000, 0x00000000, 0x00000000, 0x00000000, 0x00000000, 0x00000000
.long 0x00000000, 0x00000000, 0x00000000, 0x00000000, 0x00000000, 0x00000000, 0x00000000, 0x00000000
.long 0x00000000, 0x00000000, 0x00000000, 0x00000000, 0x00000000, 0x00000000, 0x00000000, 0x00000000
.long 0x00000000, 0x00000000, 0x00000000, 0x00000000, 0x00000000, 0x00000000, 0x00000000, 0x00000000
.long 0x00000000, 0x00000000, 0x00000000, 0x00000000, 0x00000000, 0x00000000, 0x00000000, 0x00000000
.long 0x00000000, 0x00000000, 0x00000000, 0x00000000, 0x00000000, 0x00000000, 0x00000000, 0x00000000
.long 0x00000000, 0x00000000, 0x00000000, 0x00000000, 0x00000000, 0x00000000, 0x00000000, 0x00000000
.long 0x00000000, 0x00000000, 0x00000000, 0x00000000, 0x00000000, 0x00000000, 0x00000000, 0x00000000
.long 0xbe803f80, 0x3f30bf60, 0xbf743f07, 0x0000bd4f, 0xbf780000, 0x3f3a3ef8, 0xbe99bf59, 0x00003f80
.long 0xbeb23f80, 0x3f60bf42, 0xbf7b3e1b, 0x00003f07, 0xbf700000, 0x3ef83f27, 0x3e4ebf7d, 0x00003f59
.long 0x00000000, 0x00000000, 0x00000000, 0x00000000, 0x00000000, 0x00000000, 0x00000000, 0x00000000
.long 0x00000000, 0x00000000, 0x00000000, 0x00000000, 0x00000000, 0x00000000, 0x00000000, 0x00000000
.long 0x00000000, 0x00000000, 0x00000000, 0x00000000, 0x00000000, 0x00000000, 0x00000000, 0x00000000
.long 0x00000000, 0x00000000, 0x00000000, 0x00000000, 0x00000000, 0x00000000, 0x00000000, 0x00000000
.long 0x00000000, 0x00000000, 0x00000000, 0x00000000, 0x00000000, 0x00000000, 0x00000000, 0x00000000
.long 0x00000000, 0x00000000, 0x00000000, 0x00000000, 0x00000000, 0x00000000, 0x00000000, 0x00000000
.long 0x00000000, 0x00000000, 0x00000000, 0x00000000, 0x00000000, 0x00000000, 0x00000000, 0x00000000
.long 0x00000000, 0x00000000, 0x00000000, 0x00000000, 0x00000000, 0x00000000, 0x00000000, 0x00000000
.long 0xbe803f80, 0x3f30bf60, 0xbf743f07, 0x0000bd4f, 0xbf780000, 0x3f3a3ef8, 0xbe99bf59, 0x00003f80
.long 0xbeb23f80, 0x3f60bf42, 0xbf7b3e1b, 0x00003f07, 0xbf700000, 0x3ef83f27, 0x3e4ebf7d, 0x00003f59
.long 0x00000000, 0x00000000, 0x00000000, 0x00000000, 0x00000000, 0x00000000, 0x00000000, 0x00000000
.long 0x00000000, 0x00000000, 0x00000000, 0x00000000, 0x00000000, 0x00000000, 0x00000000, 0x00000000
.long 0x00000000, 0x00000000, 0x00000000, 0x00000000, 0x00000000, 0x00000000, 0x00000000, 0x00000000
.long 0x00000000, 0x00000000, 0x00000000, 0x00000000, 0x00000000, 0x00000000, 0x00000000, 0x00000000
.long 0x00000000, 0x00000000, 0x00000000, 0x00000000, 0x00000000, 0x00000000, 0x00000000, 0x00000000
.long 0x00000000, 0x00000000, 0x00000000, 0x00000000, 0x00000000, 0x00000000, 0x00000000, 0x00000000
.long 0x00000000, 0x00000000, 0x00000000, 0x00000000, 0x00000000, 0x00000000, 0x00000000, 0x00000000
.long 0x00000000, 0x00000000, 0x00000000, 0x00000000, 0x00000000, 0x00000000, 0x00000000, 0x00000000
.long 0xbe803f80, 0x3f30bf60, 0xbf743f07, 0x0000bd4f, 0xbf780000, 0x3f3a3ef8, 0xbe99bf59, 0x00003f80
.long 0xbeb23f80, 0x3f60bf42, 0xbf7b3e1b, 0x00003f07, 0xbf700000, 0x3ef83f27, 0x3e4ebf7d, 0x00003f59
.long 0xbee13f80, 0x3f7bbf1d, 0xbf42be80, 0x00003f6b, 0xbf660000, 0x3e4e3f4a, 0x3f27bf78, 0x00003eca
.long 0xbf073f80, 0x3f7fbee1, 0xbeb2bf1d, 0x00003f7b, 0xbf590000, 0xbdcf3f66, 0x3f70bf4a, 0x0000be4e
.long 0x00000000, 0x00000000, 0x00000000, 0x00000000, 0x00000000, 0x00000000, 0x00000000, 0x00000000
.long 0x00000000, 0x00000000, 0x00000000, 0x00000000, 0x00000000, 0x00000000, 0x00000000, 0x00000000
.long 0x00000000, 0x00000000, 0x00000000, 0x00000000, 0x00000000, 0x00000000, 0x00000000, 0x00000000
.long 0x00000000, 0x00000000, 0x00000000, 0x00000000, 0x00000000, 0x00000000, 0x00000000, 0x00000000
.long 0x00000000, 0x00000000, 0x00000000, 0x00000000, 0x00000000, 0x00000000, 0x00000000, 0x00000000
.long 0x00000000, 0x00000000, 0x00000000, 0x00000000, 0x00000000, 0x00000000, 0x00000000, 0x00000000
.long 0x00000000, 0x00000000, 0x00000000, 0x00000000, 0x00000000, 0x00000000, 0x00000000, 0x00000000
.long 0x00000000, 0x00000000, 0x00000000, 0x00000000, 0x00000000, 0x00000000, 0x00000000, 0x00000000
.long 0xbee13f80, 0x3f7bbf1d, 0xbf42be80, 0x00003f6b, 0xbf660000, 0x3e4e3f4a, 0x3f27bf78, 0x00003eca
.long 0xbf073f80, 0x3f7fbee1, 0xbeb2bf1d, 0x00003f7b, 0xbf590000, 0xbdcf3f66, 0x3f70bf4a, 0x0000be4e
.long 0x00000000, 0x00000000, 0x00000000, 0x00000000, 0x00000000, 0x00000000, 0x00000000, 0x00000000
.long 0x00000000, 0x00000000, 0x00000000, 0x00000000, 0x00000000, 0x00000000, 0x00000000, 0x00000000
.long 0x00000000, 0x00000000, 0x00000000, 0x00000000, 0x00000000, 0x00000000, 0x00000000, 0x00000000
.long 0x00000000, 0x00000000, 0x00000000, 0x00000000, 0x00000000, 0x00000000, 0x00000000, 0x00000000
.long 0x00000000, 0x00000000, 0x00000000, 0x00000000, 0x00000000, 0x00000000, 0x00000000, 0x00000000
.long 0x00000000, 0x00000000, 0x00000000, 0x00000000, 0x00000000, 0x00000000, 0x00000000, 0x00000000
.long 0x00000000, 0x00000000, 0x00000000, 0x00000000, 0x00000000, 0x00000000, 0x00000000, 0x00000000
.long 0x00000000, 0x00000000, 0x00000000, 0x00000000, 0x00000000, 0x00000000, 0x00000000, 0x00000000
.long 0xbee13f80, 0x3f7bbf1d, 0xbf42be80, 0x00003f6b, 0xbf660000, 0x3e4e3f4a, 0x3f27bf78, 0x00003eca
.long 0xbf073f80, 0x3f7fbee1, 0xbeb2bf1d, 0x00003f7b, 0xbf590000, 0xbdcf3f66, 0x3f70bf4a, 0x0000be4e
.long 0x00000000, 0x00000000, 0x00000000, 0x00000000, 0x00000000, 0x00000000, 0x00000000, 0x00000000
.long 0x00000000, 0x00000000, 0x00000000, 0x00000000, 0x00000000, 0x00000000, 0x00000000, 0x00000000
.long 0x00000000, 0x00000000, 0x00000000, 0x00000000, 0x00000000, 0x00000000, 0x00000000, 0x00000000
.long 0x00000000, 0x00000000, 0x00000000, 0x00000000, 0x00000000, 0x00000000, 0x00000000, 0x00000000
.long 0x00000000, 0x00000000, 0x00000000, 0x00000000, 0x00000000, 0x00000000, 0x00000000, 0x00000000
.long 0x00000000, 0x00000000, 0x00000000, 0x00000000, 0x00000000, 0x00000000, 0x00000000, 0x00000000
.long 0x00000000, 0x00000000, 0x00000000, 0x00000000, 0x00000000, 0x00000000, 0x00000000, 0x00000000
.long 0x00000000, 0x00000000, 0x00000000, 0x00000000, 0x00000000, 0x00000000, 0x00000000, 0x00000000
.long 0xbee13f80, 0x3f7bbf1d, 0xbf42be80, 0x00003f6b, 0xbf660000, 0x3e4e3f4a, 0x3f27bf78, 0x00003eca
.long 0xbf073f80, 0x3f7fbee1, 0xbeb2bf1d, 0x00003f7b, 0xbf590000, 0xbdcf3f66, 0x3f70bf4a, 0x0000be4e
.long 0xbf1d3f80, 0x3f6bbe80, 0x3e1bbf60, 0x00003f30, 0xbf4a0000, 0xbeca3f78, 0x3f7dbef8, 0x0000bf3a
.long 0xbf303f80, 0x3f42bd4f, 0x3f1dbf7f, 0x00003e1b, 0xbf3a0000, 0xbf273f80, 0x3f4abdcf, 0x0000bf7d
.long 0x00000000, 0x00000000, 0x00000000, 0x00000000, 0x00000000, 0x00000000, 0x00000000, 0x00000000
.long 0x00000000, 0x00000000, 0x00000000, 0x00000000, 0x00000000, 0x00000000, 0x00000000, 0x00000000
.long 0x00000000, 0x00000000, 0x00000000, 0x00000000, 0x00000000, 0x00000000, 0x00000000, 0x00000000
.long 0x00000000, 0x00000000, 0x00000000, 0x00000000, 0x00000000, 0x00000000, 0x00000000, 0x00000000
.long 0x00000000, 0x00000000, 0x00000000, 0x00000000, 0x00000000, 0x00000000, 0x00000000, 0x00000000
.long 0x00000000, 0x00000000, 0x00000000, 0x00000000, 0x00000000, 0x00000000, 0x00000000, 0x00000000
.long 0x00000000, 0x00000000, 0x00000000, 0x00000000, 0x00000000, 0x00000000, 0x00000000, 0x00000000
.long 0x00000000, 0x00000000, 0x00000000, 0x00000000, 0x00000000, 0x00000000, 0x00000000, 0x00000000
.long 0xbf1d3f80, 0x3f6bbe80, 0x3e1bbf60, 0x00003f30, 0xbf4a0000, 0xbeca3f78, 0x3f7dbef8, 0x0000bf3a
.long 0xbf303f80, 0x3f42bd4f, 0x3f1dbf7f, 0x00003e1b, 0xbf3a0000, 0xbf273f80, 0x3f4abdcf, 0x0000bf7d
.long 0x00000000, 0x00000000, 0x00000000, 0x00000000, 0x00000000, 0x00000000, 0x00000000, 0x00000000
.long 0x00000000, 0x00000000, 0x00000000, 0x00000000, 0x00000000, 0x00000000, 0x00000000, 0x00000000
.long 0x00000000, 0x00000000, 0x00000000, 0x00000000, 0x00000000, 0x00000000, 0x00000000, 0x00000000
.long 0x00000000, 0x00000000, 0x00000000, 0x00000000, 0x00000000, 0x00000000, 0x00000000, 0x00000000
.long 0x00000000, 0x00000000, 0x00000000, 0x00000000, 0x00000000, 0x00000000, 0x00000000, 0x00000000
.long 0x00000000, 0x00000000, 0x00000000, 0x00000000, 0x00000000, 0x00000000, 0x00000000, 0x00000000
.long 0x00000000, 0x00000000, 0x00000000, 0x00000000, 0x00000000, 0x00000000, 0x00000000, 0x00000000
.long 0x00000000, 0x00000000, 0x00000000, 0x00000000, 0x00000000, 0x00000000, 0x00000000, 0x00000000
.long 0xbf1d3f80, 0x3f6bbe80, 0x3e1bbf60, 0x00003f30, 0xbf4a0000, 0xbeca3f78, 0x3f7dbef8, 0x0000bf3a
.long 0xbf303f80, 0x3f42bd4f, 0x3f1dbf7f, 0x00003e1b, 0xbf3a0000, 0xbf273f80, 0x3f4abdcf, 0x0000bf7d
.long 0x00000000, 0x00000000, 0x00000000, 0x00000000, 0x00000000, 0x00000000, 0x00000000, 0x00000000
.long 0x00000000, 0x00000000, 0x00000000, 0x00000000, 0x00000000, 0x00000000, 0x00000000, 0x00000000
.long 0x00000000, 0x00000000, 0x00000000, 0x00000000, 0x00000000, 0x00000000, 0x00000000, 0x00000000
.long 0x00000000, 0x00000000, 0x00000000, 0x00000000, 0x00000000, 0x00000000, 0x00000000, 0x00000000
.long 0x00000000, 0x00000000, 0x00000000, 0x00000000, 0x00000000, 0x00000000, 0x00000000, 0x00000000
.long 0x00000000, 0x00000000, 0x00000000, 0x00000000, 0x00000000, 0x00000000, 0x00000000, 0x00000000
.long 0x00000000, 0x00000000, 0x00000000, 0x00000000, 0x00000000, 0x00000000, 0x00000000, 0x00000000
.long 0x00000000, 0x00000000, 0x00000000, 0x00000000, 0x00000000, 0x00000000, 0x00000000, 0x00000000
.long 0xbf1d3f80, 0x3f6bbe80, 0x3e1bbf60, 0x00003f30, 0xbf4a0000, 0xbeca3f78, 0x3f7dbef8, 0x0000bf3a
.long 0xbf303f80, 0x3f42bd4f, 0x3f1dbf7f, 0x00003e1b, 0xbf3a0000, 0xbf273f80, 0x3f4abdcf, 0x0000bf7d
.long 0xbf423f80, 0x3f073e1b, 0x3f6bbf74, 0x0000bee1, 0xbf270000, 0xbf593f7d, 0x3eca3e99, 0x0000bf66
.long 0xbf523f80, 0x3e803eb2, 0x3f7fbf42, 0x0000bf60, 0xbf120000, 0xbf783f70, 0xbdcf3f27, 0x0000bef8
.long 0x00000000, 0x00000000, 0x00000000, 0x00000000, 0x00000000, 0x00000000, 0x00000000, 0x00000000
.long 0x00000000, 0x00000000, 0x00000000, 0x00000000, 0x00000000, 0x00000000, 0x00000000, 0x00000000
.long 0x00000000, 0x00000000, 0x00000000, 0x00000000, 0x00000000, 0x00000000, 0x00000000, 0x00000000
.long 0x00000000, 0x00000000, 0x00000000, 0x00000000, 0x00000000, 0x00000000, 0x00000000, 0x00000000
.long 0x00000000, 0x00000000, 0x00000000, 0x00000000, 0x00000000, 0x00000000, 0x00000000, 0x00000000
.long 0x00000000, 0x00000000, 0x00000000, 0x00000000, 0x00000000, 0x00000000, 0x00000000, 0x00000000
.long 0x00000000, 0x00000000, 0x00000000, 0x00000000, 0x00000000, 0x00000000, 0x00000000, 0x00000000
.long 0x00000000, 0x00000000, 0x00000000, 0x00000000, 0x00000000, 0x00000000, 0x00000000, 0x00000000
.long 0xbf423f80, 0x3f073e1b, 0x3f6bbf74, 0x0000bee1, 0xbf270000, 0xbf593f7d, 0x3eca3e99, 0x0000bf66
.long 0xbf523f80, 0x3e803eb2, 0x3f7fbf42, 0x0000bf60, 0xbf120000, 0xbf783f70, 0xbdcf3f27, 0x0000bef8
.long 0x00000000, 0x00000000, 0x00000000, 0x00000000, 0x00000000, 0x00000000, 0x00000000, 0x00000000
.long 0x00000000, 0x00000000, 0x00000000, 0x00000000, 0x00000000, 0x00000000, 0x00000000, 0x00000000
.long 0x00000000, 0x00000000, 0x00000000, 0x00000000, 0x00000000, 0x00000000, 0x00000000, 0x00000000
.long 0x00000000, 0x00000000, 0x00000000, 0x00000000, 0x00000000, 0x00000000, 0x00000000, 0x00000000
.long 0x00000000, 0x00000000, 0x00000000, 0x00000000, 0x00000000, 0x00000000, 0x00000000, 0x00000000
.long 0x00000000, 0x00000000, 0x00000000, 0x00000000, 0x00000000, 0x00000000, 0x00000000, 0x00000000
.long 0x00000000, 0x00000000, 0x00000000, 0x00000000, 0x00000000, 0x00000000, 0x00000000, 0x00000000
.long 0x00000000, 0x00000000, 0x00000000, 0x00000000, 0x00000000, 0x00000000, 0x00000000, 0x00000000
.long 0xbf423f80, 0x3f073e1b, 0x3f6bbf74, 0x0000bee1, 0xbf270000, 0xbf593f7d, 0x3eca3e99, 0x0000bf66
.long 0xbf523f80, 0x3e803eb2, 0x3f7fbf42, 0x0000bf60, 0xbf120000, 0xbf783f70, 0xbdcf3f27, 0x0000bef8
.long 0x00000000, 0x00000000, 0x00000000, 0x00000000, 0x00000000, 0x00000000, 0x00000000, 0x00000000
.long 0x00000000, 0x00000000, 0x00000000, 0x00000000, 0x00000000, 0x00000000, 0x00000000, 0x00000000
.long 0x00000000, 0x00000000, 0x00000000, 0x00000000, 0x00000000, 0x00000000, 0x00000000, 0x00000000
.long 0x00000000, 0x00000000, 0x00000000, 0x00000000, 0x00000000, 0x00000000, 0x00000000, 0x00000000
.long 0x00000000, 0x00000000, 0x00000000, 0x00000000, 0x00000000, 0x00000000, 0x00000000, 0x00000000
.long 0x00000000, 0x00000000, 0x00000000, 0x00000000, 0x00000000, 0x00000000, 0x00000000, 0x00000000
.long 0x00000000, 0x00000000, 0x00000000, 0x00000000, 0x00000000, 0x00000000, 0x00000000, 0x00000000
.long 0x00000000, 0x00000000, 0x00000000, 0x00000000, 0x00000000, 0x00000000, 0x00000000, 0x00000000
.long 0xbf423f80, 0x3f073e1b, 0x3f6bbf74, 0x0000bee1, 0xbf270000, 0xbf593f7d, 0x3eca3e99, 0x0000bf66
.long 0xbf523f80, 0x3e803eb2, 0x3f7fbf42, 0x0000bf60, 0xbf120000, 0xbf783f70, 0xbdcf3f27, 0x0000bef8
.long 0xbf603f80, 0xbd4f3f07, 0x3f52bee1, 0x0000bf7f, 0xbef80000, 0xbf803f59, 0xbf123f66, 0x00003dcf
.long 0xbf6b3f80, 0xbeb23f30, 0x3ee1bd4f, 0x0000bf42, 0xbeca0000, 0xbf703f3a, 0xbf663f80, 0x00003f27
.long 0x00000000, 0x00000000, 0x00000000, 0x00000000, 0x00000000, 0x00000000, 0x00000000, 0x00000000
.long 0x00000000, 0x00000000, 0x00000000, 0x00000000, 0x00000000, 0x00000000, 0x00000000, 0x00000000
.long 0x00000000, 0x00000000, 0x00000000, 0x00000000, 0x00000000, 0x00000000, 0x00000000, 0x00000000
.long 0x00000000, 0x00000000, 0x00000000, 0x00000000, 0x00000000, 0x00000000, 0x00000000, 0x00000000
.long 0x00000000, 0x00000000, 0x00000000, 0x00000000, 0x00000000, 0x00000000, 0x00000000, 0x00000000
.long 0x00000000, 0x00000000, 0x00000000, 0x00000000, 0x00000000, 0x00000000, 0x00000000, 0x00000000
.long 0x00000000, 0x00000000, 0x00000000, 0x00000000, 0x00000000, 0x00000000, 0x00000000, 0x00000000
.long 0x00000000, 0x00000000, 0x00000000, 0x00000000, 0x00000000, 0x00000000, 0x00000000, 0x00000000
.long 0xbf603f80, 0xbd4f3f07, 0x3f52bee1, 0x0000bf7f, 0xbef80000, 0xbf803f59, 0xbf123f66, 0x00003dcf
.long 0xbf6b3f80, 0xbeb23f30, 0x3ee1bd4f, 0x0000bf42, 0xbeca0000, 0xbf703f3a, 0xbf663f80, 0x00003f27
.long 0x00000000, 0x00000000, 0x00000000, 0x00000000, 0x00000000, 0x00000000, 0x00000000, 0x00000000
.long 0x00000000, 0x00000000, 0x00000000, 0x00000000, 0x00000000, 0x00000000, 0x00000000, 0x00000000
.long 0x00000000, 0x00000000, 0x00000000, 0x00000000, 0x00000000, 0x00000000, 0x00000000, 0x00000000
.long 0x00000000, 0x00000000, 0x00000000, 0x00000000, 0x00000000, 0x00000000, 0x00000000, 0x00000000
.long 0x00000000, 0x00000000, 0x00000000, 0x00000000, 0x00000000, 0x00000000, 0x00000000, 0x00000000
.long 0x00000000, 0x00000000, 0x00000000, 0x00000000, 0x00000000, 0x00000000, 0x00000000, 0x00000000
.long 0x00000000, 0x00000000, 0x00000000, 0x00000000, 0x00000000, 0x00000000, 0x00000000, 0x00000000
.long 0x00000000, 0x00000000, 0x00000000, 0x00000000, 0x00000000, 0x00000000, 0x00000000, 0x00000000
.long 0xbf603f80, 0xbd4f3f07, 0x3f52bee1, 0x0000bf7f, 0xbef80000, 0xbf803f59, 0xbf123f66, 0x00003dcf
.long 0xbf6b3f80, 0xbeb23f30, 0x3ee1bd4f, 0x0000bf42, 0xbeca0000, 0xbf703f3a, 0xbf663f80, 0x00003f27
.long 0x00000000, 0x00000000, 0x00000000, 0x00000000, 0x00000000, 0x00000000, 0x00000000, 0x00000000
.long 0x00000000, 0x00000000, 0x00000000, 0x00000000, 0x00000000, 0x00000000, 0x00000000, 0x00000000
.long 0x00000000, 0x00000000, 0x00000000, 0x00000000, 0x00000000, 0x00000000, 0x00000000, 0x00000000
.long 0x00000000, 0x00000000, 0x00000000, 0x00000000, 0x00000000, 0x00000000, 0x00000000, 0x00000000
.long 0x00000000, 0x00000000, 0x00000000, 0x00000000, 0x00000000, 0x00000000, 0x00000000, 0x00000000
.long 0x00000000, 0x00000000, 0x00000000, 0x00000000, 0x00000000, 0x00000000, 0x00000000, 0x00000000
.long 0x00000000, 0x00000000, 0x00000000, 0x00000000, 0x00000000, 0x00000000, 0x00000000, 0x00000000
.long 0x00000000, 0x00000000, 0x00000000, 0x00000000, 0x00000000, 0x00000000, 0x00000000, 0x00000000
.long 0xbf603f80, 0xbd4f3f07, 0x3f52bee1, 0x0000bf7f, 0xbef80000, 0xbf803f59, 0xbf123f66, 0x00003dcf
.long 0xbf6b3f80, 0xbeb23f30, 0x3ee1bd4f, 0x0000bf42, 0xbeca0000, 0xbf703f3a, 0xbf663f80, 0x00003f27
.long 0xbf743f80, 0xbf1d3f52, 0xbd4f3eb2, 0x0000be80, 0xbe990000, 0xbf4a3f12, 0xbf803f70, 0x00003f78
.long 0xbf7b3f80, 0xbf523f6b, 0xbf073f30, 0x00003eb2, 0xbe4e0000, 0xbf123eca, 0xbf593f3a, 0x00003f70
.long 0x00000000, 0x00000000, 0x00000000, 0x00000000, 0x00000000, 0x00000000, 0x00000000, 0x00000000
.long 0x00000000, 0x00000000, 0x00000000, 0x00000000, 0x00000000, 0x00000000, 0x00000000, 0x00000000
.long 0x00000000, 0x00000000, 0x00000000, 0x00000000, 0x00000000, 0x00000000, 0x00000000, 0x00000000
.long 0x00000000, 0x00000000, 0x00000000, 0x00000000, 0x00000000, 0x00000000, 0x00000000, 0x00000000
.long 0x00000000, 0x00000000, 0x00000000, 0x00000000, 0x00000000, 0x00000000, 0x00000000, 0x00000000
.long 0x00000000, 0x00000000, 0x00000000, 0x00000000, 0x00000000, 0x00000000, 0x00000000, 0x00000000
.long 0x00000000, 0x00000000, 0x00000000, 0x00000000, 0x00000000, 0x00000000, 0x00000000, 0x00000000
.long 0x00000000, 0x00000000, 0x00000000, 0x00000000, 0x00000000, 0x00000000, 0x00000000, 0x00000000
.long 0xbf743f80, 0xbf1d3f52, 0xbd4f3eb2, 0x0000be80, 0xbe990000, 0xbf4a3f12, 0xbf803f70, 0x00003f78
.long 0xbf7b3f80, 0xbf523f6b, 0xbf073f30, 0x00003eb2, 0xbe4e0000, 0xbf123eca, 0xbf593f3a, 0x00003f70
.long 0x00000000, 0x00000000, 0x00000000, 0x00000000, 0x00000000, 0x00000000, 0x00000000, 0x00000000
.long 0x00000000, 0x00000000, 0x00000000, 0x00000000, 0x00000000, 0x00000000, 0x00000000, 0x00000000
.long 0x00000000, 0x00000000, 0x00000000, 0x00000000, 0x00000000, 0x00000000, 0x00000000, 0x00000000
.long 0x00000000, 0x00000000, 0x00000000, 0x00000000, 0x00000000, 0x00000000, 0x00000000, 0x00000000
.long 0x00000000, 0x00000000, 0x00000000, 0x00000000, 0x00000000, 0x00000000, 0x00000000, 0x00000000
.long 0x00000000, 0x00000000, 0x00000000, 0x00000000, 0x00000000, 0x00000000, 0x00000000, 0x00000000
.long 0x00000000, 0x00000000, 0x00000000, 0x00000000, 0x00000000, 0x00000000, 0x00000000, 0x00000000
.long 0x00000000, 0x00000000, 0x00000000, 0x00000000, 0x00000000, 0x00000000, 0x00000000, 0x00000000
.long 0xbf743f80, 0xbf1d3f52, 0xbd4f3eb2, 0x0000be80, 0xbe990000, 0xbf4a3f12, 0xbf803f70, 0x00003f78
.long 0xbf7b3f80, 0xbf523f6b, 0xbf073f30, 0x00003eb2, 0xbe4e0000, 0xbf123eca, 0xbf593f3a, 0x00003f70
.long 0x00000000, 0x00000000, 0x00000000, 0x00000000, 0x00000000, 0x00000000, 0x00000000, 0x00000000
.long 0x00000000, 0x00000000, 0x00000000, 0x00000000, 0x00000000, 0x00000000, 0x00000000, 0x00000000
.long 0x00000000, 0x00000000, 0x00000000, 0x00000000, 0x00000000, 0x00000000, 0x00000000, 0x00000000
.long 0x00000000, 0x00000000, 0x00000000, 0x00000000, 0x00000000, 0x00000000, 0x00000000, 0x00000000
.long 0x00000000, 0x00000000, 0x00000000, 0x00000000, 0x00000000, 0x00000000, 0x00000000, 0x00000000
.long 0x00000000, 0x00000000, 0x00000000, 0x00000000, 0x00000000, 0x00000000, 0x00000000, 0x00000000
.long 0x00000000, 0x00000000, 0x00000000, 0x00000000, 0x00000000, 0x00000000, 0x00000000, 0x00000000
.long 0x00000000, 0x00000000, 0x00000000, 0x00000000, 0x00000000, 0x00000000, 0x00000000, 0x00000000
.long 0xbf743f80, 0xbf1d3f52, 0xbd4f3eb2, 0x0000be80, 0xbe990000, 0xbf4a3f12, 0xbf803f70, 0x00003f78
.long 0xbf7b3f80, 0xbf523f6b, 0xbf073f30, 0x00003eb2, 0xbe4e0000, 0xbf123eca, 0xbf593f3a, 0x00003f70
.long 0xbf7f3f80, 0xbf743f7b, 0xbf603f6b, 0x00003f52, 0xbdcf0000, 0xbe993e4e, 0xbef83eca, 0x00003f12
.long 0xbf803f80, 0xbf803f80, 0xbf803f80, 0x00003f80, 0x00000000, 0x00000000, 0x00000000, 0x00000000
.long 0x00000000, 0x00000000, 0x00000000, 0x00000000, 0x00000000, 0x00000000, 0x00000000, 0x00000000
.long 0x00000000, 0x00000000, 0x00000000, 0x00000000, 0x00000000, 0x00000000, 0x00000000, 0x00000000
.long 0x00000000, 0x00000000, 0x00000000, 0x00000000, 0x00000000, 0x00000000, 0x00000000, 0x00000000
.long 0x00000000, 0x00000000, 0x00000000, 0x00000000, 0x00000000, 0x00000000, 0x00000000, 0x00000000
.long 0x00000000, 0x00000000, 0x00000000, 0x00000000, 0x00000000, 0x00000000, 0x00000000, 0x00000000
.long 0x00000000, 0x00000000, 0x00000000, 0x00000000, 0x00000000, 0x00000000, 0x00000000, 0x00000000
.long 0x00000000, 0x00000000, 0x00000000, 0x00000000, 0x00000000, 0x00000000, 0x00000000, 0x00000000
.long 0x00000000, 0x00000000, 0x00000000, 0x00000000, 0x00000000, 0x00000000, 0x00000000, 0x00000000
.long 0xbf7f3f80, 0xbf743f7b, 0xbf603f6b, 0x00003f52, 0xbdcf0000, 0xbe993e4e, 0xbef83eca, 0x00003f12
.long 0xbf803f80, 0xbf803f80, 0xbf803f80, 0x00003f80, 0x00000000, 0x00000000, 0x00000000, 0x00000000
.long 0x00000000, 0x00000000, 0x00000000, 0x00000000, 0x00000000, 0x00000000, 0x00000000, 0x00000000
.long 0x00000000, 0x00000000, 0x00000000, 0x00000000, 0x00000000, 0x00000000, 0x00000000, 0x00000000
.long 0x00000000, 0x00000000, 0x00000000, 0x00000000, 0x00000000, 0x00000000, 0x00000000, 0x00000000
.long 0x00000000, 0x00000000, 0x00000000, 0x00000000, 0x00000000, 0x00000000, 0x00000000, 0x00000000
.long 0x00000000, 0x00000000, 0x00000000, 0x00000000, 0x00000000, 0x00000000, 0x00000000, 0x00000000
.long 0x00000000, 0x00000000, 0x00000000, 0x00000000, 0x00000000, 0x00000000, 0x00000000, 0x00000000
.long 0x00000000, 0x00000000, 0x00000000, 0x00000000, 0x00000000, 0x00000000, 0x00000000, 0x00000000
.long 0x00000000, 0x00000000, 0x00000000, 0x00000000, 0x00000000, 0x00000000, 0x00000000, 0x00000000
.long 0xbf7f3f80, 0xbf743f7b, 0xbf603f6b, 0x00003f52, 0xbdcf0000, 0xbe993e4e, 0xbef83eca, 0x00003f12
.long 0xbf803f80, 0xbf803f80, 0xbf803f80, 0x00003f80, 0x00000000, 0x00000000, 0x00000000, 0x00000000
.long 0x00000000, 0x00000000, 0x00000000, 0x00000000, 0x00000000, 0x00000000, 0x00000000, 0x00000000
.long 0x00000000, 0x00000000, 0x00000000, 0x00000000, 0x00000000, 0x00000000, 0x00000000, 0x00000000
.long 0x00000000, 0x00000000, 0x00000000, 0x00000000, 0x00000000, 0x00000000, 0x00000000, 0x00000000
.long 0x00000000, 0x00000000, 0x00000000, 0x00000000, 0x00000000, 0x00000000, 0x00000000, 0x00000000
.long 0x00000000, 0x00000000, 0x00000000, 0x00000000, 0x00000000, 0x00000000, 0x00000000, 0x00000000
.long 0x00000000, 0x00000000, 0x00000000, 0x00000000, 0x00000000, 0x00000000, 0x00000000, 0x00000000
.long 0x00000000, 0x00000000, 0x00000000, 0x00000000, 0x00000000, 0x00000000, 0x00000000, 0x00000000
.long 0x00000000, 0x00000000, 0x00000000, 0x00000000, 0x00000000, 0x00000000, 0x00000000, 0x00000000
.long 0xbf7f3f80, 0xbf743f7b, 0xbf603f6b, 0x00003f52, 0xbdcf0000, 0xbe993e4e, 0xbef83eca, 0x00003f12
.long 0xbf803f80, 0xbf803f80, 0xbf803f80, 0x00003f80, 0x00000000, 0x00000000, 0x00000000, 0x00000000
.long 0x3f803f80, 0x3f803f80, 0x3f803f80, 0x3f803f80, 0x00000000, 0x00000000, 0x00000000, 0x00000000
.long 0x3f7f3f80, 0x3f743f7b, 0x3f1d3f30, 0x3ee13f07, 0xbdcf0000, 0xbe99be4e, 0xbf4abf3a, 0xbf66bf59
.long 0x3f7b3f80, 0x3f523f6b, 0xbe80bd4f, 0xbf1dbee1, 0xbe4e0000, 0xbf12beca, 0xbf78bf80, 0xbf4abf66
.long 0x3f743f80, 0x3f1d3f52, 0xbf6bbf42, 0xbf7bbf7f, 0xbe990000, 0xbf4abf12, 0xbecabf27, 0x3e4ebdcf
.long 0x3f6b3f80, 0x3eb23f30, 0xbf60bf7f, 0xbe80bf1d, 0xbeca0000, 0xbf70bf3a, 0x3ef83dcf, 0x3f783f4a
.long 0x3f603f80, 0x3d4f3f07, 0xbe1bbf1d, 0x3f423eb2, 0xbef80000, 0xbf80bf59, 0x3f7d3f4a, 0x3f273f70
.long 0x3f523f80, 0xbe803eb2, 0x3f303e1b, 0x3f6b3f7b, 0xbf120000, 0xbf78bf70, 0x3f3a3f7d, 0xbeca3e4e
.long 0x3f423f80, 0xbf073e1b, 0x3f7f3f52, 0x3d4f3f30, 0xbf270000, 0xbf59bf7d, 0xbdcf3f12, 0xbf80bf3a
.long 0x3f803f80, 0x3f803f80, 0x3f803f80, 0x3f803f80, 0x00000000, 0x00000000, 0x00000000, 0x00000000
.long 0x3f603f6b, 0x3f423f52, 0x3e803eb2, 0x3d4f3e1b, 0xbef8beca, 0xbf27bf12, 0xbf78bf70, 0xbf80bf7d
.long 0x3f073f30, 0x3e1b3eb2, 0xbf60bf42, 0xbf7fbf74, 0xbf59bf3a, 0xbf7dbf70, 0xbef8bf27, 0xbdcfbe99
.long 0x3d4f3eb2, 0xbf07be80, 0xbf30bf60, 0xbe1bbee1, 0xbf80bf70, 0xbf59bf78, 0x3f3a3ef8, 0x3f7d3f66
.long 0xbee1bd4f, 0xbf74bf42, 0x3f073e1b, 0x3f7b3f52, 0xbf66bf80, 0xbe99bf27, 0x3f593f7d, 0x3e4e3f12
.long 0xbf52bee1, 0xbf6bbf7f, 0x3f743f7b, 0x3e803f30, 0xbf12bf66, 0x3ecabdcf, 0xbe993e4e, 0xbf78bf3a
.long 0xbf7fbf42, 0xbee1bf60, 0xbd4f3f07, 0xbf74bf1d, 0xbdcfbf27, 0x3f663ef8, 0xbf80bf59, 0xbe99bf4a
.long 0xbf6bbf74, 0x3e80bee1, 0xbf7bbf1d, 0xbeb2bf60, 0x3ecabe99, 0x3f783f66, 0xbe4ebf4a, 0x3f703ef8
.long 0x3f803f80, 0x3f803f80, 0x3f803f80, 0x3f803f80, 0x00000000, 0x00000000, 0x00000000, 0x00000000
.long 0xbe1bbd4f, 0xbeb2be80, 0xbf52bf42, 0xbf6bbf60, 0xbf7dbf80, 0xbf70bf78, 0xbf12bf27, 0xbecabef8
.long 0xbf74bf7f, 0xbf42bf60, 0x3eb23e1b, 0x3f303f07, 0x3e993dcf, 0x3f273ef8, 0x3f703f7d, 0x3f3a3f59
.long 0x3ee13e1b, 0x3f603f30, 0x3e803f07, 0xbeb2bd4f, 0x3f663f7d, 0x3ef83f3a, 0xbf78bf59, 0xbf70bf80
.long 0x3f523f7b, 0x3e1b3f07, 0xbf42bf74, 0xbd4fbee1, 0xbf12be4e, 0xbf7dbf59, 0x3f273e99, 0x3f803f66
.long 0xbf30be80, 0xbf7bbf74, 0x3f7f3f6b, 0x3ee13f52, 0xbf3abf78, 0x3e4ebe99, 0xbdcf3eca, 0xbf66bf12
.long 0xbf1dbf74, 0x3f07bd4f, 0xbf60bee1, 0xbf42bf7f, 0x3f4a3e99, 0x3f593f80, 0xbef8bf66, 0x3f273dcf
.long 0x3f603eb2, 0x3f1d3f7b, 0x3ee1be80, 0x3f743f6b, 0x3ef83f70, 0xbf4abe4e, 0x3f663f78, 0xbe993eca
.long 0x3f803f80, 0x3f803f80, 0x3f803f80, 0x3f803f80, 0x00000000, 0x00000000, 0x00000000, 0x00000000
.long 0xbf07bee1, 0xbf30bf1d, 0xbf7bbf74, 0xbf80bf7f, 0xbf59bf66, 0xbf3abf4a, 0xbe4ebe99, 0x0000bdcf
.long 0xbee1bf1d, 0xbd4fbe80, 0x3f6b3f52, 0x3f803f7b, 0x3f663f4a, 0x3f803f78, 0x3eca3f12, 0x00003e4e
.long 0x3f7f3f7b, 0x3f423f6b, 0xbf52bf1d, 0xbf80bf74, 0xbdcf3e4e, 0xbf27beca, 0xbf12bf4a, 0x0000be99
.long 0xbf1dbe80, 0xbf7fbf60, 0x3f303eb2, 0x3f803f6b, 0xbf4abf78, 0xbdcfbef8, 0x3f3a3f70, 0x00003eca
.long 0xbeb2bf42, 0x3f1d3e1b, 0xbf07bd4f, 0xbf80bf60, 0x3f703f27, 0x3f4a3f7d, 0xbf59bf80, 0x0000bef8
.long 0x3f7b3f6b, 0x3e1b3f30, 0x3eb2be80, 0x3f803f52, 0xbe4e3eca, 0xbf7dbf3a, 0x3f703f78, 0x00003f12
.long 0xbf30bd4f, 0xbf52bf7f, 0xbe1b3f07, 0xbf80bf42, 0xbf3abf80, 0x3f12bdcf, 0xbf7dbf59, 0x0000bf27
.long 0x3f803f80, 0x3f803f80, 0x3f803f80, 0x3f803f80, 0x00000000, 0x00000000, 0x00000000, 0x00000000
.long 0xbf7bbf7f, 0xbf6bbf74, 0xbf07bf1d, 0xbeb2bee1, 0x3e4e3dcf, 0x3eca3e99, 0x3f593f4a, 0x3f703f66
.long 0x3f6b3f7b, 0x3f303f52, 0xbee1be80, 0xbf42bf1d, 0xbecabe4e, 0xbf3abf12, 0xbf66bf78, 0xbf27bf4a
.long 0xbf52bf74, 0xbeb2bf1d, 0x3f7f3f6b, 0x3f603f7b, 0x3f123e99, 0x3f703f4a, 0x3dcf3eca, 0xbef8be4e
.long 0x3f303f6b, 0xbd4f3eb2, 0xbf1dbf60, 0x3e1bbe80, 0xbf3abeca, 0xbf80bf70, 0x3f4a3ef8, 0x3f7d3f78
.long 0xbf07bf60, 0x3ee1bd4f, 0xbeb23e1b, 0xbf7bbf42, 0x3f593ef8, 0x3f663f80, 0xbf70bf7d, 0xbe4ebf27
.long 0x3eb23f52, 0xbf42be80, 0x3f7b3f30, 0x3f073f6b, 0xbf70bf12, 0xbf27bf78, 0x3e4e3f3a, 0xbf59beca
.long 0xbe1bbf42, 0x3f743f07, 0xbf30bf7f, 0x3f1dbd4f, 0x3f7d3f27, 0x3e993f59, 0x3f3a3dcf, 0x3f4a3f80
.long 0x3f803f80, 0x3f803f80, 0x3f803f80, 0x3f803f80, 0x00000000, 0x00000000, 0x00000000, 0x00000000
.long 0xbf52bf60, 0xbf30bf42, 0xbe1bbe80, 0x3d4fbd4f, 0x3f123ef8, 0x3f3a3f27, 0x3f7d3f78, 0x3f803f80
.long 0x3eb23f07, 0xbd4f3e1b, 0xbf74bf60, 0xbf7fbf7f, 0xbf70bf59, 0xbf80bf7d, 0xbe99bef8, 0x3dcfbdcf
.long 0x3e80bd4f, 0x3f423f07, 0x3ee13f30, 0xbe1b3e1b, 0x3f783f80, 0x3f273f59, 0xbf66bf3a, 0xbf7dbf7d
.long 0xbf42bee1, 0xbf7fbf74, 0x3f523f07, 0x3f7b3f7b, 0xbf27bf66, 0x3dcfbe99, 0x3f123f59, 0xbe4e3e4e
.long 0x3f7f3f52, 0x3f1d3f6b, 0xbf30bf74, 0x3e80be80, 0x3dcf3f12, 0xbf4abeca, 0x3f3a3e99, 0x3f783f78
.long 0xbf60bf7f, 0x3e1bbee1, 0xbf1dbd4f, 0xbf74bf74, 0x3ef8bdcf, 0x3f7d3f66, 0xbf4abf80, 0x3e99be99
.long 0x3ee13f6b, 0xbf52be80, 0x3f603f7b, 0xbeb23eb2, 0xbf66beca, 0xbf12bf78, 0xbef83e4e, 0xbf70bf70
.long 0x3f803f80, 0x3f803f80, 0x3f803f80, 0x3f803f80, 0x00000000, 0x00000000, 0x00000000, 0x00000000
.long 0x3e803e1b, 0x3ee13eb2, 0x3f603f52, 0x3f743f6b, 0x3f783f7d, 0x3f663f70, 0x3ef83f12, 0x3e993eca
.long 0xbf60bf74, 0xbf1dbf42, 0x3f073eb2, 0x3f523f30, 0x3ef83e99, 0x3f4a3f27, 0x3f593f70, 0x3f123f3a
.long 0xbf30bee1, 0xbf7bbf60, 0x3d4fbe80, 0x3f1d3eb2, 0xbf3abf66, 0xbe4ebef8, 0x3f803f78, 0x3f4a3f70
.long 0x3f073f52, 0xbe803e1b, 0xbee1bf42, 0x3eb2bd4f, 0xbf59bf12, 0xbf78bf7d, 0x3f663f27, 0x3f703f80
.long 0x3f743f30, 0x3f423f7b, 0xbf52bf7f, 0x3d4fbee1, 0x3e993f3a, 0xbf27be4e, 0x3f123dcf, 0x3f803f66
.long 0xbd4fbf1d, 0x3f6b3f07, 0xbf7fbf60, 0xbe80bf42, 0x3f803f4a, 0x3eca3f59, 0x3dcfbef8, 0x3f783f27
.long 0xbf7bbf60, 0x3d4fbf1d, 0xbf6bbee1, 0xbf07bf74, 0x3e4ebef8, 0x3f803f4a, 0xbecabf66, 0x3f593e99
.long 0x3f803f80, 0x3f803f80, 0x3f803f80, 0x00000000, 0x00000000, 0x00000000, 0x00000000, 0x00000000
.long 0x3f1d3f07, 0x3f423f30, 0x3f7f3f7b, 0x00000000, 0x3f4a3f59, 0x3f273f3a, 0x3dcf3e4e, 0x00000000
.long 0xbe80bee1, 0x3e1bbd4f, 0x3f7b3f6b, 0x00000000, 0x3f783f66, 0x3f7d3f80, 0x3e4e3eca, 0x00000000
.long 0xbf6bbf7f, 0xbf07bf42, 0x3f743f52, 0x00000000, 0x3eca3dcf, 0x3f593f27, 0x3e993f12, 0x00000000
.long 0xbf60bf1d, 0xbf74bf7f, 0x3f6b3f30, 0x00000000, 0xbef8bf4a, 0x3e99bdcf, 0x3eca3f3a, 0x00000000
.long 0xbe1b3eb2, 0xbf6bbf1d, 0x3f603f07, 0x00000000, 0xbf7dbf70, 0xbecabf4a, 0x3ef83f59, 0x00000000
.long 0x3f303f7b, 0xbee13e1b, 0x3f523eb2, 0x00000000, 0xbf3abe4e, 0xbf66bf7d, 0x3f123f70, 0x00000000
.long 0x3f7f3f30, 0x3e803f52, 0x3f423e1b, 0x00000000, 0x3dcf3f3a, 0xbf78bf12, 0x3f273f7d, 0x00000000
.long 0x3f303f80, 0xbf42bd4f, 0x3f073f7b, 0xbf60be80, 0xbf3a0000, 0xbf27bf80, 0xbf59be4e, 0xbef8bf78
.long 0x3f1d3f80, 0xbf6bbe80, 0xbeb23f07, 0xbf52bf74, 0xbf4a0000, 0xbecabf78, 0xbf70bf59, 0x3f12be99
.long 0x3f073f80, 0xbf7fbee1, 0xbf74be80, 0x3e1bbf42, 0xbf590000, 0xbdcfbf66, 0xbe99bf78, 0x3f7d3f27
.long 0x3ee13f80, 0xbf7bbf1d, 0xbf52bf60, 0x3f743e1b, 0xbf660000, 0x3e4ebf4a, 0x3f12bef8, 0x3e993f7d
.long 0x3eb23f80, 0xbf60bf42, 0xbd4fbf74, 0x3f303f6b, 0xbf700000, 0x3ef8bf27, 0x3f803e99, 0xbf3a3eca
.long 0x3e803f80, 0xbf30bf60, 0x3f42bee1, 0xbeb23f52, 0xbf780000, 0x3f3abef8, 0x3f273f66, 0xbf70bf12
.long 0x3e1b3f80, 0xbee1bf74, 0x3f7b3eb2, 0xbf7fbd4f, 0xbf7d0000, 0x3f66be99, 0xbe4e3f70, 0xbdcfbf80
.long 0x3d4f3f80, 0xbe1bbf7f, 0x3ee13f6b, 0xbf07bf60, 0xbf800000, 0x3f7dbdcf, 0xbf663eca, 0x3f59bef8
.long 0xbf1dbf7f, 0x3f523e1b, 0xbee1bf74, 0x3f6b3eb2, 0x3f4a3dcf, 0x3f123f7d, 0x3f663e99, 0x3eca3f70
.long 0xbe1bbf60, 0x3f7f3f30, 0x3f42bd4f, 0x3ee13f7b, 0x3f7d3ef8, 0xbdcf3f3a, 0x3f273f80, 0xbf66be4e
.long 0x3eb2bf1d, 0x3f303f7b, 0x3f523f6b, 0xbf60bd4f, 0x3f703f4a, 0xbf3a3e4e, 0xbf123eca, 0xbef8bf80
.long 0x3f42be80, 0x3d4f3f6b, 0xbeb23f30, 0xbf07bf7f, 0x3f273f78, 0xbf80beca, 0xbf70bf3a, 0x3f59bdcf
.long 0x3f7b3e1b, 0xbf1d3f07, 0xbf7fbee1, 0x3f52be80, 0x3e4e3f7d, 0xbf4abf59, 0x3dcfbf66, 0x3f123f78
.long 0x3f743f07, 0xbf7bbd4f, 0xbe1bbf7f, 0x3f1d3f6b, 0xbe993f59, 0xbe4ebf80, 0x3f7d3dcf, 0xbf4a3eca
.long 0x3f303f52, 0xbf60bf1d, 0x3f6bbe80, 0xbf423f07, 0xbf3a3f12, 0x3ef8bf4a, 0x3eca3f78, 0xbf27bf59
.long 0x3e803f7b, 0xbeb2bf74, 0x3f1d3f52, 0xbf30bf42, 0xbf783e4e, 0x3f70be99, 0xbf4a3f12, 0x3f3abf27
.long 0x3eb23f6b, 0xbf74bee1, 0x3e1b3f52, 0xbf7fbf1d, 0xbf70beca, 0xbe99bf66, 0xbf7dbf12, 0xbdcfbf4a
.long 0xbf7bbee1, 0x3d4fbf42, 0xbf30bf7f, 0x3f603e1b, 0xbe4ebf66, 0x3f803f27, 0x3f3abdcf, 0x3ef83f7d
.long 0xbd4fbf60, 0x3f6b3f52, 0x3f7b3f30, 0xbf1d3eb2, 0x3f803ef8, 0xbeca3f12, 0xbe4e3f3a, 0xbf4abf70
.long 0x3f7f3f07, 0xbf303eb2, 0xbf6bbd4f, 0x3e80bf42, 0xbdcf3f59, 0xbf3abf70, 0xbecabf80, 0x3f783f27
.long 0xbe803f52, 0xbee1bf7f, 0x3f07bf1d, 0x3e1b3f7b, 0xbf78bf12, 0x3f66bdcf, 0x3f593f4a, 0xbf7dbe4e
.long 0xbf6bbf1d, 0x3f7f3e1b, 0x3d4f3f7b, 0xbf07bf74, 0x3ecabf4a, 0x3dcf3f7d, 0xbf80be4e, 0x3f59be99
.long 0x3f07bf42, 0xbe803f6b, 0xbf1dbf60, 0x3f523f30, 0x3f593f27, 0xbf78beca, 0x3f4abef8, 0xbf123f3a
.long 0x3f423f30, 0xbf52bf1d, 0x3f743eb2, 0xbf7bbe80, 0xbf273f3a, 0x3f12bf4a, 0xbe993f70, 0x3e4ebf78
.long 0xbe80bf60, 0x3f7b3f07, 0xbd4fbf42, 0x3f803f30, 0x3f783ef8, 0x3e4e3f59, 0x3f803f27, 0x00003f3a
.long 0x3f743f52, 0xbf073eb2, 0x3e803f6b, 0xbf80bf1d, 0xbe993f12, 0xbf59bf70, 0xbf78beca, 0x0000bf4a
.long 0xbf423e1b, 0xbe80bf74, 0xbee1bf7f, 0x3f803f07, 0xbf27bf7d, 0x3f783e99, 0x3f663dcf, 0x00003f59
.long 0xbe1bbf74, 0x3f603f52, 0x3f1d3f7b, 0xbf80bee1, 0x3f7d3e99, 0xbef83f12, 0xbf4a3e4e, 0x0000bf66
.long 0x3f6b3f30, 0xbf74bd4f, 0xbf42bf60, 0x3f803eb2, 0xbeca3f3a, 0xbe99bf80, 0x3f27bef8, 0x00003f70
.long 0xbf523eb2, 0x3ee1bf42, 0x3f603f30, 0xbf80be80, 0xbf12bf70, 0x3f663f27, 0xbef83f3a, 0x0000bf78
.long 0xbd4fbf7f, 0x3eb23f7b, 0xbf74bee1, 0x3f803e1b, 0x3f803dcf, 0xbf703e4e, 0x3e99bf66, 0x00003f7d
.long 0x3f603f07, 0xbf6bbee1, 0x3f7f3e1b, 0xbf80bd4f, 0xbef83f59, 0x3ecabf66, 0xbdcf3f7d, 0x0000bf80
.long 0xbd4f3f30, 0xbf7fbf42, 0xbe803f07, 0xbf74bf60, 0xbf80bf3a, 0x3dcfbf27, 0xbf78bf59, 0x3e99bef8
.long 0x3e80bf1d, 0x3f603f6b, 0x3f743eb2, 0x3d4f3f52, 0x3f783f4a, 0xbef83eca, 0x3e993f70, 0xbf80bf12
.long 0xbee13f07, 0xbf1dbf7f, 0xbf42bf74, 0x3f6b3e1b, 0xbf66bf59, 0x3f4abdcf, 0x3f27be99, 0x3eca3f7d
.long 0x3f1dbee1, 0x3e803f7b, 0xbe1b3f52, 0xbf30bf74, 0x3f4a3f66, 0xbf78be4e, 0xbf7dbf12, 0x3f3abe99
.long 0xbf423eb2, 0x3e1bbf60, 0x3f6bbd4f, 0xbee13f30, 0xbf27bf70, 0x3f7d3ef8, 0x3eca3f80, 0xbf66bf3a
.long 0x3f60be80, 0xbf073f30, 0xbf52bf42, 0x3f7f3eb2, 0x3ef83f78, 0xbf59bf3a, 0x3f12bf27, 0xbdcf3f70
.long 0xbf743e1b, 0x3f52bee1, 0xbd4f3f7b, 0xbe80bf7f, 0xbe99bf7d, 0x3f123f66, 0xbf80be4e, 0x3f78bdcf
.long 0x3f7fbd4f, 0xbf7b3e1b, 0x3f60bee1, 0xbf523f07, 0x3dcf3f80, 0xbe4ebf7d, 0x3ef83f66, 0xbf12bf59
.long 0x3e1bbf1d, 0x3f7b3f52, 0x3eb2bee1, 0x3f6b3f6b, 0x3f7d3f4a, 0xbe4e3f12, 0x3f703f66, 0xbeca3eca
.long 0xbf303e1b, 0xbf07bf7f, 0xbf7bbf42, 0x3ee1bee1, 0xbf3abf7d, 0x3f593dcf, 0x3e4ebf27, 0x3f663f66
.long 0x3f7b3eb2, 0xbe803f30, 0xbd4f3f52, 0xbf60bf60, 0x3e4e3f70, 0xbf78bf3a, 0xbf80bf12, 0x3ef8bef8
.long 0xbf6bbf42, 0x3f60bd4f, 0x3f7f3eb2, 0xbf073f07, 0x3ecabf27, 0x3ef83f80, 0x3dcf3f70, 0xbf59bf59
.long 0x3f073f7b, 0xbf74bf1d, 0xbe80bf7f, 0x3f523f52, 0xbf593e4e, 0x3e99bf4a, 0x3f783dcf, 0xbf123f12
.long 0x3d4fbf74, 0x3ee13f7b, 0xbf6b3e1b, 0x3f1dbf1d, 0x3f803e99, 0xbf663e4e, 0xbecabf7d, 0x3f4a3f4a
.long 0xbf1d3f30, 0x3eb2bf60, 0x3f073f6b, 0xbf42bf42, 0xbf4abf3a, 0x3f703ef8, 0xbf593eca, 0x3f27bf27
.long 0x3f74be80, 0xbf6b3eb2, 0x3f42bf1d, 0xbf303f30, 0x3e993f78, 0xbecabf70, 0x3f273f4a, 0xbf3abf3a
.long 0xbee13eb2, 0xbf60bf74, 0xbf1d3e1b, 0xbf42bf7f, 0xbf66bf70, 0x3ef8be99, 0xbf4abf7d, 0x3f27bdcf
.long 0x3f423f7b, 0xbf52bd4f, 0xbe1b3f30, 0xbf6bbf60, 0xbf273e4e, 0xbf12bf80, 0xbf7dbf3a, 0x3ecabef8
.long 0x3f52bd4f, 0x3e1b3f6b, 0x3eb23f7b, 0xbf7fbf1d, 0x3f123f80, 0xbf7dbeca, 0xbf70be4e, 0x3dcfbf4a
.long 0xbeb2bf7f, 0x3f743f30, 0x3f423f6b, 0xbf7bbe80, 0x3f703dcf, 0xbe993f3a, 0xbf273eca, 0xbe4ebf78
.long 0xbf7fbe80, 0x3f30bee1, 0x3f7b3f07, 0xbf603e1b, 0xbdcfbf78, 0x3f3a3f66, 0xbe4e3f59, 0xbef8bf7d
.long 0xbe1b3f6b, 0xbeb2bf7f, 0x3f74bd4f, 0xbf303f07, 0xbf7dbeca, 0x3f70bdcf, 0x3e993f80, 0xbf3abf59
.long 0x3f6b3f07, 0xbf7fbe80, 0x3f30bf1d, 0xbee13f52, 0xbeca3f59, 0x3dcfbf78, 0x3f3a3f4a, 0xbf66bf12
.long 0x3f1dbf42, 0xbf073f52, 0x3e80bf74, 0xbe1b3f7b, 0x3f4a3f27, 0xbf59bf12, 0x3f783e99, 0xbf7dbe4e
.long 0x3f07be80, 0x3f523f7b, 0x3f30bd4f, 0x00000000, 0x3f593f78, 0xbf123e4e, 0x3f3a3f80, 0x00000000
.long 0xbeb2bf74, 0x3f7f3f07, 0x3f1dbe80, 0x00000000, 0x3f703e99, 0x3dcf3f59, 0x3f4a3f78, 0x00000000
.long 0xbf74bf42, 0x3f30be80, 0x3f07bee1, 0x00000000, 0x3e99bf27, 0x3f3a3f78, 0x3f593f66, 0x00000000
.long 0xbf523e1b, 0x3d4fbf60, 0x3ee1bf1d, 0x00000000, 0xbf12bf7d, 0x3f803ef8, 0x3f663f4a, 0x00000000
.long 0xbd4f3f6b, 0xbf1dbf74, 0x3eb2bf42, 0x00000000, 0xbf80beca, 0x3f4abe99, 0x3f703f27, 0x00000000
.long 0x3f423f52, 0xbf7bbee1, 0x3e80bf60, 0x00000000, 0xbf273f12, 0x3e4ebf66, 0x3f783ef8, 0x00000000
.long 0x3f7bbd4f, 0xbf603eb2, 0x3e1bbf74, 0x00000000, 0x3e4e3f80, 0xbef8bf70, 0x3f7d3e99, 0x00000000
.long 0x3ee1bf60, 0xbeb23f6b, 0x3d4fbf7f, 0x00000000, 0x3f663ef8, 0xbf70beca, 0x3f803dcf, 0x00000000
.long 0xbd4f3f80, 0x3e1bbf7f, 0xbee13f6b, 0x3f07bf60, 0xbf800000, 0x3f7d3dcf, 0xbf66beca, 0x3f593ef8
.long 0xbe1b3f80, 0x3ee1bf74, 0xbf7b3eb2, 0x3f7fbd4f, 0xbf7d0000, 0x3f663e99, 0xbe4ebf70, 0xbdcf3f80
.long 0xbe803f80, 0x3f30bf60, 0xbf42bee1, 0x3eb23f52, 0xbf780000, 0x3f3a3ef8, 0x3f27bf66, 0xbf703f12
.long 0xbeb23f80, 0x3f60bf42, 0x3d4fbf74, 0xbf303f6b, 0xbf700000, 0x3ef83f27, 0x3f80be99, 0xbf3abeca
.long 0xbee13f80, 0x3f7bbf1d, 0x3f52bf60, 0xbf743e1b, 0xbf660000, 0x3e4e3f4a, 0x3f123ef8, 0x3e99bf7d
.long 0xbf073f80, 0x3f7fbee1, 0x3f74be80, 0xbe1bbf42, 0xbf590000, 0xbdcf3f66, 0xbe993f78, 0x3f7dbf27
.long 0xbf1d3f80, 0x3f6bbe80, 0x3eb23f07, 0x3f52bf74, 0xbf4a0000, 0xbeca3f78, 0xbf703f59, 0x3f123e99
.long 0xbf303f80, 0x3f42bd4f, 0xbf073f7b, 0x3f60be80, 0xbf3a0000, 0xbf273f80, 0xbf593e4e, 0xbef83f78
.long 0xbe803f7b, 0x3eb2bf74, 0xbf1d3f52, 0x3f30bf42, 0xbf78be4e, 0x3f703e99, 0xbf4abf12, 0x3f3a3f27
.long 0xbf303f52, 0x3f60bf1d, 0xbf6bbe80, 0x3f423f07, 0xbf3abf12, 0x3ef83f4a, 0x3ecabf78, 0xbf273f59
.long 0xbf743f07, 0x3f7bbd4f, 0x3e1bbf7f, 0xbf1d3f6b, 0xbe99bf59, 0xbe4e3f80, 0x3f7dbdcf, 0xbf4abeca
.long 0xbf7b3e1b, 0x3f1d3f07, 0x3f7fbee1, 0xbf52be80, 0x3e4ebf7d, 0xbf4a3f59, 0x3dcf3f66, 0x3f12bf78
.long 0xbf42be80, 0xbd4f3f6b, 0x3eb23f30, 0x3f07bf7f, 0x3f27bf78, 0xbf803eca, 0xbf703f3a, 0x3f593dcf
.long 0xbeb2bf1d, 0xbf303f7b, 0xbf523f6b, 0x3f60bd4f, 0x3f70bf4a, 0xbf3abe4e, 0xbf12beca, 0xbef83f80
.long 0x3e1bbf60, 0xbf7f3f30, 0xbf42bd4f, 0xbee13f7b, 0x3f7dbef8, 0xbdcfbf3a, 0x3f27bf80, 0xbf663e4e
.long 0x3f1dbf7f, 0xbf523e1b, 0x3ee1bf74, 0xbf6b3eb2, 0x3f4abdcf, 0x3f12bf7d, 0x3f66be99, 0x3ecabf70
.long 0xbf423f30, 0x3f52bf1d, 0xbf743eb2, 0x3f7bbe80, 0xbf27bf3a, 0x3f123f4a, 0xbe99bf70, 0x3e4e3f78
.long 0xbf07bf42, 0x3e803f6b, 0x3f1dbf60, 0xbf523f30, 0x3f59bf27, 0xbf783eca, 0x3f4a3ef8, 0xbf12bf3a
.long 0x3f6bbf1d, 0xbf7f3e1b, 0xbd4f3f7b, 0x3f07bf74, 0x3eca3f4a, 0x3dcfbf7d, 0xbf803e4e, 0x3f593e99
.long 0x3e803f52, 0x3ee1bf7f, 0xbf07bf1d, 0xbe1b3f7b, 0xbf783f12, 0x3f663dcf, 0x3f59bf4a, 0xbf7d3e4e
.long 0xbf7f3f07, 0x3f303eb2, 0x3f6bbd4f, 0xbe80bf42, 0xbdcfbf59, 0xbf3a3f70, 0xbeca3f80, 0x3f78bf27
.long 0x3d4fbf60, 0xbf6b3f52, 0xbf7b3f30, 0x3f1d3eb2, 0x3f80bef8, 0xbecabf12, 0xbe4ebf3a, 0xbf4a3f70
.long 0x3f7bbee1, 0xbd4fbf42, 0x3f30bf7f, 0xbf603e1b, 0xbe4e3f66, 0x3f80bf27, 0x3f3a3dcf, 0x3ef8bf7d
.long 0xbeb23f6b, 0x3f74bee1, 0xbe1b3f52, 0x3f7fbf1d, 0xbf703eca, 0xbe993f66, 0xbf7d3f12, 0xbdcf3f4a
.long 0xbf603f07, 0x3f6bbee1, 0xbf7f3e1b, 0x3f80bd4f, 0xbef8bf59, 0x3eca3f66, 0xbdcfbf7d, 0x00003f80
.long 0x3d4fbf7f, 0xbeb23f7b, 0x3f74bee1, 0xbf803e1b, 0x3f80bdcf, 0xbf70be4e, 0x3e993f66, 0x0000bf7d
.long 0x3f523eb2, 0xbee1bf42, 0xbf603f30, 0x3f80be80, 0xbf123f70, 0x3f66bf27, 0xbef8bf3a, 0x00003f78
.long 0xbf6b3f30, 0x3f74bd4f, 0x3f42bf60, 0xbf803eb2, 0xbecabf3a, 0xbe993f80, 0x3f273ef8, 0x0000bf70
.long 0x3e1bbf74, 0xbf603f52, 0xbf1d3f7b, 0x3f80bee1, 0x3f7dbe99, 0xbef8bf12, 0xbf4abe4e, 0x00003f66
.long 0x3f423e1b, 0x3e80bf74, 0x3ee1bf7f, 0xbf803f07, 0xbf273f7d, 0x3f78be99, 0x3f66bdcf, 0x0000bf59
.long 0xbf743f52, 0x3f073eb2, 0xbe803f6b, 0x3f80bf1d, 0xbe99bf12, 0xbf593f70, 0xbf783eca, 0x00003f4a
.long 0x3e80bf60, 0xbf7b3f07, 0x3d4fbf42, 0xbf803f30, 0x3f78bef8, 0x3e4ebf59, 0x3f80bf27, 0x0000bf3a
.long 0xbf7fbd4f, 0x3f7b3e1b, 0xbf60bee1, 0x3f523f07, 0x3dcfbf80, 0xbe4e3f7d, 0x3ef8bf66, 0xbf123f59
.long 0x3f743e1b, 0xbf52bee1, 0x3d4f3f7b, 0x3e80bf7f, 0xbe993f7d, 0x3f12bf66, 0xbf803e4e, 0x3f783dcf
.long 0xbf60be80, 0x3f073f30, 0x3f52bf42, 0xbf7f3eb2, 0x3ef8bf78, 0xbf593f3a, 0x3f123f27, 0xbdcfbf70
.long 0x3f423eb2, 0xbe1bbf60, 0xbf6bbd4f, 0x3ee13f30, 0xbf273f70, 0x3f7dbef8, 0x3ecabf80, 0xbf663f3a
.long 0xbf1dbee1, 0xbe803f7b, 0x3e1b3f52, 0x3f30bf74, 0x3f4abf66, 0xbf783e4e, 0xbf7d3f12, 0x3f3a3e99
.long 0x3ee13f07, 0x3f1dbf7f, 0x3f42bf74, 0xbf6b3e1b, 0xbf663f59, 0x3f4a3dcf, 0x3f273e99, 0x3ecabf7d
.long 0xbe80bf1d, 0xbf603f6b, 0xbf743eb2, 0xbd4f3f52, 0x3f78bf4a, 0xbef8beca, 0x3e99bf70, 0xbf803f12
.long 0x3d4f3f30, 0x3f7fbf42, 0x3e803f07, 0x3f74bf60, 0xbf803f3a, 0x3dcf3f27, 0xbf783f59, 0x3e993ef8
.long 0xbf74be80, 0x3f6b3eb2, 0xbf42bf1d, 0x3f303f30, 0x3e99bf78, 0xbeca3f70, 0x3f27bf4a, 0xbf3a3f3a
.long 0x3f1d3f30, 0xbeb2bf60, 0xbf073f6b, 0x3f42bf42, 0xbf4a3f3a, 0x3f70bef8, 0xbf59beca, 0x3f273f27
.long 0xbd4fbf74, 0xbee13f7b, 0x3f6b3e1b, 0xbf1dbf1d, 0x3f80be99, 0xbf66be4e, 0xbeca3f7d, 0x3f4abf4a
.long 0xbf073f7b, 0x3f74bf1d, 0x3e80bf7f, 0xbf523f52, 0xbf59be4e, 0x3e993f4a, 0x3f78bdcf, 0xbf12bf12
.long 0x3f6bbf42, 0xbf60bd4f, 0xbf7f3eb2, 0x3f073f07, 0x3eca3f27, 0x3ef8bf80, 0x3dcfbf70, 0xbf593f59
.long 0xbf7b3eb2, 0x3e803f30, 0x3d4f3f52, 0x3f60bf60, 0x3e4ebf70, 0xbf783f3a, 0xbf803f12, 0x3ef83ef8
.long 0x3f303e1b, 0x3f07bf7f, 0x3f7bbf42, 0xbee1bee1, 0xbf3a3f7d, 0x3f59bdcf, 0x3e4e3f27, 0x3f66bf66
.long 0xbe1bbf1d, 0xbf7b3f52, 0xbeb2bee1, 0xbf6b3f6b, 0x3f7dbf4a, 0xbe4ebf12, 0x3f70bf66, 0xbecabeca
.long 0xbf1dbf42, 0x3f073f52, 0xbe80bf74, 0x3e1b3f7b, 0x3f4abf27, 0xbf593f12, 0x3f78be99, 0xbf7d3e4e
.long 0xbf6b3f07, 0x3f7fbe80, 0xbf30bf1d, 0x3ee13f52, 0xbecabf59, 0x3dcf3f78, 0x3f3abf4a, 0xbf663f12
.long 0x3e1b3f6b, 0x3eb2bf7f, 0xbf74bd4f, 0x3f303f07, 0xbf7d3eca, 0x3f703dcf, 0x3e99bf80, 0xbf3a3f59
.long 0x3f7fbe80, 0xbf30bee1, 0xbf7b3f07, 0x3f603e1b, 0xbdcf3f78, 0x3f3abf66, 0xbe4ebf59, 0xbef83f7d
.long 0x3eb2bf7f, 0xbf743f30, 0xbf423f6b, 0x3f7bbe80, 0x3f70bdcf, 0xbe99bf3a, 0xbf27beca, 0xbe4e3f78
.long 0xbf52bd4f, 0xbe1b3f6b, 0xbeb23f7b, 0x3f7fbf1d, 0x3f12bf80, 0xbf7d3eca, 0xbf703e4e, 0x3dcf3f4a
.long 0xbf423f7b, 0x3f52bd4f, 0x3e1b3f30, 0x3f6bbf60, 0xbf27be4e, 0xbf123f80, 0xbf7d3f3a, 0x3eca3ef8
.long 0x3ee13eb2, 0x3f60bf74, 0x3f1d3e1b, 0x3f42bf7f, 0xbf663f70, 0x3ef83e99, 0xbf4a3f7d, 0x3f273dcf
.long 0xbee1bf60, 0x3eb23f6b, 0xbd4fbf7f, 0x00000000, 0x3f66bef8, 0xbf703eca, 0x3f80bdcf, 0x00000000
.long 0xbf7bbd4f, 0x3f603eb2, 0xbe1bbf74, 0x00000000, 0x3e4ebf80, 0xbef83f70, 0x3f7dbe99, 0x00000000
.long 0xbf423f52, 0x3f7bbee1, 0xbe80bf60, 0x00000000, 0xbf27bf12, 0x3e4e3f66, 0x3f78bef8, 0x00000000
.long 0x3d4f3f6b, 0x3f1dbf74, 0xbeb2bf42, 0x00000000, 0xbf803eca, 0x3f4a3e99, 0x3f70bf27, 0x00000000
.long 0x3f523e1b, 0xbd4fbf60, 0xbee1bf1d, 0x00000000, 0xbf123f7d, 0x3f80bef8, 0x3f66bf4a, 0x00000000
.long 0x3f74bf42, 0xbf30be80, 0xbf07bee1, 0x00000000, 0x3e993f27, 0x3f3abf78, 0x3f59bf66, 0x00000000
.long 0x3eb2bf74, 0xbf7f3f07, 0xbf1dbe80, 0x00000000, 0x3f70be99, 0x3dcfbf59, 0x3f4abf78, 0x00000000
.long 0xbf07be80, 0xbf523f7b, 0xbf30bd4f, 0x00000000, 0x3f59bf78, 0xbf12be4e, 0x3f3abf80, 0x00000000
.long 0xbf423f80, 0x3f073e1b, 0xbf7f3f52, 0xbd4f3f30, 0xbf270000, 0xbf593f7d, 0xbdcfbf12, 0xbf803f3a
.long 0xbf523f80, 0x3e803eb2, 0xbf303e1b, 0xbf6b3f7b, 0xbf120000, 0xbf783f70, 0x3f3abf7d, 0xbecabe4e
.long 0xbf603f80, 0xbd4f3f07, 0x3e1bbf1d, 0xbf423eb2, 0xbef80000, 0xbf803f59, 0x3f7dbf4a, 0x3f27bf70
.long 0xbf6b3f80, 0xbeb23f30, 0x3f60bf7f, 0x3e80bf1d, 0xbeca0000, 0xbf703f3a, 0x3ef8bdcf, 0x3f78bf4a
.long 0xbf743f80, 0xbf1d3f52, 0x3f6bbf42, 0x3f7bbf7f, 0xbe990000, 0xbf4a3f12, 0xbeca3f27, 0x3e4e3dcf
.long 0xbf7b3f80, 0xbf523f6b, 0x3e80bd4f, 0x3f1dbee1, 0xbe4e0000, 0xbf123eca, 0xbf783f80, 0xbf4a3f66
.long 0xbf7f3f80, 0xbf743f7b, 0xbf1d3f30, 0xbee13f07, 0xbdcf0000, 0xbe993e4e, 0xbf4a3f3a, 0xbf663f59
.long 0xbf803f80, 0xbf803f80, 0xbf803f80, 0xbf803f80, 0x00000000, 0x00000000, 0x00000000, 0x00000000
.long 0x3f6bbf74, 0xbe80bee1, 0x3f7bbf1d, 0x3eb2bf60, 0x3eca3e99, 0x3f78bf66, 0xbe4e3f4a, 0x3f70bef8
.long 0x3f7fbf42, 0x3ee1bf60, 0x3d4f3f07, 0x3f74bf1d, 0xbdcf3f27, 0x3f66bef8, 0xbf803f59, 0xbe993f4a
.long 0x3f52bee1, 0x3f6bbf7f, 0xbf743f7b, 0xbe803f30, 0xbf123f66, 0x3eca3dcf, 0xbe99be4e, 0xbf783f3a
.long 0x3ee1bd4f, 0x3f74bf42, 0xbf073e1b, 0xbf7b3f52, 0xbf663f80, 0xbe993f27, 0x3f59bf7d, 0x3e4ebf12
.long 0xbd4f3eb2, 0x3f07be80, 0x3f30bf60, 0x3e1bbee1, 0xbf803f70, 0xbf593f78, 0x3f3abef8, 0x3f7dbf66
.long 0xbf073f30, 0xbe1b3eb2, 0x3f60bf42, 0x3f7fbf74, 0xbf593f3a, 0xbf7d3f70, 0xbef83f27, 0xbdcf3e99
.long 0xbf603f6b, 0xbf423f52, 0xbe803eb2, 0xbd4f3e1b, 0xbef83eca, 0xbf273f12, 0xbf783f70, 0xbf803f7d
.long 0xbf803f80, 0xbf803f80, 0xbf803f80, 0xbf803f80, 0x00000000, 0x00000000, 0x00000000, 0x00000000
.long 0xbf603eb2, 0xbf1d3f7b, 0xbee1be80, 0xbf743f6b, 0x3ef8bf70, 0xbf4a3e4e, 0x3f66bf78, 0xbe99beca
.long 0x3f1dbf74, 0xbf07bd4f, 0x3f60bee1, 0x3f42bf7f, 0x3f4abe99, 0x3f59bf80, 0xbef83f66, 0x3f27bdcf
.long 0x3f30be80, 0x3f7bbf74, 0xbf7f3f6b, 0xbee13f52, 0xbf3a3f78, 0x3e4e3e99, 0xbdcfbeca, 0xbf663f12
.long 0xbf523f7b, 0xbe1b3f07, 0x3f42bf74, 0x3d4fbee1, 0xbf123e4e, 0xbf7d3f59, 0x3f27be99, 0x3f80bf66
.long 0xbee13e1b, 0xbf603f30, 0xbe803f07, 0x3eb2bd4f, 0x3f66bf7d, 0x3ef8bf3a, 0xbf783f59, 0xbf703f80
.long 0x3f74bf7f, 0x3f42bf60, 0xbeb23e1b, 0xbf303f07, 0x3e99bdcf, 0x3f27bef8, 0x3f70bf7d, 0x3f3abf59
.long 0x3e1bbd4f, 0x3eb2be80, 0x3f52bf42, 0x3f6bbf60, 0xbf7d3f80, 0xbf703f78, 0xbf123f27, 0xbeca3ef8
.long 0xbf803f80, 0xbf803f80, 0xbf803f80, 0xbf803f80, 0x00000000, 0x00000000, 0x00000000, 0x00000000
.long 0x3f30bd4f, 0x3f52bf7f, 0x3e1b3f07, 0x3f80bf42, 0xbf3a3f80, 0x3f123dcf, 0xbf7d3f59, 0x00003f27
.long 0xbf7b3f6b, 0xbe1b3f30, 0xbeb2be80, 0xbf803f52, 0xbe4ebeca, 0xbf7d3f3a, 0x3f70bf78, 0x0000bf12
.long 0x3eb2bf42, 0xbf1d3e1b, 0x3f07bd4f, 0x3f80bf60, 0x3f70bf27, 0x3f4abf7d, 0xbf593f80, 0x00003ef8
.long 0x3f1dbe80, 0x3f7fbf60, 0xbf303eb2, 0xbf803f6b, 0xbf4a3f78, 0xbdcf3ef8, 0x3f3abf70, 0x0000beca
.long 0xbf7f3f7b, 0xbf423f6b, 0x3f52bf1d, 0x3f80bf74, 0xbdcfbe4e, 0xbf273eca, 0xbf123f4a, 0x00003e99
.long 0x3ee1bf1d, 0x3d4fbe80, 0xbf6b3f52, 0xbf803f7b, 0x3f66bf4a, 0x3f80bf78, 0x3ecabf12, 0x0000be4e
.long 0x3f07bee1, 0x3f30bf1d, 0x3f7bbf74, 0x3f80bf7f, 0xbf593f66, 0xbf3a3f4a, 0xbe4e3e99, 0x00003dcf
.long 0xbf803f80, 0xbf803f80, 0xbf803f80, 0xbf803f80, 0x00000000, 0x00000000, 0x00000000, 0x00000000
.long 0x3e1bbf42, 0xbf743f07, 0x3f30bf7f, 0xbf1dbd4f, 0x3f7dbf27, 0x3e99bf59, 0x3f3abdcf, 0x3f4abf80
.long 0xbeb23f52, 0x3f42be80, 0xbf7b3f30, 0xbf073f6b, 0xbf703f12, 0xbf273f78, 0x3e4ebf3a, 0xbf593eca
.long 0x3f07bf60, 0xbee1bd4f, 0x3eb23e1b, 0x3f7bbf42, 0x3f59bef8, 0x3f66bf80, 0xbf703f7d, 0xbe4e3f27
.long 0xbf303f6b, 0x3d4f3eb2, 0x3f1dbf60, 0xbe1bbe80, 0xbf3a3eca, 0xbf803f70, 0x3f4abef8, 0x3f7dbf78
.long 0x3f52bf74, 0x3eb2bf1d, 0xbf7f3f6b, 0xbf603f7b, 0x3f12be99, 0x3f70bf4a, 0x3dcfbeca, 0xbef83e4e
.long 0xbf6b3f7b, 0xbf303f52, 0x3ee1be80, 0x3f42bf1d, 0xbeca3e4e, 0xbf3a3f12, 0xbf663f78, 0xbf273f4a
.long 0x3f7bbf7f, 0x3f6bbf74, 0x3f07bf1d, 0x3eb2bee1, 0x3e4ebdcf, 0x3ecabe99, 0x3f59bf4a, 0x3f70bf66
.long 0xbf803f80, 0xbf803f80, 0xbf803f80, 0xbf803f80, 0x00000000, 0x00000000, 0x00000000, 0x00000000
.long 0xbee13f6b, 0x3f52be80, 0xbf603f7b, 0x3eb23eb2, 0xbf663eca, 0xbf123f78, 0xbef8be4e, 0xbf703f70
.long 0x3f60bf7f, 0xbe1bbee1, 0x3f1dbd4f, 0x3f74bf74, 0x3ef83dcf, 0x3f7dbf66, 0xbf4a3f80, 0x3e993e99
.long 0xbf7f3f52, 0xbf1d3f6b, 0x3f30bf74, 0xbe80be80, 0x3dcfbf12, 0xbf4a3eca, 0x3f3abe99, 0x3f78bf78
.long 0x3f42bee1, 0x3f7fbf74, 0xbf523f07, 0xbf7b3f7b, 0xbf273f66, 0x3dcf3e99, 0x3f12bf59, 0xbe4ebe4e
.long 0xbe80bd4f, 0xbf423f07, 0xbee13f30, 0x3e1b3e1b, 0x3f78bf80, 0x3f27bf59, 0xbf663f3a, 0xbf7d3f7d
.long 0xbeb23f07, 0x3d4f3e1b, 0x3f74bf60, 0x3f7fbf7f, 0xbf703f59, 0xbf803f7d, 0xbe993ef8, 0x3dcf3dcf
.long 0x3f52bf60, 0x3f30bf42, 0x3e1bbe80, 0xbd4fbd4f, 0x3f12bef8, 0x3f3abf27, 0x3f7dbf78, 0x3f80bf80
.long 0xbf803f80, 0xbf803f80, 0xbf803f80, 0xbf803f80, 0x00000000, 0x00000000, 0x00000000, 0x00000000
.long 0x3f7bbf60, 0xbd4fbf1d, 0x3f6bbee1, 0x3f07bf74, 0x3e4e3ef8, 0x3f80bf4a, 0xbeca3f66, 0x3f59be99
.long 0x3d4fbf1d, 0xbf6b3f07, 0x3f7fbf60, 0x3e80bf42, 0x3f80bf4a, 0x3ecabf59, 0x3dcf3ef8, 0x3f78bf27
.long 0xbf743f30, 0xbf423f7b, 0x3f52bf7f, 0xbd4fbee1, 0x3e99bf3a, 0xbf273e4e, 0x3f12bdcf, 0x3f80bf66
.long 0xbf073f52, 0x3e803e1b, 0x3ee1bf42, 0xbeb2bd4f, 0xbf593f12, 0xbf783f7d, 0x3f66bf27, 0x3f70bf80
.long 0x3f30bee1, 0x3f7bbf60, 0xbd4fbe80, 0xbf1d3eb2, 0xbf3a3f66, 0xbe4e3ef8, 0x3f80bf78, 0x3f4abf70
.long 0x3f60bf74, 0x3f1dbf42, 0xbf073eb2, 0xbf523f30, 0x3ef8be99, 0x3f4abf27, 0x3f59bf70, 0x3f12bf3a
.long 0xbe803e1b, 0xbee13eb2, 0xbf603f52, 0xbf743f6b, 0x3f78bf7d, 0x3f66bf70, 0x3ef8bf12, 0x3e99beca
.long 0xbf803f80, 0xbf803f80, 0xbf803f80, 0xbf803f80, 0x00000000, 0x00000000, 0x00000000, 0x00000000
.long 0xbf7f3f30, 0xbe803f52, 0xbf423e1b, 0x00000000, 0x3dcfbf3a, 0xbf783f12, 0x3f27bf7d, 0x00000000
.long 0xbf303f7b, 0x3ee13e1b, 0xbf523eb2, 0x00000000, 0xbf3a3e4e, 0xbf663f7d, 0x3f12bf70, 0x00000000
.long 0x3e1b3eb2, 0x3f6bbf1d, 0xbf603f07, 0x00000000, 0xbf7d3f70, 0xbeca3f4a, 0x3ef8bf59, 0x00000000
.long 0x3f60bf1d, 0x3f74bf7f, 0xbf6b3f30, 0x00000000, 0xbef83f4a, 0x3e993dcf, 0x3ecabf3a, 0x00000000
.long 0x3f6bbf7f, 0x3f07bf42, 0xbf743f52, 0x00000000, 0x3ecabdcf, 0x3f59bf27, 0x3e99bf12, 0x00000000
.long 0x3e80bee1, 0xbe1bbd4f, 0xbf7b3f6b, 0x00000000, 0x3f78bf66, 0x3f7dbf80, 0x3e4ebeca, 0x00000000
.long 0xbf1d3f07, 0xbf423f30, 0xbf7f3f7b, 0x00000000, 0x3f4abf59, 0x3f27bf3a, 0x3dcfbe4e, 0x00000000
.long 0xbf803f80, 0xbf803f80, 0xbf803f80, 0x00000000, 0x00000000, 0x00000000, 0x00000000, 0x00000000
.long 0x00003c84, 0xbc973cd9, 0xbcacbcc9, 0xbb56bd03, 0x00003c84, 0xbcac3cc9, 0xbc1ebcfc, 0x3c50bcf3
.long 0x00003c84, 0xbcc03cb6, 0x3b56bd03, 0x3cd1bca2, 0x00003c84, 0xbcd13ca2, 0x3c80bce7, 0x3d03bba0
.long 0x00003c84, 0xbce03c8c, 0x3cd1bca2, 0x3cf83c38, 0x00003c84, 0xbced3c69, 0x3d00bc04, 0x3cac3cc9
.long 0x00003c84, 0xbcf83c38, 0x3d033ba0, 0x3bd53d01, 0x00003c84, 0xbd003c04, 0x3ce03c8c, 0xbc1e3cfc
.long 0x00003c84, 0xbd033ba0, 0x3c973cd9, 0xbcc03cb6, 0x00003c84, 0xbd043ad6, 0x3bd53d01, 0xbd003c04
.long 0x00003c84, 0xbd04bad6, 0xbbd53d01, 0xbd00bc04, 0x00003c84, 0xbd03bba0, 0xbc973cd9, 0xbcc0bcb6
.long 0x00003c84, 0xbd00bc04, 0xbce03c8c, 0xbc1ebcfc, 0x00003c84, 0xbcf8bc38, 0xbd033ba0, 0x3bd5bd01
.long 0x00003c84, 0xbcedbc69, 0xbd00bc04, 0x3cacbcc9, 0x00003c84, 0xbce0bc8c, 0xbcd1bca2, 0x3cf8bc38
.long 0xbcf83c38, 0xbd00bc04, 0x3c80bce7, 0x3cedbc69, 0xbd033ba0, 0xbce0bc8c, 0x3cedbc69, 0x3d003c04
.long 0xbd04bad6, 0xbcacbcc9, 0x3d033ba0, 0x3c973cd9, 0xbd00bc04, 0xbc50bcf3, 0x3cc03cb6, 0xbb563d03
.long 0xbcedbc69, 0xbb56bd03, 0x3bd53d01, 0xbcc03cb6, 0xbcd1bca2, 0x3bd5bd01, 0xbc503cf3, 0xbd043ad6
.long 0xbcacbcc9, 0x3c80bce7, 0xbce03c8c, 0xbcd1bca2, 0xbc80bce7, 0x3cc0bcb6, 0xbd04bad6, 0xbbd5bd01
.long 0xbc1ebcfc, 0x3cedbc69, 0xbcd1bca2, 0x3c80bce7, 0xbb56bd03, 0x3d03bba0, 0xbc1ebcfc, 0x3cf8bc38
.long 0x3b56bd03, 0x3d033ba0, 0x3c1ebcfc, 0x3cf83c38, 0x3c1ebcfc, 0x3ced3c69, 0x3cd1bca2, 0x3c803ce7
.long 0x3c80bce7, 0x3cc03cb6, 0x3d04bad6, 0xbbd53d01, 0x3cacbcc9, 0x3c803ce7, 0x3ce03c8c, 0xbcd13ca2
.long 0x3cd1bca2, 0x3bd53d01, 0x3c503cf3, 0xbd04bad6, 0x3cedbc69, 0xbb563d03, 0xbbd53d01, 0xbcc0bcb6
.long 0x3d033ba0, 0x3cc03cb6, 0xbce03c8c, 0xbd04bad6, 0x3c973cd9, 0xbb563d03, 0xbcd1bca2, 0xbbd5bd01
.long 0xbbd53d01, 0xbce03c8c, 0x3c1ebcfc, 0x3cedbc69, 0xbce03c8c, 0xbcf8bc38, 0x3d04bad6, 0x3cac3cc9
.long 0xbd00bc04, 0xbc1ebcfc, 0x3c503cf3, 0xbc973cd9, 0xbc80bce7, 0x3c97bcd9, 0xbcc03cb6, 0xbcf8bc38
.long 0x3c1ebcfc, 0x3d04bad6, 0xbcedbc69, 0x3b56bd03, 0x3cedbc69, 0x3cac3cc9, 0x3b56bd03, 0x3d03bba0
.long 0x3cf83c38, 0xbbd53d01, 0x3d00bc04, 0x3c503cf3, 0x3c503cf3, 0xbced3c69, 0x3c973cd9, 0xbcd13ca2
.long 0xbc503cf3, 0xbcedbc69, 0xbc973cd9, 0xbcd1bca2, 0xbcf83c38, 0xbbd5bd01, 0xbd00bc04, 0x3c50bcf3
.long 0xbcedbc69, 0x3cacbcc9, 0xbb56bd03, 0x3d033ba0, 0xbc1ebcfc, 0x3d043ad6, 0x3cedbc69, 0x3b563d03
.long 0x3c80bce7, 0x3c973cd9, 0x3cc03cb6, 0xbcf83c38, 0x3d00bc04, 0xbc1e3cfc, 0xbc503cf3, 0xbc97bcd9
.long 0x3bd53d01, 0xbc503cf3, 0xbcd1bca2, 0xbc1ebcfc, 0xbcc03cb6, 0xbd043ad6, 0x3c80bce7, 0x3cf8bc38
.long 0xbd00bc04, 0xbc80bce7, 0x3cf83c38, 0x3c503cf3, 0xbc1ebcfc, 0x3c97bcd9, 0xbbd53d01, 0xbced3c69
.long 0x3cacbcc9, 0x3d033ba0, 0xbd04bad6, 0xbc80bce7, 0x3d033ba0, 0x3c1e3cfc, 0xbb56bd03, 0x3ce0bc8c
.long 0x3c503cf3, 0xbcc03cb6, 0x3d00bc04, 0x3c973cd9, 0xbc973cd9, 0xbcf8bc38, 0x3c503cf3, 0xbcd13ca2
.long 0xbd04bad6, 0xbb56bd03, 0xbce03c8c, 0xbcacbcc9, 0xbc80bce7, 0x3ce0bc8c, 0xbcacbcc9, 0x3cc0bcb6
.long 0x3c80bce7, 0x3ce03c8c, 0x3cacbcc9, 0x3cc03cb6, 0x3d04bad6, 0xbb563d03, 0x3ce03c8c, 0xbcac3cc9
.long 0x3c973cd9, 0xbcf83c38, 0xbc503cf3, 0xbcd1bca2, 0xbc503cf3, 0xbcc0bcb6, 0xbd00bc04, 0x3c97bcd9
.long 0xbd033ba0, 0x3c1ebcfc, 0x3b56bd03, 0x3ce03c8c, 0xbcacbcc9, 0x3d03bba0, 0x3d04bad6, 0xbc803ce7
.long 0x3c1ebcfc, 0x3cd1bca2, 0x3c503cf3, 0xbbd53d01, 0x3cf83c38, 0x3c803ce7, 0xbd04bad6, 0xbcc0bcb6
.long 0xbc503cf3, 0xbcf83c38, 0x3c80bce7, 0x3d00bc04, 0xbcedbc69, 0xbbd5bd01, 0x3c973cd9, 0xbc1e3cfc
.long 0x3c80bce7, 0x3d04bad6, 0xbd033ba0, 0xbcacbcc9, 0x3ce03c8c, 0xbb563d03, 0x3c1ebcfc, 0x3d03bba0
.long 0xbc973cd9, 0xbd00bc04, 0x3cc03cb6, 0xbc503cf3, 0xbcd1bca2, 0x3c50bcf3, 0xbcf83c38, 0xbc97bcd9
.long 0x3cacbcc9, 0x3ce03c8c, 0x3b56bd03, 0x3d04bad6, 0x3cc03cb6, 0xbcac3cc9, 0x3ce03c8c, 0xbc803ce7
.long 0xbcc03cb6, 0xbcacbcc9, 0xbce03c8c, 0xbc80bce7, 0xbcacbcc9, 0x3ce0bc8c, 0xbb56bd03, 0x3d043ad6
.long 0x3cd1bca2, 0x3c503cf3, 0x3cf83c38, 0xbc973cd9, 0x3c973cd9, 0xbd003c04, 0xbcc03cb6, 0xbc50bcf3
.long 0xbce03c8c, 0xbb56bd03, 0xbc1ebcfc, 0x3d033ba0, 0xbc80bce7, 0x3d043ad6, 0x3d033ba0, 0xbcac3cc9
.long 0x3d04bad6, 0x3ce03c8c, 0xbcc03cb6, 0xbd033ba0, 0xbbd53d01, 0xbcd13ca2, 0xbb56bd03, 0x3c97bcd9
.long 0xbcedbc69, 0xbc1ebcfc, 0x3ce03c8c, 0x3bd53d01, 0x3cacbcc9, 0x3d043ad6, 0xbcf83c38, 0xbce0bc8c
.long 0x3c973cd9, 0xbc503cf3, 0x3c1ebcfc, 0x3d00bc04, 0xbcf83c38, 0xbcc0bcb6, 0x3c973cd9, 0xbc803ce7
.long 0xbb56bd03, 0x3cedbc69, 0xbd04bad6, 0xbc1ebcfc, 0x3d033ba0, 0x3b563d03, 0x3cacbcc9, 0x3ced3c69
.long 0xbc503cf3, 0xbd00bc04, 0x3bd53d01, 0xbcf83c38, 0xbcd1bca2, 0x3c97bcd9, 0xbcedbc69, 0x3c50bcf3
.long 0x3cd1bca2, 0x3c973cd9, 0x3cedbc69, 0x3c503cf3, 0x3c503cf3, 0xbd003c04, 0xbbd53d01, 0xbcf8bc38
.long 0xbd033ba0, 0x3b56bd03, 0xbcacbcc9, 0x3cedbc69, 0x3b56bd03, 0x3ced3c69, 0x3d04bad6, 0xbc1e3cfc
.long 0x3cf83c38, 0xbcc03cb6, 0xbc973cd9, 0xbc80bce7, 0xbc973cd9, 0xbc50bcf3, 0xbc1ebcfc, 0x3d003c04
.long 0xbcedbc69, 0xbc80bce7, 0x3d00bc04, 0x3cf83c38, 0x3d00bc04, 0x3ced3c69, 0xbce03c8c, 0xbd03bba0
.long 0xbc973cd9, 0xbd033ba0, 0x3cacbcc9, 0x3d04bad6, 0xbb56bd03, 0x3cc0bcb6, 0xbc503cf3, 0xbd003c04
.long 0x3cc03cb6, 0xbbd53d01, 0x3b56bd03, 0x3cedbc69, 0xbd04bad6, 0xbc50bcf3, 0x3bd53d01, 0xbcd13ca2
.long 0x3cd1bca2, 0x3ce03c8c, 0xbc80bce7, 0x3cacbcc9, 0xbbd53d01, 0xbd043ad6, 0x3cc03cb6, 0xbc803ce7
.long 0xbc80bce7, 0x3cd1bca2, 0xbcedbc69, 0x3c1ebcfc, 0x3cf83c38, 0xbc1e3cfc, 0x3d033ba0, 0xbb563d03
.long 0xbcf83c38, 0xbc1ebcfc, 0xbd033ba0, 0xbb56bd03, 0x3c80bce7, 0x3cd13ca2, 0x3cedbc69, 0x3c1e3cfc
.long 0x3bd53d01, 0xbd04bad6, 0xbcc03cb6, 0xbc80bce7, 0xbcd1bca2, 0x3ce0bc8c, 0x3c80bce7, 0x3cac3cc9
.long 0x3d04bad6, 0xbc503cf3, 0xbbd53d01, 0xbcd1bca2, 0xbcc03cb6, 0xbbd5bd01, 0xbb56bd03, 0x3ced3c69
.long 0x3b56bd03, 0x3cacbcc9, 0x3c973cd9, 0x00003c84, 0x3c503cf3, 0xbc1e3cfc, 0xbcacbcc9, 0x0000bc84
.long 0xbcd1bca2, 0xbb56bd03, 0x3cc03cb6, 0x00003c84, 0x3d033ba0, 0x3c803ce7, 0xbcd1bca2, 0x0000bc84
.long 0xbcf83c38, 0xbcd1bca2, 0x3ce03c8c, 0x00003c84, 0x3cacbcc9, 0x3d003c04, 0xbcedbc69, 0x0000bc84
.long 0xbbd53d01, 0xbd033ba0, 0x3cf83c38, 0x00003c84, 0xbc1ebcfc, 0x3ce0bc8c, 0xbd00bc04, 0x0000bc84
.long 0x3cc03cb6, 0xbc973cd9, 0x3d033ba0, 0x00003c84, 0xbd00bc04, 0x3bd5bd01, 0xbd04bad6, 0x0000bc84
.long 0x3d00bc04, 0x3bd53d01, 0x3d04bad6, 0x00003c84, 0xbcc03cb6, 0xbc97bcd9, 0xbd033ba0, 0x0000bc84
.long 0x3c1ebcfc, 0x3ce03c8c, 0x3d00bc04, 0x00003c84, 0x3bd53d01, 0xbd03bba0, 0xbcf83c38, 0x0000bc84
.long 0xbcacbcc9, 0x3d00bc04, 0x3cedbc69, 0x00003c84, 0x3cf83c38, 0xbcd13ca2, 0xbce03c8c, 0x0000bc84
.long 0x00003c84, 0xbcd1bca2, 0xbc80bce7, 0x3d033ba0, 0x00003c84, 0xbcc0bcb6, 0xbb56bd03, 0x3cd13ca2
.long 0x00003c84, 0xbcacbcc9, 0x3c1ebcfc, 0x3c503cf3, 0x00003c84, 0xbc97bcd9, 0x3cacbcc9, 0xbb563d03
.long 0x00003c84, 0xbc80bce7, 0x3cedbc69, 0xbc973cd9, 0x00003c84, 0xbc50bcf3, 0x3d04bad6, 0xbced3c69
.long 0x00003c84, 0xbc1ebcfc, 0x3cf83c38, 0xbd04bad6, 0x00003c84, 0xbbd5bd01, 0x3cc03cb6, 0xbce0bc8c
.long 0x00003c84, 0xbb56bd03, 0x3c503cf3, 0xbc80bce7, 0x00003c84, 0x0000bd04, 0x00003d04, 0x0000bd04
.long 0x00003c84, 0x3b56bd03, 0xbc503cf3, 0x3c80bce7, 0x00003c84, 0x3bd5bd01, 0xbcc03cb6, 0x3ce0bc8c
.long 0x00003c84, 0x3c1ebcfc, 0xbcf83c38, 0x3d04bad6, 0x00003c84, 0x3c50bcf3, 0xbd04bad6, 0x3ced3c69
.long 0x00003c84, 0x3c80bce7, 0xbcedbc69, 0x3c973cd9, 0x00003c84, 0x3c97bcd9, 0xbcacbcc9, 0x3b563d03
.long 0x3d00bc04, 0xbc503cf3, 0xbcc03cb6, 0xbb56bd03, 0x3d04bad6, 0xbcac3cc9, 0xbd033ba0, 0x3c97bcd9
.long 0x3d033ba0, 0xbce03c8c, 0xbcedbc69, 0x3d00bc04, 0x3cf83c38, 0xbd003c04, 0xbc80bce7, 0x3ced3c69
.long 0x3ce03c8c, 0xbd04bad6, 0x3b56bd03, 0x3c503cf3, 0x3cc03cb6, 0xbcf8bc38, 0x3cacbcc9, 0xbc1e3cfc
.long 0x3c973cd9, 0xbcd1bca2, 0x3d00bc04, 0xbce03c8c, 0x3c503cf3, 0xbc97bcd9, 0x3cf83c38, 0xbd03bba0
.long 0x3bd53d01, 0xbc1ebcfc, 0x3c973cd9, 0xbcacbcc9, 0x00003d04, 0x0000bd04, 0x00003d04, 0x0000bd04
.long 0xbbd53d01, 0x3c1ebcfc, 0xbc973cd9, 0x3cacbcc9, 0xbc503cf3, 0x3c97bcd9, 0xbcf83c38, 0x3d03bba0
.long 0xbc973cd9, 0x3cd1bca2, 0xbd00bc04, 0x3ce03c8c, 0xbcc03cb6, 0x3cf8bc38, 0xbcacbcc9, 0x3c1e3cfc
.long 0xbce03c8c, 0x3d04bad6, 0xbb56bd03, 0xbc503cf3, 0xbcf83c38, 0x3d003c04, 0x3c80bce7, 0xbced3c69
.long 0x3ce03c8c, 0xbcf83c38, 0xbd04bad6, 0x3cacbcc9, 0x3bd53d01, 0xbce0bc8c, 0xbc1ebcfc, 0x3ced3c69
.long 0xbc973cd9, 0xbb56bd03, 0x3cd1bca2, 0xbbd53d01, 0xbd033ba0, 0x3cc0bcb6, 0x3ce03c8c, 0xbd043ad6
.long 0xbcd1bca2, 0x3d033ba0, 0xbbd53d01, 0xbc1ebcfc, 0xbb56bd03, 0x3c803ce7, 0xbd033ba0, 0x3ce0bc8c
.long 0x3cacbcc9, 0xbc503cf3, 0xbc80bce7, 0x3cc03cb6, 0x3d04bad6, 0xbd003c04, 0x3cacbcc9, 0xbc803ce7
.long 0x3cc03cb6, 0xbcd1bca2, 0x3cf83c38, 0xbd00bc04, 0x00003d04, 0x0000bd04, 0x00003d04, 0x0000bd04
.long 0xbcc03cb6, 0x3cd1bca2, 0xbcf83c38, 0x3d00bc04, 0xbd04bad6, 0x3d003c04, 0xbcacbcc9, 0x3c803ce7
.long 0xbcacbcc9, 0x3c503cf3, 0x3c80bce7, 0xbcc03cb6, 0x3b56bd03, 0xbc803ce7, 0x3d033ba0, 0xbce0bc8c
.long 0x3cd1bca2, 0xbd033ba0, 0x3bd53d01, 0x3c1ebcfc, 0x3d033ba0, 0xbcc0bcb6, 0xbce03c8c, 0x3d043ad6
.long 0x3c1ebcfc, 0x3c973cd9, 0x3bd53d01, 0xbcedbc69, 0x3d00bc04, 0xbc803ce7, 0xbcf83c38, 0x3c50bcf3
.long 0x3cc03cb6, 0xbd04bad6, 0xbc80bce7, 0x3cf83c38, 0xbbd53d01, 0xbc50bcf3, 0x3cd1bca2, 0xbc1e3cfc
.long 0xbcf83c38, 0x3cacbcc9, 0x3cc03cb6, 0xbd00bc04, 0xbcd1bca2, 0x3d003c04, 0xbc973cd9, 0x3bd5bd01
.long 0x3b56bd03, 0x3bd53d01, 0xbcedbc69, 0x3d033ba0, 0x3cedbc69, 0xbcd13ca2, 0x3c1ebcfc, 0xbb563d03
.long 0x3ce03c8c, 0xbcedbc69, 0x3d033ba0, 0xbd04bad6, 0x00003d04, 0x0000bd04, 0x00003d04, 0x0000bd04
.long 0xbce03c8c, 0x3cedbc69, 0xbd033ba0, 0x3d04bad6, 0xbcedbc69, 0x3cd13ca2, 0xbc1ebcfc, 0x3b563d03
.long 0xbb56bd03, 0xbbd53d01, 0x3cedbc69, 0xbd033ba0, 0x3cd1bca2, 0xbd003c04, 0x3c973cd9, 0xbbd5bd01
.long 0x3cf83c38, 0xbcacbcc9, 0xbcc03cb6, 0x3d00bc04, 0x3bd53d01, 0x3c50bcf3, 0xbcd1bca2, 0x3c1e3cfc
.long 0x3cedbc69, 0xbbd53d01, 0xbc973cd9, 0xbc1ebcfc, 0x3c503cf3, 0xbcf8bc38, 0xbc80bce7, 0x3d003c04
.long 0xbcf83c38, 0x3c80bce7, 0x3d04bad6, 0xbcc03cb6, 0xbc1ebcfc, 0x3cd13ca2, 0xbc503cf3, 0xbbd5bd01
.long 0x3d00bc04, 0xbcc03cb6, 0xbcacbcc9, 0x3cf83c38, 0x3bd53d01, 0xbc97bcd9, 0x3d00bc04, 0xbcd13ca2
.long 0xbd033ba0, 0x3cedbc69, 0xbbd53d01, 0xbb56bd03, 0xbb56bd03, 0x3c1e3cfc, 0xbcd1bca2, 0x3ced3c69
.long 0x3d04bad6, 0xbd033ba0, 0x3cedbc69, 0xbce03c8c, 0x00003d04, 0x0000bd04, 0x00003d04, 0x0000bd04
.long 0xbd04bad6, 0x3d033ba0, 0xbcedbc69, 0x3ce03c8c, 0x3b56bd03, 0xbc1e3cfc, 0x3cd1bca2, 0xbced3c69
.long 0x3d033ba0, 0xbcedbc69, 0x3bd53d01, 0x3b56bd03, 0xbbd53d01, 0x3c97bcd9, 0xbd00bc04, 0x3cd13ca2
.long 0xbd00bc04, 0x3cc03cb6, 0x3cacbcc9, 0xbcf83c38, 0x3c1ebcfc, 0xbcd13ca2, 0x3c503cf3, 0x3bd5bd01
.long 0xbcacbcc9, 0x3d04bad6, 0x3cf83c38, 0xbce03c8c, 0x3cedbc69, 0xbc1e3cfc, 0xbce03c8c, 0x3bd5bd01
.long 0x3bd53d01, 0xbcd1bca2, 0x3b56bd03, 0x3c973cd9, 0xbd04bad6, 0x3ce0bc8c, 0x3cc03cb6, 0xbd03bba0
.long 0x3c1ebcfc, 0x3bd53d01, 0xbd033ba0, 0x3cd1bca2, 0x3ce03c8c, 0xbd03bba0, 0x3c80bce7, 0xbb563d03
.long 0xbcc03cb6, 0x3c80bce7, 0x3c503cf3, 0xbcacbcc9, 0xbc80bce7, 0x3cac3cc9, 0xbd00bc04, 0x3d043ad6
.long 0x3d00bc04, 0xbcf83c38, 0x3cd1bca2, 0xbcc03cb6, 0x00003d04, 0x0000bd04, 0x00003d04, 0x0000bd04
.long 0xbd00bc04, 0x3cf83c38, 0xbcd1bca2, 0x3cc03cb6, 0x3c80bce7, 0xbcac3cc9, 0x3d00bc04, 0xbd043ad6
.long 0x3cc03cb6, 0xbc80bce7, 0xbc503cf3, 0x3cacbcc9, 0xbce03c8c, 0x3d03bba0, 0xbc80bce7, 0x3b563d03
.long 0xbc1ebcfc, 0xbbd53d01, 0x3d033ba0, 0xbcd1bca2, 0x3d04bad6, 0xbce0bc8c, 0xbcc03cb6, 0x3d03bba0
.long 0x3b56bd03, 0x3cc03cb6, 0x3c503cf3, 0xbd00bc04, 0x3c973cd9, 0xbd03bba0, 0xbcacbcc9, 0x3d043ad6
.long 0xbd00bc04, 0x3cedbc69, 0x3ce03c8c, 0xbd033ba0, 0x3cedbc69, 0xbc803ce7, 0xbd00bc04, 0x3cf8bc38
.long 0xbc503cf3, 0xbb56bd03, 0x3d04bad6, 0xbce03c8c, 0xbc1ebcfc, 0x3cac3cc9, 0xbcf83c38, 0x3cc0bcb6
.long 0x3ce03c8c, 0xbd00bc04, 0x3cd1bca2, 0xbc973cd9, 0xbd033ba0, 0x3cf8bc38, 0xbc973cd9, 0x3c50bcf3
.long 0x3cacbcc9, 0xbc973cd9, 0x3c1ebcfc, 0xbbd53d01, 0x00003d04, 0x0000bd04, 0x00003d04, 0x0000bd04
.long 0xbcacbcc9, 0x3c973cd9, 0xbc1ebcfc, 0x3bd53d01, 0x3d033ba0, 0xbcf8bc38, 0x3c973cd9, 0xbc50bcf3
.long 0xbce03c8c, 0x3d00bc04, 0xbcd1bca2, 0x3c973cd9, 0x3c1ebcfc, 0xbcac3cc9, 0x3cf83c38, 0xbcc0bcb6
.long 0x3c503cf3, 0x3b56bd03, 0xbd04bad6, 0x3ce03c8c, 0xbcedbc69, 0x3c803ce7, 0x3d00bc04, 0xbcf8bc38
.long 0xbd033ba0, 0x3c80bce7, 0x3cd1bca2, 0x00003c84, 0x3cd1bca2, 0xbb563d03, 0xbcc03cb6, 0x0000bc84
.long 0xbc503cf3, 0xbc1ebcfc, 0x3cacbcc9, 0x00003c84, 0xbb56bd03, 0x3cac3cc9, 0xbc973cd9, 0x0000bc84
.long 0x3c973cd9, 0xbcedbc69, 0x3c80bce7, 0x00003c84, 0xbcedbc69, 0x3d043ad6, 0xbc503cf3, 0x0000bc84
.long 0x3d04bad6, 0xbcf83c38, 0x3c1ebcfc, 0x00003c84, 0xbce03c8c, 0x3cc0bcb6, 0xbbd53d01, 0x0000bc84
.long 0x3c80bce7, 0xbc503cf3, 0x3b56bd03, 0x00003c84, 0x00003d04, 0x0000bd04, 0x00003d04, 0x0000bc84
.long 0xbc80bce7, 0x3c503cf3, 0xbb56bd03, 0x00003c84, 0x3ce03c8c, 0xbcc0bcb6, 0x3bd53d01, 0x0000bc84
.long 0xbd04bad6, 0x3cf83c38, 0xbc1ebcfc, 0x00003c84, 0x3cedbc69, 0xbd043ad6, 0x3c503cf3, 0x0000bc84
.long 0xbc973cd9, 0x3cedbc69, 0xbc80bce7, 0x00003c84, 0x3b56bd03, 0xbcac3cc9, 0x3c973cd9, 0x0000bc84
.long 0x00003c84, 0x3cacbcc9, 0xbc1ebcfc, 0xbc503cf3, 0x00003c84, 0x3cc0bcb6, 0x3b56bd03, 0xbcd13ca2
.long 0x00003c84, 0x3cd1bca2, 0x3c80bce7, 0xbd033ba0, 0x00003c84, 0x3ce0bc8c, 0x3cd1bca2, 0xbcf8bc38
.long 0x00003c84, 0x3cedbc69, 0x3d00bc04, 0xbcacbcc9, 0x00003c84, 0x3cf8bc38, 0x3d033ba0, 0xbbd5bd01
.long 0x00003c84, 0x3d00bc04, 0x3ce03c8c, 0x3c1ebcfc, 0x00003c84, 0x3d03bba0, 0x3c973cd9, 0x3cc0bcb6
.long 0x00003c84, 0x3d04bad6, 0x3bd53d01, 0x3d00bc04, 0x00003c84, 0x3d043ad6, 0xbbd53d01, 0x3d003c04
.long 0x00003c84, 0x3d033ba0, 0xbc973cd9, 0x3cc03cb6, 0x00003c84, 0x3d003c04, 0xbce03c8c, 0x3c1e3cfc
.long 0x00003c84, 0x3cf83c38, 0xbd033ba0, 0xbbd53d01, 0x00003c84, 0x3ced3c69, 0xbd00bc04, 0xbcac3cc9
.long 0x00003c84, 0x3ce03c8c, 0xbcd1bca2, 0xbcf83c38, 0x00003c84, 0x3cd13ca2, 0xbc80bce7, 0xbd03bba0
.long 0xbd033ba0, 0x3ce03c8c, 0x3cedbc69, 0xbd00bc04, 0xbd04bad6, 0x3cac3cc9, 0x3d033ba0, 0xbc97bcd9
.long 0xbd00bc04, 0x3c503cf3, 0x3cc03cb6, 0x3b56bd03, 0xbcedbc69, 0x3b563d03, 0x3bd53d01, 0x3cc0bcb6
.long 0xbcd1bca2, 0xbbd53d01, 0xbc503cf3, 0x3d04bad6, 0xbcacbcc9, 0xbc803ce7, 0xbce03c8c, 0x3cd13ca2
.long 0xbc80bce7, 0xbcc03cb6, 0xbd04bad6, 0x3bd53d01, 0xbc1ebcfc, 0xbced3c69, 0xbcd1bca2, 0xbc803ce7
.long 0xbb56bd03, 0xbd033ba0, 0xbc1ebcfc, 0xbcf83c38, 0x3b56bd03, 0xbd03bba0, 0x3c1ebcfc, 0xbcf8bc38
.long 0x3c1ebcfc, 0xbcedbc69, 0x3cd1bca2, 0xbc80bce7, 0x3c80bce7, 0xbcc0bcb6, 0x3d04bad6, 0x3bd5bd01
.long 0x3cacbcc9, 0xbc80bce7, 0x3ce03c8c, 0x3cd1bca2, 0x3cd1bca2, 0xbbd5bd01, 0x3c503cf3, 0x3d043ad6
.long 0x3cedbc69, 0x3b56bd03, 0xbbd53d01, 0x3cc03cb6, 0x3d00bc04, 0x3c50bcf3, 0xbcc03cb6, 0x3b563d03
.long 0x3c973cd9, 0x3b56bd03, 0xbcd1bca2, 0x3bd53d01, 0xbbd53d01, 0x3ce0bc8c, 0x3c1ebcfc, 0xbced3c69
.long 0xbce03c8c, 0x3cf83c38, 0x3d04bad6, 0xbcacbcc9, 0xbd00bc04, 0x3c1e3cfc, 0x3c503cf3, 0x3c97bcd9
.long 0xbc80bce7, 0xbc973cd9, 0xbcc03cb6, 0x3cf83c38, 0x3c1ebcfc, 0xbd043ad6, 0xbcedbc69, 0xbb563d03
.long 0x3cedbc69, 0xbcacbcc9, 0x3b56bd03, 0xbd033ba0, 0x3cf83c38, 0x3bd5bd01, 0x3d00bc04, 0xbc50bcf3
.long 0x3c503cf3, 0x3cedbc69, 0x3c973cd9, 0x3cd1bca2, 0xbc503cf3, 0x3ced3c69, 0xbc973cd9, 0x3cd13ca2
.long 0xbcf83c38, 0x3bd53d01, 0xbd00bc04, 0xbc503cf3, 0xbcedbc69, 0xbcac3cc9, 0xbb56bd03, 0xbd03bba0
.long 0xbc1ebcfc, 0xbd04bad6, 0x3cedbc69, 0xbb56bd03, 0x3c80bce7, 0xbc97bcd9, 0x3cc03cb6, 0x3cf8bc38
.long 0x3d00bc04, 0x3c1ebcfc, 0xbc503cf3, 0x3c973cd9, 0x3ce03c8c, 0x3cf8bc38, 0xbd04bad6, 0xbcac3cc9
.long 0xbcc03cb6, 0x3d04bad6, 0x3c80bce7, 0xbcf83c38, 0xbd00bc04, 0x3c803ce7, 0x3cf83c38, 0xbc50bcf3
.long 0xbc1ebcfc, 0xbc973cd9, 0xbbd53d01, 0x3cedbc69, 0x3cacbcc9, 0xbd03bba0, 0xbd04bad6, 0x3c803ce7
.long 0x3d033ba0, 0xbc1ebcfc, 0xbb56bd03, 0xbce03c8c, 0x3c503cf3, 0x3cc0bcb6, 0x3d00bc04, 0xbc97bcd9
.long 0xbc973cd9, 0x3cf83c38, 0x3c503cf3, 0x3cd1bca2, 0xbd04bad6, 0x3b563d03, 0xbce03c8c, 0x3cac3cc9
.long 0xbc80bce7, 0xbce03c8c, 0xbcacbcc9, 0xbcc03cb6, 0x3c80bce7, 0xbce0bc8c, 0x3cacbcc9, 0xbcc0bcb6
.long 0x3d04bad6, 0x3b56bd03, 0x3ce03c8c, 0x3cacbcc9, 0x3c973cd9, 0x3cf8bc38, 0xbc503cf3, 0x3cd13ca2
.long 0xbc503cf3, 0x3cc03cb6, 0xbd00bc04, 0xbc973cd9, 0xbd033ba0, 0xbc1e3cfc, 0x3b56bd03, 0xbce0bc8c
.long 0xbcacbcc9, 0xbd033ba0, 0x3d04bad6, 0x3c80bce7, 0x3c1ebcfc, 0xbc97bcd9, 0x3bd53d01, 0x3ced3c69
.long 0x3cf83c38, 0xbc80bce7, 0xbd04bad6, 0x3cc03cb6, 0xbc503cf3, 0x3cf8bc38, 0x3c80bce7, 0xbd003c04
.long 0xbcedbc69, 0x3bd53d01, 0x3c973cd9, 0x3c1ebcfc, 0x3c80bce7, 0xbd043ad6, 0xbd033ba0, 0x3cac3cc9
.long 0x3ce03c8c, 0x3b56bd03, 0x3c1ebcfc, 0xbd033ba0, 0xbc973cd9, 0x3d003c04, 0x3cc03cb6, 0x3c50bcf3
.long 0xbcd1bca2, 0xbc503cf3, 0xbcf83c38, 0x3c973cd9, 0x3cacbcc9, 0xbce0bc8c, 0x3b56bd03, 0xbd043ad6
.long 0x3cc03cb6, 0x3cacbcc9, 0x3ce03c8c, 0x3c80bce7, 0xbcc03cb6, 0x3cac3cc9, 0xbce03c8c, 0x3c803ce7
.long 0xbcacbcc9, 0xbce03c8c, 0xbb56bd03, 0xbd04bad6, 0x3cd1bca2, 0xbc50bcf3, 0x3cf83c38, 0x3c97bcd9
.long 0x3c973cd9, 0x3d00bc04, 0xbcc03cb6, 0x3c503cf3, 0xbce03c8c, 0x3b563d03, 0xbc1ebcfc, 0xbd03bba0
.long 0xbc80bce7, 0xbd04bad6, 0x3d033ba0, 0x3cacbcc9, 0x3cedbc69, 0x3bd5bd01, 0xbc973cd9, 0x3c1e3cfc
.long 0xbbd53d01, 0x3cd1bca2, 0xbb56bd03, 0xbc973cd9, 0xbcedbc69, 0x3c1e3cfc, 0x3ce03c8c, 0xbbd5bd01
.long 0x3cacbcc9, 0xbd04bad6, 0xbcf83c38, 0x3ce03c8c, 0x3c973cd9, 0x3c50bcf3, 0x3c1ebcfc, 0xbd003c04
.long 0xbcf83c38, 0x3cc03cb6, 0x3c973cd9, 0x3c80bce7, 0xbb56bd03, 0xbced3c69, 0xbd04bad6, 0x3c1e3cfc
.long 0x3d033ba0, 0xbb56bd03, 0x3cacbcc9, 0xbcedbc69, 0xbc503cf3, 0x3d003c04, 0x3bd53d01, 0x3cf8bc38
.long 0xbcd1bca2, 0xbc973cd9, 0xbcedbc69, 0xbc503cf3, 0x3cd1bca2, 0xbc97bcd9, 0x3cedbc69, 0xbc50bcf3
.long 0x3c503cf3, 0x3d00bc04, 0xbbd53d01, 0x3cf83c38, 0xbd033ba0, 0xbb563d03, 0xbcacbcc9, 0xbced3c69
.long 0x3b56bd03, 0xbcedbc69, 0x3d04bad6, 0x3c1ebcfc, 0x3cf83c38, 0x3cc0bcb6, 0xbc973cd9, 0x3c803ce7
.long 0xbc973cd9, 0x3c503cf3, 0xbc1ebcfc, 0xbd00bc04, 0xbcacbcc9, 0xbd043ad6, 0x3cf83c38, 0x3ce0bc8c
.long 0x3d00bc04, 0xbcedbc69, 0xbce03c8c, 0x3d033ba0, 0xbc973cd9, 0x3d03bba0, 0x3cacbcc9, 0xbd043ad6
.long 0xbb56bd03, 0xbcc03cb6, 0xbc503cf3, 0x3d00bc04, 0x3cc03cb6, 0x3bd5bd01, 0x3b56bd03, 0xbced3c69
.long 0xbd04bad6, 0x3c503cf3, 0x3bd53d01, 0x3cd1bca2, 0x3cd1bca2, 0xbce0bc8c, 0xbc80bce7, 0xbcac3cc9
.long 0xbbd53d01, 0x3d04bad6, 0x3cc03cb6, 0x3c80bce7, 0xbc80bce7, 0xbcd13ca2, 0xbcedbc69, 0xbc1e3cfc
.long 0x3cf83c38, 0x3c1ebcfc, 0x3d033ba0, 0x3b56bd03, 0xbcf83c38, 0x3c1e3cfc, 0xbd033ba0, 0x3b563d03
.long 0x3c80bce7, 0xbcd1bca2, 0x3cedbc69, 0xbc1ebcfc, 0x3bd53d01, 0x3d043ad6, 0xbcc03cb6, 0x3c803ce7
.long 0xbcd1bca2, 0xbce03c8c, 0x3c80bce7, 0xbcacbcc9, 0x3d04bad6, 0x3c50bcf3, 0xbbd53d01, 0x3cd13ca2
.long 0xbcc03cb6, 0x3bd53d01, 0xbb56bd03, 0xbcedbc69, 0x3b56bd03, 0xbcc0bcb6, 0x3c503cf3, 0x3d003c04
.long 0x3c503cf3, 0x3c1ebcfc, 0xbcacbcc9, 0x00003c84, 0xbcd1bca2, 0x3b563d03, 0x3cc03cb6, 0x0000bc84
.long 0x3d033ba0, 0xbc80bce7, 0xbcd1bca2, 0x00003c84, 0xbcf83c38, 0x3cd13ca2, 0x3ce03c8c, 0x0000bc84
.long 0x3cacbcc9, 0xbd00bc04, 0xbcedbc69, 0x00003c84, 0xbbd53d01, 0x3d03bba0, 0x3cf83c38, 0x0000bc84
.long 0xbc1ebcfc, 0xbce03c8c, 0xbd00bc04, 0x00003c84, 0x3cc03cb6, 0x3c97bcd9, 0x3d033ba0, 0x0000bc84
.long 0xbd00bc04, 0xbbd53d01, 0xbd04bad6, 0x00003c84, 0x3d00bc04, 0xbbd5bd01, 0x3d04bad6, 0x0000bc84
.long 0xbcc03cb6, 0x3c973cd9, 0xbd033ba0, 0x00003c84, 0x3c1ebcfc, 0xbce0bc8c, 0x3d00bc04, 0x0000bc84
.long 0x3bd53d01, 0x3d033ba0, 0xbcf83c38, 0x00003c84, 0xbcacbcc9, 0xbd003c04, 0x3cedbc69, 0x0000bc84
.long 0x3cf83c38, 0x3cd1bca2, 0xbce03c8c, 0x00003c84, 0xbd033ba0, 0xbc803ce7, 0x3cd1bca2, 0x0000bc84
.long 0x00003c84, 0x3cc03cb6, 0xbb56bd03, 0xbcd1bca2, 0x00003c84, 0x3cac3cc9, 0x3c1ebcfc, 0xbc50bcf3
.long 0x00003c84, 0x3c973cd9, 0x3cacbcc9, 0x3b56bd03, 0x00003c84, 0x3c803ce7, 0x3cedbc69, 0x3c97bcd9
.long 0x00003c84, 0x3c503cf3, 0x3d04bad6, 0x3cedbc69, 0x00003c84, 0x3c1e3cfc, 0x3cf83c38, 0x3d043ad6
.long 0x00003c84, 0x3bd53d01, 0x3cc03cb6, 0x3ce03c8c, 0x00003c84, 0x3b563d03, 0x3c503cf3, 0x3c803ce7
.long 0x00000000, 0x00000000, 0x00000000, 0x00000000, 0x00000000, 0x00000000, 0x00000000, 0x00000000
.long 0x00000000, 0x00000000, 0x00000000, 0x00000000, 0x00000000, 0x00000000, 0x00000000, 0x00000000
.long 0x00000000, 0x00000000, 0x00000000, 0x00000000, 0x00000000, 0x00000000, 0x00000000, 0x00000000
.long 0x00000000, 0x00000000, 0x00000000, 0x00000000, 0x00000000, 0x00000000, 0x00000000, 0x00000000
.long 0x3d04bad6, 0x3cacbcc9, 0xbd033ba0, 0xbc973cd9, 0x3d033ba0, 0x3ce0bc8c, 0xbcedbc69, 0xbd003c04
.long 0x3cf83c38, 0x3d00bc04, 0xbc80bce7, 0xbcedbc69, 0x3ce03c8c, 0x3d043ad6, 0x3b56bd03, 0xbc50bcf3
.long 0x3cc03cb6, 0x3cf83c38, 0x3cacbcc9, 0x3c1ebcfc, 0x3c973cd9, 0x3cd13ca2, 0x3d00bc04, 0x3ce0bc8c
.long 0x3c503cf3, 0x3c973cd9, 0x3cf83c38, 0x3d033ba0, 0x3bd53d01, 0x3c1e3cfc, 0x3c973cd9, 0x3cac3cc9
.long 0x00000000, 0x00000000, 0x00000000, 0x00000000, 0x00000000, 0x00000000, 0x00000000, 0x00000000
.long 0x00000000, 0x00000000, 0x00000000, 0x00000000, 0x00000000, 0x00000000, 0x00000000, 0x00000000
.long 0x00000000, 0x00000000, 0x00000000, 0x00000000, 0x00000000, 0x00000000, 0x00000000, 0x00000000
.long 0x00000000, 0x00000000, 0x00000000, 0x00000000, 0x00000000, 0x00000000, 0x00000000, 0x00000000
.long 0x3bd53d01, 0x3ce03c8c, 0xbc1ebcfc, 0xbcedbc69, 0xbc973cd9, 0x3b563d03, 0x3cd1bca2, 0x3bd5bd01
.long 0xbd033ba0, 0xbcc03cb6, 0x3ce03c8c, 0x3d04bad6, 0xbcd1bca2, 0xbd03bba0, 0xbbd53d01, 0x3c1e3cfc
.long 0xbb56bd03, 0xbc80bce7, 0xbd033ba0, 0xbce03c8c, 0x3cacbcc9, 0x3c50bcf3, 0xbc80bce7, 0xbcc0bcb6
.long 0x3d04bad6, 0x3d00bc04, 0x3cacbcc9, 0x3c80bce7, 0x3cc03cb6, 0x3cd13ca2, 0x3cf83c38, 0x3d003c04
.long 0x00000000, 0x00000000, 0x00000000, 0x00000000, 0x00000000, 0x00000000, 0x00000000, 0x00000000
.long 0x00000000, 0x00000000, 0x00000000, 0x00000000, 0x00000000, 0x00000000, 0x00000000, 0x00000000
.long 0x00000000, 0x00000000, 0x00000000, 0x00000000, 0x00000000, 0x00000000, 0x00000000, 0x00000000
.long 0x00000000, 0x00000000, 0x00000000, 0x00000000, 0x00000000, 0x00000000, 0x00000000, 0x00000000
.long 0x3d00bc04, 0x3c80bce7, 0xbcf83c38, 0xbc503cf3, 0x3cc03cb6, 0x3d043ad6, 0xbc80bce7, 0xbcf8bc38
.long 0xbbd53d01, 0x3c503cf3, 0x3cd1bca2, 0x3c1ebcfc, 0xbcf83c38, 0xbcac3cc9, 0x3cc03cb6, 0x3d003c04
.long 0xbcd1bca2, 0xbd00bc04, 0xbc973cd9, 0xbbd53d01, 0x3b56bd03, 0xbbd5bd01, 0xbcedbc69, 0xbd03bba0
.long 0x3cedbc69, 0x3cd1bca2, 0x3c1ebcfc, 0x3b56bd03, 0x3ce03c8c, 0x3ced3c69, 0x3d033ba0, 0x3d043ad6
.long 0x00000000, 0x00000000, 0x00000000, 0x00000000, 0x00000000, 0x00000000, 0x00000000, 0x00000000
.long 0x00000000, 0x00000000, 0x00000000, 0x00000000, 0x00000000, 0x00000000, 0x00000000, 0x00000000
.long 0x00000000, 0x00000000, 0x00000000, 0x00000000, 0x00000000, 0x00000000, 0x00000000, 0x00000000
.long 0x00000000, 0x00000000, 0x00000000, 0x00000000, 0x00000000, 0x00000000, 0x00000000, 0x00000000
.long 0x3c503cf3, 0x3cf83c38, 0xbc80bce7, 0xbd00bc04, 0xbcf83c38, 0xbc803ce7, 0x3d04bad6, 0x3cc0bcb6
.long 0xbc1ebcfc, 0xbcd1bca2, 0xbc503cf3, 0x3bd53d01, 0x3d00bc04, 0x3cc0bcb6, 0xbcacbcc9, 0xbcf8bc38
.long 0x3bd53d01, 0x3c973cd9, 0x3d00bc04, 0x3cd1bca2, 0xbd033ba0, 0xbced3c69, 0xbbd53d01, 0x3b563d03
.long 0xbb56bd03, 0xbc1ebcfc, 0xbcd1bca2, 0xbcedbc69, 0x3d04bad6, 0x3d03bba0, 0x3cedbc69, 0x3ce0bc8c
.long 0x00000000, 0x00000000, 0x00000000, 0x00000000, 0x00000000, 0x00000000, 0x00000000, 0x00000000
.long 0x00000000, 0x00000000, 0x00000000, 0x00000000, 0x00000000, 0x00000000, 0x00000000, 0x00000000
.long 0x00000000, 0x00000000, 0x00000000, 0x00000000, 0x00000000, 0x00000000, 0x00000000, 0x00000000
.long 0x00000000, 0x00000000, 0x00000000, 0x00000000, 0x00000000, 0x00000000, 0x00000000, 0x00000000
.long 0x3cedbc69, 0x3c1ebcfc, 0xbce03c8c, 0xbbd53d01, 0x3bd53d01, 0x3cd13ca2, 0x3b56bd03, 0xbc97bcd9
.long 0xbd04bad6, 0xbce03c8c, 0x3cc03cb6, 0x3d033ba0, 0x3c1ebcfc, 0xbbd5bd01, 0xbd033ba0, 0xbcd13ca2
.long 0x3ce03c8c, 0x3d033ba0, 0x3c80bce7, 0x3b56bd03, 0xbcc03cb6, 0xbc803ce7, 0x3c503cf3, 0x3cac3cc9
.long 0xbc80bce7, 0xbcacbcc9, 0xbd00bc04, 0xbd04bad6, 0x3d00bc04, 0x3cf8bc38, 0x3cd1bca2, 0x3cc0bcb6
.long 0x00000000, 0x00000000, 0x00000000, 0x00000000, 0x00000000, 0x00000000, 0x00000000, 0x00000000
.long 0x00000000, 0x00000000, 0x00000000, 0x00000000, 0x00000000, 0x00000000, 0x00000000, 0x00000000
.long 0x00000000, 0x00000000, 0x00000000, 0x00000000, 0x00000000, 0x00000000, 0x00000000, 0x00000000
.long 0x00000000, 0x00000000, 0x00000000, 0x00000000, 0x00000000, 0x00000000, 0x00000000, 0x00000000
.long 0x3c973cd9, 0x3d033ba0, 0xbcacbcc9, 0xbd04bad6, 0xbd00bc04, 0xbced3c69, 0x3ce03c8c, 0x3d03bba0
.long 0x3cedbc69, 0x3c80bce7, 0xbd00bc04, 0xbcf83c38, 0xbc503cf3, 0x3b563d03, 0x3d04bad6, 0x3ce0bc8c
.long 0xbc1ebcfc, 0xbcacbcc9, 0xbcf83c38, 0xbcc03cb6, 0x3ce03c8c, 0x3d003c04, 0x3cd1bca2, 0x3c97bcd9
.long 0xbd033ba0, 0xbcf83c38, 0xbc973cd9, 0xbc503cf3, 0x3cacbcc9, 0x3c97bcd9, 0x3c1ebcfc, 0x3bd5bd01
.long 0x00000000, 0x00000000, 0x00000000, 0x00000000, 0x00000000, 0x00000000, 0x00000000, 0x00000000
.long 0x00000000, 0x00000000, 0x00000000, 0x00000000, 0x00000000, 0x00000000, 0x00000000, 0x00000000
.long 0x00000000, 0x00000000, 0x00000000, 0x00000000, 0x00000000, 0x00000000, 0x00000000, 0x00000000
.long 0x00000000, 0x00000000, 0x00000000, 0x00000000, 0x00000000, 0x00000000, 0x00000000, 0x00000000
.long 0x3cd1bca2, 0x3b56bd03, 0xbcc03cb6, 0x00003c84, 0xbc503cf3, 0x3c1e3cfc, 0x3cacbcc9, 0x0000bc84
.long 0xbb56bd03, 0xbcacbcc9, 0xbc973cd9, 0x00003c84, 0x3c973cd9, 0x3ced3c69, 0x3c80bce7, 0x0000bc84
.long 0xbcedbc69, 0xbd04bad6, 0xbc503cf3, 0x00003c84, 0x3d04bad6, 0x3cf8bc38, 0x3c1ebcfc, 0x0000bc84
.long 0xbce03c8c, 0xbcc03cb6, 0xbbd53d01, 0x00003c84, 0x3c80bce7, 0x3c50bcf3, 0x3b56bd03, 0x0000bc84
.long 0x00000000, 0x00000000, 0x00000000, 0x00000000, 0x00000000, 0x00000000, 0x00000000, 0x00000000
.long 0x00000000, 0x00000000, 0x00000000, 0x00000000, 0x00000000, 0x00000000, 0x00000000, 0x00000000
.long 0x00000000, 0x00000000, 0x00000000, 0x00000000, 0x00000000, 0x00000000, 0x00000000, 0x00000000
.long 0x00000000, 0x00000000, 0x00000000, 0x00000000, 0x00000000, 0x00000000, 0x00000000, 0x00000000
fft_tables_end:
.size fft_tables, fft_tables_end-fft_tables
.section .rodata,"a"
.p2align 6
.amdhsa_kernel k1_kernel
  .amdhsa_next_free_vgpr 240
  .amdhsa_next_free_sgpr 72
  .amdhsa_accum_offset 240
  .amdhsa_group_segment_fixed_size 0
  .amdhsa_kernarg_size 40
  .amdhsa_user_sgpr_count 2
  .amdhsa_user_sgpr_kernarg_segment_ptr 1
  .amdhsa_system_sgpr_workgroup_id_x 1
.end_amdhsa_kernel
.p2align 6
.amdhsa_kernel k2_kernel
  .amdhsa_next_free_vgpr 512
  .amdhsa_next_free_sgpr 72
  .amdhsa_accum_offset 256
  .amdhsa_group_segment_fixed_size 0
  .amdhsa_kernarg_size 40
  .amdhsa_user_sgpr_count 2
  .amdhsa_user_sgpr_kernarg_segment_ptr 1
  .amdhsa_system_sgpr_workgroup_id_x 1
.end_amdhsa_kernel
.p2align 6
.amdhsa_kernel k3_kernel
  .amdhsa_next_free_vgpr 252
  .amdhsa_next_free_sgpr 72
  .amdhsa_accum_offset 252
  .amdhsa_group_segment_fixed_size 0
  .amdhsa_kernarg_size 40
  .amdhsa_user_sgpr_count 2
  .amdhsa_user_sgpr_kernarg_segment_ptr 1
  .amdhsa_system_sgpr_workgroup_id_x 1
.end_amdhsa_kernel
```

```asm
; @launch kernel=k1_kernel grid=(256,1,1) block=(384,1,1) lds=64000
; @launch kernel=k2_kernel grid=(256,1,1) block=(256,1,1) lds=114688
; @launch kernel=k3_kernel grid=(224,1,1) block=(256,1,1) lds=49152
.amdgcn_target "amdgcn-amd-amdhsa--gfx950"
.text
.globl k1_kernel
.p2align 8
.type k1_kernel,@function
k1_kernel:
    s_load_dwordx4 s[4:7], s[0:1], 0
    s_load_dwordx2 s[8:9], s[0:1], 32
    s_getpc_b64 s[10:11]
K1_pc:
    v_lshrrev_b32 v5, 6, v0
    v_and_b32 v0, 63, v0
    v_readfirstlane_b32 s28, v5
    v_lshlrev_b32 v6, 4, v0
    s_nop 2
    s_lshr_b32 s26, s28, 2
    s_and_b32 s30, s2, 7
    s_lshl_b32 s30, s30, 5
    s_lshr_b32 s31, s2, 3
    s_add_u32 s30, s30, s31
    s_cmp_eq_u32 s26, 1
    s_cselect_b32 s31, s30, s2
    s_mul_i32 s27, s26, 22
    s_add_u32 s27, s27, 230
    s_cmp_ge_u32 s31, s27
    s_cbranch_scc1 K1_end
    s_cmp_ge_u32 s2, 256
    s_cbranch_scc1 K1_end
    s_and_b32 s45, s28, 3
    s_lshr_b32 s31, s30, 2
    s_mul_i32 s32, s31, 57
    s_lshr_b32 s32, s32, 9
    s_mul_i32 s33, s32, 9
    s_sub_u32 s33, s31, s33
    s_mul_i32 s34, s33, 43
    s_lshr_b32 s34, s34, 7
    s_mul_i32 s35, s34, 3
    s_sub_u32 s35, s33, s35
    s_mul_i32 s36, s32, 129024
    s_mul_i32 s37, s34, 6144
    s_add_u32 s36, s36, s37
    s_lshl_b32 s35, s35, 1
    s_add_u32 s35, s35, s45
    s_lshl_b32 s37, s35, 5
    s_add_u32 s36, s36, s37
    s_mul_i32 s50, s45, 7424
    s_add_u32 s50, s50, 49152
    v_lshrrev_b32 v8, 1, v0
    v_mul_u32_u24 v8, 192, v8
    v_and_b32 v9, 1, v0
    v_lshl_add_u32 v10, v9, 4, v8
    s_add_u32 s38, s2, 218
    s_sub_u32 s39, s2, 6
    s_min_u32 s38, s38, s39
    s_mul_i32 s38, s38, 43008
    s_mul_i32 s39, s45, 10752
    s_add_u32 s38, s38, s39
    s_cmp_eq_u32 s28, 0
    s_cselect_b32 s39, 43008, 0
    v_mov_b32 v9, s39
    v_cmp_gt_u32 vcc, 8, v0
    s_nop 1
    v_cndmask_b32 v9, 0, v9, vcc
    s_mul_i32 s29, s45, 12288
    s_cmp_eq_u32 s26, 1
    s_cselect_b32 s40, s36, s38
    s_cselect_b32 m0, s50, s29
    s_cselect_b64 vcc, -1, 0
    s_mul_i32 s41, s26, 17408
    s_add_u32 s41, s41, 1024
    s_mul_i32 s42, s26, 32
    s_add_u32 s42, s42, 1024
    s_mul_i32 s49, s26, 8731776
    s_sub_u32 s14, 9634944, s49
    v_cndmask_b32 v11, v6, v10, vcc
    v_add_u32 v12, v9, v11
    s_add_u32 s48, s40, s39
    s_add_u32 s40, s40, s41
    s_mov_b32 s15, 0x00020000
    s_waitcnt lgkmcnt(0)
    s_sub_u32 s4, s4, 1152
    s_subb_u32 s5, s5, 0
    s_cmp_eq_u32 s26, 1
    s_cselect_b32 s12, s6, s4
    s_cselect_b32 s13, s7, s5
    s_and_b32 s13, s13, 0xffff
    buffer_load_dwordx4 v11, s[12:15], s48 offen lds
    s_add_u32 m0, m0, s42
    s_nop 0
    buffer_load_dwordx4 v12, s[12:15], s40 offen lds
    s_add_u32 m0, m0, s42
    s_add_u32 s40, s40, s41
    buffer_load_dwordx4 v11, s[12:15], s40 offen lds
    s_add_u32 m0, m0, s42
    s_add_u32 s40, s40, s41
    buffer_load_dwordx4 v11, s[12:15], s40 offen lds
    s_add_u32 m0, m0, s42
    s_add_u32 s40, s40, s41
    buffer_load_dwordx4 v11, s[12:15], s40 offen lds
    s_add_u32 m0, m0, s42
    s_add_u32 s40, s40, s41
    buffer_load_dwordx4 v11, s[12:15], s40 offen lds
    s_add_u32 m0, m0, s42
    s_add_u32 s40, s40, s41
    s_cmp_eq_u32 s26, 1
    buffer_load_dwordx4 v11, s[12:15], s40 offen lds
    s_cbranch_scc1 K1_w
    s_add_u32 m0, m0, s42
    s_add_u32 s40, s40, s41
    buffer_load_dwordx4 v11, s[12:15], s40 offen lds
    s_add_u32 m0, m0, s42
    s_add_u32 s40, s40, s41
    buffer_load_dwordx4 v11, s[12:15], s40 offen lds
    s_add_u32 m0, m0, s42
    s_add_u32 s40, s40, s41
    buffer_load_dwordx4 v11, s[12:15], s40 offen lds
    s_add_u32 m0, m0, s42
    s_add_u32 s40, s40, s41
    buffer_load_dwordx4 v11, s[12:15], s40 offen lds
    s_add_u32 m0, m0, s42
    s_add_u32 s40, s40, s41
    buffer_load_dwordx4 v11, s[12:15], s40 offen lds
    v_bfe_u32 v80, v0, 1, 3
    v_lshrrev_b32 v81, 5, v0
    v_lshlrev_b32 v81, 4, v81
    v_bfe_u32 v82, v0, 4, 1
    v_lshl_add_u32 v81, v82, 2, v81
    v_cvt_f32_u32 v81, v81
    v_and_b32 v82, 1, v0
    v_cvt_f32_u32 v82, v82
    v_mul_f32 v82, 0x3e800000, v82
    v_add_u32 v83, 0, v80
    v_cvt_f32_u32 v83, v83
    v_mul_f32 v40, 0x3c842108, v83
    v_fma_f32 v44, v40, v81, v82
    v_add_u32 v83, 8, v80
    v_cvt_f32_u32 v83, v83
    v_mul_f32 v41, 0x3c842108, v83
    v_fma_f32 v45, v41, v81, v82
    v_add_u32 v83, 16, v80
    v_cvt_f32_u32 v83, v83
    v_mul_f32 v42, 0x3c842108, v83
    v_fma_f32 v46, v42, v81, v82
    v_add_u32 v83, 24, v80
    v_cvt_f32_u32 v83, v83
    v_mul_f32 v43, 0x3c842108, v83
    v_fma_f32 v47, v43, v81, v82
    v_cos_f32 v32, v44
    v_fmamk_f32 v33, v40, 0x3f800000, v44
    v_fmamk_f32 v34, v40, 0x40000000, v44
    v_fmamk_f32 v35, v40, 0x40400000, v44
    v_fmamk_f32 v36, v40, 0x41000000, v44
    v_fmamk_f32 v37, v40, 0x41100000, v44
    v_fmamk_f32 v38, v40, 0x41200000, v44
    v_fmamk_f32 v39, v40, 0x41300000, v44
    v_cos_f32 v33, v33
    v_cos_f32 v34, v34
    v_cos_f32 v35, v35
    v_cos_f32 v36, v36
    v_cos_f32 v37, v37
    v_cos_f32 v38, v38
    v_cos_f32 v39, v39
    v_cvt_pk_bf16_f32 v48, v32, v33
    v_cvt_pk_bf16_f32 v49, v34, v35
    v_cvt_pk_bf16_f32 v50, v36, v37
    v_cvt_pk_bf16_f32 v51, v38, v39
    v_fmamk_f32 v32, v40, 0x42000000, v44
    v_fmamk_f32 v33, v40, 0x42040000, v44
    v_fmamk_f32 v34, v40, 0x42080000, v44
    v_fmamk_f32 v35, v40, 0x420c0000, v44
    v_fmamk_f32 v36, v40, 0x42200000, v44
    v_fmamk_f32 v37, v40, 0x42240000, v44
    v_fmamk_f32 v38, v40, 0x42280000, v44
    v_fmamk_f32 v39, v40, 0x422c0000, v44
    v_cos_f32 v32, v32
    v_cos_f32 v33, v33
    v_cos_f32 v34, v34
    v_cos_f32 v35, v35
    v_cos_f32 v36, v36
    v_cos_f32 v37, v37
    v_cos_f32 v38, v38
    v_cos_f32 v39, v39
    v_cvt_pk_bf16_f32 v52, v32, v33
    v_cvt_pk_bf16_f32 v53, v34, v35
    v_cvt_pk_bf16_f32 v54, v36, v37
    v_cvt_pk_bf16_f32 v55, v38, v39
    v_cos_f32 v32, v45
    v_fmamk_f32 v33, v41, 0x3f800000, v45
    v_fmamk_f32 v34, v41, 0x40000000, v45
    v_fmamk_f32 v35, v41, 0x40400000, v45
    v_fmamk_f32 v36, v41, 0x41000000, v45
    v_fmamk_f32 v37, v41, 0x41100000, v45
    v_fmamk_f32 v38, v41, 0x41200000, v45
    v_fmamk_f32 v39, v41, 0x41300000, v45
    v_cos_f32 v33, v33
    v_cos_f32 v34, v34
    v_cos_f32 v35, v35
    v_cos_f32 v36, v36
    v_cos_f32 v37, v37
    v_cos_f32 v38, v38
    v_cos_f32 v39, v39
    v_cvt_pk_bf16_f32 v56, v32, v33
    v_cvt_pk_bf16_f32 v57, v34, v35
    v_cvt_pk_bf16_f32 v58, v36, v37
    v_cvt_pk_bf16_f32 v59, v38, v39
    v_fmamk_f32 v32, v41, 0x42000000, v45
    v_fmamk_f32 v33, v41, 0x42040000, v45
    v_fmamk_f32 v34, v41, 0x42080000, v45
    v_fmamk_f32 v35, v41, 0x420c0000, v45
    v_fmamk_f32 v36, v41, 0x42200000, v45
    v_fmamk_f32 v37, v41, 0x42240000, v45
    v_fmamk_f32 v38, v41, 0x42280000, v45
    v_fmamk_f32 v39, v41, 0x422c0000, v45
    v_cos_f32 v32, v32
    v_cos_f32 v33, v33
    v_cos_f32 v34, v34
    v_cos_f32 v35, v35
    v_cos_f32 v36, v36
    v_cos_f32 v37, v37
    v_cos_f32 v38, v38
    v_cos_f32 v39, v39
    v_cvt_pk_bf16_f32 v60, v32, v33
    v_cvt_pk_bf16_f32 v61, v34, v35
    v_cvt_pk_bf16_f32 v62, v36, v37
    v_cvt_pk_bf16_f32 v63, v38, v39
    v_cos_f32 v32, v46
    v_fmamk_f32 v33, v42, 0x3f800000, v46
    v_fmamk_f32 v34, v42, 0x40000000, v46
    v_fmamk_f32 v35, v42, 0x40400000, v46
    v_fmamk_f32 v36, v42, 0x41000000, v46
    v_fmamk_f32 v37, v42, 0x41100000, v46
    v_fmamk_f32 v38, v42, 0x41200000, v46
    v_fmamk_f32 v39, v42, 0x41300000, v46
    v_cos_f32 v33, v33
    v_cos_f32 v34, v34
    v_cos_f32 v35, v35
    v_cos_f32 v36, v36
    v_cos_f32 v37, v37
    v_cos_f32 v38, v38
    v_cos_f32 v39, v39
    v_cvt_pk_bf16_f32 v64, v32, v33
    v_cvt_pk_bf16_f32 v65, v34, v35
    v_cvt_pk_bf16_f32 v66, v36, v37
    v_cvt_pk_bf16_f32 v67, v38, v39
    v_fmamk_f32 v32, v42, 0x42000000, v46
    v_fmamk_f32 v33, v42, 0x42040000, v46
    v_fmamk_f32 v34, v42, 0x42080000, v46
    v_fmamk_f32 v35, v42, 0x420c0000, v46
    v_fmamk_f32 v36, v42, 0x42200000, v46
    v_fmamk_f32 v37, v42, 0x42240000, v46
    v_fmamk_f32 v38, v42, 0x42280000, v46
    v_fmamk_f32 v39, v42, 0x422c0000, v46
    v_cos_f32 v32, v32
    v_cos_f32 v33, v33
    v_cos_f32 v34, v34
    v_cos_f32 v35, v35
    v_cos_f32 v36, v36
    v_cos_f32 v37, v37
    v_cos_f32 v38, v38
    v_cos_f32 v39, v39
    v_cvt_pk_bf16_f32 v68, v32, v33
    v_cvt_pk_bf16_f32 v69, v34, v35
    v_cvt_pk_bf16_f32 v70, v36, v37
    v_cvt_pk_bf16_f32 v71, v38, v39
    v_cos_f32 v32, v47
    v_fmamk_f32 v33, v43, 0x3f800000, v47
    v_fmamk_f32 v34, v43, 0x40000000, v47
    v_fmamk_f32 v35, v43, 0x40400000, v47
    v_fmamk_f32 v36, v43, 0x41000000, v47
    v_fmamk_f32 v37, v43, 0x41100000, v47
    v_fmamk_f32 v38, v43, 0x41200000, v47
    v_fmamk_f32 v39, v43, 0x41300000, v47
    v_cos_f32 v33, v33
    v_cos_f32 v34, v34
    v_cos_f32 v35, v35
    v_cos_f32 v36, v36
    v_cos_f32 v37, v37
    v_cos_f32 v38, v38
    v_cos_f32 v39, v39
    v_cvt_pk_bf16_f32 v72, v32, v33
    v_cvt_pk_bf16_f32 v73, v34, v35
    v_cvt_pk_bf16_f32 v74, v36, v37
    v_cvt_pk_bf16_f32 v75, v38, v39
    v_fmamk_f32 v32, v43, 0x42000000, v47
    v_fmamk_f32 v33, v43, 0x42040000, v47
    v_fmamk_f32 v34, v43, 0x42080000, v47
    v_fmamk_f32 v35, v43, 0x420c0000, v47
    v_fmamk_f32 v36, v43, 0x42200000, v47
    v_fmamk_f32 v37, v43, 0x42240000, v47
    v_fmamk_f32 v38, v43, 0x42280000, v47
    v_fmamk_f32 v39, v43, 0x422c0000, v47
    v_cos_f32 v32, v32
    v_cos_f32 v33, v33
    v_cos_f32 v34, v34
    v_cos_f32 v35, v35
    v_cos_f32 v36, v36
    v_cos_f32 v37, v37
    v_cos_f32 v38, v38
    v_cos_f32 v39, v39
    v_cvt_pk_bf16_f32 v76, v32, v33
    v_cvt_pk_bf16_f32 v77, v34, v35
    v_cvt_pk_bf16_f32 v78, v36, v37
    v_cvt_pk_bf16_f32 v79, v38, v39
    v_cmp_gt_u32 vcc, 48, v0
    s_nop 1
    v_cndmask_b32 v55, 0, v55, vcc
    v_cndmask_b32 v63, 0, v63, vcc
    v_cndmask_b32 v71, 0, v71, vcc
    v_cndmask_b32 v79, 0, v79, vcc
    s_mov_b32 s16, s8
    s_and_b32 s17, s9, 0xffff
    s_mov_b32 s18, 11304960
    s_mov_b32 s19, 0x00020000
    v_and_b32 v1, 15, v0
    v_lshrrev_b32 v2, 4, v0
    v_bfe_u32 v3, v0, 2, 2
    v_and_b32 v4, 3, v0
    v_lshrrev_b32 v23, 1, v2
    v_lshlrev_b32 v23, 4, v23
    v_add_u32 v23, v23, v3
    v_and_b32 v24, 1, v2
    v_lshl_add_u32 v23, v24, 2, v23
    v_mul_u32_u24 v23, 192, v23
    v_lshl_add_u32 v23, v4, 3, v23
    v_add_u32 v20, s29, v23
    v_lshlrev_b32 v23, 6, v1
    v_lshl_add_u32 v25, v2, 4, v23
    s_lshl_b32 s53, s2, 2
    s_add_u32 s53, s53, s28
    s_mul_i32 s53, s53, 12288
    s_waitcnt vmcnt(6)
    ds_read_b64_tr_b16 v[80:81], v20 offset:0
    ds_read_b64_tr_b16 v[82:83], v20 offset:1536
    ds_read_b64_tr_b16 v[84:85], v20 offset:32
    ds_read_b64_tr_b16 v[86:87], v20 offset:1568
    ds_read_b64_tr_b16 v[88:89], v20 offset:64
    ds_read_b64_tr_b16 v[90:91], v20 offset:1600
    ds_read_b64_tr_b16 v[92:93], v20 offset:96
    ds_read_b64_tr_b16 v[94:95], v20 offset:1632
    ds_read_b64_tr_b16 v[96:97], v20 offset:128
    ds_read_b64_tr_b16 v[98:99], v20 offset:1664
    ds_read_b64_tr_b16 v[100:101], v20 offset:160
    ds_read_b64_tr_b16 v[102:103], v20 offset:1696
    s_waitcnt lgkmcnt(10)
    v_mfma_f32_16x16x32_bf16 v[128:131], v[80:83], v[48:51], 0
    v_mfma_f32_16x16x32_bf16 v[132:135], v[80:83], v[56:59], 0
    v_mfma_f32_16x16x32_bf16 v[136:139], v[80:83], v[64:67], 0
    v_mfma_f32_16x16x32_bf16 v[140:143], v[80:83], v[72:75], 0
    s_waitcnt lgkmcnt(8)
    v_mfma_f32_16x16x32_bf16 v[144:147], v[84:87], v[48:51], 0
    v_mfma_f32_16x16x32_bf16 v[148:151], v[84:87], v[56:59], 0
    v_mfma_f32_16x16x32_bf16 v[152:155], v[84:87], v[64:67], 0
    v_mfma_f32_16x16x32_bf16 v[156:159], v[84:87], v[72:75], 0
    s_waitcnt lgkmcnt(6)
    v_mfma_f32_16x16x32_bf16 v[160:163], v[88:91], v[48:51], 0
    v_mfma_f32_16x16x32_bf16 v[164:167], v[88:91], v[56:59], 0
    v_mfma_f32_16x16x32_bf16 v[168:171], v[88:91], v[64:67], 0
    v_mfma_f32_16x16x32_bf16 v[172:175], v[88:91], v[72:75], 0
    s_waitcnt lgkmcnt(4)
    v_mfma_f32_16x16x32_bf16 v[176:179], v[92:95], v[48:51], 0
    v_mfma_f32_16x16x32_bf16 v[180:183], v[92:95], v[56:59], 0
    v_mfma_f32_16x16x32_bf16 v[184:187], v[92:95], v[64:67], 0
    v_mfma_f32_16x16x32_bf16 v[188:191], v[92:95], v[72:75], 0
    s_waitcnt lgkmcnt(2)
    v_mfma_f32_16x16x32_bf16 v[192:195], v[96:99], v[48:51], 0
    v_mfma_f32_16x16x32_bf16 v[196:199], v[96:99], v[56:59], 0
    v_mfma_f32_16x16x32_bf16 v[200:203], v[96:99], v[64:67], 0
    v_mfma_f32_16x16x32_bf16 v[204:207], v[96:99], v[72:75], 0
    s_waitcnt lgkmcnt(0)
    v_mfma_f32_16x16x32_bf16 v[208:211], v[100:103], v[48:51], 0
    v_mfma_f32_16x16x32_bf16 v[212:215], v[100:103], v[56:59], 0
    v_mfma_f32_16x16x32_bf16 v[216:219], v[100:103], v[64:67], 0
    v_mfma_f32_16x16x32_bf16 v[220:223], v[100:103], v[72:75], 0
    s_waitcnt vmcnt(0)
    ds_read_b64_tr_b16 v[104:105], v20 offset:6144
    ds_read_b64_tr_b16 v[106:107], v20 offset:7680
    ds_read_b64_tr_b16 v[108:109], v20 offset:6176
    ds_read_b64_tr_b16 v[110:111], v20 offset:7712
    ds_read_b64_tr_b16 v[112:113], v20 offset:6208
    ds_read_b64_tr_b16 v[114:115], v20 offset:7744
    ds_read_b64_tr_b16 v[116:117], v20 offset:6240
    ds_read_b64_tr_b16 v[118:119], v20 offset:7776
    ds_read_b64_tr_b16 v[120:121], v20 offset:6272
    ds_read_b64_tr_b16 v[122:123], v20 offset:7808
    ds_read_b64_tr_b16 v[124:125], v20 offset:6304
    ds_read_b64_tr_b16 v[126:127], v20 offset:7840
    s_waitcnt lgkmcnt(10)
    v_mfma_f32_16x16x32_bf16 v[128:131], v[104:107], v[52:55], v[128:131]
    s_waitcnt lgkmcnt(8)
    v_mfma_f32_16x16x32_bf16 v[144:147], v[108:111], v[52:55], v[144:147]
    v_mfma_f32_16x16x32_bf16 v[132:135], v[104:107], v[60:63], v[132:135]
    v_mfma_f32_16x16x32_bf16 v[148:151], v[108:111], v[60:63], v[148:151]
    v_mfma_f32_16x16x32_bf16 v[136:139], v[104:107], v[68:71], v[136:139]
    v_mfma_f32_16x16x32_bf16 v[152:155], v[108:111], v[68:71], v[152:155]
    v_mfma_f32_16x16x32_bf16 v[140:143], v[104:107], v[76:79], v[140:143]
    v_mfma_f32_16x16x32_bf16 v[156:159], v[108:111], v[76:79], v[156:159]
    v_cvt_pk_bf16_f32 v224, v128, v129
    v_cvt_pk_bf16_f32 v225, v130, v131
    v_cvt_pk_bf16_f32 v226, v144, v145
    v_cvt_pk_bf16_f32 v227, v146, v147
    s_add_u32 s54, s53, 0
    buffer_store_dwordx4 v[224:227], v25, s[16:19], s54 offen sc1
    s_waitcnt lgkmcnt(6)
    v_mfma_f32_16x16x32_bf16 v[160:163], v[112:115], v[52:55], v[160:163]
    s_waitcnt lgkmcnt(4)
    v_mfma_f32_16x16x32_bf16 v[176:179], v[116:119], v[52:55], v[176:179]
    v_cvt_pk_bf16_f32 v228, v132, v133
    v_cvt_pk_bf16_f32 v229, v134, v135
    v_cvt_pk_bf16_f32 v230, v148, v149
    v_cvt_pk_bf16_f32 v231, v150, v151
    s_add_u32 s54, s53, 1024
    buffer_store_dwordx4 v[228:231], v25, s[16:19], s54 offen sc1
    v_mfma_f32_16x16x32_bf16 v[164:167], v[112:115], v[60:63], v[164:167]
    v_mfma_f32_16x16x32_bf16 v[180:183], v[116:119], v[60:63], v[180:183]
    v_cvt_pk_bf16_f32 v232, v136, v137
    v_cvt_pk_bf16_f32 v233, v138, v139
    v_cvt_pk_bf16_f32 v234, v152, v153
    v_cvt_pk_bf16_f32 v235, v154, v155
    s_add_u32 s54, s53, 2048
    buffer_store_dwordx4 v[232:235], v25, s[16:19], s54 offen sc1
    v_mfma_f32_16x16x32_bf16 v[168:171], v[112:115], v[68:71], v[168:171]
    v_mfma_f32_16x16x32_bf16 v[184:187], v[116:119], v[68:71], v[184:187]
    v_cvt_pk_bf16_f32 v236, v140, v141
    v_cvt_pk_bf16_f32 v237, v142, v143
    v_cvt_pk_bf16_f32 v238, v156, v157
    v_cvt_pk_bf16_f32 v239, v158, v159
    s_add_u32 s54, s53, 3072
    buffer_store_dwordx4 v[236:239], v25, s[16:19], s54 offen sc1
    v_mfma_f32_16x16x32_bf16 v[172:175], v[112:115], v[76:79], v[172:175]
    v_mfma_f32_16x16x32_bf16 v[188:191], v[116:119], v[76:79], v[188:191]
    v_cvt_pk_bf16_f32 v224, v160, v161
    v_cvt_pk_bf16_f32 v225, v162, v163
    v_cvt_pk_bf16_f32 v226, v176, v177
    v_cvt_pk_bf16_f32 v227, v178, v179
    s_add_u32 s54, s53, 4096
    buffer_store_dwordx4 v[224:227], v25, s[16:19], s54 offen sc1
    s_waitcnt lgkmcnt(2)
    v_mfma_f32_16x16x32_bf16 v[192:195], v[120:123], v[52:55], v[192:195]
    s_waitcnt lgkmcnt(0)
    v_mfma_f32_16x16x32_bf16 v[208:211], v[124:127], v[52:55], v[208:211]
    v_cvt_pk_bf16_f32 v228, v164, v165
    v_cvt_pk_bf16_f32 v229, v166, v167
    v_cvt_pk_bf16_f32 v230, v180, v181
    v_cvt_pk_bf16_f32 v231, v182, v183
    s_add_u32 s54, s53, 5120
    buffer_store_dwordx4 v[228:231], v25, s[16:19], s54 offen sc1
    v_mfma_f32_16x16x32_bf16 v[196:199], v[120:123], v[60:63], v[196:199]
    v_mfma_f32_16x16x32_bf16 v[212:215], v[124:127], v[60:63], v[212:215]
    v_cvt_pk_bf16_f32 v232, v168, v169
    v_cvt_pk_bf16_f32 v233, v170, v171
    v_cvt_pk_bf16_f32 v234, v184, v185
    v_cvt_pk_bf16_f32 v235, v186, v187
    s_add_u32 s54, s53, 6144
    buffer_store_dwordx4 v[232:235], v25, s[16:19], s54 offen sc1
    v_mfma_f32_16x16x32_bf16 v[200:203], v[120:123], v[68:71], v[200:203]
    v_mfma_f32_16x16x32_bf16 v[216:219], v[124:127], v[68:71], v[216:219]
    v_cvt_pk_bf16_f32 v236, v172, v173
    v_cvt_pk_bf16_f32 v237, v174, v175
    v_cvt_pk_bf16_f32 v238, v188, v189
    v_cvt_pk_bf16_f32 v239, v190, v191
    s_add_u32 s54, s53, 7168
    buffer_store_dwordx4 v[236:239], v25, s[16:19], s54 offen sc1
    v_mfma_f32_16x16x32_bf16 v[204:207], v[120:123], v[76:79], v[204:207]
    v_mfma_f32_16x16x32_bf16 v[220:223], v[124:127], v[76:79], v[220:223]
    v_cvt_pk_bf16_f32 v224, v192, v193
    v_cvt_pk_bf16_f32 v225, v194, v195
    v_cvt_pk_bf16_f32 v226, v208, v209
    v_cvt_pk_bf16_f32 v227, v210, v211
    s_add_u32 s54, s53, 8192
    buffer_store_dwordx4 v[224:227], v25, s[16:19], s54 offen sc1
    v_cvt_pk_bf16_f32 v228, v196, v197
    v_cvt_pk_bf16_f32 v229, v198, v199
    v_cvt_pk_bf16_f32 v230, v212, v213
    v_cvt_pk_bf16_f32 v231, v214, v215
    s_add_u32 s54, s53, 9216
    buffer_store_dwordx4 v[228:231], v25, s[16:19], s54 offen sc1
    v_cvt_pk_bf16_f32 v232, v200, v201
    v_cvt_pk_bf16_f32 v233, v202, v203
    v_cvt_pk_bf16_f32 v234, v216, v217
    v_cvt_pk_bf16_f32 v235, v218, v219
    s_add_u32 s54, s53, 10240
    buffer_store_dwordx4 v[232:235], v25, s[16:19], s54 offen sc1
    v_cvt_pk_bf16_f32 v236, v204, v205
    v_cvt_pk_bf16_f32 v237, v206, v207
    v_cvt_pk_bf16_f32 v238, v220, v221
    v_cvt_pk_bf16_f32 v239, v222, v223
    s_add_u32 s54, s53, 11264
    buffer_store_dwordx4 v[236:239], v25, s[16:19], s54 offen sc1
    s_endpgm
K1_w:
    s_mov_b32 s51, s50
    s_and_b32 s43, s30, 3
    s_lshl_b32 s43, s43, 2
    v_bfe_u32 v40, v0, 1, 1
    v_and_b32 v41, 1, v0
    v_cvt_f32_u32 v41, v41
    v_mul_f32 v41, 0x3e800000, v41
    v_bfe_u32 v42, v0, 2, 2
    v_lshrrev_b32 v43, 4, v0
    v_cmp_eq_u32 s[46:47], v42, v43
    s_lshl_b32 s44, s43, 1
    v_add_u32 v40, s44, v40
    v_cvt_f32_u32 v40, v40
    v_mul_f32 v42, 0x3c842108, v40
    v_cos_f32 v32, v41
    v_fmamk_f32 v33, v42, 0x3f800000, v41
    v_fmamk_f32 v34, v42, 0x40000000, v41
    v_fmamk_f32 v35, v42, 0x40400000, v41
    v_fmamk_f32 v36, v42, 0x40800000, v41
    v_fmamk_f32 v37, v42, 0x40a00000, v41
    v_fmamk_f32 v38, v42, 0x40c00000, v41
    v_cos_f32 v33, v33
    v_cos_f32 v34, v34
    v_cos_f32 v35, v35
    v_cos_f32 v36, v36
    v_cos_f32 v37, v37
    v_cos_f32 v38, v38
    v_mov_b32 v39, 0
    v_cvt_pk_bf16_f32 v48, v32, v33
    v_cvt_pk_bf16_f32 v49, v34, v35
    v_cvt_pk_bf16_f32 v50, v36, v37
    v_cvt_pk_bf16_f32 v51, v38, v39
    v_cndmask_b32 v48, 0, v48, s[46:47]
    v_cndmask_b32 v49, 0, v49, s[46:47]
    v_cndmask_b32 v50, 0, v50, s[46:47]
    v_cndmask_b32 v51, 0, v51, s[46:47]
    v_add_f32 v42, 0x3d042108, v42
    v_cos_f32 v32, v41
    v_fmamk_f32 v33, v42, 0x3f800000, v41
    v_fmamk_f32 v34, v42, 0x40000000, v41
    v_fmamk_f32 v35, v42, 0x40400000, v41
    v_fmamk_f32 v36, v42, 0x40800000, v41
    v_fmamk_f32 v37, v42, 0x40a00000, v41
    v_fmamk_f32 v38, v42, 0x40c00000, v41
    v_cos_f32 v33, v33
    v_cos_f32 v34, v34
    v_cos_f32 v35, v35
    v_cos_f32 v36, v36
    v_cos_f32 v37, v37
    v_cos_f32 v38, v38
    v_mov_b32 v39, 0
    v_cvt_pk_bf16_f32 v52, v32, v33
    v_cvt_pk_bf16_f32 v53, v34, v35
    v_cvt_pk_bf16_f32 v54, v36, v37
    v_cvt_pk_bf16_f32 v55, v38, v39
    v_cndmask_b32 v52, 0, v52, s[46:47]
    v_cndmask_b32 v53, 0, v53, s[46:47]
    v_cndmask_b32 v54, 0, v54, s[46:47]
    v_cndmask_b32 v55, 0, v55, s[46:47]
    v_add_f32 v42, 0x3d042108, v42
    v_cos_f32 v32, v41
    v_fmamk_f32 v33, v42, 0x3f800000, v41
    v_fmamk_f32 v34, v42, 0x40000000, v41
    v_fmamk_f32 v35, v42, 0x40400000, v41
    v_fmamk_f32 v36, v42, 0x40800000, v41
    v_fmamk_f32 v37, v42, 0x40a00000, v41
    v_fmamk_f32 v38, v42, 0x40c00000, v41
    v_cos_f32 v33, v33
    v_cos_f32 v34, v34
    v_cos_f32 v35, v35
    v_cos_f32 v36, v36
    v_cos_f32 v37, v37
    v_cos_f32 v38, v38
    v_mov_b32 v39, 0
    v_cvt_pk_bf16_f32 v56, v32, v33
    v_cvt_pk_bf16_f32 v57, v34, v35
    v_cvt_pk_bf16_f32 v58, v36, v37
    v_cvt_pk_bf16_f32 v59, v38, v39
    v_cndmask_b32 v56, 0, v56, s[46:47]
    v_cndmask_b32 v57, 0, v57, s[46:47]
    v_cndmask_b32 v58, 0, v58, s[46:47]
    v_cndmask_b32 v59, 0, v59, s[46:47]
    v_add_f32 v42, 0x3d042108, v42
    v_cos_f32 v32, v41
    v_fmamk_f32 v33, v42, 0x3f800000, v41
    v_fmamk_f32 v34, v42, 0x40000000, v41
    v_fmamk_f32 v35, v42, 0x40400000, v41
    v_fmamk_f32 v36, v42, 0x40800000, v41
    v_fmamk_f32 v37, v42, 0x40a00000, v41
    v_fmamk_f32 v38, v42, 0x40c00000, v41
    v_cos_f32 v33, v33
    v_cos_f32 v34, v34
    v_cos_f32 v35, v35
    v_cos_f32 v36, v36
    v_cos_f32 v37, v37
    v_cos_f32 v38, v38
    v_mov_b32 v39, 0
    v_cvt_pk_bf16_f32 v60, v32, v33
    v_cvt_pk_bf16_f32 v61, v34, v35
    v_cvt_pk_bf16_f32 v62, v36, v37
    v_cvt_pk_bf16_f32 v63, v38, v39
    v_cndmask_b32 v60, 0, v60, s[46:47]
    v_cndmask_b32 v61, 0, v61, s[46:47]
    v_cndmask_b32 v62, 0, v62, s[46:47]
    v_cndmask_b32 v63, 0, v63, s[46:47]
    s_add_u32 s16, s8, 0xb00000
    s_addc_u32 s17, s9, 0
    s_and_b32 s17, s17, 0xffff
    s_mov_b32 s18, 8257536
    s_mov_b32 s19, 0x00020000
    v_lshrrev_b32 v2, 4, v0
    v_bfe_u32 v3, v0, 2, 2
    v_and_b32 v4, 3, v0
    v_mul_u32_u24 v22, 1056, v3
    v_lshl_add_u32 v23, v2, 7, v22
    v_lshl_add_u32 v23, v4, 3, v23
    v_add_u32 v20, s51, v23
    v_add_u32 v22, 4, v3
    v_min_u32 v22, 6, v22
    v_sub_u32 v22, v22, v3
    v_mul_u32_u24 v22, 1056, v22
    v_add_u32 v21, v20, v22
    s_cmp_ge_u32 s35, 3
    s_cselect_b32 s48, 1, 0
    s_mul_i32 s49, s48, 3
    s_sub_u32 s49, s35, s49
    s_lshl_b32 s50, s43, 2
    s_add_u32 s50, s50, s48
    s_mul_i32 s50, s50, 21
    s_mul_i32 s51, s34, 7
    s_add_u32 s50, s50, s51
    s_add_u32 s50, s50, s32
    s_mul_i32 s50, s50, 6144
    s_lshl_b32 s49, s49, 11
    s_add_u32 s50, s50, s49
    s_waitcnt vmcnt(0)
    ds_read_b64_tr_b16 v[80:81], v20 offset:0
    ds_read_b64_tr_b16 v[82:83], v21 offset:0
    ds_read_b64_tr_b16 v[84:85], v20 offset:32
    ds_read_b64_tr_b16 v[86:87], v21 offset:32
    ds_read_b64_tr_b16 v[88:89], v20 offset:64
    ds_read_b64_tr_b16 v[90:91], v21 offset:64
    ds_read_b64_tr_b16 v[92:93], v20 offset:96
    ds_read_b64_tr_b16 v[94:95], v21 offset:96
    ds_read_b64_tr_b16 v[96:97], v20 offset:512
    ds_read_b64_tr_b16 v[98:99], v21 offset:512
    ds_read_b64_tr_b16 v[100:101], v20 offset:544
    ds_read_b64_tr_b16 v[102:103], v21 offset:544
    ds_read_b64_tr_b16 v[104:105], v20 offset:576
    ds_read_b64_tr_b16 v[106:107], v21 offset:576
    ds_read_b64_tr_b16 v[108:109], v20 offset:608
    ds_read_b64_tr_b16 v[110:111], v21 offset:608
    s_waitcnt lgkmcnt(14)
    v_mfma_f32_16x16x32_bf16 v[112:115], v[48:51], v[80:83], 0
    s_waitcnt lgkmcnt(12)
    v_mfma_f32_16x16x32_bf16 v[116:119], v[48:51], v[84:87], 0
    s_waitcnt lgkmcnt(10)
    v_mfma_f32_16x16x32_bf16 v[120:123], v[48:51], v[88:91], 0
    s_waitcnt lgkmcnt(8)
    v_mfma_f32_16x16x32_bf16 v[124:127], v[48:51], v[92:95], 0
    s_waitcnt lgkmcnt(6)
    v_mfma_f32_16x16x32_bf16 v[128:131], v[48:51], v[96:99], 0
    s_waitcnt lgkmcnt(4)
    v_mfma_f32_16x16x32_bf16 v[132:135], v[48:51], v[100:103], 0
    s_waitcnt lgkmcnt(2)
    v_mfma_f32_16x16x32_bf16 v[136:139], v[48:51], v[104:107], 0
    s_waitcnt lgkmcnt(0)
    v_mfma_f32_16x16x32_bf16 v[140:143], v[48:51], v[108:111], 0
    v_mfma_f32_16x16x32_bf16 v[144:147], v[52:55], v[80:83], 0
    v_mfma_f32_16x16x32_bf16 v[148:151], v[52:55], v[84:87], 0
    v_mfma_f32_16x16x32_bf16 v[152:155], v[52:55], v[88:91], 0
    v_mfma_f32_16x16x32_bf16 v[156:159], v[52:55], v[92:95], 0
    v_mfma_f32_16x16x32_bf16 v[160:163], v[52:55], v[96:99], 0
    v_mfma_f32_16x16x32_bf16 v[164:167], v[52:55], v[100:103], 0
    v_mfma_f32_16x16x32_bf16 v[168:171], v[52:55], v[104:107], 0
    v_mfma_f32_16x16x32_bf16 v[172:175], v[52:55], v[108:111], 0
    v_cvt_pk_bf16_f32 v176, v112, v116
    v_cvt_pk_bf16_f32 v177, v120, v124
    v_cvt_pk_bf16_f32 v178, v128, v132
    v_cvt_pk_bf16_f32 v179, v136, v140
    buffer_store_dwordx4 v[176:179], v6, s[16:19], s50 offen offset:0 sc1
    v_cvt_pk_bf16_f32 v180, v113, v117
    v_cvt_pk_bf16_f32 v181, v121, v125
    v_cvt_pk_bf16_f32 v182, v129, v133
    v_cvt_pk_bf16_f32 v183, v137, v141
    buffer_store_dwordx4 v[180:183], v6, s[16:19], s50 offen offset:1024 sc1
    v_cvt_pk_bf16_f32 v184, v114, v118
    v_cvt_pk_bf16_f32 v185, v122, v126
    v_cvt_pk_bf16_f32 v186, v130, v134
    v_cvt_pk_bf16_f32 v187, v138, v142
    s_add_u32 s50, s50, 258048
    buffer_store_dwordx4 v[184:187], v6, s[16:19], s50 offen offset:0 sc1
    v_cvt_pk_bf16_f32 v188, v115, v119
    v_cvt_pk_bf16_f32 v189, v123, v127
    v_cvt_pk_bf16_f32 v190, v131, v135
    v_cvt_pk_bf16_f32 v191, v139, v143
    buffer_store_dwordx4 v[188:191], v6, s[16:19], s50 offen offset:1024 sc1
    v_mfma_f32_16x16x32_bf16 v[112:115], v[56:59], v[80:83], 0
    v_mfma_f32_16x16x32_bf16 v[116:119], v[56:59], v[84:87], 0
    v_mfma_f32_16x16x32_bf16 v[120:123], v[56:59], v[88:91], 0
    v_mfma_f32_16x16x32_bf16 v[124:127], v[56:59], v[92:95], 0
    v_mfma_f32_16x16x32_bf16 v[128:131], v[56:59], v[96:99], 0
    v_mfma_f32_16x16x32_bf16 v[132:135], v[56:59], v[100:103], 0
    v_mfma_f32_16x16x32_bf16 v[136:139], v[56:59], v[104:107], 0
    v_mfma_f32_16x16x32_bf16 v[140:143], v[56:59], v[108:111], 0
    v_cvt_pk_bf16_f32 v192, v144, v148
    v_cvt_pk_bf16_f32 v193, v152, v156
    v_cvt_pk_bf16_f32 v194, v160, v164
    v_cvt_pk_bf16_f32 v195, v168, v172
    s_add_u32 s50, s50, 258048
    buffer_store_dwordx4 v[192:195], v6, s[16:19], s50 offen offset:0 sc1
    v_cvt_pk_bf16_f32 v196, v145, v149
    v_cvt_pk_bf16_f32 v197, v153, v157
    v_cvt_pk_bf16_f32 v198, v161, v165
    v_cvt_pk_bf16_f32 v199, v169, v173
    buffer_store_dwordx4 v[196:199], v6, s[16:19], s50 offen offset:1024 sc1
    v_cvt_pk_bf16_f32 v200, v146, v150
    v_cvt_pk_bf16_f32 v201, v154, v158
    v_cvt_pk_bf16_f32 v202, v162, v166
    v_cvt_pk_bf16_f32 v203, v170, v174
    s_add_u32 s50, s50, 258048
    buffer_store_dwordx4 v[200:203], v6, s[16:19], s50 offen offset:0 sc1
    v_cvt_pk_bf16_f32 v204, v147, v151
    v_cvt_pk_bf16_f32 v205, v155, v159
    v_cvt_pk_bf16_f32 v206, v163, v167
    v_cvt_pk_bf16_f32 v207, v171, v175
    buffer_store_dwordx4 v[204:207], v6, s[16:19], s50 offen offset:1024 sc1
    v_mfma_f32_16x16x32_bf16 v[144:147], v[60:63], v[80:83], 0
    v_mfma_f32_16x16x32_bf16 v[148:151], v[60:63], v[84:87], 0
    v_mfma_f32_16x16x32_bf16 v[152:155], v[60:63], v[88:91], 0
    v_mfma_f32_16x16x32_bf16 v[156:159], v[60:63], v[92:95], 0
    v_mfma_f32_16x16x32_bf16 v[160:163], v[60:63], v[96:99], 0
    v_mfma_f32_16x16x32_bf16 v[164:167], v[60:63], v[100:103], 0
    v_mfma_f32_16x16x32_bf16 v[168:171], v[60:63], v[104:107], 0
    v_mfma_f32_16x16x32_bf16 v[172:175], v[60:63], v[108:111], 0
    v_cvt_pk_bf16_f32 v176, v112, v116
    v_cvt_pk_bf16_f32 v177, v120, v124
    v_cvt_pk_bf16_f32 v178, v128, v132
    v_cvt_pk_bf16_f32 v179, v136, v140
    s_add_u32 s50, s50, 258048
    buffer_store_dwordx4 v[176:179], v6, s[16:19], s50 offen offset:0 sc1
    v_cvt_pk_bf16_f32 v180, v113, v117
    v_cvt_pk_bf16_f32 v181, v121, v125
    v_cvt_pk_bf16_f32 v182, v129, v133
    v_cvt_pk_bf16_f32 v183, v137, v141
    buffer_store_dwordx4 v[180:183], v6, s[16:19], s50 offen offset:1024 sc1
    v_cvt_pk_bf16_f32 v184, v114, v118
    v_cvt_pk_bf16_f32 v185, v122, v126
    v_cvt_pk_bf16_f32 v186, v130, v134
    v_cvt_pk_bf16_f32 v187, v138, v142
    s_add_u32 s50, s50, 258048
    buffer_store_dwordx4 v[184:187], v6, s[16:19], s50 offen offset:0 sc1
    v_cvt_pk_bf16_f32 v188, v115, v119
    v_cvt_pk_bf16_f32 v189, v123, v127
    v_cvt_pk_bf16_f32 v190, v131, v135
    v_cvt_pk_bf16_f32 v191, v139, v143
    buffer_store_dwordx4 v[188:191], v6, s[16:19], s50 offen offset:1024 sc1
    v_cvt_pk_bf16_f32 v192, v144, v148
    v_cvt_pk_bf16_f32 v193, v152, v156
    v_cvt_pk_bf16_f32 v194, v160, v164
    v_cvt_pk_bf16_f32 v195, v168, v172
    s_add_u32 s50, s50, 258048
    buffer_store_dwordx4 v[192:195], v6, s[16:19], s50 offen offset:0 sc1
    v_cvt_pk_bf16_f32 v196, v145, v149
    v_cvt_pk_bf16_f32 v197, v153, v157
    v_cvt_pk_bf16_f32 v198, v161, v165
    v_cvt_pk_bf16_f32 v199, v169, v173
    buffer_store_dwordx4 v[196:199], v6, s[16:19], s50 offen offset:1024 sc1
    v_cvt_pk_bf16_f32 v200, v146, v150
    v_cvt_pk_bf16_f32 v201, v154, v158
    v_cvt_pk_bf16_f32 v202, v162, v166
    v_cvt_pk_bf16_f32 v203, v170, v174
    s_add_u32 s50, s50, 258048
    buffer_store_dwordx4 v[200:203], v6, s[16:19], s50 offen offset:0 sc1
    v_cvt_pk_bf16_f32 v204, v147, v151
    v_cvt_pk_bf16_f32 v205, v155, v159
    v_cvt_pk_bf16_f32 v206, v163, v167
    v_cvt_pk_bf16_f32 v207, v171, v175
    buffer_store_dwordx4 v[204:207], v6, s[16:19], s50 offen offset:1024 sc1
    s_cmp_lg_u32 s28, 5
    s_cbranch_scc1 K1_nopf
    s_bfe_u32 s52, s2, 0x30003
    s_lshl_b32 s52, s52, 13
    v_lshlrev_b32 v24, 7, v0
    v_add_u32 v24, s52, v24
    v_add_u32 v24, k2_kernel-K1_pc, v24
    v_min_u32 v24, fft_tables_end-K1_pc-4, v24
    global_load_dword v25, v24, s[10:11]
K1_nopf:
K1_end:
    s_endpgm
.globl k2_kernel
.p2align 8
.type k2_kernel,@function
k2_kernel:
    s_load_dwordx2 s[8:9], s[0:1], 32
    s_getpc_b64 s[10:11]
K2_pc:
    s_cmp_ge_u32 s2, 256
    s_cbranch_scc1 K2_end
    v_lshrrev_b32 v5, 6, v0
    v_lshlrev_b32 v11, 7, v0
    v_min_u32 v11, K2_end-K2_pc, v11
    global_load_dword v11, v11, s[10:11]
    v_and_b32 v0, 63, v0
    v_readfirstlane_b32 s28, v5
    s_and_b32 s30, s2, 7
    s_lshl_b32 s30, s30, 2
    s_lshr_b32 s31, s2, 6
    s_add_u32 s30, s30, s31
    s_bfe_u32 s31, s2, 0x20004
    s_bfe_u32 s32, s2, 0x10003
    s_mul_i32 s33, s31, 12288
    s_lshl_b32 s39, s30, 7
    s_add_u32 s33, s33, s39
    s_lshl_b32 s34, s30, 1
    s_add_u32 s34, s34, s32
    s_mul_i32 s34, s34, 129024
    s_add_u32 s34, s34, 0xb00000
    v_lshrrev_b32 v5, 3, v0
    v_and_b32 v6, 7, v0
    v_and_b32 v7, 6, v5
    v_xor_b32 v6, v6, v7
    v_lshlrev_b32 v6, 4, v6
    v_mul_u32_u24 v5, 344064, v5
    v_add_u32 v3, v5, v6
    v_lshlrev_b32 v4, 4, v0
    s_lshl_b32 s42, s28, 10
    s_mul_i32 s43, s28, 2752512
    s_min_u32 s40, s28, 2
    s_sub_u32 s40, 5, s40
    s_sub_u32 s41, 2, s28
    s_cmp_eq_u32 s28, 3
    s_cselect_b32 s41, 6, s41
    s_mul_i32 s50, s40, 5120
    s_add_u32 s50, s50, 4096
    s_add_u32 s40, s40, 224
    s_mul_i32 s40, s40, 49152
    s_mul_i32 s51, s41, 5120
    s_add_u32 s51, s51, 4096
    s_add_u32 s41, s41, 224
    s_mul_i32 s41, s41, 49152
    s_and_b32 s36, s28, 1
    s_lshr_b32 s37, s28, 1
    s_lshl_b32 s45, s37, 11
    s_waitcnt lgkmcnt(0)
    s_sub_u32 s39, 11304960, s33
    s_add_u32 s12, s8, s33
    s_addc_u32 s13, s9, 0
    s_and_b32 s13, s13, 0xffff
    s_mov_b32 s14, 0
    s_mov_b32 s15, 0x00020000
    s_mov_b32 s14, s39
    s_add_u32 s16, s8, s34
    s_addc_u32 s17, s9, 0
    s_and_b32 s17, s17, 0xffff
    s_mov_b32 s18, 129024
    s_mov_b32 s19, 0x00020000
    s_add_u32 m0, s42, 25600
    s_add_u32 s46, s43, 245760
    buffer_load_dwordx4 v3, s[12:15], s46 offen lds
    s_add_u32 m0, s42, 20480
    s_add_u32 s46, s43, 196608
    buffer_load_dwordx4 v3, s[12:15], s46 offen lds
    s_add_u32 m0, s42, 15360
    s_add_u32 s46, s43, 147456
    buffer_load_dwordx4 v3, s[12:15], s46 offen lds
    s_add_u32 m0, s50, 0
    s_add_u32 s46, s40, 0
    buffer_load_dwordx4 v3, s[12:15], s46 offen lds
    s_add_u32 s47, s45, 0
    buffer_load_dwordx4 a[104:107], v4, s[16:19], s47 offen offset:0
    buffer_load_dwordx4 a[108:111], v4, s[16:19], s47 offen offset:1024
    buffer_load_dwordx4 a[112:115], v4, s[16:19], s47 offen offset:2048
    buffer_load_dwordx4 a[116:119], v4, s[16:19], s47 offen offset:3072
    s_add_u32 m0, s42, 10240
    s_add_u32 s46, s43, 98304
    buffer_load_dwordx4 v3, s[12:15], s46 offen lds
    s_add_u32 m0, s42, 5120
    s_add_u32 s46, s43, 49152
    buffer_load_dwordx4 v3, s[12:15], s46 offen lds
    s_add_u32 m0, s42, 0
    s_add_u32 s46, s43, 0
    buffer_load_dwordx4 v3, s[12:15], s46 offen lds
    s_add_u32 m0, s42, 30720
    s_add_u32 s46, s43, 294912
    buffer_load_dwordx4 v3, s[12:15], s46 offen lds
    s_add_u32 m0, s51, 0
    s_add_u32 s46, s41, 0
    buffer_load_dwordx4 v3, s[12:15], s46 offen lds
    s_add_u32 s47, s45, 6144
    buffer_load_dwordx4 a[120:123], v4, s[16:19], s47 offen offset:0
    buffer_load_dwordx4 a[124:127], v4, s[16:19], s47 offen offset:1024
    buffer_load_dwordx4 a[128:131], v4, s[16:19], s47 offen offset:2048
    buffer_load_dwordx4 a[132:135], v4, s[16:19], s47 offen offset:3072
    s_add_u32 s47, s45, 12288
    buffer_load_dwordx4 a[136:139], v4, s[16:19], s47 offen offset:0
    buffer_load_dwordx4 a[140:143], v4, s[16:19], s47 offen offset:1024
    buffer_load_dwordx4 a[144:147], v4, s[16:19], s47 offen offset:2048
    buffer_load_dwordx4 a[148:151], v4, s[16:19], s47 offen offset:3072
    v_and_b32 v1, 15, v0
    v_lshrrev_b32 v2, 4, v0
    s_lshl_b32 s38, s36, 4
    v_add_u32 v5, 0, v1
    v_and_b32 v6, 6, v5
    v_add_u32 v5, s38, v5
    v_lshlrev_b32 v5, 7, v5
    v_mov_b32 v7, v2
    v_xor_b32 v7, v7, v6
    v_lshl_add_u32 v12, v7, 4, v5
    v_add_u32 v16, 35840, v12
    v_add_u32 v20, 71680, v12
    v_or_b32 v7, 4, v2
    v_xor_b32 v7, v7, v6
    v_lshl_add_u32 v13, v7, 4, v5
    v_add_u32 v17, 35840, v13
    v_add_u32 v21, 71680, v13
    v_add_u32 v5, 1, v1
    v_and_b32 v6, 6, v5
    v_add_u32 v5, s38, v5
    v_lshlrev_b32 v5, 7, v5
    v_mov_b32 v7, v2
    v_xor_b32 v7, v7, v6
    v_lshl_add_u32 v14, v7, 4, v5
    v_add_u32 v18, 35840, v14
    v_add_u32 v22, 71680, v14
    v_or_b32 v7, 4, v2
    v_xor_b32 v7, v7, v6
    v_lshl_add_u32 v15, v7, 4, v5
    v_add_u32 v19, 35840, v15
    v_add_u32 v23, 71680, v15
    s_lshl_b32 s35, s31, 5
    s_add_u32 s35, s35, s30
    s_lshl_b32 s35, s35, 1
    s_add_u32 s35, s35, s32
    s_mul_i32 s35, s35, 192
    v_mul_u32_u24 v9, 344064, v1
    v_lshl_add_u32 v9, v2, 4, v9
    s_mul_i32 s38, s36, 5505024
    s_add_u32 s38, s38, s35
    v_add_u32 v9, s38, v9
    v_lshlrev_b32 v10, 3, v0
    s_mul_i32 s38, s36, 3584
    s_add_u32 s38, s38, 107520
    v_add_u32 v10, s38, v10
    s_add_u32 s20, s8, 0x1400000
    s_addc_u32 s21, s9, 0
    s_and_b32 s21, s21, 0xffff
    s_mov_b32 s22, 11010048
    s_mov_b32 s23, 0x00020000
    s_cmp_eq_u32 s37, 1
    s_cbranch_scc1 K2_q1
    s_waitcnt vmcnt(17)
    s_barrier
    ds_read_b128 a[48:51], v14 offset:25600
    ds_read_b128 a[100:103], v15 offset:25600
    ds_read_b128 a[44:47], v14 offset:20480
    ds_read_b128 a[96:99], v15 offset:20480
    ds_read_b128 a[40:43], v14 offset:15360
    ds_read_b128 a[92:95], v15 offset:15360
    s_waitcnt vmcnt(16)
    s_waitcnt lgkmcnt(5)
    v_mfma_f32_16x16x32_bf16 v[48:51], a[104:107], a[48:51], 0
    s_add_u32 s47, s45, 18432
    s_waitcnt vmcnt(15)
    v_mfma_f32_16x16x32_bf16 v[104:107], a[108:111], a[48:51], 0
    buffer_load_dwordx4 a[152:155], v4, s[16:19], s47 offen offset:0
    s_waitcnt vmcnt(15)
    v_mfma_f32_16x16x32_bf16 v[132:135], a[112:115], a[48:51], 0
    s_waitcnt vmcnt(14)
    s_waitcnt lgkmcnt(4)
    v_mfma_f32_16x16x32_bf16 v[160:163], a[116:119], a[100:103], 0
    buffer_load_dwordx4 a[156:159], v4, s[16:19], s47 offen offset:1024
    v_mfma_f32_16x16x32_bf16 v[104:107], a[104:107], a[100:103], v[104:107]
    v_mfma_f32_16x16x32_bf16 v[76:79], a[108:111], a[100:103], 0
    buffer_load_dwordx4 a[160:163], v4, s[16:19], s47 offen offset:2048
    s_waitcnt lgkmcnt(2)
    v_mfma_f32_16x16x32_bf16 v[72:75], a[108:111], a[96:99], 0
    v_mfma_f32_16x16x32_bf16 v[100:103], a[104:107], a[96:99], 0
    buffer_load_dwordx4 a[164:167], v4, s[16:19], s47 offen offset:3072
    v_mfma_f32_16x16x32_bf16 v[156:159], a[116:119], a[96:99], 0
    v_mfma_f32_16x16x32_bf16 v[128:131], a[112:115], a[44:47], 0
    s_waitcnt vmcnt(12)
    s_barrier
    s_add_u32 s47, s45, 43008
    v_mfma_f32_16x16x32_bf16 v[100:103], a[108:111], a[44:47], v[100:103]
    ds_read_b128 a[88:91], v15 offset:10240
    ds_read_b128 a[36:39], v14 offset:10240
    buffer_load_dwordx4 a[216:219], v4, s[16:19], s47 offen offset:0
    v_mfma_f32_16x16x32_bf16 v[44:47], a[104:107], a[44:47], 0
    ds_read_b128 a[84:87], v15 offset:5120
    ds_read_b128 a[32:35], v14 offset:5120
    s_waitcnt lgkmcnt(5)
    v_mfma_f32_16x16x32_bf16 v[40:43], a[104:107], a[40:43], 0
    ds_read_b128 a[80:83], v15 offset:0
    ds_read_b128 a[28:31], v14 offset:0
    buffer_load_dwordx4 a[220:223], v4, s[16:19], s47 offen offset:1024
    v_mfma_f32_16x16x32_bf16 v[96:99], a[108:111], a[40:43], 0
    ds_read_b128 a[76:79], v13 offset:30720
    ds_read_b128 a[24:27], v12 offset:30720
    v_mfma_f32_16x16x32_bf16 v[124:127], a[112:115], a[40:43], 0
    buffer_load_dwordx4 a[224:227], v4, s[16:19], s47 offen offset:2048
    s_waitcnt lgkmcnt(8)
    v_mfma_f32_16x16x32_bf16 v[152:155], a[116:119], a[92:95], 0
    v_mfma_f32_16x16x32_bf16 v[96:99], a[104:107], a[92:95], v[96:99]
    buffer_load_dwordx4 a[228:231], v4, s[16:19], s47 offen offset:3072
    v_mfma_f32_16x16x32_bf16 v[68:71], a[108:111], a[92:95], 0
    s_waitcnt lgkmcnt(7)
    v_mfma_f32_16x16x32_bf16 v[64:67], a[108:111], a[88:91], 0
    v_mfma_f32_16x16x32_bf16 v[92:95], a[104:107], a[88:91], 0
    ds_read_b128 a[20:23], v12 offset:25600
    v_mfma_f32_16x16x32_bf16 v[148:151], a[116:119], a[88:91], 0
    s_waitcnt lgkmcnt(7)
    v_mfma_f32_16x16x32_bf16 v[120:123], a[112:115], a[36:39], 0
    ds_read_b128 a[72:75], v13 offset:25600
    v_mfma_f32_16x16x32_bf16 v[92:95], a[108:111], a[36:39], v[92:95]
    v_mfma_f32_16x16x32_bf16 v[36:39], a[104:107], a[36:39], 0
    s_waitcnt lgkmcnt(6)
    v_mfma_f32_16x16x32_bf16 v[32:35], a[104:107], a[32:35], 0
    v_mfma_f32_16x16x32_bf16 v[88:91], a[108:111], a[32:35], 0
    s_add_u32 m0, s42, 61440
    s_add_u32 s46, s43, 249856
    buffer_load_dwordx4 v3, s[12:15], s46 offen lds
    v_mfma_f32_16x16x32_bf16 v[116:119], a[112:115], a[32:35], 0
    v_mfma_f32_16x16x32_bf16 v[144:147], a[116:119], a[84:87], 0
    v_mfma_f32_16x16x32_bf16 v[88:91], a[104:107], a[84:87], v[88:91]
    v_mfma_f32_16x16x32_bf16 v[60:63], a[108:111], a[84:87], 0
    s_waitcnt lgkmcnt(5)
    v_mfma_f32_16x16x32_bf16 v[56:59], a[108:111], a[80:83], 0
    s_add_u32 m0, s42, 56320
    s_add_u32 s46, s43, 200704
    buffer_load_dwordx4 v3, s[12:15], s46 offen lds
    v_mfma_f32_16x16x32_bf16 v[84:87], a[104:107], a[80:83], 0
    v_mfma_f32_16x16x32_bf16 v[140:143], a[116:119], a[80:83], 0
    s_waitcnt lgkmcnt(4)
    v_mfma_f32_16x16x32_bf16 v[112:115], a[112:115], a[28:31], 0
    v_mfma_f32_16x16x32_bf16 v[84:87], a[108:111], a[28:31], v[84:87]
    v_mfma_f32_16x16x32_bf16 v[28:31], a[104:107], a[28:31], 0
    s_add_u32 m0, s42, 51200
    s_add_u32 s46, s43, 151552
    buffer_load_dwordx4 v3, s[12:15], s46 offen lds
    s_waitcnt lgkmcnt(2)
    v_mfma_f32_16x16x32_bf16 v[24:27], a[104:107], a[24:27], 0
    v_mfma_f32_16x16x32_bf16 v[80:83], a[108:111], a[24:27], 0
    v_mfma_f32_16x16x32_bf16 v[108:111], a[112:115], a[24:27], 0
    v_mfma_f32_16x16x32_bf16 v[136:139], a[116:119], a[76:79], 0
    v_mfma_f32_16x16x32_bf16 v[80:83], a[104:107], a[76:79], v[80:83]
    v_mfma_f32_16x16x32_bf16 v[52:55], a[108:111], a[76:79], 0
    s_waitcnt vmcnt(18)
    v_mfma_f32_16x16x32_bf16 v[48:51], a[120:123], a[44:47], v[48:51]
    s_add_u32 s47, s45, 24576
    s_waitcnt vmcnt(17)
    v_mfma_f32_16x16x32_bf16 v[104:107], a[124:127], a[44:47], v[104:107]
    buffer_load_dwordx4 a[168:171], v4, s[16:19], s47 offen offset:0
    s_waitcnt vmcnt(17)
    v_mfma_f32_16x16x32_bf16 v[132:135], a[128:131], a[44:47], v[132:135]
    s_waitcnt vmcnt(16)
    v_mfma_f32_16x16x32_bf16 v[160:163], a[132:135], a[96:99], v[160:163]
    buffer_load_dwordx4 a[172:175], v4, s[16:19], s47 offen offset:1024
    v_mfma_f32_16x16x32_bf16 v[104:107], a[120:123], a[96:99], v[104:107]
    v_mfma_f32_16x16x32_bf16 v[76:79], a[124:127], a[96:99], v[76:79]
    buffer_load_dwordx4 a[176:179], v4, s[16:19], s47 offen offset:2048
    v_mfma_f32_16x16x32_bf16 v[72:75], a[124:127], a[92:95], v[72:75]
    v_mfma_f32_16x16x32_bf16 v[100:103], a[120:123], a[92:95], v[100:103]
    buffer_load_dwordx4 a[180:183], v4, s[16:19], s47 offen offset:3072
    v_mfma_f32_16x16x32_bf16 v[156:159], a[132:135], a[92:95], v[156:159]
    v_mfma_f32_16x16x32_bf16 v[128:131], a[128:131], a[40:43], v[128:131]
    s_add_u32 s47, s45, 49152
    v_mfma_f32_16x16x32_bf16 v[100:103], a[124:127], a[40:43], v[100:103]
    buffer_load_dwordx4 a[232:235], v4, s[16:19], s47 offen offset:0
    v_mfma_f32_16x16x32_bf16 v[44:47], a[120:123], a[40:43], v[44:47]
    v_mfma_f32_16x16x32_bf16 v[40:43], a[120:123], a[36:39], v[40:43]
    buffer_load_dwordx4 a[236:239], v4, s[16:19], s47 offen offset:1024
    v_mfma_f32_16x16x32_bf16 v[96:99], a[124:127], a[36:39], v[96:99]
    v_mfma_f32_16x16x32_bf16 v[124:127], a[128:131], a[36:39], v[124:127]
    buffer_load_dwordx4 a[240:243], v4, s[16:19], s47 offen offset:2048
    v_mfma_f32_16x16x32_bf16 v[152:155], a[132:135], a[88:91], v[152:155]
    v_mfma_f32_16x16x32_bf16 v[96:99], a[120:123], a[88:91], v[96:99]
    buffer_load_dwordx4 a[244:247], v4, s[16:19], s47 offen offset:3072
    v_mfma_f32_16x16x32_bf16 v[68:71], a[124:127], a[88:91], v[68:71]
    v_mfma_f32_16x16x32_bf16 v[64:67], a[124:127], a[84:87], v[64:67]
    v_mfma_f32_16x16x32_bf16 v[92:95], a[120:123], a[84:87], v[92:95]
    ds_read_b128 a[16:19], v12 offset:20480
    v_mfma_f32_16x16x32_bf16 v[148:151], a[132:135], a[84:87], v[148:151]
    v_mfma_f32_16x16x32_bf16 v[120:123], a[128:131], a[32:35], v[120:123]
    ds_read_b128 a[68:71], v13 offset:20480
    v_mfma_f32_16x16x32_bf16 v[92:95], a[124:127], a[32:35], v[92:95]
    v_mfma_f32_16x16x32_bf16 v[36:39], a[120:123], a[32:35], v[36:39]
    v_mfma_f32_16x16x32_bf16 v[32:35], a[120:123], a[28:31], v[32:35]
    v_mfma_f32_16x16x32_bf16 v[88:91], a[124:127], a[28:31], v[88:91]
    s_add_u32 m0, s50, 35840
    s_add_u32 s46, s40, 4096
    buffer_load_dwordx4 v3, s[12:15], s46 offen lds
    v_mfma_f32_16x16x32_bf16 v[116:119], a[128:131], a[28:31], v[116:119]
    v_mfma_f32_16x16x32_bf16 v[144:147], a[132:135], a[80:83], v[144:147]
    v_mfma_f32_16x16x32_bf16 v[88:91], a[120:123], a[80:83], v[88:91]
    v_mfma_f32_16x16x32_bf16 v[60:63], a[124:127], a[80:83], v[60:63]
    v_mfma_f32_16x16x32_bf16 v[56:59], a[124:127], a[76:79], v[56:59]
    s_add_u32 m0, s42, 46080
    s_add_u32 s46, s43, 102400
    buffer_load_dwordx4 v3, s[12:15], s46 offen lds
    v_mfma_f32_16x16x32_bf16 v[84:87], a[120:123], a[76:79], v[84:87]
    v_mfma_f32_16x16x32_bf16 v[140:143], a[132:135], a[76:79], v[140:143]
    v_mfma_f32_16x16x32_bf16 v[112:115], a[128:131], a[24:27], v[112:115]
    v_mfma_f32_16x16x32_bf16 v[84:87], a[124:127], a[24:27], v[84:87]
    v_mfma_f32_16x16x32_bf16 v[28:31], a[120:123], a[24:27], v[28:31]
    s_waitcnt lgkmcnt(3)
    v_mfma_f32_16x16x32_bf16 v[24:27], a[120:123], a[20:23], v[24:27]
    v_mfma_f32_16x16x32_bf16 v[80:83], a[124:127], a[20:23], v[80:83]
    v_mfma_f32_16x16x32_bf16 v[108:111], a[128:131], a[20:23], v[108:111]
    s_waitcnt lgkmcnt(2)
    v_mfma_f32_16x16x32_bf16 v[136:139], a[132:135], a[72:75], v[136:139]
    v_mfma_f32_16x16x32_bf16 v[80:83], a[120:123], a[72:75], v[80:83]
    v_mfma_f32_16x16x32_bf16 v[52:55], a[124:127], a[72:75], v[52:55]
    s_waitcnt vmcnt(24)
    v_mfma_f32_16x16x32_bf16 v[48:51], a[136:139], a[40:43], v[48:51]
    s_add_u32 s47, s45, 30720
    s_waitcnt vmcnt(23)
    v_mfma_f32_16x16x32_bf16 v[104:107], a[140:143], a[40:43], v[104:107]
    buffer_load_dwordx4 a[184:187], v4, s[16:19], s47 offen offset:0
    s_waitcnt vmcnt(23)
    v_mfma_f32_16x16x32_bf16 v[132:135], a[144:147], a[40:43], v[132:135]
    s_waitcnt vmcnt(22)
    v_mfma_f32_16x16x32_bf16 v[160:163], a[148:151], a[92:95], v[160:163]
    buffer_load_dwordx4 a[188:191], v4, s[16:19], s47 offen offset:1024
    v_mfma_f32_16x16x32_bf16 v[104:107], a[136:139], a[92:95], v[104:107]
    v_mfma_f32_16x16x32_bf16 v[76:79], a[140:143], a[92:95], v[76:79]
    buffer_load_dwordx4 a[192:195], v4, s[16:19], s47 offen offset:2048
    v_mfma_f32_16x16x32_bf16 v[72:75], a[140:143], a[88:91], v[72:75]
    v_mfma_f32_16x16x32_bf16 v[100:103], a[136:139], a[88:91], v[100:103]
    buffer_load_dwordx4 a[196:199], v4, s[16:19], s47 offen offset:3072
    v_mfma_f32_16x16x32_bf16 v[156:159], a[148:151], a[88:91], v[156:159]
    v_mfma_f32_16x16x32_bf16 v[128:131], a[144:147], a[36:39], v[128:131]
    s_add_u32 s47, s45, 55296
    v_mfma_f32_16x16x32_bf16 v[100:103], a[140:143], a[36:39], v[100:103]
    buffer_load_dwordx4 a[248:251], v4, s[16:19], s47 offen offset:0
    v_mfma_f32_16x16x32_bf16 v[44:47], a[136:139], a[36:39], v[44:47]
    v_mfma_f32_16x16x32_bf16 v[40:43], a[136:139], a[32:35], v[40:43]
    buffer_load_dwordx4 a[252:255], v4, s[16:19], s47 offen offset:1024
    v_mfma_f32_16x16x32_bf16 v[96:99], a[140:143], a[32:35], v[96:99]
    v_mfma_f32_16x16x32_bf16 v[124:127], a[144:147], a[32:35], v[124:127]
    buffer_load_dwordx4 v[180:183], v4, s[16:19], s47 offen offset:2048
    v_mfma_f32_16x16x32_bf16 v[152:155], a[148:151], a[84:87], v[152:155]
    v_mfma_f32_16x16x32_bf16 v[96:99], a[136:139], a[84:87], v[96:99]
    buffer_load_dwordx4 v[184:187], v4, s[16:19], s47 offen offset:3072
    v_mfma_f32_16x16x32_bf16 v[68:71], a[140:143], a[84:87], v[68:71]
    v_mfma_f32_16x16x32_bf16 v[64:67], a[140:143], a[80:83], v[64:67]
    v_mfma_f32_16x16x32_bf16 v[92:95], a[136:139], a[80:83], v[92:95]
    ds_read_b128 a[12:15], v12 offset:15360
    v_mfma_f32_16x16x32_bf16 v[148:151], a[148:151], a[80:83], v[148:151]
    v_mfma_f32_16x16x32_bf16 v[120:123], a[144:147], a[28:31], v[120:123]
    ds_read_b128 a[64:67], v13 offset:15360
    v_mfma_f32_16x16x32_bf16 v[92:95], a[140:143], a[28:31], v[92:95]
    v_mfma_f32_16x16x32_bf16 v[36:39], a[136:139], a[28:31], v[36:39]
    v_mfma_f32_16x16x32_bf16 v[32:35], a[136:139], a[24:27], v[32:35]
    v_mfma_f32_16x16x32_bf16 v[88:91], a[140:143], a[24:27], v[88:91]
    s_add_u32 m0, s42, 40960
    s_add_u32 s46, s43, 53248
    buffer_load_dwordx4 v3, s[12:15], s46 offen lds
    v_mfma_f32_16x16x32_bf16 v[116:119], a[144:147], a[24:27], v[116:119]
    v_mfma_f32_16x16x32_bf16 v[144:147], a[148:151], a[76:79], v[144:147]
    v_mfma_f32_16x16x32_bf16 v[88:91], a[136:139], a[76:79], v[88:91]
    v_mfma_f32_16x16x32_bf16 v[60:63], a[140:143], a[76:79], v[60:63]
    v_mfma_f32_16x16x32_bf16 v[56:59], a[140:143], a[72:75], v[56:59]
    s_add_u32 m0, s42, 35840
    s_add_u32 s46, s43, 4096
    buffer_load_dwordx4 v3, s[12:15], s46 offen lds
    v_mfma_f32_16x16x32_bf16 v[84:87], a[136:139], a[72:75], v[84:87]
    v_mfma_f32_16x16x32_bf16 v[140:143], a[148:151], a[72:75], v[140:143]
    v_mfma_f32_16x16x32_bf16 v[112:115], a[144:147], a[20:23], v[112:115]
    v_mfma_f32_16x16x32_bf16 v[84:87], a[140:143], a[20:23], v[84:87]
    v_mfma_f32_16x16x32_bf16 v[28:31], a[136:139], a[20:23], v[28:31]
    s_waitcnt lgkmcnt(3)
    v_mfma_f32_16x16x32_bf16 v[24:27], a[136:139], a[16:19], v[24:27]
    v_mfma_f32_16x16x32_bf16 v[80:83], a[140:143], a[16:19], v[80:83]
    v_mfma_f32_16x16x32_bf16 v[108:111], a[144:147], a[16:19], v[108:111]
    s_waitcnt lgkmcnt(2)
    v_mfma_f32_16x16x32_bf16 v[136:139], a[148:151], a[68:71], v[136:139]
    v_mfma_f32_16x16x32_bf16 v[80:83], a[136:139], a[68:71], v[80:83]
    v_mfma_f32_16x16x32_bf16 v[52:55], a[140:143], a[68:71], v[52:55]
    s_waitcnt vmcnt(30)
    v_mfma_f32_16x16x32_bf16 v[48:51], a[152:155], a[36:39], v[48:51]
    s_add_u32 s47, s45, 36864
    s_waitcnt vmcnt(29)
    v_mfma_f32_16x16x32_bf16 v[104:107], a[156:159], a[36:39], v[104:107]
    buffer_load_dwordx4 a[200:203], v4, s[16:19], s47 offen offset:0
    s_waitcnt vmcnt(29)
    v_mfma_f32_16x16x32_bf16 v[132:135], a[160:163], a[36:39], v[132:135]
    s_waitcnt vmcnt(28)
    v_mfma_f32_16x16x32_bf16 v[160:163], a[164:167], a[88:91], v[160:163]
    buffer_load_dwordx4 a[204:207], v4, s[16:19], s47 offen offset:1024
    v_mfma_f32_16x16x32_bf16 v[104:107], a[152:155], a[88:91], v[104:107]
    v_mfma_f32_16x16x32_bf16 v[76:79], a[156:159], a[88:91], v[76:79]
    buffer_load_dwordx4 a[208:211], v4, s[16:19], s47 offen offset:2048
    v_mfma_f32_16x16x32_bf16 v[72:75], a[156:159], a[84:87], v[72:75]
    v_mfma_f32_16x16x32_bf16 v[100:103], a[152:155], a[84:87], v[100:103]
    buffer_load_dwordx4 a[212:215], v4, s[16:19], s47 offen offset:3072
    v_mfma_f32_16x16x32_bf16 v[156:159], a[164:167], a[84:87], v[156:159]
    v_mfma_f32_16x16x32_bf16 v[128:131], a[160:163], a[32:35], v[128:131]
    s_add_u32 s47, s45, 61440
    v_mfma_f32_16x16x32_bf16 v[100:103], a[156:159], a[32:35], v[100:103]
    buffer_load_dwordx4 v[188:191], v4, s[16:19], s47 offen offset:0
    v_mfma_f32_16x16x32_bf16 v[44:47], a[152:155], a[32:35], v[44:47]
    v_mfma_f32_16x16x32_bf16 v[40:43], a[152:155], a[28:31], v[40:43]
    buffer_load_dwordx4 v[192:195], v4, s[16:19], s47 offen offset:1024
    v_mfma_f32_16x16x32_bf16 v[96:99], a[156:159], a[28:31], v[96:99]
    v_mfma_f32_16x16x32_bf16 v[124:127], a[160:163], a[28:31], v[124:127]
    buffer_load_dwordx4 v[196:199], v4, s[16:19], s47 offen offset:2048
    v_mfma_f32_16x16x32_bf16 v[152:155], a[164:167], a[80:83], v[152:155]
    v_mfma_f32_16x16x32_bf16 v[96:99], a[152:155], a[80:83], v[96:99]
    buffer_load_dwordx4 v[200:203], v4, s[16:19], s47 offen offset:3072
    v_mfma_f32_16x16x32_bf16 v[68:71], a[156:159], a[80:83], v[68:71]
    v_mfma_f32_16x16x32_bf16 v[64:67], a[156:159], a[76:79], v[64:67]
    v_mfma_f32_16x16x32_bf16 v[92:95], a[152:155], a[76:79], v[92:95]
    ds_read_b128 a[8:11], v12 offset:10240
    v_mfma_f32_16x16x32_bf16 v[148:151], a[164:167], a[76:79], v[148:151]
    v_mfma_f32_16x16x32_bf16 v[120:123], a[160:163], a[24:27], v[120:123]
    ds_read_b128 a[60:63], v13 offset:10240
    v_mfma_f32_16x16x32_bf16 v[92:95], a[156:159], a[24:27], v[92:95]
    v_mfma_f32_16x16x32_bf16 v[36:39], a[152:155], a[24:27], v[36:39]
    v_mfma_f32_16x16x32_bf16 v[32:35], a[152:155], a[20:23], v[32:35]
    v_mfma_f32_16x16x32_bf16 v[88:91], a[156:159], a[20:23], v[88:91]
    s_add_u32 m0, s42, 66560
    s_add_u32 s46, s43, 299008
    buffer_load_dwordx4 v3, s[12:15], s46 offen lds
    v_mfma_f32_16x16x32_bf16 v[116:119], a[160:163], a[20:23], v[116:119]
    v_mfma_f32_16x16x32_bf16 v[144:147], a[164:167], a[72:75], v[144:147]
    v_mfma_f32_16x16x32_bf16 v[88:91], a[152:155], a[72:75], v[88:91]
    v_mfma_f32_16x16x32_bf16 v[60:63], a[156:159], a[72:75], v[60:63]
    v_mfma_f32_16x16x32_bf16 v[56:59], a[156:159], a[68:71], v[56:59]
    s_add_u32 m0, s51, 35840
    s_add_u32 s46, s41, 4096
    buffer_load_dwordx4 v3, s[12:15], s46 offen lds
    v_mfma_f32_16x16x32_bf16 v[84:87], a[152:155], a[68:71], v[84:87]
    v_mfma_f32_16x16x32_bf16 v[140:143], a[164:167], a[68:71], v[140:143]
    v_mfma_f32_16x16x32_bf16 v[112:115], a[160:163], a[16:19], v[112:115]
    v_mfma_f32_16x16x32_bf16 v[84:87], a[156:159], a[16:19], v[84:87]
    v_mfma_f32_16x16x32_bf16 v[28:31], a[152:155], a[16:19], v[28:31]
    s_waitcnt lgkmcnt(3)
    v_mfma_f32_16x16x32_bf16 v[24:27], a[152:155], a[12:15], v[24:27]
    v_mfma_f32_16x16x32_bf16 v[80:83], a[156:159], a[12:15], v[80:83]
    v_mfma_f32_16x16x32_bf16 v[108:111], a[160:163], a[12:15], v[108:111]
    s_waitcnt lgkmcnt(2)
    v_mfma_f32_16x16x32_bf16 v[136:139], a[164:167], a[64:67], v[136:139]
    v_mfma_f32_16x16x32_bf16 v[80:83], a[152:155], a[64:67], v[80:83]
    v_mfma_f32_16x16x32_bf16 v[52:55], a[156:159], a[64:67], v[52:55]
    s_waitcnt vmcnt(29)
    v_mfma_f32_16x16x32_bf16 v[48:51], a[168:171], a[32:35], v[48:51]
    s_waitcnt vmcnt(28)
    v_mfma_f32_16x16x32_bf16 v[104:107], a[172:175], a[32:35], v[104:107]
    s_waitcnt vmcnt(27)
    v_mfma_f32_16x16x32_bf16 v[132:135], a[176:179], a[32:35], v[132:135]
    s_waitcnt vmcnt(26)
    v_mfma_f32_16x16x32_bf16 v[160:163], a[180:183], a[84:87], v[160:163]
    v_mfma_f32_16x16x32_bf16 v[104:107], a[168:171], a[84:87], v[104:107]
    v_mfma_f32_16x16x32_bf16 v[76:79], a[172:175], a[84:87], v[76:79]
    v_mfma_f32_16x16x32_bf16 v[72:75], a[172:175], a[80:83], v[72:75]
    v_mfma_f32_16x16x32_bf16 v[100:103], a[168:171], a[80:83], v[100:103]
    v_mfma_f32_16x16x32_bf16 v[156:159], a[180:183], a[80:83], v[156:159]
    v_mfma_f32_16x16x32_bf16 v[128:131], a[176:179], a[28:31], v[128:131]
    s_add_u32 s47, s45, 67584
    v_mfma_f32_16x16x32_bf16 v[100:103], a[172:175], a[28:31], v[100:103]
    buffer_load_dwordx4 v[204:207], v4, s[16:19], s47 offen offset:0
    v_mfma_f32_16x16x32_bf16 v[44:47], a[168:171], a[28:31], v[44:47]
    v_mfma_f32_16x16x32_bf16 v[40:43], a[168:171], a[24:27], v[40:43]
    buffer_load_dwordx4 v[208:211], v4, s[16:19], s47 offen offset:1024
    v_mfma_f32_16x16x32_bf16 v[96:99], a[172:175], a[24:27], v[96:99]
    v_mfma_f32_16x16x32_bf16 v[124:127], a[176:179], a[24:27], v[124:127]
    buffer_load_dwordx4 v[212:215], v4, s[16:19], s47 offen offset:2048
    v_mfma_f32_16x16x32_bf16 v[152:155], a[180:183], a[76:79], v[152:155]
    v_mfma_f32_16x16x32_bf16 v[96:99], a[168:171], a[76:79], v[96:99]
    buffer_load_dwordx4 v[216:219], v4, s[16:19], s47 offen offset:3072
    v_mfma_f32_16x16x32_bf16 v[68:71], a[172:175], a[76:79], v[68:71]
    v_mfma_f32_16x16x32_bf16 v[64:67], a[172:175], a[72:75], v[64:67]
    v_mfma_f32_16x16x32_bf16 v[92:95], a[168:171], a[72:75], v[92:95]
    ds_read_b128 a[4:7], v12 offset:5120
    v_mfma_f32_16x16x32_bf16 v[148:151], a[180:183], a[72:75], v[148:151]
    v_mfma_f32_16x16x32_bf16 v[120:123], a[176:179], a[20:23], v[120:123]
    ds_read_b128 a[56:59], v13 offset:5120
    v_mfma_f32_16x16x32_bf16 v[92:95], a[172:175], a[20:23], v[92:95]
    v_mfma_f32_16x16x32_bf16 v[36:39], a[168:171], a[20:23], v[36:39]
    v_mfma_f32_16x16x32_bf16 v[32:35], a[168:171], a[16:19], v[32:35]
    v_mfma_f32_16x16x32_bf16 v[88:91], a[172:175], a[16:19], v[88:91]
    v_mfma_f32_16x16x32_bf16 v[116:119], a[176:179], a[16:19], v[116:119]
    v_mfma_f32_16x16x32_bf16 v[144:147], a[180:183], a[68:71], v[144:147]
    v_mfma_f32_16x16x32_bf16 v[88:91], a[168:171], a[68:71], v[88:91]
    v_mfma_f32_16x16x32_bf16 v[60:63], a[172:175], a[68:71], v[60:63]
    v_mfma_f32_16x16x32_bf16 v[56:59], a[172:175], a[64:67], v[56:59]
    v_mfma_f32_16x16x32_bf16 v[84:87], a[168:171], a[64:67], v[84:87]
    v_mfma_f32_16x16x32_bf16 v[140:143], a[180:183], a[64:67], v[140:143]
    v_mfma_f32_16x16x32_bf16 v[112:115], a[176:179], a[12:15], v[112:115]
    v_mfma_f32_16x16x32_bf16 v[84:87], a[172:175], a[12:15], v[84:87]
    v_mfma_f32_16x16x32_bf16 v[28:31], a[168:171], a[12:15], v[28:31]
    s_waitcnt lgkmcnt(3)
    v_mfma_f32_16x16x32_bf16 v[24:27], a[168:171], a[8:11], v[24:27]
    v_mfma_f32_16x16x32_bf16 v[80:83], a[172:175], a[8:11], v[80:83]
    v_mfma_f32_16x16x32_bf16 v[108:111], a[176:179], a[8:11], v[108:111]
    s_waitcnt lgkmcnt(2)
    v_mfma_f32_16x16x32_bf16 v[136:139], a[180:183], a[60:63], v[136:139]
    v_mfma_f32_16x16x32_bf16 v[80:83], a[168:171], a[60:63], v[80:83]
    v_mfma_f32_16x16x32_bf16 v[52:55], a[172:175], a[60:63], v[52:55]
    s_waitcnt vmcnt(23)
    v_mfma_f32_16x16x32_bf16 v[48:51], a[184:187], a[28:31], v[48:51]
    s_waitcnt vmcnt(22)
    v_mfma_f32_16x16x32_bf16 v[104:107], a[188:191], a[28:31], v[104:107]
    s_waitcnt vmcnt(21)
    v_mfma_f32_16x16x32_bf16 v[132:135], a[192:195], a[28:31], v[132:135]
    s_waitcnt vmcnt(20)
    v_mfma_f32_16x16x32_bf16 v[160:163], a[196:199], a[80:83], v[160:163]
    v_mfma_f32_16x16x32_bf16 v[104:107], a[184:187], a[80:83], v[104:107]
    v_mfma_f32_16x16x32_bf16 v[76:79], a[188:191], a[80:83], v[76:79]
    v_mfma_f32_16x16x32_bf16 v[72:75], a[188:191], a[76:79], v[72:75]
    v_mfma_f32_16x16x32_bf16 v[100:103], a[184:187], a[76:79], v[100:103]
    v_mfma_f32_16x16x32_bf16 v[156:159], a[196:199], a[76:79], v[156:159]
    v_mfma_f32_16x16x32_bf16 v[128:131], a[192:195], a[24:27], v[128:131]
    s_add_u32 s47, s45, 73728
    v_mfma_f32_16x16x32_bf16 v[100:103], a[188:191], a[24:27], v[100:103]
    buffer_load_dwordx4 v[220:223], v4, s[16:19], s47 offen offset:0
    v_mfma_f32_16x16x32_bf16 v[44:47], a[184:187], a[24:27], v[44:47]
    v_mfma_f32_16x16x32_bf16 v[40:43], a[184:187], a[20:23], v[40:43]
    buffer_load_dwordx4 v[224:227], v4, s[16:19], s47 offen offset:1024
    v_mfma_f32_16x16x32_bf16 v[96:99], a[188:191], a[20:23], v[96:99]
    v_mfma_f32_16x16x32_bf16 v[124:127], a[192:195], a[20:23], v[124:127]
    buffer_load_dwordx4 v[228:231], v4, s[16:19], s47 offen offset:2048
    v_mfma_f32_16x16x32_bf16 v[152:155], a[196:199], a[72:75], v[152:155]
    v_mfma_f32_16x16x32_bf16 v[96:99], a[184:187], a[72:75], v[96:99]
    buffer_load_dwordx4 v[232:235], v4, s[16:19], s47 offen offset:3072
    v_mfma_f32_16x16x32_bf16 v[68:71], a[188:191], a[72:75], v[68:71]
    v_mfma_f32_16x16x32_bf16 v[64:67], a[188:191], a[68:71], v[64:67]
    s_waitcnt vmcnt(8)
    s_barrier
    v_mfma_f32_16x16x32_bf16 v[92:95], a[184:187], a[68:71], v[92:95]
    ds_read_b128 a[0:3], v12 offset:0
    v_mfma_f32_16x16x32_bf16 v[148:151], a[196:199], a[68:71], v[148:151]
    v_mfma_f32_16x16x32_bf16 v[120:123], a[192:195], a[16:19], v[120:123]
    ds_read_b128 a[52:55], v13 offset:0
    v_mfma_f32_16x16x32_bf16 v[92:95], a[188:191], a[16:19], v[92:95]
    v_mfma_f32_16x16x32_bf16 v[36:39], a[184:187], a[16:19], v[36:39]
    ds_read_b128 a[48:51], v18 offset:25600
    v_mfma_f32_16x16x32_bf16 v[32:35], a[184:187], a[12:15], v[32:35]
    v_mfma_f32_16x16x32_bf16 v[88:91], a[188:191], a[12:15], v[88:91]
    ds_read_b128 a[100:103], v19 offset:25600
    v_mfma_f32_16x16x32_bf16 v[116:119], a[192:195], a[12:15], v[116:119]
    v_mfma_f32_16x16x32_bf16 v[144:147], a[196:199], a[64:67], v[144:147]
    ds_read_b128 a[44:47], v18 offset:20480
    v_mfma_f32_16x16x32_bf16 v[88:91], a[184:187], a[64:67], v[88:91]
    v_mfma_f32_16x16x32_bf16 v[60:63], a[188:191], a[64:67], v[60:63]
    ds_read_b128 a[96:99], v19 offset:20480
    v_mfma_f32_16x16x32_bf16 v[56:59], a[188:191], a[60:63], v[56:59]
    v_mfma_f32_16x16x32_bf16 v[84:87], a[184:187], a[60:63], v[84:87]
    s_add_u32 s47, s45, 79872
    ds_read_b128 a[40:43], v18 offset:15360
    v_mfma_f32_16x16x32_bf16 v[140:143], a[196:199], a[60:63], v[140:143]
    buffer_load_dwordx4 v[236:239], v4, s[16:19], s47 offen offset:0
    v_mfma_f32_16x16x32_bf16 v[112:115], a[192:195], a[8:11], v[112:115]
    ds_read_b128 a[92:95], v19 offset:15360
    v_mfma_f32_16x16x32_bf16 v[84:87], a[188:191], a[8:11], v[84:87]
    buffer_load_dwordx4 v[240:243], v4, s[16:19], s47 offen offset:1024
    v_mfma_f32_16x16x32_bf16 v[28:31], a[184:187], a[8:11], v[28:31]
    s_waitcnt lgkmcnt(9)
    v_mfma_f32_16x16x32_bf16 v[24:27], a[184:187], a[4:7], v[24:27]
    buffer_load_dwordx4 v[244:247], v4, s[16:19], s47 offen offset:2048
    v_mfma_f32_16x16x32_bf16 v[80:83], a[188:191], a[4:7], v[80:83]
    v_mfma_f32_16x16x32_bf16 v[108:111], a[192:195], a[4:7], v[108:111]
    buffer_load_dwordx4 v[248:251], v4, s[16:19], s47 offen offset:3072
    s_waitcnt lgkmcnt(8)
    v_mfma_f32_16x16x32_bf16 v[136:139], a[196:199], a[56:59], v[136:139]
    v_mfma_f32_16x16x32_bf16 v[80:83], a[184:187], a[56:59], v[80:83]
    v_mfma_f32_16x16x32_bf16 v[52:55], a[188:191], a[56:59], v[52:55]
    v_mfma_f32_16x16x32_bf16 v[48:51], a[200:203], a[24:27], v[48:51]
    v_mfma_f32_16x16x32_bf16 v[104:107], a[204:207], a[24:27], v[104:107]
    v_mfma_f32_16x16x32_bf16 v[132:135], a[208:211], a[24:27], v[132:135]
    v_mfma_f32_16x16x32_bf16 v[160:163], a[212:215], a[76:79], v[160:163]
    v_mfma_f32_16x16x32_bf16 v[104:107], a[200:203], a[76:79], v[104:107]
    v_mfma_f32_16x16x32_bf16 v[76:79], a[204:207], a[76:79], v[76:79]
    v_mfma_f32_16x16x32_bf16 v[72:75], a[204:207], a[72:75], v[72:75]
    v_mfma_f32_16x16x32_bf16 v[100:103], a[200:203], a[72:75], v[100:103]
    v_mfma_f32_16x16x32_bf16 v[156:159], a[212:215], a[72:75], v[156:159]
    v_mfma_f32_16x16x32_bf16 v[128:131], a[208:211], a[20:23], v[128:131]
    v_mfma_f32_16x16x32_bf16 v[100:103], a[204:207], a[20:23], v[100:103]
    v_mfma_f32_16x16x32_bf16 v[44:47], a[200:203], a[20:23], v[44:47]
    v_mfma_f32_16x16x32_bf16 v[40:43], a[200:203], a[16:19], v[40:43]
    v_mfma_f32_16x16x32_bf16 v[96:99], a[204:207], a[16:19], v[96:99]
    v_mfma_f32_16x16x32_bf16 v[124:127], a[208:211], a[16:19], v[124:127]
    v_mfma_f32_16x16x32_bf16 v[152:155], a[212:215], a[68:71], v[152:155]
    v_mfma_f32_16x16x32_bf16 v[96:99], a[200:203], a[68:71], v[96:99]
    v_mfma_f32_16x16x32_bf16 v[68:71], a[204:207], a[68:71], v[68:71]
    v_mfma_f32_16x16x32_bf16 v[64:67], a[204:207], a[64:67], v[64:67]
    v_mfma_f32_16x16x32_bf16 v[92:95], a[200:203], a[64:67], v[92:95]
    ds_read_b128 a[36:39], v18 offset:10240
    v_mfma_f32_16x16x32_bf16 v[148:151], a[212:215], a[64:67], v[148:151]
    v_mfma_f32_16x16x32_bf16 v[120:123], a[208:211], a[12:15], v[120:123]
    ds_read_b128 a[88:91], v19 offset:10240
    v_mfma_f32_16x16x32_bf16 v[92:95], a[204:207], a[12:15], v[92:95]
    v_mfma_f32_16x16x32_bf16 v[36:39], a[200:203], a[12:15], v[36:39]
    ds_read_b128 a[32:35], v18 offset:5120
    v_mfma_f32_16x16x32_bf16 v[32:35], a[200:203], a[8:11], v[32:35]
    v_mfma_f32_16x16x32_bf16 v[88:91], a[204:207], a[8:11], v[88:91]
    ds_read_b128 a[84:87], v19 offset:5120
    v_mfma_f32_16x16x32_bf16 v[116:119], a[208:211], a[8:11], v[116:119]
    v_mfma_f32_16x16x32_bf16 v[144:147], a[212:215], a[60:63], v[144:147]
    ds_read_b128 a[28:31], v18 offset:0
    v_mfma_f32_16x16x32_bf16 v[88:91], a[200:203], a[60:63], v[88:91]
    v_mfma_f32_16x16x32_bf16 v[60:63], a[204:207], a[60:63], v[60:63]
    ds_read_b128 a[80:83], v19 offset:0
    v_mfma_f32_16x16x32_bf16 v[56:59], a[204:207], a[56:59], v[56:59]
    v_mfma_f32_16x16x32_bf16 v[84:87], a[200:203], a[56:59], v[84:87]
    ds_read_b128 a[24:27], v16 offset:30720
    v_mfma_f32_16x16x32_bf16 v[140:143], a[212:215], a[56:59], v[140:143]
    v_mfma_f32_16x16x32_bf16 v[112:115], a[208:211], a[4:7], v[112:115]
    ds_read_b128 a[76:79], v17 offset:30720
    v_mfma_f32_16x16x32_bf16 v[84:87], a[204:207], a[4:7], v[84:87]
    v_mfma_f32_16x16x32_bf16 v[28:31], a[200:203], a[4:7], v[28:31]
    s_waitcnt lgkmcnt(15)
    v_mfma_f32_16x16x32_bf16 v[24:27], a[200:203], a[0:3], v[24:27]
    v_mfma_f32_16x16x32_bf16 v[80:83], a[204:207], a[0:3], v[80:83]
    v_mfma_f32_16x16x32_bf16 v[108:111], a[208:211], a[0:3], v[108:111]
    s_waitcnt lgkmcnt(14)
    v_mfma_f32_16x16x32_bf16 v[136:139], a[212:215], a[52:55], v[136:139]
    v_mfma_f32_16x16x32_bf16 v[80:83], a[200:203], a[52:55], v[80:83]
    v_mfma_f32_16x16x32_bf16 v[52:55], a[204:207], a[52:55], v[52:55]
    s_waitcnt lgkmcnt(13)
    v_mfma_f32_16x16x32_bf16 v[48:51], a[216:219], a[48:51], v[48:51]
    v_mfma_f32_16x16x32_bf16 v[104:107], a[220:223], a[48:51], v[104:107]
    v_mfma_f32_16x16x32_bf16 v[132:135], a[224:227], a[48:51], v[132:135]
    ds_read_b128 a[20:23], v16 offset:25600
    s_waitcnt lgkmcnt(12)
    v_mfma_f32_16x16x32_bf16 v[48:51], a[232:235], a[44:47], v[48:51]
    v_mfma_f32_16x16x32_bf16 v[104:107], a[236:239], a[44:47], v[104:107]
    v_mfma_f32_16x16x32_bf16 v[132:135], a[240:243], a[44:47], v[132:135]
    ds_read_b128 a[72:75], v17 offset:25600
    s_waitcnt lgkmcnt(11)
    v_mfma_f32_16x16x32_bf16 v[48:51], a[248:251], a[40:43], v[48:51]
    v_mfma_f32_16x16x32_bf16 v[104:107], a[252:255], a[40:43], v[104:107]
    v_mfma_f32_16x16x32_bf16 v[132:135], v[180:183], a[40:43], v[132:135]
    s_add_u32 s47, s45, 86016
    s_waitcnt lgkmcnt(9)
    v_mfma_f32_16x16x32_bf16 v[48:51], v[188:191], a[36:39], v[48:51]
    buffer_load_dwordx4 a[104:107], v4, s[16:19], s47 offen offset:0
    v_mfma_f32_16x16x32_bf16 v[104:107], v[192:195], a[36:39], v[104:107]
    v_mfma_f32_16x16x32_bf16 v[132:135], v[196:199], a[36:39], v[132:135]
    buffer_load_dwordx4 a[108:111], v4, s[16:19], s47 offen offset:1024
    s_waitcnt vmcnt(13)
    s_waitcnt lgkmcnt(7)
    v_mfma_f32_16x16x32_bf16 v[48:51], v[204:207], a[32:35], v[48:51]
    s_waitcnt vmcnt(12)
    v_mfma_f32_16x16x32_bf16 v[104:107], v[208:211], a[32:35], v[104:107]
    buffer_load_dwordx4 a[112:115], v4, s[16:19], s47 offen offset:2048
    s_waitcnt vmcnt(12)
    v_mfma_f32_16x16x32_bf16 v[132:135], v[212:215], a[32:35], v[132:135]
    s_waitcnt vmcnt(10)
    s_waitcnt lgkmcnt(5)
    v_mfma_f32_16x16x32_bf16 v[48:51], v[220:223], a[28:31], v[48:51]
    buffer_load_dwordx4 a[116:119], v4, s[16:19], s47 offen offset:3072
    s_waitcnt vmcnt(10)
    v_mfma_f32_16x16x32_bf16 v[104:107], v[224:227], a[28:31], v[104:107]
    s_waitcnt vmcnt(9)
    v_mfma_f32_16x16x32_bf16 v[132:135], v[228:231], a[28:31], v[132:135]
    s_waitcnt vmcnt(7)
    s_waitcnt lgkmcnt(3)
    v_mfma_f32_16x16x32_bf16 v[48:51], v[236:239], a[24:27], v[48:51]
    s_waitcnt vmcnt(6)
    v_mfma_f32_16x16x32_bf16 v[104:107], v[240:243], a[24:27], v[104:107]
    s_add_u32 m0, s42, 97280
    s_add_u32 s46, s43, 253952
    buffer_load_dwordx4 v3, s[12:15], s46 offen lds
    s_waitcnt vmcnt(6)
    v_mfma_f32_16x16x32_bf16 v[132:135], v[244:247], a[24:27], v[132:135]
    v_mfma_f32_16x16x32_bf16 v[76:79], a[220:223], a[100:103], v[76:79]
    v_mfma_f32_16x16x32_bf16 v[104:107], a[216:219], a[100:103], v[104:107]
    v_mfma_f32_16x16x32_bf16 v[160:163], a[228:231], a[100:103], v[160:163]
    v_mfma_f32_16x16x32_bf16 v[76:79], a[236:239], a[96:99], v[76:79]
    s_add_u32 m0, s42, 92160
    s_add_u32 s46, s43, 204800
    buffer_load_dwordx4 v3, s[12:15], s46 offen lds
    v_mfma_f32_16x16x32_bf16 v[104:107], a[232:235], a[96:99], v[104:107]
    v_mfma_f32_16x16x32_bf16 v[160:163], a[244:247], a[96:99], v[160:163]
    v_mfma_f32_16x16x32_bf16 v[76:79], a[252:255], a[92:95], v[76:79]
    v_mfma_f32_16x16x32_bf16 v[104:107], a[248:251], a[92:95], v[104:107]
    v_mfma_f32_16x16x32_bf16 v[160:163], v[184:187], a[92:95], v[160:163]
    s_add_u32 m0, s42, 87040
    s_add_u32 s46, s43, 155648
    buffer_load_dwordx4 v3, s[12:15], s46 offen lds
    v_mfma_f32_16x16x32_bf16 v[76:79], v[192:195], a[88:91], v[76:79]
    v_mfma_f32_16x16x32_bf16 v[104:107], v[188:191], a[88:91], v[104:107]
    v_mfma_f32_16x16x32_bf16 v[160:163], v[200:203], a[88:91], v[160:163]
    v_mfma_f32_16x16x32_bf16 v[76:79], v[208:211], a[84:87], v[76:79]
    v_mfma_f32_16x16x32_bf16 v[104:107], v[204:207], a[84:87], v[104:107]
    v_mfma_f32_16x16x32_bf16 v[160:163], v[216:219], a[84:87], v[160:163]
    v_mfma_f32_16x16x32_bf16 v[76:79], v[224:227], a[80:83], v[76:79]
    v_mfma_f32_16x16x32_bf16 v[104:107], v[220:223], a[80:83], v[104:107]
    v_mfma_f32_16x16x32_bf16 v[160:163], v[232:235], a[80:83], v[160:163]
    s_waitcnt lgkmcnt(2)
    v_mfma_f32_16x16x32_bf16 v[76:79], v[240:243], a[76:79], v[76:79]
    v_mfma_f32_16x16x32_bf16 v[104:107], v[236:239], a[76:79], v[104:107]
    s_waitcnt vmcnt(7)
    v_mfma_f32_16x16x32_bf16 v[160:163], v[248:251], a[76:79], v[160:163]
    v_mfma_f32_16x16x32_bf16 v[44:47], a[216:219], a[44:47], v[44:47]
    v_mfma_f32_16x16x32_bf16 v[100:103], a[220:223], a[44:47], v[100:103]
    v_mfma_f32_16x16x32_bf16 v[128:131], a[224:227], a[44:47], v[128:131]
    ds_read_b128 a[16:19], v16 offset:20480
    v_mfma_f32_16x16x32_bf16 v[44:47], a[232:235], a[40:43], v[44:47]
    v_mfma_f32_16x16x32_bf16 v[100:103], a[236:239], a[40:43], v[100:103]
    v_mfma_f32_16x16x32_bf16 v[128:131], a[240:243], a[40:43], v[128:131]
    ds_read_b128 a[68:71], v17 offset:20480
    v_mfma_f32_16x16x32_bf16 v[44:47], a[248:251], a[36:39], v[44:47]
    v_mfma_f32_16x16x32_bf16 v[100:103], a[252:255], a[36:39], v[100:103]
    v_mfma_f32_16x16x32_bf16 v[128:131], v[180:183], a[36:39], v[128:131]
    s_add_u32 s47, s45, 92160
    v_mfma_f32_16x16x32_bf16 v[44:47], v[188:191], a[32:35], v[44:47]
    buffer_load_dwordx4 a[120:123], v4, s[16:19], s47 offen offset:0
    v_mfma_f32_16x16x32_bf16 v[100:103], v[192:195], a[32:35], v[100:103]
    v_mfma_f32_16x16x32_bf16 v[128:131], v[196:199], a[32:35], v[128:131]
    buffer_load_dwordx4 a[124:127], v4, s[16:19], s47 offen offset:1024
    v_mfma_f32_16x16x32_bf16 v[44:47], v[204:207], a[28:31], v[44:47]
    v_mfma_f32_16x16x32_bf16 v[100:103], v[208:211], a[28:31], v[100:103]
    buffer_load_dwordx4 a[128:131], v4, s[16:19], s47 offen offset:2048
    v_mfma_f32_16x16x32_bf16 v[128:131], v[212:215], a[28:31], v[128:131]
    v_mfma_f32_16x16x32_bf16 v[44:47], v[220:223], a[24:27], v[44:47]
    buffer_load_dwordx4 a[132:135], v4, s[16:19], s47 offen offset:3072
    v_mfma_f32_16x16x32_bf16 v[100:103], v[224:227], a[24:27], v[100:103]
    v_mfma_f32_16x16x32_bf16 v[128:131], v[228:231], a[24:27], v[128:131]
    s_waitcnt lgkmcnt(3)
    v_mfma_f32_16x16x32_bf16 v[44:47], v[236:239], a[20:23], v[44:47]
    v_mfma_f32_16x16x32_bf16 v[100:103], v[240:243], a[20:23], v[100:103]
    s_add_u32 m0, s50, 71680
    s_add_u32 s46, s40, 8192
    buffer_load_dwordx4 v3, s[12:15], s46 offen lds
    v_mfma_f32_16x16x32_bf16 v[128:131], v[244:247], a[20:23], v[128:131]
    v_mfma_f32_16x16x32_bf16 v[72:75], a[220:223], a[96:99], v[72:75]
    v_mfma_f32_16x16x32_bf16 v[100:103], a[216:219], a[96:99], v[100:103]
    v_mfma_f32_16x16x32_bf16 v[156:159], a[228:231], a[96:99], v[156:159]
    v_mfma_f32_16x16x32_bf16 v[72:75], a[236:239], a[92:95], v[72:75]
    s_add_u32 m0, s42, 81920
    s_add_u32 s46, s43, 106496
    buffer_load_dwordx4 v3, s[12:15], s46 offen lds
    v_mfma_f32_16x16x32_bf16 v[100:103], a[232:235], a[92:95], v[100:103]
    v_mfma_f32_16x16x32_bf16 v[156:159], a[244:247], a[92:95], v[156:159]
    v_mfma_f32_16x16x32_bf16 v[72:75], a[252:255], a[88:91], v[72:75]
    v_mfma_f32_16x16x32_bf16 v[100:103], a[248:251], a[88:91], v[100:103]
    v_mfma_f32_16x16x32_bf16 v[156:159], v[184:187], a[88:91], v[156:159]
    s_add_u32 m0, s42, 76800
    s_add_u32 s46, s43, 57344
    buffer_load_dwordx4 v3, s[12:15], s46 offen lds
    v_mfma_f32_16x16x32_bf16 v[72:75], v[192:195], a[84:87], v[72:75]
    v_mfma_f32_16x16x32_bf16 v[100:103], v[188:191], a[84:87], v[100:103]
    v_mfma_f32_16x16x32_bf16 v[156:159], v[200:203], a[84:87], v[156:159]
    v_mfma_f32_16x16x32_bf16 v[72:75], v[208:211], a[80:83], v[72:75]
    v_mfma_f32_16x16x32_bf16 v[100:103], v[204:207], a[80:83], v[100:103]
    v_mfma_f32_16x16x32_bf16 v[156:159], v[216:219], a[80:83], v[156:159]
    v_mfma_f32_16x16x32_bf16 v[72:75], v[224:227], a[76:79], v[72:75]
    v_mfma_f32_16x16x32_bf16 v[100:103], v[220:223], a[76:79], v[100:103]
    v_mfma_f32_16x16x32_bf16 v[156:159], v[232:235], a[76:79], v[156:159]
    s_waitcnt lgkmcnt(2)
    v_mfma_f32_16x16x32_bf16 v[72:75], v[240:243], a[72:75], v[72:75]
    v_mfma_f32_16x16x32_bf16 v[100:103], v[236:239], a[72:75], v[100:103]
    v_mfma_f32_16x16x32_bf16 v[156:159], v[248:251], a[72:75], v[156:159]
    v_mfma_f32_16x16x32_bf16 v[40:43], a[216:219], a[40:43], v[40:43]
    v_mfma_f32_16x16x32_bf16 v[96:99], a[220:223], a[40:43], v[96:99]
    v_mfma_f32_16x16x32_bf16 v[124:127], a[224:227], a[40:43], v[124:127]
    ds_read_b128 a[12:15], v16 offset:15360
    v_mfma_f32_16x16x32_bf16 v[40:43], a[232:235], a[36:39], v[40:43]
    v_mfma_f32_16x16x32_bf16 v[96:99], a[236:239], a[36:39], v[96:99]
    v_mfma_f32_16x16x32_bf16 v[124:127], a[240:243], a[36:39], v[124:127]
    ds_read_b128 a[64:67], v17 offset:15360
    v_mfma_f32_16x16x32_bf16 v[40:43], a[248:251], a[32:35], v[40:43]
    v_mfma_f32_16x16x32_bf16 v[96:99], a[252:255], a[32:35], v[96:99]
    v_mfma_f32_16x16x32_bf16 v[124:127], v[180:183], a[32:35], v[124:127]
    s_add_u32 s47, s45, 98304
    v_mfma_f32_16x16x32_bf16 v[40:43], v[188:191], a[28:31], v[40:43]
    buffer_load_dwordx4 a[136:139], v4, s[16:19], s47 offen offset:0
    v_mfma_f32_16x16x32_bf16 v[96:99], v[192:195], a[28:31], v[96:99]
    v_mfma_f32_16x16x32_bf16 v[124:127], v[196:199], a[28:31], v[124:127]
    buffer_load_dwordx4 a[140:143], v4, s[16:19], s47 offen offset:1024
    v_mfma_f32_16x16x32_bf16 v[40:43], v[204:207], a[24:27], v[40:43]
    v_mfma_f32_16x16x32_bf16 v[96:99], v[208:211], a[24:27], v[96:99]
    buffer_load_dwordx4 a[144:147], v4, s[16:19], s47 offen offset:2048
    v_mfma_f32_16x16x32_bf16 v[124:127], v[212:215], a[24:27], v[124:127]
    v_mfma_f32_16x16x32_bf16 v[40:43], v[220:223], a[20:23], v[40:43]
    buffer_load_dwordx4 a[148:151], v4, s[16:19], s47 offen offset:3072
    v_mfma_f32_16x16x32_bf16 v[96:99], v[224:227], a[20:23], v[96:99]
    v_mfma_f32_16x16x32_bf16 v[124:127], v[228:231], a[20:23], v[124:127]
    s_waitcnt lgkmcnt(3)
    v_mfma_f32_16x16x32_bf16 v[40:43], v[236:239], a[16:19], v[40:43]
    v_mfma_f32_16x16x32_bf16 v[96:99], v[240:243], a[16:19], v[96:99]
    s_add_u32 m0, s42, 71680
    s_add_u32 s46, s43, 8192
    buffer_load_dwordx4 v3, s[12:15], s46 offen lds
    v_mfma_f32_16x16x32_bf16 v[124:127], v[244:247], a[16:19], v[124:127]
    v_mfma_f32_16x16x32_bf16 v[68:71], a[220:223], a[92:95], v[68:71]
    v_mfma_f32_16x16x32_bf16 v[96:99], a[216:219], a[92:95], v[96:99]
    v_mfma_f32_16x16x32_bf16 v[152:155], a[228:231], a[92:95], v[152:155]
    v_mfma_f32_16x16x32_bf16 v[68:71], a[236:239], a[88:91], v[68:71]
    s_add_u32 m0, s42, 102400
    s_add_u32 s46, s43, 303104
    buffer_load_dwordx4 v3, s[12:15], s46 offen lds
    v_mfma_f32_16x16x32_bf16 v[96:99], a[232:235], a[88:91], v[96:99]
    v_mfma_f32_16x16x32_bf16 v[152:155], a[244:247], a[88:91], v[152:155]
    v_mfma_f32_16x16x32_bf16 v[68:71], a[252:255], a[84:87], v[68:71]
    v_mfma_f32_16x16x32_bf16 v[96:99], a[248:251], a[84:87], v[96:99]
    v_mfma_f32_16x16x32_bf16 v[152:155], v[184:187], a[84:87], v[152:155]
    s_add_u32 m0, s51, 71680
    s_add_u32 s46, s41, 8192
    buffer_load_dwordx4 v3, s[12:15], s46 offen lds
    v_mfma_f32_16x16x32_bf16 v[68:71], v[192:195], a[80:83], v[68:71]
    v_mfma_f32_16x16x32_bf16 v[96:99], v[188:191], a[80:83], v[96:99]
    v_mfma_f32_16x16x32_bf16 v[152:155], v[200:203], a[80:83], v[152:155]
    v_mfma_f32_16x16x32_bf16 v[68:71], v[208:211], a[76:79], v[68:71]
    v_mfma_f32_16x16x32_bf16 v[96:99], v[204:207], a[76:79], v[96:99]
    v_mfma_f32_16x16x32_bf16 v[152:155], v[216:219], a[76:79], v[152:155]
    v_mfma_f32_16x16x32_bf16 v[68:71], v[224:227], a[72:75], v[68:71]
    v_mfma_f32_16x16x32_bf16 v[96:99], v[220:223], a[72:75], v[96:99]
    v_mfma_f32_16x16x32_bf16 v[152:155], v[232:235], a[72:75], v[152:155]
    s_waitcnt lgkmcnt(2)
    v_mfma_f32_16x16x32_bf16 v[68:71], v[240:243], a[68:71], v[68:71]
    v_mfma_f32_16x16x32_bf16 v[96:99], v[236:239], a[68:71], v[96:99]
    v_mfma_f32_16x16x32_bf16 v[152:155], v[248:251], a[68:71], v[152:155]
    v_mfma_f32_16x16x32_bf16 v[36:39], a[216:219], a[36:39], v[36:39]
    v_mfma_f32_16x16x32_bf16 v[92:95], a[220:223], a[36:39], v[92:95]
    v_mfma_f32_16x16x32_bf16 v[120:123], a[224:227], a[36:39], v[120:123]
    ds_read_b128 a[8:11], v16 offset:10240
    v_mfma_f32_16x16x32_bf16 v[36:39], a[232:235], a[32:35], v[36:39]
    v_mfma_f32_16x16x32_bf16 v[92:95], a[236:239], a[32:35], v[92:95]
    v_mfma_f32_16x16x32_bf16 v[120:123], a[240:243], a[32:35], v[120:123]
    ds_read_b128 a[60:63], v17 offset:10240
    v_mfma_f32_16x16x32_bf16 v[36:39], a[248:251], a[28:31], v[36:39]
    v_mfma_f32_16x16x32_bf16 v[92:95], a[252:255], a[28:31], v[92:95]
    v_mfma_f32_16x16x32_bf16 v[120:123], v[180:183], a[28:31], v[120:123]
    s_add_u32 s47, s45, 104448
    v_mfma_f32_16x16x32_bf16 v[36:39], v[188:191], a[24:27], v[36:39]
    buffer_load_dwordx4 a[152:155], v4, s[16:19], s47 offen offset:0
    v_mfma_f32_16x16x32_bf16 v[92:95], v[192:195], a[24:27], v[92:95]
    v_mfma_f32_16x16x32_bf16 v[120:123], v[196:199], a[24:27], v[120:123]
    buffer_load_dwordx4 a[156:159], v4, s[16:19], s47 offen offset:1024
    v_mfma_f32_16x16x32_bf16 v[36:39], v[204:207], a[20:23], v[36:39]
    v_mfma_f32_16x16x32_bf16 v[92:95], v[208:211], a[20:23], v[92:95]
    buffer_load_dwordx4 a[160:163], v4, s[16:19], s47 offen offset:2048
    v_mfma_f32_16x16x32_bf16 v[120:123], v[212:215], a[20:23], v[120:123]
    v_mfma_f32_16x16x32_bf16 v[36:39], v[220:223], a[16:19], v[36:39]
    buffer_load_dwordx4 a[164:167], v4, s[16:19], s47 offen offset:3072
    v_mfma_f32_16x16x32_bf16 v[92:95], v[224:227], a[16:19], v[92:95]
    v_mfma_f32_16x16x32_bf16 v[120:123], v[228:231], a[16:19], v[120:123]
    s_waitcnt lgkmcnt(3)
    v_mfma_f32_16x16x32_bf16 v[36:39], v[236:239], a[12:15], v[36:39]
    v_mfma_f32_16x16x32_bf16 v[92:95], v[240:243], a[12:15], v[92:95]
    v_mfma_f32_16x16x32_bf16 v[120:123], v[244:247], a[12:15], v[120:123]
    v_mfma_f32_16x16x32_bf16 v[64:67], a[220:223], a[88:91], v[64:67]
    v_mfma_f32_16x16x32_bf16 v[92:95], a[216:219], a[88:91], v[92:95]
    v_mfma_f32_16x16x32_bf16 v[148:151], a[228:231], a[88:91], v[148:151]
    v_mfma_f32_16x16x32_bf16 v[64:67], a[236:239], a[84:87], v[64:67]
    v_mfma_f32_16x16x32_bf16 v[92:95], a[232:235], a[84:87], v[92:95]
    v_mfma_f32_16x16x32_bf16 v[148:151], a[244:247], a[84:87], v[148:151]
    v_mfma_f32_16x16x32_bf16 v[64:67], a[252:255], a[80:83], v[64:67]
    v_mfma_f32_16x16x32_bf16 v[92:95], a[248:251], a[80:83], v[92:95]
    v_mfma_f32_16x16x32_bf16 v[148:151], v[184:187], a[80:83], v[148:151]
    v_mfma_f32_16x16x32_bf16 v[64:67], v[192:195], a[76:79], v[64:67]
    v_mfma_f32_16x16x32_bf16 v[92:95], v[188:191], a[76:79], v[92:95]
    v_mfma_f32_16x16x32_bf16 v[148:151], v[200:203], a[76:79], v[148:151]
    v_mfma_f32_16x16x32_bf16 v[64:67], v[208:211], a[72:75], v[64:67]
    v_mfma_f32_16x16x32_bf16 v[92:95], v[204:207], a[72:75], v[92:95]
    v_mfma_f32_16x16x32_bf16 v[148:151], v[216:219], a[72:75], v[148:151]
    v_mfma_f32_16x16x32_bf16 v[64:67], v[224:227], a[68:71], v[64:67]
    v_mfma_f32_16x16x32_bf16 v[92:95], v[220:223], a[68:71], v[92:95]
    v_mfma_f32_16x16x32_bf16 v[148:151], v[232:235], a[68:71], v[148:151]
    s_waitcnt lgkmcnt(2)
    v_mfma_f32_16x16x32_bf16 v[64:67], v[240:243], a[64:67], v[64:67]
    v_mfma_f32_16x16x32_bf16 v[92:95], v[236:239], a[64:67], v[92:95]
    v_mfma_f32_16x16x32_bf16 v[148:151], v[248:251], a[64:67], v[148:151]
    v_mfma_f32_16x16x32_bf16 v[32:35], a[216:219], a[32:35], v[32:35]
    v_mfma_f32_16x16x32_bf16 v[88:91], a[220:223], a[32:35], v[88:91]
    v_mfma_f32_16x16x32_bf16 v[116:119], a[224:227], a[32:35], v[116:119]
    ds_read_b128 a[4:7], v16 offset:5120
    v_mfma_f32_16x16x32_bf16 v[32:35], a[232:235], a[28:31], v[32:35]
    v_mfma_f32_16x16x32_bf16 v[88:91], a[236:239], a[28:31], v[88:91]
    v_mfma_f32_16x16x32_bf16 v[116:119], a[240:243], a[28:31], v[116:119]
    ds_read_b128 a[56:59], v17 offset:5120
    v_mfma_f32_16x16x32_bf16 v[32:35], a[248:251], a[24:27], v[32:35]
    v_mfma_f32_16x16x32_bf16 v[88:91], a[252:255], a[24:27], v[88:91]
    v_mfma_f32_16x16x32_bf16 v[116:119], v[180:183], a[24:27], v[116:119]
    s_add_u32 s47, s45, 110592
    v_mfma_f32_16x16x32_bf16 v[32:35], v[188:191], a[20:23], v[32:35]
    buffer_load_dwordx4 a[168:171], v4, s[16:19], s47 offen offset:0
    v_mfma_f32_16x16x32_bf16 v[88:91], v[192:195], a[20:23], v[88:91]
    v_mfma_f32_16x16x32_bf16 v[116:119], v[196:199], a[20:23], v[116:119]
    buffer_load_dwordx4 a[172:175], v4, s[16:19], s47 offen offset:1024
    v_mfma_f32_16x16x32_bf16 v[32:35], v[204:207], a[16:19], v[32:35]
    v_mfma_f32_16x16x32_bf16 v[88:91], v[208:211], a[16:19], v[88:91]
    buffer_load_dwordx4 a[176:179], v4, s[16:19], s47 offen offset:2048
    v_mfma_f32_16x16x32_bf16 v[116:119], v[212:215], a[16:19], v[116:119]
    v_mfma_f32_16x16x32_bf16 v[32:35], v[220:223], a[12:15], v[32:35]
    buffer_load_dwordx4 a[180:183], v4, s[16:19], s47 offen offset:3072
    v_mfma_f32_16x16x32_bf16 v[88:91], v[224:227], a[12:15], v[88:91]
    v_mfma_f32_16x16x32_bf16 v[116:119], v[228:231], a[12:15], v[116:119]
    s_waitcnt lgkmcnt(3)
    v_mfma_f32_16x16x32_bf16 v[32:35], v[236:239], a[8:11], v[32:35]
    v_mfma_f32_16x16x32_bf16 v[88:91], v[240:243], a[8:11], v[88:91]
    v_mfma_f32_16x16x32_bf16 v[116:119], v[244:247], a[8:11], v[116:119]
    v_mfma_f32_16x16x32_bf16 v[60:63], a[220:223], a[84:87], v[60:63]
    v_mfma_f32_16x16x32_bf16 v[88:91], a[216:219], a[84:87], v[88:91]
    v_mfma_f32_16x16x32_bf16 v[144:147], a[228:231], a[84:87], v[144:147]
    v_mfma_f32_16x16x32_bf16 v[60:63], a[236:239], a[80:83], v[60:63]
    v_mfma_f32_16x16x32_bf16 v[88:91], a[232:235], a[80:83], v[88:91]
    v_mfma_f32_16x16x32_bf16 v[144:147], a[244:247], a[80:83], v[144:147]
    v_mfma_f32_16x16x32_bf16 v[60:63], a[252:255], a[76:79], v[60:63]
    v_mfma_f32_16x16x32_bf16 v[88:91], a[248:251], a[76:79], v[88:91]
    v_mfma_f32_16x16x32_bf16 v[144:147], v[184:187], a[76:79], v[144:147]
    v_mfma_f32_16x16x32_bf16 v[60:63], v[192:195], a[72:75], v[60:63]
    v_mfma_f32_16x16x32_bf16 v[88:91], v[188:191], a[72:75], v[88:91]
    v_mfma_f32_16x16x32_bf16 v[144:147], v[200:203], a[72:75], v[144:147]
    v_mfma_f32_16x16x32_bf16 v[60:63], v[208:211], a[68:71], v[60:63]
    v_mfma_f32_16x16x32_bf16 v[88:91], v[204:207], a[68:71], v[88:91]
    v_mfma_f32_16x16x32_bf16 v[144:147], v[216:219], a[68:71], v[144:147]
    v_mfma_f32_16x16x32_bf16 v[60:63], v[224:227], a[64:67], v[60:63]
    v_mfma_f32_16x16x32_bf16 v[88:91], v[220:223], a[64:67], v[88:91]
    v_mfma_f32_16x16x32_bf16 v[144:147], v[232:235], a[64:67], v[144:147]
    s_waitcnt lgkmcnt(2)
    v_mfma_f32_16x16x32_bf16 v[60:63], v[240:243], a[60:63], v[60:63]
    v_mfma_f32_16x16x32_bf16 v[88:91], v[236:239], a[60:63], v[88:91]
    v_mfma_f32_16x16x32_bf16 v[144:147], v[248:251], a[60:63], v[144:147]
    v_mfma_f32_16x16x32_bf16 v[28:31], a[216:219], a[28:31], v[28:31]
    s_waitcnt vmcnt(8)
    s_barrier
    v_mfma_f32_16x16x32_bf16 v[84:87], a[220:223], a[28:31], v[84:87]
    v_mfma_f32_16x16x32_bf16 v[112:115], a[224:227], a[28:31], v[112:115]
    ds_read_b128 a[0:3], v16 offset:0
    v_mfma_f32_16x16x32_bf16 v[28:31], a[232:235], a[24:27], v[28:31]
    v_mfma_f32_16x16x32_bf16 v[84:87], a[236:239], a[24:27], v[84:87]
    v_mfma_f32_16x16x32_bf16 v[112:115], a[240:243], a[24:27], v[112:115]
    ds_read_b128 a[52:55], v17 offset:0
    v_mfma_f32_16x16x32_bf16 v[28:31], a[248:251], a[20:23], v[28:31]
    v_mfma_f32_16x16x32_bf16 v[84:87], a[252:255], a[20:23], v[84:87]
    v_mfma_f32_16x16x32_bf16 v[112:115], v[180:183], a[20:23], v[112:115]
    s_add_u32 s47, s45, 116736
    v_mfma_f32_16x16x32_bf16 v[28:31], v[188:191], a[16:19], v[28:31]
    buffer_load_dwordx4 a[184:187], v4, s[16:19], s47 offen offset:0
    v_mfma_f32_16x16x32_bf16 v[84:87], v[192:195], a[16:19], v[84:87]
    v_mfma_f32_16x16x32_bf16 v[112:115], v[196:199], a[16:19], v[112:115]
    buffer_load_dwordx4 a[188:191], v4, s[16:19], s47 offen offset:1024
    v_mfma_f32_16x16x32_bf16 v[28:31], v[204:207], a[12:15], v[28:31]
    v_mfma_f32_16x16x32_bf16 v[84:87], v[208:211], a[12:15], v[84:87]
    buffer_load_dwordx4 a[192:195], v4, s[16:19], s47 offen offset:2048
    v_mfma_f32_16x16x32_bf16 v[112:115], v[212:215], a[12:15], v[112:115]
    v_mfma_f32_16x16x32_bf16 v[28:31], v[220:223], a[8:11], v[28:31]
    buffer_load_dwordx4 a[196:199], v4, s[16:19], s47 offen offset:3072
    v_mfma_f32_16x16x32_bf16 v[84:87], v[224:227], a[8:11], v[84:87]
    v_mfma_f32_16x16x32_bf16 v[112:115], v[228:231], a[8:11], v[112:115]
    s_waitcnt lgkmcnt(3)
    v_mfma_f32_16x16x32_bf16 v[28:31], v[236:239], a[4:7], v[28:31]
    s_add_u32 s47, s45, 122880
    v_mfma_f32_16x16x32_bf16 v[84:87], v[240:243], a[4:7], v[84:87]
    buffer_load_dwordx4 a[200:203], v4, s[16:19], s47 offen offset:0
    v_mfma_f32_16x16x32_bf16 v[112:115], v[244:247], a[4:7], v[112:115]
    v_mfma_f32_16x16x32_bf16 v[56:59], a[220:223], a[80:83], v[56:59]
    buffer_load_dwordx4 a[204:207], v4, s[16:19], s47 offen offset:1024
    v_mfma_f32_16x16x32_bf16 v[84:87], a[216:219], a[80:83], v[84:87]
    v_mfma_f32_16x16x32_bf16 v[140:143], a[228:231], a[80:83], v[140:143]
    buffer_load_dwordx4 a[208:211], v4, s[16:19], s47 offen offset:2048
    v_mfma_f32_16x16x32_bf16 v[56:59], a[236:239], a[76:79], v[56:59]
    v_mfma_f32_16x16x32_bf16 v[84:87], a[232:235], a[76:79], v[84:87]
    buffer_load_dwordx4 a[212:215], v4, s[16:19], s47 offen offset:3072
    v_mfma_f32_16x16x32_bf16 v[140:143], a[244:247], a[76:79], v[140:143]
    v_mfma_f32_16x16x32_bf16 v[56:59], a[252:255], a[72:75], v[56:59]
    ds_read_b128 a[48:51], v22 offset:25600
    v_mfma_f32_16x16x32_bf16 v[84:87], a[248:251], a[72:75], v[84:87]
    ds_read_b128 a[100:103], v23 offset:25600
    v_mfma_f32_16x16x32_bf16 v[140:143], v[184:187], a[72:75], v[140:143]
    ds_read_b128 a[44:47], v22 offset:20480
    v_mfma_f32_16x16x32_bf16 v[56:59], v[192:195], a[68:71], v[56:59]
    ds_read_b128 a[96:99], v23 offset:20480
    v_mfma_f32_16x16x32_bf16 v[84:87], v[188:191], a[68:71], v[84:87]
    ds_read_b128 a[40:43], v22 offset:15360
    v_mfma_f32_16x16x32_bf16 v[140:143], v[200:203], a[68:71], v[140:143]
    ds_read_b128 a[92:95], v23 offset:15360
    v_mfma_f32_16x16x32_bf16 v[56:59], v[208:211], a[64:67], v[56:59]
    ds_read_b128 a[36:39], v22 offset:10240
    v_mfma_f32_16x16x32_bf16 v[84:87], v[204:207], a[64:67], v[84:87]
    ds_read_b128 a[88:91], v23 offset:10240
    v_mfma_f32_16x16x32_bf16 v[140:143], v[216:219], a[64:67], v[140:143]
    ds_read_b128 a[32:35], v22 offset:5120
    v_mfma_f32_16x16x32_bf16 v[56:59], v[224:227], a[60:63], v[56:59]
    ds_read_b128 a[84:87], v23 offset:5120
    v_mfma_f32_16x16x32_bf16 v[84:87], v[220:223], a[60:63], v[84:87]
    v_mfma_f32_16x16x32_bf16 v[140:143], v[232:235], a[60:63], v[140:143]
    s_waitcnt lgkmcnt(12)
    v_mfma_f32_16x16x32_bf16 v[56:59], v[240:243], a[56:59], v[56:59]
    v_mfma_f32_16x16x32_bf16 v[84:87], v[236:239], a[56:59], v[84:87]
    v_mfma_f32_16x16x32_bf16 v[140:143], v[248:251], a[56:59], v[140:143]
    v_mfma_f32_16x16x32_bf16 v[24:27], a[216:219], a[24:27], v[24:27]
    v_mfma_f32_16x16x32_bf16 v[80:83], a[220:223], a[24:27], v[80:83]
    v_mfma_f32_16x16x32_bf16 v[108:111], a[224:227], a[24:27], v[108:111]
    ds_read_b128 a[24:27], v20 offset:30720
    v_mfma_f32_16x16x32_bf16 v[24:27], a[232:235], a[20:23], v[24:27]
    v_mfma_f32_16x16x32_bf16 v[80:83], a[236:239], a[20:23], v[80:83]
    v_mfma_f32_16x16x32_bf16 v[108:111], a[240:243], a[20:23], v[108:111]
    v_mfma_f32_16x16x32_bf16 v[24:27], a[248:251], a[16:19], v[24:27]
    v_mfma_f32_16x16x32_bf16 v[80:83], a[252:255], a[16:19], v[80:83]
    v_mfma_f32_16x16x32_bf16 v[108:111], v[180:183], a[16:19], v[108:111]
    ds_read_b128 a[28:31], v22 offset:0
    v_mfma_f32_16x16x32_bf16 v[24:27], v[188:191], a[12:15], v[24:27]
    ds_read_b128 a[80:83], v23 offset:0
    v_mfma_f32_16x16x32_bf16 v[80:83], v[192:195], a[12:15], v[80:83]
    v_mfma_f32_16x16x32_bf16 v[108:111], v[196:199], a[12:15], v[108:111]
    v_mfma_f32_16x16x32_bf16 v[24:27], v[204:207], a[8:11], v[24:27]
    v_mfma_f32_16x16x32_bf16 v[80:83], v[208:211], a[8:11], v[80:83]
    v_mfma_f32_16x16x32_bf16 v[108:111], v[212:215], a[8:11], v[108:111]
    v_mfma_f32_16x16x32_bf16 v[24:27], v[220:223], a[4:7], v[24:27]
    v_mfma_f32_16x16x32_bf16 v[80:83], v[224:227], a[4:7], v[80:83]
    v_mfma_f32_16x16x32_bf16 v[108:111], v[228:231], a[4:7], v[108:111]
    s_waitcnt lgkmcnt(14)
    v_mfma_f32_16x16x32_bf16 v[24:27], v[236:239], a[0:3], v[24:27]
    v_mfma_f32_16x16x32_bf16 v[80:83], v[240:243], a[0:3], v[80:83]
    v_mfma_f32_16x16x32_bf16 v[108:111], v[244:247], a[0:3], v[108:111]
    v_mfma_f32_16x16x32_bf16 v[52:55], a[220:223], a[76:79], v[52:55]
    v_mfma_f32_16x16x32_bf16 v[80:83], a[216:219], a[76:79], v[80:83]
    v_mfma_f32_16x16x32_bf16 v[136:139], a[228:231], a[76:79], v[136:139]
    ds_read_b128 a[76:79], v21 offset:30720
    v_mfma_f32_16x16x32_bf16 v[52:55], a[236:239], a[72:75], v[52:55]
    v_mfma_f32_16x16x32_bf16 v[80:83], a[232:235], a[72:75], v[80:83]
    v_mfma_f32_16x16x32_bf16 v[136:139], a[244:247], a[72:75], v[136:139]
    v_mfma_f32_16x16x32_bf16 v[52:55], a[252:255], a[68:71], v[52:55]
    v_mfma_f32_16x16x32_bf16 v[80:83], a[248:251], a[68:71], v[80:83]
    v_mfma_f32_16x16x32_bf16 v[136:139], v[184:187], a[68:71], v[136:139]
    v_mfma_f32_16x16x32_bf16 v[52:55], v[192:195], a[64:67], v[52:55]
    v_mfma_f32_16x16x32_bf16 v[80:83], v[188:191], a[64:67], v[80:83]
    v_mfma_f32_16x16x32_bf16 v[136:139], v[200:203], a[64:67], v[136:139]
    v_mfma_f32_16x16x32_bf16 v[52:55], v[208:211], a[60:63], v[52:55]
    v_mfma_f32_16x16x32_bf16 v[80:83], v[204:207], a[60:63], v[80:83]
    v_mfma_f32_16x16x32_bf16 v[136:139], v[216:219], a[60:63], v[136:139]
    v_mfma_f32_16x16x32_bf16 v[52:55], v[224:227], a[56:59], v[52:55]
    v_mfma_f32_16x16x32_bf16 v[80:83], v[220:223], a[56:59], v[80:83]
    v_mfma_f32_16x16x32_bf16 v[136:139], v[232:235], a[56:59], v[136:139]
    s_waitcnt lgkmcnt(14)
    v_mfma_f32_16x16x32_bf16 v[52:55], v[240:243], a[52:55], v[52:55]
    v_mfma_f32_16x16x32_bf16 v[80:83], v[236:239], a[52:55], v[80:83]
    v_mfma_f32_16x16x32_bf16 v[136:139], v[248:251], a[52:55], v[136:139]
    s_waitcnt lgkmcnt(13)
    v_mfma_f32_16x16x32_bf16 v[48:51], a[104:107], a[48:51], v[48:51]
    v_mfma_f32_16x16x32_bf16 v[104:107], a[108:111], a[48:51], v[104:107]
    v_mfma_f32_16x16x32_bf16 v[132:135], a[112:115], a[48:51], v[132:135]
    ds_read_b128 a[20:23], v20 offset:25600
    s_waitcnt lgkmcnt(12)
    v_mfma_f32_16x16x32_bf16 v[48:51], a[120:123], a[44:47], v[48:51]
    v_mfma_f32_16x16x32_bf16 v[104:107], a[124:127], a[44:47], v[104:107]
    v_mfma_f32_16x16x32_bf16 v[132:135], a[128:131], a[44:47], v[132:135]
    ds_read_b128 a[72:75], v21 offset:25600
    s_waitcnt lgkmcnt(11)
    v_mfma_f32_16x16x32_bf16 v[48:51], a[136:139], a[40:43], v[48:51]
    v_mfma_f32_16x16x32_bf16 v[104:107], a[140:143], a[40:43], v[104:107]
    v_mfma_f32_16x16x32_bf16 v[132:135], a[144:147], a[40:43], v[132:135]
    s_waitcnt vmcnt(15)
    s_waitcnt lgkmcnt(9)
    v_mfma_f32_16x16x32_bf16 v[48:51], a[152:155], a[36:39], v[48:51]
    s_waitcnt vmcnt(14)
    v_mfma_f32_16x16x32_bf16 v[104:107], a[156:159], a[36:39], v[104:107]
    s_waitcnt vmcnt(13)
    v_mfma_f32_16x16x32_bf16 v[132:135], a[160:163], a[36:39], v[132:135]
    s_waitcnt vmcnt(11)
    s_waitcnt lgkmcnt(7)
    v_mfma_f32_16x16x32_bf16 v[48:51], a[168:171], a[32:35], v[48:51]
    s_waitcnt vmcnt(10)
    v_mfma_f32_16x16x32_bf16 v[104:107], a[172:175], a[32:35], v[104:107]
    s_waitcnt vmcnt(9)
    v_mfma_f32_16x16x32_bf16 v[132:135], a[176:179], a[32:35], v[132:135]
    s_waitcnt vmcnt(7)
    s_waitcnt lgkmcnt(4)
    v_mfma_f32_16x16x32_bf16 v[48:51], a[184:187], a[28:31], v[48:51]
    s_waitcnt vmcnt(6)
    v_mfma_f32_16x16x32_bf16 v[104:107], a[188:191], a[28:31], v[104:107]
    s_waitcnt vmcnt(5)
    v_mfma_f32_16x16x32_bf16 v[132:135], a[192:195], a[28:31], v[132:135]
    s_waitcnt vmcnt(3)
    v_mfma_f32_16x16x32_bf16 v[48:51], a[200:203], a[24:27], v[48:51]
    s_waitcnt vmcnt(2)
    v_mfma_f32_16x16x32_bf16 v[104:107], a[204:207], a[24:27], v[104:107]
    s_waitcnt vmcnt(1)
    v_mfma_f32_16x16x32_bf16 v[132:135], a[208:211], a[24:27], v[132:135]
    v_mfma_f32_16x16x32_bf16 v[76:79], a[108:111], a[100:103], v[76:79]
    v_mfma_f32_16x16x32_bf16 v[104:107], a[104:107], a[100:103], v[104:107]
    v_mfma_f32_16x16x32_bf16 v[160:163], a[116:119], a[100:103], v[160:163]
    v_mfma_f32_16x16x32_bf16 v[76:79], a[124:127], a[96:99], v[76:79]
    v_mfma_f32_16x16x32_bf16 v[104:107], a[120:123], a[96:99], v[104:107]
    v_mfma_f32_16x16x32_bf16 v[160:163], a[132:135], a[96:99], v[160:163]
    v_mfma_f32_16x16x32_bf16 v[76:79], a[140:143], a[92:95], v[76:79]
    v_mfma_f32_16x16x32_bf16 v[104:107], a[136:139], a[92:95], v[104:107]
    v_mfma_f32_16x16x32_bf16 v[160:163], a[148:151], a[92:95], v[160:163]
    v_mfma_f32_16x16x32_bf16 v[76:79], a[156:159], a[88:91], v[76:79]
    v_mfma_f32_16x16x32_bf16 v[104:107], a[152:155], a[88:91], v[104:107]
    v_mfma_f32_16x16x32_bf16 v[160:163], a[164:167], a[88:91], v[160:163]
    v_mfma_f32_16x16x32_bf16 v[76:79], a[172:175], a[84:87], v[76:79]
    v_mfma_f32_16x16x32_bf16 v[104:107], a[168:171], a[84:87], v[104:107]
    v_mfma_f32_16x16x32_bf16 v[160:163], a[180:183], a[84:87], v[160:163]
    s_waitcnt lgkmcnt(3)
    v_mfma_f32_16x16x32_bf16 v[76:79], a[188:191], a[80:83], v[76:79]
    v_mfma_f32_16x16x32_bf16 v[104:107], a[184:187], a[80:83], v[104:107]
    v_mfma_f32_16x16x32_bf16 v[160:163], a[196:199], a[80:83], v[160:163]
    s_waitcnt lgkmcnt(2)
    v_mfma_f32_16x16x32_bf16 v[76:79], a[204:207], a[76:79], v[76:79]
    v_mfma_f32_16x16x32_bf16 v[104:107], a[200:203], a[76:79], v[104:107]
    s_waitcnt vmcnt(0)
    v_mfma_f32_16x16x32_bf16 v[160:163], a[212:215], a[76:79], v[160:163]
    v_mfma_f32_16x16x32_bf16 v[44:47], a[104:107], a[44:47], v[44:47]
    v_mfma_f32_16x16x32_bf16 v[100:103], a[108:111], a[44:47], v[100:103]
    v_mfma_f32_16x16x32_bf16 v[128:131], a[112:115], a[44:47], v[128:131]
    ds_read_b128 a[16:19], v20 offset:20480
    v_mfma_f32_16x16x32_bf16 v[44:47], a[120:123], a[40:43], v[44:47]
    v_mfma_f32_16x16x32_bf16 v[100:103], a[124:127], a[40:43], v[100:103]
    v_mfma_f32_16x16x32_bf16 v[128:131], a[128:131], a[40:43], v[128:131]
    ds_read_b128 a[68:71], v21 offset:20480
    v_mfma_f32_16x16x32_bf16 v[44:47], a[136:139], a[36:39], v[44:47]
    v_mfma_f32_16x16x32_bf16 v[100:103], a[140:143], a[36:39], v[100:103]
    v_sub_f32 v48, v48, v76
    v_mfma_f32_16x16x32_bf16 v[128:131], a[144:147], a[36:39], v[128:131]
    v_sub_f32 v49, v49, v77
    v_mfma_f32_16x16x32_bf16 v[44:47], a[152:155], a[32:35], v[44:47]
    v_sub_f32 v50, v50, v78
    v_mfma_f32_16x16x32_bf16 v[100:103], a[156:159], a[32:35], v[100:103]
    v_sub_f32 v51, v51, v79
    v_mfma_f32_16x16x32_bf16 v[128:131], a[160:163], a[32:35], v[128:131]
    v_cvt_pk_bf16_f32 v164, v48, v49
    v_mfma_f32_16x16x32_bf16 v[44:47], a[168:171], a[28:31], v[44:47]
    v_cvt_pk_bf16_f32 v165, v50, v51
    v_mfma_f32_16x16x32_bf16 v[100:103], a[172:175], a[28:31], v[100:103]
    v_cvt_pk_bf16_f32 v166, v104, v105
    v_mfma_f32_16x16x32_bf16 v[128:131], a[176:179], a[28:31], v[128:131]
    v_cvt_pk_bf16_f32 v167, v106, v107
    v_mfma_f32_16x16x32_bf16 v[44:47], a[184:187], a[24:27], v[44:47]
    s_mov_b32 s48, 294912
    v_mfma_f32_16x16x32_bf16 v[100:103], a[188:191], a[24:27], v[100:103]
    buffer_store_dwordx4 v[164:167], v9, s[20:23], s48 offen offset:0 sc1
    v_mfma_f32_16x16x32_bf16 v[128:131], a[192:195], a[24:27], v[128:131]
    v_sub_f32 v132, v132, v160
    s_waitcnt lgkmcnt(3)
    v_mfma_f32_16x16x32_bf16 v[44:47], a[200:203], a[20:23], v[44:47]
    v_sub_f32 v133, v133, v161
    v_mfma_f32_16x16x32_bf16 v[100:103], a[204:207], a[20:23], v[100:103]
    v_sub_f32 v134, v134, v162
    v_mfma_f32_16x16x32_bf16 v[128:131], a[208:211], a[20:23], v[128:131]
    v_sub_f32 v135, v135, v163
    v_mfma_f32_16x16x32_bf16 v[72:75], a[108:111], a[96:99], v[72:75]
    v_cvt_pk_bf16_f32 v132, v132, v133
    v_mfma_f32_16x16x32_bf16 v[100:103], a[104:107], a[96:99], v[100:103]
    v_cvt_pk_bf16_f32 v133, v134, v135
    v_mfma_f32_16x16x32_bf16 v[156:159], a[116:119], a[96:99], v[156:159]
    ds_write_b64 v10, v[132:133] offset:3072
    v_mfma_f32_16x16x32_bf16 v[72:75], a[124:127], a[92:95], v[72:75]
    v_mfma_f32_16x16x32_bf16 v[100:103], a[120:123], a[92:95], v[100:103]
    v_mfma_f32_16x16x32_bf16 v[156:159], a[132:135], a[92:95], v[156:159]
    v_mfma_f32_16x16x32_bf16 v[72:75], a[140:143], a[88:91], v[72:75]
    s_waitcnt lgkmcnt(0)
    s_barrier
    v_mfma_f32_16x16x32_bf16 v[100:103], a[136:139], a[88:91], v[100:103]
    v_mfma_f32_16x16x32_bf16 v[156:159], a[148:151], a[88:91], v[156:159]
    v_mfma_f32_16x16x32_bf16 v[72:75], a[156:159], a[84:87], v[72:75]
    v_mfma_f32_16x16x32_bf16 v[100:103], a[152:155], a[84:87], v[100:103]
    v_mfma_f32_16x16x32_bf16 v[156:159], a[164:167], a[84:87], v[156:159]
    v_mfma_f32_16x16x32_bf16 v[72:75], a[172:175], a[80:83], v[72:75]
    v_mfma_f32_16x16x32_bf16 v[100:103], a[168:171], a[80:83], v[100:103]
    v_mfma_f32_16x16x32_bf16 v[156:159], a[180:183], a[80:83], v[156:159]
    v_mfma_f32_16x16x32_bf16 v[72:75], a[188:191], a[76:79], v[72:75]
    v_mfma_f32_16x16x32_bf16 v[100:103], a[184:187], a[76:79], v[100:103]
    v_mfma_f32_16x16x32_bf16 v[156:159], a[196:199], a[76:79], v[156:159]
    v_mfma_f32_16x16x32_bf16 v[72:75], a[204:207], a[72:75], v[72:75]
    v_mfma_f32_16x16x32_bf16 v[100:103], a[200:203], a[72:75], v[100:103]
    v_mfma_f32_16x16x32_bf16 v[156:159], a[212:215], a[72:75], v[156:159]
    v_mfma_f32_16x16x32_bf16 v[40:43], a[104:107], a[40:43], v[40:43]
    v_mfma_f32_16x16x32_bf16 v[96:99], a[108:111], a[40:43], v[96:99]
    v_mfma_f32_16x16x32_bf16 v[124:127], a[112:115], a[40:43], v[124:127]
    ds_read_b128 a[12:15], v20 offset:15360
    v_mfma_f32_16x16x32_bf16 v[40:43], a[120:123], a[36:39], v[40:43]
    v_mfma_f32_16x16x32_bf16 v[96:99], a[124:127], a[36:39], v[96:99]
    v_mfma_f32_16x16x32_bf16 v[124:127], a[128:131], a[36:39], v[124:127]
    ds_read_b128 a[64:67], v21 offset:15360
    v_mfma_f32_16x16x32_bf16 v[40:43], a[136:139], a[32:35], v[40:43]
    v_mfma_f32_16x16x32_bf16 v[96:99], a[140:143], a[32:35], v[96:99]
    v_sub_f32 v44, v44, v72
    v_mfma_f32_16x16x32_bf16 v[124:127], a[144:147], a[32:35], v[124:127]
    v_sub_f32 v45, v45, v73
    v_mfma_f32_16x16x32_bf16 v[40:43], a[152:155], a[28:31], v[40:43]
    v_sub_f32 v46, v46, v74
    v_mfma_f32_16x16x32_bf16 v[96:99], a[156:159], a[28:31], v[96:99]
    v_sub_f32 v47, v47, v75
    v_mfma_f32_16x16x32_bf16 v[124:127], a[160:163], a[28:31], v[124:127]
    v_cvt_pk_bf16_f32 v168, v44, v45
    v_mfma_f32_16x16x32_bf16 v[40:43], a[168:171], a[24:27], v[40:43]
    v_cvt_pk_bf16_f32 v169, v46, v47
    v_mfma_f32_16x16x32_bf16 v[96:99], a[172:175], a[24:27], v[96:99]
    v_cvt_pk_bf16_f32 v170, v100, v101
    v_mfma_f32_16x16x32_bf16 v[124:127], a[176:179], a[24:27], v[124:127]
    v_cvt_pk_bf16_f32 v171, v102, v103
    v_mfma_f32_16x16x32_bf16 v[40:43], a[184:187], a[20:23], v[40:43]
    s_mov_b32 s48, 245760
    v_mfma_f32_16x16x32_bf16 v[96:99], a[188:191], a[20:23], v[96:99]
    buffer_store_dwordx4 v[168:171], v9, s[20:23], s48 offen offset:0 sc1
    v_mfma_f32_16x16x32_bf16 v[124:127], a[192:195], a[20:23], v[124:127]
    v_sub_f32 v128, v128, v156
    v_mfma_f32_16x16x32_bf16 v[40:43], a[200:203], a[16:19], v[40:43]
    v_sub_f32 v129, v129, v157
    v_mfma_f32_16x16x32_bf16 v[96:99], a[204:207], a[16:19], v[96:99]
    v_sub_f32 v130, v130, v158
    v_mfma_f32_16x16x32_bf16 v[124:127], a[208:211], a[16:19], v[124:127]
    v_sub_f32 v131, v131, v159
    v_mfma_f32_16x16x32_bf16 v[68:71], a[108:111], a[92:95], v[68:71]
    v_cvt_pk_bf16_f32 v128, v128, v129
    v_mfma_f32_16x16x32_bf16 v[96:99], a[104:107], a[92:95], v[96:99]
    v_cvt_pk_bf16_f32 v129, v130, v131
    v_mfma_f32_16x16x32_bf16 v[152:155], a[116:119], a[92:95], v[152:155]
    v_mfma_f32_16x16x32_bf16 v[68:71], a[124:127], a[88:91], v[68:71]
    v_mfma_f32_16x16x32_bf16 v[96:99], a[120:123], a[88:91], v[96:99]
    v_mfma_f32_16x16x32_bf16 v[152:155], a[132:135], a[88:91], v[152:155]
    v_mfma_f32_16x16x32_bf16 v[68:71], a[140:143], a[84:87], v[68:71]
    s_barrier
    v_mfma_f32_16x16x32_bf16 v[96:99], a[136:139], a[84:87], v[96:99]
    ds_read_b64 v[130:131], v10 offset:2560
    v_mfma_f32_16x16x32_bf16 v[152:155], a[148:151], a[84:87], v[152:155]
    v_mfma_f32_16x16x32_bf16 v[68:71], a[156:159], a[80:83], v[68:71]
    v_mfma_f32_16x16x32_bf16 v[96:99], a[152:155], a[80:83], v[96:99]
    v_mfma_f32_16x16x32_bf16 v[152:155], a[164:167], a[80:83], v[152:155]
    v_mfma_f32_16x16x32_bf16 v[68:71], a[172:175], a[76:79], v[68:71]
    v_mfma_f32_16x16x32_bf16 v[96:99], a[168:171], a[76:79], v[96:99]
    s_mov_b32 s47, 245760
    v_mfma_f32_16x16x32_bf16 v[152:155], a[180:183], a[76:79], v[152:155]
    s_waitcnt lgkmcnt(0)
    buffer_store_dwordx4 v[128:131], v9, s[20:23], s47 offen offset:64 sc1
    v_mfma_f32_16x16x32_bf16 v[68:71], a[188:191], a[72:75], v[68:71]
    v_mfma_f32_16x16x32_bf16 v[96:99], a[184:187], a[72:75], v[96:99]
    v_mfma_f32_16x16x32_bf16 v[152:155], a[196:199], a[72:75], v[152:155]
    v_mfma_f32_16x16x32_bf16 v[68:71], a[204:207], a[68:71], v[68:71]
    v_mfma_f32_16x16x32_bf16 v[96:99], a[200:203], a[68:71], v[96:99]
    v_mfma_f32_16x16x32_bf16 v[152:155], a[212:215], a[68:71], v[152:155]
    v_mfma_f32_16x16x32_bf16 v[36:39], a[104:107], a[36:39], v[36:39]
    v_mfma_f32_16x16x32_bf16 v[92:95], a[108:111], a[36:39], v[92:95]
    v_mfma_f32_16x16x32_bf16 v[120:123], a[112:115], a[36:39], v[120:123]
    ds_read_b128 a[8:11], v20 offset:10240
    v_mfma_f32_16x16x32_bf16 v[36:39], a[120:123], a[32:35], v[36:39]
    v_mfma_f32_16x16x32_bf16 v[92:95], a[124:127], a[32:35], v[92:95]
    v_mfma_f32_16x16x32_bf16 v[120:123], a[128:131], a[32:35], v[120:123]
    ds_read_b128 a[60:63], v21 offset:10240
    v_mfma_f32_16x16x32_bf16 v[36:39], a[136:139], a[28:31], v[36:39]
    v_mfma_f32_16x16x32_bf16 v[92:95], a[140:143], a[28:31], v[92:95]
    v_sub_f32 v40, v40, v68
    v_mfma_f32_16x16x32_bf16 v[120:123], a[144:147], a[28:31], v[120:123]
    v_sub_f32 v41, v41, v69
    v_mfma_f32_16x16x32_bf16 v[36:39], a[152:155], a[24:27], v[36:39]
    v_sub_f32 v42, v42, v70
    v_mfma_f32_16x16x32_bf16 v[92:95], a[156:159], a[24:27], v[92:95]
    v_sub_f32 v43, v43, v71
    v_mfma_f32_16x16x32_bf16 v[120:123], a[160:163], a[24:27], v[120:123]
    v_cvt_pk_bf16_f32 v172, v40, v41
    v_mfma_f32_16x16x32_bf16 v[36:39], a[168:171], a[20:23], v[36:39]
    v_cvt_pk_bf16_f32 v173, v42, v43
    v_mfma_f32_16x16x32_bf16 v[92:95], a[172:175], a[20:23], v[92:95]
    v_cvt_pk_bf16_f32 v174, v96, v97
    v_mfma_f32_16x16x32_bf16 v[120:123], a[176:179], a[20:23], v[120:123]
    v_cvt_pk_bf16_f32 v175, v98, v99
    v_mfma_f32_16x16x32_bf16 v[36:39], a[184:187], a[16:19], v[36:39]
    s_mov_b32 s48, 196608
    v_mfma_f32_16x16x32_bf16 v[92:95], a[188:191], a[16:19], v[92:95]
    buffer_store_dwordx4 v[172:175], v9, s[20:23], s48 offen offset:0 sc1
    v_mfma_f32_16x16x32_bf16 v[120:123], a[192:195], a[16:19], v[120:123]
    v_sub_f32 v124, v124, v152
    v_mfma_f32_16x16x32_bf16 v[36:39], a[200:203], a[12:15], v[36:39]
    v_sub_f32 v125, v125, v153
    v_mfma_f32_16x16x32_bf16 v[92:95], a[204:207], a[12:15], v[92:95]
    v_sub_f32 v126, v126, v154
    v_mfma_f32_16x16x32_bf16 v[120:123], a[208:211], a[12:15], v[120:123]
    v_sub_f32 v127, v127, v155
    v_mfma_f32_16x16x32_bf16 v[64:67], a[108:111], a[88:91], v[64:67]
    v_cvt_pk_bf16_f32 v124, v124, v125
    v_mfma_f32_16x16x32_bf16 v[92:95], a[104:107], a[88:91], v[92:95]
    v_cvt_pk_bf16_f32 v125, v126, v127
    v_mfma_f32_16x16x32_bf16 v[148:151], a[116:119], a[88:91], v[148:151]
    ds_write_b64 v10, v[124:125] offset:2048
    v_mfma_f32_16x16x32_bf16 v[64:67], a[124:127], a[84:87], v[64:67]
    v_mfma_f32_16x16x32_bf16 v[92:95], a[120:123], a[84:87], v[92:95]
    v_mfma_f32_16x16x32_bf16 v[148:151], a[132:135], a[84:87], v[148:151]
    v_mfma_f32_16x16x32_bf16 v[64:67], a[140:143], a[80:83], v[64:67]
    s_waitcnt lgkmcnt(0)
    s_barrier
    v_mfma_f32_16x16x32_bf16 v[92:95], a[136:139], a[80:83], v[92:95]
    v_mfma_f32_16x16x32_bf16 v[148:151], a[148:151], a[80:83], v[148:151]
    v_mfma_f32_16x16x32_bf16 v[64:67], a[156:159], a[76:79], v[64:67]
    v_mfma_f32_16x16x32_bf16 v[92:95], a[152:155], a[76:79], v[92:95]
    v_mfma_f32_16x16x32_bf16 v[148:151], a[164:167], a[76:79], v[148:151]
    v_mfma_f32_16x16x32_bf16 v[64:67], a[172:175], a[72:75], v[64:67]
    v_mfma_f32_16x16x32_bf16 v[92:95], a[168:171], a[72:75], v[92:95]
    v_mfma_f32_16x16x32_bf16 v[148:151], a[180:183], a[72:75], v[148:151]
    v_mfma_f32_16x16x32_bf16 v[64:67], a[188:191], a[68:71], v[64:67]
    v_mfma_f32_16x16x32_bf16 v[92:95], a[184:187], a[68:71], v[92:95]
    v_mfma_f32_16x16x32_bf16 v[148:151], a[196:199], a[68:71], v[148:151]
    v_mfma_f32_16x16x32_bf16 v[64:67], a[204:207], a[64:67], v[64:67]
    v_mfma_f32_16x16x32_bf16 v[92:95], a[200:203], a[64:67], v[92:95]
    v_mfma_f32_16x16x32_bf16 v[148:151], a[212:215], a[64:67], v[148:151]
    v_mfma_f32_16x16x32_bf16 v[32:35], a[104:107], a[32:35], v[32:35]
    v_mfma_f32_16x16x32_bf16 v[88:91], a[108:111], a[32:35], v[88:91]
    v_mfma_f32_16x16x32_bf16 v[116:119], a[112:115], a[32:35], v[116:119]
    ds_read_b128 a[4:7], v20 offset:5120
    v_mfma_f32_16x16x32_bf16 v[32:35], a[120:123], a[28:31], v[32:35]
    v_mfma_f32_16x16x32_bf16 v[88:91], a[124:127], a[28:31], v[88:91]
    v_mfma_f32_16x16x32_bf16 v[116:119], a[128:131], a[28:31], v[116:119]
    ds_read_b128 a[56:59], v21 offset:5120
    v_mfma_f32_16x16x32_bf16 v[32:35], a[136:139], a[24:27], v[32:35]
    v_mfma_f32_16x16x32_bf16 v[88:91], a[140:143], a[24:27], v[88:91]
    v_sub_f32 v36, v36, v64
    v_mfma_f32_16x16x32_bf16 v[116:119], a[144:147], a[24:27], v[116:119]
    v_sub_f32 v37, v37, v65
    v_mfma_f32_16x16x32_bf16 v[32:35], a[152:155], a[20:23], v[32:35]
    v_sub_f32 v38, v38, v66
    v_mfma_f32_16x16x32_bf16 v[88:91], a[156:159], a[20:23], v[88:91]
    v_sub_f32 v39, v39, v67
    v_mfma_f32_16x16x32_bf16 v[116:119], a[160:163], a[20:23], v[116:119]
    v_cvt_pk_bf16_f32 v176, v36, v37
    v_mfma_f32_16x16x32_bf16 v[32:35], a[168:171], a[16:19], v[32:35]
    v_cvt_pk_bf16_f32 v177, v38, v39
    v_mfma_f32_16x16x32_bf16 v[88:91], a[172:175], a[16:19], v[88:91]
    v_cvt_pk_bf16_f32 v178, v92, v93
    v_mfma_f32_16x16x32_bf16 v[116:119], a[176:179], a[16:19], v[116:119]
    v_cvt_pk_bf16_f32 v179, v94, v95
    v_mfma_f32_16x16x32_bf16 v[32:35], a[184:187], a[12:15], v[32:35]
    s_mov_b32 s48, 147456
    v_mfma_f32_16x16x32_bf16 v[88:91], a[188:191], a[12:15], v[88:91]
    buffer_store_dwordx4 v[176:179], v9, s[20:23], s48 offen offset:0 sc1
    v_mfma_f32_16x16x32_bf16 v[116:119], a[192:195], a[12:15], v[116:119]
    v_sub_f32 v120, v120, v148
    v_mfma_f32_16x16x32_bf16 v[32:35], a[200:203], a[8:11], v[32:35]
    v_sub_f32 v121, v121, v149
    v_mfma_f32_16x16x32_bf16 v[88:91], a[204:207], a[8:11], v[88:91]
    v_sub_f32 v122, v122, v150
    v_mfma_f32_16x16x32_bf16 v[116:119], a[208:211], a[8:11], v[116:119]
    v_sub_f32 v123, v123, v151
    v_mfma_f32_16x16x32_bf16 v[60:63], a[108:111], a[84:87], v[60:63]
    v_cvt_pk_bf16_f32 v120, v120, v121
    v_mfma_f32_16x16x32_bf16 v[88:91], a[104:107], a[84:87], v[88:91]
    v_cvt_pk_bf16_f32 v121, v122, v123
    v_mfma_f32_16x16x32_bf16 v[144:147], a[116:119], a[84:87], v[144:147]
    v_mfma_f32_16x16x32_bf16 v[60:63], a[124:127], a[80:83], v[60:63]
    v_mfma_f32_16x16x32_bf16 v[88:91], a[120:123], a[80:83], v[88:91]
    v_mfma_f32_16x16x32_bf16 v[144:147], a[132:135], a[80:83], v[144:147]
    v_mfma_f32_16x16x32_bf16 v[60:63], a[140:143], a[76:79], v[60:63]
    s_barrier
    v_mfma_f32_16x16x32_bf16 v[88:91], a[136:139], a[76:79], v[88:91]
    ds_read_b64 v[122:123], v10 offset:1536
    v_mfma_f32_16x16x32_bf16 v[144:147], a[148:151], a[76:79], v[144:147]
    v_mfma_f32_16x16x32_bf16 v[60:63], a[156:159], a[72:75], v[60:63]
    v_mfma_f32_16x16x32_bf16 v[88:91], a[152:155], a[72:75], v[88:91]
    v_mfma_f32_16x16x32_bf16 v[144:147], a[164:167], a[72:75], v[144:147]
    v_mfma_f32_16x16x32_bf16 v[60:63], a[172:175], a[68:71], v[60:63]
    v_mfma_f32_16x16x32_bf16 v[88:91], a[168:171], a[68:71], v[88:91]
    s_mov_b32 s47, 147456
    v_mfma_f32_16x16x32_bf16 v[144:147], a[180:183], a[68:71], v[144:147]
    s_waitcnt lgkmcnt(0)
    buffer_store_dwordx4 v[120:123], v9, s[20:23], s47 offen offset:64 sc1
    v_mfma_f32_16x16x32_bf16 v[60:63], a[188:191], a[64:67], v[60:63]
    v_mfma_f32_16x16x32_bf16 v[88:91], a[184:187], a[64:67], v[88:91]
    v_mfma_f32_16x16x32_bf16 v[144:147], a[196:199], a[64:67], v[144:147]
    v_mfma_f32_16x16x32_bf16 v[60:63], a[204:207], a[60:63], v[60:63]
    v_mfma_f32_16x16x32_bf16 v[88:91], a[200:203], a[60:63], v[88:91]
    v_mfma_f32_16x16x32_bf16 v[144:147], a[212:215], a[60:63], v[144:147]
    v_mfma_f32_16x16x32_bf16 v[28:31], a[104:107], a[28:31], v[28:31]
    v_mfma_f32_16x16x32_bf16 v[84:87], a[108:111], a[28:31], v[84:87]
    v_mfma_f32_16x16x32_bf16 v[112:115], a[112:115], a[28:31], v[112:115]
    ds_read_b128 a[0:3], v20 offset:0
    v_mfma_f32_16x16x32_bf16 v[28:31], a[120:123], a[24:27], v[28:31]
    v_mfma_f32_16x16x32_bf16 v[84:87], a[124:127], a[24:27], v[84:87]
    v_mfma_f32_16x16x32_bf16 v[112:115], a[128:131], a[24:27], v[112:115]
    ds_read_b128 a[52:55], v21 offset:0
    v_mfma_f32_16x16x32_bf16 v[28:31], a[136:139], a[20:23], v[28:31]
    v_mfma_f32_16x16x32_bf16 v[84:87], a[140:143], a[20:23], v[84:87]
    v_sub_f32 v32, v32, v60
    v_mfma_f32_16x16x32_bf16 v[112:115], a[144:147], a[20:23], v[112:115]
    v_sub_f32 v33, v33, v61
    v_mfma_f32_16x16x32_bf16 v[28:31], a[152:155], a[16:19], v[28:31]
    v_sub_f32 v34, v34, v62
    v_mfma_f32_16x16x32_bf16 v[84:87], a[156:159], a[16:19], v[84:87]
    v_sub_f32 v35, v35, v63
    v_mfma_f32_16x16x32_bf16 v[112:115], a[160:163], a[16:19], v[112:115]
    v_cvt_pk_bf16_f32 v164, v32, v33
    v_mfma_f32_16x16x32_bf16 v[28:31], a[168:171], a[12:15], v[28:31]
    v_cvt_pk_bf16_f32 v165, v34, v35
    v_mfma_f32_16x16x32_bf16 v[84:87], a[172:175], a[12:15], v[84:87]
    v_cvt_pk_bf16_f32 v166, v88, v89
    v_mfma_f32_16x16x32_bf16 v[112:115], a[176:179], a[12:15], v[112:115]
    v_cvt_pk_bf16_f32 v167, v90, v91
    v_mfma_f32_16x16x32_bf16 v[28:31], a[184:187], a[8:11], v[28:31]
    s_mov_b32 s48, 98304
    v_mfma_f32_16x16x32_bf16 v[84:87], a[188:191], a[8:11], v[84:87]
    buffer_store_dwordx4 v[164:167], v9, s[20:23], s48 offen offset:0 sc1
    v_mfma_f32_16x16x32_bf16 v[112:115], a[192:195], a[8:11], v[112:115]
    v_sub_f32 v116, v116, v144
    v_mfma_f32_16x16x32_bf16 v[28:31], a[200:203], a[4:7], v[28:31]
    v_sub_f32 v117, v117, v145
    v_mfma_f32_16x16x32_bf16 v[84:87], a[204:207], a[4:7], v[84:87]
    v_sub_f32 v118, v118, v146
    v_mfma_f32_16x16x32_bf16 v[112:115], a[208:211], a[4:7], v[112:115]
    v_sub_f32 v119, v119, v147
    v_mfma_f32_16x16x32_bf16 v[56:59], a[108:111], a[80:83], v[56:59]
    v_cvt_pk_bf16_f32 v116, v116, v117
    v_mfma_f32_16x16x32_bf16 v[84:87], a[104:107], a[80:83], v[84:87]
    v_cvt_pk_bf16_f32 v117, v118, v119
    v_mfma_f32_16x16x32_bf16 v[140:143], a[116:119], a[80:83], v[140:143]
    ds_write_b64 v10, v[116:117] offset:1024
    v_mfma_f32_16x16x32_bf16 v[56:59], a[124:127], a[76:79], v[56:59]
    v_mfma_f32_16x16x32_bf16 v[84:87], a[120:123], a[76:79], v[84:87]
    v_mfma_f32_16x16x32_bf16 v[140:143], a[132:135], a[76:79], v[140:143]
    v_mfma_f32_16x16x32_bf16 v[56:59], a[140:143], a[72:75], v[56:59]
    s_waitcnt lgkmcnt(0)
    s_barrier
    v_mfma_f32_16x16x32_bf16 v[84:87], a[136:139], a[72:75], v[84:87]
    v_mfma_f32_16x16x32_bf16 v[140:143], a[148:151], a[72:75], v[140:143]
    v_mfma_f32_16x16x32_bf16 v[56:59], a[156:159], a[68:71], v[56:59]
    v_mfma_f32_16x16x32_bf16 v[84:87], a[152:155], a[68:71], v[84:87]
    v_mfma_f32_16x16x32_bf16 v[140:143], a[164:167], a[68:71], v[140:143]
    v_mfma_f32_16x16x32_bf16 v[56:59], a[172:175], a[64:67], v[56:59]
    v_mfma_f32_16x16x32_bf16 v[84:87], a[168:171], a[64:67], v[84:87]
    v_mfma_f32_16x16x32_bf16 v[140:143], a[180:183], a[64:67], v[140:143]
    v_mfma_f32_16x16x32_bf16 v[56:59], a[188:191], a[60:63], v[56:59]
    v_mfma_f32_16x16x32_bf16 v[84:87], a[184:187], a[60:63], v[84:87]
    v_mfma_f32_16x16x32_bf16 v[140:143], a[196:199], a[60:63], v[140:143]
    v_mfma_f32_16x16x32_bf16 v[56:59], a[204:207], a[56:59], v[56:59]
    v_mfma_f32_16x16x32_bf16 v[84:87], a[200:203], a[56:59], v[84:87]
    v_mfma_f32_16x16x32_bf16 v[140:143], a[212:215], a[56:59], v[140:143]
    v_mfma_f32_16x16x32_bf16 v[108:111], a[112:115], a[24:27], v[108:111]
    v_mfma_f32_16x16x32_bf16 v[136:139], a[116:119], a[76:79], v[136:139]
    v_mfma_f32_16x16x32_bf16 v[108:111], a[128:131], a[20:23], v[108:111]
    v_mfma_f32_16x16x32_bf16 v[136:139], a[132:135], a[72:75], v[136:139]
    v_mfma_f32_16x16x32_bf16 v[108:111], a[144:147], a[16:19], v[108:111]
    v_mfma_f32_16x16x32_bf16 v[136:139], a[148:151], a[68:71], v[136:139]
    v_mfma_f32_16x16x32_bf16 v[108:111], a[160:163], a[12:15], v[108:111]
    v_mfma_f32_16x16x32_bf16 v[136:139], a[164:167], a[64:67], v[136:139]
    v_sub_f32 v28, v28, v56
    v_mfma_f32_16x16x32_bf16 v[108:111], a[176:179], a[8:11], v[108:111]
    v_sub_f32 v29, v29, v57
    v_mfma_f32_16x16x32_bf16 v[136:139], a[180:183], a[60:63], v[136:139]
    v_sub_f32 v30, v30, v58
    v_mfma_f32_16x16x32_bf16 v[108:111], a[192:195], a[4:7], v[108:111]
    v_sub_f32 v31, v31, v59
    v_mfma_f32_16x16x32_bf16 v[136:139], a[196:199], a[56:59], v[136:139]
    v_cvt_pk_bf16_f32 v168, v28, v29
    v_mfma_f32_16x16x32_bf16 v[108:111], a[208:211], a[0:3], v[108:111]
    v_cvt_pk_bf16_f32 v169, v30, v31
    v_mfma_f32_16x16x32_bf16 v[136:139], a[212:215], a[52:55], v[136:139]
    v_cvt_pk_bf16_f32 v170, v84, v85
    v_mfma_f32_16x16x32_bf16 v[24:27], a[104:107], a[24:27], v[24:27]
    v_cvt_pk_bf16_f32 v171, v86, v87
    v_mfma_f32_16x16x32_bf16 v[80:83], a[108:111], a[24:27], v[80:83]
    s_mov_b32 s48, 49152
    v_mfma_f32_16x16x32_bf16 v[24:27], a[120:123], a[20:23], v[24:27]
    buffer_store_dwordx4 v[168:171], v9, s[20:23], s48 offen offset:0 sc1
    v_mfma_f32_16x16x32_bf16 v[80:83], a[124:127], a[20:23], v[80:83]
    v_sub_f32 v112, v112, v140
    v_mfma_f32_16x16x32_bf16 v[24:27], a[136:139], a[16:19], v[24:27]
    v_sub_f32 v113, v113, v141
    v_mfma_f32_16x16x32_bf16 v[80:83], a[140:143], a[16:19], v[80:83]
    v_sub_f32 v114, v114, v142
    v_mfma_f32_16x16x32_bf16 v[24:27], a[152:155], a[12:15], v[24:27]
    v_sub_f32 v115, v115, v143
    v_mfma_f32_16x16x32_bf16 v[80:83], a[156:159], a[12:15], v[80:83]
    v_cvt_pk_bf16_f32 v112, v112, v113
    v_sub_f32 v108, v108, v136
    v_mfma_f32_16x16x32_bf16 v[24:27], a[168:171], a[8:11], v[24:27]
    v_cvt_pk_bf16_f32 v113, v114, v115
    v_sub_f32 v109, v109, v137
    v_mfma_f32_16x16x32_bf16 v[80:83], a[172:175], a[8:11], v[80:83]
    v_sub_f32 v110, v110, v138
    v_mfma_f32_16x16x32_bf16 v[24:27], a[184:187], a[4:7], v[24:27]
    v_sub_f32 v111, v111, v139
    v_mfma_f32_16x16x32_bf16 v[80:83], a[188:191], a[4:7], v[80:83]
    v_cvt_pk_bf16_f32 v108, v108, v109
    v_mfma_f32_16x16x32_bf16 v[24:27], a[200:203], a[0:3], v[24:27]
    v_cvt_pk_bf16_f32 v109, v110, v111
    v_mfma_f32_16x16x32_bf16 v[80:83], a[204:207], a[0:3], v[80:83]
    s_barrier
    ds_write_b64 v10, v[108:109] offset:0
    v_mfma_f32_16x16x32_bf16 v[52:55], a[108:111], a[76:79], v[52:55]
    ds_read_b64 v[114:115], v10 offset:512
    v_mfma_f32_16x16x32_bf16 v[80:83], a[104:107], a[76:79], v[80:83]
    v_mfma_f32_16x16x32_bf16 v[52:55], a[124:127], a[72:75], v[52:55]
    v_mfma_f32_16x16x32_bf16 v[80:83], a[120:123], a[72:75], v[80:83]
    s_waitcnt lgkmcnt(1)
    s_barrier
    v_mfma_f32_16x16x32_bf16 v[52:55], a[140:143], a[68:71], v[52:55]
    v_mfma_f32_16x16x32_bf16 v[80:83], a[136:139], a[68:71], v[80:83]
    v_mfma_f32_16x16x32_bf16 v[52:55], a[156:159], a[64:67], v[52:55]
    s_mov_b32 s47, 49152
    v_mfma_f32_16x16x32_bf16 v[80:83], a[152:155], a[64:67], v[80:83]
    s_waitcnt lgkmcnt(0)
    buffer_store_dwordx4 v[112:115], v9, s[20:23], s47 offen offset:64 sc1
    v_mfma_f32_16x16x32_bf16 v[52:55], a[172:175], a[60:63], v[52:55]
    v_mfma_f32_16x16x32_bf16 v[80:83], a[168:171], a[60:63], v[80:83]
    v_mfma_f32_16x16x32_bf16 v[52:55], a[188:191], a[56:59], v[52:55]
    v_mfma_f32_16x16x32_bf16 v[80:83], a[184:187], a[56:59], v[80:83]
    v_mfma_f32_16x16x32_bf16 v[52:55], a[204:207], a[52:55], v[52:55]
    v_mfma_f32_16x16x32_bf16 v[80:83], a[200:203], a[52:55], v[80:83]
    s_nop 6
    v_sub_f32 v24, v24, v52
    v_sub_f32 v25, v25, v53
    v_sub_f32 v26, v26, v54
    v_sub_f32 v27, v27, v55
    v_cvt_pk_bf16_f32 v172, v24, v25
    v_cvt_pk_bf16_f32 v173, v26, v27
    v_cvt_pk_bf16_f32 v174, v80, v81
    v_cvt_pk_bf16_f32 v175, v82, v83
    s_mov_b32 s48, 0
    buffer_store_dwordx4 v[172:175], v9, s[20:23], s48 offen offset:0 sc1
    s_endpgm
K2_q1:
    s_waitcnt vmcnt(17)
    s_barrier
    ds_read_b128 a[48:51], v14 offset:25600
    ds_read_b128 a[100:103], v15 offset:25600
    ds_read_b128 a[44:47], v14 offset:20480
    ds_read_b128 a[96:99], v15 offset:20480
    ds_read_b128 a[40:43], v14 offset:15360
    ds_read_b128 a[92:95], v15 offset:15360
    s_waitcnt vmcnt(15)
    s_waitcnt lgkmcnt(5)
    v_mfma_f32_16x16x32_bf16 v[48:51], a[108:111], a[48:51], 0
    s_add_u32 s47, s45, 18432
    s_waitcnt vmcnt(14)
    v_mfma_f32_16x16x32_bf16 v[76:79], a[112:115], a[48:51], 0
    buffer_load_dwordx4 a[152:155], v4, s[16:19], s47 offen offset:0
    s_waitcnt vmcnt(14)
    v_mfma_f32_16x16x32_bf16 v[132:135], a[116:119], a[48:51], 0
    s_waitcnt lgkmcnt(4)
    v_mfma_f32_16x16x32_bf16 v[132:135], a[112:115], a[100:103], v[132:135]
    buffer_load_dwordx4 a[156:159], v4, s[16:19], s47 offen offset:1024
    v_mfma_f32_16x16x32_bf16 v[104:107], a[116:119], a[100:103], 0
    v_mfma_f32_16x16x32_bf16 v[48:51], a[104:107], a[100:103], v[48:51]
    buffer_load_dwordx4 a[160:163], v4, s[16:19], s47 offen offset:2048
    s_waitcnt lgkmcnt(2)
    v_mfma_f32_16x16x32_bf16 v[44:47], a[104:107], a[96:99], 0
    v_mfma_f32_16x16x32_bf16 v[100:103], a[116:119], a[96:99], 0
    buffer_load_dwordx4 a[164:167], v4, s[16:19], s47 offen offset:3072
    v_mfma_f32_16x16x32_bf16 v[128:131], a[112:115], a[96:99], 0
    v_mfma_f32_16x16x32_bf16 v[128:131], a[116:119], a[44:47], v[128:131]
    s_waitcnt vmcnt(12)
    s_barrier
    s_add_u32 s47, s45, 43008
    v_mfma_f32_16x16x32_bf16 v[72:75], a[112:115], a[44:47], 0
    ds_read_b128 a[88:91], v15 offset:10240
    ds_read_b128 a[36:39], v14 offset:10240
    buffer_load_dwordx4 a[216:219], v4, s[16:19], s47 offen offset:0
    v_mfma_f32_16x16x32_bf16 v[44:47], a[108:111], a[44:47], v[44:47]
    ds_read_b128 a[84:87], v15 offset:5120
    ds_read_b128 a[32:35], v14 offset:5120
    s_waitcnt lgkmcnt(5)
    v_mfma_f32_16x16x32_bf16 v[40:43], a[108:111], a[40:43], 0
    ds_read_b128 a[80:83], v15 offset:0
    ds_read_b128 a[28:31], v14 offset:0
    buffer_load_dwordx4 a[220:223], v4, s[16:19], s47 offen offset:1024
    v_mfma_f32_16x16x32_bf16 v[68:71], a[112:115], a[40:43], 0
    ds_read_b128 a[76:79], v13 offset:30720
    ds_read_b128 a[24:27], v12 offset:30720
    v_mfma_f32_16x16x32_bf16 v[124:127], a[116:119], a[40:43], 0
    buffer_load_dwordx4 a[224:227], v4, s[16:19], s47 offen offset:2048
    s_waitcnt lgkmcnt(8)
    v_mfma_f32_16x16x32_bf16 v[124:127], a[112:115], a[92:95], v[124:127]
    v_mfma_f32_16x16x32_bf16 v[96:99], a[116:119], a[92:95], 0
    buffer_load_dwordx4 a[228:231], v4, s[16:19], s47 offen offset:3072
    v_mfma_f32_16x16x32_bf16 v[40:43], a[104:107], a[92:95], v[40:43]
    s_waitcnt lgkmcnt(7)
    v_mfma_f32_16x16x32_bf16 v[36:39], a[104:107], a[88:91], 0
    v_mfma_f32_16x16x32_bf16 v[92:95], a[116:119], a[88:91], 0
    ds_read_b128 a[20:23], v12 offset:25600
    v_mfma_f32_16x16x32_bf16 v[120:123], a[112:115], a[88:91], 0
    s_waitcnt lgkmcnt(7)
    v_mfma_f32_16x16x32_bf16 v[120:123], a[116:119], a[36:39], v[120:123]
    ds_read_b128 a[72:75], v13 offset:25600
    v_mfma_f32_16x16x32_bf16 v[64:67], a[112:115], a[36:39], 0
    v_mfma_f32_16x16x32_bf16 v[36:39], a[108:111], a[36:39], v[36:39]
    s_waitcnt lgkmcnt(6)
    v_mfma_f32_16x16x32_bf16 v[32:35], a[108:111], a[32:35], 0
    v_mfma_f32_16x16x32_bf16 v[60:63], a[112:115], a[32:35], 0
    s_add_u32 m0, s42, 61440
    s_add_u32 s46, s43, 249856
    buffer_load_dwordx4 v3, s[12:15], s46 offen lds
    v_mfma_f32_16x16x32_bf16 v[116:119], a[116:119], a[32:35], 0
    v_mfma_f32_16x16x32_bf16 v[116:119], a[112:115], a[84:87], v[116:119]
    v_mfma_f32_16x16x32_bf16 v[88:91], a[116:119], a[84:87], 0
    v_mfma_f32_16x16x32_bf16 v[32:35], a[104:107], a[84:87], v[32:35]
    s_waitcnt lgkmcnt(5)
    v_mfma_f32_16x16x32_bf16 v[28:31], a[104:107], a[80:83], 0
    s_add_u32 m0, s42, 56320
    s_add_u32 s46, s43, 200704
    buffer_load_dwordx4 v3, s[12:15], s46 offen lds
    v_mfma_f32_16x16x32_bf16 v[84:87], a[116:119], a[80:83], 0
    v_mfma_f32_16x16x32_bf16 v[112:115], a[112:115], a[80:83], 0
    s_waitcnt lgkmcnt(4)
    v_mfma_f32_16x16x32_bf16 v[112:115], a[116:119], a[28:31], v[112:115]
    v_mfma_f32_16x16x32_bf16 v[56:59], a[112:115], a[28:31], 0
    v_mfma_f32_16x16x32_bf16 v[28:31], a[108:111], a[28:31], v[28:31]
    s_add_u32 m0, s42, 51200
    s_add_u32 s46, s43, 151552
    buffer_load_dwordx4 v3, s[12:15], s46 offen lds
    s_waitcnt lgkmcnt(2)
    v_mfma_f32_16x16x32_bf16 v[24:27], a[108:111], a[24:27], 0
    v_mfma_f32_16x16x32_bf16 v[52:55], a[112:115], a[24:27], 0
    v_mfma_f32_16x16x32_bf16 v[108:111], a[116:119], a[24:27], 0
    v_mfma_f32_16x16x32_bf16 v[108:111], a[112:115], a[76:79], v[108:111]
    v_mfma_f32_16x16x32_bf16 v[80:83], a[116:119], a[76:79], 0
    v_mfma_f32_16x16x32_bf16 v[24:27], a[104:107], a[76:79], v[24:27]
    s_waitcnt vmcnt(17)
    v_mfma_f32_16x16x32_bf16 v[48:51], a[124:127], a[44:47], v[48:51]
    s_add_u32 s47, s45, 24576
    s_waitcnt vmcnt(16)
    v_mfma_f32_16x16x32_bf16 v[76:79], a[128:131], a[44:47], v[76:79]
    buffer_load_dwordx4 a[168:171], v4, s[16:19], s47 offen offset:0
    s_waitcnt vmcnt(16)
    v_mfma_f32_16x16x32_bf16 v[132:135], a[132:135], a[44:47], v[132:135]
    v_mfma_f32_16x16x32_bf16 v[132:135], a[128:131], a[96:99], v[132:135]
    buffer_load_dwordx4 a[172:175], v4, s[16:19], s47 offen offset:1024
    v_mfma_f32_16x16x32_bf16 v[104:107], a[132:135], a[96:99], v[104:107]
    v_mfma_f32_16x16x32_bf16 v[48:51], a[120:123], a[96:99], v[48:51]
    buffer_load_dwordx4 a[176:179], v4, s[16:19], s47 offen offset:2048
    v_mfma_f32_16x16x32_bf16 v[44:47], a[120:123], a[92:95], v[44:47]
    v_mfma_f32_16x16x32_bf16 v[100:103], a[132:135], a[92:95], v[100:103]
    buffer_load_dwordx4 a[180:183], v4, s[16:19], s47 offen offset:3072
    v_mfma_f32_16x16x32_bf16 v[128:131], a[128:131], a[92:95], v[128:131]
    v_mfma_f32_16x16x32_bf16 v[128:131], a[132:135], a[40:43], v[128:131]
    s_add_u32 s47, s45, 49152
    v_mfma_f32_16x16x32_bf16 v[72:75], a[128:131], a[40:43], v[72:75]
    buffer_load_dwordx4 a[232:235], v4, s[16:19], s47 offen offset:0
    v_mfma_f32_16x16x32_bf16 v[44:47], a[124:127], a[40:43], v[44:47]
    v_mfma_f32_16x16x32_bf16 v[40:43], a[124:127], a[36:39], v[40:43]
    buffer_load_dwordx4 a[236:239], v4, s[16:19], s47 offen offset:1024
    v_mfma_f32_16x16x32_bf16 v[68:71], a[128:131], a[36:39], v[68:71]
    v_mfma_f32_16x16x32_bf16 v[124:127], a[132:135], a[36:39], v[124:127]
    buffer_load_dwordx4 a[240:243], v4, s[16:19], s47 offen offset:2048
    v_mfma_f32_16x16x32_bf16 v[124:127], a[128:131], a[88:91], v[124:127]
    v_mfma_f32_16x16x32_bf16 v[96:99], a[132:135], a[88:91], v[96:99]
    buffer_load_dwordx4 a[244:247], v4, s[16:19], s47 offen offset:3072
    v_mfma_f32_16x16x32_bf16 v[40:43], a[120:123], a[88:91], v[40:43]
    v_mfma_f32_16x16x32_bf16 v[36:39], a[120:123], a[84:87], v[36:39]
    v_mfma_f32_16x16x32_bf16 v[92:95], a[132:135], a[84:87], v[92:95]
    ds_read_b128 a[16:19], v12 offset:20480
    v_mfma_f32_16x16x32_bf16 v[120:123], a[128:131], a[84:87], v[120:123]
    v_mfma_f32_16x16x32_bf16 v[120:123], a[132:135], a[32:35], v[120:123]
    ds_read_b128 a[68:71], v13 offset:20480
    v_mfma_f32_16x16x32_bf16 v[64:67], a[128:131], a[32:35], v[64:67]
    v_mfma_f32_16x16x32_bf16 v[36:39], a[124:127], a[32:35], v[36:39]
    v_mfma_f32_16x16x32_bf16 v[32:35], a[124:127], a[28:31], v[32:35]
    v_mfma_f32_16x16x32_bf16 v[60:63], a[128:131], a[28:31], v[60:63]
    s_add_u32 m0, s50, 35840
    s_add_u32 s46, s40, 4096
    buffer_load_dwordx4 v3, s[12:15], s46 offen lds
    v_mfma_f32_16x16x32_bf16 v[116:119], a[132:135], a[28:31], v[116:119]
    v_mfma_f32_16x16x32_bf16 v[116:119], a[128:131], a[80:83], v[116:119]
    v_mfma_f32_16x16x32_bf16 v[88:91], a[132:135], a[80:83], v[88:91]
    v_mfma_f32_16x16x32_bf16 v[32:35], a[120:123], a[80:83], v[32:35]
    v_mfma_f32_16x16x32_bf16 v[28:31], a[120:123], a[76:79], v[28:31]
    s_add_u32 m0, s42, 46080
    s_add_u32 s46, s43, 102400
    buffer_load_dwordx4 v3, s[12:15], s46 offen lds
    v_mfma_f32_16x16x32_bf16 v[84:87], a[132:135], a[76:79], v[84:87]
    v_mfma_f32_16x16x32_bf16 v[112:115], a[128:131], a[76:79], v[112:115]
    v_mfma_f32_16x16x32_bf16 v[112:115], a[132:135], a[24:27], v[112:115]
    v_mfma_f32_16x16x32_bf16 v[56:59], a[128:131], a[24:27], v[56:59]
    v_mfma_f32_16x16x32_bf16 v[28:31], a[124:127], a[24:27], v[28:31]
    s_waitcnt lgkmcnt(3)
    v_mfma_f32_16x16x32_bf16 v[24:27], a[124:127], a[20:23], v[24:27]
    v_mfma_f32_16x16x32_bf16 v[52:55], a[128:131], a[20:23], v[52:55]
    v_mfma_f32_16x16x32_bf16 v[108:111], a[132:135], a[20:23], v[108:111]
    s_waitcnt lgkmcnt(2)
    v_mfma_f32_16x16x32_bf16 v[108:111], a[128:131], a[72:75], v[108:111]
    v_mfma_f32_16x16x32_bf16 v[80:83], a[132:135], a[72:75], v[80:83]
    v_mfma_f32_16x16x32_bf16 v[24:27], a[120:123], a[72:75], v[24:27]
    s_waitcnt vmcnt(23)
    v_mfma_f32_16x16x32_bf16 v[48:51], a[140:143], a[40:43], v[48:51]
    s_add_u32 s47, s45, 30720
    s_waitcnt vmcnt(22)
    v_mfma_f32_16x16x32_bf16 v[76:79], a[144:147], a[40:43], v[76:79]
    buffer_load_dwordx4 a[184:187], v4, s[16:19], s47 offen offset:0
    s_waitcnt vmcnt(22)
    v_mfma_f32_16x16x32_bf16 v[132:135], a[148:151], a[40:43], v[132:135]
    v_mfma_f32_16x16x32_bf16 v[132:135], a[144:147], a[92:95], v[132:135]
    buffer_load_dwordx4 a[188:191], v4, s[16:19], s47 offen offset:1024
    v_mfma_f32_16x16x32_bf16 v[104:107], a[148:151], a[92:95], v[104:107]
    v_mfma_f32_16x16x32_bf16 v[48:51], a[136:139], a[92:95], v[48:51]
    buffer_load_dwordx4 a[192:195], v4, s[16:19], s47 offen offset:2048
    v_mfma_f32_16x16x32_bf16 v[44:47], a[136:139], a[88:91], v[44:47]
    v_mfma_f32_16x16x32_bf16 v[100:103], a[148:151], a[88:91], v[100:103]
    buffer_load_dwordx4 a[196:199], v4, s[16:19], s47 offen offset:3072
    v_mfma_f32_16x16x32_bf16 v[128:131], a[144:147], a[88:91], v[128:131]
    v_mfma_f32_16x16x32_bf16 v[128:131], a[148:151], a[36:39], v[128:131]
    s_add_u32 s47, s45, 55296
    v_mfma_f32_16x16x32_bf16 v[72:75], a[144:147], a[36:39], v[72:75]
    buffer_load_dwordx4 a[248:251], v4, s[16:19], s47 offen offset:0
    v_mfma_f32_16x16x32_bf16 v[44:47], a[140:143], a[36:39], v[44:47]
    v_mfma_f32_16x16x32_bf16 v[40:43], a[140:143], a[32:35], v[40:43]
    buffer_load_dwordx4 a[252:255], v4, s[16:19], s47 offen offset:1024
    v_mfma_f32_16x16x32_bf16 v[68:71], a[144:147], a[32:35], v[68:71]
    v_mfma_f32_16x16x32_bf16 v[124:127], a[148:151], a[32:35], v[124:127]
    buffer_load_dwordx4 v[180:183], v4, s[16:19], s47 offen offset:2048
    v_mfma_f32_16x16x32_bf16 v[124:127], a[144:147], a[84:87], v[124:127]
    v_mfma_f32_16x16x32_bf16 v[96:99], a[148:151], a[84:87], v[96:99]
    buffer_load_dwordx4 v[184:187], v4, s[16:19], s47 offen offset:3072
    v_mfma_f32_16x16x32_bf16 v[40:43], a[136:139], a[84:87], v[40:43]
    v_mfma_f32_16x16x32_bf16 v[36:39], a[136:139], a[80:83], v[36:39]
    v_mfma_f32_16x16x32_bf16 v[92:95], a[148:151], a[80:83], v[92:95]
    ds_read_b128 a[12:15], v12 offset:15360
    v_mfma_f32_16x16x32_bf16 v[120:123], a[144:147], a[80:83], v[120:123]
    v_mfma_f32_16x16x32_bf16 v[120:123], a[148:151], a[28:31], v[120:123]
    ds_read_b128 a[64:67], v13 offset:15360
    v_mfma_f32_16x16x32_bf16 v[64:67], a[144:147], a[28:31], v[64:67]
    v_mfma_f32_16x16x32_bf16 v[36:39], a[140:143], a[28:31], v[36:39]
    v_mfma_f32_16x16x32_bf16 v[32:35], a[140:143], a[24:27], v[32:35]
    v_mfma_f32_16x16x32_bf16 v[60:63], a[144:147], a[24:27], v[60:63]
    s_add_u32 m0, s42, 40960
    s_add_u32 s46, s43, 53248
    buffer_load_dwordx4 v3, s[12:15], s46 offen lds
    v_mfma_f32_16x16x32_bf16 v[116:119], a[148:151], a[24:27], v[116:119]
    v_mfma_f32_16x16x32_bf16 v[116:119], a[144:147], a[76:79], v[116:119]
    v_mfma_f32_16x16x32_bf16 v[88:91], a[148:151], a[76:79], v[88:91]
    v_mfma_f32_16x16x32_bf16 v[32:35], a[136:139], a[76:79], v[32:35]
    v_mfma_f32_16x16x32_bf16 v[28:31], a[136:139], a[72:75], v[28:31]
    s_add_u32 m0, s42, 35840
    s_add_u32 s46, s43, 4096
    buffer_load_dwordx4 v3, s[12:15], s46 offen lds
    v_mfma_f32_16x16x32_bf16 v[84:87], a[148:151], a[72:75], v[84:87]
    v_mfma_f32_16x16x32_bf16 v[112:115], a[144:147], a[72:75], v[112:115]
    v_mfma_f32_16x16x32_bf16 v[112:115], a[148:151], a[20:23], v[112:115]
    v_mfma_f32_16x16x32_bf16 v[56:59], a[144:147], a[20:23], v[56:59]
    v_mfma_f32_16x16x32_bf16 v[28:31], a[140:143], a[20:23], v[28:31]
    s_waitcnt lgkmcnt(3)
    v_mfma_f32_16x16x32_bf16 v[24:27], a[140:143], a[16:19], v[24:27]
    v_mfma_f32_16x16x32_bf16 v[52:55], a[144:147], a[16:19], v[52:55]
    v_mfma_f32_16x16x32_bf16 v[108:111], a[148:151], a[16:19], v[108:111]
    s_waitcnt lgkmcnt(2)
    v_mfma_f32_16x16x32_bf16 v[108:111], a[144:147], a[68:71], v[108:111]
    v_mfma_f32_16x16x32_bf16 v[80:83], a[148:151], a[68:71], v[80:83]
    v_mfma_f32_16x16x32_bf16 v[24:27], a[136:139], a[68:71], v[24:27]
    s_waitcnt vmcnt(29)
    v_mfma_f32_16x16x32_bf16 v[48:51], a[156:159], a[36:39], v[48:51]
    s_add_u32 s47, s45, 36864
    s_waitcnt vmcnt(28)
    v_mfma_f32_16x16x32_bf16 v[76:79], a[160:163], a[36:39], v[76:79]
    buffer_load_dwordx4 a[200:203], v4, s[16:19], s47 offen offset:0
    s_waitcnt vmcnt(28)
    v_mfma_f32_16x16x32_bf16 v[132:135], a[164:167], a[36:39], v[132:135]
    v_mfma_f32_16x16x32_bf16 v[132:135], a[160:163], a[88:91], v[132:135]
    buffer_load_dwordx4 a[204:207], v4, s[16:19], s47 offen offset:1024
    v_mfma_f32_16x16x32_bf16 v[104:107], a[164:167], a[88:91], v[104:107]
    v_mfma_f32_16x16x32_bf16 v[48:51], a[152:155], a[88:91], v[48:51]
    buffer_load_dwordx4 a[208:211], v4, s[16:19], s47 offen offset:2048
    v_mfma_f32_16x16x32_bf16 v[44:47], a[152:155], a[84:87], v[44:47]
    v_mfma_f32_16x16x32_bf16 v[100:103], a[164:167], a[84:87], v[100:103]
    buffer_load_dwordx4 a[212:215], v4, s[16:19], s47 offen offset:3072
    v_mfma_f32_16x16x32_bf16 v[128:131], a[160:163], a[84:87], v[128:131]
    v_mfma_f32_16x16x32_bf16 v[128:131], a[164:167], a[32:35], v[128:131]
    s_add_u32 s47, s45, 61440
    v_mfma_f32_16x16x32_bf16 v[72:75], a[160:163], a[32:35], v[72:75]
    buffer_load_dwordx4 v[188:191], v4, s[16:19], s47 offen offset:0
    v_mfma_f32_16x16x32_bf16 v[44:47], a[156:159], a[32:35], v[44:47]
    v_mfma_f32_16x16x32_bf16 v[40:43], a[156:159], a[28:31], v[40:43]
    buffer_load_dwordx4 v[192:195], v4, s[16:19], s47 offen offset:1024
    v_mfma_f32_16x16x32_bf16 v[68:71], a[160:163], a[28:31], v[68:71]
    v_mfma_f32_16x16x32_bf16 v[124:127], a[164:167], a[28:31], v[124:127]
    buffer_load_dwordx4 v[196:199], v4, s[16:19], s47 offen offset:2048
    v_mfma_f32_16x16x32_bf16 v[124:127], a[160:163], a[80:83], v[124:127]
    v_mfma_f32_16x16x32_bf16 v[96:99], a[164:167], a[80:83], v[96:99]
    buffer_load_dwordx4 v[200:203], v4, s[16:19], s47 offen offset:3072
    v_mfma_f32_16x16x32_bf16 v[40:43], a[152:155], a[80:83], v[40:43]
    v_mfma_f32_16x16x32_bf16 v[36:39], a[152:155], a[76:79], v[36:39]
    v_mfma_f32_16x16x32_bf16 v[92:95], a[164:167], a[76:79], v[92:95]
    ds_read_b128 a[8:11], v12 offset:10240
    v_mfma_f32_16x16x32_bf16 v[120:123], a[160:163], a[76:79], v[120:123]
    v_mfma_f32_16x16x32_bf16 v[120:123], a[164:167], a[24:27], v[120:123]
    ds_read_b128 a[60:63], v13 offset:10240
    v_mfma_f32_16x16x32_bf16 v[64:67], a[160:163], a[24:27], v[64:67]
    v_mfma_f32_16x16x32_bf16 v[36:39], a[156:159], a[24:27], v[36:39]
    v_mfma_f32_16x16x32_bf16 v[32:35], a[156:159], a[20:23], v[32:35]
    v_mfma_f32_16x16x32_bf16 v[60:63], a[160:163], a[20:23], v[60:63]
    s_add_u32 m0, s42, 66560
    s_add_u32 s46, s43, 299008
    buffer_load_dwordx4 v3, s[12:15], s46 offen lds
    v_mfma_f32_16x16x32_bf16 v[116:119], a[164:167], a[20:23], v[116:119]
    v_mfma_f32_16x16x32_bf16 v[116:119], a[160:163], a[72:75], v[116:119]
    v_mfma_f32_16x16x32_bf16 v[88:91], a[164:167], a[72:75], v[88:91]
    v_mfma_f32_16x16x32_bf16 v[32:35], a[152:155], a[72:75], v[32:35]
    v_mfma_f32_16x16x32_bf16 v[28:31], a[152:155], a[68:71], v[28:31]
    s_add_u32 m0, s51, 35840
    s_add_u32 s46, s41, 4096
    buffer_load_dwordx4 v3, s[12:15], s46 offen lds
    v_mfma_f32_16x16x32_bf16 v[84:87], a[164:167], a[68:71], v[84:87]
    v_mfma_f32_16x16x32_bf16 v[112:115], a[160:163], a[68:71], v[112:115]
    v_mfma_f32_16x16x32_bf16 v[112:115], a[164:167], a[16:19], v[112:115]
    v_mfma_f32_16x16x32_bf16 v[56:59], a[160:163], a[16:19], v[56:59]
    v_mfma_f32_16x16x32_bf16 v[28:31], a[156:159], a[16:19], v[28:31]
    s_waitcnt lgkmcnt(3)
    v_mfma_f32_16x16x32_bf16 v[24:27], a[156:159], a[12:15], v[24:27]
    v_mfma_f32_16x16x32_bf16 v[52:55], a[160:163], a[12:15], v[52:55]
    v_mfma_f32_16x16x32_bf16 v[108:111], a[164:167], a[12:15], v[108:111]
    s_waitcnt lgkmcnt(2)
    v_mfma_f32_16x16x32_bf16 v[108:111], a[160:163], a[64:67], v[108:111]
    v_mfma_f32_16x16x32_bf16 v[80:83], a[164:167], a[64:67], v[80:83]
    v_mfma_f32_16x16x32_bf16 v[24:27], a[152:155], a[64:67], v[24:27]
    s_waitcnt vmcnt(28)
    v_mfma_f32_16x16x32_bf16 v[48:51], a[172:175], a[32:35], v[48:51]
    s_waitcnt vmcnt(27)
    v_mfma_f32_16x16x32_bf16 v[76:79], a[176:179], a[32:35], v[76:79]
    s_waitcnt vmcnt(26)
    v_mfma_f32_16x16x32_bf16 v[132:135], a[180:183], a[32:35], v[132:135]
    v_mfma_f32_16x16x32_bf16 v[132:135], a[176:179], a[84:87], v[132:135]
    v_mfma_f32_16x16x32_bf16 v[104:107], a[180:183], a[84:87], v[104:107]
    v_mfma_f32_16x16x32_bf16 v[48:51], a[168:171], a[84:87], v[48:51]
    v_mfma_f32_16x16x32_bf16 v[44:47], a[168:171], a[80:83], v[44:47]
    v_mfma_f32_16x16x32_bf16 v[100:103], a[180:183], a[80:83], v[100:103]
    v_mfma_f32_16x16x32_bf16 v[128:131], a[176:179], a[80:83], v[128:131]
    v_mfma_f32_16x16x32_bf16 v[128:131], a[180:183], a[28:31], v[128:131]
    s_add_u32 s47, s45, 67584
    v_mfma_f32_16x16x32_bf16 v[72:75], a[176:179], a[28:31], v[72:75]
    buffer_load_dwordx4 v[204:207], v4, s[16:19], s47 offen offset:0
    v_mfma_f32_16x16x32_bf16 v[44:47], a[172:175], a[28:31], v[44:47]
    v_mfma_f32_16x16x32_bf16 v[40:43], a[172:175], a[24:27], v[40:43]
    buffer_load_dwordx4 v[208:211], v4, s[16:19], s47 offen offset:1024
    v_mfma_f32_16x16x32_bf16 v[68:71], a[176:179], a[24:27], v[68:71]
    v_mfma_f32_16x16x32_bf16 v[124:127], a[180:183], a[24:27], v[124:127]
    buffer_load_dwordx4 v[212:215], v4, s[16:19], s47 offen offset:2048
    v_mfma_f32_16x16x32_bf16 v[124:127], a[176:179], a[76:79], v[124:127]
    v_mfma_f32_16x16x32_bf16 v[96:99], a[180:183], a[76:79], v[96:99]
    buffer_load_dwordx4 v[216:219], v4, s[16:19], s47 offen offset:3072
    v_mfma_f32_16x16x32_bf16 v[40:43], a[168:171], a[76:79], v[40:43]
    v_mfma_f32_16x16x32_bf16 v[36:39], a[168:171], a[72:75], v[36:39]
    v_mfma_f32_16x16x32_bf16 v[92:95], a[180:183], a[72:75], v[92:95]
    ds_read_b128 a[4:7], v12 offset:5120
    v_mfma_f32_16x16x32_bf16 v[120:123], a[176:179], a[72:75], v[120:123]
    v_mfma_f32_16x16x32_bf16 v[120:123], a[180:183], a[20:23], v[120:123]
    ds_read_b128 a[56:59], v13 offset:5120
    v_mfma_f32_16x16x32_bf16 v[64:67], a[176:179], a[20:23], v[64:67]
    v_mfma_f32_16x16x32_bf16 v[36:39], a[172:175], a[20:23], v[36:39]
    v_mfma_f32_16x16x32_bf16 v[32:35], a[172:175], a[16:19], v[32:35]
    v_mfma_f32_16x16x32_bf16 v[60:63], a[176:179], a[16:19], v[60:63]
    v_mfma_f32_16x16x32_bf16 v[116:119], a[180:183], a[16:19], v[116:119]
    v_mfma_f32_16x16x32_bf16 v[116:119], a[176:179], a[68:71], v[116:119]
    v_mfma_f32_16x16x32_bf16 v[88:91], a[180:183], a[68:71], v[88:91]
    v_mfma_f32_16x16x32_bf16 v[32:35], a[168:171], a[68:71], v[32:35]
    v_mfma_f32_16x16x32_bf16 v[28:31], a[168:171], a[64:67], v[28:31]
    v_mfma_f32_16x16x32_bf16 v[84:87], a[180:183], a[64:67], v[84:87]
    v_mfma_f32_16x16x32_bf16 v[112:115], a[176:179], a[64:67], v[112:115]
    v_mfma_f32_16x16x32_bf16 v[112:115], a[180:183], a[12:15], v[112:115]
    v_mfma_f32_16x16x32_bf16 v[56:59], a[176:179], a[12:15], v[56:59]
    v_mfma_f32_16x16x32_bf16 v[28:31], a[172:175], a[12:15], v[28:31]
    s_waitcnt lgkmcnt(3)
    v_mfma_f32_16x16x32_bf16 v[24:27], a[172:175], a[8:11], v[24:27]
    v_mfma_f32_16x16x32_bf16 v[52:55], a[176:179], a[8:11], v[52:55]
    v_mfma_f32_16x16x32_bf16 v[108:111], a[180:183], a[8:11], v[108:111]
    s_waitcnt lgkmcnt(2)
    v_mfma_f32_16x16x32_bf16 v[108:111], a[176:179], a[60:63], v[108:111]
    v_mfma_f32_16x16x32_bf16 v[80:83], a[180:183], a[60:63], v[80:83]
    v_mfma_f32_16x16x32_bf16 v[24:27], a[168:171], a[60:63], v[24:27]
    s_waitcnt vmcnt(22)
    v_mfma_f32_16x16x32_bf16 v[48:51], a[188:191], a[28:31], v[48:51]
    s_waitcnt vmcnt(21)
    v_mfma_f32_16x16x32_bf16 v[76:79], a[192:195], a[28:31], v[76:79]
    s_waitcnt vmcnt(20)
    v_mfma_f32_16x16x32_bf16 v[132:135], a[196:199], a[28:31], v[132:135]
    v_mfma_f32_16x16x32_bf16 v[132:135], a[192:195], a[80:83], v[132:135]
    v_mfma_f32_16x16x32_bf16 v[104:107], a[196:199], a[80:83], v[104:107]
    v_mfma_f32_16x16x32_bf16 v[48:51], a[184:187], a[80:83], v[48:51]
    v_mfma_f32_16x16x32_bf16 v[44:47], a[184:187], a[76:79], v[44:47]
    v_mfma_f32_16x16x32_bf16 v[100:103], a[196:199], a[76:79], v[100:103]
    v_mfma_f32_16x16x32_bf16 v[128:131], a[192:195], a[76:79], v[128:131]
    v_mfma_f32_16x16x32_bf16 v[128:131], a[196:199], a[24:27], v[128:131]
    s_add_u32 s47, s45, 73728
    v_mfma_f32_16x16x32_bf16 v[72:75], a[192:195], a[24:27], v[72:75]
    buffer_load_dwordx4 v[220:223], v4, s[16:19], s47 offen offset:0
    v_mfma_f32_16x16x32_bf16 v[44:47], a[188:191], a[24:27], v[44:47]
    v_mfma_f32_16x16x32_bf16 v[40:43], a[188:191], a[20:23], v[40:43]
    buffer_load_dwordx4 v[224:227], v4, s[16:19], s47 offen offset:1024
    v_mfma_f32_16x16x32_bf16 v[68:71], a[192:195], a[20:23], v[68:71]
    v_mfma_f32_16x16x32_bf16 v[124:127], a[196:199], a[20:23], v[124:127]
    buffer_load_dwordx4 v[228:231], v4, s[16:19], s47 offen offset:2048
    v_mfma_f32_16x16x32_bf16 v[124:127], a[192:195], a[72:75], v[124:127]
    v_mfma_f32_16x16x32_bf16 v[96:99], a[196:199], a[72:75], v[96:99]
    buffer_load_dwordx4 v[232:235], v4, s[16:19], s47 offen offset:3072
    v_mfma_f32_16x16x32_bf16 v[40:43], a[184:187], a[72:75], v[40:43]
    v_mfma_f32_16x16x32_bf16 v[36:39], a[184:187], a[68:71], v[36:39]
    s_waitcnt vmcnt(8)
    s_barrier
    v_mfma_f32_16x16x32_bf16 v[92:95], a[196:199], a[68:71], v[92:95]
    ds_read_b128 a[0:3], v12 offset:0
    v_mfma_f32_16x16x32_bf16 v[120:123], a[192:195], a[68:71], v[120:123]
    v_mfma_f32_16x16x32_bf16 v[120:123], a[196:199], a[16:19], v[120:123]
    ds_read_b128 a[52:55], v13 offset:0
    v_mfma_f32_16x16x32_bf16 v[64:67], a[192:195], a[16:19], v[64:67]
    v_mfma_f32_16x16x32_bf16 v[36:39], a[188:191], a[16:19], v[36:39]
    ds_read_b128 a[48:51], v18 offset:25600
    v_mfma_f32_16x16x32_bf16 v[32:35], a[188:191], a[12:15], v[32:35]
    v_mfma_f32_16x16x32_bf16 v[60:63], a[192:195], a[12:15], v[60:63]
    ds_read_b128 a[100:103], v19 offset:25600
    v_mfma_f32_16x16x32_bf16 v[116:119], a[196:199], a[12:15], v[116:119]
    v_mfma_f32_16x16x32_bf16 v[116:119], a[192:195], a[64:67], v[116:119]
    ds_read_b128 a[44:47], v18 offset:20480
    v_mfma_f32_16x16x32_bf16 v[88:91], a[196:199], a[64:67], v[88:91]
    v_mfma_f32_16x16x32_bf16 v[32:35], a[184:187], a[64:67], v[32:35]
    ds_read_b128 a[96:99], v19 offset:20480
    v_mfma_f32_16x16x32_bf16 v[28:31], a[184:187], a[60:63], v[28:31]
    v_mfma_f32_16x16x32_bf16 v[84:87], a[196:199], a[60:63], v[84:87]
    s_add_u32 s47, s45, 79872
    ds_read_b128 a[40:43], v18 offset:15360
    v_mfma_f32_16x16x32_bf16 v[112:115], a[192:195], a[60:63], v[112:115]
    buffer_load_dwordx4 v[236:239], v4, s[16:19], s47 offen offset:0
    v_mfma_f32_16x16x32_bf16 v[112:115], a[196:199], a[8:11], v[112:115]
    ds_read_b128 a[92:95], v19 offset:15360
    v_mfma_f32_16x16x32_bf16 v[56:59], a[192:195], a[8:11], v[56:59]
    buffer_load_dwordx4 v[240:243], v4, s[16:19], s47 offen offset:1024
    v_mfma_f32_16x16x32_bf16 v[28:31], a[188:191], a[8:11], v[28:31]
    s_waitcnt lgkmcnt(9)
    v_mfma_f32_16x16x32_bf16 v[24:27], a[188:191], a[4:7], v[24:27]
    buffer_load_dwordx4 v[244:247], v4, s[16:19], s47 offen offset:2048
    v_mfma_f32_16x16x32_bf16 v[52:55], a[192:195], a[4:7], v[52:55]
    v_mfma_f32_16x16x32_bf16 v[108:111], a[196:199], a[4:7], v[108:111]
    buffer_load_dwordx4 v[248:251], v4, s[16:19], s47 offen offset:3072
    s_waitcnt lgkmcnt(8)
    v_mfma_f32_16x16x32_bf16 v[108:111], a[192:195], a[56:59], v[108:111]
    v_mfma_f32_16x16x32_bf16 v[80:83], a[196:199], a[56:59], v[80:83]
    v_mfma_f32_16x16x32_bf16 v[24:27], a[184:187], a[56:59], v[24:27]
    v_mfma_f32_16x16x32_bf16 v[48:51], a[204:207], a[24:27], v[48:51]
    v_mfma_f32_16x16x32_bf16 v[76:79], a[208:211], a[24:27], v[76:79]
    v_mfma_f32_16x16x32_bf16 v[132:135], a[212:215], a[24:27], v[132:135]
    v_mfma_f32_16x16x32_bf16 v[132:135], a[208:211], a[76:79], v[132:135]
    v_mfma_f32_16x16x32_bf16 v[104:107], a[212:215], a[76:79], v[104:107]
    v_mfma_f32_16x16x32_bf16 v[48:51], a[200:203], a[76:79], v[48:51]
    v_mfma_f32_16x16x32_bf16 v[44:47], a[200:203], a[72:75], v[44:47]
    v_mfma_f32_16x16x32_bf16 v[100:103], a[212:215], a[72:75], v[100:103]
    v_mfma_f32_16x16x32_bf16 v[128:131], a[208:211], a[72:75], v[128:131]
    v_mfma_f32_16x16x32_bf16 v[128:131], a[212:215], a[20:23], v[128:131]
    v_mfma_f32_16x16x32_bf16 v[72:75], a[208:211], a[20:23], v[72:75]
    v_mfma_f32_16x16x32_bf16 v[44:47], a[204:207], a[20:23], v[44:47]
    v_mfma_f32_16x16x32_bf16 v[40:43], a[204:207], a[16:19], v[40:43]
    v_mfma_f32_16x16x32_bf16 v[68:71], a[208:211], a[16:19], v[68:71]
    v_mfma_f32_16x16x32_bf16 v[124:127], a[212:215], a[16:19], v[124:127]
    v_mfma_f32_16x16x32_bf16 v[124:127], a[208:211], a[68:71], v[124:127]
    v_mfma_f32_16x16x32_bf16 v[96:99], a[212:215], a[68:71], v[96:99]
    v_mfma_f32_16x16x32_bf16 v[40:43], a[200:203], a[68:71], v[40:43]
    v_mfma_f32_16x16x32_bf16 v[36:39], a[200:203], a[64:67], v[36:39]
    v_mfma_f32_16x16x32_bf16 v[92:95], a[212:215], a[64:67], v[92:95]
    ds_read_b128 a[36:39], v18 offset:10240
    v_mfma_f32_16x16x32_bf16 v[120:123], a[208:211], a[64:67], v[120:123]
    v_mfma_f32_16x16x32_bf16 v[120:123], a[212:215], a[12:15], v[120:123]
    ds_read_b128 a[88:91], v19 offset:10240
    v_mfma_f32_16x16x32_bf16 v[64:67], a[208:211], a[12:15], v[64:67]
    v_mfma_f32_16x16x32_bf16 v[36:39], a[204:207], a[12:15], v[36:39]
    ds_read_b128 a[32:35], v18 offset:5120
    v_mfma_f32_16x16x32_bf16 v[32:35], a[204:207], a[8:11], v[32:35]
    v_mfma_f32_16x16x32_bf16 v[60:63], a[208:211], a[8:11], v[60:63]
    ds_read_b128 a[84:87], v19 offset:5120
    v_mfma_f32_16x16x32_bf16 v[116:119], a[212:215], a[8:11], v[116:119]
    v_mfma_f32_16x16x32_bf16 v[116:119], a[208:211], a[60:63], v[116:119]
    ds_read_b128 a[28:31], v18 offset:0
    v_mfma_f32_16x16x32_bf16 v[88:91], a[212:215], a[60:63], v[88:91]
    v_mfma_f32_16x16x32_bf16 v[32:35], a[200:203], a[60:63], v[32:35]
    ds_read_b128 a[80:83], v19 offset:0
    v_mfma_f32_16x16x32_bf16 v[28:31], a[200:203], a[56:59], v[28:31]
    v_mfma_f32_16x16x32_bf16 v[84:87], a[212:215], a[56:59], v[84:87]
    ds_read_b128 a[24:27], v16 offset:30720
    v_mfma_f32_16x16x32_bf16 v[112:115], a[208:211], a[56:59], v[112:115]
    v_mfma_f32_16x16x32_bf16 v[112:115], a[212:215], a[4:7], v[112:115]
    ds_read_b128 a[76:79], v17 offset:30720
    v_mfma_f32_16x16x32_bf16 v[56:59], a[208:211], a[4:7], v[56:59]
    v_mfma_f32_16x16x32_bf16 v[28:31], a[204:207], a[4:7], v[28:31]
    s_waitcnt lgkmcnt(15)
    v_mfma_f32_16x16x32_bf16 v[24:27], a[204:207], a[0:3], v[24:27]
    v_mfma_f32_16x16x32_bf16 v[52:55], a[208:211], a[0:3], v[52:55]
    v_mfma_f32_16x16x32_bf16 v[108:111], a[212:215], a[0:3], v[108:111]
    s_waitcnt lgkmcnt(14)
    v_mfma_f32_16x16x32_bf16 v[108:111], a[208:211], a[52:55], v[108:111]
    v_mfma_f32_16x16x32_bf16 v[80:83], a[212:215], a[52:55], v[80:83]
    v_mfma_f32_16x16x32_bf16 v[24:27], a[200:203], a[52:55], v[24:27]
    s_waitcnt lgkmcnt(13)
    v_mfma_f32_16x16x32_bf16 v[48:51], a[220:223], a[48:51], v[48:51]
    v_mfma_f32_16x16x32_bf16 v[76:79], a[224:227], a[48:51], v[76:79]
    v_mfma_f32_16x16x32_bf16 v[132:135], a[228:231], a[48:51], v[132:135]
    ds_read_b128 a[20:23], v16 offset:25600
    s_waitcnt lgkmcnt(12)
    v_mfma_f32_16x16x32_bf16 v[48:51], a[236:239], a[44:47], v[48:51]
    v_mfma_f32_16x16x32_bf16 v[76:79], a[240:243], a[44:47], v[76:79]
    v_mfma_f32_16x16x32_bf16 v[132:135], a[244:247], a[44:47], v[132:135]
    ds_read_b128 a[72:75], v17 offset:25600
    s_waitcnt lgkmcnt(11)
    v_mfma_f32_16x16x32_bf16 v[48:51], a[252:255], a[40:43], v[48:51]
    v_mfma_f32_16x16x32_bf16 v[76:79], v[180:183], a[40:43], v[76:79]
    v_mfma_f32_16x16x32_bf16 v[132:135], v[184:187], a[40:43], v[132:135]
    s_add_u32 s47, s45, 86016
    s_waitcnt lgkmcnt(9)
    v_mfma_f32_16x16x32_bf16 v[48:51], v[192:195], a[36:39], v[48:51]
    buffer_load_dwordx4 a[104:107], v4, s[16:19], s47 offen offset:0
    v_mfma_f32_16x16x32_bf16 v[76:79], v[196:199], a[36:39], v[76:79]
    v_mfma_f32_16x16x32_bf16 v[132:135], v[200:203], a[36:39], v[132:135]
    buffer_load_dwordx4 a[108:111], v4, s[16:19], s47 offen offset:1024
    s_waitcnt vmcnt(12)
    s_waitcnt lgkmcnt(7)
    v_mfma_f32_16x16x32_bf16 v[48:51], v[208:211], a[32:35], v[48:51]
    s_waitcnt vmcnt(11)
    v_mfma_f32_16x16x32_bf16 v[76:79], v[212:215], a[32:35], v[76:79]
    buffer_load_dwordx4 a[112:115], v4, s[16:19], s47 offen offset:2048
    s_waitcnt vmcnt(11)
    v_mfma_f32_16x16x32_bf16 v[132:135], v[216:219], a[32:35], v[132:135]
    s_waitcnt vmcnt(9)
    s_waitcnt lgkmcnt(5)
    v_mfma_f32_16x16x32_bf16 v[48:51], v[224:227], a[28:31], v[48:51]
    buffer_load_dwordx4 a[116:119], v4, s[16:19], s47 offen offset:3072
    s_waitcnt vmcnt(9)
    v_mfma_f32_16x16x32_bf16 v[76:79], v[228:231], a[28:31], v[76:79]
    s_waitcnt vmcnt(8)
    v_mfma_f32_16x16x32_bf16 v[132:135], v[232:235], a[28:31], v[132:135]
    s_waitcnt vmcnt(6)
    s_waitcnt lgkmcnt(3)
    v_mfma_f32_16x16x32_bf16 v[48:51], v[240:243], a[24:27], v[48:51]
    s_waitcnt vmcnt(5)
    v_mfma_f32_16x16x32_bf16 v[76:79], v[244:247], a[24:27], v[76:79]
    s_add_u32 m0, s42, 97280
    s_add_u32 s46, s43, 253952
    buffer_load_dwordx4 v3, s[12:15], s46 offen lds
    s_waitcnt vmcnt(5)
    v_mfma_f32_16x16x32_bf16 v[132:135], v[248:251], a[24:27], v[132:135]
    v_mfma_f32_16x16x32_bf16 v[48:51], a[216:219], a[100:103], v[48:51]
    v_mfma_f32_16x16x32_bf16 v[104:107], a[228:231], a[100:103], v[104:107]
    v_mfma_f32_16x16x32_bf16 v[132:135], a[224:227], a[100:103], v[132:135]
    v_mfma_f32_16x16x32_bf16 v[48:51], a[232:235], a[96:99], v[48:51]
    s_add_u32 m0, s42, 92160
    s_add_u32 s46, s43, 204800
    buffer_load_dwordx4 v3, s[12:15], s46 offen lds
    v_mfma_f32_16x16x32_bf16 v[104:107], a[244:247], a[96:99], v[104:107]
    v_mfma_f32_16x16x32_bf16 v[132:135], a[240:243], a[96:99], v[132:135]
    v_mfma_f32_16x16x32_bf16 v[48:51], a[248:251], a[92:95], v[48:51]
    v_mfma_f32_16x16x32_bf16 v[104:107], v[184:187], a[92:95], v[104:107]
    v_mfma_f32_16x16x32_bf16 v[132:135], v[180:183], a[92:95], v[132:135]
    s_add_u32 m0, s42, 87040
    s_add_u32 s46, s43, 155648
    buffer_load_dwordx4 v3, s[12:15], s46 offen lds
    v_mfma_f32_16x16x32_bf16 v[48:51], v[188:191], a[88:91], v[48:51]
    v_mfma_f32_16x16x32_bf16 v[104:107], v[200:203], a[88:91], v[104:107]
    v_mfma_f32_16x16x32_bf16 v[132:135], v[196:199], a[88:91], v[132:135]
    v_mfma_f32_16x16x32_bf16 v[48:51], v[204:207], a[84:87], v[48:51]
    v_mfma_f32_16x16x32_bf16 v[104:107], v[216:219], a[84:87], v[104:107]
    v_mfma_f32_16x16x32_bf16 v[132:135], v[212:215], a[84:87], v[132:135]
    v_mfma_f32_16x16x32_bf16 v[48:51], v[220:223], a[80:83], v[48:51]
    v_mfma_f32_16x16x32_bf16 v[104:107], v[232:235], a[80:83], v[104:107]
    v_mfma_f32_16x16x32_bf16 v[132:135], v[228:231], a[80:83], v[132:135]
    s_waitcnt lgkmcnt(2)
    v_mfma_f32_16x16x32_bf16 v[48:51], v[236:239], a[76:79], v[48:51]
    v_mfma_f32_16x16x32_bf16 v[104:107], v[248:251], a[76:79], v[104:107]
    v_mfma_f32_16x16x32_bf16 v[132:135], v[244:247], a[76:79], v[132:135]
    v_mfma_f32_16x16x32_bf16 v[44:47], a[220:223], a[44:47], v[44:47]
    v_mfma_f32_16x16x32_bf16 v[72:75], a[224:227], a[44:47], v[72:75]
    v_mfma_f32_16x16x32_bf16 v[128:131], a[228:231], a[44:47], v[128:131]
    ds_read_b128 a[16:19], v16 offset:20480
    v_mfma_f32_16x16x32_bf16 v[44:47], a[236:239], a[40:43], v[44:47]
    v_mfma_f32_16x16x32_bf16 v[72:75], a[240:243], a[40:43], v[72:75]
    v_mfma_f32_16x16x32_bf16 v[128:131], a[244:247], a[40:43], v[128:131]
    ds_read_b128 a[68:71], v17 offset:20480
    v_mfma_f32_16x16x32_bf16 v[44:47], a[252:255], a[36:39], v[44:47]
    v_mfma_f32_16x16x32_bf16 v[72:75], v[180:183], a[36:39], v[72:75]
    v_mfma_f32_16x16x32_bf16 v[128:131], v[184:187], a[36:39], v[128:131]
    s_add_u32 s47, s45, 92160
    v_mfma_f32_16x16x32_bf16 v[44:47], v[192:195], a[32:35], v[44:47]
    buffer_load_dwordx4 a[120:123], v4, s[16:19], s47 offen offset:0
    v_mfma_f32_16x16x32_bf16 v[72:75], v[196:199], a[32:35], v[72:75]
    v_mfma_f32_16x16x32_bf16 v[128:131], v[200:203], a[32:35], v[128:131]
    buffer_load_dwordx4 a[124:127], v4, s[16:19], s47 offen offset:1024
    v_mfma_f32_16x16x32_bf16 v[44:47], v[208:211], a[28:31], v[44:47]
    v_mfma_f32_16x16x32_bf16 v[72:75], v[212:215], a[28:31], v[72:75]
    buffer_load_dwordx4 a[128:131], v4, s[16:19], s47 offen offset:2048
    v_mfma_f32_16x16x32_bf16 v[128:131], v[216:219], a[28:31], v[128:131]
    v_mfma_f32_16x16x32_bf16 v[44:47], v[224:227], a[24:27], v[44:47]
    buffer_load_dwordx4 a[132:135], v4, s[16:19], s47 offen offset:3072
    v_mfma_f32_16x16x32_bf16 v[72:75], v[228:231], a[24:27], v[72:75]
    v_mfma_f32_16x16x32_bf16 v[128:131], v[232:235], a[24:27], v[128:131]
    s_waitcnt lgkmcnt(3)
    v_mfma_f32_16x16x32_bf16 v[44:47], v[240:243], a[20:23], v[44:47]
    v_mfma_f32_16x16x32_bf16 v[72:75], v[244:247], a[20:23], v[72:75]
    s_add_u32 m0, s50, 71680
    s_add_u32 s46, s40, 8192
    buffer_load_dwordx4 v3, s[12:15], s46 offen lds
    v_mfma_f32_16x16x32_bf16 v[128:131], v[248:251], a[20:23], v[128:131]
    v_mfma_f32_16x16x32_bf16 v[44:47], a[216:219], a[96:99], v[44:47]
    v_mfma_f32_16x16x32_bf16 v[100:103], a[228:231], a[96:99], v[100:103]
    v_mfma_f32_16x16x32_bf16 v[128:131], a[224:227], a[96:99], v[128:131]
    v_mfma_f32_16x16x32_bf16 v[44:47], a[232:235], a[92:95], v[44:47]
    s_add_u32 m0, s42, 81920
    s_add_u32 s46, s43, 106496
    buffer_load_dwordx4 v3, s[12:15], s46 offen lds
    v_mfma_f32_16x16x32_bf16 v[100:103], a[244:247], a[92:95], v[100:103]
    v_mfma_f32_16x16x32_bf16 v[128:131], a[240:243], a[92:95], v[128:131]
    v_mfma_f32_16x16x32_bf16 v[44:47], a[248:251], a[88:91], v[44:47]
    v_mfma_f32_16x16x32_bf16 v[100:103], v[184:187], a[88:91], v[100:103]
    v_mfma_f32_16x16x32_bf16 v[128:131], v[180:183], a[88:91], v[128:131]
    s_add_u32 m0, s42, 76800
    s_add_u32 s46, s43, 57344
    buffer_load_dwordx4 v3, s[12:15], s46 offen lds
    v_mfma_f32_16x16x32_bf16 v[44:47], v[188:191], a[84:87], v[44:47]
    v_mfma_f32_16x16x32_bf16 v[100:103], v[200:203], a[84:87], v[100:103]
    v_mfma_f32_16x16x32_bf16 v[128:131], v[196:199], a[84:87], v[128:131]
    v_mfma_f32_16x16x32_bf16 v[44:47], v[204:207], a[80:83], v[44:47]
    v_mfma_f32_16x16x32_bf16 v[100:103], v[216:219], a[80:83], v[100:103]
    v_mfma_f32_16x16x32_bf16 v[128:131], v[212:215], a[80:83], v[128:131]
    v_mfma_f32_16x16x32_bf16 v[44:47], v[220:223], a[76:79], v[44:47]
    v_mfma_f32_16x16x32_bf16 v[100:103], v[232:235], a[76:79], v[100:103]
    v_mfma_f32_16x16x32_bf16 v[128:131], v[228:231], a[76:79], v[128:131]
    s_waitcnt lgkmcnt(2)
    v_mfma_f32_16x16x32_bf16 v[44:47], v[236:239], a[72:75], v[44:47]
    v_mfma_f32_16x16x32_bf16 v[100:103], v[248:251], a[72:75], v[100:103]
    v_mfma_f32_16x16x32_bf16 v[128:131], v[244:247], a[72:75], v[128:131]
    v_mfma_f32_16x16x32_bf16 v[40:43], a[220:223], a[40:43], v[40:43]
    v_mfma_f32_16x16x32_bf16 v[68:71], a[224:227], a[40:43], v[68:71]
    v_mfma_f32_16x16x32_bf16 v[124:127], a[228:231], a[40:43], v[124:127]
    ds_read_b128 a[12:15], v16 offset:15360
    v_mfma_f32_16x16x32_bf16 v[40:43], a[236:239], a[36:39], v[40:43]
    v_mfma_f32_16x16x32_bf16 v[68:71], a[240:243], a[36:39], v[68:71]
    v_mfma_f32_16x16x32_bf16 v[124:127], a[244:247], a[36:39], v[124:127]
    ds_read_b128 a[64:67], v17 offset:15360
    v_mfma_f32_16x16x32_bf16 v[40:43], a[252:255], a[32:35], v[40:43]
    v_mfma_f32_16x16x32_bf16 v[68:71], v[180:183], a[32:35], v[68:71]
    v_mfma_f32_16x16x32_bf16 v[124:127], v[184:187], a[32:35], v[124:127]
    s_add_u32 s47, s45, 98304
    v_mfma_f32_16x16x32_bf16 v[40:43], v[192:195], a[28:31], v[40:43]
    buffer_load_dwordx4 a[136:139], v4, s[16:19], s47 offen offset:0
    v_mfma_f32_16x16x32_bf16 v[68:71], v[196:199], a[28:31], v[68:71]
    v_mfma_f32_16x16x32_bf16 v[124:127], v[200:203], a[28:31], v[124:127]
    buffer_load_dwordx4 a[140:143], v4, s[16:19], s47 offen offset:1024
    v_mfma_f32_16x16x32_bf16 v[40:43], v[208:211], a[24:27], v[40:43]
    v_mfma_f32_16x16x32_bf16 v[68:71], v[212:215], a[24:27], v[68:71]
    buffer_load_dwordx4 a[144:147], v4, s[16:19], s47 offen offset:2048
    v_mfma_f32_16x16x32_bf16 v[124:127], v[216:219], a[24:27], v[124:127]
    v_mfma_f32_16x16x32_bf16 v[40:43], v[224:227], a[20:23], v[40:43]
    buffer_load_dwordx4 a[148:151], v4, s[16:19], s47 offen offset:3072
    v_mfma_f32_16x16x32_bf16 v[68:71], v[228:231], a[20:23], v[68:71]
    v_mfma_f32_16x16x32_bf16 v[124:127], v[232:235], a[20:23], v[124:127]
    s_waitcnt lgkmcnt(3)
    v_mfma_f32_16x16x32_bf16 v[40:43], v[240:243], a[16:19], v[40:43]
    v_mfma_f32_16x16x32_bf16 v[68:71], v[244:247], a[16:19], v[68:71]
    s_add_u32 m0, s42, 71680
    s_add_u32 s46, s43, 8192
    buffer_load_dwordx4 v3, s[12:15], s46 offen lds
    v_mfma_f32_16x16x32_bf16 v[124:127], v[248:251], a[16:19], v[124:127]
    v_mfma_f32_16x16x32_bf16 v[40:43], a[216:219], a[92:95], v[40:43]
    v_mfma_f32_16x16x32_bf16 v[96:99], a[228:231], a[92:95], v[96:99]
    v_mfma_f32_16x16x32_bf16 v[124:127], a[224:227], a[92:95], v[124:127]
    v_mfma_f32_16x16x32_bf16 v[40:43], a[232:235], a[88:91], v[40:43]
    s_add_u32 m0, s42, 102400
    s_add_u32 s46, s43, 303104
    buffer_load_dwordx4 v3, s[12:15], s46 offen lds
    v_mfma_f32_16x16x32_bf16 v[96:99], a[244:247], a[88:91], v[96:99]
    v_mfma_f32_16x16x32_bf16 v[124:127], a[240:243], a[88:91], v[124:127]
    v_mfma_f32_16x16x32_bf16 v[40:43], a[248:251], a[84:87], v[40:43]
    v_mfma_f32_16x16x32_bf16 v[96:99], v[184:187], a[84:87], v[96:99]
    v_mfma_f32_16x16x32_bf16 v[124:127], v[180:183], a[84:87], v[124:127]
    s_add_u32 m0, s51, 71680
    s_add_u32 s46, s41, 8192
    buffer_load_dwordx4 v3, s[12:15], s46 offen lds
    v_mfma_f32_16x16x32_bf16 v[40:43], v[188:191], a[80:83], v[40:43]
    v_mfma_f32_16x16x32_bf16 v[96:99], v[200:203], a[80:83], v[96:99]
    v_mfma_f32_16x16x32_bf16 v[124:127], v[196:199], a[80:83], v[124:127]
    v_mfma_f32_16x16x32_bf16 v[40:43], v[204:207], a[76:79], v[40:43]
    v_mfma_f32_16x16x32_bf16 v[96:99], v[216:219], a[76:79], v[96:99]
    v_mfma_f32_16x16x32_bf16 v[124:127], v[212:215], a[76:79], v[124:127]
    v_mfma_f32_16x16x32_bf16 v[40:43], v[220:223], a[72:75], v[40:43]
    v_mfma_f32_16x16x32_bf16 v[96:99], v[232:235], a[72:75], v[96:99]
    v_mfma_f32_16x16x32_bf16 v[124:127], v[228:231], a[72:75], v[124:127]
    s_waitcnt lgkmcnt(2)
    v_mfma_f32_16x16x32_bf16 v[40:43], v[236:239], a[68:71], v[40:43]
    v_mfma_f32_16x16x32_bf16 v[96:99], v[248:251], a[68:71], v[96:99]
    v_mfma_f32_16x16x32_bf16 v[124:127], v[244:247], a[68:71], v[124:127]
    v_mfma_f32_16x16x32_bf16 v[36:39], a[220:223], a[36:39], v[36:39]
    v_mfma_f32_16x16x32_bf16 v[64:67], a[224:227], a[36:39], v[64:67]
    v_mfma_f32_16x16x32_bf16 v[120:123], a[228:231], a[36:39], v[120:123]
    ds_read_b128 a[8:11], v16 offset:10240
    v_mfma_f32_16x16x32_bf16 v[36:39], a[236:239], a[32:35], v[36:39]
    v_mfma_f32_16x16x32_bf16 v[64:67], a[240:243], a[32:35], v[64:67]
    v_mfma_f32_16x16x32_bf16 v[120:123], a[244:247], a[32:35], v[120:123]
    ds_read_b128 a[60:63], v17 offset:10240
    v_mfma_f32_16x16x32_bf16 v[36:39], a[252:255], a[28:31], v[36:39]
    v_mfma_f32_16x16x32_bf16 v[64:67], v[180:183], a[28:31], v[64:67]
    v_mfma_f32_16x16x32_bf16 v[120:123], v[184:187], a[28:31], v[120:123]
    s_add_u32 s47, s45, 104448
    v_mfma_f32_16x16x32_bf16 v[36:39], v[192:195], a[24:27], v[36:39]
    buffer_load_dwordx4 a[152:155], v4, s[16:19], s47 offen offset:0
    v_mfma_f32_16x16x32_bf16 v[64:67], v[196:199], a[24:27], v[64:67]
    v_mfma_f32_16x16x32_bf16 v[120:123], v[200:203], a[24:27], v[120:123]
    buffer_load_dwordx4 a[156:159], v4, s[16:19], s47 offen offset:1024
    v_mfma_f32_16x16x32_bf16 v[36:39], v[208:211], a[20:23], v[36:39]
    v_mfma_f32_16x16x32_bf16 v[64:67], v[212:215], a[20:23], v[64:67]
    buffer_load_dwordx4 a[160:163], v4, s[16:19], s47 offen offset:2048
    v_mfma_f32_16x16x32_bf16 v[120:123], v[216:219], a[20:23], v[120:123]
    v_mfma_f32_16x16x32_bf16 v[36:39], v[224:227], a[16:19], v[36:39]
    buffer_load_dwordx4 a[164:167], v4, s[16:19], s47 offen offset:3072
    v_mfma_f32_16x16x32_bf16 v[64:67], v[228:231], a[16:19], v[64:67]
    v_mfma_f32_16x16x32_bf16 v[120:123], v[232:235], a[16:19], v[120:123]
    s_waitcnt lgkmcnt(3)
    v_mfma_f32_16x16x32_bf16 v[36:39], v[240:243], a[12:15], v[36:39]
    v_mfma_f32_16x16x32_bf16 v[64:67], v[244:247], a[12:15], v[64:67]
    v_mfma_f32_16x16x32_bf16 v[120:123], v[248:251], a[12:15], v[120:123]
    v_mfma_f32_16x16x32_bf16 v[36:39], a[216:219], a[88:91], v[36:39]
    v_mfma_f32_16x16x32_bf16 v[92:95], a[228:231], a[88:91], v[92:95]
    v_mfma_f32_16x16x32_bf16 v[120:123], a[224:227], a[88:91], v[120:123]
    v_mfma_f32_16x16x32_bf16 v[36:39], a[232:235], a[84:87], v[36:39]
    v_mfma_f32_16x16x32_bf16 v[92:95], a[244:247], a[84:87], v[92:95]
    v_mfma_f32_16x16x32_bf16 v[120:123], a[240:243], a[84:87], v[120:123]
    v_mfma_f32_16x16x32_bf16 v[36:39], a[248:251], a[80:83], v[36:39]
    v_mfma_f32_16x16x32_bf16 v[92:95], v[184:187], a[80:83], v[92:95]
    v_mfma_f32_16x16x32_bf16 v[120:123], v[180:183], a[80:83], v[120:123]
    v_mfma_f32_16x16x32_bf16 v[36:39], v[188:191], a[76:79], v[36:39]
    v_mfma_f32_16x16x32_bf16 v[92:95], v[200:203], a[76:79], v[92:95]
    v_mfma_f32_16x16x32_bf16 v[120:123], v[196:199], a[76:79], v[120:123]
    v_mfma_f32_16x16x32_bf16 v[36:39], v[204:207], a[72:75], v[36:39]
    v_mfma_f32_16x16x32_bf16 v[92:95], v[216:219], a[72:75], v[92:95]
    v_mfma_f32_16x16x32_bf16 v[120:123], v[212:215], a[72:75], v[120:123]
    v_mfma_f32_16x16x32_bf16 v[36:39], v[220:223], a[68:71], v[36:39]
    v_mfma_f32_16x16x32_bf16 v[92:95], v[232:235], a[68:71], v[92:95]
    v_mfma_f32_16x16x32_bf16 v[120:123], v[228:231], a[68:71], v[120:123]
    s_waitcnt lgkmcnt(2)
    v_mfma_f32_16x16x32_bf16 v[36:39], v[236:239], a[64:67], v[36:39]
    v_mfma_f32_16x16x32_bf16 v[92:95], v[248:251], a[64:67], v[92:95]
    v_mfma_f32_16x16x32_bf16 v[120:123], v[244:247], a[64:67], v[120:123]
    v_mfma_f32_16x16x32_bf16 v[32:35], a[220:223], a[32:35], v[32:35]
    v_mfma_f32_16x16x32_bf16 v[60:63], a[224:227], a[32:35], v[60:63]
    v_mfma_f32_16x16x32_bf16 v[116:119], a[228:231], a[32:35], v[116:119]
    ds_read_b128 a[4:7], v16 offset:5120
    v_mfma_f32_16x16x32_bf16 v[32:35], a[236:239], a[28:31], v[32:35]
    v_mfma_f32_16x16x32_bf16 v[60:63], a[240:243], a[28:31], v[60:63]
    v_mfma_f32_16x16x32_bf16 v[116:119], a[244:247], a[28:31], v[116:119]
    ds_read_b128 a[56:59], v17 offset:5120
    v_mfma_f32_16x16x32_bf16 v[32:35], a[252:255], a[24:27], v[32:35]
    v_mfma_f32_16x16x32_bf16 v[60:63], v[180:183], a[24:27], v[60:63]
    v_mfma_f32_16x16x32_bf16 v[116:119], v[184:187], a[24:27], v[116:119]
    s_add_u32 s47, s45, 110592
    v_mfma_f32_16x16x32_bf16 v[32:35], v[192:195], a[20:23], v[32:35]
    buffer_load_dwordx4 a[168:171], v4, s[16:19], s47 offen offset:0
    v_mfma_f32_16x16x32_bf16 v[60:63], v[196:199], a[20:23], v[60:63]
    v_mfma_f32_16x16x32_bf16 v[116:119], v[200:203], a[20:23], v[116:119]
    buffer_load_dwordx4 a[172:175], v4, s[16:19], s47 offen offset:1024
    v_mfma_f32_16x16x32_bf16 v[32:35], v[208:211], a[16:19], v[32:35]
    v_mfma_f32_16x16x32_bf16 v[60:63], v[212:215], a[16:19], v[60:63]
    buffer_load_dwordx4 a[176:179], v4, s[16:19], s47 offen offset:2048
    v_mfma_f32_16x16x32_bf16 v[116:119], v[216:219], a[16:19], v[116:119]
    v_mfma_f32_16x16x32_bf16 v[32:35], v[224:227], a[12:15], v[32:35]
    buffer_load_dwordx4 a[180:183], v4, s[16:19], s47 offen offset:3072
    v_mfma_f32_16x16x32_bf16 v[60:63], v[228:231], a[12:15], v[60:63]
    v_mfma_f32_16x16x32_bf16 v[116:119], v[232:235], a[12:15], v[116:119]
    s_waitcnt lgkmcnt(3)
    v_mfma_f32_16x16x32_bf16 v[32:35], v[240:243], a[8:11], v[32:35]
    v_mfma_f32_16x16x32_bf16 v[60:63], v[244:247], a[8:11], v[60:63]
    v_mfma_f32_16x16x32_bf16 v[116:119], v[248:251], a[8:11], v[116:119]
    v_mfma_f32_16x16x32_bf16 v[32:35], a[216:219], a[84:87], v[32:35]
    v_mfma_f32_16x16x32_bf16 v[88:91], a[228:231], a[84:87], v[88:91]
    v_mfma_f32_16x16x32_bf16 v[116:119], a[224:227], a[84:87], v[116:119]
    v_mfma_f32_16x16x32_bf16 v[32:35], a[232:235], a[80:83], v[32:35]
    v_mfma_f32_16x16x32_bf16 v[88:91], a[244:247], a[80:83], v[88:91]
    v_mfma_f32_16x16x32_bf16 v[116:119], a[240:243], a[80:83], v[116:119]
    v_mfma_f32_16x16x32_bf16 v[32:35], a[248:251], a[76:79], v[32:35]
    v_mfma_f32_16x16x32_bf16 v[88:91], v[184:187], a[76:79], v[88:91]
    v_mfma_f32_16x16x32_bf16 v[116:119], v[180:183], a[76:79], v[116:119]
    v_mfma_f32_16x16x32_bf16 v[32:35], v[188:191], a[72:75], v[32:35]
    v_mfma_f32_16x16x32_bf16 v[88:91], v[200:203], a[72:75], v[88:91]
    v_mfma_f32_16x16x32_bf16 v[116:119], v[196:199], a[72:75], v[116:119]
    v_mfma_f32_16x16x32_bf16 v[32:35], v[204:207], a[68:71], v[32:35]
    v_mfma_f32_16x16x32_bf16 v[88:91], v[216:219], a[68:71], v[88:91]
    v_mfma_f32_16x16x32_bf16 v[116:119], v[212:215], a[68:71], v[116:119]
    v_mfma_f32_16x16x32_bf16 v[32:35], v[220:223], a[64:67], v[32:35]
    v_mfma_f32_16x16x32_bf16 v[88:91], v[232:235], a[64:67], v[88:91]
    v_mfma_f32_16x16x32_bf16 v[116:119], v[228:231], a[64:67], v[116:119]
    s_waitcnt lgkmcnt(2)
    v_mfma_f32_16x16x32_bf16 v[32:35], v[236:239], a[60:63], v[32:35]
    v_mfma_f32_16x16x32_bf16 v[88:91], v[248:251], a[60:63], v[88:91]
    v_mfma_f32_16x16x32_bf16 v[116:119], v[244:247], a[60:63], v[116:119]
    v_mfma_f32_16x16x32_bf16 v[28:31], a[220:223], a[28:31], v[28:31]
    s_waitcnt vmcnt(8)
    s_barrier
    v_mfma_f32_16x16x32_bf16 v[56:59], a[224:227], a[28:31], v[56:59]
    v_mfma_f32_16x16x32_bf16 v[112:115], a[228:231], a[28:31], v[112:115]
    ds_read_b128 a[0:3], v16 offset:0
    v_mfma_f32_16x16x32_bf16 v[28:31], a[236:239], a[24:27], v[28:31]
    v_mfma_f32_16x16x32_bf16 v[56:59], a[240:243], a[24:27], v[56:59]
    v_mfma_f32_16x16x32_bf16 v[112:115], a[244:247], a[24:27], v[112:115]
    ds_read_b128 a[52:55], v17 offset:0
    v_mfma_f32_16x16x32_bf16 v[28:31], a[252:255], a[20:23], v[28:31]
    v_mfma_f32_16x16x32_bf16 v[56:59], v[180:183], a[20:23], v[56:59]
    v_mfma_f32_16x16x32_bf16 v[112:115], v[184:187], a[20:23], v[112:115]
    s_add_u32 s47, s45, 116736
    v_mfma_f32_16x16x32_bf16 v[28:31], v[192:195], a[16:19], v[28:31]
    buffer_load_dwordx4 a[184:187], v4, s[16:19], s47 offen offset:0
    v_mfma_f32_16x16x32_bf16 v[56:59], v[196:199], a[16:19], v[56:59]
    v_mfma_f32_16x16x32_bf16 v[112:115], v[200:203], a[16:19], v[112:115]
    buffer_load_dwordx4 a[188:191], v4, s[16:19], s47 offen offset:1024
    v_mfma_f32_16x16x32_bf16 v[28:31], v[208:211], a[12:15], v[28:31]
    v_mfma_f32_16x16x32_bf16 v[56:59], v[212:215], a[12:15], v[56:59]
    buffer_load_dwordx4 a[192:195], v4, s[16:19], s47 offen offset:2048
    v_mfma_f32_16x16x32_bf16 v[112:115], v[216:219], a[12:15], v[112:115]
    v_mfma_f32_16x16x32_bf16 v[28:31], v[224:227], a[8:11], v[28:31]
    buffer_load_dwordx4 a[196:199], v4, s[16:19], s47 offen offset:3072
    v_mfma_f32_16x16x32_bf16 v[56:59], v[228:231], a[8:11], v[56:59]
    v_mfma_f32_16x16x32_bf16 v[112:115], v[232:235], a[8:11], v[112:115]
    s_waitcnt lgkmcnt(3)
    v_mfma_f32_16x16x32_bf16 v[28:31], v[240:243], a[4:7], v[28:31]
    s_add_u32 s47, s45, 122880
    v_mfma_f32_16x16x32_bf16 v[56:59], v[244:247], a[4:7], v[56:59]
    buffer_load_dwordx4 a[200:203], v4, s[16:19], s47 offen offset:0
    v_mfma_f32_16x16x32_bf16 v[112:115], v[248:251], a[4:7], v[112:115]
    v_mfma_f32_16x16x32_bf16 v[28:31], a[216:219], a[80:83], v[28:31]
    buffer_load_dwordx4 a[204:207], v4, s[16:19], s47 offen offset:1024
    v_mfma_f32_16x16x32_bf16 v[84:87], a[228:231], a[80:83], v[84:87]
    v_mfma_f32_16x16x32_bf16 v[112:115], a[224:227], a[80:83], v[112:115]
    buffer_load_dwordx4 a[208:211], v4, s[16:19], s47 offen offset:2048
    v_mfma_f32_16x16x32_bf16 v[28:31], a[232:235], a[76:79], v[28:31]
    v_mfma_f32_16x16x32_bf16 v[84:87], a[244:247], a[76:79], v[84:87]
    buffer_load_dwordx4 a[212:215], v4, s[16:19], s47 offen offset:3072
    v_mfma_f32_16x16x32_bf16 v[112:115], a[240:243], a[76:79], v[112:115]
    v_mfma_f32_16x16x32_bf16 v[28:31], a[248:251], a[72:75], v[28:31]
    ds_read_b128 a[48:51], v22 offset:25600
    v_mfma_f32_16x16x32_bf16 v[84:87], v[184:187], a[72:75], v[84:87]
    ds_read_b128 a[100:103], v23 offset:25600
    v_mfma_f32_16x16x32_bf16 v[112:115], v[180:183], a[72:75], v[112:115]
    ds_read_b128 a[44:47], v22 offset:20480
    v_mfma_f32_16x16x32_bf16 v[28:31], v[188:191], a[68:71], v[28:31]
    ds_read_b128 a[96:99], v23 offset:20480
    v_mfma_f32_16x16x32_bf16 v[84:87], v[200:203], a[68:71], v[84:87]
    ds_read_b128 a[40:43], v22 offset:15360
    v_mfma_f32_16x16x32_bf16 v[112:115], v[196:199], a[68:71], v[112:115]
    ds_read_b128 a[92:95], v23 offset:15360
    v_mfma_f32_16x16x32_bf16 v[28:31], v[204:207], a[64:67], v[28:31]
    ds_read_b128 a[36:39], v22 offset:10240
    v_mfma_f32_16x16x32_bf16 v[84:87], v[216:219], a[64:67], v[84:87]
    ds_read_b128 a[88:91], v23 offset:10240
    v_mfma_f32_16x16x32_bf16 v[112:115], v[212:215], a[64:67], v[112:115]
    ds_read_b128 a[32:35], v22 offset:5120
    v_mfma_f32_16x16x32_bf16 v[28:31], v[220:223], a[60:63], v[28:31]
    ds_read_b128 a[84:87], v23 offset:5120
    v_mfma_f32_16x16x32_bf16 v[84:87], v[232:235], a[60:63], v[84:87]
    v_mfma_f32_16x16x32_bf16 v[112:115], v[228:231], a[60:63], v[112:115]
    s_waitcnt lgkmcnt(12)
    v_mfma_f32_16x16x32_bf16 v[28:31], v[236:239], a[56:59], v[28:31]
    v_mfma_f32_16x16x32_bf16 v[84:87], v[248:251], a[56:59], v[84:87]
    v_mfma_f32_16x16x32_bf16 v[112:115], v[244:247], a[56:59], v[112:115]
    v_mfma_f32_16x16x32_bf16 v[24:27], a[220:223], a[24:27], v[24:27]
    v_mfma_f32_16x16x32_bf16 v[52:55], a[224:227], a[24:27], v[52:55]
    v_mfma_f32_16x16x32_bf16 v[108:111], a[228:231], a[24:27], v[108:111]
    ds_read_b128 a[24:27], v20 offset:30720
    v_mfma_f32_16x16x32_bf16 v[24:27], a[236:239], a[20:23], v[24:27]
    v_mfma_f32_16x16x32_bf16 v[52:55], a[240:243], a[20:23], v[52:55]
    v_mfma_f32_16x16x32_bf16 v[108:111], a[244:247], a[20:23], v[108:111]
    v_mfma_f32_16x16x32_bf16 v[24:27], a[252:255], a[16:19], v[24:27]
    v_mfma_f32_16x16x32_bf16 v[52:55], v[180:183], a[16:19], v[52:55]
    v_mfma_f32_16x16x32_bf16 v[108:111], v[184:187], a[16:19], v[108:111]
    ds_read_b128 a[28:31], v22 offset:0
    v_mfma_f32_16x16x32_bf16 v[24:27], v[192:195], a[12:15], v[24:27]
    ds_read_b128 a[80:83], v23 offset:0
    v_mfma_f32_16x16x32_bf16 v[52:55], v[196:199], a[12:15], v[52:55]
    v_mfma_f32_16x16x32_bf16 v[108:111], v[200:203], a[12:15], v[108:111]
    v_mfma_f32_16x16x32_bf16 v[24:27], v[208:211], a[8:11], v[24:27]
    v_mfma_f32_16x16x32_bf16 v[52:55], v[212:215], a[8:11], v[52:55]
    v_mfma_f32_16x16x32_bf16 v[108:111], v[216:219], a[8:11], v[108:111]
    v_mfma_f32_16x16x32_bf16 v[24:27], v[224:227], a[4:7], v[24:27]
    v_mfma_f32_16x16x32_bf16 v[52:55], v[228:231], a[4:7], v[52:55]
    v_mfma_f32_16x16x32_bf16 v[108:111], v[232:235], a[4:7], v[108:111]
    s_waitcnt lgkmcnt(14)
    v_mfma_f32_16x16x32_bf16 v[24:27], v[240:243], a[0:3], v[24:27]
    v_mfma_f32_16x16x32_bf16 v[52:55], v[244:247], a[0:3], v[52:55]
    v_mfma_f32_16x16x32_bf16 v[108:111], v[248:251], a[0:3], v[108:111]
    v_mfma_f32_16x16x32_bf16 v[24:27], a[216:219], a[76:79], v[24:27]
    v_mfma_f32_16x16x32_bf16 v[80:83], a[228:231], a[76:79], v[80:83]
    v_mfma_f32_16x16x32_bf16 v[108:111], a[224:227], a[76:79], v[108:111]
    ds_read_b128 a[76:79], v21 offset:30720
    v_mfma_f32_16x16x32_bf16 v[24:27], a[232:235], a[72:75], v[24:27]
    v_mfma_f32_16x16x32_bf16 v[80:83], a[244:247], a[72:75], v[80:83]
    v_mfma_f32_16x16x32_bf16 v[108:111], a[240:243], a[72:75], v[108:111]
    v_mfma_f32_16x16x32_bf16 v[24:27], a[248:251], a[68:71], v[24:27]
    v_mfma_f32_16x16x32_bf16 v[80:83], v[184:187], a[68:71], v[80:83]
    v_mfma_f32_16x16x32_bf16 v[108:111], v[180:183], a[68:71], v[108:111]
    v_mfma_f32_16x16x32_bf16 v[24:27], v[188:191], a[64:67], v[24:27]
    v_mfma_f32_16x16x32_bf16 v[80:83], v[200:203], a[64:67], v[80:83]
    v_mfma_f32_16x16x32_bf16 v[108:111], v[196:199], a[64:67], v[108:111]
    v_mfma_f32_16x16x32_bf16 v[24:27], v[204:207], a[60:63], v[24:27]
    v_mfma_f32_16x16x32_bf16 v[80:83], v[216:219], a[60:63], v[80:83]
    v_mfma_f32_16x16x32_bf16 v[108:111], v[212:215], a[60:63], v[108:111]
    v_mfma_f32_16x16x32_bf16 v[24:27], v[220:223], a[56:59], v[24:27]
    v_mfma_f32_16x16x32_bf16 v[80:83], v[232:235], a[56:59], v[80:83]
    v_mfma_f32_16x16x32_bf16 v[108:111], v[228:231], a[56:59], v[108:111]
    s_waitcnt lgkmcnt(14)
    v_mfma_f32_16x16x32_bf16 v[24:27], v[236:239], a[52:55], v[24:27]
    v_mfma_f32_16x16x32_bf16 v[80:83], v[248:251], a[52:55], v[80:83]
    v_mfma_f32_16x16x32_bf16 v[108:111], v[244:247], a[52:55], v[108:111]
    s_waitcnt lgkmcnt(13)
    v_mfma_f32_16x16x32_bf16 v[48:51], a[108:111], a[48:51], v[48:51]
    v_mfma_f32_16x16x32_bf16 v[76:79], a[112:115], a[48:51], v[76:79]
    v_mfma_f32_16x16x32_bf16 v[132:135], a[116:119], a[48:51], v[132:135]
    ds_read_b128 a[20:23], v20 offset:25600
    s_waitcnt lgkmcnt(12)
    v_mfma_f32_16x16x32_bf16 v[48:51], a[124:127], a[44:47], v[48:51]
    v_mfma_f32_16x16x32_bf16 v[76:79], a[128:131], a[44:47], v[76:79]
    v_mfma_f32_16x16x32_bf16 v[132:135], a[132:135], a[44:47], v[132:135]
    ds_read_b128 a[72:75], v21 offset:25600
    s_waitcnt lgkmcnt(11)
    v_mfma_f32_16x16x32_bf16 v[48:51], a[140:143], a[40:43], v[48:51]
    v_mfma_f32_16x16x32_bf16 v[76:79], a[144:147], a[40:43], v[76:79]
    v_mfma_f32_16x16x32_bf16 v[132:135], a[148:151], a[40:43], v[132:135]
    s_waitcnt vmcnt(14)
    s_waitcnt lgkmcnt(9)
    v_mfma_f32_16x16x32_bf16 v[48:51], a[156:159], a[36:39], v[48:51]
    s_waitcnt vmcnt(13)
    v_mfma_f32_16x16x32_bf16 v[76:79], a[160:163], a[36:39], v[76:79]
    s_waitcnt vmcnt(12)
    v_mfma_f32_16x16x32_bf16 v[132:135], a[164:167], a[36:39], v[132:135]
    s_waitcnt vmcnt(10)
    s_waitcnt lgkmcnt(7)
    v_mfma_f32_16x16x32_bf16 v[48:51], a[172:175], a[32:35], v[48:51]
    s_waitcnt vmcnt(9)
    v_mfma_f32_16x16x32_bf16 v[76:79], a[176:179], a[32:35], v[76:79]
    s_waitcnt vmcnt(8)
    v_mfma_f32_16x16x32_bf16 v[132:135], a[180:183], a[32:35], v[132:135]
    s_waitcnt vmcnt(6)
    s_waitcnt lgkmcnt(4)
    v_mfma_f32_16x16x32_bf16 v[48:51], a[188:191], a[28:31], v[48:51]
    s_waitcnt vmcnt(5)
    v_mfma_f32_16x16x32_bf16 v[76:79], a[192:195], a[28:31], v[76:79]
    s_waitcnt vmcnt(4)
    v_mfma_f32_16x16x32_bf16 v[132:135], a[196:199], a[28:31], v[132:135]
    s_waitcnt vmcnt(2)
    v_mfma_f32_16x16x32_bf16 v[48:51], a[204:207], a[24:27], v[48:51]
    s_waitcnt vmcnt(1)
    v_mfma_f32_16x16x32_bf16 v[76:79], a[208:211], a[24:27], v[76:79]
    s_waitcnt vmcnt(0)
    v_mfma_f32_16x16x32_bf16 v[132:135], a[212:215], a[24:27], v[132:135]
    v_mfma_f32_16x16x32_bf16 v[48:51], a[104:107], a[100:103], v[48:51]
    v_mfma_f32_16x16x32_bf16 v[104:107], a[116:119], a[100:103], v[104:107]
    v_mfma_f32_16x16x32_bf16 v[132:135], a[112:115], a[100:103], v[132:135]
    v_mfma_f32_16x16x32_bf16 v[48:51], a[120:123], a[96:99], v[48:51]
    v_mfma_f32_16x16x32_bf16 v[104:107], a[132:135], a[96:99], v[104:107]
    v_mfma_f32_16x16x32_bf16 v[132:135], a[128:131], a[96:99], v[132:135]
    v_mfma_f32_16x16x32_bf16 v[48:51], a[136:139], a[92:95], v[48:51]
    v_mfma_f32_16x16x32_bf16 v[104:107], a[148:151], a[92:95], v[104:107]
    v_mfma_f32_16x16x32_bf16 v[132:135], a[144:147], a[92:95], v[132:135]
    v_mfma_f32_16x16x32_bf16 v[48:51], a[152:155], a[88:91], v[48:51]
    v_mfma_f32_16x16x32_bf16 v[104:107], a[164:167], a[88:91], v[104:107]
    v_mfma_f32_16x16x32_bf16 v[132:135], a[160:163], a[88:91], v[132:135]
    v_mfma_f32_16x16x32_bf16 v[48:51], a[168:171], a[84:87], v[48:51]
    v_mfma_f32_16x16x32_bf16 v[104:107], a[180:183], a[84:87], v[104:107]
    v_mfma_f32_16x16x32_bf16 v[132:135], a[176:179], a[84:87], v[132:135]
    s_waitcnt lgkmcnt(3)
    v_mfma_f32_16x16x32_bf16 v[48:51], a[184:187], a[80:83], v[48:51]
    v_mfma_f32_16x16x32_bf16 v[104:107], a[196:199], a[80:83], v[104:107]
    v_mfma_f32_16x16x32_bf16 v[132:135], a[192:195], a[80:83], v[132:135]
    s_waitcnt lgkmcnt(2)
    v_mfma_f32_16x16x32_bf16 v[48:51], a[200:203], a[76:79], v[48:51]
    v_mfma_f32_16x16x32_bf16 v[104:107], a[212:215], a[76:79], v[104:107]
    v_mfma_f32_16x16x32_bf16 v[132:135], a[208:211], a[76:79], v[132:135]
    v_mfma_f32_16x16x32_bf16 v[44:47], a[108:111], a[44:47], v[44:47]
    v_mfma_f32_16x16x32_bf16 v[72:75], a[112:115], a[44:47], v[72:75]
    v_mfma_f32_16x16x32_bf16 v[128:131], a[116:119], a[44:47], v[128:131]
    ds_read_b128 a[16:19], v20 offset:20480
    v_mfma_f32_16x16x32_bf16 v[44:47], a[124:127], a[40:43], v[44:47]
    v_mfma_f32_16x16x32_bf16 v[72:75], a[128:131], a[40:43], v[72:75]
    v_mfma_f32_16x16x32_bf16 v[128:131], a[132:135], a[40:43], v[128:131]
    ds_read_b128 a[68:71], v21 offset:20480
    v_mfma_f32_16x16x32_bf16 v[44:47], a[140:143], a[36:39], v[44:47]
    v_mfma_f32_16x16x32_bf16 v[72:75], a[144:147], a[36:39], v[72:75]
    v_sub_f32 v76, v76, v104
    v_mfma_f32_16x16x32_bf16 v[128:131], a[148:151], a[36:39], v[128:131]
    v_sub_f32 v77, v77, v105
    v_mfma_f32_16x16x32_bf16 v[44:47], a[156:159], a[32:35], v[44:47]
    v_sub_f32 v78, v78, v106
    v_mfma_f32_16x16x32_bf16 v[72:75], a[160:163], a[32:35], v[72:75]
    v_sub_f32 v79, v79, v107
    v_mfma_f32_16x16x32_bf16 v[128:131], a[164:167], a[32:35], v[128:131]
    v_cvt_pk_bf16_f32 v164, v76, v77
    v_mfma_f32_16x16x32_bf16 v[44:47], a[172:175], a[28:31], v[44:47]
    v_cvt_pk_bf16_f32 v165, v78, v79
    v_mfma_f32_16x16x32_bf16 v[72:75], a[176:179], a[28:31], v[72:75]
    v_cvt_pk_bf16_f32 v166, v132, v133
    v_mfma_f32_16x16x32_bf16 v[128:131], a[180:183], a[28:31], v[128:131]
    v_cvt_pk_bf16_f32 v167, v134, v135
    v_mfma_f32_16x16x32_bf16 v[44:47], a[188:191], a[24:27], v[44:47]
    s_mov_b32 s48, 294912
    v_mfma_f32_16x16x32_bf16 v[72:75], a[192:195], a[24:27], v[72:75]
    buffer_store_dwordx4 v[164:167], v9, s[20:23], s48 offen offset:128 sc1
    v_mfma_f32_16x16x32_bf16 v[128:131], a[196:199], a[24:27], v[128:131]
    s_waitcnt lgkmcnt(3)
    v_mfma_f32_16x16x32_bf16 v[44:47], a[204:207], a[20:23], v[44:47]
    v_mfma_f32_16x16x32_bf16 v[72:75], a[208:211], a[20:23], v[72:75]
    v_mfma_f32_16x16x32_bf16 v[128:131], a[212:215], a[20:23], v[128:131]
    v_mfma_f32_16x16x32_bf16 v[44:47], a[104:107], a[96:99], v[44:47]
    v_cvt_pk_bf16_f32 v51, v50, v51
    v_mfma_f32_16x16x32_bf16 v[100:103], a[116:119], a[96:99], v[100:103]
    v_cvt_pk_bf16_f32 v50, v48, v49
    v_mfma_f32_16x16x32_bf16 v[128:131], a[112:115], a[96:99], v[128:131]
    v_mfma_f32_16x16x32_bf16 v[44:47], a[120:123], a[92:95], v[44:47]
    v_mfma_f32_16x16x32_bf16 v[100:103], a[132:135], a[92:95], v[100:103]
    v_mfma_f32_16x16x32_bf16 v[128:131], a[128:131], a[92:95], v[128:131]
    v_mfma_f32_16x16x32_bf16 v[44:47], a[136:139], a[88:91], v[44:47]
    s_barrier
    v_mfma_f32_16x16x32_bf16 v[100:103], a[148:151], a[88:91], v[100:103]
    ds_read_b64 v[48:49], v10 offset:3072
    v_mfma_f32_16x16x32_bf16 v[128:131], a[144:147], a[88:91], v[128:131]
    v_mfma_f32_16x16x32_bf16 v[44:47], a[152:155], a[84:87], v[44:47]
    v_mfma_f32_16x16x32_bf16 v[100:103], a[164:167], a[84:87], v[100:103]
    v_mfma_f32_16x16x32_bf16 v[128:131], a[160:163], a[84:87], v[128:131]
    v_mfma_f32_16x16x32_bf16 v[44:47], a[168:171], a[80:83], v[44:47]
    v_mfma_f32_16x16x32_bf16 v[100:103], a[180:183], a[80:83], v[100:103]
    s_mov_b32 s47, 294912
    v_mfma_f32_16x16x32_bf16 v[128:131], a[176:179], a[80:83], v[128:131]
    s_waitcnt lgkmcnt(0)
    buffer_store_dwordx4 v[48:51], v9, s[20:23], s47 offen offset:64 sc1
    v_mfma_f32_16x16x32_bf16 v[44:47], a[184:187], a[76:79], v[44:47]
    v_mfma_f32_16x16x32_bf16 v[100:103], a[196:199], a[76:79], v[100:103]
    v_mfma_f32_16x16x32_bf16 v[128:131], a[192:195], a[76:79], v[128:131]
    v_mfma_f32_16x16x32_bf16 v[44:47], a[200:203], a[72:75], v[44:47]
    v_mfma_f32_16x16x32_bf16 v[100:103], a[212:215], a[72:75], v[100:103]
    v_mfma_f32_16x16x32_bf16 v[128:131], a[208:211], a[72:75], v[128:131]
    v_mfma_f32_16x16x32_bf16 v[40:43], a[108:111], a[40:43], v[40:43]
    v_mfma_f32_16x16x32_bf16 v[68:71], a[112:115], a[40:43], v[68:71]
    v_mfma_f32_16x16x32_bf16 v[124:127], a[116:119], a[40:43], v[124:127]
    ds_read_b128 a[12:15], v20 offset:15360
    v_mfma_f32_16x16x32_bf16 v[40:43], a[124:127], a[36:39], v[40:43]
    v_mfma_f32_16x16x32_bf16 v[68:71], a[128:131], a[36:39], v[68:71]
    v_mfma_f32_16x16x32_bf16 v[124:127], a[132:135], a[36:39], v[124:127]
    ds_read_b128 a[64:67], v21 offset:15360
    v_mfma_f32_16x16x32_bf16 v[40:43], a[140:143], a[32:35], v[40:43]
    v_mfma_f32_16x16x32_bf16 v[68:71], a[144:147], a[32:35], v[68:71]
    v_sub_f32 v72, v72, v100
    v_mfma_f32_16x16x32_bf16 v[124:127], a[148:151], a[32:35], v[124:127]
    v_sub_f32 v73, v73, v101
    v_mfma_f32_16x16x32_bf16 v[40:43], a[156:159], a[28:31], v[40:43]
    v_sub_f32 v74, v74, v102
    v_mfma_f32_16x16x32_bf16 v[68:71], a[160:163], a[28:31], v[68:71]
    v_sub_f32 v75, v75, v103
    v_mfma_f32_16x16x32_bf16 v[124:127], a[164:167], a[28:31], v[124:127]
    v_cvt_pk_bf16_f32 v168, v72, v73
    v_mfma_f32_16x16x32_bf16 v[40:43], a[172:175], a[24:27], v[40:43]
    v_cvt_pk_bf16_f32 v169, v74, v75
    v_mfma_f32_16x16x32_bf16 v[68:71], a[176:179], a[24:27], v[68:71]
    v_cvt_pk_bf16_f32 v170, v128, v129
    v_mfma_f32_16x16x32_bf16 v[124:127], a[180:183], a[24:27], v[124:127]
    v_cvt_pk_bf16_f32 v171, v130, v131
    v_mfma_f32_16x16x32_bf16 v[40:43], a[188:191], a[20:23], v[40:43]
    s_mov_b32 s48, 245760
    v_mfma_f32_16x16x32_bf16 v[68:71], a[192:195], a[20:23], v[68:71]
    buffer_store_dwordx4 v[168:171], v9, s[20:23], s48 offen offset:128 sc1
    v_mfma_f32_16x16x32_bf16 v[124:127], a[196:199], a[20:23], v[124:127]
    v_mfma_f32_16x16x32_bf16 v[40:43], a[204:207], a[16:19], v[40:43]
    v_mfma_f32_16x16x32_bf16 v[68:71], a[208:211], a[16:19], v[68:71]
    v_mfma_f32_16x16x32_bf16 v[124:127], a[212:215], a[16:19], v[124:127]
    v_mfma_f32_16x16x32_bf16 v[40:43], a[104:107], a[92:95], v[40:43]
    v_cvt_pk_bf16_f32 v44, v44, v45
    v_mfma_f32_16x16x32_bf16 v[96:99], a[116:119], a[92:95], v[96:99]
    v_cvt_pk_bf16_f32 v45, v46, v47
    v_mfma_f32_16x16x32_bf16 v[124:127], a[112:115], a[92:95], v[124:127]
    ds_write_b64 v10, v[44:45] offset:2560
    v_mfma_f32_16x16x32_bf16 v[40:43], a[120:123], a[88:91], v[40:43]
    v_mfma_f32_16x16x32_bf16 v[96:99], a[132:135], a[88:91], v[96:99]
    v_mfma_f32_16x16x32_bf16 v[124:127], a[128:131], a[88:91], v[124:127]
    v_mfma_f32_16x16x32_bf16 v[40:43], a[136:139], a[84:87], v[40:43]
    s_waitcnt lgkmcnt(0)
    s_barrier
    v_mfma_f32_16x16x32_bf16 v[96:99], a[148:151], a[84:87], v[96:99]
    v_mfma_f32_16x16x32_bf16 v[124:127], a[144:147], a[84:87], v[124:127]
    v_mfma_f32_16x16x32_bf16 v[40:43], a[152:155], a[80:83], v[40:43]
    v_mfma_f32_16x16x32_bf16 v[96:99], a[164:167], a[80:83], v[96:99]
    v_mfma_f32_16x16x32_bf16 v[124:127], a[160:163], a[80:83], v[124:127]
    v_mfma_f32_16x16x32_bf16 v[40:43], a[168:171], a[76:79], v[40:43]
    v_mfma_f32_16x16x32_bf16 v[96:99], a[180:183], a[76:79], v[96:99]
    v_mfma_f32_16x16x32_bf16 v[124:127], a[176:179], a[76:79], v[124:127]
    v_mfma_f32_16x16x32_bf16 v[40:43], a[184:187], a[72:75], v[40:43]
    v_mfma_f32_16x16x32_bf16 v[96:99], a[196:199], a[72:75], v[96:99]
    v_mfma_f32_16x16x32_bf16 v[124:127], a[192:195], a[72:75], v[124:127]
    v_mfma_f32_16x16x32_bf16 v[40:43], a[200:203], a[68:71], v[40:43]
    v_mfma_f32_16x16x32_bf16 v[96:99], a[212:215], a[68:71], v[96:99]
    v_mfma_f32_16x16x32_bf16 v[124:127], a[208:211], a[68:71], v[124:127]
    v_mfma_f32_16x16x32_bf16 v[36:39], a[108:111], a[36:39], v[36:39]
    v_mfma_f32_16x16x32_bf16 v[64:67], a[112:115], a[36:39], v[64:67]
    v_mfma_f32_16x16x32_bf16 v[120:123], a[116:119], a[36:39], v[120:123]
    ds_read_b128 a[8:11], v20 offset:10240
    v_mfma_f32_16x16x32_bf16 v[36:39], a[124:127], a[32:35], v[36:39]
    v_mfma_f32_16x16x32_bf16 v[64:67], a[128:131], a[32:35], v[64:67]
    v_mfma_f32_16x16x32_bf16 v[120:123], a[132:135], a[32:35], v[120:123]
    ds_read_b128 a[60:63], v21 offset:10240
    v_mfma_f32_16x16x32_bf16 v[36:39], a[140:143], a[28:31], v[36:39]
    v_mfma_f32_16x16x32_bf16 v[64:67], a[144:147], a[28:31], v[64:67]
    v_sub_f32 v68, v68, v96
    v_mfma_f32_16x16x32_bf16 v[120:123], a[148:151], a[28:31], v[120:123]
    v_sub_f32 v69, v69, v97
    v_mfma_f32_16x16x32_bf16 v[36:39], a[156:159], a[24:27], v[36:39]
    v_sub_f32 v70, v70, v98
    v_mfma_f32_16x16x32_bf16 v[64:67], a[160:163], a[24:27], v[64:67]
    v_sub_f32 v71, v71, v99
    v_mfma_f32_16x16x32_bf16 v[120:123], a[164:167], a[24:27], v[120:123]
    v_cvt_pk_bf16_f32 v172, v68, v69
    v_mfma_f32_16x16x32_bf16 v[36:39], a[172:175], a[20:23], v[36:39]
    v_cvt_pk_bf16_f32 v173, v70, v71
    v_mfma_f32_16x16x32_bf16 v[64:67], a[176:179], a[20:23], v[64:67]
    v_cvt_pk_bf16_f32 v174, v124, v125
    v_mfma_f32_16x16x32_bf16 v[120:123], a[180:183], a[20:23], v[120:123]
    v_cvt_pk_bf16_f32 v175, v126, v127
    v_mfma_f32_16x16x32_bf16 v[36:39], a[188:191], a[16:19], v[36:39]
    s_mov_b32 s48, 196608
    v_mfma_f32_16x16x32_bf16 v[64:67], a[192:195], a[16:19], v[64:67]
    buffer_store_dwordx4 v[172:175], v9, s[20:23], s48 offen offset:128 sc1
    v_mfma_f32_16x16x32_bf16 v[120:123], a[196:199], a[16:19], v[120:123]
    v_mfma_f32_16x16x32_bf16 v[36:39], a[204:207], a[12:15], v[36:39]
    v_mfma_f32_16x16x32_bf16 v[64:67], a[208:211], a[12:15], v[64:67]
    v_mfma_f32_16x16x32_bf16 v[120:123], a[212:215], a[12:15], v[120:123]
    v_mfma_f32_16x16x32_bf16 v[36:39], a[104:107], a[88:91], v[36:39]
    v_cvt_pk_bf16_f32 v43, v42, v43
    v_mfma_f32_16x16x32_bf16 v[92:95], a[116:119], a[88:91], v[92:95]
    v_cvt_pk_bf16_f32 v42, v40, v41
    v_mfma_f32_16x16x32_bf16 v[120:123], a[112:115], a[88:91], v[120:123]
    v_mfma_f32_16x16x32_bf16 v[36:39], a[120:123], a[84:87], v[36:39]
    v_mfma_f32_16x16x32_bf16 v[92:95], a[132:135], a[84:87], v[92:95]
    v_mfma_f32_16x16x32_bf16 v[120:123], a[128:131], a[84:87], v[120:123]
    v_mfma_f32_16x16x32_bf16 v[36:39], a[136:139], a[80:83], v[36:39]
    s_barrier
    v_mfma_f32_16x16x32_bf16 v[92:95], a[148:151], a[80:83], v[92:95]
    ds_read_b64 v[40:41], v10 offset:2048
    v_mfma_f32_16x16x32_bf16 v[120:123], a[144:147], a[80:83], v[120:123]
    v_mfma_f32_16x16x32_bf16 v[36:39], a[152:155], a[76:79], v[36:39]
    v_mfma_f32_16x16x32_bf16 v[92:95], a[164:167], a[76:79], v[92:95]
    v_mfma_f32_16x16x32_bf16 v[120:123], a[160:163], a[76:79], v[120:123]
    v_mfma_f32_16x16x32_bf16 v[36:39], a[168:171], a[72:75], v[36:39]
    v_mfma_f32_16x16x32_bf16 v[92:95], a[180:183], a[72:75], v[92:95]
    s_mov_b32 s47, 196608
    v_mfma_f32_16x16x32_bf16 v[120:123], a[176:179], a[72:75], v[120:123]
    s_waitcnt lgkmcnt(0)
    buffer_store_dwordx4 v[40:43], v9, s[20:23], s47 offen offset:64 sc1
    v_mfma_f32_16x16x32_bf16 v[36:39], a[184:187], a[68:71], v[36:39]
    v_mfma_f32_16x16x32_bf16 v[92:95], a[196:199], a[68:71], v[92:95]
    v_mfma_f32_16x16x32_bf16 v[120:123], a[192:195], a[68:71], v[120:123]
    v_mfma_f32_16x16x32_bf16 v[36:39], a[200:203], a[64:67], v[36:39]
    v_mfma_f32_16x16x32_bf16 v[92:95], a[212:215], a[64:67], v[92:95]
    v_mfma_f32_16x16x32_bf16 v[120:123], a[208:211], a[64:67], v[120:123]
    v_mfma_f32_16x16x32_bf16 v[32:35], a[108:111], a[32:35], v[32:35]
    v_mfma_f32_16x16x32_bf16 v[60:63], a[112:115], a[32:35], v[60:63]
    v_mfma_f32_16x16x32_bf16 v[116:119], a[116:119], a[32:35], v[116:119]
    ds_read_b128 a[4:7], v20 offset:5120
    v_mfma_f32_16x16x32_bf16 v[32:35], a[124:127], a[28:31], v[32:35]
    v_mfma_f32_16x16x32_bf16 v[60:63], a[128:131], a[28:31], v[60:63]
    v_mfma_f32_16x16x32_bf16 v[116:119], a[132:135], a[28:31], v[116:119]
    ds_read_b128 a[56:59], v21 offset:5120
    v_mfma_f32_16x16x32_bf16 v[32:35], a[140:143], a[24:27], v[32:35]
    v_mfma_f32_16x16x32_bf16 v[60:63], a[144:147], a[24:27], v[60:63]
    v_sub_f32 v64, v64, v92
    v_mfma_f32_16x16x32_bf16 v[116:119], a[148:151], a[24:27], v[116:119]
    v_sub_f32 v65, v65, v93
    v_mfma_f32_16x16x32_bf16 v[32:35], a[156:159], a[20:23], v[32:35]
    v_sub_f32 v66, v66, v94
    v_mfma_f32_16x16x32_bf16 v[60:63], a[160:163], a[20:23], v[60:63]
    v_sub_f32 v67, v67, v95
    v_mfma_f32_16x16x32_bf16 v[116:119], a[164:167], a[20:23], v[116:119]
    v_cvt_pk_bf16_f32 v176, v64, v65
    v_mfma_f32_16x16x32_bf16 v[32:35], a[172:175], a[16:19], v[32:35]
    v_cvt_pk_bf16_f32 v177, v66, v67
    v_mfma_f32_16x16x32_bf16 v[60:63], a[176:179], a[16:19], v[60:63]
    v_cvt_pk_bf16_f32 v178, v120, v121
    v_mfma_f32_16x16x32_bf16 v[116:119], a[180:183], a[16:19], v[116:119]
    v_cvt_pk_bf16_f32 v179, v122, v123
    v_mfma_f32_16x16x32_bf16 v[32:35], a[188:191], a[12:15], v[32:35]
    s_mov_b32 s48, 147456
    v_mfma_f32_16x16x32_bf16 v[60:63], a[192:195], a[12:15], v[60:63]
    buffer_store_dwordx4 v[176:179], v9, s[20:23], s48 offen offset:128 sc1
    v_mfma_f32_16x16x32_bf16 v[116:119], a[196:199], a[12:15], v[116:119]
    v_mfma_f32_16x16x32_bf16 v[32:35], a[204:207], a[8:11], v[32:35]
    v_mfma_f32_16x16x32_bf16 v[60:63], a[208:211], a[8:11], v[60:63]
    v_mfma_f32_16x16x32_bf16 v[116:119], a[212:215], a[8:11], v[116:119]
    v_mfma_f32_16x16x32_bf16 v[32:35], a[104:107], a[84:87], v[32:35]
    v_cvt_pk_bf16_f32 v36, v36, v37
    v_mfma_f32_16x16x32_bf16 v[88:91], a[116:119], a[84:87], v[88:91]
    v_cvt_pk_bf16_f32 v37, v38, v39
    v_mfma_f32_16x16x32_bf16 v[116:119], a[112:115], a[84:87], v[116:119]
    ds_write_b64 v10, v[36:37] offset:1536
    v_mfma_f32_16x16x32_bf16 v[32:35], a[120:123], a[80:83], v[32:35]
    v_mfma_f32_16x16x32_bf16 v[88:91], a[132:135], a[80:83], v[88:91]
    v_mfma_f32_16x16x32_bf16 v[116:119], a[128:131], a[80:83], v[116:119]
    v_mfma_f32_16x16x32_bf16 v[32:35], a[136:139], a[76:79], v[32:35]
    s_waitcnt lgkmcnt(0)
    s_barrier
    v_mfma_f32_16x16x32_bf16 v[88:91], a[148:151], a[76:79], v[88:91]
    v_mfma_f32_16x16x32_bf16 v[116:119], a[144:147], a[76:79], v[116:119]
    v_mfma_f32_16x16x32_bf16 v[32:35], a[152:155], a[72:75], v[32:35]
    v_mfma_f32_16x16x32_bf16 v[88:91], a[164:167], a[72:75], v[88:91]
    v_mfma_f32_16x16x32_bf16 v[116:119], a[160:163], a[72:75], v[116:119]
    v_mfma_f32_16x16x32_bf16 v[32:35], a[168:171], a[68:71], v[32:35]
    v_mfma_f32_16x16x32_bf16 v[88:91], a[180:183], a[68:71], v[88:91]
    v_mfma_f32_16x16x32_bf16 v[116:119], a[176:179], a[68:71], v[116:119]
    v_mfma_f32_16x16x32_bf16 v[32:35], a[184:187], a[64:67], v[32:35]
    v_mfma_f32_16x16x32_bf16 v[88:91], a[196:199], a[64:67], v[88:91]
    v_mfma_f32_16x16x32_bf16 v[116:119], a[192:195], a[64:67], v[116:119]
    v_mfma_f32_16x16x32_bf16 v[32:35], a[200:203], a[60:63], v[32:35]
    v_mfma_f32_16x16x32_bf16 v[88:91], a[212:215], a[60:63], v[88:91]
    v_mfma_f32_16x16x32_bf16 v[116:119], a[208:211], a[60:63], v[116:119]
    v_mfma_f32_16x16x32_bf16 v[28:31], a[108:111], a[28:31], v[28:31]
    v_mfma_f32_16x16x32_bf16 v[56:59], a[112:115], a[28:31], v[56:59]
    v_mfma_f32_16x16x32_bf16 v[112:115], a[116:119], a[28:31], v[112:115]
    ds_read_b128 a[0:3], v20 offset:0
    v_mfma_f32_16x16x32_bf16 v[28:31], a[124:127], a[24:27], v[28:31]
    v_mfma_f32_16x16x32_bf16 v[56:59], a[128:131], a[24:27], v[56:59]
    v_mfma_f32_16x16x32_bf16 v[112:115], a[132:135], a[24:27], v[112:115]
    ds_read_b128 a[52:55], v21 offset:0
    v_mfma_f32_16x16x32_bf16 v[28:31], a[140:143], a[20:23], v[28:31]
    v_mfma_f32_16x16x32_bf16 v[56:59], a[144:147], a[20:23], v[56:59]
    v_sub_f32 v60, v60, v88
    v_mfma_f32_16x16x32_bf16 v[112:115], a[148:151], a[20:23], v[112:115]
    v_sub_f32 v61, v61, v89
    v_mfma_f32_16x16x32_bf16 v[28:31], a[156:159], a[16:19], v[28:31]
    v_sub_f32 v62, v62, v90
    v_mfma_f32_16x16x32_bf16 v[56:59], a[160:163], a[16:19], v[56:59]
    v_sub_f32 v63, v63, v91
    v_mfma_f32_16x16x32_bf16 v[112:115], a[164:167], a[16:19], v[112:115]
    v_cvt_pk_bf16_f32 v164, v60, v61
    v_mfma_f32_16x16x32_bf16 v[28:31], a[172:175], a[12:15], v[28:31]
    v_cvt_pk_bf16_f32 v165, v62, v63
    v_mfma_f32_16x16x32_bf16 v[56:59], a[176:179], a[12:15], v[56:59]
    v_cvt_pk_bf16_f32 v166, v116, v117
    v_mfma_f32_16x16x32_bf16 v[112:115], a[180:183], a[12:15], v[112:115]
    v_cvt_pk_bf16_f32 v167, v118, v119
    v_mfma_f32_16x16x32_bf16 v[28:31], a[188:191], a[8:11], v[28:31]
    s_mov_b32 s48, 98304
    v_mfma_f32_16x16x32_bf16 v[56:59], a[192:195], a[8:11], v[56:59]
    buffer_store_dwordx4 v[164:167], v9, s[20:23], s48 offen offset:128 sc1
    v_mfma_f32_16x16x32_bf16 v[112:115], a[196:199], a[8:11], v[112:115]
    v_mfma_f32_16x16x32_bf16 v[28:31], a[204:207], a[4:7], v[28:31]
    v_mfma_f32_16x16x32_bf16 v[56:59], a[208:211], a[4:7], v[56:59]
    v_mfma_f32_16x16x32_bf16 v[112:115], a[212:215], a[4:7], v[112:115]
    v_mfma_f32_16x16x32_bf16 v[28:31], a[104:107], a[80:83], v[28:31]
    v_cvt_pk_bf16_f32 v35, v34, v35
    v_mfma_f32_16x16x32_bf16 v[84:87], a[116:119], a[80:83], v[84:87]
    v_cvt_pk_bf16_f32 v34, v32, v33
    v_mfma_f32_16x16x32_bf16 v[112:115], a[112:115], a[80:83], v[112:115]
    v_mfma_f32_16x16x32_bf16 v[28:31], a[120:123], a[76:79], v[28:31]
    v_mfma_f32_16x16x32_bf16 v[84:87], a[132:135], a[76:79], v[84:87]
    v_mfma_f32_16x16x32_bf16 v[112:115], a[128:131], a[76:79], v[112:115]
    v_mfma_f32_16x16x32_bf16 v[28:31], a[136:139], a[72:75], v[28:31]
    s_barrier
    v_mfma_f32_16x16x32_bf16 v[84:87], a[148:151], a[72:75], v[84:87]
    ds_read_b64 v[32:33], v10 offset:1024
    v_mfma_f32_16x16x32_bf16 v[112:115], a[144:147], a[72:75], v[112:115]
    v_mfma_f32_16x16x32_bf16 v[28:31], a[152:155], a[68:71], v[28:31]
    v_mfma_f32_16x16x32_bf16 v[84:87], a[164:167], a[68:71], v[84:87]
    v_mfma_f32_16x16x32_bf16 v[112:115], a[160:163], a[68:71], v[112:115]
    v_mfma_f32_16x16x32_bf16 v[28:31], a[168:171], a[64:67], v[28:31]
    v_mfma_f32_16x16x32_bf16 v[84:87], a[180:183], a[64:67], v[84:87]
    s_mov_b32 s47, 98304
    v_mfma_f32_16x16x32_bf16 v[112:115], a[176:179], a[64:67], v[112:115]
    s_waitcnt lgkmcnt(0)
    buffer_store_dwordx4 v[32:35], v9, s[20:23], s47 offen offset:64 sc1
    v_mfma_f32_16x16x32_bf16 v[28:31], a[184:187], a[60:63], v[28:31]
    v_mfma_f32_16x16x32_bf16 v[84:87], a[196:199], a[60:63], v[84:87]
    v_mfma_f32_16x16x32_bf16 v[112:115], a[192:195], a[60:63], v[112:115]
    v_mfma_f32_16x16x32_bf16 v[28:31], a[200:203], a[56:59], v[28:31]
    v_mfma_f32_16x16x32_bf16 v[84:87], a[212:215], a[56:59], v[84:87]
    v_mfma_f32_16x16x32_bf16 v[112:115], a[208:211], a[56:59], v[112:115]
    v_mfma_f32_16x16x32_bf16 v[24:27], a[108:111], a[24:27], v[24:27]
    v_mfma_f32_16x16x32_bf16 v[24:27], a[104:107], a[76:79], v[24:27]
    v_mfma_f32_16x16x32_bf16 v[24:27], a[124:127], a[20:23], v[24:27]
    v_mfma_f32_16x16x32_bf16 v[24:27], a[120:123], a[72:75], v[24:27]
    v_mfma_f32_16x16x32_bf16 v[24:27], a[140:143], a[16:19], v[24:27]
    v_mfma_f32_16x16x32_bf16 v[24:27], a[136:139], a[68:71], v[24:27]
    v_mfma_f32_16x16x32_bf16 v[24:27], a[156:159], a[12:15], v[24:27]
    v_mfma_f32_16x16x32_bf16 v[24:27], a[152:155], a[64:67], v[24:27]
    v_sub_f32 v56, v56, v84
    v_mfma_f32_16x16x32_bf16 v[24:27], a[172:175], a[8:11], v[24:27]
    v_sub_f32 v57, v57, v85
    v_mfma_f32_16x16x32_bf16 v[24:27], a[168:171], a[60:63], v[24:27]
    v_sub_f32 v58, v58, v86
    v_mfma_f32_16x16x32_bf16 v[24:27], a[188:191], a[4:7], v[24:27]
    v_sub_f32 v59, v59, v87
    v_mfma_f32_16x16x32_bf16 v[24:27], a[184:187], a[56:59], v[24:27]
    v_cvt_pk_bf16_f32 v168, v56, v57
    v_mfma_f32_16x16x32_bf16 v[24:27], a[204:207], a[0:3], v[24:27]
    v_cvt_pk_bf16_f32 v169, v58, v59
    v_mfma_f32_16x16x32_bf16 v[24:27], a[200:203], a[52:55], v[24:27]
    v_cvt_pk_bf16_f32 v170, v112, v113
    v_mfma_f32_16x16x32_bf16 v[52:55], a[112:115], a[24:27], v[52:55]
    v_cvt_pk_bf16_f32 v171, v114, v115
    v_mfma_f32_16x16x32_bf16 v[108:111], a[116:119], a[24:27], v[108:111]
    s_mov_b32 s48, 49152
    v_mfma_f32_16x16x32_bf16 v[52:55], a[128:131], a[20:23], v[52:55]
    buffer_store_dwordx4 v[168:171], v9, s[20:23], s48 offen offset:128 sc1
    v_mfma_f32_16x16x32_bf16 v[108:111], a[132:135], a[20:23], v[108:111]
    v_mfma_f32_16x16x32_bf16 v[52:55], a[144:147], a[16:19], v[52:55]
    v_mfma_f32_16x16x32_bf16 v[108:111], a[148:151], a[16:19], v[108:111]
    v_mfma_f32_16x16x32_bf16 v[52:55], a[160:163], a[12:15], v[52:55]
    v_mfma_f32_16x16x32_bf16 v[108:111], a[164:167], a[12:15], v[108:111]
    v_cvt_pk_bf16_f32 v28, v28, v29
    v_mfma_f32_16x16x32_bf16 v[52:55], a[176:179], a[8:11], v[52:55]
    v_cvt_pk_bf16_f32 v29, v30, v31
    v_mfma_f32_16x16x32_bf16 v[108:111], a[180:183], a[8:11], v[108:111]
    ds_write_b64 v10, v[28:29] offset:512
    v_mfma_f32_16x16x32_bf16 v[52:55], a[192:195], a[4:7], v[52:55]
    v_mfma_f32_16x16x32_bf16 v[108:111], a[196:199], a[4:7], v[108:111]
    v_cvt_pk_bf16_f32 v27, v26, v27
    v_mfma_f32_16x16x32_bf16 v[52:55], a[208:211], a[0:3], v[52:55]
    v_cvt_pk_bf16_f32 v26, v24, v25
    v_mfma_f32_16x16x32_bf16 v[108:111], a[212:215], a[0:3], v[108:111]
    s_waitcnt lgkmcnt(0)
    s_barrier
    v_mfma_f32_16x16x32_bf16 v[80:83], a[116:119], a[76:79], v[80:83]
    v_mfma_f32_16x16x32_bf16 v[108:111], a[112:115], a[76:79], v[108:111]
    v_mfma_f32_16x16x32_bf16 v[80:83], a[132:135], a[72:75], v[80:83]
    v_mfma_f32_16x16x32_bf16 v[108:111], a[128:131], a[72:75], v[108:111]
    s_barrier
    v_mfma_f32_16x16x32_bf16 v[80:83], a[148:151], a[68:71], v[80:83]
    ds_read_b64 v[24:25], v10 offset:0
    v_mfma_f32_16x16x32_bf16 v[108:111], a[144:147], a[68:71], v[108:111]
    v_mfma_f32_16x16x32_bf16 v[80:83], a[164:167], a[64:67], v[80:83]
    v_mfma_f32_16x16x32_bf16 v[108:111], a[160:163], a[64:67], v[108:111]
    v_mfma_f32_16x16x32_bf16 v[80:83], a[180:183], a[60:63], v[80:83]
    v_mfma_f32_16x16x32_bf16 v[108:111], a[176:179], a[60:63], v[108:111]
    v_mfma_f32_16x16x32_bf16 v[80:83], a[196:199], a[56:59], v[80:83]
    s_mov_b32 s47, 0
    v_mfma_f32_16x16x32_bf16 v[108:111], a[192:195], a[56:59], v[108:111]
    s_waitcnt lgkmcnt(0)
    buffer_store_dwordx4 v[24:27], v9, s[20:23], s47 offen offset:64 sc1
    v_mfma_f32_16x16x32_bf16 v[80:83], a[212:215], a[52:55], v[80:83]
    v_mfma_f32_16x16x32_bf16 v[108:111], a[208:211], a[52:55], v[108:111]
    s_nop 6
    v_sub_f32 v52, v52, v80
    v_sub_f32 v53, v53, v81
    v_sub_f32 v54, v54, v82
    v_sub_f32 v55, v55, v83
    v_cvt_pk_bf16_f32 v172, v52, v53
    v_cvt_pk_bf16_f32 v173, v54, v55
    v_cvt_pk_bf16_f32 v174, v108, v109
    v_cvt_pk_bf16_f32 v175, v110, v111
    s_mov_b32 s48, 0
    buffer_store_dwordx4 v[172:175], v9, s[20:23], s48 offen offset:128 sc1
    s_endpgm
K2_end:
    s_endpgm
.globl k3_kernel
.p2align 8
.type k3_kernel,@function
k3_kernel:
    s_load_dwordx2 s[4:5], s[0:1], 16
    s_load_dwordx2 s[8:9], s[0:1], 32
    s_getpc_b64 s[10:11]
K3_pc:
    s_cmp_ge_u32 s2, 224
    s_cbranch_scc1 K3_end
    v_lshrrev_b32 v5, 6, v0
    v_and_b32 v0, 63, v0
    v_readfirstlane_b32 s28, v5
    v_lshlrev_b32 v6, 4, v0
    v_add_u32 v7, fft_tables-K3_pc+24576, v6
    v_add_u32 v8, 4096, v7
    global_load_dwordx4 v[48:51], v7, s[10:11] offset:0
    global_load_dwordx4 v[52:55], v7, s[10:11] offset:1024
    global_load_dwordx4 v[56:59], v7, s[10:11] offset:2048
    global_load_dwordx4 v[60:63], v7, s[10:11] offset:3072
    global_load_dwordx4 v[64:67], v8, s[10:11] offset:0
    global_load_dwordx4 v[68:71], v8, s[10:11] offset:1024
    global_load_dwordx4 v[72:75], v8, s[10:11] offset:2048
    global_load_dwordx4 v[76:79], v8, s[10:11] offset:3072
    s_mul_i32 s29, s28, 12288
    s_lshl_b32 s33, s2, 2
    s_add_u32 s33, s33, s28
    s_mul_i32 s33, s33, 12288
    v_lshrrev_b32 v9, 3, v0
    v_mul_u32_u24 v9, 384, v9
    v_and_b32 v10, 7, v0
    v_lshl_add_u32 v9, v10, 4, v9
    s_mov_b32 m0, s29
    s_waitcnt lgkmcnt(0)
    s_add_u32 s12, s8, 0x1400000
    s_addc_u32 s13, s9, 0
    s_and_b32 s13, s13, 0xffff
    s_mov_b32 s14, 11010048
    s_mov_b32 s15, 0x00020000
    s_add_u32 s34, s33, 0
    buffer_load_dwordx4 v9, s[12:15], s34 offen lds
    s_add_u32 m0, m0, 1024
    s_add_u32 s34, s33, 3072
    buffer_load_dwordx4 v9, s[12:15], s34 offen lds
    s_add_u32 m0, m0, 1024
    s_add_u32 s34, s33, 6144
    buffer_load_dwordx4 v9, s[12:15], s34 offen lds
    s_add_u32 m0, m0, 1024
    s_add_u32 s34, s33, 9216
    buffer_load_dwordx4 v9, s[12:15], s34 offen lds
    s_add_u32 m0, m0, 1024
    s_add_u32 s34, s33, 128
    buffer_load_dwordx4 v9, s[12:15], s34 offen lds
    s_add_u32 m0, m0, 1024
    s_add_u32 s34, s33, 3200
    buffer_load_dwordx4 v9, s[12:15], s34 offen lds
    s_add_u32 m0, m0, 1024
    s_add_u32 s34, s33, 6272
    buffer_load_dwordx4 v9, s[12:15], s34 offen lds
    s_add_u32 m0, m0, 1024
    s_add_u32 s34, s33, 9344
    buffer_load_dwordx4 v9, s[12:15], s34 offen lds
    s_add_u32 m0, m0, 1024
    s_add_u32 s34, s33, 256
    buffer_load_dwordx4 v9, s[12:15], s34 offen lds
    s_add_u32 m0, m0, 1024
    s_add_u32 s34, s33, 3328
    buffer_load_dwordx4 v9, s[12:15], s34 offen lds
    s_add_u32 m0, m0, 1024
    s_add_u32 s34, s33, 6400
    buffer_load_dwordx4 v9, s[12:15], s34 offen lds
    s_add_u32 m0, m0, 1024
    s_add_u32 s34, s33, 9472
    buffer_load_dwordx4 v9, s[12:15], s34 offen lds
    s_mov_b32 s16, s4
    s_and_b32 s17, s5, 0xffff
    s_mov_b32 s18, 9633792
    s_mov_b32 s19, 0x00020000
    v_and_b32 v1, 15, v0
    v_lshrrev_b32 v2, 4, v0
    v_bfe_u32 v3, v0, 2, 2
    v_and_b32 v4, 3, v0
    v_lshrrev_b32 v23, 1, v2
    v_lshlrev_b32 v23, 3, v23
    v_and_b32 v24, 1, v2
    v_lshl_add_u32 v23, v24, 1, v23
    v_lshrrev_b32 v25, 1, v3
    v_add_u32 v23, v23, v25
    v_lshlrev_b32 v23, 7, v23
    v_lshl_add_u32 v23, v4, 5, v23
    v_and_b32 v25, 1, v3
    v_lshl_add_u32 v23, v25, 3, v23
    v_add_u32 v20, s29, v23
    v_mul_u32_u24 v23, 192, v1
    v_lshl_add_u32 v25, v2, 4, v23
    v_cmp_gt_u32 vcc, 8, v1
    v_mov_b32 v23, 0x40000000
    s_nop 0
    v_cndmask_b32 v26, v23, v25, vcc
    s_mul_i32 s35, s2, 43008
    s_mul_i32 s36, s28, 10752
    s_add_u32 s35, s35, s36
    s_add_u32 s37, s35, 3072
    s_add_u32 s38, s35, 6144
    s_add_u32 s39, s35, 9216
    s_waitcnt vmcnt(8)
    ds_read_b64_tr_b16 v[80:81], v20 offset:0
    ds_read_b64_tr_b16 v[82:83], v20 offset:512
    ds_read_b64_tr_b16 v[84:85], v20 offset:2048
    ds_read_b64_tr_b16 v[86:87], v20 offset:2560
    ds_read_b64_tr_b16 v[88:89], v20 offset:16
    ds_read_b64_tr_b16 v[90:91], v20 offset:528
    ds_read_b64_tr_b16 v[92:93], v20 offset:2064
    ds_read_b64_tr_b16 v[94:95], v20 offset:2576
    s_waitcnt lgkmcnt(6)
    v_mfma_f32_16x16x32_bf16 v[128:131], v[80:83], v[48:51], 0
    s_waitcnt lgkmcnt(2)
    v_mfma_f32_16x16x32_bf16 v[144:147], v[88:91], v[48:51], 0
    v_mfma_f32_16x16x32_bf16 v[128:131], v[84:87], v[52:55], v[128:131]
    s_waitcnt lgkmcnt(0)
    v_mfma_f32_16x16x32_bf16 v[144:147], v[92:95], v[52:55], v[144:147]
    v_mfma_f32_16x16x32_bf16 v[132:135], v[80:83], v[56:59], 0
    v_mfma_f32_16x16x32_bf16 v[148:151], v[88:91], v[56:59], 0
    v_mfma_f32_16x16x32_bf16 v[132:135], v[84:87], v[60:63], v[132:135]
    v_mfma_f32_16x16x32_bf16 v[148:151], v[92:95], v[60:63], v[148:151]
    v_mfma_f32_16x16x32_bf16 v[136:139], v[80:83], v[64:67], 0
    v_mfma_f32_16x16x32_bf16 v[152:155], v[88:91], v[64:67], 0
    v_mfma_f32_16x16x32_bf16 v[136:139], v[84:87], v[68:71], v[136:139]
    v_mfma_f32_16x16x32_bf16 v[152:155], v[92:95], v[68:71], v[152:155]
    v_mfma_f32_16x16x32_bf16 v[140:143], v[80:83], v[72:75], 0
    v_mfma_f32_16x16x32_bf16 v[156:159], v[88:91], v[72:75], 0
    v_mfma_f32_16x16x32_bf16 v[140:143], v[84:87], v[76:79], v[140:143]
    v_mfma_f32_16x16x32_bf16 v[156:159], v[92:95], v[76:79], v[156:159]
    v_cvt_pk_bf16_f32 v224, v128, v129
    v_cvt_pk_bf16_f32 v225, v130, v131
    v_cvt_pk_bf16_f32 v226, v144, v145
    v_cvt_pk_bf16_f32 v227, v146, v147
    buffer_store_dwordx4 v[224:227], v25, s[16:19], s35 offen offset:0 sc1
    v_cvt_pk_bf16_f32 v228, v132, v133
    v_cvt_pk_bf16_f32 v229, v134, v135
    v_cvt_pk_bf16_f32 v230, v148, v149
    v_cvt_pk_bf16_f32 v231, v150, v151
    buffer_store_dwordx4 v[228:231], v25, s[16:19], s37 offen offset:0 sc1
    v_cvt_pk_bf16_f32 v232, v136, v137
    v_cvt_pk_bf16_f32 v233, v138, v139
    v_cvt_pk_bf16_f32 v234, v152, v153
    v_cvt_pk_bf16_f32 v235, v154, v155
    buffer_store_dwordx4 v[232:235], v25, s[16:19], s38 offen offset:0 sc1
    v_cvt_pk_bf16_f32 v236, v140, v141
    v_cvt_pk_bf16_f32 v237, v142, v143
    v_cvt_pk_bf16_f32 v238, v156, v157
    v_cvt_pk_bf16_f32 v239, v158, v159
    buffer_store_dwordx4 v[236:239], v26, s[16:19], s39 offen offset:0 sc1
    s_waitcnt vmcnt(8)
    ds_read_b64_tr_b16 v[96:97], v20 offset:4096
    ds_read_b64_tr_b16 v[98:99], v20 offset:4608
    ds_read_b64_tr_b16 v[100:101], v20 offset:6144
    ds_read_b64_tr_b16 v[102:103], v20 offset:6656
    ds_read_b64_tr_b16 v[104:105], v20 offset:4112
    ds_read_b64_tr_b16 v[106:107], v20 offset:4624
    ds_read_b64_tr_b16 v[108:109], v20 offset:6160
    ds_read_b64_tr_b16 v[110:111], v20 offset:6672
    s_waitcnt lgkmcnt(6)
    v_mfma_f32_16x16x32_bf16 v[160:163], v[96:99], v[48:51], 0
    s_waitcnt lgkmcnt(2)
    v_mfma_f32_16x16x32_bf16 v[176:179], v[104:107], v[48:51], 0
    v_mfma_f32_16x16x32_bf16 v[160:163], v[100:103], v[52:55], v[160:163]
    s_waitcnt lgkmcnt(0)
    v_mfma_f32_16x16x32_bf16 v[176:179], v[108:111], v[52:55], v[176:179]
    v_mfma_f32_16x16x32_bf16 v[164:167], v[96:99], v[56:59], 0
    v_mfma_f32_16x16x32_bf16 v[180:183], v[104:107], v[56:59], 0
    v_mfma_f32_16x16x32_bf16 v[164:167], v[100:103], v[60:63], v[164:167]
    v_mfma_f32_16x16x32_bf16 v[180:183], v[108:111], v[60:63], v[180:183]
    v_mfma_f32_16x16x32_bf16 v[168:171], v[96:99], v[64:67], 0
    v_mfma_f32_16x16x32_bf16 v[184:187], v[104:107], v[64:67], 0
    v_mfma_f32_16x16x32_bf16 v[168:171], v[100:103], v[68:71], v[168:171]
    v_mfma_f32_16x16x32_bf16 v[184:187], v[108:111], v[68:71], v[184:187]
    v_mfma_f32_16x16x32_bf16 v[172:175], v[96:99], v[72:75], 0
    v_mfma_f32_16x16x32_bf16 v[188:191], v[104:107], v[72:75], 0
    v_mfma_f32_16x16x32_bf16 v[172:175], v[100:103], v[76:79], v[172:175]
    v_mfma_f32_16x16x32_bf16 v[188:191], v[108:111], v[76:79], v[188:191]
    v_cvt_pk_bf16_f32 v224, v160, v161
    v_cvt_pk_bf16_f32 v225, v162, v163
    v_cvt_pk_bf16_f32 v226, v176, v177
    v_cvt_pk_bf16_f32 v227, v178, v179
    buffer_store_dwordx4 v[224:227], v25, s[16:19], s35 offen offset:64 sc1
    v_cvt_pk_bf16_f32 v228, v164, v165
    v_cvt_pk_bf16_f32 v229, v166, v167
    v_cvt_pk_bf16_f32 v230, v180, v181
    v_cvt_pk_bf16_f32 v231, v182, v183
    buffer_store_dwordx4 v[228:231], v25, s[16:19], s37 offen offset:64 sc1
    v_cvt_pk_bf16_f32 v232, v168, v169
    v_cvt_pk_bf16_f32 v233, v170, v171
    v_cvt_pk_bf16_f32 v234, v184, v185
    v_cvt_pk_bf16_f32 v235, v186, v187
    buffer_store_dwordx4 v[232:235], v25, s[16:19], s38 offen offset:64 sc1
    v_cvt_pk_bf16_f32 v236, v172, v173
    v_cvt_pk_bf16_f32 v237, v174, v175
    v_cvt_pk_bf16_f32 v238, v188, v189
    v_cvt_pk_bf16_f32 v239, v190, v191
    buffer_store_dwordx4 v[236:239], v26, s[16:19], s39 offen offset:64 sc1
    s_waitcnt vmcnt(8)
    ds_read_b64_tr_b16 v[112:113], v20 offset:8192
    ds_read_b64_tr_b16 v[114:115], v20 offset:8704
    ds_read_b64_tr_b16 v[116:117], v20 offset:10240
    ds_read_b64_tr_b16 v[118:119], v20 offset:10752
    ds_read_b64_tr_b16 v[120:121], v20 offset:8208
    ds_read_b64_tr_b16 v[122:123], v20 offset:8720
    ds_read_b64_tr_b16 v[124:125], v20 offset:10256
    ds_read_b64_tr_b16 v[126:127], v20 offset:10768
    s_waitcnt lgkmcnt(6)
    v_mfma_f32_16x16x32_bf16 v[192:195], v[112:115], v[48:51], 0
    s_waitcnt lgkmcnt(2)
    v_mfma_f32_16x16x32_bf16 v[208:211], v[120:123], v[48:51], 0
    v_mfma_f32_16x16x32_bf16 v[192:195], v[116:119], v[52:55], v[192:195]
    s_waitcnt lgkmcnt(0)
    v_mfma_f32_16x16x32_bf16 v[208:211], v[124:127], v[52:55], v[208:211]
    v_mfma_f32_16x16x32_bf16 v[196:199], v[112:115], v[56:59], 0
    v_mfma_f32_16x16x32_bf16 v[212:215], v[120:123], v[56:59], 0
    v_mfma_f32_16x16x32_bf16 v[196:199], v[116:119], v[60:63], v[196:199]
    v_mfma_f32_16x16x32_bf16 v[212:215], v[124:127], v[60:63], v[212:215]
    v_mfma_f32_16x16x32_bf16 v[200:203], v[112:115], v[64:67], 0
    v_mfma_f32_16x16x32_bf16 v[216:219], v[120:123], v[64:67], 0
    v_mfma_f32_16x16x32_bf16 v[200:203], v[116:119], v[68:71], v[200:203]
    v_mfma_f32_16x16x32_bf16 v[216:219], v[124:127], v[68:71], v[216:219]
    v_mfma_f32_16x16x32_bf16 v[204:207], v[112:115], v[72:75], 0
    v_mfma_f32_16x16x32_bf16 v[220:223], v[120:123], v[72:75], 0
    v_mfma_f32_16x16x32_bf16 v[204:207], v[116:119], v[76:79], v[204:207]
    v_mfma_f32_16x16x32_bf16 v[220:223], v[124:127], v[76:79], v[220:223]
    v_cvt_pk_bf16_f32 v224, v192, v193
    v_cvt_pk_bf16_f32 v225, v194, v195
    v_cvt_pk_bf16_f32 v226, v208, v209
    v_cvt_pk_bf16_f32 v227, v210, v211
    buffer_store_dwordx4 v[224:227], v25, s[16:19], s35 offen offset:128 sc1
    v_cvt_pk_bf16_f32 v228, v196, v197
    v_cvt_pk_bf16_f32 v229, v198, v199
    v_cvt_pk_bf16_f32 v230, v212, v213
    v_cvt_pk_bf16_f32 v231, v214, v215
    buffer_store_dwordx4 v[228:231], v25, s[16:19], s37 offen offset:128 sc1
    v_cvt_pk_bf16_f32 v232, v200, v201
    v_cvt_pk_bf16_f32 v233, v202, v203
    v_cvt_pk_bf16_f32 v234, v216, v217
    v_cvt_pk_bf16_f32 v235, v218, v219
    buffer_store_dwordx4 v[232:235], v25, s[16:19], s38 offen offset:128 sc1
    v_cvt_pk_bf16_f32 v236, v204, v205
    v_cvt_pk_bf16_f32 v237, v206, v207
    v_cvt_pk_bf16_f32 v238, v220, v221
    v_cvt_pk_bf16_f32 v239, v222, v223
    buffer_store_dwordx4 v[236:239], v26, s[16:19], s39 offen offset:128 sc1
K3_end:
    s_endpgm
.p2align 8
.type fft_tables,@object
fft_tables:
.long 0x3f803f80, 0x3f803f80, 0x3f803f80, 0x00003f80, 0x00000000, 0x00000000, 0x00000000, 0x00000000
.long 0x3f7f3f80, 0x3f743f7b, 0x3f603f6b, 0x00003f52, 0xbdcf0000, 0xbe99be4e, 0xbef8beca, 0x0000bf12
.long 0x00000000, 0x00000000, 0x00000000, 0x00000000, 0x00000000, 0x00000000, 0x00000000, 0x00000000
.long 0x00000000, 0x00000000, 0x00000000, 0x00000000, 0x00000000, 0x00000000, 0x00000000, 0x00000000
.long 0x00000000, 0x00000000, 0x00000000, 0x00000000, 0x00000000, 0x00000000, 0x00000000, 0x00000000
.long 0x00000000, 0x00000000, 0x00000000, 0x00000000, 0x00000000, 0x00000000, 0x00000000, 0x00000000
.long 0x00000000, 0x00000000, 0x00000000, 0x00000000, 0x00000000, 0x00000000, 0x00000000, 0x00000000
.long 0x00000000, 0x00000000, 0x00000000, 0x00000000, 0x00000000, 0x00000000, 0x00000000, 0x00000000
.long 0x00000000, 0x00000000, 0x00000000, 0x00000000, 0x00000000, 0x00000000, 0x00000000, 0x00000000
.long 0x00000000, 0x00000000, 0x00000000, 0x00000000, 0x00000000, 0x00000000, 0x00000000, 0x00000000
.long 0x3f803f80, 0x3f803f80, 0x3f803f80, 0x00003f80, 0x00000000, 0x00000000, 0x00000000, 0x00000000
.long 0x3f7f3f80, 0x3f743f7b, 0x3f603f6b, 0x00003f52, 0xbdcf0000, 0xbe99be4e, 0xbef8beca, 0x0000bf12
.long 0x00000000, 0x00000000, 0x00000000, 0x00000000, 0x00000000, 0x00000000, 0x00000000, 0x00000000
.long 0x00000000, 0x00000000, 0x00000000, 0x00000000, 0x00000000, 0x00000000, 0x00000000, 0x00000000
.long 0x00000000, 0x00000000, 0x00000000, 0x00000000, 0x00000000, 0x00000000, 0x00000000, 0x00000000
.long 0x00000000, 0x00000000, 0x00000000, 0x00000000, 0x00000000, 0x00000000, 0x00000000, 0x00000000
.long 0x00000000, 0x00000000, 0x00000000, 0x00000000, 0x00000000, 0x00000000, 0x00000000, 0x00000000
.long 0x00000000, 0x00000000, 0x00000000, 0x00000000, 0x00000000, 0x00000000, 0x00000000, 0x00000000
.long 0x00000000, 0x00000000, 0x00000000, 0x00000000, 0x00000000, 0x00000000, 0x00000000, 0x00000000
.long 0x00000000, 0x00000000, 0x00000000, 0x00000000, 0x00000000, 0x00000000, 0x00000000, 0x00000000
.long 0x3f803f80, 0x3f803f80, 0x3f803f80, 0x00003f80, 0x00000000, 0x00000000, 0x00000000, 0x00000000
.long 0x3f7f3f80, 0x3f743f7b, 0x3f603f6b, 0x00003f52, 0xbdcf0000, 0xbe99be4e, 0xbef8beca, 0x0000bf12
.long 0x00000000, 0x00000000, 0x00000000, 0x00000000, 0x00000000, 0x00000000, 0x00000000, 0x00000000
.long 0x00000000, 0x00000000, 0x00000000, 0x00000000, 0x00000000, 0x00000000, 0x00000000, 0x00000000
.long 0x00000000, 0x00000000, 0x00000000, 0x00000000, 0x00000000, 0x00000000, 0x00000000, 0x00000000
.long 0x00000000, 0x00000000, 0x00000000, 0x00000000, 0x00000000, 0x00000000, 0x00000000, 0x00000000
.long 0x00000000, 0x00000000, 0x00000000, 0x00000000, 0x00000000, 0x00000000, 0x00000000, 0x00000000
.long 0x00000000, 0x00000000, 0x00000000, 0x00000000, 0x00000000, 0x00000000, 0x00000000, 0x00000000
.long 0x00000000, 0x00000000, 0x00000000, 0x00000000, 0x00000000, 0x00000000, 0x00000000, 0x00000000
.long 0x00000000, 0x00000000, 0x00000000, 0x00000000, 0x00000000, 0x00000000, 0x00000000, 0x00000000
.long 0x3f803f80, 0x3f803f80, 0x3f803f80, 0x00003f80, 0x00000000, 0x00000000, 0x00000000, 0x00000000
.long 0x3f7f3f80, 0x3f743f7b, 0x3f603f6b, 0x00003f52, 0xbdcf0000, 0xbe99be4e, 0xbef8beca, 0x0000bf12
.long 0x3f7b3f80, 0x3f523f6b, 0x3f073f30, 0x00003eb2, 0xbe4e0000, 0xbf12beca, 0xbf59bf3a, 0x0000bf70
.long 0x3f743f80, 0x3f1d3f52, 0x3d4f3eb2, 0x0000be80, 0xbe990000, 0xbf4abf12, 0xbf80bf70, 0x0000bf78
.long 0x00000000, 0x00000000, 0x00000000, 0x00000000, 0x00000000, 0x00000000, 0x00000000, 0x00000000
.long 0x00000000, 0x00000000, 0x00000000, 0x00000000, 0x00000000, 0x00000000, 0x00000000, 0x00000000
.long 0x00000000, 0x00000000, 0x00000000, 0x00000000, 0x00000000, 0x00000000, 0x00000000, 0x00000000
.long 0x00000000, 0x00000000, 0x00000000, 0x00000000, 0x00000000, 0x00000000, 0x00000000, 0x00000000
.long 0x00000000, 0x00000000, 0x00000000, 0x00000000, 0x00000000, 0x00000000, 0x00000000, 0x00000000
.long 0x00000000, 0x00000000, 0x00000000, 0x00000000, 0x00000000, 0x00000000, 0x00000000, 0x00000000
.long 0x00000000, 0x00000000, 0x00000000, 0x00000000, 0x00000000, 0x00000000, 0x00000000, 0x00000000
.long 0x00000000, 0x00000000, 0x00000000, 0x00000000, 0x00000000, 0x00000000, 0x00000000, 0x00000000
.long 0x3f7b3f80, 0x3f523f6b, 0x3f073f30, 0x00003eb2, 0xbe4e0000, 0xbf12beca, 0xbf59bf3a, 0x0000bf70
.long 0x3f743f80, 0x3f1d3f52, 0x3d4f3eb2, 0x0000be80, 0xbe990000, 0xbf4abf12, 0xbf80bf70, 0x0000bf78
.long 0x00000000, 0x00000000, 0x00000000, 0x00000000, 0x00000000, 0x00000000, 0x00000000, 0x00000000
.long 0x00000000, 0x00000000, 0x00000000, 0x00000000, 0x00000000, 0x00000000, 0x00000000, 0x00000000
.long 0x00000000, 0x00000000, 0x00000000, 0x00000000, 0x00000000, 0x00000000, 0x00000000, 0x00000000
.long 0x00000000, 0x00000000, 0x00000000, 0x00000000, 0x00000000, 0x00000000, 0x00000000, 0x00000000
.long 0x00000000, 0x00000000, 0x00000000, 0x00000000, 0x00000000, 0x00000000, 0x00000000, 0x00000000
.long 0x00000000, 0x00000000, 0x00000000, 0x00000000, 0x00000000, 0x00000000, 0x00000000, 0x00000000
.long 0x00000000, 0x00000000, 0x00000000, 0x00000000, 0x00000000, 0x00000000, 0x00000000, 0x00000000
.long 0x00000000, 0x00000000, 0x00000000, 0x00000000, 0x00000000, 0x00000000, 0x00000000, 0x00000000
.long 0x3f7b3f80, 0x3f523f6b, 0x3f073f30, 0x00003eb2, 0xbe4e0000, 0xbf12beca, 0xbf59bf3a, 0x0000bf70
.long 0x3f743f80, 0x3f1d3f52, 0x3d4f3eb2, 0x0000be80, 0xbe990000, 0xbf4abf12, 0xbf80bf70, 0x0000bf78
.long 0x00000000, 0x00000000, 0x00000000, 0x00000000, 0x00000000, 0x00000000, 0x00000000, 0x00000000
.long 0x00000000, 0x00000000, 0x00000000, 0x00000000, 0x00000000, 0x00000000, 0x00000000, 0x00000000
.long 0x00000000, 0x00000000, 0x00000000, 0x00000000, 0x00000000, 0x00000000, 0x00000000, 0x00000000
.long 0x00000000, 0x00000000, 0x00000000, 0x00000000, 0x00000000, 0x00000000, 0x00000000, 0x00000000
.long 0x00000000, 0x00000000, 0x00000000, 0x00000000, 0x00000000, 0x00000000, 0x00000000, 0x00000000
.long 0x00000000, 0x00000000, 0x00000000, 0x00000000, 0x00000000, 0x00000000, 0x00000000, 0x00000000
.long 0x00000000, 0x00000000, 0x00000000, 0x00000000, 0x00000000, 0x00000000, 0x00000000, 0x00000000
.long 0x00000000, 0x00000000, 0x00000000, 0x00000000, 0x00000000, 0x00000000, 0x00000000, 0x00000000
.long 0x3f7b3f80, 0x3f523f6b, 0x3f073f30, 0x00003eb2, 0xbe4e0000, 0xbf12beca, 0xbf59bf3a, 0x0000bf70
.long 0x3f743f80, 0x3f1d3f52, 0x3d4f3eb2, 0x0000be80, 0xbe990000, 0xbf4abf12, 0xbf80bf70, 0x0000bf78
.long 0x3f6b3f80, 0x3eb23f30, 0xbee1bd4f, 0x0000bf42, 0xbeca0000, 0xbf70bf3a, 0xbf66bf80, 0x0000bf27
.long 0x3f603f80, 0x3d4f3f07, 0xbf52bee1, 0x0000bf7f, 0xbef80000, 0xbf80bf59, 0xbf12bf66, 0x0000bdcf
.long 0x00000000, 0x00000000, 0x00000000, 0x00000000, 0x00000000, 0x00000000, 0x00000000, 0x00000000
.long 0x00000000, 0x00000000, 0x00000000, 0x00000000, 0x00000000, 0x00000000, 0x00000000, 0x00000000
.long 0x00000000, 0x00000000, 0x00000000, 0x00000000, 0x00000000, 0x00000000, 0x00000000, 0x00000000
.long 0x00000000, 0x00000000, 0x00000000, 0x00000000, 0x00000000, 0x00000000, 0x00000000, 0x00000000
.long 0x00000000, 0x00000000, 0x00000000, 0x00000000, 0x00000000, 0x00000000, 0x00000000, 0x00000000
.long 0x00000000, 0x00000000, 0x00000000, 0x00000000, 0x00000000, 0x00000000, 0x00000000, 0x00000000
.long 0x00000000, 0x00000000, 0x00000000, 0x00000000, 0x00000000, 0x00000000, 0x00000000, 0x00000000
.long 0x00000000, 0x00000000, 0x00000000, 0x00000000, 0x00000000, 0x00000000, 0x00000000, 0x00000000
.long 0x3f6b3f80, 0x3eb23f30, 0xbee1bd4f, 0x0000bf42, 0xbeca0000, 0xbf70bf3a, 0xbf66bf80, 0x0000bf27
.long 0x3f603f80, 0x3d4f3f07, 0xbf52bee1, 0x0000bf7f, 0xbef80000, 0xbf80bf59, 0xbf12bf66, 0x0000bdcf
.long 0x00000000, 0x00000000, 0x00000000, 0x00000000, 0x00000000, 0x00000000, 0x00000000, 0x00000000
.long 0x00000000, 0x00000000, 0x00000000, 0x00000000, 0x00000000, 0x00000000, 0x00000000, 0x00000000
.long 0x00000000, 0x00000000, 0x00000000, 0x00000000, 0x00000000, 0x00000000, 0x00000000, 0x00000000
.long 0x00000000, 0x00000000, 0x00000000, 0x00000000, 0x00000000, 0x00000000, 0x00000000, 0x00000000
.long 0x00000000, 0x00000000, 0x00000000, 0x00000000, 0x00000000, 0x00000000, 0x00000000, 0x00000000
.long 0x00000000, 0x00000000, 0x00000000, 0x00000000, 0x00000000, 0x00000000, 0x00000000, 0x00000000
.long 0x00000000, 0x00000000, 0x00000000, 0x00000000, 0x00000000, 0x00000000, 0x00000000, 0x00000000
.long 0x00000000, 0x00000000, 0x00000000, 0x00000000, 0x00000000, 0x00000000, 0x00000000, 0x00000000
.long 0x3f6b3f80, 0x3eb23f30, 0xbee1bd4f, 0x0000bf42, 0xbeca0000, 0xbf70bf3a, 0xbf66bf80, 0x0000bf27
.long 0x3f603f80, 0x3d4f3f07, 0xbf52bee1, 0x0000bf7f, 0xbef80000, 0xbf80bf59, 0xbf12bf66, 0x0000bdcf
.long 0x00000000, 0x00000000, 0x00000000, 0x00000000, 0x00000000, 0x00000000, 0x00000000, 0x00000000
.long 0x00000000, 0x00000000, 0x00000000, 0x00000000, 0x00000000, 0x00000000, 0x00000000, 0x00000000
.long 0x00000000, 0x00000000, 0x00000000, 0x00000000, 0x00000000, 0x00000000, 0x00000000, 0x00000000
.long 0x00000000, 0x00000000, 0x00000000, 0x00000000, 0x00000000, 0x00000000, 0x00000000, 0x00000000
.long 0x00000000, 0x00000000, 0x00000000, 0x00000000, 0x00000000, 0x00000000, 0x00000000, 0x00000000
.long 0x00000000, 0x00000000, 0x00000000, 0x00000000, 0x00000000, 0x00000000, 0x00000000, 0x00000000
.long 0x00000000, 0x00000000, 0x00000000, 0x00000000, 0x00000000, 0x00000000, 0x00000000, 0x00000000
.long 0x00000000, 0x00000000, 0x00000000, 0x00000000, 0x00000000, 0x00000000, 0x00000000, 0x00000000
.long 0x3f6b3f80, 0x3eb23f30, 0xbee1bd4f, 0x0000bf42, 0xbeca0000, 0xbf70bf3a, 0xbf66bf80, 0x0000bf27
.long 0x3f603f80, 0x3d4f3f07, 0xbf52bee1, 0x0000bf7f, 0xbef80000, 0xbf80bf59, 0xbf12bf66, 0x0000bdcf
.long 0x3f523f80, 0xbe803eb2, 0xbf7fbf42, 0x0000bf60, 0xbf120000, 0xbf78bf70, 0xbdcfbf27, 0x00003ef8
.long 0x3f423f80, 0xbf073e1b, 0xbf6bbf74, 0x0000bee1, 0xbf270000, 0xbf59bf7d, 0x3ecabe99, 0x00003f66
.long 0x00000000, 0x00000000, 0x00000000, 0x00000000, 0x00000000, 0x00000000, 0x00000000, 0x00000000
.long 0x00000000, 0x00000000, 0x00000000, 0x00000000, 0x00000000, 0x00000000, 0x00000000, 0x00000000
.long 0x00000000, 0x00000000, 0x00000000, 0x00000000, 0x00000000, 0x00000000, 0x00000000, 0x00000000
.long 0x00000000, 0x00000000, 0x00000000, 0x00000000, 0x00000000, 0x00000000, 0x00000000, 0x00000000
.long 0x00000000, 0x00000000, 0x00000000, 0x00000000, 0x00000000, 0x00000000, 0x00000000, 0x00000000
.long 0x00000000, 0x00000000, 0x00000000, 0x00000000, 0x00000000, 0x00000000, 0x00000000, 0x00000000
.long 0x00000000, 0x00000000, 0x00000000, 0x00000000, 0x00000000, 0x00000000, 0x00000000, 0x00000000
.long 0x00000000, 0x00000000, 0x00000000, 0x00000000, 0x00000000, 0x00000000, 0x00000000, 0x00000000
.long 0x3f523f80, 0xbe803eb2, 0xbf7fbf42, 0x0000bf60, 0xbf120000, 0xbf78bf70, 0xbdcfbf27, 0x00003ef8
.long 0x3f423f80, 0xbf073e1b, 0xbf6bbf74, 0x0000bee1, 0xbf270000, 0xbf59bf7d, 0x3ecabe99, 0x00003f66
.long 0x00000000, 0x00000000, 0x00000000, 0x00000000, 0x00000000, 0x00000000, 0x00000000, 0x00000000
.long 0x00000000, 0x00000000, 0x00000000, 0x00000000, 0x00000000, 0x00000000, 0x00000000, 0x00000000
.long 0x00000000, 0x00000000, 0x00000000, 0x00000000, 0x00000000, 0x00000000, 0x00000000, 0x00000000
.long 0x00000000, 0x00000000, 0x00000000, 0x00000000, 0x00000000, 0x00000000, 0x00000000, 0x00000000
.long 0x00000000, 0x00000000, 0x00000000, 0x00000000, 0x00000000, 0x00000000, 0x00000000, 0x00000000
.long 0x00000000, 0x00000000, 0x00000000, 0x00000000, 0x00000000, 0x00000000, 0x00000000, 0x00000000
.long 0x00000000, 0x00000000, 0x00000000, 0x00000000, 0x00000000, 0x00000000, 0x00000000, 0x00000000
.long 0x00000000, 0x00000000, 0x00000000, 0x00000000, 0x00000000, 0x00000000, 0x00000000, 0x00000000
.long 0x3f523f80, 0xbe803eb2, 0xbf7fbf42, 0x0000bf60, 0xbf120000, 0xbf78bf70, 0xbdcfbf27, 0x00003ef8
.long 0x3f423f80, 0xbf073e1b, 0xbf6bbf74, 0x0000bee1, 0xbf270000, 0xbf59bf7d, 0x3ecabe99, 0x00003f66
.long 0x00000000, 0x00000000, 0x00000000, 0x00000000, 0x00000000, 0x00000000, 0x00000000, 0x00000000
.long 0x00000000, 0x00000000, 0x00000000, 0x00000000, 0x00000000, 0x00000000, 0x00000000, 0x00000000
.long 0x00000000, 0x00000000, 0x00000000, 0x00000000, 0x00000000, 0x00000000, 0x00000000, 0x00000000
.long 0x00000000, 0x00000000, 0x00000000, 0x00000000, 0x00000000, 0x00000000, 0x00000000, 0x00000000
.long 0x00000000, 0x00000000, 0x00000000, 0x00000000, 0x00000000, 0x00000000, 0x00000000, 0x00000000
.long 0x00000000, 0x00000000, 0x00000000, 0x00000000, 0x00000000, 0x00000000, 0x00000000, 0x00000000
.long 0x00000000, 0x00000000, 0x00000000, 0x00000000, 0x00000000, 0x00000000, 0x00000000, 0x00000000
.long 0x00000000, 0x00000000, 0x00000000, 0x00000000, 0x00000000, 0x00000000, 0x00000000, 0x00000000
.long 0x3f523f80, 0xbe803eb2, 0xbf7fbf42, 0x0000bf60, 0xbf120000, 0xbf78bf70, 0xbdcfbf27, 0x00003ef8
.long 0x3f423f80, 0xbf073e1b, 0xbf6bbf74, 0x0000bee1, 0xbf270000, 0xbf59bf7d, 0x3ecabe99, 0x00003f66
.long 0x3f303f80, 0xbf42bd4f, 0xbf1dbf7f, 0x00003e1b, 0xbf3a0000, 0xbf27bf80, 0x3f4a3dcf, 0x00003f7d
.long 0x3f1d3f80, 0xbf6bbe80, 0xbe1bbf60, 0x00003f30, 0xbf4a0000, 0xbecabf78, 0x3f7d3ef8, 0x00003f3a
.long 0x00000000, 0x00000000, 0x00000000, 0x00000000, 0x00000000, 0x00000000, 0x00000000, 0x00000000
.long 0x00000000, 0x00000000, 0x00000000, 0x00000000, 0x00000000, 0x00000000, 0x00000000, 0x00000000
.long 0x00000000, 0x00000000, 0x00000000, 0x00000000, 0x00000000, 0x00000000, 0x00000000, 0x00000000
.long 0x00000000, 0x00000000, 0x00000000, 0x00000000, 0x00000000, 0x00000000, 0x00000000, 0x00000000
.long 0x00000000, 0x00000000, 0x00000000, 0x00000000, 0x00000000, 0x00000000, 0x00000000, 0x00000000
.long 0x00000000, 0x00000000, 0x00000000, 0x00000000, 0x00000000, 0x00000000, 0x00000000, 0x00000000
.long 0x00000000, 0x00000000, 0x00000000, 0x00000000, 0x00000000, 0x00000000, 0x00000000, 0x00000000
.long 0x00000000, 0x00000000, 0x00000000, 0x00000000, 0x00000000, 0x00000000, 0x00000000, 0x00000000
.long 0x3f303f80, 0xbf42bd4f, 0xbf1dbf7f, 0x00003e1b, 0xbf3a0000, 0xbf27bf80, 0x3f4a3dcf, 0x00003f7d
.long 0x3f1d3f80, 0xbf6bbe80, 0xbe1bbf60, 0x00003f30, 0xbf4a0000, 0xbecabf78, 0x3f7d3ef8, 0x00003f3a
.long 0x00000000, 0x00000000, 0x00000000, 0x00000000, 0x00000000, 0x00000000, 0x00000000, 0x00000000
.long 0x00000000, 0x00000000, 0x00000000, 0x00000000, 0x00000000, 0x00000000, 0x00000000, 0x00000000
.long 0x00000000, 0x00000000, 0x00000000, 0x00000000, 0x00000000, 0x00000000, 0x00000000, 0x00000000
.long 0x00000000, 0x00000000, 0x00000000, 0x00000000, 0x00000000, 0x00000000, 0x00000000, 0x00000000
.long 0x00000000, 0x00000000, 0x00000000, 0x00000000, 0x00000000, 0x00000000, 0x00000000, 0x00000000
.long 0x00000000, 0x00000000, 0x00000000, 0x00000000, 0x00000000, 0x00000000, 0x00000000, 0x00000000
.long 0x00000000, 0x00000000, 0x00000000, 0x00000000, 0x00000000, 0x00000000, 0x00000000, 0x00000000
.long 0x00000000, 0x00000000, 0x00000000, 0x00000000, 0x00000000, 0x00000000, 0x00000000, 0x00000000
.long 0x3f303f80, 0xbf42bd4f, 0xbf1dbf7f, 0x00003e1b, 0xbf3a0000, 0xbf27bf80, 0x3f4a3dcf, 0x00003f7d
.long 0x3f1d3f80, 0xbf6bbe80, 0xbe1bbf60, 0x00003f30, 0xbf4a0000, 0xbecabf78, 0x3f7d3ef8, 0x00003f3a
.long 0x00000000, 0x00000000, 0x00000000, 0x00000000, 0x00000000, 0x00000000, 0x00000000, 0x00000000
.long 0x00000000, 0x00000000, 0x00000000, 0x00000000, 0x00000000, 0x00000000, 0x00000000, 0x00000000
.long 0x00000000, 0x00000000, 0x00000000, 0x00000000, 0x00000000, 0x00000000, 0x00000000, 0x00000000
.long 0x00000000, 0x00000000, 0x00000000, 0x00000000, 0x00000000, 0x00000000, 0x00000000, 0x00000000
.long 0x00000000, 0x00000000, 0x00000000, 0x00000000, 0x00000000, 0x00000000, 0x00000000, 0x00000000
.long 0x00000000, 0x00000000, 0x00000000, 0x00000000, 0x00000000, 0x00000000, 0x00000000, 0x00000000
.long 0x00000000, 0x00000000, 0x00000000, 0x00000000, 0x00000000, 0x00000000, 0x00000000, 0x00000000
.long 0x00000000, 0x00000000, 0x00000000, 0x00000000, 0x00000000, 0x00000000, 0x00000000, 0x00000000
.long 0x3f303f80, 0xbf42bd4f, 0xbf1dbf7f, 0x00003e1b, 0xbf3a0000, 0xbf27bf80, 0x3f4a3dcf, 0x00003f7d
.long 0x3f1d3f80, 0xbf6bbe80, 0xbe1bbf60, 0x00003f30, 0xbf4a0000, 0xbecabf78, 0x3f7d3ef8, 0x00003f3a
.long 0x3f073f80, 0xbf7fbee1, 0x3eb2bf1d, 0x00003f7b, 0xbf590000, 0xbdcfbf66, 0x3f703f4a, 0x00003e4e
.long 0x3ee13f80, 0xbf7bbf1d, 0x3f42be80, 0x00003f6b, 0xbf660000, 0x3e4ebf4a, 0x3f273f78, 0x0000beca
.long 0x00000000, 0x00000000, 0x00000000, 0x00000000, 0x00000000, 0x00000000, 0x00000000, 0x00000000
.long 0x00000000, 0x00000000, 0x00000000, 0x00000000, 0x00000000, 0x00000000, 0x00000000, 0x00000000
.long 0x00000000, 0x00000000, 0x00000000, 0x00000000, 0x00000000, 0x00000000, 0x00000000, 0x00000000
.long 0x00000000, 0x00000000, 0x00000000, 0x00000000, 0x00000000, 0x00000000, 0x00000000, 0x00000000
.long 0x00000000, 0x00000000, 0x00000000, 0x00000000, 0x00000000, 0x00000000, 0x00000000, 0x00000000
.long 0x00000000, 0x00000000, 0x00000000, 0x00000000, 0x00000000, 0x00000000, 0x00000000, 0x00000000
.long 0x00000000, 0x00000000, 0x00000000, 0x00000000, 0x00000000, 0x00000000, 0x00000000, 0x00000000
.long 0x00000000, 0x00000000, 0x00000000, 0x00000000, 0x00000000, 0x00000000, 0x00000000, 0x00000000
.long 0x3f073f80, 0xbf7fbee1, 0x3eb2bf1d, 0x00003f7b, 0xbf590000, 0xbdcfbf66, 0x3f703f4a, 0x00003e4e
.long 0x3ee13f80, 0xbf7bbf1d, 0x3f42be80, 0x00003f6b, 0xbf660000, 0x3e4ebf4a, 0x3f273f78, 0x0000beca
.long 0x00000000, 0x00000000, 0x00000000, 0x00000000, 0x00000000, 0x00000000, 0x00000000, 0x00000000
.long 0x00000000, 0x00000000, 0x00000000, 0x00000000, 0x00000000, 0x00000000, 0x00000000, 0x00000000
.long 0x00000000, 0x00000000, 0x00000000, 0x00000000, 0x00000000, 0x00000000, 0x00000000, 0x00000000
.long 0x00000000, 0x00000000, 0x00000000, 0x00000000, 0x00000000, 0x00000000, 0x00000000, 0x00000000
.long 0x00000000, 0x00000000, 0x00000000, 0x00000000, 0x00000000, 0x00000000, 0x00000000, 0x00000000
.long 0x00000000, 0x00000000, 0x00000000, 0x00000000, 0x00000000, 0x00000000, 0x00000000, 0x00000000
.long 0x00000000, 0x00000000, 0x00000000, 0x00000000, 0x00000000, 0x00000000, 0x00000000, 0x00000000
.long 0x00000000, 0x00000000, 0x00000000, 0x00000000, 0x00000000, 0x00000000, 0x00000000, 0x00000000
.long 0x3f073f80, 0xbf7fbee1, 0x3eb2bf1d, 0x00003f7b, 0xbf590000, 0xbdcfbf66, 0x3f703f4a, 0x00003e4e
.long 0x3ee13f80, 0xbf7bbf1d, 0x3f42be80, 0x00003f6b, 0xbf660000, 0x3e4ebf4a, 0x3f273f78, 0x0000beca
.long 0x00000000, 0x00000000, 0x00000000, 0x00000000, 0x00000000, 0x00000000, 0x00000000, 0x00000000
.long 0x00000000, 0x00000000, 0x00000000, 0x00000000, 0x00000000, 0x00000000, 0x00000000, 0x00000000
.long 0x00000000, 0x00000000, 0x00000000, 0x00000000, 0x00000000, 0x00000000, 0x00000000, 0x00000000
.long 0x00000000, 0x00000000, 0x00000000, 0x00000000, 0x00000000, 0x00000000, 0x00000000, 0x00000000
.long 0x00000000, 0x00000000, 0x00000000, 0x00000000, 0x00000000, 0x00000000, 0x00000000, 0x00000000
.long 0x00000000, 0x00000000, 0x00000000, 0x00000000, 0x00000000, 0x00000000, 0x00000000, 0x00000000
.long 0x00000000, 0x00000000, 0x00000000, 0x00000000, 0x00000000, 0x00000000, 0x00000000, 0x00000000
.long 0x00000000, 0x00000000, 0x00000000, 0x00000000, 0x00000000, 0x00000000, 0x00000000, 0x00000000
.long 0x3f073f80, 0xbf7fbee1, 0x3eb2bf1d, 0x00003f7b, 0xbf590000, 0xbdcfbf66, 0x3f703f4a, 0x00003e4e
.long 0x3ee13f80, 0xbf7bbf1d, 0x3f42be80, 0x00003f6b, 0xbf660000, 0x3e4ebf4a, 0x3f273f78, 0x0000beca
.long 0x3eb23f80, 0xbf60bf42, 0x3f7b3e1b, 0x00003f07, 0xbf700000, 0x3ef8bf27, 0x3e4e3f7d, 0x0000bf59
.long 0x3e803f80, 0xbf30bf60, 0x3f743f07, 0x0000bd4f, 0xbf780000, 0x3f3abef8, 0xbe993f59, 0x0000bf80
.long 0x00000000, 0x00000000, 0x00000000, 0x00000000, 0x00000000, 0x00000000, 0x00000000, 0x00000000
.long 0x00000000, 0x00000000, 0x00000000, 0x00000000, 0x00000000, 0x00000000, 0x00000000, 0x00000000
.long 0x00000000, 0x00000000, 0x00000000, 0x00000000, 0x00000000, 0x00000000, 0x00000000, 0x00000000
.long 0x00000000, 0x00000000, 0x00000000, 0x00000000, 0x00000000, 0x00000000, 0x00000000, 0x00000000
.long 0x00000000, 0x00000000, 0x00000000, 0x00000000, 0x00000000, 0x00000000, 0x00000000, 0x00000000
.long 0x00000000, 0x00000000, 0x00000000, 0x00000000, 0x00000000, 0x00000000, 0x00000000, 0x00000000
.long 0x00000000, 0x00000000, 0x00000000, 0x00000000, 0x00000000, 0x00000000, 0x00000000, 0x00000000
.long 0x00000000, 0x00000000, 0x00000000, 0x00000000, 0x00000000, 0x00000000, 0x00000000, 0x00000000
.long 0x3eb23f80, 0xbf60bf42, 0x3f7b3e1b, 0x00003f07, 0xbf700000, 0x3ef8bf27, 0x3e4e3f7d, 0x0000bf59
.long 0x3e803f80, 0xbf30bf60, 0x3f743f07, 0x0000bd4f, 0xbf780000, 0x3f3abef8, 0xbe993f59, 0x0000bf80
.long 0x00000000, 0x00000000, 0x00000000, 0x00000000, 0x00000000, 0x00000000, 0x00000000, 0x00000000
.long 0x00000000, 0x00000000, 0x00000000, 0x00000000, 0x00000000, 0x00000000, 0x00000000, 0x00000000
.long 0x00000000, 0x00000000, 0x00000000, 0x00000000, 0x00000000, 0x00000000, 0x00000000, 0x00000000
.long 0x00000000, 0x00000000, 0x00000000, 0x00000000, 0x00000000, 0x00000000, 0x00000000, 0x00000000
.long 0x00000000, 0x00000000, 0x00000000, 0x00000000, 0x00000000, 0x00000000, 0x00000000, 0x00000000
.long 0x00000000, 0x00000000, 0x00000000, 0x00000000, 0x00000000, 0x00000000, 0x00000000, 0x00000000
.long 0x00000000, 0x00000000, 0x00000000, 0x00000000, 0x00000000, 0x00000000, 0x00000000, 0x00000000
.long 0x00000000, 0x00000000, 0x00000000, 0x00000000, 0x00000000, 0x00000000, 0x00000000, 0x00000000
.long 0x3eb23f80, 0xbf60bf42, 0x3f7b3e1b, 0x00003f07, 0xbf700000, 0x3ef8bf27, 0x3e4e3f7d, 0x0000bf59
.long 0x3e803f80, 0xbf30bf60, 0x3f743f07, 0x0000bd4f, 0xbf780000, 0x3f3abef8, 0xbe993f59, 0x0000bf80
.long 0x00000000, 0x00000000, 0x00000000, 0x00000000, 0x00000000, 0x00000000, 0x00000000, 0x00000000
.long 0x00000000, 0x00000000, 0x00000000, 0x00000000, 0x00000000, 0x00000000, 0x00000000, 0x00000000
.long 0x00000000, 0x00000000, 0x00000000, 0x00000000, 0x00000000, 0x00000000, 0x00000000, 0x00000000
.long 0x00000000, 0x00000000, 0x00000000, 0x00000000, 0x00000000, 0x00000000, 0x00000000, 0x00000000
.long 0x00000000, 0x00000000, 0x00000000, 0x00000000, 0x00000000, 0x00000000, 0x00000000, 0x00000000
.long 0x00000000, 0x00000000, 0x00000000, 0x00000000, 0x00000000, 0x00000000, 0x00000000, 0x00000000
.long 0x00000000, 0x00000000, 0x00000000, 0x00000000, 0x00000000, 0x00000000, 0x00000000, 0x00000000
.long 0x00000000, 0x00000000, 0x00000000, 0x00000000, 0x00000000, 0x00000000, 0x00000000, 0x00000000
.long 0x3eb23f80, 0xbf60bf42, 0x3f7b3e1b, 0x00003f07, 0xbf700000, 0x3ef8bf27, 0x3e4e3f7d, 0x0000bf59
.long 0x3e803f80, 0xbf30bf60, 0x3f743f07, 0x0000bd4f, 0xbf780000, 0x3f3abef8, 0xbe993f59, 0x0000bf80
.long 0x3e1b3f80, 0xbee1bf74, 0x3f303f52, 0x0000bf1d, 0xbf7d0000, 0x3f66be99, 0xbf3a3f12, 0x0000bf4a
.long 0x3d4f3f80, 0xbe1bbf7f, 0x3e803f7b, 0x0000bf74, 0xbf800000, 0x3f7dbdcf, 0xbf783e4e, 0x0000be99
.long 0x00000000, 0x00000000, 0x00000000, 0x00000000, 0x00000000, 0x00000000, 0x00000000, 0x00000000
.long 0x00000000, 0x00000000, 0x00000000, 0x00000000, 0x00000000, 0x00000000, 0x00000000, 0x00000000
.long 0x00000000, 0x00000000, 0x00000000, 0x00000000, 0x00000000, 0x00000000, 0x00000000, 0x00000000
.long 0x00000000, 0x00000000, 0x00000000, 0x00000000, 0x00000000, 0x00000000, 0x00000000, 0x00000000
.long 0x00000000, 0x00000000, 0x00000000, 0x00000000, 0x00000000, 0x00000000, 0x00000000, 0x00000000
.long 0x00000000, 0x00000000, 0x00000000, 0x00000000, 0x00000000, 0x00000000, 0x00000000, 0x00000000
.long 0x00000000, 0x00000000, 0x00000000, 0x00000000, 0x00000000, 0x00000000, 0x00000000, 0x00000000
.long 0x00000000, 0x00000000, 0x00000000, 0x00000000, 0x00000000, 0x00000000, 0x00000000, 0x00000000
.long 0x3e1b3f80, 0xbee1bf74, 0x3f303f52, 0x0000bf1d, 0xbf7d0000, 0x3f66be99, 0xbf3a3f12, 0x0000bf4a
.long 0x3d4f3f80, 0xbe1bbf7f, 0x3e803f7b, 0x0000bf74, 0xbf800000, 0x3f7dbdcf, 0xbf783e4e, 0x0000be99
.long 0x00000000, 0x00000000, 0x00000000, 0x00000000, 0x00000000, 0x00000000, 0x00000000, 0x00000000
.long 0x00000000, 0x00000000, 0x00000000, 0x00000000, 0x00000000, 0x00000000, 0x00000000, 0x00000000
.long 0x00000000, 0x00000000, 0x00000000, 0x00000000, 0x00000000, 0x00000000, 0x00000000, 0x00000000
.long 0x00000000, 0x00000000, 0x00000000, 0x00000000, 0x00000000, 0x00000000, 0x00000000, 0x00000000
.long 0x00000000, 0x00000000, 0x00000000, 0x00000000, 0x00000000, 0x00000000, 0x00000000, 0x00000000
.long 0x00000000, 0x00000000, 0x00000000, 0x00000000, 0x00000000, 0x00000000, 0x00000000, 0x00000000
.long 0x00000000, 0x00000000, 0x00000000, 0x00000000, 0x00000000, 0x00000000, 0x00000000, 0x00000000
.long 0x00000000, 0x00000000, 0x00000000, 0x00000000, 0x00000000, 0x00000000, 0x00000000, 0x00000000
.long 0x3e1b3f80, 0xbee1bf74, 0x3f303f52, 0x0000bf1d, 0xbf7d0000, 0x3f66be99, 0xbf3a3f12, 0x0000bf4a
.long 0x3d4f3f80, 0xbe1bbf7f, 0x3e803f7b, 0x0000bf74, 0xbf800000, 0x3f7dbdcf, 0xbf783e4e, 0x0000be99
.long 0x00000000, 0x00000000, 0x00000000, 0x00000000, 0x00000000, 0x00000000, 0x00000000, 0x00000000
.long 0x00000000, 0x00000000, 0x00000000, 0x00000000, 0x00000000, 0x00000000, 0x00000000, 0x00000000
.long 0x00000000, 0x00000000, 0x00000000, 0x00000000, 0x00000000, 0x00000000, 0x00000000, 0x00000000
.long 0x00000000, 0x00000000, 0x00000000, 0x00000000, 0x00000000, 0x00000000, 0x00000000, 0x00000000
.long 0x00000000, 0x00000000, 0x00000000, 0x00000000, 0x00000000, 0x00000000, 0x00000000, 0x00000000
.long 0x00000000, 0x00000000, 0x00000000, 0x00000000, 0x00000000, 0x00000000, 0x00000000, 0x00000000
.long 0x00000000, 0x00000000, 0x00000000, 0x00000000, 0x00000000, 0x00000000, 0x00000000, 0x00000000
.long 0x00000000, 0x00000000, 0x00000000, 0x00000000, 0x00000000, 0x00000000, 0x00000000, 0x00000000
.long 0x3e1b3f80, 0xbee1bf74, 0x3f303f52, 0x0000bf1d, 0xbf7d0000, 0x3f66be99, 0xbf3a3f12, 0x0000bf4a
.long 0x3d4f3f80, 0xbe1bbf7f, 0x3e803f7b, 0x0000bf74, 0xbf800000, 0x3f7dbdcf, 0xbf783e4e, 0x0000be99
.long 0xbd4f3f80, 0x3e1bbf7f, 0xbe803f7b, 0x0000bf74, 0xbf800000, 0x3f7d3dcf, 0xbf78be4e, 0x00003e99
.long 0xbe1b3f80, 0x3ee1bf74, 0xbf303f52, 0x0000bf1d, 0xbf7d0000, 0x3f663e99, 0xbf3abf12, 0x00003f4a
.long 0x00000000, 0x00000000, 0x00000000, 0x00000000, 0x00000000, 0x00000000, 0x00000000, 0x00000000
.long 0x00000000, 0x00000000, 0x00000000, 0x00000000, 0x00000000, 0x00000000, 0x00000000, 0x00000000
.long 0x00000000, 0x00000000, 0x00000000, 0x00000000, 0x00000000, 0x00000000, 0x00000000, 0x00000000
.long 0x00000000, 0x00000000, 0x00000000, 0x00000000, 0x00000000, 0x00000000, 0x00000000, 0x00000000
.long 0x00000000, 0x00000000, 0x00000000, 0x00000000, 0x00000000, 0x00000000, 0x00000000, 0x00000000
.long 0x00000000, 0x00000000, 0x00000000, 0x00000000, 0x00000000, 0x00000000, 0x00000000, 0x00000000
.long 0x00000000, 0x00000000, 0x00000000, 0x00000000, 0x00000000, 0x00000000, 0x00000000, 0x00000000
.long 0x00000000, 0x00000000, 0x00000000, 0x00000000, 0x00000000, 0x00000000, 0x00000000, 0x00000000
.long 0xbd4f3f80, 0x3e1bbf7f, 0xbe803f7b, 0x0000bf74, 0xbf800000, 0x3f7d3dcf, 0xbf78be4e, 0x00003e99
.long 0xbe1b3f80, 0x3ee1bf74, 0xbf303f52, 0x0000bf1d, 0xbf7d0000, 0x3f663e99, 0xbf3abf12, 0x00003f4a
.long 0x00000000, 0x00000000, 0x00000000, 0x00000000, 0x00000000, 0x00000000, 0x00000000, 0x00000000
.long 0x00000000, 0x00000000, 0x00000000, 0x00000000, 0x00000000, 0x00000000, 0x00000000, 0x00000000
.long 0x00000000, 0x00000000, 0x00000000, 0x00000000, 0x00000000, 0x00000000, 0x00000000, 0x00000000
.long 0x00000000, 0x00000000, 0x00000000, 0x00000000, 0x00000000, 0x00000000, 0x00000000, 0x00000000
.long 0x00000000, 0x00000000, 0x00000000, 0x00000000, 0x00000000, 0x00000000, 0x00000000, 0x00000000
.long 0x00000000, 0x00000000, 0x00000000, 0x00000000, 0x00000000, 0x00000000, 0x00000000, 0x00000000
.long 0x00000000, 0x00000000, 0x00000000, 0x00000000, 0x00000000, 0x00000000, 0x00000000, 0x00000000
.long 0x00000000, 0x00000000, 0x00000000, 0x00000000, 0x00000000, 0x00000000, 0x00000000, 0x00000000
.long 0xbd4f3f80, 0x3e1bbf7f, 0xbe803f7b, 0x0000bf74, 0xbf800000, 0x3f7d3dcf, 0xbf78be4e, 0x00003e99
.long 0xbe1b3f80, 0x3ee1bf74, 0xbf303f52, 0x0000bf1d, 0xbf7d0000, 0x3f663e99, 0xbf3abf12, 0x00003f4a
.long 0x00000000, 0x00000000, 0x00000000, 0x00000000, 0x00000000, 0x00000000, 0x00000000, 0x00000000
.long 0x00000000, 0x00000000, 0x00000000, 0x00000000, 0x00000000, 0x00000000, 0x00000000, 0x00000000
.long 0x00000000, 0x00000000, 0x00000000, 0x00000000, 0x00000000, 0x00000000, 0x00000000, 0x00000000
.long 0x00000000, 0x00000000, 0x00000000, 0x00000000, 0x00000000, 0x00000000, 0x00000000, 0x00000000
.long 0x00000000, 0x00000000, 0x00000000, 0x00000000, 0x00000000, 0x00000000, 0x00000000, 0x00000000
.long 0x00000000, 0x00000000, 0x00000000, 0x00000000, 0x00000000, 0x00000000, 0x00000000, 0x00000000
.long 0x00000000, 0x00000000, 0x00000000, 0x00000000, 0x00000000, 0x00000000, 0x00000000, 0x00000000
.long 0x00000000, 0x00000000, 0x00000000, 0x00000000, 0x00000000, 0x00000000, 0x00000000, 0x00000000
.long 0xbd4f3f80, 0x3e1bbf7f, 0xbe803f7b, 0x0000bf74, 0xbf800000, 0x3f7d3dcf, 0xbf78be4e, 0x00003e99
.long 0xbe1b3f80, 0x3ee1bf74, 0xbf303f52, 0x0000bf1d, 0xbf7d0000, 0x3f663e99, 0xbf3abf12, 0x00003f4a
.long 0xbe803f80, 0x3f30bf60, 0xbf743f07, 0x0000bd4f, 0xbf780000, 0x3f3a3ef8, 0xbe99bf59, 0x00003f80
.long 0xbeb23f80, 0x3f60bf42, 0xbf7b3e1b, 0x00003f07, 0xbf700000, 0x3ef83f27, 0x3e4ebf7d, 0x00003f59
.long 0x00000000, 0x00000000, 0x00000000, 0x00000000, 0x00000000, 0x00000000, 0x00000000, 0x00000000
.long 0x00000000, 0x00000000, 0x00000000, 0x00000000, 0x00000000, 0x00000000, 0x00000000, 0x00000000
.long 0x00000000, 0x00000000, 0x00000000, 0x00000000, 0x00000000, 0x00000000, 0x00000000, 0x00000000
.long 0x00000000, 0x00000000, 0x00000000, 0x00000000, 0x00000000, 0x00000000, 0x00000000, 0x00000000
.long 0x00000000, 0x00000000, 0x00000000, 0x00000000, 0x00000000, 0x00000000, 0x00000000, 0x00000000
.long 0x00000000, 0x00000000, 0x00000000, 0x00000000, 0x00000000, 0x00000000, 0x00000000, 0x00000000
.long 0x00000000, 0x00000000, 0x00000000, 0x00000000, 0x00000000, 0x00000000, 0x00000000, 0x00000000
.long 0x00000000, 0x00000000, 0x00000000, 0x00000000, 0x00000000, 0x00000000, 0x00000000, 0x00000000
.long 0xbe803f80, 0x3f30bf60, 0xbf743f07, 0x0000bd4f, 0xbf780000, 0x3f3a3ef8, 0xbe99bf59, 0x00003f80
.long 0xbeb23f80, 0x3f60bf42, 0xbf7b3e1b, 0x00003f07, 0xbf700000, 0x3ef83f27, 0x3e4ebf7d, 0x00003f59
.long 0x00000000, 0x00000000, 0x00000000, 0x00000000, 0x00000000, 0x00000000, 0x00000000, 0x00000000
.long 0x00000000, 0x00000000, 0x00000000, 0x00000000, 0x00000000, 0x00000000, 0x00000000, 0x00000000
.long 0x00000000, 0x00000000, 0x00000000, 0x00000000, 0x00000000, 0x00000000, 0x00000000, 0x00000000
.long 0x00000000, 0x00000000, 0x00000000, 0x00000000, 0x00000000, 0x00000000, 0x00000000, 0x00000000
.long 0x00000000, 0x00000000, 0x00000000, 0x00000000, 0x00000000, 0x00000000, 0x00000000, 0x00000000
.long 0x00000000, 0x00000000, 0x00000000, 0x00000000, 0x00000000, 0x00000000, 0x00000000, 0x00000000
.long 0x00000000, 0x00000000, 0x00000000, 0x00000000, 0x00000000, 0x00000000, 0x00000000, 0x00000000
.long 0x00000000, 0x00000000, 0x00000000, 0x00000000, 0x00000000, 0x00000000, 0x00000000, 0x00000000
.long 0xbe803f80, 0x3f30bf60, 0xbf743f07, 0x0000bd4f, 0xbf780000, 0x3f3a3ef8, 0xbe99bf59, 0x00003f80
.long 0xbeb23f80, 0x3f60bf42, 0xbf7b3e1b, 0x00003f07, 0xbf700000, 0x3ef83f27, 0x3e4ebf7d, 0x00003f59
.long 0x00000000, 0x00000000, 0x00000000, 0x00000000, 0x00000000, 0x00000000, 0x00000000, 0x00000000
.long 0x00000000, 0x00000000, 0x00000000, 0x00000000, 0x00000000, 0x00000000, 0x00000000, 0x00000000
.long 0x00000000, 0x00000000, 0x00000000, 0x00000000, 0x00000000, 0x00000000, 0x00000000, 0x00000000
.long 0x00000000, 0x00000000, 0x00000000, 0x00000000, 0x00000000, 0x00000000, 0x00000000, 0x00000000
.long 0x00000000, 0x00000000, 0x00000000, 0x00000000, 0x00000000, 0x00000000, 0x00000000, 0x00000000
.long 0x00000000, 0x00000000, 0x00000000, 0x00000000, 0x00000000, 0x00000000, 0x00000000, 0x00000000
.long 0x00000000, 0x00000000, 0x00000000, 0x00000000, 0x00000000, 0x00000000, 0x00000000, 0x00000000
.long 0x00000000, 0x00000000, 0x00000000, 0x00000000, 0x00000000, 0x00000000, 0x00000000, 0x00000000
.long 0xbe803f80, 0x3f30bf60, 0xbf743f07, 0x0000bd4f, 0xbf780000, 0x3f3a3ef8, 0xbe99bf59, 0x00003f80
.long 0xbeb23f80, 0x3f60bf42, 0xbf7b3e1b, 0x00003f07, 0xbf700000, 0x3ef83f27, 0x3e4ebf7d, 0x00003f59
.long 0xbee13f80, 0x3f7bbf1d, 0xbf42be80, 0x00003f6b, 0xbf660000, 0x3e4e3f4a, 0x3f27bf78, 0x00003eca
.long 0xbf073f80, 0x3f7fbee1, 0xbeb2bf1d, 0x00003f7b, 0xbf590000, 0xbdcf3f66, 0x3f70bf4a, 0x0000be4e
.long 0x00000000, 0x00000000, 0x00000000, 0x00000000, 0x00000000, 0x00000000, 0x00000000, 0x00000000
.long 0x00000000, 0x00000000, 0x00000000, 0x00000000, 0x00000000, 0x00000000, 0x00000000, 0x00000000
.long 0x00000000, 0x00000000, 0x00000000, 0x00000000, 0x00000000, 0x00000000, 0x00000000, 0x00000000
.long 0x00000000, 0x00000000, 0x00000000, 0x00000000, 0x00000000, 0x00000000, 0x00000000, 0x00000000
.long 0x00000000, 0x00000000, 0x00000000, 0x00000000, 0x00000000, 0x00000000, 0x00000000, 0x00000000
.long 0x00000000, 0x00000000, 0x00000000, 0x00000000, 0x00000000, 0x00000000, 0x00000000, 0x00000000
.long 0x00000000, 0x00000000, 0x00000000, 0x00000000, 0x00000000, 0x00000000, 0x00000000, 0x00000000
.long 0x00000000, 0x00000000, 0x00000000, 0x00000000, 0x00000000, 0x00000000, 0x00000000, 0x00000000
.long 0xbee13f80, 0x3f7bbf1d, 0xbf42be80, 0x00003f6b, 0xbf660000, 0x3e4e3f4a, 0x3f27bf78, 0x00003eca
.long 0xbf073f80, 0x3f7fbee1, 0xbeb2bf1d, 0x00003f7b, 0xbf590000, 0xbdcf3f66, 0x3f70bf4a, 0x0000be4e
.long 0x00000000, 0x00000000, 0x00000000, 0x00000000, 0x00000000, 0x00000000, 0x00000000, 0x00000000
.long 0x00000000, 0x00000000, 0x00000000, 0x00000000, 0x00000000, 0x00000000, 0x00000000, 0x00000000
.long 0x00000000, 0x00000000, 0x00000000, 0x00000000, 0x00000000, 0x00000000, 0x00000000, 0x00000000
.long 0x00000000, 0x00000000, 0x00000000, 0x00000000, 0x00000000, 0x00000000, 0x00000000, 0x00000000
.long 0x00000000, 0x00000000, 0x00000000, 0x00000000, 0x00000000, 0x00000000, 0x00000000, 0x00000000
.long 0x00000000, 0x00000000, 0x00000000, 0x00000000, 0x00000000, 0x00000000, 0x00000000, 0x00000000
.long 0x00000000, 0x00000000, 0x00000000, 0x00000000, 0x00000000, 0x00000000, 0x00000000, 0x00000000
.long 0x00000000, 0x00000000, 0x00000000, 0x00000000, 0x00000000, 0x00000000, 0x00000000, 0x00000000
.long 0xbee13f80, 0x3f7bbf1d, 0xbf42be80, 0x00003f6b, 0xbf660000, 0x3e4e3f4a, 0x3f27bf78, 0x00003eca
.long 0xbf073f80, 0x3f7fbee1, 0xbeb2bf1d, 0x00003f7b, 0xbf590000, 0xbdcf3f66, 0x3f70bf4a, 0x0000be4e
.long 0x00000000, 0x00000000, 0x00000000, 0x00000000, 0x00000000, 0x00000000, 0x00000000, 0x00000000
.long 0x00000000, 0x00000000, 0x00000000, 0x00000000, 0x00000000, 0x00000000, 0x00000000, 0x00000000
.long 0x00000000, 0x00000000, 0x00000000, 0x00000000, 0x00000000, 0x00000000, 0x00000000, 0x00000000
.long 0x00000000, 0x00000000, 0x00000000, 0x00000000, 0x00000000, 0x00000000, 0x00000000, 0x00000000
.long 0x00000000, 0x00000000, 0x00000000, 0x00000000, 0x00000000, 0x00000000, 0x00000000, 0x00000000
.long 0x00000000, 0x00000000, 0x00000000, 0x00000000, 0x00000000, 0x00000000, 0x00000000, 0x00000000
.long 0x00000000, 0x00000000, 0x00000000, 0x00000000, 0x00000000, 0x00000000, 0x00000000, 0x00000000
.long 0x00000000, 0x00000000, 0x00000000, 0x00000000, 0x00000000, 0x00000000, 0x00000000, 0x00000000
.long 0xbee13f80, 0x3f7bbf1d, 0xbf42be80, 0x00003f6b, 0xbf660000, 0x3e4e3f4a, 0x3f27bf78, 0x00003eca
.long 0xbf073f80, 0x3f7fbee1, 0xbeb2bf1d, 0x00003f7b, 0xbf590000, 0xbdcf3f66, 0x3f70bf4a, 0x0000be4e
.long 0xbf1d3f80, 0x3f6bbe80, 0x3e1bbf60, 0x00003f30, 0xbf4a0000, 0xbeca3f78, 0x3f7dbef8, 0x0000bf3a
.long 0xbf303f80, 0x3f42bd4f, 0x3f1dbf7f, 0x00003e1b, 0xbf3a0000, 0xbf273f80, 0x3f4abdcf, 0x0000bf7d
.long 0x00000000, 0x00000000, 0x00000000, 0x00000000, 0x00000000, 0x00000000, 0x00000000, 0x00000000
.long 0x00000000, 0x00000000, 0x00000000, 0x00000000, 0x00000000, 0x00000000, 0x00000000, 0x00000000
.long 0x00000000, 0x00000000, 0x00000000, 0x00000000, 0x00000000, 0x00000000, 0x00000000, 0x00000000
.long 0x00000000, 0x00000000, 0x00000000, 0x00000000, 0x00000000, 0x00000000, 0x00000000, 0x00000000
.long 0x00000000, 0x00000000, 0x00000000, 0x00000000, 0x00000000, 0x00000000, 0x00000000, 0x00000000
.long 0x00000000, 0x00000000, 0x00000000, 0x00000000, 0x00000000, 0x00000000, 0x00000000, 0x00000000
.long 0x00000000, 0x00000000, 0x00000000, 0x00000000, 0x00000000, 0x00000000, 0x00000000, 0x00000000
.long 0x00000000, 0x00000000, 0x00000000, 0x00000000, 0x00000000, 0x00000000, 0x00000000, 0x00000000
.long 0xbf1d3f80, 0x3f6bbe80, 0x3e1bbf60, 0x00003f30, 0xbf4a0000, 0xbeca3f78, 0x3f7dbef8, 0x0000bf3a
.long 0xbf303f80, 0x3f42bd4f, 0x3f1dbf7f, 0x00003e1b, 0xbf3a0000, 0xbf273f80, 0x3f4abdcf, 0x0000bf7d
.long 0x00000000, 0x00000000, 0x00000000, 0x00000000, 0x00000000, 0x00000000, 0x00000000, 0x00000000
.long 0x00000000, 0x00000000, 0x00000000, 0x00000000, 0x00000000, 0x00000000, 0x00000000, 0x00000000
.long 0x00000000, 0x00000000, 0x00000000, 0x00000000, 0x00000000, 0x00000000, 0x00000000, 0x00000000
.long 0x00000000, 0x00000000, 0x00000000, 0x00000000, 0x00000000, 0x00000000, 0x00000000, 0x00000000
.long 0x00000000, 0x00000000, 0x00000000, 0x00000000, 0x00000000, 0x00000000, 0x00000000, 0x00000000
.long 0x00000000, 0x00000000, 0x00000000, 0x00000000, 0x00000000, 0x00000000, 0x00000000, 0x00000000
.long 0x00000000, 0x00000000, 0x00000000, 0x00000000, 0x00000000, 0x00000000, 0x00000000, 0x00000000
.long 0x00000000, 0x00000000, 0x00000000, 0x00000000, 0x00000000, 0x00000000, 0x00000000, 0x00000000
.long 0xbf1d3f80, 0x3f6bbe80, 0x3e1bbf60, 0x00003f30, 0xbf4a0000, 0xbeca3f78, 0x3f7dbef8, 0x0000bf3a
.long 0xbf303f80, 0x3f42bd4f, 0x3f1dbf7f, 0x00003e1b, 0xbf3a0000, 0xbf273f80, 0x3f4abdcf, 0x0000bf7d
.long 0x00000000, 0x00000000, 0x00000000, 0x00000000, 0x00000000, 0x00000000, 0x00000000, 0x00000000
.long 0x00000000, 0x00000000, 0x00000000, 0x00000000, 0x00000000, 0x00000000, 0x00000000, 0x00000000
.long 0x00000000, 0x00000000, 0x00000000, 0x00000000, 0x00000000, 0x00000000, 0x00000000, 0x00000000
.long 0x00000000, 0x00000000, 0x00000000, 0x00000000, 0x00000000, 0x00000000, 0x00000000, 0x00000000
.long 0x00000000, 0x00000000, 0x00000000, 0x00000000, 0x00000000, 0x00000000, 0x00000000, 0x00000000
.long 0x00000000, 0x00000000, 0x00000000, 0x00000000, 0x00000000, 0x00000000, 0x00000000, 0x00000000
.long 0x00000000, 0x00000000, 0x00000000, 0x00000000, 0x00000000, 0x00000000, 0x00000000, 0x00000000
.long 0x00000000, 0x00000000, 0x00000000, 0x00000000, 0x00000000, 0x00000000, 0x00000000, 0x00000000
.long 0xbf1d3f80, 0x3f6bbe80, 0x3e1bbf60, 0x00003f30, 0xbf4a0000, 0xbeca3f78, 0x3f7dbef8, 0x0000bf3a
.long 0xbf303f80, 0x3f42bd4f, 0x3f1dbf7f, 0x00003e1b, 0xbf3a0000, 0xbf273f80, 0x3f4abdcf, 0x0000bf7d
.long 0xbf423f80, 0x3f073e1b, 0x3f6bbf74, 0x0000bee1, 0xbf270000, 0xbf593f7d, 0x3eca3e99, 0x0000bf66
.long 0xbf523f80, 0x3e803eb2, 0x3f7fbf42, 0x0000bf60, 0xbf120000, 0xbf783f70, 0xbdcf3f27, 0x0000bef8
.long 0x00000000, 0x00000000, 0x00000000, 0x00000000, 0x00000000, 0x00000000, 0x00000000, 0x00000000
.long 0x00000000, 0x00000000, 0x00000000, 0x00000000, 0x00000000, 0x00000000, 0x00000000, 0x00000000
.long 0x00000000, 0x00000000, 0x00000000, 0x00000000, 0x00000000, 0x00000000, 0x00000000, 0x00000000
.long 0x00000000, 0x00000000, 0x00000000, 0x00000000, 0x00000000, 0x00000000, 0x00000000, 0x00000000
.long 0x00000000, 0x00000000, 0x00000000, 0x00000000, 0x00000000, 0x00000000, 0x00000000, 0x00000000
.long 0x00000000, 0x00000000, 0x00000000, 0x00000000, 0x00000000, 0x00000000, 0x00000000, 0x00000000
.long 0x00000000, 0x00000000, 0x00000000, 0x00000000, 0x00000000, 0x00000000, 0x00000000, 0x00000000
.long 0x00000000, 0x00000000, 0x00000000, 0x00000000, 0x00000000, 0x00000000, 0x00000000, 0x00000000
.long 0xbf423f80, 0x3f073e1b, 0x3f6bbf74, 0x0000bee1, 0xbf270000, 0xbf593f7d, 0x3eca3e99, 0x0000bf66
.long 0xbf523f80, 0x3e803eb2, 0x3f7fbf42, 0x0000bf60, 0xbf120000, 0xbf783f70, 0xbdcf3f27, 0x0000bef8
.long 0x00000000, 0x00000000, 0x00000000, 0x00000000, 0x00000000, 0x00000000, 0x00000000, 0x00000000
.long 0x00000000, 0x00000000, 0x00000000, 0x00000000, 0x00000000, 0x00000000, 0x00000000, 0x00000000
.long 0x00000000, 0x00000000, 0x00000000, 0x00000000, 0x00000000, 0x00000000, 0x00000000, 0x00000000
.long 0x00000000, 0x00000000, 0x00000000, 0x00000000, 0x00000000, 0x00000000, 0x00000000, 0x00000000
.long 0x00000000, 0x00000000, 0x00000000, 0x00000000, 0x00000000, 0x00000000, 0x00000000, 0x00000000
.long 0x00000000, 0x00000000, 0x00000000, 0x00000000, 0x00000000, 0x00000000, 0x00000000, 0x00000000
.long 0x00000000, 0x00000000, 0x00000000, 0x00000000, 0x00000000, 0x00000000, 0x00000000, 0x00000000
.long 0x00000000, 0x00000000, 0x00000000, 0x00000000, 0x00000000, 0x00000000, 0x00000000, 0x00000000
.long 0xbf423f80, 0x3f073e1b, 0x3f6bbf74, 0x0000bee1, 0xbf270000, 0xbf593f7d, 0x3eca3e99, 0x0000bf66
.long 0xbf523f80, 0x3e803eb2, 0x3f7fbf42, 0x0000bf60, 0xbf120000, 0xbf783f70, 0xbdcf3f27, 0x0000bef8
.long 0x00000000, 0x00000000, 0x00000000, 0x00000000, 0x00000000, 0x00000000, 0x00000000, 0x00000000
.long 0x00000000, 0x00000000, 0x00000000, 0x00000000, 0x00000000, 0x00000000, 0x00000000, 0x00000000
.long 0x00000000, 0x00000000, 0x00000000, 0x00000000, 0x00000000, 0x00000000, 0x00000000, 0x00000000
.long 0x00000000, 0x00000000, 0x00000000, 0x00000000, 0x00000000, 0x00000000, 0x00000000, 0x00000000
.long 0x00000000, 0x00000000, 0x00000000, 0x00000000, 0x00000000, 0x00000000, 0x00000000, 0x00000000
.long 0x00000000, 0x00000000, 0x00000000, 0x00000000, 0x00000000, 0x00000000, 0x00000000, 0x00000000
.long 0x00000000, 0x00000000, 0x00000000, 0x00000000, 0x00000000, 0x00000000, 0x00000000, 0x00000000
.long 0x00000000, 0x00000000, 0x00000000, 0x00000000, 0x00000000, 0x00000000, 0x00000000, 0x00000000
.long 0xbf423f80, 0x3f073e1b, 0x3f6bbf74, 0x0000bee1, 0xbf270000, 0xbf593f7d, 0x3eca3e99, 0x0000bf66
.long 0xbf523f80, 0x3e803eb2, 0x3f7fbf42, 0x0000bf60, 0xbf120000, 0xbf783f70, 0xbdcf3f27, 0x0000bef8
.long 0xbf603f80, 0xbd4f3f07, 0x3f52bee1, 0x0000bf7f, 0xbef80000, 0xbf803f59, 0xbf123f66, 0x00003dcf
.long 0xbf6b3f80, 0xbeb23f30, 0x3ee1bd4f, 0x0000bf42, 0xbeca0000, 0xbf703f3a, 0xbf663f80, 0x00003f27
.long 0x00000000, 0x00000000, 0x00000000, 0x00000000, 0x00000000, 0x00000000, 0x00000000, 0x00000000
.long 0x00000000, 0x00000000, 0x00000000, 0x00000000, 0x00000000, 0x00000000, 0x00000000, 0x00000000
.long 0x00000000, 0x00000000, 0x00000000, 0x00000000, 0x00000000, 0x00000000, 0x00000000, 0x00000000
.long 0x00000000, 0x00000000, 0x00000000, 0x00000000, 0x00000000, 0x00000000, 0x00000000, 0x00000000
.long 0x00000000, 0x00000000, 0x00000000, 0x00000000, 0x00000000, 0x00000000, 0x00000000, 0x00000000
.long 0x00000000, 0x00000000, 0x00000000, 0x00000000, 0x00000000, 0x00000000, 0x00000000, 0x00000000
.long 0x00000000, 0x00000000, 0x00000000, 0x00000000, 0x00000000, 0x00000000, 0x00000000, 0x00000000
.long 0x00000000, 0x00000000, 0x00000000, 0x00000000, 0x00000000, 0x00000000, 0x00000000, 0x00000000
.long 0xbf603f80, 0xbd4f3f07, 0x3f52bee1, 0x0000bf7f, 0xbef80000, 0xbf803f59, 0xbf123f66, 0x00003dcf
.long 0xbf6b3f80, 0xbeb23f30, 0x3ee1bd4f, 0x0000bf42, 0xbeca0000, 0xbf703f3a, 0xbf663f80, 0x00003f27
.long 0x00000000, 0x00000000, 0x00000000, 0x00000000, 0x00000000, 0x00000000, 0x00000000, 0x00000000
.long 0x00000000, 0x00000000, 0x00000000, 0x00000000, 0x00000000, 0x00000000, 0x00000000, 0x00000000
.long 0x00000000, 0x00000000, 0x00000000, 0x00000000, 0x00000000, 0x00000000, 0x00000000, 0x00000000
.long 0x00000000, 0x00000000, 0x00000000, 0x00000000, 0x00000000, 0x00000000, 0x00000000, 0x00000000
.long 0x00000000, 0x00000000, 0x00000000, 0x00000000, 0x00000000, 0x00000000, 0x00000000, 0x00000000
.long 0x00000000, 0x00000000, 0x00000000, 0x00000000, 0x00000000, 0x00000000, 0x00000000, 0x00000000
.long 0x00000000, 0x00000000, 0x00000000, 0x00000000, 0x00000000, 0x00000000, 0x00000000, 0x00000000
.long 0x00000000, 0x00000000, 0x00000000, 0x00000000, 0x00000000, 0x00000000, 0x00000000, 0x00000000
.long 0xbf603f80, 0xbd4f3f07, 0x3f52bee1, 0x0000bf7f, 0xbef80000, 0xbf803f59, 0xbf123f66, 0x00003dcf
.long 0xbf6b3f80, 0xbeb23f30, 0x3ee1bd4f, 0x0000bf42, 0xbeca0000, 0xbf703f3a, 0xbf663f80, 0x00003f27
.long 0x00000000, 0x00000000, 0x00000000, 0x00000000, 0x00000000, 0x00000000, 0x00000000, 0x00000000
.long 0x00000000, 0x00000000, 0x00000000, 0x00000000, 0x00000000, 0x00000000, 0x00000000, 0x00000000
.long 0x00000000, 0x00000000, 0x00000000, 0x00000000, 0x00000000, 0x00000000, 0x00000000, 0x00000000
.long 0x00000000, 0x00000000, 0x00000000, 0x00000000, 0x00000000, 0x00000000, 0x00000000, 0x00000000
.long 0x00000000, 0x00000000, 0x00000000, 0x00000000, 0x00000000, 0x00000000, 0x00000000, 0x00000000
.long 0x00000000, 0x00000000, 0x00000000, 0x00000000, 0x00000000, 0x00000000, 0x00000000, 0x00000000
.long 0x00000000, 0x00000000, 0x00000000, 0x00000000, 0x00000000, 0x00000000, 0x00000000, 0x00000000
.long 0x00000000, 0x00000000, 0x00000000, 0x00000000, 0x00000000, 0x00000000, 0x00000000, 0x00000000
.long 0xbf603f80, 0xbd4f3f07, 0x3f52bee1, 0x0000bf7f, 0xbef80000, 0xbf803f59, 0xbf123f66, 0x00003dcf
.long 0xbf6b3f80, 0xbeb23f30, 0x3ee1bd4f, 0x0000bf42, 0xbeca0000, 0xbf703f3a, 0xbf663f80, 0x00003f27
.long 0xbf743f80, 0xbf1d3f52, 0xbd4f3eb2, 0x0000be80, 0xbe990000, 0xbf4a3f12, 0xbf803f70, 0x00003f78
.long 0xbf7b3f80, 0xbf523f6b, 0xbf073f30, 0x00003eb2, 0xbe4e0000, 0xbf123eca, 0xbf593f3a, 0x00003f70
.long 0x00000000, 0x00000000, 0x00000000, 0x00000000, 0x00000000, 0x00000000, 0x00000000, 0x00000000
.long 0x00000000, 0x00000000, 0x00000000, 0x00000000, 0x00000000, 0x00000000, 0x00000000, 0x00000000
.long 0x00000000, 0x00000000, 0x00000000, 0x00000000, 0x00000000, 0x00000000, 0x00000000, 0x00000000
.long 0x00000000, 0x00000000, 0x00000000, 0x00000000, 0x00000000, 0x00000000, 0x00000000, 0x00000000
.long 0x00000000, 0x00000000, 0x00000000, 0x00000000, 0x00000000, 0x00000000, 0x00000000, 0x00000000
.long 0x00000000, 0x00000000, 0x00000000, 0x00000000, 0x00000000, 0x00000000, 0x00000000, 0x00000000
.long 0x00000000, 0x00000000, 0x00000000, 0x00000000, 0x00000000, 0x00000000, 0x00000000, 0x00000000
.long 0x00000000, 0x00000000, 0x00000000, 0x00000000, 0x00000000, 0x00000000, 0x00000000, 0x00000000
.long 0xbf743f80, 0xbf1d3f52, 0xbd4f3eb2, 0x0000be80, 0xbe990000, 0xbf4a3f12, 0xbf803f70, 0x00003f78
.long 0xbf7b3f80, 0xbf523f6b, 0xbf073f30, 0x00003eb2, 0xbe4e0000, 0xbf123eca, 0xbf593f3a, 0x00003f70
.long 0x00000000, 0x00000000, 0x00000000, 0x00000000, 0x00000000, 0x00000000, 0x00000000, 0x00000000
.long 0x00000000, 0x00000000, 0x00000000, 0x00000000, 0x00000000, 0x00000000, 0x00000000, 0x00000000
.long 0x00000000, 0x00000000, 0x00000000, 0x00000000, 0x00000000, 0x00000000, 0x00000000, 0x00000000
.long 0x00000000, 0x00000000, 0x00000000, 0x00000000, 0x00000000, 0x00000000, 0x00000000, 0x00000000
.long 0x00000000, 0x00000000, 0x00000000, 0x00000000, 0x00000000, 0x00000000, 0x00000000, 0x00000000
.long 0x00000000, 0x00000000, 0x00000000, 0x00000000, 0x00000000, 0x00000000, 0x00000000, 0x00000000
.long 0x00000000, 0x00000000, 0x00000000, 0x00000000, 0x00000000, 0x00000000, 0x00000000, 0x00000000
.long 0x00000000, 0x00000000, 0x00000000, 0x00000000, 0x00000000, 0x00000000, 0x00000000, 0x00000000
.long 0xbf743f80, 0xbf1d3f52, 0xbd4f3eb2, 0x0000be80, 0xbe990000, 0xbf4a3f12, 0xbf803f70, 0x00003f78
.long 0xbf7b3f80, 0xbf523f6b, 0xbf073f30, 0x00003eb2, 0xbe4e0000, 0xbf123eca, 0xbf593f3a, 0x00003f70
.long 0x00000000, 0x00000000, 0x00000000, 0x00000000, 0x00000000, 0x00000000, 0x00000000, 0x00000000
.long 0x00000000, 0x00000000, 0x00000000, 0x00000000, 0x00000000, 0x00000000, 0x00000000, 0x00000000
.long 0x00000000, 0x00000000, 0x00000000, 0x00000000, 0x00000000, 0x00000000, 0x00000000, 0x00000000
.long 0x00000000, 0x00000000, 0x00000000, 0x00000000, 0x00000000, 0x00000000, 0x00000000, 0x00000000
.long 0x00000000, 0x00000000, 0x00000000, 0x00000000, 0x00000000, 0x00000000, 0x00000000, 0x00000000
.long 0x00000000, 0x00000000, 0x00000000, 0x00000000, 0x00000000, 0x00000000, 0x00000000, 0x00000000
.long 0x00000000, 0x00000000, 0x00000000, 0x00000000, 0x00000000, 0x00000000, 0x00000000, 0x00000000
.long 0x00000000, 0x00000000, 0x00000000, 0x00000000, 0x00000000, 0x00000000, 0x00000000, 0x00000000
.long 0xbf743f80, 0xbf1d3f52, 0xbd4f3eb2, 0x0000be80, 0xbe990000, 0xbf4a3f12, 0xbf803f70, 0x00003f78
.long 0xbf7b3f80, 0xbf523f6b, 0xbf073f30, 0x00003eb2, 0xbe4e0000, 0xbf123eca, 0xbf593f3a, 0x00003f70
.long 0xbf7f3f80, 0xbf743f7b, 0xbf603f6b, 0x00003f52, 0xbdcf0000, 0xbe993e4e, 0xbef83eca, 0x00003f12
.long 0xbf803f80, 0xbf803f80, 0xbf803f80, 0x00003f80, 0x00000000, 0x00000000, 0x00000000, 0x00000000
.long 0x00000000, 0x00000000, 0x00000000, 0x00000000, 0x00000000, 0x00000000, 0x00000000, 0x00000000
.long 0x00000000, 0x00000000, 0x00000000, 0x00000000, 0x00000000, 0x00000000, 0x00000000, 0x00000000
.long 0x00000000, 0x00000000, 0x00000000, 0x00000000, 0x00000000, 0x00000000, 0x00000000, 0x00000000
.long 0x00000000, 0x00000000, 0x00000000, 0x00000000, 0x00000000, 0x00000000, 0x00000000, 0x00000000
.long 0x00000000, 0x00000000, 0x00000000, 0x00000000, 0x00000000, 0x00000000, 0x00000000, 0x00000000
.long 0x00000000, 0x00000000, 0x00000000, 0x00000000, 0x00000000, 0x00000000, 0x00000000, 0x00000000
.long 0x00000000, 0x00000000, 0x00000000, 0x00000000, 0x00000000, 0x00000000, 0x00000000, 0x00000000
.long 0x00000000, 0x00000000, 0x00000000, 0x00000000, 0x00000000, 0x00000000, 0x00000000, 0x00000000
.long 0xbf7f3f80, 0xbf743f7b, 0xbf603f6b, 0x00003f52, 0xbdcf0000, 0xbe993e4e, 0xbef83eca, 0x00003f12
.long 0xbf803f80, 0xbf803f80, 0xbf803f80, 0x00003f80, 0x00000000, 0x00000000, 0x00000000, 0x00000000
.long 0x00000000, 0x00000000, 0x00000000, 0x00000000, 0x00000000, 0x00000000, 0x00000000, 0x00000000
.long 0x00000000, 0x00000000, 0x00000000, 0x00000000, 0x00000000, 0x00000000, 0x00000000, 0x00000000
.long 0x00000000, 0x00000000, 0x00000000, 0x00000000, 0x00000000, 0x00000000, 0x00000000, 0x00000000
.long 0x00000000, 0x00000000, 0x00000000, 0x00000000, 0x00000000, 0x00000000, 0x00000000, 0x00000000
.long 0x00000000, 0x00000000, 0x00000000, 0x00000000, 0x00000000, 0x00000000, 0x00000000, 0x00000000
.long 0x00000000, 0x00000000, 0x00000000, 0x00000000, 0x00000000, 0x00000000, 0x00000000, 0x00000000
.long 0x00000000, 0x00000000, 0x00000000, 0x00000000, 0x00000000, 0x00000000, 0x00000000, 0x00000000
.long 0x00000000, 0x00000000, 0x00000000, 0x00000000, 0x00000000, 0x00000000, 0x00000000, 0x00000000
.long 0xbf7f3f80, 0xbf743f7b, 0xbf603f6b, 0x00003f52, 0xbdcf0000, 0xbe993e4e, 0xbef83eca, 0x00003f12
.long 0xbf803f80, 0xbf803f80, 0xbf803f80, 0x00003f80, 0x00000000, 0x00000000, 0x00000000, 0x00000000
.long 0x00000000, 0x00000000, 0x00000000, 0x00000000, 0x00000000, 0x00000000, 0x00000000, 0x00000000
.long 0x00000000, 0x00000000, 0x00000000, 0x00000000, 0x00000000, 0x00000000, 0x00000000, 0x00000000
.long 0x00000000, 0x00000000, 0x00000000, 0x00000000, 0x00000000, 0x00000000, 0x00000000, 0x00000000
.long 0x00000000, 0x00000000, 0x00000000, 0x00000000, 0x00000000, 0x00000000, 0x00000000, 0x00000000
.long 0x00000000, 0x00000000, 0x00000000, 0x00000000, 0x00000000, 0x00000000, 0x00000000, 0x00000000
.long 0x00000000, 0x00000000, 0x00000000, 0x00000000, 0x00000000, 0x00000000, 0x00000000, 0x00000000
.long 0x00000000, 0x00000000, 0x00000000, 0x00000000, 0x00000000, 0x00000000, 0x00000000, 0x00000000
.long 0x00000000, 0x00000000, 0x00000000, 0x00000000, 0x00000000, 0x00000000, 0x00000000, 0x00000000
.long 0xbf7f3f80, 0xbf743f7b, 0xbf603f6b, 0x00003f52, 0xbdcf0000, 0xbe993e4e, 0xbef83eca, 0x00003f12
.long 0xbf803f80, 0xbf803f80, 0xbf803f80, 0x00003f80, 0x00000000, 0x00000000, 0x00000000, 0x00000000
.long 0x3f803f80, 0x3f803f80, 0x3f803f80, 0x3f803f80, 0x00000000, 0x00000000, 0x00000000, 0x00000000
.long 0x3f7f3f80, 0x3f743f7b, 0x3f1d3f30, 0x3ee13f07, 0xbdcf0000, 0xbe99be4e, 0xbf4abf3a, 0xbf66bf59
.long 0x3f7b3f80, 0x3f523f6b, 0xbe80bd4f, 0xbf1dbee1, 0xbe4e0000, 0xbf12beca, 0xbf78bf80, 0xbf4abf66
.long 0x3f743f80, 0x3f1d3f52, 0xbf6bbf42, 0xbf7bbf7f, 0xbe990000, 0xbf4abf12, 0xbecabf27, 0x3e4ebdcf
.long 0x3f6b3f80, 0x3eb23f30, 0xbf60bf7f, 0xbe80bf1d, 0xbeca0000, 0xbf70bf3a, 0x3ef83dcf, 0x3f783f4a
.long 0x3f603f80, 0x3d4f3f07, 0xbe1bbf1d, 0x3f423eb2, 0xbef80000, 0xbf80bf59, 0x3f7d3f4a, 0x3f273f70
.long 0x3f523f80, 0xbe803eb2, 0x3f303e1b, 0x3f6b3f7b, 0xbf120000, 0xbf78bf70, 0x3f3a3f7d, 0xbeca3e4e
.long 0x3f423f80, 0xbf073e1b, 0x3f7f3f52, 0x3d4f3f30, 0xbf270000, 0xbf59bf7d, 0xbdcf3f12, 0xbf80bf3a
.long 0x3f803f80, 0x3f803f80, 0x3f803f80, 0x3f803f80, 0x00000000, 0x00000000, 0x00000000, 0x00000000
.long 0x3f603f6b, 0x3f423f52, 0x3e803eb2, 0x3d4f3e1b, 0xbef8beca, 0xbf27bf12, 0xbf78bf70, 0xbf80bf7d
.long 0x3f073f30, 0x3e1b3eb2, 0xbf60bf42, 0xbf7fbf74, 0xbf59bf3a, 0xbf7dbf70, 0xbef8bf27, 0xbdcfbe99
.long 0x3d4f3eb2, 0xbf07be80, 0xbf30bf60, 0xbe1bbee1, 0xbf80bf70, 0xbf59bf78, 0x3f3a3ef8, 0x3f7d3f66
.long 0xbee1bd4f, 0xbf74bf42, 0x3f073e1b, 0x3f7b3f52, 0xbf66bf80, 0xbe99bf27, 0x3f593f7d, 0x3e4e3f12
.long 0xbf52bee1, 0xbf6bbf7f, 0x3f743f7b, 0x3e803f30, 0xbf12bf66, 0x3ecabdcf, 0xbe993e4e, 0xbf78bf3a
.long 0xbf7fbf42, 0xbee1bf60, 0xbd4f3f07, 0xbf74bf1d, 0xbdcfbf27, 0x3f663ef8, 0xbf80bf59, 0xbe99bf4a
.long 0xbf6bbf74, 0x3e80bee1, 0xbf7bbf1d, 0xbeb2bf60, 0x3ecabe99, 0x3f783f66, 0xbe4ebf4a, 0x3f703ef8
.long 0x3f803f80, 0x3f803f80, 0x3f803f80, 0x3f803f80, 0x00000000, 0x00000000, 0x00000000, 0x00000000
.long 0xbe1bbd4f, 0xbeb2be80, 0xbf52bf42, 0xbf6bbf60, 0xbf7dbf80, 0xbf70bf78, 0xbf12bf27, 0xbecabef8
.long 0xbf74bf7f, 0xbf42bf60, 0x3eb23e1b, 0x3f303f07, 0x3e993dcf, 0x3f273ef8, 0x3f703f7d, 0x3f3a3f59
.long 0x3ee13e1b, 0x3f603f30, 0x3e803f07, 0xbeb2bd4f, 0x3f663f7d, 0x3ef83f3a, 0xbf78bf59, 0xbf70bf80
.long 0x3f523f7b, 0x3e1b3f07, 0xbf42bf74, 0xbd4fbee1, 0xbf12be4e, 0xbf7dbf59, 0x3f273e99, 0x3f803f66
.long 0xbf30be80, 0xbf7bbf74, 0x3f7f3f6b, 0x3ee13f52, 0xbf3abf78, 0x3e4ebe99, 0xbdcf3eca, 0xbf66bf12
.long 0xbf1dbf74, 0x3f07bd4f, 0xbf60bee1, 0xbf42bf7f, 0x3f4a3e99, 0x3f593f80, 0xbef8bf66, 0x3f273dcf
.long 0x3f603eb2, 0x3f1d3f7b, 0x3ee1be80, 0x3f743f6b, 0x3ef83f70, 0xbf4abe4e, 0x3f663f78, 0xbe993eca
.long 0x3f803f80, 0x3f803f80, 0x3f803f80, 0x3f803f80, 0x00000000, 0x00000000, 0x00000000, 0x00000000
.long 0xbf07bee1, 0xbf30bf1d, 0xbf7bbf74, 0xbf80bf7f, 0xbf59bf66, 0xbf3abf4a, 0xbe4ebe99, 0x0000bdcf
.long 0xbee1bf1d, 0xbd4fbe80, 0x3f6b3f52, 0x3f803f7b, 0x3f663f4a, 0x3f803f78, 0x3eca3f12, 0x00003e4e
.long 0x3f7f3f7b, 0x3f423f6b, 0xbf52bf1d, 0xbf80bf74, 0xbdcf3e4e, 0xbf27beca, 0xbf12bf4a, 0x0000be99
.long 0xbf1dbe80, 0xbf7fbf60, 0x3f303eb2, 0x3f803f6b, 0xbf4abf78, 0xbdcfbef8, 0x3f3a3f70, 0x00003eca
.long 0xbeb2bf42, 0x3f1d3e1b, 0xbf07bd4f, 0xbf80bf60, 0x3f703f27, 0x3f4a3f7d, 0xbf59bf80, 0x0000bef8
.long 0x3f7b3f6b, 0x3e1b3f30, 0x3eb2be80, 0x3f803f52, 0xbe4e3eca, 0xbf7dbf3a, 0x3f703f78, 0x00003f12
.long 0xbf30bd4f, 0xbf52bf7f, 0xbe1b3f07, 0xbf80bf42, 0xbf3abf80, 0x3f12bdcf, 0xbf7dbf59, 0x0000bf27
.long 0x3f803f80, 0x3f803f80, 0x3f803f80, 0x3f803f80, 0x00000000, 0x00000000, 0x00000000, 0x00000000
.long 0xbf7bbf7f, 0xbf6bbf74, 0xbf07bf1d, 0xbeb2bee1, 0x3e4e3dcf, 0x3eca3e99, 0x3f593f4a, 0x3f703f66
.long 0x3f6b3f7b, 0x3f303f52, 0xbee1be80, 0xbf42bf1d, 0xbecabe4e, 0xbf3abf12, 0xbf66bf78, 0xbf27bf4a
.long 0xbf52bf74, 0xbeb2bf1d, 0x3f7f3f6b, 0x3f603f7b, 0x3f123e99, 0x3f703f4a, 0x3dcf3eca, 0xbef8be4e
.long 0x3f303f6b, 0xbd4f3eb2, 0xbf1dbf60, 0x3e1bbe80, 0xbf3abeca, 0xbf80bf70, 0x3f4a3ef8, 0x3f7d3f78
.long 0xbf07bf60, 0x3ee1bd4f, 0xbeb23e1b, 0xbf7bbf42, 0x3f593ef8, 0x3f663f80, 0xbf70bf7d, 0xbe4ebf27
.long 0x3eb23f52, 0xbf42be80, 0x3f7b3f30, 0x3f073f6b, 0xbf70bf12, 0xbf27bf78, 0x3e4e3f3a, 0xbf59beca
.long 0xbe1bbf42, 0x3f743f07, 0xbf30bf7f, 0x3f1dbd4f, 0x3f7d3f27, 0x3e993f59, 0x3f3a3dcf, 0x3f4a3f80
.long 0x3f803f80, 0x3f803f80, 0x3f803f80, 0x3f803f80, 0x00000000, 0x00000000, 0x00000000, 0x00000000
.long 0xbf52bf60, 0xbf30bf42, 0xbe1bbe80, 0x3d4fbd4f, 0x3f123ef8, 0x3f3a3f27, 0x3f7d3f78, 0x3f803f80
.long 0x3eb23f07, 0xbd4f3e1b, 0xbf74bf60, 0xbf7fbf7f, 0xbf70bf59, 0xbf80bf7d, 0xbe99bef8, 0x3dcfbdcf
.long 0x3e80bd4f, 0x3f423f07, 0x3ee13f30, 0xbe1b3e1b, 0x3f783f80, 0x3f273f59, 0xbf66bf3a, 0xbf7dbf7d
.long 0xbf42bee1, 0xbf7fbf74, 0x3f523f07, 0x3f7b3f7b, 0xbf27bf66, 0x3dcfbe99, 0x3f123f59, 0xbe4e3e4e
.long 0x3f7f3f52, 0x3f1d3f6b, 0xbf30bf74, 0x3e80be80, 0x3dcf3f12, 0xbf4abeca, 0x3f3a3e99, 0x3f783f78
.long 0xbf60bf7f, 0x3e1bbee1, 0xbf1dbd4f, 0xbf74bf74, 0x3ef8bdcf, 0x3f7d3f66, 0xbf4abf80, 0x3e99be99
.long 0x3ee13f6b, 0xbf52be80, 0x3f603f7b, 0xbeb23eb2, 0xbf66beca, 0xbf12bf78, 0xbef83e4e, 0xbf70bf70
.long 0x3f803f80, 0x3f803f80, 0x3f803f80, 0x3f803f80, 0x00000000, 0x00000000, 0x00000000, 0x00000000
.long 0x3e803e1b, 0x3ee13eb2, 0x3f603f52, 0x3f743f6b, 0x3f783f7d, 0x3f663f70, 0x3ef83f12, 0x3e993eca
.long 0xbf60bf74, 0xbf1dbf42, 0x3f073eb2, 0x3f523f30, 0x3ef83e99, 0x3f4a3f27, 0x3f593f70, 0x3f123f3a
.long 0xbf30bee1, 0xbf7bbf60, 0x3d4fbe80, 0x3f1d3eb2, 0xbf3abf66, 0xbe4ebef8, 0x3f803f78, 0x3f4a3f70
.long 0x3f073f52, 0xbe803e1b, 0xbee1bf42, 0x3eb2bd4f, 0xbf59bf12, 0xbf78bf7d, 0x3f663f27, 0x3f703f80
.long 0x3f743f30, 0x3f423f7b, 0xbf52bf7f, 0x3d4fbee1, 0x3e993f3a, 0xbf27be4e, 0x3f123dcf, 0x3f803f66
.long 0xbd4fbf1d, 0x3f6b3f07, 0xbf7fbf60, 0xbe80bf42, 0x3f803f4a, 0x3eca3f59, 0x3dcfbef8, 0x3f783f27
.long 0xbf7bbf60, 0x3d4fbf1d, 0xbf6bbee1, 0xbf07bf74, 0x3e4ebef8, 0x3f803f4a, 0xbecabf66, 0x3f593e99
.long 0x3f803f80, 0x3f803f80, 0x3f803f80, 0x00000000, 0x00000000, 0x00000000, 0x00000000, 0x00000000
.long 0x3f1d3f07, 0x3f423f30, 0x3f7f3f7b, 0x00000000, 0x3f4a3f59, 0x3f273f3a, 0x3dcf3e4e, 0x00000000
.long 0xbe80bee1, 0x3e1bbd4f, 0x3f7b3f6b, 0x00000000, 0x3f783f66, 0x3f7d3f80, 0x3e4e3eca, 0x00000000
.long 0xbf6bbf7f, 0xbf07bf42, 0x3f743f52, 0x00000000, 0x3eca3dcf, 0x3f593f27, 0x3e993f12, 0x00000000
.long 0xbf60bf1d, 0xbf74bf7f, 0x3f6b3f30, 0x00000000, 0xbef8bf4a, 0x3e99bdcf, 0x3eca3f3a, 0x00000000
.long 0xbe1b3eb2, 0xbf6bbf1d, 0x3f603f07, 0x00000000, 0xbf7dbf70, 0xbecabf4a, 0x3ef83f59, 0x00000000
.long 0x3f303f7b, 0xbee13e1b, 0x3f523eb2, 0x00000000, 0xbf3abe4e, 0xbf66bf7d, 0x3f123f70, 0x00000000
.long 0x3f7f3f30, 0x3e803f52, 0x3f423e1b, 0x00000000, 0x3dcf3f3a, 0xbf78bf12, 0x3f273f7d, 0x00000000
.long 0x3f303f80, 0xbf42bd4f, 0x3f073f7b, 0xbf60be80, 0xbf3a0000, 0xbf27bf80, 0xbf59be4e, 0xbef8bf78
.long 0x3f1d3f80, 0xbf6bbe80, 0xbeb23f07, 0xbf52bf74, 0xbf4a0000, 0xbecabf78, 0xbf70bf59, 0x3f12be99
.long 0x3f073f80, 0xbf7fbee1, 0xbf74be80, 0x3e1bbf42, 0xbf590000, 0xbdcfbf66, 0xbe99bf78, 0x3f7d3f27
.long 0x3ee13f80, 0xbf7bbf1d, 0xbf52bf60, 0x3f743e1b, 0xbf660000, 0x3e4ebf4a, 0x3f12bef8, 0x3e993f7d
.long 0x3eb23f80, 0xbf60bf42, 0xbd4fbf74, 0x3f303f6b, 0xbf700000, 0x3ef8bf27, 0x3f803e99, 0xbf3a3eca
.long 0x3e803f80, 0xbf30bf60, 0x3f42bee1, 0xbeb23f52, 0xbf780000, 0x3f3abef8, 0x3f273f66, 0xbf70bf12
.long 0x3e1b3f80, 0xbee1bf74, 0x3f7b3eb2, 0xbf7fbd4f, 0xbf7d0000, 0x3f66be99, 0xbe4e3f70, 0xbdcfbf80
.long 0x3d4f3f80, 0xbe1bbf7f, 0x3ee13f6b, 0xbf07bf60, 0xbf800000, 0x3f7dbdcf, 0xbf663eca, 0x3f59bef8
.long 0xbf1dbf7f, 0x3f523e1b, 0xbee1bf74, 0x3f6b3eb2, 0x3f4a3dcf, 0x3f123f7d, 0x3f663e99, 0x3eca3f70
.long 0xbe1bbf60, 0x3f7f3f30, 0x3f42bd4f, 0x3ee13f7b, 0x3f7d3ef8, 0xbdcf3f3a, 0x3f273f80, 0xbf66be4e
.long 0x3eb2bf1d, 0x3f303f7b, 0x3f523f6b, 0xbf60bd4f, 0x3f703f4a, 0xbf3a3e4e, 0xbf123eca, 0xbef8bf80
.long 0x3f42be80, 0x3d4f3f6b, 0xbeb23f30, 0xbf07bf7f, 0x3f273f78, 0xbf80beca, 0xbf70bf3a, 0x3f59bdcf
.long 0x3f7b3e1b, 0xbf1d3f07, 0xbf7fbee1, 0x3f52be80, 0x3e4e3f7d, 0xbf4abf59, 0x3dcfbf66, 0x3f123f78
.long 0x3f743f07, 0xbf7bbd4f, 0xbe1bbf7f, 0x3f1d3f6b, 0xbe993f59, 0xbe4ebf80, 0x3f7d3dcf, 0xbf4a3eca
.long 0x3f303f52, 0xbf60bf1d, 0x3f6bbe80, 0xbf423f07, 0xbf3a3f12, 0x3ef8bf4a, 0x3eca3f78, 0xbf27bf59
.long 0x3e803f7b, 0xbeb2bf74, 0x3f1d3f52, 0xbf30bf42, 0xbf783e4e, 0x3f70be99, 0xbf4a3f12, 0x3f3abf27
.long 0x3eb23f6b, 0xbf74bee1, 0x3e1b3f52, 0xbf7fbf1d, 0xbf70beca, 0xbe99bf66, 0xbf7dbf12, 0xbdcfbf4a
.long 0xbf7bbee1, 0x3d4fbf42, 0xbf30bf7f, 0x3f603e1b, 0xbe4ebf66, 0x3f803f27, 0x3f3abdcf, 0x3ef83f7d
.long 0xbd4fbf60, 0x3f6b3f52, 0x3f7b3f30, 0xbf1d3eb2, 0x3f803ef8, 0xbeca3f12, 0xbe4e3f3a, 0xbf4abf70
.long 0x3f7f3f07, 0xbf303eb2, 0xbf6bbd4f, 0x3e80bf42, 0xbdcf3f59, 0xbf3abf70, 0xbecabf80, 0x3f783f27
.long 0xbe803f52, 0xbee1bf7f, 0x3f07bf1d, 0x3e1b3f7b, 0xbf78bf12, 0x3f66bdcf, 0x3f593f4a, 0xbf7dbe4e
.long 0xbf6bbf1d, 0x3f7f3e1b, 0x3d4f3f7b, 0xbf07bf74, 0x3ecabf4a, 0x3dcf3f7d, 0xbf80be4e, 0x3f59be99
.long 0x3f07bf42, 0xbe803f6b, 0xbf1dbf60, 0x3f523f30, 0x3f593f27, 0xbf78beca, 0x3f4abef8, 0xbf123f3a
.long 0x3f423f30, 0xbf52bf1d, 0x3f743eb2, 0xbf7bbe80, 0xbf273f3a, 0x3f12bf4a, 0xbe993f70, 0x3e4ebf78
.long 0xbe80bf60, 0x3f7b3f07, 0xbd4fbf42, 0x3f803f30, 0x3f783ef8, 0x3e4e3f59, 0x3f803f27, 0x00003f3a
.long 0x3f743f52, 0xbf073eb2, 0x3e803f6b, 0xbf80bf1d, 0xbe993f12, 0xbf59bf70, 0xbf78beca, 0x0000bf4a
.long 0xbf423e1b, 0xbe80bf74, 0xbee1bf7f, 0x3f803f07, 0xbf27bf7d, 0x3f783e99, 0x3f663dcf, 0x00003f59
.long 0xbe1bbf74, 0x3f603f52, 0x3f1d3f7b, 0xbf80bee1, 0x3f7d3e99, 0xbef83f12, 0xbf4a3e4e, 0x0000bf66
.long 0x3f6b3f30, 0xbf74bd4f, 0xbf42bf60, 0x3f803eb2, 0xbeca3f3a, 0xbe99bf80, 0x3f27bef8, 0x00003f70
.long 0xbf523eb2, 0x3ee1bf42, 0x3f603f30, 0xbf80be80, 0xbf12bf70, 0x3f663f27, 0xbef83f3a, 0x0000bf78
.long 0xbd4fbf7f, 0x3eb23f7b, 0xbf74bee1, 0x3f803e1b, 0x3f803dcf, 0xbf703e4e, 0x3e99bf66, 0x00003f7d
.long 0x3f603f07, 0xbf6bbee1, 0x3f7f3e1b, 0xbf80bd4f, 0xbef83f59, 0x3ecabf66, 0xbdcf3f7d, 0x0000bf80
.long 0xbd4f3f30, 0xbf7fbf42, 0xbe803f07, 0xbf74bf60, 0xbf80bf3a, 0x3dcfbf27, 0xbf78bf59, 0x3e99bef8
.long 0x3e80bf1d, 0x3f603f6b, 0x3f743eb2, 0x3d4f3f52, 0x3f783f4a, 0xbef83eca, 0x3e993f70, 0xbf80bf12
.long 0xbee13f07, 0xbf1dbf7f, 0xbf42bf74, 0x3f6b3e1b, 0xbf66bf59, 0x3f4abdcf, 0x3f27be99, 0x3eca3f7d
.long 0x3f1dbee1, 0x3e803f7b, 0xbe1b3f52, 0xbf30bf74, 0x3f4a3f66, 0xbf78be4e, 0xbf7dbf12, 0x3f3abe99
.long 0xbf423eb2, 0x3e1bbf60, 0x3f6bbd4f, 0xbee13f30, 0xbf27bf70, 0x3f7d3ef8, 0x3eca3f80, 0xbf66bf3a
.long 0x3f60be80, 0xbf073f30, 0xbf52bf42, 0x3f7f3eb2, 0x3ef83f78, 0xbf59bf3a, 0x3f12bf27, 0xbdcf3f70
.long 0xbf743e1b, 0x3f52bee1, 0xbd4f3f7b, 0xbe80bf7f, 0xbe99bf7d, 0x3f123f66, 0xbf80be4e, 0x3f78bdcf
.long 0x3f7fbd4f, 0xbf7b3e1b, 0x3f60bee1, 0xbf523f07, 0x3dcf3f80, 0xbe4ebf7d, 0x3ef83f66, 0xbf12bf59
.long 0x3e1bbf1d, 0x3f7b3f52, 0x3eb2bee1, 0x3f6b3f6b, 0x3f7d3f4a, 0xbe4e3f12, 0x3f703f66, 0xbeca3eca
.long 0xbf303e1b, 0xbf07bf7f, 0xbf7bbf42, 0x3ee1bee1, 0xbf3abf7d, 0x3f593dcf, 0x3e4ebf27, 0x3f663f66
.long 0x3f7b3eb2, 0xbe803f30, 0xbd4f3f52, 0xbf60bf60, 0x3e4e3f70, 0xbf78bf3a, 0xbf80bf12, 0x3ef8bef8
.long 0xbf6bbf42, 0x3f60bd4f, 0x3f7f3eb2, 0xbf073f07, 0x3ecabf27, 0x3ef83f80, 0x3dcf3f70, 0xbf59bf59
.long 0x3f073f7b, 0xbf74bf1d, 0xbe80bf7f, 0x3f523f52, 0xbf593e4e, 0x3e99bf4a, 0x3f783dcf, 0xbf123f12
.long 0x3d4fbf74, 0x3ee13f7b, 0xbf6b3e1b, 0x3f1dbf1d, 0x3f803e99, 0xbf663e4e, 0xbecabf7d, 0x3f4a3f4a
.long 0xbf1d3f30, 0x3eb2bf60, 0x3f073f6b, 0xbf42bf42, 0xbf4abf3a, 0x3f703ef8, 0xbf593eca, 0x3f27bf27
.long 0x3f74be80, 0xbf6b3eb2, 0x3f42bf1d, 0xbf303f30, 0x3e993f78, 0xbecabf70, 0x3f273f4a, 0xbf3abf3a
.long 0xbee13eb2, 0xbf60bf74, 0xbf1d3e1b, 0xbf42bf7f, 0xbf66bf70, 0x3ef8be99, 0xbf4abf7d, 0x3f27bdcf
.long 0x3f423f7b, 0xbf52bd4f, 0xbe1b3f30, 0xbf6bbf60, 0xbf273e4e, 0xbf12bf80, 0xbf7dbf3a, 0x3ecabef8
.long 0x3f52bd4f, 0x3e1b3f6b, 0x3eb23f7b, 0xbf7fbf1d, 0x3f123f80, 0xbf7dbeca, 0xbf70be4e, 0x3dcfbf4a
.long 0xbeb2bf7f, 0x3f743f30, 0x3f423f6b, 0xbf7bbe80, 0x3f703dcf, 0xbe993f3a, 0xbf273eca, 0xbe4ebf78
.long 0xbf7fbe80, 0x3f30bee1, 0x3f7b3f07, 0xbf603e1b, 0xbdcfbf78, 0x3f3a3f66, 0xbe4e3f59, 0xbef8bf7d
.long 0xbe1b3f6b, 0xbeb2bf7f, 0x3f74bd4f, 0xbf303f07, 0xbf7dbeca, 0x3f70bdcf, 0x3e993f80, 0xbf3abf59
.long 0x3f6b3f07, 0xbf7fbe80, 0x3f30bf1d, 0xbee13f52, 0xbeca3f59, 0x3dcfbf78, 0x3f3a3f4a, 0xbf66bf12
.long 0x3f1dbf42, 0xbf073f52, 0x3e80bf74, 0xbe1b3f7b, 0x3f4a3f27, 0xbf59bf12, 0x3f783e99, 0xbf7dbe4e
.long 0x3f07be80, 0x3f523f7b, 0x3f30bd4f, 0x00000000, 0x3f593f78, 0xbf123e4e, 0x3f3a3f80, 0x00000000
.long 0xbeb2bf74, 0x3f7f3f07, 0x3f1dbe80, 0x00000000, 0x3f703e99, 0x3dcf3f59, 0x3f4a3f78, 0x00000000
.long 0xbf74bf42, 0x3f30be80, 0x3f07bee1, 0x00000000, 0x3e99bf27, 0x3f3a3f78, 0x3f593f66, 0x00000000
.long 0xbf523e1b, 0x3d4fbf60, 0x3ee1bf1d, 0x00000000, 0xbf12bf7d, 0x3f803ef8, 0x3f663f4a, 0x00000000
.long 0xbd4f3f6b, 0xbf1dbf74, 0x3eb2bf42, 0x00000000, 0xbf80beca, 0x3f4abe99, 0x3f703f27, 0x00000000
.long 0x3f423f52, 0xbf7bbee1, 0x3e80bf60, 0x00000000, 0xbf273f12, 0x3e4ebf66, 0x3f783ef8, 0x00000000
.long 0x3f7bbd4f, 0xbf603eb2, 0x3e1bbf74, 0x00000000, 0x3e4e3f80, 0xbef8bf70, 0x3f7d3e99, 0x00000000
.long 0x3ee1bf60, 0xbeb23f6b, 0x3d4fbf7f, 0x00000000, 0x3f663ef8, 0xbf70beca, 0x3f803dcf, 0x00000000
.long 0xbd4f3f80, 0x3e1bbf7f, 0xbee13f6b, 0x3f07bf60, 0xbf800000, 0x3f7d3dcf, 0xbf66beca, 0x3f593ef8
.long 0xbe1b3f80, 0x3ee1bf74, 0xbf7b3eb2, 0x3f7fbd4f, 0xbf7d0000, 0x3f663e99, 0xbe4ebf70, 0xbdcf3f80
.long 0xbe803f80, 0x3f30bf60, 0xbf42bee1, 0x3eb23f52, 0xbf780000, 0x3f3a3ef8, 0x3f27bf66, 0xbf703f12
.long 0xbeb23f80, 0x3f60bf42, 0x3d4fbf74, 0xbf303f6b, 0xbf700000, 0x3ef83f27, 0x3f80be99, 0xbf3abeca
.long 0xbee13f80, 0x3f7bbf1d, 0x3f52bf60, 0xbf743e1b, 0xbf660000, 0x3e4e3f4a, 0x3f123ef8, 0x3e99bf7d
.long 0xbf073f80, 0x3f7fbee1, 0x3f74be80, 0xbe1bbf42, 0xbf590000, 0xbdcf3f66, 0xbe993f78, 0x3f7dbf27
.long 0xbf1d3f80, 0x3f6bbe80, 0x3eb23f07, 0x3f52bf74, 0xbf4a0000, 0xbeca3f78, 0xbf703f59, 0x3f123e99
.long 0xbf303f80, 0x3f42bd4f, 0xbf073f7b, 0x3f60be80, 0xbf3a0000, 0xbf273f80, 0xbf593e4e, 0xbef83f78
.long 0xbe803f7b, 0x3eb2bf74, 0xbf1d3f52, 0x3f30bf42, 0xbf78be4e, 0x3f703e99, 0xbf4abf12, 0x3f3a3f27
.long 0xbf303f52, 0x3f60bf1d, 0xbf6bbe80, 0x3f423f07, 0xbf3abf12, 0x3ef83f4a, 0x3ecabf78, 0xbf273f59
.long 0xbf743f07, 0x3f7bbd4f, 0x3e1bbf7f, 0xbf1d3f6b, 0xbe99bf59, 0xbe4e3f80, 0x3f7dbdcf, 0xbf4abeca
.long 0xbf7b3e1b, 0x3f1d3f07, 0x3f7fbee1, 0xbf52be80, 0x3e4ebf7d, 0xbf4a3f59, 0x3dcf3f66, 0x3f12bf78
.long 0xbf42be80, 0xbd4f3f6b, 0x3eb23f30, 0x3f07bf7f, 0x3f27bf78, 0xbf803eca, 0xbf703f3a, 0x3f593dcf
.long 0xbeb2bf1d, 0xbf303f7b, 0xbf523f6b, 0x3f60bd4f, 0x3f70bf4a, 0xbf3abe4e, 0xbf12beca, 0xbef83f80
.long 0x3e1bbf60, 0xbf7f3f30, 0xbf42bd4f, 0xbee13f7b, 0x3f7dbef8, 0xbdcfbf3a, 0x3f27bf80, 0xbf663e4e
.long 0x3f1dbf7f, 0xbf523e1b, 0x3ee1bf74, 0xbf6b3eb2, 0x3f4abdcf, 0x3f12bf7d, 0x3f66be99, 0x3ecabf70
.long 0xbf423f30, 0x3f52bf1d, 0xbf743eb2, 0x3f7bbe80, 0xbf27bf3a, 0x3f123f4a, 0xbe99bf70, 0x3e4e3f78
.long 0xbf07bf42, 0x3e803f6b, 0x3f1dbf60, 0xbf523f30, 0x3f59bf27, 0xbf783eca, 0x3f4a3ef8, 0xbf12bf3a
.long 0x3f6bbf1d, 0xbf7f3e1b, 0xbd4f3f7b, 0x3f07bf74, 0x3eca3f4a, 0x3dcfbf7d, 0xbf803e4e, 0x3f593e99
.long 0x3e803f52, 0x3ee1bf7f, 0xbf07bf1d, 0xbe1b3f7b, 0xbf783f12, 0x3f663dcf, 0x3f59bf4a, 0xbf7d3e4e
.long 0xbf7f3f07, 0x3f303eb2, 0x3f6bbd4f, 0xbe80bf42, 0xbdcfbf59, 0xbf3a3f70, 0xbeca3f80, 0x3f78bf27
.long 0x3d4fbf60, 0xbf6b3f52, 0xbf7b3f30, 0x3f1d3eb2, 0x3f80bef8, 0xbecabf12, 0xbe4ebf3a, 0xbf4a3f70
.long 0x3f7bbee1, 0xbd4fbf42, 0x3f30bf7f, 0xbf603e1b, 0xbe4e3f66, 0x3f80bf27, 0x3f3a3dcf, 0x3ef8bf7d
.long 0xbeb23f6b, 0x3f74bee1, 0xbe1b3f52, 0x3f7fbf1d, 0xbf703eca, 0xbe993f66, 0xbf7d3f12, 0xbdcf3f4a
.long 0xbf603f07, 0x3f6bbee1, 0xbf7f3e1b, 0x3f80bd4f, 0xbef8bf59, 0x3eca3f66, 0xbdcfbf7d, 0x00003f80
.long 0x3d4fbf7f, 0xbeb23f7b, 0x3f74bee1, 0xbf803e1b, 0x3f80bdcf, 0xbf70be4e, 0x3e993f66, 0x0000bf7d
.long 0x3f523eb2, 0xbee1bf42, 0xbf603f30, 0x3f80be80, 0xbf123f70, 0x3f66bf27, 0xbef8bf3a, 0x00003f78
.long 0xbf6b3f30, 0x3f74bd4f, 0x3f42bf60, 0xbf803eb2, 0xbecabf3a, 0xbe993f80, 0x3f273ef8, 0x0000bf70
.long 0x3e1bbf74, 0xbf603f52, 0xbf1d3f7b, 0x3f80bee1, 0x3f7dbe99, 0xbef8bf12, 0xbf4abe4e, 0x00003f66
.long 0x3f423e1b, 0x3e80bf74, 0x3ee1bf7f, 0xbf803f07, 0xbf273f7d, 0x3f78be99, 0x3f66bdcf, 0x0000bf59
.long 0xbf743f52, 0x3f073eb2, 0xbe803f6b, 0x3f80bf1d, 0xbe99bf12, 0xbf593f70, 0xbf783eca, 0x00003f4a
.long 0x3e80bf60, 0xbf7b3f07, 0x3d4fbf42, 0xbf803f30, 0x3f78bef8, 0x3e4ebf59, 0x3f80bf27, 0x0000bf3a
.long 0xbf7fbd4f, 0x3f7b3e1b, 0xbf60bee1, 0x3f523f07, 0x3dcfbf80, 0xbe4e3f7d, 0x3ef8bf66, 0xbf123f59
.long 0x3f743e1b, 0xbf52bee1, 0x3d4f3f7b, 0x3e80bf7f, 0xbe993f7d, 0x3f12bf66, 0xbf803e4e, 0x3f783dcf
.long 0xbf60be80, 0x3f073f30, 0x3f52bf42, 0xbf7f3eb2, 0x3ef8bf78, 0xbf593f3a, 0x3f123f27, 0xbdcfbf70
.long 0x3f423eb2, 0xbe1bbf60, 0xbf6bbd4f, 0x3ee13f30, 0xbf273f70, 0x3f7dbef8, 0x3ecabf80, 0xbf663f3a
.long 0xbf1dbee1, 0xbe803f7b, 0x3e1b3f52, 0x3f30bf74, 0x3f4abf66, 0xbf783e4e, 0xbf7d3f12, 0x3f3a3e99
.long 0x3ee13f07, 0x3f1dbf7f, 0x3f42bf74, 0xbf6b3e1b, 0xbf663f59, 0x3f4a3dcf, 0x3f273e99, 0x3ecabf7d
.long 0xbe80bf1d, 0xbf603f6b, 0xbf743eb2, 0xbd4f3f52, 0x3f78bf4a, 0xbef8beca, 0x3e99bf70, 0xbf803f12
.long 0x3d4f3f30, 0x3f7fbf42, 0x3e803f07, 0x3f74bf60, 0xbf803f3a, 0x3dcf3f27, 0xbf783f59, 0x3e993ef8
.long 0xbf74be80, 0x3f6b3eb2, 0xbf42bf1d, 0x3f303f30, 0x3e99bf78, 0xbeca3f70, 0x3f27bf4a, 0xbf3a3f3a
.long 0x3f1d3f30, 0xbeb2bf60, 0xbf073f6b, 0x3f42bf42, 0xbf4a3f3a, 0x3f70bef8, 0xbf59beca, 0x3f273f27
.long 0xbd4fbf74, 0xbee13f7b, 0x3f6b3e1b, 0xbf1dbf1d, 0x3f80be99, 0xbf66be4e, 0xbeca3f7d, 0x3f4abf4a
.long 0xbf073f7b, 0x3f74bf1d, 0x3e80bf7f, 0xbf523f52, 0xbf59be4e, 0x3e993f4a, 0x3f78bdcf, 0xbf12bf12
.long 0x3f6bbf42, 0xbf60bd4f, 0xbf7f3eb2, 0x3f073f07, 0x3eca3f27, 0x3ef8bf80, 0x3dcfbf70, 0xbf593f59
.long 0xbf7b3eb2, 0x3e803f30, 0x3d4f3f52, 0x3f60bf60, 0x3e4ebf70, 0xbf783f3a, 0xbf803f12, 0x3ef83ef8
.long 0x3f303e1b, 0x3f07bf7f, 0x3f7bbf42, 0xbee1bee1, 0xbf3a3f7d, 0x3f59bdcf, 0x3e4e3f27, 0x3f66bf66
.long 0xbe1bbf1d, 0xbf7b3f52, 0xbeb2bee1, 0xbf6b3f6b, 0x3f7dbf4a, 0xbe4ebf12, 0x3f70bf66, 0xbecabeca
.long 0xbf1dbf42, 0x3f073f52, 0xbe80bf74, 0x3e1b3f7b, 0x3f4abf27, 0xbf593f12, 0x3f78be99, 0xbf7d3e4e
.long 0xbf6b3f07, 0x3f7fbe80, 0xbf30bf1d, 0x3ee13f52, 0xbecabf59, 0x3dcf3f78, 0x3f3abf4a, 0xbf663f12
.long 0x3e1b3f6b, 0x3eb2bf7f, 0xbf74bd4f, 0x3f303f07, 0xbf7d3eca, 0x3f703dcf, 0x3e99bf80, 0xbf3a3f59
.long 0x3f7fbe80, 0xbf30bee1, 0xbf7b3f07, 0x3f603e1b, 0xbdcf3f78, 0x3f3abf66, 0xbe4ebf59, 0xbef83f7d
.long 0x3eb2bf7f, 0xbf743f30, 0xbf423f6b, 0x3f7bbe80, 0x3f70bdcf, 0xbe99bf3a, 0xbf27beca, 0xbe4e3f78
.long 0xbf52bd4f, 0xbe1b3f6b, 0xbeb23f7b, 0x3f7fbf1d, 0x3f12bf80, 0xbf7d3eca, 0xbf703e4e, 0x3dcf3f4a
.long 0xbf423f7b, 0x3f52bd4f, 0x3e1b3f30, 0x3f6bbf60, 0xbf27be4e, 0xbf123f80, 0xbf7d3f3a, 0x3eca3ef8
.long 0x3ee13eb2, 0x3f60bf74, 0x3f1d3e1b, 0x3f42bf7f, 0xbf663f70, 0x3ef83e99, 0xbf4a3f7d, 0x3f273dcf
.long 0xbee1bf60, 0x3eb23f6b, 0xbd4fbf7f, 0x00000000, 0x3f66bef8, 0xbf703eca, 0x3f80bdcf, 0x00000000
.long 0xbf7bbd4f, 0x3f603eb2, 0xbe1bbf74, 0x00000000, 0x3e4ebf80, 0xbef83f70, 0x3f7dbe99, 0x00000000
.long 0xbf423f52, 0x3f7bbee1, 0xbe80bf60, 0x00000000, 0xbf27bf12, 0x3e4e3f66, 0x3f78bef8, 0x00000000
.long 0x3d4f3f6b, 0x3f1dbf74, 0xbeb2bf42, 0x00000000, 0xbf803eca, 0x3f4a3e99, 0x3f70bf27, 0x00000000
.long 0x3f523e1b, 0xbd4fbf60, 0xbee1bf1d, 0x00000000, 0xbf123f7d, 0x3f80bef8, 0x3f66bf4a, 0x00000000
.long 0x3f74bf42, 0xbf30be80, 0xbf07bee1, 0x00000000, 0x3e993f27, 0x3f3abf78, 0x3f59bf66, 0x00000000
.long 0x3eb2bf74, 0xbf7f3f07, 0xbf1dbe80, 0x00000000, 0x3f70be99, 0x3dcfbf59, 0x3f4abf78, 0x00000000
.long 0xbf07be80, 0xbf523f7b, 0xbf30bd4f, 0x00000000, 0x3f59bf78, 0xbf12be4e, 0x3f3abf80, 0x00000000
.long 0xbf423f80, 0x3f073e1b, 0xbf7f3f52, 0xbd4f3f30, 0xbf270000, 0xbf593f7d, 0xbdcfbf12, 0xbf803f3a
.long 0xbf523f80, 0x3e803eb2, 0xbf303e1b, 0xbf6b3f7b, 0xbf120000, 0xbf783f70, 0x3f3abf7d, 0xbecabe4e
.long 0xbf603f80, 0xbd4f3f07, 0x3e1bbf1d, 0xbf423eb2, 0xbef80000, 0xbf803f59, 0x3f7dbf4a, 0x3f27bf70
.long 0xbf6b3f80, 0xbeb23f30, 0x3f60bf7f, 0x3e80bf1d, 0xbeca0000, 0xbf703f3a, 0x3ef8bdcf, 0x3f78bf4a
.long 0xbf743f80, 0xbf1d3f52, 0x3f6bbf42, 0x3f7bbf7f, 0xbe990000, 0xbf4a3f12, 0xbeca3f27, 0x3e4e3dcf
.long 0xbf7b3f80, 0xbf523f6b, 0x3e80bd4f, 0x3f1dbee1, 0xbe4e0000, 0xbf123eca, 0xbf783f80, 0xbf4a3f66
.long 0xbf7f3f80, 0xbf743f7b, 0xbf1d3f30, 0xbee13f07, 0xbdcf0000, 0xbe993e4e, 0xbf4a3f3a, 0xbf663f59
.long 0xbf803f80, 0xbf803f80, 0xbf803f80, 0xbf803f80, 0x00000000, 0x00000000, 0x00000000, 0x00000000
.long 0x3f6bbf74, 0xbe80bee1, 0x3f7bbf1d, 0x3eb2bf60, 0x3eca3e99, 0x3f78bf66, 0xbe4e3f4a, 0x3f70bef8
.long 0x3f7fbf42, 0x3ee1bf60, 0x3d4f3f07, 0x3f74bf1d, 0xbdcf3f27, 0x3f66bef8, 0xbf803f59, 0xbe993f4a
.long 0x3f52bee1, 0x3f6bbf7f, 0xbf743f7b, 0xbe803f30, 0xbf123f66, 0x3eca3dcf, 0xbe99be4e, 0xbf783f3a
.long 0x3ee1bd4f, 0x3f74bf42, 0xbf073e1b, 0xbf7b3f52, 0xbf663f80, 0xbe993f27, 0x3f59bf7d, 0x3e4ebf12
.long 0xbd4f3eb2, 0x3f07be80, 0x3f30bf60, 0x3e1bbee1, 0xbf803f70, 0xbf593f78, 0x3f3abef8, 0x3f7dbf66
.long 0xbf073f30, 0xbe1b3eb2, 0x3f60bf42, 0x3f7fbf74, 0xbf593f3a, 0xbf7d3f70, 0xbef83f27, 0xbdcf3e99
.long 0xbf603f6b, 0xbf423f52, 0xbe803eb2, 0xbd4f3e1b, 0xbef83eca, 0xbf273f12, 0xbf783f70, 0xbf803f7d
.long 0xbf803f80, 0xbf803f80, 0xbf803f80, 0xbf803f80, 0x00000000, 0x00000000, 0x00000000, 0x00000000
.long 0xbf603eb2, 0xbf1d3f7b, 0xbee1be80, 0xbf743f6b, 0x3ef8bf70, 0xbf4a3e4e, 0x3f66bf78, 0xbe99beca
.long 0x3f1dbf74, 0xbf07bd4f, 0x3f60bee1, 0x3f42bf7f, 0x3f4abe99, 0x3f59bf80, 0xbef83f66, 0x3f27bdcf
.long 0x3f30be80, 0x3f7bbf74, 0xbf7f3f6b, 0xbee13f52, 0xbf3a3f78, 0x3e4e3e99, 0xbdcfbeca, 0xbf663f12
.long 0xbf523f7b, 0xbe1b3f07, 0x3f42bf74, 0x3d4fbee1, 0xbf123e4e, 0xbf7d3f59, 0x3f27be99, 0x3f80bf66
.long 0xbee13e1b, 0xbf603f30, 0xbe803f07, 0x3eb2bd4f, 0x3f66bf7d, 0x3ef8bf3a, 0xbf783f59, 0xbf703f80
.long 0x3f74bf7f, 0x3f42bf60, 0xbeb23e1b, 0xbf303f07, 0x3e99bdcf, 0x3f27bef8, 0x3f70bf7d, 0x3f3abf59
.long 0x3e1bbd4f, 0x3eb2be80, 0x3f52bf42, 0x3f6bbf60, 0xbf7d3f80, 0xbf703f78, 0xbf123f27, 0xbeca3ef8
.long 0xbf803f80, 0xbf803f80, 0xbf803f80, 0xbf803f80, 0x00000000, 0x00000000, 0x00000000, 0x00000000
.long 0x3f30bd4f, 0x3f52bf7f, 0x3e1b3f07, 0x3f80bf42, 0xbf3a3f80, 0x3f123dcf, 0xbf7d3f59, 0x00003f27
.long 0xbf7b3f6b, 0xbe1b3f30, 0xbeb2be80, 0xbf803f52, 0xbe4ebeca, 0xbf7d3f3a, 0x3f70bf78, 0x0000bf12
.long 0x3eb2bf42, 0xbf1d3e1b, 0x3f07bd4f, 0x3f80bf60, 0x3f70bf27, 0x3f4abf7d, 0xbf593f80, 0x00003ef8
.long 0x3f1dbe80, 0x3f7fbf60, 0xbf303eb2, 0xbf803f6b, 0xbf4a3f78, 0xbdcf3ef8, 0x3f3abf70, 0x0000beca
.long 0xbf7f3f7b, 0xbf423f6b, 0x3f52bf1d, 0x3f80bf74, 0xbdcfbe4e, 0xbf273eca, 0xbf123f4a, 0x00003e99
.long 0x3ee1bf1d, 0x3d4fbe80, 0xbf6b3f52, 0xbf803f7b, 0x3f66bf4a, 0x3f80bf78, 0x3ecabf12, 0x0000be4e
.long 0x3f07bee1, 0x3f30bf1d, 0x3f7bbf74, 0x3f80bf7f, 0xbf593f66, 0xbf3a3f4a, 0xbe4e3e99, 0x00003dcf
.long 0xbf803f80, 0xbf803f80, 0xbf803f80, 0xbf803f80, 0x00000000, 0x00000000, 0x00000000, 0x00000000
.long 0x3e1bbf42, 0xbf743f07, 0x3f30bf7f, 0xbf1dbd4f, 0x3f7dbf27, 0x3e99bf59, 0x3f3abdcf, 0x3f4abf80
.long 0xbeb23f52, 0x3f42be80, 0xbf7b3f30, 0xbf073f6b, 0xbf703f12, 0xbf273f78, 0x3e4ebf3a, 0xbf593eca
.long 0x3f07bf60, 0xbee1bd4f, 0x3eb23e1b, 0x3f7bbf42, 0x3f59bef8, 0x3f66bf80, 0xbf703f7d, 0xbe4e3f27
.long 0xbf303f6b, 0x3d4f3eb2, 0x3f1dbf60, 0xbe1bbe80, 0xbf3a3eca, 0xbf803f70, 0x3f4abef8, 0x3f7dbf78
.long 0x3f52bf74, 0x3eb2bf1d, 0xbf7f3f6b, 0xbf603f7b, 0x3f12be99, 0x3f70bf4a, 0x3dcfbeca, 0xbef83e4e
.long 0xbf6b3f7b, 0xbf303f52, 0x3ee1be80, 0x3f42bf1d, 0xbeca3e4e, 0xbf3a3f12, 0xbf663f78, 0xbf273f4a
.long 0x3f7bbf7f, 0x3f6bbf74, 0x3f07bf1d, 0x3eb2bee1, 0x3e4ebdcf, 0x3ecabe99, 0x3f59bf4a, 0x3f70bf66
.long 0xbf803f80, 0xbf803f80, 0xbf803f80, 0xbf803f80, 0x00000000, 0x00000000, 0x00000000, 0x00000000
.long 0xbee13f6b, 0x3f52be80, 0xbf603f7b, 0x3eb23eb2, 0xbf663eca, 0xbf123f78, 0xbef8be4e, 0xbf703f70
.long 0x3f60bf7f, 0xbe1bbee1, 0x3f1dbd4f, 0x3f74bf74, 0x3ef83dcf, 0x3f7dbf66, 0xbf4a3f80, 0x3e993e99
.long 0xbf7f3f52, 0xbf1d3f6b, 0x3f30bf74, 0xbe80be80, 0x3dcfbf12, 0xbf4a3eca, 0x3f3abe99, 0x3f78bf78
.long 0x3f42bee1, 0x3f7fbf74, 0xbf523f07, 0xbf7b3f7b, 0xbf273f66, 0x3dcf3e99, 0x3f12bf59, 0xbe4ebe4e
.long 0xbe80bd4f, 0xbf423f07, 0xbee13f30, 0x3e1b3e1b, 0x3f78bf80, 0x3f27bf59, 0xbf663f3a, 0xbf7d3f7d
.long 0xbeb23f07, 0x3d4f3e1b, 0x3f74bf60, 0x3f7fbf7f, 0xbf703f59, 0xbf803f7d, 0xbe993ef8, 0x3dcf3dcf
.long 0x3f52bf60, 0x3f30bf42, 0x3e1bbe80, 0xbd4fbd4f, 0x3f12bef8, 0x3f3abf27, 0x3f7dbf78, 0x3f80bf80
.long 0xbf803f80, 0xbf803f80, 0xbf803f80, 0xbf803f80, 0x00000000, 0x00000000, 0x00000000, 0x00000000
.long 0x3f7bbf60, 0xbd4fbf1d, 0x3f6bbee1, 0x3f07bf74, 0x3e4e3ef8, 0x3f80bf4a, 0xbeca3f66, 0x3f59be99
.long 0x3d4fbf1d, 0xbf6b3f07, 0x3f7fbf60, 0x3e80bf42, 0x3f80bf4a, 0x3ecabf59, 0x3dcf3ef8, 0x3f78bf27
.long 0xbf743f30, 0xbf423f7b, 0x3f52bf7f, 0xbd4fbee1, 0x3e99bf3a, 0xbf273e4e, 0x3f12bdcf, 0x3f80bf66
.long 0xbf073f52, 0x3e803e1b, 0x3ee1bf42, 0xbeb2bd4f, 0xbf593f12, 0xbf783f7d, 0x3f66bf27, 0x3f70bf80
.long 0x3f30bee1, 0x3f7bbf60, 0xbd4fbe80, 0xbf1d3eb2, 0xbf3a3f66, 0xbe4e3ef8, 0x3f80bf78, 0x3f4abf70
.long 0x3f60bf74, 0x3f1dbf42, 0xbf073eb2, 0xbf523f30, 0x3ef8be99, 0x3f4abf27, 0x3f59bf70, 0x3f12bf3a
.long 0xbe803e1b, 0xbee13eb2, 0xbf603f52, 0xbf743f6b, 0x3f78bf7d, 0x3f66bf70, 0x3ef8bf12, 0x3e99beca
.long 0xbf803f80, 0xbf803f80, 0xbf803f80, 0xbf803f80, 0x00000000, 0x00000000, 0x00000000, 0x00000000
.long 0xbf7f3f30, 0xbe803f52, 0xbf423e1b, 0x00000000, 0x3dcfbf3a, 0xbf783f12, 0x3f27bf7d, 0x00000000
.long 0xbf303f7b, 0x3ee13e1b, 0xbf523eb2, 0x00000000, 0xbf3a3e4e, 0xbf663f7d, 0x3f12bf70, 0x00000000
.long 0x3e1b3eb2, 0x3f6bbf1d, 0xbf603f07, 0x00000000, 0xbf7d3f70, 0xbeca3f4a, 0x3ef8bf59, 0x00000000
.long 0x3f60bf1d, 0x3f74bf7f, 0xbf6b3f30, 0x00000000, 0xbef83f4a, 0x3e993dcf, 0x3ecabf3a, 0x00000000
.long 0x3f6bbf7f, 0x3f07bf42, 0xbf743f52, 0x00000000, 0x3ecabdcf, 0x3f59bf27, 0x3e99bf12, 0x00000000
.long 0x3e80bee1, 0xbe1bbd4f, 0xbf7b3f6b, 0x00000000, 0x3f78bf66, 0x3f7dbf80, 0x3e4ebeca, 0x00000000
.long 0xbf1d3f07, 0xbf423f30, 0xbf7f3f7b, 0x00000000, 0x3f4abf59, 0x3f27bf3a, 0x3dcfbe4e, 0x00000000
.long 0xbf803f80, 0xbf803f80, 0xbf803f80, 0x00000000, 0x00000000, 0x00000000, 0x00000000, 0x00000000
.long 0x00003c84, 0xbc973cd9, 0xbcacbcc9, 0xbb56bd03, 0x00003c84, 0xbcac3cc9, 0xbc1ebcfc, 0x3c50bcf3
.long 0x00003c84, 0xbcc03cb6, 0x3b56bd03, 0x3cd1bca2, 0x00003c84, 0xbcd13ca2, 0x3c80bce7, 0x3d03bba0
.long 0x00003c84, 0xbce03c8c, 0x3cd1bca2, 0x3cf83c38, 0x00003c84, 0xbced3c69, 0x3d00bc04, 0x3cac3cc9
.long 0x00003c84, 0xbcf83c38, 0x3d033ba0, 0x3bd53d01, 0x00003c84, 0xbd003c04, 0x3ce03c8c, 0xbc1e3cfc
.long 0x00003c84, 0xbd033ba0, 0x3c973cd9, 0xbcc03cb6, 0x00003c84, 0xbd043ad6, 0x3bd53d01, 0xbd003c04
.long 0x00003c84, 0xbd04bad6, 0xbbd53d01, 0xbd00bc04, 0x00003c84, 0xbd03bba0, 0xbc973cd9, 0xbcc0bcb6
.long 0x00003c84, 0xbd00bc04, 0xbce03c8c, 0xbc1ebcfc, 0x00003c84, 0xbcf8bc38, 0xbd033ba0, 0x3bd5bd01
.long 0x00003c84, 0xbcedbc69, 0xbd00bc04, 0x3cacbcc9, 0x00003c84, 0xbce0bc8c, 0xbcd1bca2, 0x3cf8bc38
.long 0xbcf83c38, 0xbd00bc04, 0x3c80bce7, 0x3cedbc69, 0xbd033ba0, 0xbce0bc8c, 0x3cedbc69, 0x3d003c04
.long 0xbd04bad6, 0xbcacbcc9, 0x3d033ba0, 0x3c973cd9, 0xbd00bc04, 0xbc50bcf3, 0x3cc03cb6, 0xbb563d03
.long 0xbcedbc69, 0xbb56bd03, 0x3bd53d01, 0xbcc03cb6, 0xbcd1bca2, 0x3bd5bd01, 0xbc503cf3, 0xbd043ad6
.long 0xbcacbcc9, 0x3c80bce7, 0xbce03c8c, 0xbcd1bca2, 0xbc80bce7, 0x3cc0bcb6, 0xbd04bad6, 0xbbd5bd01
.long 0xbc1ebcfc, 0x3cedbc69, 0xbcd1bca2, 0x3c80bce7, 0xbb56bd03, 0x3d03bba0, 0xbc1ebcfc, 0x3cf8bc38
.long 0x3b56bd03, 0x3d033ba0, 0x3c1ebcfc, 0x3cf83c38, 0x3c1ebcfc, 0x3ced3c69, 0x3cd1bca2, 0x3c803ce7
.long 0x3c80bce7, 0x3cc03cb6, 0x3d04bad6, 0xbbd53d01, 0x3cacbcc9, 0x3c803ce7, 0x3ce03c8c, 0xbcd13ca2
.long 0x3cd1bca2, 0x3bd53d01, 0x3c503cf3, 0xbd04bad6, 0x3cedbc69, 0xbb563d03, 0xbbd53d01, 0xbcc0bcb6
.long 0x3d033ba0, 0x3cc03cb6, 0xbce03c8c, 0xbd04bad6, 0x3c973cd9, 0xbb563d03, 0xbcd1bca2, 0xbbd5bd01
.long 0xbbd53d01, 0xbce03c8c, 0x3c1ebcfc, 0x3cedbc69, 0xbce03c8c, 0xbcf8bc38, 0x3d04bad6, 0x3cac3cc9
.long 0xbd00bc04, 0xbc1ebcfc, 0x3c503cf3, 0xbc973cd9, 0xbc80bce7, 0x3c97bcd9, 0xbcc03cb6, 0xbcf8bc38
.long 0x3c1ebcfc, 0x3d04bad6, 0xbcedbc69, 0x3b56bd03, 0x3cedbc69, 0x3cac3cc9, 0x3b56bd03, 0x3d03bba0
.long 0x3cf83c38, 0xbbd53d01, 0x3d00bc04, 0x3c503cf3, 0x3c503cf3, 0xbced3c69, 0x3c973cd9, 0xbcd13ca2
.long 0xbc503cf3, 0xbcedbc69, 0xbc973cd9, 0xbcd1bca2, 0xbcf83c38, 0xbbd5bd01, 0xbd00bc04, 0x3c50bcf3
.long 0xbcedbc69, 0x3cacbcc9, 0xbb56bd03, 0x3d033ba0, 0xbc1ebcfc, 0x3d043ad6, 0x3cedbc69, 0x3b563d03
.long 0x3c80bce7, 0x3c973cd9, 0x3cc03cb6, 0xbcf83c38, 0x3d00bc04, 0xbc1e3cfc, 0xbc503cf3, 0xbc97bcd9
.long 0x3bd53d01, 0xbc503cf3, 0xbcd1bca2, 0xbc1ebcfc, 0xbcc03cb6, 0xbd043ad6, 0x3c80bce7, 0x3cf8bc38
.long 0xbd00bc04, 0xbc80bce7, 0x3cf83c38, 0x3c503cf3, 0xbc1ebcfc, 0x3c97bcd9, 0xbbd53d01, 0xbced3c69
.long 0x3cacbcc9, 0x3d033ba0, 0xbd04bad6, 0xbc80bce7, 0x3d033ba0, 0x3c1e3cfc, 0xbb56bd03, 0x3ce0bc8c
.long 0x3c503cf3, 0xbcc03cb6, 0x3d00bc04, 0x3c973cd9, 0xbc973cd9, 0xbcf8bc38, 0x3c503cf3, 0xbcd13ca2
.long 0xbd04bad6, 0xbb56bd03, 0xbce03c8c, 0xbcacbcc9, 0xbc80bce7, 0x3ce0bc8c, 0xbcacbcc9, 0x3cc0bcb6
.long 0x3c80bce7, 0x3ce03c8c, 0x3cacbcc9, 0x3cc03cb6, 0x3d04bad6, 0xbb563d03, 0x3ce03c8c, 0xbcac3cc9
.long 0x3c973cd9, 0xbcf83c38, 0xbc503cf3, 0xbcd1bca2, 0xbc503cf3, 0xbcc0bcb6, 0xbd00bc04, 0x3c97bcd9
.long 0xbd033ba0, 0x3c1ebcfc, 0x3b56bd03, 0x3ce03c8c, 0xbcacbcc9, 0x3d03bba0, 0x3d04bad6, 0xbc803ce7
.long 0x3c1ebcfc, 0x3cd1bca2, 0x3c503cf3, 0xbbd53d01, 0x3cf83c38, 0x3c803ce7, 0xbd04bad6, 0xbcc0bcb6
.long 0xbc503cf3, 0xbcf83c38, 0x3c80bce7, 0x3d00bc04, 0xbcedbc69, 0xbbd5bd01, 0x3c973cd9, 0xbc1e3cfc
.long 0x3c80bce7, 0x3d04bad6, 0xbd033ba0, 0xbcacbcc9, 0x3ce03c8c, 0xbb563d03, 0x3c1ebcfc, 0x3d03bba0
.long 0xbc973cd9, 0xbd00bc04, 0x3cc03cb6, 0xbc503cf3, 0xbcd1bca2, 0x3c50bcf3, 0xbcf83c38, 0xbc97bcd9
.long 0x3cacbcc9, 0x3ce03c8c, 0x3b56bd03, 0x3d04bad6, 0x3cc03cb6, 0xbcac3cc9, 0x3ce03c8c, 0xbc803ce7
.long 0xbcc03cb6, 0xbcacbcc9, 0xbce03c8c, 0xbc80bce7, 0xbcacbcc9, 0x3ce0bc8c, 0xbb56bd03, 0x3d043ad6
.long 0x3cd1bca2, 0x3c503cf3, 0x3cf83c38, 0xbc973cd9, 0x3c973cd9, 0xbd003c04, 0xbcc03cb6, 0xbc50bcf3
.long 0xbce03c8c, 0xbb56bd03, 0xbc1ebcfc, 0x3d033ba0, 0xbc80bce7, 0x3d043ad6, 0x3d033ba0, 0xbcac3cc9
.long 0x3d04bad6, 0x3ce03c8c, 0xbcc03cb6, 0xbd033ba0, 0xbbd53d01, 0xbcd13ca2, 0xbb56bd03, 0x3c97bcd9
.long 0xbcedbc69, 0xbc1ebcfc, 0x3ce03c8c, 0x3bd53d01, 0x3cacbcc9, 0x3d043ad6, 0xbcf83c38, 0xbce0bc8c
.long 0x3c973cd9, 0xbc503cf3, 0x3c1ebcfc, 0x3d00bc04, 0xbcf83c38, 0xbcc0bcb6, 0x3c973cd9, 0xbc803ce7
.long 0xbb56bd03, 0x3cedbc69, 0xbd04bad6, 0xbc1ebcfc, 0x3d033ba0, 0x3b563d03, 0x3cacbcc9, 0x3ced3c69
.long 0xbc503cf3, 0xbd00bc04, 0x3bd53d01, 0xbcf83c38, 0xbcd1bca2, 0x3c97bcd9, 0xbcedbc69, 0x3c50bcf3
.long 0x3cd1bca2, 0x3c973cd9, 0x3cedbc69, 0x3c503cf3, 0x3c503cf3, 0xbd003c04, 0xbbd53d01, 0xbcf8bc38
.long 0xbd033ba0, 0x3b56bd03, 0xbcacbcc9, 0x3cedbc69, 0x3b56bd03, 0x3ced3c69, 0x3d04bad6, 0xbc1e3cfc
.long 0x3cf83c38, 0xbcc03cb6, 0xbc973cd9, 0xbc80bce7, 0xbc973cd9, 0xbc50bcf3, 0xbc1ebcfc, 0x3d003c04
.long 0xbcedbc69, 0xbc80bce7, 0x3d00bc04, 0x3cf83c38, 0x3d00bc04, 0x3ced3c69, 0xbce03c8c, 0xbd03bba0
.long 0xbc973cd9, 0xbd033ba0, 0x3cacbcc9, 0x3d04bad6, 0xbb56bd03, 0x3cc0bcb6, 0xbc503cf3, 0xbd003c04
.long 0x3cc03cb6, 0xbbd53d01, 0x3b56bd03, 0x3cedbc69, 0xbd04bad6, 0xbc50bcf3, 0x3bd53d01, 0xbcd13ca2
.long 0x3cd1bca2, 0x3ce03c8c, 0xbc80bce7, 0x3cacbcc9, 0xbbd53d01, 0xbd043ad6, 0x3cc03cb6, 0xbc803ce7
.long 0xbc80bce7, 0x3cd1bca2, 0xbcedbc69, 0x3c1ebcfc, 0x3cf83c38, 0xbc1e3cfc, 0x3d033ba0, 0xbb563d03
.long 0xbcf83c38, 0xbc1ebcfc, 0xbd033ba0, 0xbb56bd03, 0x3c80bce7, 0x3cd13ca2, 0x3cedbc69, 0x3c1e3cfc
.long 0x3bd53d01, 0xbd04bad6, 0xbcc03cb6, 0xbc80bce7, 0xbcd1bca2, 0x3ce0bc8c, 0x3c80bce7, 0x3cac3cc9
.long 0x3d04bad6, 0xbc503cf3, 0xbbd53d01, 0xbcd1bca2, 0xbcc03cb6, 0xbbd5bd01, 0xbb56bd03, 0x3ced3c69
.long 0x3b56bd03, 0x3cacbcc9, 0x3c973cd9, 0x00003c84, 0x3c503cf3, 0xbc1e3cfc, 0xbcacbcc9, 0x0000bc84
.long 0xbcd1bca2, 0xbb56bd03, 0x3cc03cb6, 0x00003c84, 0x3d033ba0, 0x3c803ce7, 0xbcd1bca2, 0x0000bc84
.long 0xbcf83c38, 0xbcd1bca2, 0x3ce03c8c, 0x00003c84, 0x3cacbcc9, 0x3d003c04, 0xbcedbc69, 0x0000bc84
.long 0xbbd53d01, 0xbd033ba0, 0x3cf83c38, 0x00003c84, 0xbc1ebcfc, 0x3ce0bc8c, 0xbd00bc04, 0x0000bc84
.long 0x3cc03cb6, 0xbc973cd9, 0x3d033ba0, 0x00003c84, 0xbd00bc04, 0x3bd5bd01, 0xbd04bad6, 0x0000bc84
.long 0x3d00bc04, 0x3bd53d01, 0x3d04bad6, 0x00003c84, 0xbcc03cb6, 0xbc97bcd9, 0xbd033ba0, 0x0000bc84
.long 0x3c1ebcfc, 0x3ce03c8c, 0x3d00bc04, 0x00003c84, 0x3bd53d01, 0xbd03bba0, 0xbcf83c38, 0x0000bc84
.long 0xbcacbcc9, 0x3d00bc04, 0x3cedbc69, 0x00003c84, 0x3cf83c38, 0xbcd13ca2, 0xbce03c8c, 0x0000bc84
.long 0x00003c84, 0xbcd1bca2, 0xbc80bce7, 0x3d033ba0, 0x00003c84, 0xbcc0bcb6, 0xbb56bd03, 0x3cd13ca2
.long 0x00003c84, 0xbcacbcc9, 0x3c1ebcfc, 0x3c503cf3, 0x00003c84, 0xbc97bcd9, 0x3cacbcc9, 0xbb563d03
.long 0x00003c84, 0xbc80bce7, 0x3cedbc69, 0xbc973cd9, 0x00003c84, 0xbc50bcf3, 0x3d04bad6, 0xbced3c69
.long 0x00003c84, 0xbc1ebcfc, 0x3cf83c38, 0xbd04bad6, 0x00003c84, 0xbbd5bd01, 0x3cc03cb6, 0xbce0bc8c
.long 0x00003c84, 0xbb56bd03, 0x3c503cf3, 0xbc80bce7, 0x00003c84, 0x0000bd04, 0x00003d04, 0x0000bd04
.long 0x00003c84, 0x3b56bd03, 0xbc503cf3, 0x3c80bce7, 0x00003c84, 0x3bd5bd01, 0xbcc03cb6, 0x3ce0bc8c
.long 0x00003c84, 0x3c1ebcfc, 0xbcf83c38, 0x3d04bad6, 0x00003c84, 0x3c50bcf3, 0xbd04bad6, 0x3ced3c69
.long 0x00003c84, 0x3c80bce7, 0xbcedbc69, 0x3c973cd9, 0x00003c84, 0x3c97bcd9, 0xbcacbcc9, 0x3b563d03
.long 0x3d00bc04, 0xbc503cf3, 0xbcc03cb6, 0xbb56bd03, 0x3d04bad6, 0xbcac3cc9, 0xbd033ba0, 0x3c97bcd9
.long 0x3d033ba0, 0xbce03c8c, 0xbcedbc69, 0x3d00bc04, 0x3cf83c38, 0xbd003c04, 0xbc80bce7, 0x3ced3c69
.long 0x3ce03c8c, 0xbd04bad6, 0x3b56bd03, 0x3c503cf3, 0x3cc03cb6, 0xbcf8bc38, 0x3cacbcc9, 0xbc1e3cfc
.long 0x3c973cd9, 0xbcd1bca2, 0x3d00bc04, 0xbce03c8c, 0x3c503cf3, 0xbc97bcd9, 0x3cf83c38, 0xbd03bba0
.long 0x3bd53d01, 0xbc1ebcfc, 0x3c973cd9, 0xbcacbcc9, 0x00003d04, 0x0000bd04, 0x00003d04, 0x0000bd04
.long 0xbbd53d01, 0x3c1ebcfc, 0xbc973cd9, 0x3cacbcc9, 0xbc503cf3, 0x3c97bcd9, 0xbcf83c38, 0x3d03bba0
.long 0xbc973cd9, 0x3cd1bca2, 0xbd00bc04, 0x3ce03c8c, 0xbcc03cb6, 0x3cf8bc38, 0xbcacbcc9, 0x3c1e3cfc
.long 0xbce03c8c, 0x3d04bad6, 0xbb56bd03, 0xbc503cf3, 0xbcf83c38, 0x3d003c04, 0x3c80bce7, 0xbced3c69
.long 0x3ce03c8c, 0xbcf83c38, 0xbd04bad6, 0x3cacbcc9, 0x3bd53d01, 0xbce0bc8c, 0xbc1ebcfc, 0x3ced3c69
.long 0xbc973cd9, 0xbb56bd03, 0x3cd1bca2, 0xbbd53d01, 0xbd033ba0, 0x3cc0bcb6, 0x3ce03c8c, 0xbd043ad6
.long 0xbcd1bca2, 0x3d033ba0, 0xbbd53d01, 0xbc1ebcfc, 0xbb56bd03, 0x3c803ce7, 0xbd033ba0, 0x3ce0bc8c
.long 0x3cacbcc9, 0xbc503cf3, 0xbc80bce7, 0x3cc03cb6, 0x3d04bad6, 0xbd003c04, 0x3cacbcc9, 0xbc803ce7
.long 0x3cc03cb6, 0xbcd1bca2, 0x3cf83c38, 0xbd00bc04, 0x00003d04, 0x0000bd04, 0x00003d04, 0x0000bd04
.long 0xbcc03cb6, 0x3cd1bca2, 0xbcf83c38, 0x3d00bc04, 0xbd04bad6, 0x3d003c04, 0xbcacbcc9, 0x3c803ce7
.long 0xbcacbcc9, 0x3c503cf3, 0x3c80bce7, 0xbcc03cb6, 0x3b56bd03, 0xbc803ce7, 0x3d033ba0, 0xbce0bc8c
.long 0x3cd1bca2, 0xbd033ba0, 0x3bd53d01, 0x3c1ebcfc, 0x3d033ba0, 0xbcc0bcb6, 0xbce03c8c, 0x3d043ad6
.long 0x3c1ebcfc, 0x3c973cd9, 0x3bd53d01, 0xbcedbc69, 0x3d00bc04, 0xbc803ce7, 0xbcf83c38, 0x3c50bcf3
.long 0x3cc03cb6, 0xbd04bad6, 0xbc80bce7, 0x3cf83c38, 0xbbd53d01, 0xbc50bcf3, 0x3cd1bca2, 0xbc1e3cfc
.long 0xbcf83c38, 0x3cacbcc9, 0x3cc03cb6, 0xbd00bc04, 0xbcd1bca2, 0x3d003c04, 0xbc973cd9, 0x3bd5bd01
.long 0x3b56bd03, 0x3bd53d01, 0xbcedbc69, 0x3d033ba0, 0x3cedbc69, 0xbcd13ca2, 0x3c1ebcfc, 0xbb563d03
.long 0x3ce03c8c, 0xbcedbc69, 0x3d033ba0, 0xbd04bad6, 0x00003d04, 0x0000bd04, 0x00003d04, 0x0000bd04
.long 0xbce03c8c, 0x3cedbc69, 0xbd033ba0, 0x3d04bad6, 0xbcedbc69, 0x3cd13ca2, 0xbc1ebcfc, 0x3b563d03
.long 0xbb56bd03, 0xbbd53d01, 0x3cedbc69, 0xbd033ba0, 0x3cd1bca2, 0xbd003c04, 0x3c973cd9, 0xbbd5bd01
.long 0x3cf83c38, 0xbcacbcc9, 0xbcc03cb6, 0x3d00bc04, 0x3bd53d01, 0x3c50bcf3, 0xbcd1bca2, 0x3c1e3cfc
.long 0x3cedbc69, 0xbbd53d01, 0xbc973cd9, 0xbc1ebcfc, 0x3c503cf3, 0xbcf8bc38, 0xbc80bce7, 0x3d003c04
.long 0xbcf83c38, 0x3c80bce7, 0x3d04bad6, 0xbcc03cb6, 0xbc1ebcfc, 0x3cd13ca2, 0xbc503cf3, 0xbbd5bd01
.long 0x3d00bc04, 0xbcc03cb6, 0xbcacbcc9, 0x3cf83c38, 0x3bd53d01, 0xbc97bcd9, 0x3d00bc04, 0xbcd13ca2
.long 0xbd033ba0, 0x3cedbc69, 0xbbd53d01, 0xbb56bd03, 0xbb56bd03, 0x3c1e3cfc, 0xbcd1bca2, 0x3ced3c69
.long 0x3d04bad6, 0xbd033ba0, 0x3cedbc69, 0xbce03c8c, 0x00003d04, 0x0000bd04, 0x00003d04, 0x0000bd04
.long 0xbd04bad6, 0x3d033ba0, 0xbcedbc69, 0x3ce03c8c, 0x3b56bd03, 0xbc1e3cfc, 0x3cd1bca2, 0xbced3c69
.long 0x3d033ba0, 0xbcedbc69, 0x3bd53d01, 0x3b56bd03, 0xbbd53d01, 0x3c97bcd9, 0xbd00bc04, 0x3cd13ca2
.long 0xbd00bc04, 0x3cc03cb6, 0x3cacbcc9, 0xbcf83c38, 0x3c1ebcfc, 0xbcd13ca2, 0x3c503cf3, 0x3bd5bd01
.long 0xbcacbcc9, 0x3d04bad6, 0x3cf83c38, 0xbce03c8c, 0x3cedbc69, 0xbc1e3cfc, 0xbce03c8c, 0x3bd5bd01
.long 0x3bd53d01, 0xbcd1bca2, 0x3b56bd03, 0x3c973cd9, 0xbd04bad6, 0x3ce0bc8c, 0x3cc03cb6, 0xbd03bba0
.long 0x3c1ebcfc, 0x3bd53d01, 0xbd033ba0, 0x3cd1bca2, 0x3ce03c8c, 0xbd03bba0, 0x3c80bce7, 0xbb563d03
.long 0xbcc03cb6, 0x3c80bce7, 0x3c503cf3, 0xbcacbcc9, 0xbc80bce7, 0x3cac3cc9, 0xbd00bc04, 0x3d043ad6
.long 0x3d00bc04, 0xbcf83c38, 0x3cd1bca2, 0xbcc03cb6, 0x00003d04, 0x0000bd04, 0x00003d04, 0x0000bd04
.long 0xbd00bc04, 0x3cf83c38, 0xbcd1bca2, 0x3cc03cb6, 0x3c80bce7, 0xbcac3cc9, 0x3d00bc04, 0xbd043ad6
.long 0x3cc03cb6, 0xbc80bce7, 0xbc503cf3, 0x3cacbcc9, 0xbce03c8c, 0x3d03bba0, 0xbc80bce7, 0x3b563d03
.long 0xbc1ebcfc, 0xbbd53d01, 0x3d033ba0, 0xbcd1bca2, 0x3d04bad6, 0xbce0bc8c, 0xbcc03cb6, 0x3d03bba0
.long 0x3b56bd03, 0x3cc03cb6, 0x3c503cf3, 0xbd00bc04, 0x3c973cd9, 0xbd03bba0, 0xbcacbcc9, 0x3d043ad6
.long 0xbd00bc04, 0x3cedbc69, 0x3ce03c8c, 0xbd033ba0, 0x3cedbc69, 0xbc803ce7, 0xbd00bc04, 0x3cf8bc38
.long 0xbc503cf3, 0xbb56bd03, 0x3d04bad6, 0xbce03c8c, 0xbc1ebcfc, 0x3cac3cc9, 0xbcf83c38, 0x3cc0bcb6
.long 0x3ce03c8c, 0xbd00bc04, 0x3cd1bca2, 0xbc973cd9, 0xbd033ba0, 0x3cf8bc38, 0xbc973cd9, 0x3c50bcf3
.long 0x3cacbcc9, 0xbc973cd9, 0x3c1ebcfc, 0xbbd53d01, 0x00003d04, 0x0000bd04, 0x00003d04, 0x0000bd04
.long 0xbcacbcc9, 0x3c973cd9, 0xbc1ebcfc, 0x3bd53d01, 0x3d033ba0, 0xbcf8bc38, 0x3c973cd9, 0xbc50bcf3
.long 0xbce03c8c, 0x3d00bc04, 0xbcd1bca2, 0x3c973cd9, 0x3c1ebcfc, 0xbcac3cc9, 0x3cf83c38, 0xbcc0bcb6
.long 0x3c503cf3, 0x3b56bd03, 0xbd04bad6, 0x3ce03c8c, 0xbcedbc69, 0x3c803ce7, 0x3d00bc04, 0xbcf8bc38
.long 0xbd033ba0, 0x3c80bce7, 0x3cd1bca2, 0x00003c84, 0x3cd1bca2, 0xbb563d03, 0xbcc03cb6, 0x0000bc84
.long 0xbc503cf3, 0xbc1ebcfc, 0x3cacbcc9, 0x00003c84, 0xbb56bd03, 0x3cac3cc9, 0xbc973cd9, 0x0000bc84
.long 0x3c973cd9, 0xbcedbc69, 0x3c80bce7, 0x00003c84, 0xbcedbc69, 0x3d043ad6, 0xbc503cf3, 0x0000bc84
.long 0x3d04bad6, 0xbcf83c38, 0x3c1ebcfc, 0x00003c84, 0xbce03c8c, 0x3cc0bcb6, 0xbbd53d01, 0x0000bc84
.long 0x3c80bce7, 0xbc503cf3, 0x3b56bd03, 0x00003c84, 0x00003d04, 0x0000bd04, 0x00003d04, 0x0000bc84
.long 0xbc80bce7, 0x3c503cf3, 0xbb56bd03, 0x00003c84, 0x3ce03c8c, 0xbcc0bcb6, 0x3bd53d01, 0x0000bc84
.long 0xbd04bad6, 0x3cf83c38, 0xbc1ebcfc, 0x00003c84, 0x3cedbc69, 0xbd043ad6, 0x3c503cf3, 0x0000bc84
.long 0xbc973cd9, 0x3cedbc69, 0xbc80bce7, 0x00003c84, 0x3b56bd03, 0xbcac3cc9, 0x3c973cd9, 0x0000bc84
.long 0x00003c84, 0x3cacbcc9, 0xbc1ebcfc, 0xbc503cf3, 0x00003c84, 0x3cc0bcb6, 0x3b56bd03, 0xbcd13ca2
.long 0x00003c84, 0x3cd1bca2, 0x3c80bce7, 0xbd033ba0, 0x00003c84, 0x3ce0bc8c, 0x3cd1bca2, 0xbcf8bc38
.long 0x00003c84, 0x3cedbc69, 0x3d00bc04, 0xbcacbcc9, 0x00003c84, 0x3cf8bc38, 0x3d033ba0, 0xbbd5bd01
.long 0x00003c84, 0x3d00bc04, 0x3ce03c8c, 0x3c1ebcfc, 0x00003c84, 0x3d03bba0, 0x3c973cd9, 0x3cc0bcb6
.long 0x00003c84, 0x3d04bad6, 0x3bd53d01, 0x3d00bc04, 0x00003c84, 0x3d043ad6, 0xbbd53d01, 0x3d003c04
.long 0x00003c84, 0x3d033ba0, 0xbc973cd9, 0x3cc03cb6, 0x00003c84, 0x3d003c04, 0xbce03c8c, 0x3c1e3cfc
.long 0x00003c84, 0x3cf83c38, 0xbd033ba0, 0xbbd53d01, 0x00003c84, 0x3ced3c69, 0xbd00bc04, 0xbcac3cc9
.long 0x00003c84, 0x3ce03c8c, 0xbcd1bca2, 0xbcf83c38, 0x00003c84, 0x3cd13ca2, 0xbc80bce7, 0xbd03bba0
.long 0xbd033ba0, 0x3ce03c8c, 0x3cedbc69, 0xbd00bc04, 0xbd04bad6, 0x3cac3cc9, 0x3d033ba0, 0xbc97bcd9
.long 0xbd00bc04, 0x3c503cf3, 0x3cc03cb6, 0x3b56bd03, 0xbcedbc69, 0x3b563d03, 0x3bd53d01, 0x3cc0bcb6
.long 0xbcd1bca2, 0xbbd53d01, 0xbc503cf3, 0x3d04bad6, 0xbcacbcc9, 0xbc803ce7, 0xbce03c8c, 0x3cd13ca2
.long 0xbc80bce7, 0xbcc03cb6, 0xbd04bad6, 0x3bd53d01, 0xbc1ebcfc, 0xbced3c69, 0xbcd1bca2, 0xbc803ce7
.long 0xbb56bd03, 0xbd033ba0, 0xbc1ebcfc, 0xbcf83c38, 0x3b56bd03, 0xbd03bba0, 0x3c1ebcfc, 0xbcf8bc38
.long 0x3c1ebcfc, 0xbcedbc69, 0x3cd1bca2, 0xbc80bce7, 0x3c80bce7, 0xbcc0bcb6, 0x3d04bad6, 0x3bd5bd01
.long 0x3cacbcc9, 0xbc80bce7, 0x3ce03c8c, 0x3cd1bca2, 0x3cd1bca2, 0xbbd5bd01, 0x3c503cf3, 0x3d043ad6
.long 0x3cedbc69, 0x3b56bd03, 0xbbd53d01, 0x3cc03cb6, 0x3d00bc04, 0x3c50bcf3, 0xbcc03cb6, 0x3b563d03
.long 0x3c973cd9, 0x3b56bd03, 0xbcd1bca2, 0x3bd53d01, 0xbbd53d01, 0x3ce0bc8c, 0x3c1ebcfc, 0xbced3c69
.long 0xbce03c8c, 0x3cf83c38, 0x3d04bad6, 0xbcacbcc9, 0xbd00bc04, 0x3c1e3cfc, 0x3c503cf3, 0x3c97bcd9
.long 0xbc80bce7, 0xbc973cd9, 0xbcc03cb6, 0x3cf83c38, 0x3c1ebcfc, 0xbd043ad6, 0xbcedbc69, 0xbb563d03
.long 0x3cedbc69, 0xbcacbcc9, 0x3b56bd03, 0xbd033ba0, 0x3cf83c38, 0x3bd5bd01, 0x3d00bc04, 0xbc50bcf3
.long 0x3c503cf3, 0x3cedbc69, 0x3c973cd9, 0x3cd1bca2, 0xbc503cf3, 0x3ced3c69, 0xbc973cd9, 0x3cd13ca2
.long 0xbcf83c38, 0x3bd53d01, 0xbd00bc04, 0xbc503cf3, 0xbcedbc69, 0xbcac3cc9, 0xbb56bd03, 0xbd03bba0
.long 0xbc1ebcfc, 0xbd04bad6, 0x3cedbc69, 0xbb56bd03, 0x3c80bce7, 0xbc97bcd9, 0x3cc03cb6, 0x3cf8bc38
.long 0x3d00bc04, 0x3c1ebcfc, 0xbc503cf3, 0x3c973cd9, 0x3ce03c8c, 0x3cf8bc38, 0xbd04bad6, 0xbcac3cc9
.long 0xbcc03cb6, 0x3d04bad6, 0x3c80bce7, 0xbcf83c38, 0xbd00bc04, 0x3c803ce7, 0x3cf83c38, 0xbc50bcf3
.long 0xbc1ebcfc, 0xbc973cd9, 0xbbd53d01, 0x3cedbc69, 0x3cacbcc9, 0xbd03bba0, 0xbd04bad6, 0x3c803ce7
.long 0x3d033ba0, 0xbc1ebcfc, 0xbb56bd03, 0xbce03c8c, 0x3c503cf3, 0x3cc0bcb6, 0x3d00bc04, 0xbc97bcd9
.long 0xbc973cd9, 0x3cf83c38, 0x3c503cf3, 0x3cd1bca2, 0xbd04bad6, 0x3b563d03, 0xbce03c8c, 0x3cac3cc9
.long 0xbc80bce7, 0xbce03c8c, 0xbcacbcc9, 0xbcc03cb6, 0x3c80bce7, 0xbce0bc8c, 0x3cacbcc9, 0xbcc0bcb6
.long 0x3d04bad6, 0x3b56bd03, 0x3ce03c8c, 0x3cacbcc9, 0x3c973cd9, 0x3cf8bc38, 0xbc503cf3, 0x3cd13ca2
.long 0xbc503cf3, 0x3cc03cb6, 0xbd00bc04, 0xbc973cd9, 0xbd033ba0, 0xbc1e3cfc, 0x3b56bd03, 0xbce0bc8c
.long 0xbcacbcc9, 0xbd033ba0, 0x3d04bad6, 0x3c80bce7, 0x3c1ebcfc, 0xbc97bcd9, 0x3bd53d01, 0x3ced3c69
.long 0x3cf83c38, 0xbc80bce7, 0xbd04bad6, 0x3cc03cb6, 0xbc503cf3, 0x3cf8bc38, 0x3c80bce7, 0xbd003c04
.long 0xbcedbc69, 0x3bd53d01, 0x3c973cd9, 0x3c1ebcfc, 0x3c80bce7, 0xbd043ad6, 0xbd033ba0, 0x3cac3cc9
.long 0x3ce03c8c, 0x3b56bd03, 0x3c1ebcfc, 0xbd033ba0, 0xbc973cd9, 0x3d003c04, 0x3cc03cb6, 0x3c50bcf3
.long 0xbcd1bca2, 0xbc503cf3, 0xbcf83c38, 0x3c973cd9, 0x3cacbcc9, 0xbce0bc8c, 0x3b56bd03, 0xbd043ad6
.long 0x3cc03cb6, 0x3cacbcc9, 0x3ce03c8c, 0x3c80bce7, 0xbcc03cb6, 0x3cac3cc9, 0xbce03c8c, 0x3c803ce7
.long 0xbcacbcc9, 0xbce03c8c, 0xbb56bd03, 0xbd04bad6, 0x3cd1bca2, 0xbc50bcf3, 0x3cf83c38, 0x3c97bcd9
.long 0x3c973cd9, 0x3d00bc04, 0xbcc03cb6, 0x3c503cf3, 0xbce03c8c, 0x3b563d03, 0xbc1ebcfc, 0xbd03bba0
.long 0xbc80bce7, 0xbd04bad6, 0x3d033ba0, 0x3cacbcc9, 0x3cedbc69, 0x3bd5bd01, 0xbc973cd9, 0x3c1e3cfc
.long 0xbbd53d01, 0x3cd1bca2, 0xbb56bd03, 0xbc973cd9, 0xbcedbc69, 0x3c1e3cfc, 0x3ce03c8c, 0xbbd5bd01
.long 0x3cacbcc9, 0xbd04bad6, 0xbcf83c38, 0x3ce03c8c, 0x3c973cd9, 0x3c50bcf3, 0x3c1ebcfc, 0xbd003c04
.long 0xbcf83c38, 0x3cc03cb6, 0x3c973cd9, 0x3c80bce7, 0xbb56bd03, 0xbced3c69, 0xbd04bad6, 0x3c1e3cfc
.long 0x3d033ba0, 0xbb56bd03, 0x3cacbcc9, 0xbcedbc69, 0xbc503cf3, 0x3d003c04, 0x3bd53d01, 0x3cf8bc38
.long 0xbcd1bca2, 0xbc973cd9, 0xbcedbc69, 0xbc503cf3, 0x3cd1bca2, 0xbc97bcd9, 0x3cedbc69, 0xbc50bcf3
.long 0x3c503cf3, 0x3d00bc04, 0xbbd53d01, 0x3cf83c38, 0xbd033ba0, 0xbb563d03, 0xbcacbcc9, 0xbced3c69
.long 0x3b56bd03, 0xbcedbc69, 0x3d04bad6, 0x3c1ebcfc, 0x3cf83c38, 0x3cc0bcb6, 0xbc973cd9, 0x3c803ce7
.long 0xbc973cd9, 0x3c503cf3, 0xbc1ebcfc, 0xbd00bc04, 0xbcacbcc9, 0xbd043ad6, 0x3cf83c38, 0x3ce0bc8c
.long 0x3d00bc04, 0xbcedbc69, 0xbce03c8c, 0x3d033ba0, 0xbc973cd9, 0x3d03bba0, 0x3cacbcc9, 0xbd043ad6
.long 0xbb56bd03, 0xbcc03cb6, 0xbc503cf3, 0x3d00bc04, 0x3cc03cb6, 0x3bd5bd01, 0x3b56bd03, 0xbced3c69
.long 0xbd04bad6, 0x3c503cf3, 0x3bd53d01, 0x3cd1bca2, 0x3cd1bca2, 0xbce0bc8c, 0xbc80bce7, 0xbcac3cc9
.long 0xbbd53d01, 0x3d04bad6, 0x3cc03cb6, 0x3c80bce7, 0xbc80bce7, 0xbcd13ca2, 0xbcedbc69, 0xbc1e3cfc
.long 0x3cf83c38, 0x3c1ebcfc, 0x3d033ba0, 0x3b56bd03, 0xbcf83c38, 0x3c1e3cfc, 0xbd033ba0, 0x3b563d03
.long 0x3c80bce7, 0xbcd1bca2, 0x3cedbc69, 0xbc1ebcfc, 0x3bd53d01, 0x3d043ad6, 0xbcc03cb6, 0x3c803ce7
.long 0xbcd1bca2, 0xbce03c8c, 0x3c80bce7, 0xbcacbcc9, 0x3d04bad6, 0x3c50bcf3, 0xbbd53d01, 0x3cd13ca2
.long 0xbcc03cb6, 0x3bd53d01, 0xbb56bd03, 0xbcedbc69, 0x3b56bd03, 0xbcc0bcb6, 0x3c503cf3, 0x3d003c04
.long 0x3c503cf3, 0x3c1ebcfc, 0xbcacbcc9, 0x00003c84, 0xbcd1bca2, 0x3b563d03, 0x3cc03cb6, 0x0000bc84
.long 0x3d033ba0, 0xbc80bce7, 0xbcd1bca2, 0x00003c84, 0xbcf83c38, 0x3cd13ca2, 0x3ce03c8c, 0x0000bc84
.long 0x3cacbcc9, 0xbd00bc04, 0xbcedbc69, 0x00003c84, 0xbbd53d01, 0x3d03bba0, 0x3cf83c38, 0x0000bc84
.long 0xbc1ebcfc, 0xbce03c8c, 0xbd00bc04, 0x00003c84, 0x3cc03cb6, 0x3c97bcd9, 0x3d033ba0, 0x0000bc84
.long 0xbd00bc04, 0xbbd53d01, 0xbd04bad6, 0x00003c84, 0x3d00bc04, 0xbbd5bd01, 0x3d04bad6, 0x0000bc84
.long 0xbcc03cb6, 0x3c973cd9, 0xbd033ba0, 0x00003c84, 0x3c1ebcfc, 0xbce0bc8c, 0x3d00bc04, 0x0000bc84
.long 0x3bd53d01, 0x3d033ba0, 0xbcf83c38, 0x00003c84, 0xbcacbcc9, 0xbd003c04, 0x3cedbc69, 0x0000bc84
.long 0x3cf83c38, 0x3cd1bca2, 0xbce03c8c, 0x00003c84, 0xbd033ba0, 0xbc803ce7, 0x3cd1bca2, 0x0000bc84
.long 0x00003c84, 0x3cc03cb6, 0xbb56bd03, 0xbcd1bca2, 0x00003c84, 0x3cac3cc9, 0x3c1ebcfc, 0xbc50bcf3
.long 0x00003c84, 0x3c973cd9, 0x3cacbcc9, 0x3b56bd03, 0x00003c84, 0x3c803ce7, 0x3cedbc69, 0x3c97bcd9
.long 0x00003c84, 0x3c503cf3, 0x3d04bad6, 0x3cedbc69, 0x00003c84, 0x3c1e3cfc, 0x3cf83c38, 0x3d043ad6
.long 0x00003c84, 0x3bd53d01, 0x3cc03cb6, 0x3ce03c8c, 0x00003c84, 0x3b563d03, 0x3c503cf3, 0x3c803ce7
.long 0x00000000, 0x00000000, 0x00000000, 0x00000000, 0x00000000, 0x00000000, 0x00000000, 0x00000000
.long 0x00000000, 0x00000000, 0x00000000, 0x00000000, 0x00000000, 0x00000000, 0x00000000, 0x00000000
.long 0x00000000, 0x00000000, 0x00000000, 0x00000000, 0x00000000, 0x00000000, 0x00000000, 0x00000000
.long 0x00000000, 0x00000000, 0x00000000, 0x00000000, 0x00000000, 0x00000000, 0x00000000, 0x00000000
.long 0x3d04bad6, 0x3cacbcc9, 0xbd033ba0, 0xbc973cd9, 0x3d033ba0, 0x3ce0bc8c, 0xbcedbc69, 0xbd003c04
.long 0x3cf83c38, 0x3d00bc04, 0xbc80bce7, 0xbcedbc69, 0x3ce03c8c, 0x3d043ad6, 0x3b56bd03, 0xbc50bcf3
.long 0x3cc03cb6, 0x3cf83c38, 0x3cacbcc9, 0x3c1ebcfc, 0x3c973cd9, 0x3cd13ca2, 0x3d00bc04, 0x3ce0bc8c
.long 0x3c503cf3, 0x3c973cd9, 0x3cf83c38, 0x3d033ba0, 0x3bd53d01, 0x3c1e3cfc, 0x3c973cd9, 0x3cac3cc9
.long 0x00000000, 0x00000000, 0x00000000, 0x00000000, 0x00000000, 0x00000000, 0x00000000, 0x00000000
.long 0x00000000, 0x00000000, 0x00000000, 0x00000000, 0x00000000, 0x00000000, 0x00000000, 0x00000000
.long 0x00000000, 0x00000000, 0x00000000, 0x00000000, 0x00000000, 0x00000000, 0x00000000, 0x00000000
.long 0x00000000, 0x00000000, 0x00000000, 0x00000000, 0x00000000, 0x00000000, 0x00000000, 0x00000000
.long 0x3bd53d01, 0x3ce03c8c, 0xbc1ebcfc, 0xbcedbc69, 0xbc973cd9, 0x3b563d03, 0x3cd1bca2, 0x3bd5bd01
.long 0xbd033ba0, 0xbcc03cb6, 0x3ce03c8c, 0x3d04bad6, 0xbcd1bca2, 0xbd03bba0, 0xbbd53d01, 0x3c1e3cfc
.long 0xbb56bd03, 0xbc80bce7, 0xbd033ba0, 0xbce03c8c, 0x3cacbcc9, 0x3c50bcf3, 0xbc80bce7, 0xbcc0bcb6
.long 0x3d04bad6, 0x3d00bc04, 0x3cacbcc9, 0x3c80bce7, 0x3cc03cb6, 0x3cd13ca2, 0x3cf83c38, 0x3d003c04
.long 0x00000000, 0x00000000, 0x00000000, 0x00000000, 0x00000000, 0x00000000, 0x00000000, 0x00000000
.long 0x00000000, 0x00000000, 0x00000000, 0x00000000, 0x00000000, 0x00000000, 0x00000000, 0x00000000
.long 0x00000000, 0x00000000, 0x00000000, 0x00000000, 0x00000000, 0x00000000, 0x00000000, 0x00000000
.long 0x00000000, 0x00000000, 0x00000000, 0x00000000, 0x00000000, 0x00000000, 0x00000000, 0x00000000
.long 0x3d00bc04, 0x3c80bce7, 0xbcf83c38, 0xbc503cf3, 0x3cc03cb6, 0x3d043ad6, 0xbc80bce7, 0xbcf8bc38
.long 0xbbd53d01, 0x3c503cf3, 0x3cd1bca2, 0x3c1ebcfc, 0xbcf83c38, 0xbcac3cc9, 0x3cc03cb6, 0x3d003c04
.long 0xbcd1bca2, 0xbd00bc04, 0xbc973cd9, 0xbbd53d01, 0x3b56bd03, 0xbbd5bd01, 0xbcedbc69, 0xbd03bba0
.long 0x3cedbc69, 0x3cd1bca2, 0x3c1ebcfc, 0x3b56bd03, 0x3ce03c8c, 0x3ced3c69, 0x3d033ba0, 0x3d043ad6
.long 0x00000000, 0x00000000, 0x00000000, 0x00000000, 0x00000000, 0x00000000, 0x00000000, 0x00000000
.long 0x00000000, 0x00000000, 0x00000000, 0x00000000, 0x00000000, 0x00000000, 0x00000000, 0x00000000
.long 0x00000000, 0x00000000, 0x00000000, 0x00000000, 0x00000000, 0x00000000, 0x00000000, 0x00000000
.long 0x00000000, 0x00000000, 0x00000000, 0x00000000, 0x00000000, 0x00000000, 0x00000000, 0x00000000
.long 0x3c503cf3, 0x3cf83c38, 0xbc80bce7, 0xbd00bc04, 0xbcf83c38, 0xbc803ce7, 0x3d04bad6, 0x3cc0bcb6
.long 0xbc1ebcfc, 0xbcd1bca2, 0xbc503cf3, 0x3bd53d01, 0x3d00bc04, 0x3cc0bcb6, 0xbcacbcc9, 0xbcf8bc38
.long 0x3bd53d01, 0x3c973cd9, 0x3d00bc04, 0x3cd1bca2, 0xbd033ba0, 0xbced3c69, 0xbbd53d01, 0x3b563d03
.long 0xbb56bd03, 0xbc1ebcfc, 0xbcd1bca2, 0xbcedbc69, 0x3d04bad6, 0x3d03bba0, 0x3cedbc69, 0x3ce0bc8c
.long 0x00000000, 0x00000000, 0x00000000, 0x00000000, 0x00000000, 0x00000000, 0x00000000, 0x00000000
.long 0x00000000, 0x00000000, 0x00000000, 0x00000000, 0x00000000, 0x00000000, 0x00000000, 0x00000000
.long 0x00000000, 0x00000000, 0x00000000, 0x00000000, 0x00000000, 0x00000000, 0x00000000, 0x00000000
.long 0x00000000, 0x00000000, 0x00000000, 0x00000000, 0x00000000, 0x00000000, 0x00000000, 0x00000000
.long 0x3cedbc69, 0x3c1ebcfc, 0xbce03c8c, 0xbbd53d01, 0x3bd53d01, 0x3cd13ca2, 0x3b56bd03, 0xbc97bcd9
.long 0xbd04bad6, 0xbce03c8c, 0x3cc03cb6, 0x3d033ba0, 0x3c1ebcfc, 0xbbd5bd01, 0xbd033ba0, 0xbcd13ca2
.long 0x3ce03c8c, 0x3d033ba0, 0x3c80bce7, 0x3b56bd03, 0xbcc03cb6, 0xbc803ce7, 0x3c503cf3, 0x3cac3cc9
.long 0xbc80bce7, 0xbcacbcc9, 0xbd00bc04, 0xbd04bad6, 0x3d00bc04, 0x3cf8bc38, 0x3cd1bca2, 0x3cc0bcb6
.long 0x00000000, 0x00000000, 0x00000000, 0x00000000, 0x00000000, 0x00000000, 0x00000000, 0x00000000
.long 0x00000000, 0x00000000, 0x00000000, 0x00000000, 0x00000000, 0x00000000, 0x00000000, 0x00000000
.long 0x00000000, 0x00000000, 0x00000000, 0x00000000, 0x00000000, 0x00000000, 0x00000000, 0x00000000
.long 0x00000000, 0x00000000, 0x00000000, 0x00000000, 0x00000000, 0x00000000, 0x00000000, 0x00000000
.long 0x3c973cd9, 0x3d033ba0, 0xbcacbcc9, 0xbd04bad6, 0xbd00bc04, 0xbced3c69, 0x3ce03c8c, 0x3d03bba0
.long 0x3cedbc69, 0x3c80bce7, 0xbd00bc04, 0xbcf83c38, 0xbc503cf3, 0x3b563d03, 0x3d04bad6, 0x3ce0bc8c
.long 0xbc1ebcfc, 0xbcacbcc9, 0xbcf83c38, 0xbcc03cb6, 0x3ce03c8c, 0x3d003c04, 0x3cd1bca2, 0x3c97bcd9
.long 0xbd033ba0, 0xbcf83c38, 0xbc973cd9, 0xbc503cf3, 0x3cacbcc9, 0x3c97bcd9, 0x3c1ebcfc, 0x3bd5bd01
.long 0x00000000, 0x00000000, 0x00000000, 0x00000000, 0x00000000, 0x00000000, 0x00000000, 0x00000000
.long 0x00000000, 0x00000000, 0x00000000, 0x00000000, 0x00000000, 0x00000000, 0x00000000, 0x00000000
.long 0x00000000, 0x00000000, 0x00000000, 0x00000000, 0x00000000, 0x00000000, 0x00000000, 0x00000000
.long 0x00000000, 0x00000000, 0x00000000, 0x00000000, 0x00000000, 0x00000000, 0x00000000, 0x00000000
.long 0x3cd1bca2, 0x3b56bd03, 0xbcc03cb6, 0x00003c84, 0xbc503cf3, 0x3c1e3cfc, 0x3cacbcc9, 0x0000bc84
.long 0xbb56bd03, 0xbcacbcc9, 0xbc973cd9, 0x00003c84, 0x3c973cd9, 0x3ced3c69, 0x3c80bce7, 0x0000bc84
.long 0xbcedbc69, 0xbd04bad6, 0xbc503cf3, 0x00003c84, 0x3d04bad6, 0x3cf8bc38, 0x3c1ebcfc, 0x0000bc84
.long 0xbce03c8c, 0xbcc03cb6, 0xbbd53d01, 0x00003c84, 0x3c80bce7, 0x3c50bcf3, 0x3b56bd03, 0x0000bc84
.long 0x00000000, 0x00000000, 0x00000000, 0x00000000, 0x00000000, 0x00000000, 0x00000000, 0x00000000
.long 0x00000000, 0x00000000, 0x00000000, 0x00000000, 0x00000000, 0x00000000, 0x00000000, 0x00000000
.long 0x00000000, 0x00000000, 0x00000000, 0x00000000, 0x00000000, 0x00000000, 0x00000000, 0x00000000
.long 0x00000000, 0x00000000, 0x00000000, 0x00000000, 0x00000000, 0x00000000, 0x00000000, 0x00000000
fft_tables_end:
.size fft_tables, fft_tables_end-fft_tables
.section .rodata,"a"
.p2align 6
.amdhsa_kernel k1_kernel
  .amdhsa_next_free_vgpr 240
  .amdhsa_next_free_sgpr 72
  .amdhsa_accum_offset 240
  .amdhsa_group_segment_fixed_size 0
  .amdhsa_kernarg_size 40
  .amdhsa_user_sgpr_count 2
  .amdhsa_user_sgpr_kernarg_segment_ptr 1
  .amdhsa_system_sgpr_workgroup_id_x 1
.end_amdhsa_kernel
.p2align 6
.amdhsa_kernel k2_kernel
  .amdhsa_next_free_vgpr 512
  .amdhsa_next_free_sgpr 72
  .amdhsa_accum_offset 256
  .amdhsa_group_segment_fixed_size 0
  .amdhsa_kernarg_size 40
  .amdhsa_user_sgpr_count 2
  .amdhsa_user_sgpr_kernarg_segment_ptr 1
  .amdhsa_system_sgpr_workgroup_id_x 1
.end_amdhsa_kernel
.p2align 6
.amdhsa_kernel k3_kernel
  .amdhsa_next_free_vgpr 240
  .amdhsa_next_free_sgpr 72
  .amdhsa_accum_offset 240
  .amdhsa_group_segment_fixed_size 0
  .amdhsa_kernarg_size 40
  .amdhsa_user_sgpr_count 2
  .amdhsa_user_sgpr_kernarg_segment_ptr 1
  .amdhsa_system_sgpr_workgroup_id_x 1
.end_amdhsa_kernel
```
